```python
import torch

def _softmax(x, axis=-1):
    return torch.softmax(x, dim=axis)
def _gelu(x):
    return torch.nn.functional.gelu(x, approximate="tanh")
def _silu(x):
    return torch.nn.functional.silu(x)
def _sigmoid(x):
    return torch.sigmoid(x)
def _layernorm(x, axis=-1, eps=1e-5):
    m = x.mean(dim=axis, keepdim=True)
    v = x.var(dim=axis, keepdim=True, unbiased=False)
    return (x - m) / torch.sqrt(v + eps)
def _scatter_add(tgt, idx, src, axis=0):
    return tgt.clone().index_add_(axis, idx, src)
def _segment_sum(src, seg, n):
    out = torch.zeros((n,) + src.shape[1:], dtype=src.dtype)
    return out.index_add_(0, seg, src)
def _pad(x, pw):
    flat = tuple(v for pair in reversed(pw) for v in pair)
    return torch.nn.functional.pad(x, flat)

kernel_name = 'standalone__hybrid_graph_tf_exphormer__graph'

def setup_inputs():

    _w = (lambda a: (lambda t: t.to(torch.bfloat16) if t.is_floating_point() else t)(torch.as_tensor(a)))
    N, deg, D = 10000, 16, 256
    E = N * deg
    exp_deg = 4
    Ee = N * exp_deg
    src = (lambda lo, hi, *s: torch.randint(lo, hi, s))(0, N, E).to(torch.int64)
    dst = (lambda lo, hi, *s: torch.randint(lo, hi, s))(0, N, E).to(torch.int64)
    esrc = (lambda lo, hi, *s: torch.randint(lo, hi, s))(0, N, Ee).to(torch.int64)
    edst = torch.repeat_interleave(torch.arange(N), exp_deg).to(torch.int64)
    deg_cnt = torch.bincount(dst, minlength=N).to(float) + 1.0
    return {
        "x": _w((lambda *s: torch.randn(*s, dtype=torch.bfloat16) * 0.05)(N, D)),
        "src": _w(src),
        "dst": _w(dst),
        "esrc": _w(esrc),
        "edst": _w(edst),
        "deg_inv_sqrt": _w(1.0 / (lambda _x: torch.sqrt(torch.as_tensor(_x)))(deg_cnt)),
        "w_l": _w((lambda *s: torch.randn(*s, dtype=torch.bfloat16) * 0.05)(D, D)),
        "wq": _w((lambda *s: torch.randn(*s, dtype=torch.bfloat16) * 0.05)(D, D)),
        "wk": _w((lambda *s: torch.randn(*s, dtype=torch.bfloat16) * 0.05)(D, D)),
        "wv": _w((lambda *s: torch.randn(*s, dtype=torch.bfloat16) * 0.05)(D, D)),
    }

def reference(x, src, dst, esrc, edst, deg_inv_sqrt, w_l, wq, wk, wv):
    N, D = x.shape
    h = x @ w_l
    msg = h[src] * deg_inv_sqrt[src, None] * deg_inv_sqrt[dst, None]
    h_local = _segment_sum(msg, dst, N)
    q = x @ wq
    k = x @ wk
    v = x @ wv
    e = (q[edst] * k[esrc]).sum(-1) * (D ** -0.5)
    exp_e = torch.exp(e)
    denom = _segment_sum(exp_e[:, None], edst, N)[:, 0] + 1e-9
    alpha = exp_e / denom[edst]
    h_attn = _segment_sum(alpha[:, None] * v[esrc], edst, N)
    return h_local + h_attn
```

```asm
; @launch grid=(253,1,1) block=(512,1,1) lds=158208
.amdgcn_target "amdgcn-amd-amdhsa--gfx950"
.text
.globl standalone__hybrid_graph_tf_exphormer__graph_kernel
.p2align 8
.type standalone__hybrid_graph_tf_exphormer__graph_kernel,@function
standalone__hybrid_graph_tf_exphormer__graph_kernel:
    s_cmp_ge_u32 s2, 253
    s_cbranch_scc1 L_end
    s_load_dwordx16 s[4:19], s[0:1], 0
    s_load_dwordx8 s[20:27], s[0:1], 64
    s_load_dwordx2 s[28:29], s[0:1], 96
    v_lshrrev_b32 v1, 6, v0
    v_and_b32 v2, 63, v0
    s_mov_b32 s79, 67108864
    v_readfirstlane_b32 s3, v1
    v_and_b32 v3, 15, v2
    v_lshrrev_b32 v4, 4, v2
    s_and_b32 s31, s3, 3
    s_cmp_ge_u32 s3, 4
    s_cbranch_scc1 L_sparse
    s_cmp_ge_u32 s2, 250
    s_cbranch_scc1 L_end
    v_lshrrev_b32 v0, 5, v2
    s_lshl_b32 s64, s31, 1
    v_add_u32 v0, s64, v0
    v_and_b32 v1, 31, v2
    v_xor_b32 v1, v1, v0
    v_lshlrev_b32 v1, 4, v1
    v_lshl_add_u32 v0, v0, 9, v1
    v_xor_b32 v1, 0x80, v0
    v_lshrrev_b32 v11, 3, v2
    v_lshrrev_b32 v15, 2, v2
    v_and_b32 v15, 4, v15
    v_and_b32 v12, 7, v2
    v_xor_b32 v15, v15, v12
    v_lshlrev_b32 v15, 4, v15
    v_lshl_add_u32 v11, v11, 9, v15
    s_lshl_b32 s64, s31, 7
    v_add_u32 v11, s64, v11
    s_mul_i32 s65, s2, 20480
    s_lshl_b32 s66, s31, 10
    s_lshl_b32 s70, s31, 14
    s_add_u32 s70, s70, 92672
    s_mov_b32 s71, 3072
    s_mov_b32 s72, 6144
    s_mov_b32 s73, 9216
    s_waitcnt lgkmcnt(0)
    s_load_dword s30, s[28:29], 0
    s_mov_b32 s32, s4
    s_and_b32 s33, s5, 0xffff
    s_mov_b32 s34, 5120000
    s_mov_b32 s35, 0x20000
    s_mov_b32 s36, s22
    s_and_b32 s37, s23, 0xffff
    s_mov_b32 s38, 131072
    s_mov_b32 s39, 0x20000
    s_add_u32 m0, s66, 0
    s_nop 0
    buffer_load_dwordx4 v0, s[32:35], s65 offen lds
    s_add_u32 m0, s66, 4096
    s_add_u32 s65, s65, 4096
    buffer_load_dwordx4 v1, s[32:35], s65 offen lds
    s_add_u32 m0, s66, 8192
    s_add_u32 s65, s65, 4096
    buffer_load_dwordx4 v0, s[32:35], s65 offen lds
    s_add_u32 m0, s66, 12288
    s_add_u32 s65, s65, 4096
    buffer_load_dwordx4 v1, s[32:35], s65 offen lds
    s_add_u32 m0, s66, 16384
    s_add_u32 s65, s65, 4096
    buffer_load_dwordx4 v0, s[32:35], s65 offen lds
    s_add_u32 m0, s70, 0
    s_nop 0
    buffer_load_dwordx4 v11, s[36:39], 0 offen offset:0 lds
    buffer_load_dwordx4 v11, s[36:39], s71 offen offset:1024 lds
    buffer_load_dwordx4 v11, s[36:39], s72 offen offset:2048 lds
    buffer_load_dwordx4 v11, s[36:39], s73 offen offset:3072 lds
    v_add_u32 v11, 0x4000, v11
    s_mov_b32 s40, s16
    s_and_b32 s41, s17, 0xffff
    s_mov_b32 s42, 131072
    s_mov_b32 s43, 0x20000
    s_mov_b32 s44, s28
    s_and_b32 s45, s29, 0xffff
    s_mov_b32 s46, 1048576
    s_mov_b32 s47, 0x20000
    s_mov_b32 s48, s24
    s_and_b32 s49, s25, 0xffff
    s_mov_b32 s50, 5120000
    s_mov_b32 s51, 0x20000
    v_xor_b32 v15, v4, v3
    v_lshlrev_b32 v15, 4, v15
    v_lshl_add_u32 v5, v3, 9, v15
    v_xor_b32 v6, 64, v5
    v_xor_b32 v7, 0x80, v5
    v_xor_b32 v8, 0xc0, v5
    v_lshrrev_b32 v15, 2, v3
    v_lshl_add_u32 v15, v4, 3, v15
    v_lshlrev_b32 v15, 7, v15
    v_lshrrev_b32 v12, 1, v3
    v_and_b32 v12, 4, v12
    v_and_b32 v13, 3, v3
    v_xor_b32 v12, v12, v13
    v_lshl_add_u32 v15, v12, 4, v15
    v_add_u32 v9, s70, v15
    v_xor_b32 v10, 64, v9
    v_mov_b32 v13, 92416
    v_mov_b32 v14, 1
    s_waitcnt lgkmcnt(0)
    s_barrier
    s_mul_i32 s30, s30, 0x9E3779B1
    s_add_u32 s30, s30, 0x7F4A7C15
    s_add_u32 m0, s70, 4096
    s_nop 0
    buffer_load_dwordx4 v11, s[36:39], 0 offen offset:0 lds
    buffer_load_dwordx4 v11, s[36:39], s71 offen offset:1024 lds
    buffer_load_dwordx4 v11, s[36:39], s72 offen offset:2048 lds
    buffer_load_dwordx4 v11, s[36:39], s73 offen offset:3072 lds
    v_add_u32 v11, 0x4000, v11
    s_add_u32 m0, s70, 8192
    s_nop 0
    buffer_load_dwordx4 v11, s[36:39], 0 offen offset:0 lds
    buffer_load_dwordx4 v11, s[36:39], s71 offen offset:1024 lds
    buffer_load_dwordx4 v11, s[36:39], s72 offen offset:2048 lds
    buffer_load_dwordx4 v11, s[36:39], s73 offen offset:3072 lds
    v_add_u32 v11, 0x4000, v11
    s_add_u32 m0, s70, 12288
    s_nop 0
    buffer_load_dwordx4 v11, s[36:39], 0 offen offset:0 lds
    buffer_load_dwordx4 v11, s[36:39], s71 offen offset:1024 lds
    buffer_load_dwordx4 v11, s[36:39], s72 offen offset:2048 lds
    buffer_load_dwordx4 v11, s[36:39], s73 offen offset:3072 lds
    v_add_u32 v11, 0x4000, v11
    s_waitcnt vmcnt(12)
    s_waitcnt lgkmcnt(0)
    s_mov_b64 exec, 1
    ds_add_u32 v13, v14 offset:4
    s_mov_b64 exec, -1
    ds_read_b64_tr_b16 v[128:129], v9 offset:0
    ds_read_b64_tr_b16 v[130:131], v9 offset:512
    ds_read_b64_tr_b16 v[132:133], v9 offset:8
    ds_read_b64_tr_b16 v[134:135], v9 offset:520
    ds_read_b64_tr_b16 v[136:137], v10 offset:0
    ds_read_b64_tr_b16 v[138:139], v10 offset:512
    ds_read_b64_tr_b16 v[140:141], v10 offset:8
    ds_read_b64_tr_b16 v[142:143], v10 offset:520
    s_waitcnt lgkmcnt(0)
    s_add_u32 m0, s70, 0
    s_nop 0
    buffer_load_dwordx4 v11, s[36:39], 0 offen offset:0 lds
    buffer_load_dwordx4 v11, s[36:39], s71 offen offset:1024 lds
    buffer_load_dwordx4 v11, s[36:39], s72 offen offset:2048 lds
    buffer_load_dwordx4 v11, s[36:39], s73 offen offset:3072 lds
    v_add_u32 v11, 0x4000, v11
    s_waitcnt vmcnt(12)
    ds_read_b64_tr_b16 v[144:145], v9 offset:4096
    ds_read_b64_tr_b16 v[146:147], v9 offset:4608
    ds_read_b64_tr_b16 v[148:149], v9 offset:4104
    ds_read_b64_tr_b16 v[150:151], v9 offset:4616
    ds_read_b64_tr_b16 v[152:153], v10 offset:4096
    ds_read_b64_tr_b16 v[154:155], v10 offset:4608
    ds_read_b64_tr_b16 v[156:157], v10 offset:4104
    ds_read_b64_tr_b16 v[158:159], v10 offset:4616
    s_waitcnt lgkmcnt(0)
    s_add_u32 m0, s70, 4096
    s_nop 0
    buffer_load_dwordx4 v11, s[36:39], 0 offen offset:0 lds
    buffer_load_dwordx4 v11, s[36:39], s71 offen offset:1024 lds
    buffer_load_dwordx4 v11, s[36:39], s72 offen offset:2048 lds
    buffer_load_dwordx4 v11, s[36:39], s73 offen offset:3072 lds
    v_add_u32 v11, 0x4000, v11
    s_waitcnt vmcnt(12)
    ds_read_b64_tr_b16 v[160:161], v9 offset:8192
    ds_read_b64_tr_b16 v[162:163], v9 offset:8704
    ds_read_b64_tr_b16 v[164:165], v9 offset:8200
    ds_read_b64_tr_b16 v[166:167], v9 offset:8712
    ds_read_b64_tr_b16 v[168:169], v10 offset:8192
    ds_read_b64_tr_b16 v[170:171], v10 offset:8704
    ds_read_b64_tr_b16 v[172:173], v10 offset:8200
    ds_read_b64_tr_b16 v[174:175], v10 offset:8712
    s_waitcnt lgkmcnt(0)
    s_add_u32 m0, s70, 8192
    s_nop 0
    buffer_load_dwordx4 v11, s[36:39], 0 offen offset:0 lds
    buffer_load_dwordx4 v11, s[36:39], s71 offen offset:1024 lds
    buffer_load_dwordx4 v11, s[36:39], s72 offen offset:2048 lds
    buffer_load_dwordx4 v11, s[36:39], s73 offen offset:3072 lds
    v_add_u32 v11, 0x4000, v11
    s_waitcnt vmcnt(12)
    ds_read_b64_tr_b16 v[176:177], v9 offset:12288
    ds_read_b64_tr_b16 v[178:179], v9 offset:12800
    ds_read_b64_tr_b16 v[180:181], v9 offset:12296
    ds_read_b64_tr_b16 v[182:183], v9 offset:12808
    ds_read_b64_tr_b16 v[184:185], v10 offset:12288
    ds_read_b64_tr_b16 v[186:187], v10 offset:12800
    ds_read_b64_tr_b16 v[188:189], v10 offset:12296
    ds_read_b64_tr_b16 v[190:191], v10 offset:12808
    s_waitcnt lgkmcnt(0)
    s_add_u32 m0, s70, 12288
    s_nop 0
    buffer_load_dwordx4 v11, s[36:39], 0 offen offset:0 lds
    buffer_load_dwordx4 v11, s[36:39], s71 offen offset:1024 lds
    buffer_load_dwordx4 v11, s[36:39], s72 offen offset:2048 lds
    buffer_load_dwordx4 v11, s[36:39], s73 offen offset:3072 lds
    v_add_u32 v11, 0x4000, v11
    s_waitcnt vmcnt(12)
    ds_read_b64_tr_b16 v[192:193], v9 offset:0
    ds_read_b64_tr_b16 v[194:195], v9 offset:512
    ds_read_b64_tr_b16 v[196:197], v9 offset:8
    ds_read_b64_tr_b16 v[198:199], v9 offset:520
    ds_read_b64_tr_b16 v[200:201], v10 offset:0
    ds_read_b64_tr_b16 v[202:203], v10 offset:512
    ds_read_b64_tr_b16 v[204:205], v10 offset:8
    ds_read_b64_tr_b16 v[206:207], v10 offset:520
    s_waitcnt vmcnt(8)
    ds_read_b64_tr_b16 v[208:209], v9 offset:4096
    ds_read_b64_tr_b16 v[210:211], v9 offset:4608
    ds_read_b64_tr_b16 v[212:213], v9 offset:4104
    ds_read_b64_tr_b16 v[214:215], v9 offset:4616
    ds_read_b64_tr_b16 v[216:217], v10 offset:4096
    ds_read_b64_tr_b16 v[218:219], v10 offset:4608
    ds_read_b64_tr_b16 v[220:221], v10 offset:4104
    ds_read_b64_tr_b16 v[222:223], v10 offset:4616
    s_waitcnt vmcnt(4)
    ds_read_b64_tr_b16 v[224:225], v9 offset:8192
    ds_read_b64_tr_b16 v[226:227], v9 offset:8704
    ds_read_b64_tr_b16 v[228:229], v9 offset:8200
    ds_read_b64_tr_b16 v[230:231], v9 offset:8712
    ds_read_b64_tr_b16 v[232:233], v10 offset:8192
    ds_read_b64_tr_b16 v[234:235], v10 offset:8704
    ds_read_b64_tr_b16 v[236:237], v10 offset:8200
    ds_read_b64_tr_b16 v[238:239], v10 offset:8712
    s_waitcnt vmcnt(0)
    ds_read_b64_tr_b16 v[240:241], v9 offset:12288
    ds_read_b64_tr_b16 v[242:243], v9 offset:12800
    ds_read_b64_tr_b16 v[244:245], v9 offset:12296
    ds_read_b64_tr_b16 v[246:247], v9 offset:12808
    ds_read_b64_tr_b16 v[248:249], v10 offset:12288
    ds_read_b64_tr_b16 v[250:251], v10 offset:12800
    ds_read_b64_tr_b16 v[252:253], v10 offset:12296
    ds_read_b64_tr_b16 v[254:255], v10 offset:12808
    v_and_b32 v0, 31, v2
    v_lshlrev_b32 v0, 2, v0
    s_and_b32 s64, s2, 15
    s_lshl_b32 s64, s64, 9
    s_lshl_b32 s65, s31, 7
    s_add_u32 s64, s64, s65
    s_add_u32 s74, s64, 4096
    v_subrev_u32 v11, 0x20000, v11
    v_lshlrev_b32 v12, 4, v2
    s_lshl_b32 s75, s31, 15
    s_add_u32 s75, s75, 65536
L_mpoll_1:
    buffer_load_dword v1, v0, s[44:47], s74 offen sc1
    s_waitcnt vmcnt(0)
    v_cmp_ne_u32 vcc, s30, v1
    s_cbranch_vccz L_mgo_2
    s_sub_u32 s79, s79, 1
    s_cbranch_scc1 L_end
    s_sleep 2
    s_branch L_mpoll_1
L_mgo_2:
    buffer_load_dwordx4 v[40:43], v12, s[44:47], s75 offen offset:0 sc1
    buffer_load_dwordx4 v[44:47], v12, s[44:47], s75 offen offset:1024 sc1
    buffer_load_dwordx4 v[48:51], v12, s[44:47], s75 offen offset:2048 sc1
    buffer_load_dwordx4 v[52:55], v12, s[44:47], s75 offen offset:3072 sc1
    s_add_u32 s75, s75, 4096
    buffer_load_dwordx4 v[56:59], v12, s[44:47], s75 offen offset:0 sc1
    buffer_load_dwordx4 v[60:63], v12, s[44:47], s75 offen offset:1024 sc1
    buffer_load_dwordx4 v[64:67], v12, s[44:47], s75 offen offset:2048 sc1
    buffer_load_dwordx4 v[68:71], v12, s[44:47], s75 offen offset:3072 sc1
    s_add_u32 s75, s75, 4096
    buffer_load_dwordx4 v[72:75], v12, s[44:47], s75 offen offset:0 sc1
    buffer_load_dwordx4 v[76:79], v12, s[44:47], s75 offen offset:1024 sc1
L_spin_3:
    ds_read_b32 v15, v13 offset:4
    s_waitcnt lgkmcnt(0)
    v_readfirstlane_b32 s64, v15
    s_cmp_ge_u32 s64, 4
    s_cbranch_scc1 L_go_4
    s_sub_u32 s79, s79, 1
    s_cbranch_scc1 L_end
    s_sleep 1
    s_branch L_spin_3
L_go_4:
    ds_read_b128 v[16:19], v5 offset:0
    ds_read_b128 v[20:23], v5 offset:8192
    ds_read_b128 v[24:27], v5 offset:16384
    ds_read_b128 v[28:31], v6 offset:0
    ds_read_b128 v[32:35], v6 offset:8192
    ds_read_b128 v[36:39], v6 offset:16384
    s_waitcnt lgkmcnt(3)
    s_waitcnt vmcnt(9)
    v_mfma_f32_16x16x32_bf16 v[80:83], v[40:43], v[16:19], 0
    v_mfma_f32_16x16x32_bf16 v[96:99], v[40:43], v[20:23], 0
    v_mfma_f32_16x16x32_bf16 v[112:115], v[40:43], v[24:27], 0
    buffer_load_dwordx4 v[40:43], v12, s[44:47], s75 offen offset:2048 sc1
    s_waitcnt vmcnt(9)
    v_mfma_f32_16x16x32_bf16 v[84:87], v[44:47], v[16:19], 0
    v_mfma_f32_16x16x32_bf16 v[100:103], v[44:47], v[20:23], 0
    v_mfma_f32_16x16x32_bf16 v[116:119], v[44:47], v[24:27], 0
    buffer_load_dwordx4 v[44:47], v12, s[44:47], s75 offen offset:3072 sc1
    s_add_u32 s75, s75, 4096
    s_waitcnt vmcnt(9)
    v_mfma_f32_16x16x32_bf16 v[88:91], v[48:51], v[16:19], 0
    v_mfma_f32_16x16x32_bf16 v[104:107], v[48:51], v[20:23], 0
    v_mfma_f32_16x16x32_bf16 v[120:123], v[48:51], v[24:27], 0
    buffer_load_dwordx4 v[48:51], v12, s[44:47], s75 offen offset:0 sc1
    s_waitcnt vmcnt(9)
    v_mfma_f32_16x16x32_bf16 v[92:95], v[52:55], v[16:19], 0
    v_mfma_f32_16x16x32_bf16 v[108:111], v[52:55], v[20:23], 0
    v_mfma_f32_16x16x32_bf16 v[124:127], v[52:55], v[24:27], 0
    buffer_load_dwordx4 v[52:55], v12, s[44:47], s75 offen offset:1024 sc1
    ds_read_b128 v[16:19], v7 offset:0
    ds_read_b128 v[20:23], v7 offset:8192
    ds_read_b128 v[24:27], v7 offset:16384
    s_waitcnt lgkmcnt(3)
    s_waitcnt vmcnt(9)
    v_mfma_f32_16x16x32_bf16 v[80:83], v[56:59], v[28:31], v[80:83]
    v_mfma_f32_16x16x32_bf16 v[96:99], v[56:59], v[32:35], v[96:99]
    v_mfma_f32_16x16x32_bf16 v[112:115], v[56:59], v[36:39], v[112:115]
    buffer_load_dwordx4 v[56:59], v12, s[44:47], s75 offen offset:2048 sc1
    s_waitcnt vmcnt(9)
    v_mfma_f32_16x16x32_bf16 v[84:87], v[60:63], v[28:31], v[84:87]
    v_mfma_f32_16x16x32_bf16 v[100:103], v[60:63], v[32:35], v[100:103]
    v_mfma_f32_16x16x32_bf16 v[116:119], v[60:63], v[36:39], v[116:119]
    buffer_load_dwordx4 v[60:63], v12, s[44:47], s75 offen offset:3072 sc1
    s_add_u32 s75, s75, 4096
    s_waitcnt vmcnt(9)
    v_mfma_f32_16x16x32_bf16 v[88:91], v[64:67], v[28:31], v[88:91]
    v_mfma_f32_16x16x32_bf16 v[104:107], v[64:67], v[32:35], v[104:107]
    v_mfma_f32_16x16x32_bf16 v[120:123], v[64:67], v[36:39], v[120:123]
    buffer_load_dwordx4 v[64:67], v12, s[44:47], s75 offen offset:0 sc1
    s_waitcnt vmcnt(9)
    v_mfma_f32_16x16x32_bf16 v[92:95], v[68:71], v[28:31], v[92:95]
    v_mfma_f32_16x16x32_bf16 v[108:111], v[68:71], v[32:35], v[108:111]
    v_mfma_f32_16x16x32_bf16 v[124:127], v[68:71], v[36:39], v[124:127]
    buffer_load_dwordx4 v[68:71], v12, s[44:47], s75 offen offset:1024 sc1
    ds_read_b128 v[28:31], v8 offset:0
    ds_read_b128 v[32:35], v8 offset:8192
    ds_read_b128 v[36:39], v8 offset:16384
    s_waitcnt lgkmcnt(3)
    s_waitcnt vmcnt(9)
    v_mfma_f32_16x16x32_bf16 v[80:83], v[72:75], v[16:19], v[80:83]
    v_mfma_f32_16x16x32_bf16 v[96:99], v[72:75], v[20:23], v[96:99]
    v_mfma_f32_16x16x32_bf16 v[112:115], v[72:75], v[24:27], v[112:115]
    buffer_load_dwordx4 v[72:75], v12, s[44:47], s75 offen offset:2048 sc1
    s_waitcnt vmcnt(9)
    v_mfma_f32_16x16x32_bf16 v[84:87], v[76:79], v[16:19], v[84:87]
    v_mfma_f32_16x16x32_bf16 v[100:103], v[76:79], v[20:23], v[100:103]
    v_mfma_f32_16x16x32_bf16 v[116:119], v[76:79], v[24:27], v[116:119]
    buffer_load_dwordx4 v[76:79], v12, s[44:47], s75 offen offset:3072 sc1
    s_add_u32 s75, s75, 4096
    s_waitcnt vmcnt(9)
    v_mfma_f32_16x16x32_bf16 v[88:91], v[40:43], v[16:19], v[88:91]
    v_mfma_f32_16x16x32_bf16 v[104:107], v[40:43], v[20:23], v[104:107]
    v_mfma_f32_16x16x32_bf16 v[120:123], v[40:43], v[24:27], v[120:123]
    buffer_load_dwordx4 v[40:43], v12, s[44:47], s75 offen offset:0 sc1
    s_waitcnt vmcnt(9)
    v_mfma_f32_16x16x32_bf16 v[92:95], v[44:47], v[16:19], v[92:95]
    v_mfma_f32_16x16x32_bf16 v[108:111], v[44:47], v[20:23], v[108:111]
    v_mfma_f32_16x16x32_bf16 v[124:127], v[44:47], v[24:27], v[124:127]
    buffer_load_dwordx4 v[44:47], v12, s[44:47], s75 offen offset:1024 sc1
    ds_read_b128 v[16:19], v5 offset:256
    ds_read_b128 v[20:23], v5 offset:8448
    ds_read_b128 v[24:27], v5 offset:16640
    s_waitcnt lgkmcnt(3)
    s_waitcnt vmcnt(9)
    v_mfma_f32_16x16x32_bf16 v[80:83], v[48:51], v[28:31], v[80:83]
    v_mfma_f32_16x16x32_bf16 v[96:99], v[48:51], v[32:35], v[96:99]
    v_mfma_f32_16x16x32_bf16 v[112:115], v[48:51], v[36:39], v[112:115]
    buffer_load_dwordx4 v[48:51], v12, s[44:47], s75 offen offset:2048 sc1
    s_waitcnt vmcnt(9)
    v_mfma_f32_16x16x32_bf16 v[84:87], v[52:55], v[28:31], v[84:87]
    v_mfma_f32_16x16x32_bf16 v[100:103], v[52:55], v[32:35], v[100:103]
    v_mfma_f32_16x16x32_bf16 v[116:119], v[52:55], v[36:39], v[116:119]
    buffer_load_dwordx4 v[52:55], v12, s[44:47], s75 offen offset:3072 sc1
    s_add_u32 s75, s75, 4096
    s_waitcnt vmcnt(9)
    v_mfma_f32_16x16x32_bf16 v[88:91], v[56:59], v[28:31], v[88:91]
    v_mfma_f32_16x16x32_bf16 v[104:107], v[56:59], v[32:35], v[104:107]
    v_mfma_f32_16x16x32_bf16 v[120:123], v[56:59], v[36:39], v[120:123]
    buffer_load_dwordx4 v[56:59], v12, s[44:47], s75 offen offset:0 sc1
    s_waitcnt vmcnt(9)
    v_mfma_f32_16x16x32_bf16 v[92:95], v[60:63], v[28:31], v[92:95]
    v_mfma_f32_16x16x32_bf16 v[108:111], v[60:63], v[32:35], v[108:111]
    v_mfma_f32_16x16x32_bf16 v[124:127], v[60:63], v[36:39], v[124:127]
    buffer_load_dwordx4 v[60:63], v12, s[44:47], s75 offen offset:1024 sc1
    ds_read_b128 v[28:31], v6 offset:256
    ds_read_b128 v[32:35], v6 offset:8448
    ds_read_b128 v[36:39], v6 offset:16640
    s_waitcnt lgkmcnt(3)
    s_waitcnt vmcnt(9)
    v_mfma_f32_16x16x32_bf16 v[80:83], v[64:67], v[16:19], v[80:83]
    v_mfma_f32_16x16x32_bf16 v[96:99], v[64:67], v[20:23], v[96:99]
    v_mfma_f32_16x16x32_bf16 v[112:115], v[64:67], v[24:27], v[112:115]
    buffer_load_dwordx4 v[64:67], v12, s[44:47], s75 offen offset:2048 sc1
    s_waitcnt vmcnt(9)
    v_mfma_f32_16x16x32_bf16 v[84:87], v[68:71], v[16:19], v[84:87]
    v_mfma_f32_16x16x32_bf16 v[100:103], v[68:71], v[20:23], v[100:103]
    v_mfma_f32_16x16x32_bf16 v[116:119], v[68:71], v[24:27], v[116:119]
    buffer_load_dwordx4 v[68:71], v12, s[44:47], s75 offen offset:3072 sc1
    s_add_u32 s75, s75, 4096
    s_waitcnt vmcnt(9)
    v_mfma_f32_16x16x32_bf16 v[88:91], v[72:75], v[16:19], v[88:91]
    v_mfma_f32_16x16x32_bf16 v[104:107], v[72:75], v[20:23], v[104:107]
    v_mfma_f32_16x16x32_bf16 v[120:123], v[72:75], v[24:27], v[120:123]
    buffer_load_dwordx4 v[72:75], v12, s[44:47], s75 offen offset:0 sc1
    s_waitcnt vmcnt(9)
    v_mfma_f32_16x16x32_bf16 v[92:95], v[76:79], v[16:19], v[92:95]
    v_mfma_f32_16x16x32_bf16 v[108:111], v[76:79], v[20:23], v[108:111]
    v_mfma_f32_16x16x32_bf16 v[124:127], v[76:79], v[24:27], v[124:127]
    buffer_load_dwordx4 v[76:79], v12, s[44:47], s75 offen offset:1024 sc1
    ds_read_b128 v[16:19], v7 offset:256
    ds_read_b128 v[20:23], v7 offset:8448
    ds_read_b128 v[24:27], v7 offset:16640
    s_waitcnt lgkmcnt(3)
    s_waitcnt vmcnt(9)
    v_mfma_f32_16x16x32_bf16 v[80:83], v[40:43], v[28:31], v[80:83]
    v_mfma_f32_16x16x32_bf16 v[96:99], v[40:43], v[32:35], v[96:99]
    v_mfma_f32_16x16x32_bf16 v[112:115], v[40:43], v[36:39], v[112:115]
    buffer_load_dwordx4 v[40:43], v12, s[44:47], s75 offen offset:2048 sc1
    s_waitcnt vmcnt(9)
    v_mfma_f32_16x16x32_bf16 v[84:87], v[44:47], v[28:31], v[84:87]
    v_mfma_f32_16x16x32_bf16 v[100:103], v[44:47], v[32:35], v[100:103]
    v_mfma_f32_16x16x32_bf16 v[116:119], v[44:47], v[36:39], v[116:119]
    buffer_load_dwordx4 v[44:47], v12, s[44:47], s75 offen offset:3072 sc1
    s_add_u32 s75, s75, 4096
    s_waitcnt vmcnt(9)
    v_mfma_f32_16x16x32_bf16 v[88:91], v[48:51], v[28:31], v[88:91]
    v_mfma_f32_16x16x32_bf16 v[104:107], v[48:51], v[32:35], v[104:107]
    v_mfma_f32_16x16x32_bf16 v[120:123], v[48:51], v[36:39], v[120:123]
    s_add_u32 m0, s70, 0
    s_nop 0
    buffer_load_dwordx4 v11, s[40:43], 0 offen offset:0 lds
    s_waitcnt vmcnt(9)
    v_mfma_f32_16x16x32_bf16 v[92:95], v[52:55], v[28:31], v[92:95]
    v_mfma_f32_16x16x32_bf16 v[108:111], v[52:55], v[32:35], v[108:111]
    v_mfma_f32_16x16x32_bf16 v[124:127], v[52:55], v[36:39], v[124:127]
    buffer_load_dwordx4 v11, s[40:43], s71 offen offset:1024 lds
    ds_read_b128 v[28:31], v8 offset:256
    ds_read_b128 v[32:35], v8 offset:8448
    ds_read_b128 v[36:39], v8 offset:16640
    s_waitcnt lgkmcnt(3)
    s_waitcnt vmcnt(9)
    v_mfma_f32_16x16x32_bf16 v[80:83], v[56:59], v[16:19], v[80:83]
    v_mfma_f32_16x16x32_bf16 v[96:99], v[56:59], v[20:23], v[96:99]
    v_mfma_f32_16x16x32_bf16 v[112:115], v[56:59], v[24:27], v[112:115]
    buffer_load_dwordx4 v11, s[40:43], s72 offen offset:2048 lds
    s_waitcnt vmcnt(9)
    v_mfma_f32_16x16x32_bf16 v[84:87], v[60:63], v[16:19], v[84:87]
    v_mfma_f32_16x16x32_bf16 v[100:103], v[60:63], v[20:23], v[100:103]
    v_mfma_f32_16x16x32_bf16 v[116:119], v[60:63], v[24:27], v[116:119]
    buffer_load_dwordx4 v11, s[40:43], s73 offen offset:3072 lds
    v_add_u32 v11, 0x4000, v11
    s_waitcnt vmcnt(9)
    v_mfma_f32_16x16x32_bf16 v[88:91], v[64:67], v[16:19], v[88:91]
    v_mfma_f32_16x16x32_bf16 v[104:107], v[64:67], v[20:23], v[104:107]
    v_mfma_f32_16x16x32_bf16 v[120:123], v[64:67], v[24:27], v[120:123]
    s_add_u32 m0, s70, 4096
    s_nop 0
    buffer_load_dwordx4 v11, s[40:43], 0 offen offset:0 lds
    s_waitcnt vmcnt(9)
    v_mfma_f32_16x16x32_bf16 v[92:95], v[68:71], v[16:19], v[92:95]
    v_mfma_f32_16x16x32_bf16 v[108:111], v[68:71], v[20:23], v[108:111]
    v_mfma_f32_16x16x32_bf16 v[124:127], v[68:71], v[24:27], v[124:127]
    buffer_load_dwordx4 v11, s[40:43], s71 offen offset:1024 lds
    s_waitcnt lgkmcnt(0)
    s_waitcnt vmcnt(9)
    v_mfma_f32_16x16x32_bf16 v[80:83], v[72:75], v[28:31], v[80:83]
    v_mfma_f32_16x16x32_bf16 v[96:99], v[72:75], v[32:35], v[96:99]
    v_mfma_f32_16x16x32_bf16 v[112:115], v[72:75], v[36:39], v[112:115]
    buffer_load_dwordx4 v11, s[40:43], s72 offen offset:2048 lds
    s_waitcnt vmcnt(9)
    v_mfma_f32_16x16x32_bf16 v[84:87], v[76:79], v[28:31], v[84:87]
    v_mfma_f32_16x16x32_bf16 v[100:103], v[76:79], v[32:35], v[100:103]
    v_mfma_f32_16x16x32_bf16 v[116:119], v[76:79], v[36:39], v[116:119]
    buffer_load_dwordx4 v11, s[40:43], s73 offen offset:3072 lds
    v_add_u32 v11, 0x4000, v11
    s_waitcnt vmcnt(9)
    v_mfma_f32_16x16x32_bf16 v[88:91], v[40:43], v[28:31], v[88:91]
    v_mfma_f32_16x16x32_bf16 v[104:107], v[40:43], v[32:35], v[104:107]
    v_mfma_f32_16x16x32_bf16 v[120:123], v[40:43], v[36:39], v[120:123]
    s_add_u32 m0, s70, 8192
    s_nop 0
    buffer_load_dwordx4 v11, s[40:43], 0 offen offset:0 lds
    s_waitcnt vmcnt(9)
    v_mfma_f32_16x16x32_bf16 v[92:95], v[44:47], v[28:31], v[92:95]
    v_mfma_f32_16x16x32_bf16 v[108:111], v[44:47], v[32:35], v[108:111]
    v_mfma_f32_16x16x32_bf16 v[124:127], v[44:47], v[36:39], v[124:127]
    buffer_load_dwordx4 v11, s[40:43], s71 offen offset:1024 lds
    s_lshl_b32 s64, s31, 3
    v_add_u32 v0, s64, v4
    v_xor_b32 v0, v0, v3
    v_lshlrev_b32 v0, 4, v0
    v_lshl_add_u32 v0, v3, 9, v0
    v_xor_b32 v1, 64, v0
    s_mov_b32 s76, 0x00ff00ff
    s_mov_b32 s77, 0x00ff00ff
    v_cvt_pk_bf16_f32 v16, v80, v81
    v_cvt_pk_bf16_f32 v17, v82, v83
    v_cvt_pk_bf16_f32 v18, v84, v85
    v_cvt_pk_bf16_f32 v19, v86, v87
    ds_write_b128 v0, v[16:19] offset:20480
    v_cvt_pk_bf16_f32 v20, v88, v89
    v_cvt_pk_bf16_f32 v21, v90, v91
    v_cvt_pk_bf16_f32 v22, v92, v93
    v_cvt_pk_bf16_f32 v23, v94, v95
    ds_write_b128 v1, v[20:23] offset:20480
    v_cvt_pk_bf16_f32 v24, v96, v97
    v_cvt_pk_bf16_f32 v25, v98, v99
    v_cvt_pk_bf16_f32 v26, v100, v101
    v_cvt_pk_bf16_f32 v27, v102, v103
    ds_write_b128 v0, v[24:27] offset:28672
    v_cvt_pk_bf16_f32 v28, v104, v105
    v_cvt_pk_bf16_f32 v29, v106, v107
    v_cvt_pk_bf16_f32 v30, v108, v109
    v_cvt_pk_bf16_f32 v31, v110, v111
    ds_write_b128 v1, v[28:31] offset:28672
    s_mov_b64 exec, s[76:77]
    v_cvt_pk_bf16_f32 v32, v112, v113
    v_cvt_pk_bf16_f32 v33, v114, v115
    v_cvt_pk_bf16_f32 v34, v116, v117
    v_cvt_pk_bf16_f32 v35, v118, v119
    ds_write_b128 v0, v[32:35] offset:36864
    v_cvt_pk_bf16_f32 v36, v120, v121
    v_cvt_pk_bf16_f32 v37, v122, v123
    v_cvt_pk_bf16_f32 v38, v124, v125
    v_cvt_pk_bf16_f32 v39, v126, v127
    ds_write_b128 v1, v[36:39] offset:36864
    s_mov_b64 exec, -1
    s_waitcnt lgkmcnt(0)
    s_barrier
    buffer_load_dwordx4 v11, s[40:43], s72 offen offset:2048 lds
    buffer_load_dwordx4 v11, s[40:43], s73 offen offset:3072 lds
    v_add_u32 v11, 0x4000, v11
    s_add_u32 m0, s70, 12288
    s_nop 0
    buffer_load_dwordx4 v11, s[40:43], 0 offen offset:0 lds
    buffer_load_dwordx4 v11, s[40:43], s71 offen offset:1024 lds
    buffer_load_dwordx4 v11, s[40:43], s72 offen offset:2048 lds
    buffer_load_dwordx4 v11, s[40:43], s73 offen offset:3072 lds
    v_add_u32 v11, 0x4000, v11
    v_lshlrev_b32 v0, 4, v4
    v_lshl_add_u32 v0, v3, 9, v0
    s_mul_i32 s74, s2, 20480
    s_lshl_b32 s64, s31, 7
    s_add_u32 s74, s74, s64
    s_waitcnt vmcnt(0)
    s_barrier
    ds_read_b128 v[16:19], v5 offset:0
    ds_read_b128 v[20:23], v5 offset:8192
    ds_read_b128 v[24:27], v5 offset:16384
    ds_read_b128 v[28:31], v6 offset:0
    ds_read_b128 v[32:35], v6 offset:8192
    ds_read_b128 v[36:39], v6 offset:16384
    s_waitcnt lgkmcnt(3)
    v_mfma_f32_16x16x32_bf16 v[80:83], v[128:131], v[16:19], 0
    v_mfma_f32_16x16x32_bf16 v[96:99], v[128:131], v[20:23], 0
    v_mfma_f32_16x16x32_bf16 v[112:115], v[128:131], v[24:27], 0
    v_mfma_f32_16x16x32_bf16 v[84:87], v[132:135], v[16:19], 0
    v_mfma_f32_16x16x32_bf16 v[100:103], v[132:135], v[20:23], 0
    v_mfma_f32_16x16x32_bf16 v[116:119], v[132:135], v[24:27], 0
    v_mfma_f32_16x16x32_bf16 v[88:91], v[136:139], v[16:19], 0
    v_mfma_f32_16x16x32_bf16 v[104:107], v[136:139], v[20:23], 0
    v_mfma_f32_16x16x32_bf16 v[120:123], v[136:139], v[24:27], 0
    v_mfma_f32_16x16x32_bf16 v[92:95], v[140:143], v[16:19], 0
    v_mfma_f32_16x16x32_bf16 v[108:111], v[140:143], v[20:23], 0
    v_mfma_f32_16x16x32_bf16 v[124:127], v[140:143], v[24:27], 0
    ds_read_b64_tr_b16 v[128:129], v9 offset:0
    ds_read_b64_tr_b16 v[130:131], v9 offset:512
    ds_read_b64_tr_b16 v[132:133], v9 offset:8
    ds_read_b64_tr_b16 v[134:135], v9 offset:520
    ds_read_b64_tr_b16 v[136:137], v10 offset:0
    ds_read_b64_tr_b16 v[138:139], v10 offset:512
    ds_read_b64_tr_b16 v[140:141], v10 offset:8
    ds_read_b64_tr_b16 v[142:143], v10 offset:520
    ds_read_b128 v[16:19], v7 offset:0
    ds_read_b128 v[20:23], v7 offset:8192
    ds_read_b128 v[24:27], v7 offset:16384
    s_waitcnt lgkmcnt(11)
    v_mfma_f32_16x16x32_bf16 v[80:83], v[144:147], v[28:31], v[80:83]
    v_mfma_f32_16x16x32_bf16 v[96:99], v[144:147], v[32:35], v[96:99]
    v_mfma_f32_16x16x32_bf16 v[112:115], v[144:147], v[36:39], v[112:115]
    v_mfma_f32_16x16x32_bf16 v[84:87], v[148:151], v[28:31], v[84:87]
    v_mfma_f32_16x16x32_bf16 v[100:103], v[148:151], v[32:35], v[100:103]
    v_mfma_f32_16x16x32_bf16 v[116:119], v[148:151], v[36:39], v[116:119]
    v_mfma_f32_16x16x32_bf16 v[88:91], v[152:155], v[28:31], v[88:91]
    v_mfma_f32_16x16x32_bf16 v[104:107], v[152:155], v[32:35], v[104:107]
    v_mfma_f32_16x16x32_bf16 v[120:123], v[152:155], v[36:39], v[120:123]
    v_mfma_f32_16x16x32_bf16 v[92:95], v[156:159], v[28:31], v[92:95]
    v_mfma_f32_16x16x32_bf16 v[108:111], v[156:159], v[32:35], v[108:111]
    v_mfma_f32_16x16x32_bf16 v[124:127], v[156:159], v[36:39], v[124:127]
    s_waitcnt lgkmcnt(3)
    s_add_u32 m0, s70, 0
    s_nop 0
    buffer_load_dwordx4 v11, s[40:43], 0 offen offset:0 lds
    buffer_load_dwordx4 v11, s[40:43], s71 offen offset:1024 lds
    buffer_load_dwordx4 v11, s[40:43], s72 offen offset:2048 lds
    buffer_load_dwordx4 v11, s[40:43], s73 offen offset:3072 lds
    v_add_u32 v11, 0x4000, v11
    ds_read_b64_tr_b16 v[144:145], v9 offset:4096
    ds_read_b64_tr_b16 v[146:147], v9 offset:4608
    ds_read_b64_tr_b16 v[148:149], v9 offset:4104
    ds_read_b64_tr_b16 v[150:151], v9 offset:4616
    ds_read_b64_tr_b16 v[152:153], v10 offset:4096
    ds_read_b64_tr_b16 v[154:155], v10 offset:4608
    ds_read_b64_tr_b16 v[156:157], v10 offset:4104
    ds_read_b64_tr_b16 v[158:159], v10 offset:4616
    ds_read_b128 v[28:31], v8 offset:0
    ds_read_b128 v[32:35], v8 offset:8192
    ds_read_b128 v[36:39], v8 offset:16384
    s_waitcnt lgkmcnt(11)
    v_mfma_f32_16x16x32_bf16 v[80:83], v[160:163], v[16:19], v[80:83]
    v_mfma_f32_16x16x32_bf16 v[96:99], v[160:163], v[20:23], v[96:99]
    v_mfma_f32_16x16x32_bf16 v[112:115], v[160:163], v[24:27], v[112:115]
    v_mfma_f32_16x16x32_bf16 v[84:87], v[164:167], v[16:19], v[84:87]
    v_mfma_f32_16x16x32_bf16 v[100:103], v[164:167], v[20:23], v[100:103]
    v_mfma_f32_16x16x32_bf16 v[116:119], v[164:167], v[24:27], v[116:119]
    v_mfma_f32_16x16x32_bf16 v[88:91], v[168:171], v[16:19], v[88:91]
    v_mfma_f32_16x16x32_bf16 v[104:107], v[168:171], v[20:23], v[104:107]
    v_mfma_f32_16x16x32_bf16 v[120:123], v[168:171], v[24:27], v[120:123]
    v_mfma_f32_16x16x32_bf16 v[92:95], v[172:175], v[16:19], v[92:95]
    v_mfma_f32_16x16x32_bf16 v[108:111], v[172:175], v[20:23], v[108:111]
    v_mfma_f32_16x16x32_bf16 v[124:127], v[172:175], v[24:27], v[124:127]
    s_waitcnt lgkmcnt(3)
    s_add_u32 m0, s70, 4096
    s_nop 0
    buffer_load_dwordx4 v11, s[40:43], 0 offen offset:0 lds
    buffer_load_dwordx4 v11, s[40:43], s71 offen offset:1024 lds
    buffer_load_dwordx4 v11, s[40:43], s72 offen offset:2048 lds
    buffer_load_dwordx4 v11, s[40:43], s73 offen offset:3072 lds
    v_add_u32 v11, 0x4000, v11
    ds_read_b64_tr_b16 v[160:161], v9 offset:8192
    ds_read_b64_tr_b16 v[162:163], v9 offset:8704
    ds_read_b64_tr_b16 v[164:165], v9 offset:8200
    ds_read_b64_tr_b16 v[166:167], v9 offset:8712
    ds_read_b64_tr_b16 v[168:169], v10 offset:8192
    ds_read_b64_tr_b16 v[170:171], v10 offset:8704
    ds_read_b64_tr_b16 v[172:173], v10 offset:8200
    ds_read_b64_tr_b16 v[174:175], v10 offset:8712
    ds_read_b128 v[16:19], v5 offset:256
    ds_read_b128 v[20:23], v5 offset:8448
    ds_read_b128 v[24:27], v5 offset:16640
    s_waitcnt lgkmcnt(11)
    v_mfma_f32_16x16x32_bf16 v[80:83], v[176:179], v[28:31], v[80:83]
    v_mfma_f32_16x16x32_bf16 v[96:99], v[176:179], v[32:35], v[96:99]
    v_mfma_f32_16x16x32_bf16 v[112:115], v[176:179], v[36:39], v[112:115]
    v_mfma_f32_16x16x32_bf16 v[84:87], v[180:183], v[28:31], v[84:87]
    v_mfma_f32_16x16x32_bf16 v[100:103], v[180:183], v[32:35], v[100:103]
    v_mfma_f32_16x16x32_bf16 v[116:119], v[180:183], v[36:39], v[116:119]
    v_mfma_f32_16x16x32_bf16 v[88:91], v[184:187], v[28:31], v[88:91]
    v_mfma_f32_16x16x32_bf16 v[104:107], v[184:187], v[32:35], v[104:107]
    v_mfma_f32_16x16x32_bf16 v[120:123], v[184:187], v[36:39], v[120:123]
    v_mfma_f32_16x16x32_bf16 v[92:95], v[188:191], v[28:31], v[92:95]
    v_mfma_f32_16x16x32_bf16 v[108:111], v[188:191], v[32:35], v[108:111]
    v_mfma_f32_16x16x32_bf16 v[124:127], v[188:191], v[36:39], v[124:127]
    s_waitcnt lgkmcnt(3)
    s_add_u32 m0, s70, 8192
    s_nop 0
    buffer_load_dwordx4 v11, s[40:43], 0 offen offset:0 lds
    buffer_load_dwordx4 v11, s[40:43], s71 offen offset:1024 lds
    buffer_load_dwordx4 v11, s[40:43], s72 offen offset:2048 lds
    buffer_load_dwordx4 v11, s[40:43], s73 offen offset:3072 lds
    v_add_u32 v11, 0x4000, v11
    ds_read_b64_tr_b16 v[176:177], v9 offset:12288
    ds_read_b64_tr_b16 v[178:179], v9 offset:12800
    ds_read_b64_tr_b16 v[180:181], v9 offset:12296
    ds_read_b64_tr_b16 v[182:183], v9 offset:12808
    ds_read_b64_tr_b16 v[184:185], v10 offset:12288
    ds_read_b64_tr_b16 v[186:187], v10 offset:12800
    ds_read_b64_tr_b16 v[188:189], v10 offset:12296
    ds_read_b64_tr_b16 v[190:191], v10 offset:12808
    ds_read_b128 v[28:31], v6 offset:256
    ds_read_b128 v[32:35], v6 offset:8448
    ds_read_b128 v[36:39], v6 offset:16640
    s_waitcnt lgkmcnt(11)
    v_mfma_f32_16x16x32_bf16 v[80:83], v[192:195], v[16:19], v[80:83]
    v_mfma_f32_16x16x32_bf16 v[96:99], v[192:195], v[20:23], v[96:99]
    v_mfma_f32_16x16x32_bf16 v[112:115], v[192:195], v[24:27], v[112:115]
    v_mfma_f32_16x16x32_bf16 v[84:87], v[196:199], v[16:19], v[84:87]
    v_mfma_f32_16x16x32_bf16 v[100:103], v[196:199], v[20:23], v[100:103]
    v_mfma_f32_16x16x32_bf16 v[116:119], v[196:199], v[24:27], v[116:119]
    v_mfma_f32_16x16x32_bf16 v[88:91], v[200:203], v[16:19], v[88:91]
    v_mfma_f32_16x16x32_bf16 v[104:107], v[200:203], v[20:23], v[104:107]
    v_mfma_f32_16x16x32_bf16 v[120:123], v[200:203], v[24:27], v[120:123]
    v_mfma_f32_16x16x32_bf16 v[92:95], v[204:207], v[16:19], v[92:95]
    v_mfma_f32_16x16x32_bf16 v[108:111], v[204:207], v[20:23], v[108:111]
    v_mfma_f32_16x16x32_bf16 v[124:127], v[204:207], v[24:27], v[124:127]
    s_waitcnt lgkmcnt(3)
    s_add_u32 m0, s70, 12288
    s_nop 0
    buffer_load_dwordx4 v11, s[40:43], 0 offen offset:0 lds
    buffer_load_dwordx4 v11, s[40:43], s71 offen offset:1024 lds
    buffer_load_dwordx4 v11, s[40:43], s72 offen offset:2048 lds
    buffer_load_dwordx4 v11, s[40:43], s73 offen offset:3072 lds
    v_add_u32 v11, 0x4000, v11
    ds_read_b128 v[16:19], v7 offset:256
    ds_read_b128 v[20:23], v7 offset:8448
    ds_read_b128 v[24:27], v7 offset:16640
    s_waitcnt lgkmcnt(3)
    v_mfma_f32_16x16x32_bf16 v[80:83], v[208:211], v[28:31], v[80:83]
    v_mfma_f32_16x16x32_bf16 v[96:99], v[208:211], v[32:35], v[96:99]
    v_mfma_f32_16x16x32_bf16 v[112:115], v[208:211], v[36:39], v[112:115]
    v_mfma_f32_16x16x32_bf16 v[84:87], v[212:215], v[28:31], v[84:87]
    v_mfma_f32_16x16x32_bf16 v[100:103], v[212:215], v[32:35], v[100:103]
    v_mfma_f32_16x16x32_bf16 v[116:119], v[212:215], v[36:39], v[116:119]
    v_mfma_f32_16x16x32_bf16 v[88:91], v[216:219], v[28:31], v[88:91]
    v_mfma_f32_16x16x32_bf16 v[104:107], v[216:219], v[32:35], v[104:107]
    v_mfma_f32_16x16x32_bf16 v[120:123], v[216:219], v[36:39], v[120:123]
    v_mfma_f32_16x16x32_bf16 v[92:95], v[220:223], v[28:31], v[92:95]
    v_mfma_f32_16x16x32_bf16 v[108:111], v[220:223], v[32:35], v[108:111]
    v_mfma_f32_16x16x32_bf16 v[124:127], v[220:223], v[36:39], v[124:127]
    ds_read_b128 v[28:31], v8 offset:256
    ds_read_b128 v[32:35], v8 offset:8448
    ds_read_b128 v[36:39], v8 offset:16640
    s_waitcnt lgkmcnt(3)
    v_mfma_f32_16x16x32_bf16 v[80:83], v[224:227], v[16:19], v[80:83]
    v_mfma_f32_16x16x32_bf16 v[96:99], v[224:227], v[20:23], v[96:99]
    v_mfma_f32_16x16x32_bf16 v[112:115], v[224:227], v[24:27], v[112:115]
    v_mfma_f32_16x16x32_bf16 v[84:87], v[228:231], v[16:19], v[84:87]
    v_mfma_f32_16x16x32_bf16 v[100:103], v[228:231], v[20:23], v[100:103]
    v_mfma_f32_16x16x32_bf16 v[116:119], v[228:231], v[24:27], v[116:119]
    v_mfma_f32_16x16x32_bf16 v[88:91], v[232:235], v[16:19], v[88:91]
    v_mfma_f32_16x16x32_bf16 v[104:107], v[232:235], v[20:23], v[104:107]
    v_mfma_f32_16x16x32_bf16 v[120:123], v[232:235], v[24:27], v[120:123]
    v_mfma_f32_16x16x32_bf16 v[92:95], v[236:239], v[16:19], v[92:95]
    v_mfma_f32_16x16x32_bf16 v[108:111], v[236:239], v[20:23], v[108:111]
    v_mfma_f32_16x16x32_bf16 v[124:127], v[236:239], v[24:27], v[124:127]
    s_waitcnt lgkmcnt(0)
    v_mfma_f32_16x16x32_bf16 v[80:83], v[240:243], v[28:31], v[80:83]
    v_mfma_f32_16x16x32_bf16 v[96:99], v[240:243], v[32:35], v[96:99]
    v_mfma_f32_16x16x32_bf16 v[112:115], v[240:243], v[36:39], v[112:115]
    v_mfma_f32_16x16x32_bf16 v[84:87], v[244:247], v[28:31], v[84:87]
    v_mfma_f32_16x16x32_bf16 v[100:103], v[244:247], v[32:35], v[100:103]
    v_mfma_f32_16x16x32_bf16 v[116:119], v[244:247], v[36:39], v[116:119]
    v_mfma_f32_16x16x32_bf16 v[88:91], v[248:251], v[28:31], v[88:91]
    v_mfma_f32_16x16x32_bf16 v[104:107], v[248:251], v[32:35], v[104:107]
    v_mfma_f32_16x16x32_bf16 v[120:123], v[248:251], v[36:39], v[120:123]
    v_mfma_f32_16x16x32_bf16 v[92:95], v[252:255], v[28:31], v[92:95]
    v_mfma_f32_16x16x32_bf16 v[108:111], v[252:255], v[32:35], v[108:111]
    v_mfma_f32_16x16x32_bf16 v[124:127], v[252:255], v[36:39], v[124:127]
    s_waitcnt vmcnt(12)
    ds_read_b64_tr_b16 v[192:193], v9 offset:0
    ds_read_b64_tr_b16 v[194:195], v9 offset:512
    ds_read_b64_tr_b16 v[196:197], v9 offset:8
    ds_read_b64_tr_b16 v[198:199], v9 offset:520
    ds_read_b64_tr_b16 v[200:201], v10 offset:0
    ds_read_b64_tr_b16 v[202:203], v10 offset:512
    ds_read_b64_tr_b16 v[204:205], v10 offset:8
    ds_read_b64_tr_b16 v[206:207], v10 offset:520
    s_waitcnt vmcnt(8)
    ds_read_b64_tr_b16 v[208:209], v9 offset:4096
    ds_read_b64_tr_b16 v[210:211], v9 offset:4608
    ds_read_b64_tr_b16 v[212:213], v9 offset:4104
    ds_read_b64_tr_b16 v[214:215], v9 offset:4616
    ds_read_b64_tr_b16 v[216:217], v10 offset:4096
    ds_read_b64_tr_b16 v[218:219], v10 offset:4608
    ds_read_b64_tr_b16 v[220:221], v10 offset:4104
    ds_read_b64_tr_b16 v[222:223], v10 offset:4616
    s_waitcnt vmcnt(4)
    ds_read_b64_tr_b16 v[224:225], v9 offset:8192
    ds_read_b64_tr_b16 v[226:227], v9 offset:8704
    ds_read_b64_tr_b16 v[228:229], v9 offset:8200
    ds_read_b64_tr_b16 v[230:231], v9 offset:8712
    ds_read_b64_tr_b16 v[232:233], v10 offset:8192
    ds_read_b64_tr_b16 v[234:235], v10 offset:8704
    ds_read_b64_tr_b16 v[236:237], v10 offset:8200
    ds_read_b64_tr_b16 v[238:239], v10 offset:8712
    s_waitcnt vmcnt(0)
    ds_read_b64_tr_b16 v[240:241], v9 offset:12288
    ds_read_b64_tr_b16 v[242:243], v9 offset:12800
    ds_read_b64_tr_b16 v[244:245], v9 offset:12296
    ds_read_b64_tr_b16 v[246:247], v9 offset:12808
    ds_read_b64_tr_b16 v[248:249], v10 offset:12288
    ds_read_b64_tr_b16 v[250:251], v10 offset:12800
    ds_read_b64_tr_b16 v[252:253], v10 offset:12296
    ds_read_b64_tr_b16 v[254:255], v10 offset:12808
L_spin_5:
    ds_read_b32 v15, v13 offset:16
    s_waitcnt lgkmcnt(0)
    v_readfirstlane_b32 s64, v15
    s_cmp_ge_u32 s64, 8
    s_cbranch_scc1 L_go_6
    s_sub_u32 s79, s79, 1
    s_cbranch_scc1 L_end
    s_sleep 1
    s_branch L_spin_5
L_go_6:
    ds_read_b128 v[16:19], v5 offset:40960
    ds_read_b128 v[20:23], v6 offset:40960
    ds_read_b128 v[24:27], v7 offset:40960
    ds_read_b128 v[28:31], v8 offset:40960
    ds_read_b128 v[32:35], v5 offset:41216
    ds_read_b128 v[36:39], v6 offset:41216
    ds_read_b128 v[40:43], v7 offset:41216
    ds_read_b128 v[44:47], v8 offset:41216
    s_waitcnt lgkmcnt(7)
    v_mfma_f32_16x16x32_bf16 v[80:83], v[128:131], v[16:19], v[80:83]
    v_mfma_f32_16x16x32_bf16 v[84:87], v[132:135], v[16:19], v[84:87]
    v_mfma_f32_16x16x32_bf16 v[88:91], v[136:139], v[16:19], v[88:91]
    v_mfma_f32_16x16x32_bf16 v[92:95], v[140:143], v[16:19], v[92:95]
    s_waitcnt lgkmcnt(6)
    v_mfma_f32_16x16x32_bf16 v[80:83], v[144:147], v[20:23], v[80:83]
    v_mfma_f32_16x16x32_bf16 v[84:87], v[148:151], v[20:23], v[84:87]
    v_mfma_f32_16x16x32_bf16 v[88:91], v[152:155], v[20:23], v[88:91]
    v_mfma_f32_16x16x32_bf16 v[92:95], v[156:159], v[20:23], v[92:95]
    s_waitcnt lgkmcnt(5)
    v_mfma_f32_16x16x32_bf16 v[80:83], v[160:163], v[24:27], v[80:83]
    v_mfma_f32_16x16x32_bf16 v[84:87], v[164:167], v[24:27], v[84:87]
    v_mfma_f32_16x16x32_bf16 v[88:91], v[168:171], v[24:27], v[88:91]
    v_mfma_f32_16x16x32_bf16 v[92:95], v[172:175], v[24:27], v[92:95]
    s_waitcnt lgkmcnt(4)
    v_mfma_f32_16x16x32_bf16 v[80:83], v[176:179], v[28:31], v[80:83]
    v_mfma_f32_16x16x32_bf16 v[84:87], v[180:183], v[28:31], v[84:87]
    v_mfma_f32_16x16x32_bf16 v[88:91], v[184:187], v[28:31], v[88:91]
    v_mfma_f32_16x16x32_bf16 v[92:95], v[188:191], v[28:31], v[92:95]
    s_waitcnt lgkmcnt(3)
    v_mfma_f32_16x16x32_bf16 v[80:83], v[192:195], v[32:35], v[80:83]
    v_mfma_f32_16x16x32_bf16 v[84:87], v[196:199], v[32:35], v[84:87]
    v_mfma_f32_16x16x32_bf16 v[88:91], v[200:203], v[32:35], v[88:91]
    v_mfma_f32_16x16x32_bf16 v[92:95], v[204:207], v[32:35], v[92:95]
    s_waitcnt lgkmcnt(2)
    v_mfma_f32_16x16x32_bf16 v[80:83], v[208:211], v[36:39], v[80:83]
    v_mfma_f32_16x16x32_bf16 v[84:87], v[212:215], v[36:39], v[84:87]
    v_mfma_f32_16x16x32_bf16 v[88:91], v[216:219], v[36:39], v[88:91]
    v_mfma_f32_16x16x32_bf16 v[92:95], v[220:223], v[36:39], v[92:95]
    s_waitcnt lgkmcnt(1)
    v_mfma_f32_16x16x32_bf16 v[80:83], v[224:227], v[40:43], v[80:83]
    v_mfma_f32_16x16x32_bf16 v[84:87], v[228:231], v[40:43], v[84:87]
    v_mfma_f32_16x16x32_bf16 v[88:91], v[232:235], v[40:43], v[88:91]
    v_mfma_f32_16x16x32_bf16 v[92:95], v[236:239], v[40:43], v[92:95]
    s_waitcnt lgkmcnt(0)
    v_mfma_f32_16x16x32_bf16 v[80:83], v[240:243], v[44:47], v[80:83]
    v_mfma_f32_16x16x32_bf16 v[84:87], v[244:247], v[44:47], v[84:87]
    v_mfma_f32_16x16x32_bf16 v[88:91], v[248:251], v[44:47], v[88:91]
    v_mfma_f32_16x16x32_bf16 v[92:95], v[252:255], v[44:47], v[92:95]
    s_nop 5
    v_cvt_pk_bf16_f32 v48, v80, v81
    v_cvt_pk_bf16_f32 v49, v82, v83
    v_cvt_pk_bf16_f32 v50, v84, v85
    v_cvt_pk_bf16_f32 v51, v86, v87
    buffer_store_dwordx4 v[48:51], v0, s[48:51], s74 offen offset:0
    v_cvt_pk_bf16_f32 v52, v88, v89
    v_cvt_pk_bf16_f32 v53, v90, v91
    v_cvt_pk_bf16_f32 v54, v92, v93
    v_cvt_pk_bf16_f32 v55, v94, v95
    buffer_store_dwordx4 v[52:55], v0, s[48:51], s74 offen offset:64
    s_add_u32 s74, s74, 8192
L_spin_7:
    ds_read_b32 v15, v13 offset:20
    s_waitcnt lgkmcnt(0)
    v_readfirstlane_b32 s64, v15
    s_cmp_ge_u32 s64, 8
    s_cbranch_scc1 L_go_8
    s_sub_u32 s79, s79, 1
    s_cbranch_scc1 L_end
    s_sleep 1
    s_branch L_spin_7
L_go_8:
    ds_read_b128 v[16:19], v5 offset:49152
    ds_read_b128 v[20:23], v6 offset:49152
    ds_read_b128 v[24:27], v7 offset:49152
    ds_read_b128 v[28:31], v8 offset:49152
    ds_read_b128 v[32:35], v5 offset:49408
    ds_read_b128 v[36:39], v6 offset:49408
    ds_read_b128 v[40:43], v7 offset:49408
    ds_read_b128 v[44:47], v8 offset:49408
    s_waitcnt lgkmcnt(7)
    v_mfma_f32_16x16x32_bf16 v[96:99], v[128:131], v[16:19], v[96:99]
    v_mfma_f32_16x16x32_bf16 v[100:103], v[132:135], v[16:19], v[100:103]
    v_mfma_f32_16x16x32_bf16 v[104:107], v[136:139], v[16:19], v[104:107]
    v_mfma_f32_16x16x32_bf16 v[108:111], v[140:143], v[16:19], v[108:111]
    s_waitcnt lgkmcnt(6)
    v_mfma_f32_16x16x32_bf16 v[96:99], v[144:147], v[20:23], v[96:99]
    v_mfma_f32_16x16x32_bf16 v[100:103], v[148:151], v[20:23], v[100:103]
    v_mfma_f32_16x16x32_bf16 v[104:107], v[152:155], v[20:23], v[104:107]
    v_mfma_f32_16x16x32_bf16 v[108:111], v[156:159], v[20:23], v[108:111]
    s_waitcnt lgkmcnt(5)
    v_mfma_f32_16x16x32_bf16 v[96:99], v[160:163], v[24:27], v[96:99]
    v_mfma_f32_16x16x32_bf16 v[100:103], v[164:167], v[24:27], v[100:103]
    v_mfma_f32_16x16x32_bf16 v[104:107], v[168:171], v[24:27], v[104:107]
    v_mfma_f32_16x16x32_bf16 v[108:111], v[172:175], v[24:27], v[108:111]
    s_waitcnt lgkmcnt(4)
    v_mfma_f32_16x16x32_bf16 v[96:99], v[176:179], v[28:31], v[96:99]
    v_mfma_f32_16x16x32_bf16 v[100:103], v[180:183], v[28:31], v[100:103]
    v_mfma_f32_16x16x32_bf16 v[104:107], v[184:187], v[28:31], v[104:107]
    v_mfma_f32_16x16x32_bf16 v[108:111], v[188:191], v[28:31], v[108:111]
    s_waitcnt lgkmcnt(3)
    v_mfma_f32_16x16x32_bf16 v[96:99], v[192:195], v[32:35], v[96:99]
    v_mfma_f32_16x16x32_bf16 v[100:103], v[196:199], v[32:35], v[100:103]
    v_mfma_f32_16x16x32_bf16 v[104:107], v[200:203], v[32:35], v[104:107]
    v_mfma_f32_16x16x32_bf16 v[108:111], v[204:207], v[32:35], v[108:111]
    s_waitcnt lgkmcnt(2)
    v_mfma_f32_16x16x32_bf16 v[96:99], v[208:211], v[36:39], v[96:99]
    v_mfma_f32_16x16x32_bf16 v[100:103], v[212:215], v[36:39], v[100:103]
    v_mfma_f32_16x16x32_bf16 v[104:107], v[216:219], v[36:39], v[104:107]
    v_mfma_f32_16x16x32_bf16 v[108:111], v[220:223], v[36:39], v[108:111]
    s_waitcnt lgkmcnt(1)
    v_mfma_f32_16x16x32_bf16 v[96:99], v[224:227], v[40:43], v[96:99]
    v_mfma_f32_16x16x32_bf16 v[100:103], v[228:231], v[40:43], v[100:103]
    v_mfma_f32_16x16x32_bf16 v[104:107], v[232:235], v[40:43], v[104:107]
    v_mfma_f32_16x16x32_bf16 v[108:111], v[236:239], v[40:43], v[108:111]
    s_waitcnt lgkmcnt(0)
    v_mfma_f32_16x16x32_bf16 v[96:99], v[240:243], v[44:47], v[96:99]
    v_mfma_f32_16x16x32_bf16 v[100:103], v[244:247], v[44:47], v[100:103]
    v_mfma_f32_16x16x32_bf16 v[104:107], v[248:251], v[44:47], v[104:107]
    v_mfma_f32_16x16x32_bf16 v[108:111], v[252:255], v[44:47], v[108:111]
    s_nop 5
    v_cvt_pk_bf16_f32 v56, v96, v97
    v_cvt_pk_bf16_f32 v57, v98, v99
    v_cvt_pk_bf16_f32 v58, v100, v101
    v_cvt_pk_bf16_f32 v59, v102, v103
    buffer_store_dwordx4 v[56:59], v0, s[48:51], s74 offen offset:0
    v_cvt_pk_bf16_f32 v60, v104, v105
    v_cvt_pk_bf16_f32 v61, v106, v107
    v_cvt_pk_bf16_f32 v62, v108, v109
    v_cvt_pk_bf16_f32 v63, v110, v111
    buffer_store_dwordx4 v[60:63], v0, s[48:51], s74 offen offset:64
    s_add_u32 s74, s74, 8192
L_spin_9:
    ds_read_b32 v15, v13 offset:24
    s_waitcnt lgkmcnt(0)
    v_readfirstlane_b32 s64, v15
    s_cmp_ge_u32 s64, 4
    s_cbranch_scc1 L_go_10
    s_sub_u32 s79, s79, 1
    s_cbranch_scc1 L_end
    s_sleep 1
    s_branch L_spin_9
L_go_10:
    ds_read_b128 v[16:19], v5 offset:57344
    ds_read_b128 v[20:23], v6 offset:57344
    ds_read_b128 v[24:27], v7 offset:57344
    ds_read_b128 v[28:31], v8 offset:57344
    ds_read_b128 v[32:35], v5 offset:57600
    ds_read_b128 v[36:39], v6 offset:57600
    ds_read_b128 v[40:43], v7 offset:57600
    ds_read_b128 v[44:47], v8 offset:57600
    s_waitcnt lgkmcnt(7)
    v_mfma_f32_16x16x32_bf16 v[112:115], v[128:131], v[16:19], v[112:115]
    v_mfma_f32_16x16x32_bf16 v[116:119], v[132:135], v[16:19], v[116:119]
    v_mfma_f32_16x16x32_bf16 v[120:123], v[136:139], v[16:19], v[120:123]
    v_mfma_f32_16x16x32_bf16 v[124:127], v[140:143], v[16:19], v[124:127]
    s_waitcnt lgkmcnt(6)
    v_mfma_f32_16x16x32_bf16 v[112:115], v[144:147], v[20:23], v[112:115]
    v_mfma_f32_16x16x32_bf16 v[116:119], v[148:151], v[20:23], v[116:119]
    v_mfma_f32_16x16x32_bf16 v[120:123], v[152:155], v[20:23], v[120:123]
    v_mfma_f32_16x16x32_bf16 v[124:127], v[156:159], v[20:23], v[124:127]
    s_waitcnt lgkmcnt(5)
    v_mfma_f32_16x16x32_bf16 v[112:115], v[160:163], v[24:27], v[112:115]
    v_mfma_f32_16x16x32_bf16 v[116:119], v[164:167], v[24:27], v[116:119]
    v_mfma_f32_16x16x32_bf16 v[120:123], v[168:171], v[24:27], v[120:123]
    v_mfma_f32_16x16x32_bf16 v[124:127], v[172:175], v[24:27], v[124:127]
    s_waitcnt lgkmcnt(4)
    v_mfma_f32_16x16x32_bf16 v[112:115], v[176:179], v[28:31], v[112:115]
    v_mfma_f32_16x16x32_bf16 v[116:119], v[180:183], v[28:31], v[116:119]
    v_mfma_f32_16x16x32_bf16 v[120:123], v[184:187], v[28:31], v[120:123]
    v_mfma_f32_16x16x32_bf16 v[124:127], v[188:191], v[28:31], v[124:127]
    s_waitcnt lgkmcnt(3)
    v_mfma_f32_16x16x32_bf16 v[112:115], v[192:195], v[32:35], v[112:115]
    v_mfma_f32_16x16x32_bf16 v[116:119], v[196:199], v[32:35], v[116:119]
    v_mfma_f32_16x16x32_bf16 v[120:123], v[200:203], v[32:35], v[120:123]
    v_mfma_f32_16x16x32_bf16 v[124:127], v[204:207], v[32:35], v[124:127]
    s_waitcnt lgkmcnt(2)
    v_mfma_f32_16x16x32_bf16 v[112:115], v[208:211], v[36:39], v[112:115]
    v_mfma_f32_16x16x32_bf16 v[116:119], v[212:215], v[36:39], v[116:119]
    v_mfma_f32_16x16x32_bf16 v[120:123], v[216:219], v[36:39], v[120:123]
    v_mfma_f32_16x16x32_bf16 v[124:127], v[220:223], v[36:39], v[124:127]
    s_waitcnt lgkmcnt(1)
    v_mfma_f32_16x16x32_bf16 v[112:115], v[224:227], v[40:43], v[112:115]
    v_mfma_f32_16x16x32_bf16 v[116:119], v[228:231], v[40:43], v[116:119]
    v_mfma_f32_16x16x32_bf16 v[120:123], v[232:235], v[40:43], v[120:123]
    v_mfma_f32_16x16x32_bf16 v[124:127], v[236:239], v[40:43], v[124:127]
    s_waitcnt lgkmcnt(0)
    v_mfma_f32_16x16x32_bf16 v[112:115], v[240:243], v[44:47], v[112:115]
    v_mfma_f32_16x16x32_bf16 v[116:119], v[244:247], v[44:47], v[116:119]
    v_mfma_f32_16x16x32_bf16 v[120:123], v[248:251], v[44:47], v[120:123]
    v_mfma_f32_16x16x32_bf16 v[124:127], v[252:255], v[44:47], v[124:127]
    s_nop 5
    s_mov_b64 exec, s[76:77]
    v_cvt_pk_bf16_f32 v64, v112, v113
    v_cvt_pk_bf16_f32 v65, v114, v115
    v_cvt_pk_bf16_f32 v66, v116, v117
    v_cvt_pk_bf16_f32 v67, v118, v119
    buffer_store_dwordx4 v[64:67], v0, s[48:51], s74 offen offset:0
    v_cvt_pk_bf16_f32 v68, v120, v121
    v_cvt_pk_bf16_f32 v69, v122, v123
    v_cvt_pk_bf16_f32 v70, v124, v125
    v_cvt_pk_bf16_f32 v71, v126, v127
    buffer_store_dwordx4 v[68:71], v0, s[48:51], s74 offen offset:64
    s_mov_b64 exec, -1
    s_or_b32 s64, s2, s3
    s_cbranch_scc1 L_noepoch_11
    v_mov_b32 v0, 0
    v_mov_b32 v1, s30
    s_mov_b64 exec, 1
    buffer_store_dword v1, v0, s[44:47], 0 offen
    s_mov_b64 exec, -1
L_noepoch_11:
    s_endpgm
L_sparse:
    s_setprio 3
    v_and_b32 v32, 0xff, v0
    v_mov_b32 v5, 92416
    v_mov_b32 v6, 1
    v_mov_b32 v36, 0
    v_lshlrev_b32 v33, 2, v32
    ds_write_b32 v33, v36 offset:57344
    v_mul_u32_u24 v34, 516, v32
    v_add_u32 v34, 81920, v34
    v_add_u32 v35, 92416, v33
    v_mov_b32 v37, 4
    v_cmp_gt_u32 vcc, 20, v32
    s_and_saveexec_b64 s[64:65], vcc
    ds_write_b32 v34, v37
    ds_write_b32 v35, v36
    s_mov_b64 exec, -1
    v_lshlrev_b32 v34, 4, v32
    v_mov_b32 v36, 2064384
    v_mov_b32 v37, 2064384
    v_mov_b32 v38, 2064384
    v_mov_b32 v39, 2064384
    ds_write_b128 v34, v[36:39] offset:40960
    ds_write_b128 v34, v[36:39] offset:45056
    ds_write_b128 v34, v[36:39] offset:49152
    ds_write_b128 v34, v[36:39] offset:53248
    v_lshrrev_b32 v40, 2, v3
    v_lshlrev_b32 v40, 4, v40
    v_and_b32 v41, 3, v3
    v_add_u32 v40, v40, v41
    s_lshl_b32 s64, s31, 1
    v_mov_b32 v41, s64
    v_lshlrev_b32 v42, 1, v41
    v_cmp_gt_u32 vcc, 8, v3
    s_mul_i32 s65, s2, 640
    s_lshr_b32 s66, s2, 4
    v_cndmask_b32 v41, v41, v42, vcc
    v_add_u32 v40, v40, v41
    v_min_u32 v40, 39, v40
    v_lshlrev_b32 v40, 4, v40
    v_lshl_add_u32 v40, v4, 2, v40
    v_add_u32 v40, s65, v40
    s_lshl_b32 s66, s66, 3
    s_and_b32 s67, s2, 7
    s_or_b32 s73, s66, s67
    v_lshlrev_b32 v7, 4, v3
    s_waitcnt lgkmcnt(0)
    s_load_dword s30, s[28:29], 0
    s_mov_b32 s44, s8
    s_and_b32 s45, s9, 0xffff
    s_mov_b32 s46, 640000
    s_mov_b32 s47, 0x20000
    s_mov_b32 s48, s6
    s_and_b32 s49, s7, 0xffff
    s_mov_b32 s50, 640000
    s_mov_b32 s51, 0x20000
    s_mov_b32 s52, s18
    s_and_b32 s53, s19, 0xffff
    s_mov_b32 s54, 131072
    s_mov_b32 s55, 0x20000
    s_mov_b32 s56, s20
    s_and_b32 s57, s21, 0xffff
    s_mov_b32 s58, 131072
    s_mov_b32 s59, 0x20000
    s_bitcmp1_b32 s2, 3
    s_cbranch_scc0 L_mrole_12
    s_mul_i32 s64, s73, 5120
    s_add_u32 s65, s64, 4096
    buffer_load_dwordx4 v[48:51], v34, s[44:47], s64 offen
    buffer_load_dword v52, v33, s[44:47], s65 offen
    buffer_load_dwordx4 v[56:59], v34, s[48:51], s64 offen
    buffer_load_dword v60, v33, s[48:51], s65 offen
    s_branch L_roled_13
L_mrole_12:
    s_cmp_lg_u32 s31, 0
    s_cbranch_scc1 L_roled_13
    v_lshrrev_b32 v41, 2, v3
    v_and_b32 v42, 3, v3
    v_lshl_add_u32 v41, v41, 3, v42
    v_lshlrev_b32 v42, 4, v4
    v_lshl_add_u32 v41, v41, 9, v42
    s_bfe_u32 s64, s73, 0x30002
    s_lshl_b32 s64, s64, 14
    s_lshr_b32 s65, s73, 5
    s_lshl_b32 s65, s65, 15
    s_bfe_u32 s66, s73, 0x10001
    s_lshl_b32 s66, s66, 14
    s_add_u32 s65, s65, s66
    s_and_b32 s66, s73, 1
    s_lshl_b32 s66, s66, 11
    s_add_u32 s65, s65, s66
    buffer_load_dwordx4 v[48:51], v41, s[56:59], s65 offen offset:0
    buffer_load_dwordx4 v[52:55], v41, s[52:55], s64 offen offset:0
    buffer_load_dwordx4 v[56:59], v41, s[52:55], s64 offen offset:2048
    buffer_load_dwordx4 v[60:63], v41, s[56:59], s65 offen offset:64
    buffer_load_dwordx4 v[64:67], v41, s[52:55], s64 offen offset:64
    buffer_load_dwordx4 v[68:71], v41, s[52:55], s64 offen offset:2112
    buffer_load_dwordx4 v[72:75], v41, s[56:59], s65 offen offset:128
    buffer_load_dwordx4 v[76:79], v41, s[52:55], s64 offen offset:128
    buffer_load_dwordx4 v[80:83], v41, s[52:55], s64 offen offset:2176
    buffer_load_dwordx4 v[84:87], v41, s[56:59], s65 offen offset:192
    buffer_load_dwordx4 v[88:91], v41, s[52:55], s64 offen offset:192
    buffer_load_dwordx4 v[92:95], v41, s[52:55], s64 offen offset:2240
    buffer_load_dwordx4 v[96:99], v41, s[56:59], s65 offen offset:256
    buffer_load_dwordx4 v[100:103], v41, s[52:55], s64 offen offset:256
    buffer_load_dwordx4 v[104:107], v41, s[52:55], s64 offen offset:2304
    buffer_load_dwordx4 v[108:111], v41, s[56:59], s65 offen offset:320
    buffer_load_dwordx4 v[112:115], v41, s[52:55], s64 offen offset:320
    buffer_load_dwordx4 v[116:119], v41, s[52:55], s64 offen offset:2368
    buffer_load_dwordx4 v[120:123], v41, s[56:59], s65 offen offset:384
    buffer_load_dwordx4 v[124:127], v41, s[52:55], s64 offen offset:384
    buffer_load_dwordx4 v[128:131], v41, s[52:55], s64 offen offset:2432
    buffer_load_dwordx4 v[132:135], v41, s[56:59], s65 offen offset:448
    buffer_load_dwordx4 v[136:139], v41, s[52:55], s64 offen offset:448
    buffer_load_dwordx4 v[140:143], v41, s[52:55], s64 offen offset:2496
L_roled_13:
    s_mov_b32 s32, s10
    s_and_b32 s33, s11, 0xffff
    s_mov_b32 s34, 160000
    s_mov_b32 s35, 0x20000
    s_nop 0
    buffer_load_dword v0, v40, s[32:35], 0 offen
    s_mov_b32 s36, s14
    s_and_b32 s37, s15, 0xffff
    s_mov_b32 s38, 20000
    s_mov_b32 s39, 0x20000
    s_add_u32 s40, s28, 1048576
    s_addc_u32 s41, s29, 0
    s_and_b32 s41, s41, 0xffff
    s_mov_b32 s42, 2048000
    s_mov_b32 s43, 0x20000
    v_lshrrev_b32 v40, 3, v3
    v_mul_u32_u24 v40, 0x0202, v40
    v_add_u32 v40, 0x0100, v40
    v_xor_b32 v40, 0x0c0c, v40
    v_and_b32 v41, 1, v3
    v_lshlrev_b32 v41, 4, v41
    v_lshlrev_b32 v40, v41, v40
    v_xor_b32 v40, 0x0c0c0c0c, v40
    v_mov_b32 v41, 0x0c0c0c0c
    v_bfe_u32 v42, v3, 1, 2
    v_cmp_eq_u32 vcc, 0, v42
    s_nop 1
    v_cndmask_b32 v8, v41, v40, vcc
    v_cmp_eq_u32 vcc, 1, v42
    s_nop 1
    v_cndmask_b32 v9, v41, v40, vcc
    v_cmp_eq_u32 vcc, 2, v42
    s_nop 1
    v_cndmask_b32 v10, v41, v40, vcc
    v_cmp_eq_u32 vcc, 3, v42
    s_nop 1
    v_cndmask_b32 v11, v41, v40, vcc
    s_waitcnt lgkmcnt(0)
    s_barrier
    s_mul_i32 s30, s30, 0x9E3779B1
    s_add_u32 s30, s30, 0x7F4A7C15
    s_and_b32 s60, s30, 0xffe00000
    s_lshl_b32 s61, s30, 11
    s_and_b32 s61, s61, 0xffe00000
    s_lshl_b32 s62, s30, 21
    s_lshl_b32 s63, s30, 16
    s_and_b32 s63, s63, 0xffe00000
    s_bitcmp1_b32 s2, 3
    s_cbranch_scc0 L_mwork_14
    s_waitcnt vmcnt(3)
    v_mul_u32_u24 v64, 52429, v48
    v_lshrrev_b32 v64, 22, v64
    v_lshlrev_b32 v72, 2, v64
    ds_add_rtn_u32 v80, v72, v6 offset:57344
    v_mul_u32_u24 v65, 52429, v49
    v_lshrrev_b32 v65, 22, v65
    v_lshlrev_b32 v73, 2, v65
    ds_add_rtn_u32 v81, v73, v6 offset:57344
    v_mul_u32_u24 v66, 52429, v50
    v_lshrrev_b32 v66, 22, v66
    v_lshlrev_b32 v74, 2, v66
    ds_add_rtn_u32 v82, v74, v6 offset:57344
    v_mul_u32_u24 v67, 52429, v51
    v_lshrrev_b32 v67, 22, v67
    v_lshlrev_b32 v75, 2, v67
    ds_add_rtn_u32 v83, v75, v6 offset:57344
    v_mul_u32_u24 v68, 52429, v52
    v_lshrrev_b32 v68, 22, v68
    v_lshlrev_b32 v76, 2, v68
    ds_add_rtn_u32 v84, v76, v6 offset:57344
    v_mul_u32_u24 v88, 80, v64
    v_sub_u32 v88, v48, v88
    v_mul_u32_u24 v89, 80, v65
    v_sub_u32 v89, v49, v89
    v_mul_u32_u24 v90, 80, v66
    v_sub_u32 v90, v50, v90
    v_mul_u32_u24 v91, 80, v67
    v_sub_u32 v91, v51, v91
    v_mul_u32_u24 v92, 80, v68
    v_sub_u32 v92, v52, v92
    s_waitcnt vmcnt(1)
    v_mov_b32 v40, 2080768
    v_lshl_or_b32 v88, v88, 14, v56
    v_lshl_or_b32 v89, v89, 14, v57
    v_lshl_or_b32 v90, v90, 14, v58
    v_lshl_or_b32 v91, v91, 14, v59
    v_lshl_or_b32 v92, v92, 14, v60
    s_waitcnt lgkmcnt(0)
    v_cmp_gt_u32 vcc, 31, v80
    v_min_u32 v80, 31, v80
    v_add_u32 v80, v80, v64
    v_cndmask_b32 v88, v40, v88, vcc
    v_and_b32 v80, 31, v80
    v_lshl_add_u32 v80, v64, 5, v80
    v_lshlrev_b32 v80, 2, v80
    ds_write_b32 v80, v88 offset:40960
    v_cmp_gt_u32 vcc, 31, v81
    v_min_u32 v81, 31, v81
    v_add_u32 v81, v81, v65
    v_cndmask_b32 v89, v40, v89, vcc
    v_and_b32 v81, 31, v81
    v_lshl_add_u32 v81, v65, 5, v81
    v_lshlrev_b32 v81, 2, v81
    ds_write_b32 v81, v89 offset:40960
    v_cmp_gt_u32 vcc, 31, v82
    v_min_u32 v82, 31, v82
    v_add_u32 v82, v82, v66
    v_cndmask_b32 v90, v40, v90, vcc
    v_and_b32 v82, 31, v82
    v_lshl_add_u32 v82, v66, 5, v82
    v_lshlrev_b32 v82, 2, v82
    ds_write_b32 v82, v90 offset:40960
    v_cmp_gt_u32 vcc, 31, v83
    v_min_u32 v83, 31, v83
    v_add_u32 v83, v83, v67
    v_cndmask_b32 v91, v40, v91, vcc
    v_and_b32 v83, 31, v83
    v_lshl_add_u32 v83, v67, 5, v83
    v_lshlrev_b32 v83, 2, v83
    ds_write_b32 v83, v91 offset:40960
    v_cmp_gt_u32 vcc, 31, v84
    v_min_u32 v84, 31, v84
    v_add_u32 v84, v84, v68
    v_cndmask_b32 v92, v40, v92, vcc
    v_and_b32 v84, 31, v84
    v_lshl_add_u32 v84, v68, 5, v84
    v_lshlrev_b32 v84, 2, v84
    ds_write_b32 v84, v92 offset:40960
    s_waitcnt lgkmcnt(0)
    s_mov_b64 exec, 1
    ds_add_u32 v5, v6 offset:0
    s_mov_b64 exec, -1
    v_lshrrev_b32 v40, 3, v32
    v_and_b32 v41, 7, v32
    v_lshlrev_b32 v41, 4, v41
    v_lshl_add_u32 v40, v40, 14, v41
    s_lshl_b32 s65, s73, 7
L_spin_16:
    ds_read_b32 v41, v5 offset:0
    s_waitcnt lgkmcnt(0)
    v_readfirstlane_b32 s64, v41
    s_cmp_ge_u32 s64, 4
    s_cbranch_scc1 L_go_17
    s_sub_u32 s79, s79, 1
    s_cbranch_scc1 L_end
    s_sleep 1
    s_branch L_spin_16
L_go_17:
    ds_read_b128 v[48:51], v34 offset:40960
    ds_read_b128 v[52:55], v34 offset:45056
    ds_read_b128 v[56:59], v34 offset:49152
    ds_read_b128 v[60:63], v34 offset:53248
    s_waitcnt lgkmcnt(3)
    v_or_b32 v48, s60, v48
    v_or_b32 v49, s61, v49
    v_or_b32 v50, s62, v50
    v_or_b32 v51, s63, v51
    buffer_store_dwordx4 v[48:51], v40, s[40:43], s65 offen sc1
    s_add_u32 s65, s65, 0x80000
    s_waitcnt lgkmcnt(2)
    v_or_b32 v52, s60, v52
    v_or_b32 v53, s61, v53
    v_or_b32 v54, s62, v54
    v_or_b32 v55, s63, v55
    buffer_store_dwordx4 v[52:55], v40, s[40:43], s65 offen sc1
    s_add_u32 s65, s65, 0x80000
    s_waitcnt lgkmcnt(1)
    v_or_b32 v56, s60, v56
    v_or_b32 v57, s61, v57
    v_or_b32 v58, s62, v58
    v_or_b32 v59, s63, v59
    buffer_store_dwordx4 v[56:59], v40, s[40:43], s65 offen sc1
    s_add_u32 s65, s65, 0x80000
    s_waitcnt lgkmcnt(0)
    v_or_b32 v60, s60, v60
    v_or_b32 v61, s61, v61
    v_or_b32 v62, s62, v62
    v_or_b32 v63, s63, v63
    buffer_store_dwordx4 v[60:63], v40, s[40:43], s65 offen sc1
    s_cmp_ge_u32 s2, 250
    s_cbranch_scc1 L_end
    s_waitcnt vmcnt(4)
    s_branch L_worked_15
L_mwork_14:
    s_cmp_lg_u32 s31, 0
    s_cbranch_scc1 L_worked_15_w
    s_waitcnt vmcnt(22)
    v_mfma_f32_16x16x32_bf16 v[16:19], v[52:55], v[48:51], 0
    v_mfma_f32_16x16x32_bf16 v[20:23], v[56:59], v[48:51], 0
    s_waitcnt vmcnt(19)
    v_mfma_f32_16x16x32_bf16 v[16:19], v[64:67], v[60:63], v[16:19]
    v_mfma_f32_16x16x32_bf16 v[20:23], v[68:71], v[60:63], v[20:23]
    s_waitcnt vmcnt(16)
    v_mfma_f32_16x16x32_bf16 v[16:19], v[76:79], v[72:75], v[16:19]
    v_mfma_f32_16x16x32_bf16 v[20:23], v[80:83], v[72:75], v[20:23]
    s_waitcnt vmcnt(13)
    v_mfma_f32_16x16x32_bf16 v[16:19], v[88:91], v[84:87], v[16:19]
    v_mfma_f32_16x16x32_bf16 v[20:23], v[92:95], v[84:87], v[20:23]
    s_waitcnt vmcnt(10)
    v_mfma_f32_16x16x32_bf16 v[16:19], v[100:103], v[96:99], v[16:19]
    v_mfma_f32_16x16x32_bf16 v[20:23], v[104:107], v[96:99], v[20:23]
    s_waitcnt vmcnt(7)
    v_mfma_f32_16x16x32_bf16 v[16:19], v[112:115], v[108:111], v[16:19]
    v_mfma_f32_16x16x32_bf16 v[20:23], v[116:119], v[108:111], v[20:23]
    s_waitcnt vmcnt(4)
    v_mfma_f32_16x16x32_bf16 v[16:19], v[124:127], v[120:123], v[16:19]
    v_mfma_f32_16x16x32_bf16 v[20:23], v[128:131], v[120:123], v[20:23]
    s_waitcnt vmcnt(1)
    v_mfma_f32_16x16x32_bf16 v[16:19], v[136:139], v[132:135], v[16:19]
    v_mfma_f32_16x16x32_bf16 v[20:23], v[140:143], v[132:135], v[20:23]
    s_lshl_b32 s64, s73, 10
    s_add_u32 s64, s64, 65536
    v_lshl_add_u32 v40, v2, 4, s64
    s_lshl_b32 s64, s73, 2
    s_add_u32 s64, s64, 4096
    v_lshl_add_u32 v41, v2, 9, s64
    v_mov_b32 v42, s30
    s_nop 1
    v_cvt_pk_bf16_f32 v44, v16, v17
    v_cvt_pk_bf16_f32 v45, v18, v19
    v_cvt_pk_bf16_f32 v46, v20, v21
    v_cvt_pk_bf16_f32 v47, v22, v23
    global_store_dwordx4 v40, v[44:47], s[28:29] sc1
    s_waitcnt vmcnt(0)
    s_mov_b64 exec, 65535
    global_store_dword v41, v42, s[28:29] sc1
    s_mov_b64 exec, -1
    s_branch L_worked_15
L_worked_15_w:
    s_waitcnt vmcnt(0)
L_worked_15:
    s_mov_b32 s32, s4
    s_and_b32 s33, s5, 0xffff
    s_mov_b32 s34, 5120000
    s_mov_b32 s35, 0x20000
    v_lshlrev_b32 v0, 9, v0
    s_setprio 0
    s_nop 0
    v_add_u32_dpp v40, v0, v7 row_newbcast:0 row_mask:0xf bank_mask:0xf
    buffer_load_dwordx4 v[176:179], v40, s[32:35], 0 offen offset:0
    buffer_load_dwordx4 v[180:183], v40, s[32:35], 0 offen offset:256
    v_add_u32_dpp v40, v0, v7 row_newbcast:1 row_mask:0xf bank_mask:0xf
    buffer_load_dwordx4 v[184:187], v40, s[32:35], 0 offen offset:0
    buffer_load_dwordx4 v[188:191], v40, s[32:35], 0 offen offset:256
    s_lshl_b32 s64, s31, 10
    s_add_u32 m0, s64, 61440
    s_mov_b32 s65, 0
    buffer_load_dwordx4 v34, s[36:39], s65 offen lds
    v_add_u32_dpp v40, v0, v7 row_newbcast:2 row_mask:0xf bank_mask:0xf
    buffer_load_dwordx4 v[192:195], v40, s[32:35], 0 offen offset:0
    buffer_load_dwordx4 v[196:199], v40, s[32:35], 0 offen offset:256
    v_add_u32_dpp v40, v0, v7 row_newbcast:3 row_mask:0xf bank_mask:0xf
    buffer_load_dwordx4 v[200:203], v40, s[32:35], 0 offen offset:0
    buffer_load_dwordx4 v[204:207], v40, s[32:35], 0 offen offset:256
    s_lshl_b32 s64, s31, 10
    s_add_u32 m0, s64, 65536
    s_mov_b32 s65, 4096
    buffer_load_dwordx4 v34, s[36:39], s65 offen lds
    v_add_u32_dpp v40, v0, v7 row_newbcast:4 row_mask:0xf bank_mask:0xf
    buffer_load_dwordx4 v[208:211], v40, s[32:35], 0 offen offset:0
    buffer_load_dwordx4 v[212:215], v40, s[32:35], 0 offen offset:256
    v_add_u32_dpp v40, v0, v7 row_newbcast:5 row_mask:0xf bank_mask:0xf
    buffer_load_dwordx4 v[216:219], v40, s[32:35], 0 offen offset:0
    buffer_load_dwordx4 v[220:223], v40, s[32:35], 0 offen offset:256
    s_lshl_b32 s64, s31, 10
    s_add_u32 m0, s64, 69632
    s_mov_b32 s65, 8192
    buffer_load_dwordx4 v34, s[36:39], s65 offen lds
    v_add_u32_dpp v40, v0, v7 row_newbcast:6 row_mask:0xf bank_mask:0xf
    buffer_load_dwordx4 v[224:227], v40, s[32:35], 0 offen offset:0
    buffer_load_dwordx4 v[228:231], v40, s[32:35], 0 offen offset:256
    v_add_u32_dpp v40, v0, v7 row_newbcast:7 row_mask:0xf bank_mask:0xf
    buffer_load_dwordx4 v[232:235], v40, s[32:35], 0 offen offset:0
    buffer_load_dwordx4 v[236:239], v40, s[32:35], 0 offen offset:256
    s_lshl_b32 s64, s31, 10
    s_add_u32 m0, s64, 73728
    s_mov_b32 s65, 12288
    buffer_load_dwordx4 v34, s[36:39], s65 offen lds
    v_add_u32_dpp v40, v0, v7 row_newbcast:8 row_mask:0xf bank_mask:0xf
    buffer_load_dwordx4 v[240:243], v40, s[32:35], 0 offen offset:0
    buffer_load_dwordx4 v[244:247], v40, s[32:35], 0 offen offset:256
    v_add_u32_dpp v40, v0, v7 row_newbcast:9 row_mask:0xf bank_mask:0xf
    buffer_load_dwordx4 v[248:251], v40, s[32:35], 0 offen offset:0
    buffer_load_dwordx4 v[252:255], v40, s[32:35], 0 offen offset:256
    s_lshl_b32 s64, s31, 10
    s_add_u32 m0, s64, 77824
    s_mov_b32 s65, 16384
    buffer_load_dwordx4 v34, s[36:39], s65 offen lds
    s_lshr_b32 s64, s2, 1
    s_lshl_b32 s64, s64, 14
    s_add_u32 s65, s64, 4096
    s_add_u32 s66, s64, 8192
    s_add_u32 s67, s64, 12288
    v_cmp_gt_u32 vcc, 0xe8, v32
    s_mov_b64 s[74:75], vcc
L_ipoll_18:
    buffer_load_dwordx4 v[48:51], v34, s[40:43], s64 offen sc1
    buffer_load_dwordx4 v[52:55], v34, s[40:43], s65 offen sc1
    buffer_load_dwordx4 v[56:59], v34, s[40:43], s66 offen sc1
    s_mov_b64 exec, s[74:75]
    buffer_load_dwordx4 v[60:63], v34, s[40:43], s67 offen sc1
    s_mov_b64 exec, -1
    v_mov_b32 v76, 2064384
    v_mov_b32 v77, 2064384
    v_mov_b32 v78, 2064384
    v_mov_b32 v79, 2064384
    s_waitcnt vmcnt(3)
    v_subrev_u32 v64, s60, v48
    v_subrev_u32 v65, s61, v49
    v_subrev_u32 v66, s62, v50
    v_subrev_u32 v67, s63, v51
    s_waitcnt vmcnt(2)
    v_subrev_u32 v68, s60, v52
    v_subrev_u32 v69, s61, v53
    v_subrev_u32 v70, s62, v54
    v_subrev_u32 v71, s63, v55
    s_waitcnt vmcnt(1)
    v_subrev_u32 v72, s60, v56
    v_subrev_u32 v73, s61, v57
    v_subrev_u32 v74, s62, v58
    v_subrev_u32 v75, s63, v59
    s_waitcnt vmcnt(0)
    s_mov_b64 exec, s[74:75]
    v_subrev_u32 v76, s60, v60
    v_subrev_u32 v77, s61, v61
    v_subrev_u32 v78, s62, v62
    v_subrev_u32 v79, s63, v63
    s_mov_b64 exec, -1
    v_max_u32 v40, v64, v65
    v_max3_u32 v40, v40, v66, v67
    v_max3_u32 v40, v40, v68, v69
    v_max3_u32 v40, v40, v70, v71
    v_max3_u32 v40, v40, v72, v73
    v_max3_u32 v40, v40, v74, v75
    v_max3_u32 v40, v40, v76, v77
    v_max3_u32 v40, v40, v78, v79
    v_cmp_le_u32 vcc, 0x200000, v40
    s_cbranch_vccz L_igo_19
    s_sub_u32 s79, s79, 1
    s_cbranch_scc1 L_end
    s_sleep 2
    s_branch L_ipoll_18
L_igo_19:
    v_cmpx_le_u32 vcc, 2080768, v40
    ds_write_b32 v5, v6 offset:12
    s_mov_b64 exec, -1
    s_and_b32 s64, s2, 1
    s_mul_i32 s64, s64, 655360
    s_mov_b32 s65, 655360
    s_mov_b32 s66, 516
    v_mov_b32 v41, 81920
    v_mov_b32 v42, 4
    v_subrev_u32 v64, s64, v64
    v_lshrrev_b32 v80, 15, v64
    v_mad_u32_u24 v80, v80, s66, v41
    v_cmpx_gt_u32 vcc, s65, v64
    ds_add_rtn_u32 v96, v80, v42
    s_mov_b64 exec, -1
    v_subrev_u32 v65, s64, v65
    v_lshrrev_b32 v81, 15, v65
    v_mad_u32_u24 v81, v81, s66, v41
    v_cmpx_gt_u32 vcc, s65, v65
    ds_add_rtn_u32 v97, v81, v42
    s_mov_b64 exec, -1
    v_subrev_u32 v66, s64, v66
    v_lshrrev_b32 v82, 15, v66
    v_mad_u32_u24 v82, v82, s66, v41
    v_cmpx_gt_u32 vcc, s65, v66
    ds_add_rtn_u32 v98, v82, v42
    s_mov_b64 exec, -1
    v_subrev_u32 v67, s64, v67
    v_lshrrev_b32 v83, 15, v67
    v_mad_u32_u24 v83, v83, s66, v41
    v_cmpx_gt_u32 vcc, s65, v67
    ds_add_rtn_u32 v99, v83, v42
    s_mov_b64 exec, -1
    v_subrev_u32 v68, s64, v68
    v_lshrrev_b32 v84, 15, v68
    v_mad_u32_u24 v84, v84, s66, v41
    v_cmpx_gt_u32 vcc, s65, v68
    ds_add_rtn_u32 v100, v84, v42
    s_mov_b64 exec, -1
    v_subrev_u32 v69, s64, v69
    v_lshrrev_b32 v85, 15, v69
    v_mad_u32_u24 v85, v85, s66, v41
    v_cmpx_gt_u32 vcc, s65, v69
    ds_add_rtn_u32 v101, v85, v42
    s_mov_b64 exec, -1
    v_subrev_u32 v70, s64, v70
    v_lshrrev_b32 v86, 15, v70
    v_mad_u32_u24 v86, v86, s66, v41
    v_cmpx_gt_u32 vcc, s65, v70
    ds_add_rtn_u32 v102, v86, v42
    s_mov_b64 exec, -1
    v_subrev_u32 v71, s64, v71
    v_lshrrev_b32 v87, 15, v71
    v_mad_u32_u24 v87, v87, s66, v41
    v_cmpx_gt_u32 vcc, s65, v71
    ds_add_rtn_u32 v103, v87, v42
    s_mov_b64 exec, -1
    v_subrev_u32 v72, s64, v72
    v_lshrrev_b32 v88, 15, v72
    v_mad_u32_u24 v88, v88, s66, v41
    v_cmpx_gt_u32 vcc, s65, v72
    ds_add_rtn_u32 v104, v88, v42
    s_mov_b64 exec, -1
    v_subrev_u32 v73, s64, v73
    v_lshrrev_b32 v89, 15, v73
    v_mad_u32_u24 v89, v89, s66, v41
    v_cmpx_gt_u32 vcc, s65, v73
    ds_add_rtn_u32 v105, v89, v42
    s_mov_b64 exec, -1
    v_subrev_u32 v74, s64, v74
    v_lshrrev_b32 v90, 15, v74
    v_mad_u32_u24 v90, v90, s66, v41
    v_cmpx_gt_u32 vcc, s65, v74
    ds_add_rtn_u32 v106, v90, v42
    s_mov_b64 exec, -1
    v_subrev_u32 v75, s64, v75
    v_lshrrev_b32 v91, 15, v75
    v_mad_u32_u24 v91, v91, s66, v41
    v_cmpx_gt_u32 vcc, s65, v75
    ds_add_rtn_u32 v107, v91, v42
    s_mov_b64 exec, -1
    s_waitcnt lgkmcnt(4)
    v_subrev_u32 v76, s64, v76
    v_lshrrev_b32 v92, 15, v76
    v_mad_u32_u24 v92, v92, s66, v41
    v_cmpx_gt_u32 vcc, s65, v76
    ds_add_rtn_u32 v108, v92, v42
    s_mov_b64 exec, -1
    v_subrev_u32 v77, s64, v77
    v_lshrrev_b32 v93, 15, v77
    v_mad_u32_u24 v93, v93, s66, v41
    v_cmpx_gt_u32 vcc, s65, v77
    ds_add_rtn_u32 v109, v93, v42
    s_mov_b64 exec, -1
    v_subrev_u32 v78, s64, v78
    v_lshrrev_b32 v94, 15, v78
    v_mad_u32_u24 v94, v94, s66, v41
    v_cmpx_gt_u32 vcc, s65, v78
    ds_add_rtn_u32 v110, v94, v42
    s_mov_b64 exec, -1
    v_subrev_u32 v79, s64, v79
    v_lshrrev_b32 v95, 15, v79
    v_mad_u32_u24 v95, v95, s66, v41
    v_cmpx_gt_u32 vcc, s65, v79
    ds_add_rtn_u32 v111, v95, v42
    s_mov_b64 exec, -1
    s_waitcnt lgkmcnt(0)
    v_min_u32 v96, 0x200, v96
    v_add_u32 v96, v96, v80
    v_cmpx_gt_u32 vcc, s65, v64
    ds_write_b32 v96, v64
    s_mov_b64 exec, -1
    v_min_u32 v97, 0x200, v97
    v_add_u32 v97, v97, v81
    v_cmpx_gt_u32 vcc, s65, v65
    ds_write_b32 v97, v65
    s_mov_b64 exec, -1
    v_min_u32 v98, 0x200, v98
    v_add_u32 v98, v98, v82
    v_cmpx_gt_u32 vcc, s65, v66
    ds_write_b32 v98, v66
    s_mov_b64 exec, -1
    v_min_u32 v99, 0x200, v99
    v_add_u32 v99, v99, v83
    v_cmpx_gt_u32 vcc, s65, v67
    ds_write_b32 v99, v67
    s_mov_b64 exec, -1
    v_min_u32 v100, 0x200, v100
    v_add_u32 v100, v100, v84
    v_cmpx_gt_u32 vcc, s65, v68
    ds_write_b32 v100, v68
    s_mov_b64 exec, -1
    v_min_u32 v101, 0x200, v101
    v_add_u32 v101, v101, v85
    v_cmpx_gt_u32 vcc, s65, v69
    ds_write_b32 v101, v69
    s_mov_b64 exec, -1
    v_min_u32 v102, 0x200, v102
    v_add_u32 v102, v102, v86
    v_cmpx_gt_u32 vcc, s65, v70
    ds_write_b32 v102, v70
    s_mov_b64 exec, -1
    v_min_u32 v103, 0x200, v103
    v_add_u32 v103, v103, v87
    v_cmpx_gt_u32 vcc, s65, v71
    ds_write_b32 v103, v71
    s_mov_b64 exec, -1
    v_min_u32 v104, 0x200, v104
    v_add_u32 v104, v104, v88
    v_cmpx_gt_u32 vcc, s65, v72
    ds_write_b32 v104, v72
    s_mov_b64 exec, -1
    v_min_u32 v105, 0x200, v105
    v_add_u32 v105, v105, v89
    v_cmpx_gt_u32 vcc, s65, v73
    ds_write_b32 v105, v73
    s_mov_b64 exec, -1
    v_min_u32 v106, 0x200, v106
    v_add_u32 v106, v106, v90
    v_cmpx_gt_u32 vcc, s65, v74
    ds_write_b32 v106, v74
    s_mov_b64 exec, -1
    v_min_u32 v107, 0x200, v107
    v_add_u32 v107, v107, v91
    v_cmpx_gt_u32 vcc, s65, v75
    ds_write_b32 v107, v75
    s_mov_b64 exec, -1
    s_waitcnt lgkmcnt(4)
    v_min_u32 v108, 0x200, v108
    v_add_u32 v108, v108, v92
    v_cmpx_gt_u32 vcc, s65, v76
    ds_write_b32 v108, v76
    s_mov_b64 exec, -1
    v_min_u32 v109, 0x200, v109
    v_add_u32 v109, v109, v93
    v_cmpx_gt_u32 vcc, s65, v77
    ds_write_b32 v109, v77
    s_mov_b64 exec, -1
    v_min_u32 v110, 0x200, v110
    v_add_u32 v110, v110, v94
    v_cmpx_gt_u32 vcc, s65, v78
    ds_write_b32 v110, v78
    s_mov_b64 exec, -1
    v_min_u32 v111, 0x200, v111
    v_add_u32 v111, v111, v95
    v_cmpx_gt_u32 vcc, s65, v79
    ds_write_b32 v111, v79
    s_mov_b64 exec, -1
    s_waitcnt lgkmcnt(0)
    s_mov_b64 exec, 1
    ds_add_u32 v5, v6 offset:8
    s_mov_b64 exec, -1
    s_lshl_b32 s4, s31, 1
    s_add_u32 s5, s4, 1
    s_add_u32 s6, s4, 8
    s_add_u32 s7, s4, 9
    s_add_u32 s8, s31, 16
    v_min_u32 v40, 19, v2
    v_mad_u32_u24 v40, v40, s66, v41
L_spin_20:
    ds_read_b32 v42, v5 offset:8
    s_waitcnt lgkmcnt(0)
    v_readfirstlane_b32 s64, v42
    s_cmp_ge_u32 s64, 4
    s_cbranch_scc1 L_go_21
    s_sub_u32 s79, s79, 1
    s_cbranch_scc1 L_end
    s_sleep 1
    s_branch L_spin_20
L_go_21:
    ds_read_b32 v42, v40
    ds_read_b32 v43, v5 offset:12
    s_waitcnt lgkmcnt(0)
    v_readfirstlane_b32 s71, v43
    v_readlane_b32 s10, v42, s4
    v_readlane_b32 s11, v42, s5
    v_readlane_b32 s12, v42, s6
    v_readlane_b32 s13, v42, s7
    v_readlane_b32 s14, v42, s8
    s_mov_b32 s15, 0
    s_cmp_gt_u32 s10, 516
    s_cselect_b32 s71, 1, s71
    s_add_u32 s64, s10, 8
    s_lshr_b32 s64, s64, 4
    s_add_u32 s16, s15, s64
    s_mul_i32 s21, s4, 516
    s_add_u32 s21, s21, 81920
    s_add_u32 s10, s10, s21
    s_lshl_b32 s64, s15, 4
    s_sub_u32 s21, s21, s64
    s_cmp_gt_u32 s11, 516
    s_cselect_b32 s71, 1, s71
    s_add_u32 s64, s11, 8
    s_lshr_b32 s64, s64, 4
    s_add_u32 s17, s16, s64
    s_mul_i32 s22, s5, 516
    s_add_u32 s22, s22, 81920
    s_add_u32 s11, s11, s22
    s_lshl_b32 s64, s16, 4
    s_sub_u32 s22, s22, s64
    s_cmp_gt_u32 s12, 516
    s_cselect_b32 s71, 1, s71
    s_add_u32 s64, s12, 8
    s_lshr_b32 s64, s64, 4
    s_add_u32 s18, s17, s64
    s_mul_i32 s23, s6, 516
    s_add_u32 s23, s23, 81920
    s_add_u32 s12, s12, s23
    s_lshl_b32 s64, s17, 4
    s_sub_u32 s23, s23, s64
    s_cmp_gt_u32 s13, 516
    s_cselect_b32 s71, 1, s71
    s_add_u32 s64, s13, 8
    s_lshr_b32 s64, s64, 4
    s_add_u32 s19, s18, s64
    s_mul_i32 s24, s7, 516
    s_add_u32 s24, s24, 81920
    s_add_u32 s13, s13, s24
    s_lshl_b32 s64, s18, 4
    s_sub_u32 s24, s24, s64
    s_cmp_gt_u32 s14, 516
    s_cselect_b32 s71, 1, s71
    s_add_u32 s64, s14, 8
    s_lshr_b32 s64, s64, 4
    s_add_u32 s20, s19, s64
    s_mul_i32 s25, s8, 516
    s_add_u32 s25, s25, 81920
    s_add_u32 s14, s14, s25
    s_lshl_b32 s64, s19, 4
    s_sub_u32 s25, s25, s64
    s_cmp_gt_u32 s20, 64
    s_cselect_b32 s71, 1, s71
    s_mov_b32 s68, s20
    s_sub_u32 s74, s20, s16
    s_sub_u32 s75, s20, s17
    s_sub_u32 s76, s20, s18
    s_sub_u32 s77, s20, s19
    s_sub_u32 s78, s20, s20
    s_cmp_lg_u32 s71, 0
    s_cselect_b32 s68, 0, s68
    v_add_u32 v32, 0, v3
    v_mov_b32 v33, s21
    v_mov_b32 v34, s10
    v_add_u32 v35, 16, v3
    v_mov_b32 v36, s21
    v_mov_b32 v37, s10
    v_add_u32 v38, 32, v3
    v_mov_b32 v39, s21
    v_mov_b32 v40, s10
    v_add_u32 v41, 48, v3
    v_mov_b32 v42, s21
    v_mov_b32 v43, s10
    v_mov_b32 v44, s22
    v_mov_b32 v45, s11
    v_cmp_le_u32 vcc, s16, v32
    s_nop 1
    v_cndmask_b32 v33, v33, v44, vcc
    v_cndmask_b32 v34, v34, v45, vcc
    v_cmp_le_u32 vcc, s16, v35
    s_nop 1
    v_cndmask_b32 v36, v36, v44, vcc
    v_cndmask_b32 v37, v37, v45, vcc
    v_cmp_le_u32 vcc, s16, v38
    s_nop 1
    v_cndmask_b32 v39, v39, v44, vcc
    v_cndmask_b32 v40, v40, v45, vcc
    v_cmp_le_u32 vcc, s16, v41
    s_nop 1
    v_cndmask_b32 v42, v42, v44, vcc
    v_cndmask_b32 v43, v43, v45, vcc
    v_mov_b32 v44, s23
    v_mov_b32 v45, s12
    v_cmp_le_u32 vcc, s17, v32
    s_nop 1
    v_cndmask_b32 v33, v33, v44, vcc
    v_cndmask_b32 v34, v34, v45, vcc
    v_cmp_le_u32 vcc, s17, v35
    s_nop 1
    v_cndmask_b32 v36, v36, v44, vcc
    v_cndmask_b32 v37, v37, v45, vcc
    v_cmp_le_u32 vcc, s17, v38
    s_nop 1
    v_cndmask_b32 v39, v39, v44, vcc
    v_cndmask_b32 v40, v40, v45, vcc
    v_cmp_le_u32 vcc, s17, v41
    s_nop 1
    v_cndmask_b32 v42, v42, v44, vcc
    v_cndmask_b32 v43, v43, v45, vcc
    v_mov_b32 v44, s24
    v_mov_b32 v45, s13
    v_cmp_le_u32 vcc, s18, v32
    s_nop 1
    v_cndmask_b32 v33, v33, v44, vcc
    v_cndmask_b32 v34, v34, v45, vcc
    v_cmp_le_u32 vcc, s18, v35
    s_nop 1
    v_cndmask_b32 v36, v36, v44, vcc
    v_cndmask_b32 v37, v37, v45, vcc
    v_cmp_le_u32 vcc, s18, v38
    s_nop 1
    v_cndmask_b32 v39, v39, v44, vcc
    v_cndmask_b32 v40, v40, v45, vcc
    v_cmp_le_u32 vcc, s18, v41
    s_nop 1
    v_cndmask_b32 v42, v42, v44, vcc
    v_cndmask_b32 v43, v43, v45, vcc
    v_mov_b32 v44, s25
    v_mov_b32 v45, s14
    v_cmp_le_u32 vcc, s19, v32
    s_nop 1
    v_cndmask_b32 v33, v33, v44, vcc
    v_cndmask_b32 v34, v34, v45, vcc
    v_cmp_le_u32 vcc, s19, v35
    s_nop 1
    v_cndmask_b32 v36, v36, v44, vcc
    v_cndmask_b32 v37, v37, v45, vcc
    v_cmp_le_u32 vcc, s19, v38
    s_nop 1
    v_cndmask_b32 v39, v39, v44, vcc
    v_cndmask_b32 v40, v40, v45, vcc
    v_cmp_le_u32 vcc, s19, v41
    s_nop 1
    v_cndmask_b32 v42, v42, v44, vcc
    v_cndmask_b32 v43, v43, v45, vcc
    v_lshl_add_u32 v44, v4, 2, 4
    v_lshl_add_u32 v32, v32, 4, v44
    v_add_u32 v33, v33, v32
    ds_read_b32 v32, v33
    v_lshl_add_u32 v35, v35, 4, v44
    v_add_u32 v36, v36, v35
    ds_read_b32 v35, v36
    v_lshl_add_u32 v38, v38, 4, v44
    v_add_u32 v39, v39, v38
    ds_read_b32 v38, v39
    v_lshl_add_u32 v41, v41, 4, v44
    v_add_u32 v42, v42, v41
    ds_read_b32 v41, v42
    s_waitcnt lgkmcnt(3)
    v_and_b32 v24, 0x3fff, v32
    v_lshlrev_b32 v44, 1, v24
    ds_read_u16 v25, v44 offset:61440
    s_waitcnt lgkmcnt(3)
    v_and_b32 v26, 0x3fff, v35
    v_lshlrev_b32 v44, 1, v26
    ds_read_u16 v27, v44 offset:61440
    s_waitcnt lgkmcnt(3)
    v_and_b32 v28, 0x3fff, v38
    v_lshlrev_b32 v44, 1, v28
    ds_read_u16 v29, v44 offset:61440
    s_waitcnt lgkmcnt(3)
    v_and_b32 v30, 0x3fff, v41
    v_lshlrev_b32 v44, 1, v30
    ds_read_u16 v31, v44 offset:61440
    v_mov_b32 v45, 2147483648
    v_cmp_lt_u32 vcc, v33, v34
    v_lshlrev_b32 v24, 9, v24
    v_lshrrev_b32 v32, 10, v32
    v_and_b32 v32, 16, v32
    v_cndmask_b32 v24, v45, v24, vcc
    s_waitcnt lgkmcnt(3)
    v_lshlrev_b32 v25, v32, v25
    v_cndmask_b32 v25, 0, v25, vcc
    v_cmp_lt_u32 vcc, v36, v37
    v_lshlrev_b32 v26, 9, v26
    v_lshrrev_b32 v35, 10, v35
    v_and_b32 v35, 16, v35
    v_cndmask_b32 v26, v45, v26, vcc
    s_waitcnt lgkmcnt(2)
    v_lshlrev_b32 v27, v35, v27
    v_cndmask_b32 v27, 0, v27, vcc
    v_cmp_lt_u32 vcc, v39, v40
    v_lshlrev_b32 v28, 9, v28
    v_lshrrev_b32 v38, 10, v38
    v_and_b32 v38, 16, v38
    v_cndmask_b32 v28, v45, v28, vcc
    s_waitcnt lgkmcnt(1)
    v_lshlrev_b32 v29, v38, v29
    v_cndmask_b32 v29, 0, v29, vcc
    v_cmp_lt_u32 vcc, v42, v43
    v_lshlrev_b32 v30, 9, v30
    v_lshrrev_b32 v41, 10, v41
    v_and_b32 v41, 16, v41
    v_cndmask_b32 v30, v45, v30, vcc
    s_waitcnt lgkmcnt(0)
    v_lshlrev_b32 v31, v41, v31
    v_cndmask_b32 v31, 0, v31, vcc
    s_nop 0
    s_cmp_gt_u32 s68, 0
    s_cbranch_scc0 L_ni_22
    v_add_u32_dpp v47, v24, v7 row_newbcast:0 row_mask:0xf bank_mask:0xf
    buffer_load_dwordx4 v[48:51], v47, s[32:35], 0 offen offset:0
    buffer_load_dwordx4 v[52:55], v47, s[32:35], 0 offen offset:256
L_ni_22:
    s_cmp_gt_u32 s68, 1
    s_cbranch_scc0 L_ni_23
    v_add_u32_dpp v47, v24, v7 row_newbcast:1 row_mask:0xf bank_mask:0xf
    buffer_load_dwordx4 v[56:59], v47, s[32:35], 0 offen offset:0
    buffer_load_dwordx4 v[60:63], v47, s[32:35], 0 offen offset:256
L_ni_23:
    s_cmp_gt_u32 s68, 2
    s_cbranch_scc0 L_ni_24
    v_add_u32_dpp v47, v24, v7 row_newbcast:2 row_mask:0xf bank_mask:0xf
    buffer_load_dwordx4 v[64:67], v47, s[32:35], 0 offen offset:0
    buffer_load_dwordx4 v[68:71], v47, s[32:35], 0 offen offset:256
L_ni_24:
    s_cmp_gt_u32 s68, 3
    s_cbranch_scc0 L_ni_25
    v_add_u32_dpp v47, v24, v7 row_newbcast:3 row_mask:0xf bank_mask:0xf
    buffer_load_dwordx4 v[72:75], v47, s[32:35], 0 offen offset:0
    buffer_load_dwordx4 v[76:79], v47, s[32:35], 0 offen offset:256
L_ni_25:
    s_cmp_gt_u32 s68, 4
    s_cbranch_scc0 L_ni_26
    v_add_u32_dpp v47, v24, v7 row_newbcast:4 row_mask:0xf bank_mask:0xf
    buffer_load_dwordx4 v[80:83], v47, s[32:35], 0 offen offset:0
    buffer_load_dwordx4 v[84:87], v47, s[32:35], 0 offen offset:256
L_ni_26:
    s_cmp_gt_u32 s68, 5
    s_cbranch_scc0 L_ni_27
    v_add_u32_dpp v47, v24, v7 row_newbcast:5 row_mask:0xf bank_mask:0xf
    buffer_load_dwordx4 v[88:91], v47, s[32:35], 0 offen offset:0
    buffer_load_dwordx4 v[92:95], v47, s[32:35], 0 offen offset:256
L_ni_27:
    s_cmp_gt_u32 s68, 6
    s_cbranch_scc0 L_ni_28
    v_add_u32_dpp v47, v24, v7 row_newbcast:6 row_mask:0xf bank_mask:0xf
    buffer_load_dwordx4 v[96:99], v47, s[32:35], 0 offen offset:0
    buffer_load_dwordx4 v[100:103], v47, s[32:35], 0 offen offset:256
L_ni_28:
    s_cmp_gt_u32 s68, 7
    s_cbranch_scc0 L_ni_29
    v_add_u32_dpp v47, v24, v7 row_newbcast:7 row_mask:0xf bank_mask:0xf
    buffer_load_dwordx4 v[104:107], v47, s[32:35], 0 offen offset:0
    buffer_load_dwordx4 v[108:111], v47, s[32:35], 0 offen offset:256
L_ni_29:
    v_lshrrev_b32 v44, 1, v4
    v_mul_u32_u24 v44, 528, v44
    v_xor_b32 v44, v44, v7
    v_and_b32 v45, 1, v4
    v_lshl_or_b32 v2, v45, 3, v44
    s_lshl_b32 s64, s4, 10
    s_and_b32 s65, s4, 7
    s_lshl_b32 s65, s65, 5
    s_or_b32 s21, s64, s65
    s_lshl_b32 s64, s5, 10
    s_and_b32 s65, s5, 7
    s_lshl_b32 s65, s65, 5
    s_or_b32 s22, s64, s65
    s_lshl_b32 s64, s6, 10
    s_and_b32 s65, s6, 7
    s_lshl_b32 s65, s65, 5
    s_or_b32 s23, s64, s65
    s_lshl_b32 s64, s7, 10
    s_and_b32 s65, s7, 7
    s_lshl_b32 s65, s65, 5
    s_or_b32 s24, s64, s65
    s_lshl_b32 s64, s8, 10
    s_and_b32 s65, s8, 7
    s_lshl_b32 s65, s65, 5
    s_or_b32 s25, s64, s65
    s_barrier
    v_mov_b32 v44, 0
    s_xor_b32 s64, s21, 0
    v_xor_b32 v46, s64, v7
    ds_read_b128 v[32:35], v46 offset:20480
    ds_read_b128 v[36:39], v46 offset:20736
    s_mov_b32 s66, 0x00010001
    s_mov_b32 s67, 0x00010001
    s_xor_b32 s64, s21, 528
    v_xor_b32 v46, s64, v7
    ds_read_b128 v[40:43], v46 offset:20480
    ds_read_b128 v[16:19], v46 offset:20736
    s_waitcnt lgkmcnt(2)
    v_dot2_f32_bf16 v45, v176, v32, 0
    v_dot2_f32_bf16 v45, v177, v33, v45
    v_dot2_f32_bf16 v45, v178, v34, v45
    v_dot2_f32_bf16 v45, v179, v35, v45
    v_dot2_f32_bf16 v45, v180, v36, v45
    v_dot2_f32_bf16 v45, v181, v37, v45
    v_dot2_f32_bf16 v45, v182, v38, v45
    v_dot2_f32_bf16 v45, v183, v39, v45
    s_cmp_gt_u32 s68, 8
    s_cbranch_scc0 L_ni_30
    v_add_u32_dpp v47, v24, v7 row_newbcast:8 row_mask:0xf bank_mask:0xf
    buffer_load_dwordx4 v[112:115], v47, s[32:35], 0 offen offset:0
    buffer_load_dwordx4 v[116:119], v47, s[32:35], 0 offen offset:256
L_ni_30:
    s_nop 2
    v_add_f32_dpp v45, v45, v45 row_ror:8 row_mask:0xf bank_mask:0xf
    s_nop 1
    v_add_f32_dpp v45, v45, v45 row_ror:4 row_mask:0xf bank_mask:0xf
    s_nop 1
    v_add_f32_dpp v45, v45, v45 row_ror:2 row_mask:0xf bank_mask:0xf
    s_nop 1
    v_add_f32_dpp v45, v45, v45 row_ror:1 row_mask:0xf bank_mask:0xf
    s_nop 1
    v_cndmask_b32 v44, v44, v45, s[66:67]
    s_lshl_b64 s[66:67], s[66:67], 1
    s_xor_b32 s64, s22, 0
    v_xor_b32 v46, s64, v7
    ds_read_b128 v[32:35], v46 offset:20480
    ds_read_b128 v[36:39], v46 offset:20736
    s_waitcnt lgkmcnt(2)
    v_dot2_f32_bf16 v45, v184, v40, 0
    v_dot2_f32_bf16 v45, v185, v41, v45
    v_dot2_f32_bf16 v45, v186, v42, v45
    v_dot2_f32_bf16 v45, v187, v43, v45
    v_dot2_f32_bf16 v45, v188, v16, v45
    v_dot2_f32_bf16 v45, v189, v17, v45
    v_dot2_f32_bf16 v45, v190, v18, v45
    v_dot2_f32_bf16 v45, v191, v19, v45
    s_cmp_gt_u32 s68, 9
    s_cbranch_scc0 L_ni_31
    v_add_u32_dpp v47, v24, v7 row_newbcast:9 row_mask:0xf bank_mask:0xf
    buffer_load_dwordx4 v[120:123], v47, s[32:35], 0 offen offset:0
    buffer_load_dwordx4 v[124:127], v47, s[32:35], 0 offen offset:256
L_ni_31:
    s_nop 2
    v_add_f32_dpp v45, v45, v45 row_ror:8 row_mask:0xf bank_mask:0xf
    s_nop 1
    v_add_f32_dpp v45, v45, v45 row_ror:4 row_mask:0xf bank_mask:0xf
    s_nop 1
    v_add_f32_dpp v45, v45, v45 row_ror:2 row_mask:0xf bank_mask:0xf
    s_nop 1
    v_add_f32_dpp v45, v45, v45 row_ror:1 row_mask:0xf bank_mask:0xf
    s_nop 1
    v_cndmask_b32 v44, v44, v45, s[66:67]
    s_lshl_b64 s[66:67], s[66:67], 1
    s_xor_b32 s64, s22, 528
    v_xor_b32 v46, s64, v7
    ds_read_b128 v[40:43], v46 offset:20480
    ds_read_b128 v[16:19], v46 offset:20736
    s_waitcnt lgkmcnt(2)
    v_dot2_f32_bf16 v45, v192, v32, 0
    v_dot2_f32_bf16 v45, v193, v33, v45
    v_dot2_f32_bf16 v45, v194, v34, v45
    v_dot2_f32_bf16 v45, v195, v35, v45
    v_dot2_f32_bf16 v45, v196, v36, v45
    v_dot2_f32_bf16 v45, v197, v37, v45
    v_dot2_f32_bf16 v45, v198, v38, v45
    v_dot2_f32_bf16 v45, v199, v39, v45
    s_cmp_gt_u32 s68, 10
    s_cbranch_scc0 L_ni_32
    v_add_u32_dpp v47, v24, v7 row_newbcast:10 row_mask:0xf bank_mask:0xf
    buffer_load_dwordx4 v[128:131], v47, s[32:35], 0 offen offset:0
    buffer_load_dwordx4 v[132:135], v47, s[32:35], 0 offen offset:256
L_ni_32:
    s_nop 2
    v_add_f32_dpp v45, v45, v45 row_ror:8 row_mask:0xf bank_mask:0xf
    s_nop 1
    v_add_f32_dpp v45, v45, v45 row_ror:4 row_mask:0xf bank_mask:0xf
    s_nop 1
    v_add_f32_dpp v45, v45, v45 row_ror:2 row_mask:0xf bank_mask:0xf
    s_nop 1
    v_add_f32_dpp v45, v45, v45 row_ror:1 row_mask:0xf bank_mask:0xf
    s_nop 1
    v_cndmask_b32 v44, v44, v45, s[66:67]
    s_lshl_b64 s[66:67], s[66:67], 1
    s_xor_b32 s64, s23, 0
    v_xor_b32 v46, s64, v7
    ds_read_b128 v[32:35], v46 offset:20480
    ds_read_b128 v[36:39], v46 offset:20736
    s_waitcnt lgkmcnt(2)
    v_dot2_f32_bf16 v45, v200, v40, 0
    v_dot2_f32_bf16 v45, v201, v41, v45
    v_dot2_f32_bf16 v45, v202, v42, v45
    v_dot2_f32_bf16 v45, v203, v43, v45
    v_dot2_f32_bf16 v45, v204, v16, v45
    v_dot2_f32_bf16 v45, v205, v17, v45
    v_dot2_f32_bf16 v45, v206, v18, v45
    v_dot2_f32_bf16 v45, v207, v19, v45
    s_cmp_gt_u32 s68, 11
    s_cbranch_scc0 L_ni_33
    v_add_u32_dpp v47, v24, v7 row_newbcast:11 row_mask:0xf bank_mask:0xf
    buffer_load_dwordx4 v[136:139], v47, s[32:35], 0 offen offset:0
    buffer_load_dwordx4 v[140:143], v47, s[32:35], 0 offen offset:256
L_ni_33:
    s_nop 2
    v_add_f32_dpp v45, v45, v45 row_ror:8 row_mask:0xf bank_mask:0xf
    s_nop 1
    v_add_f32_dpp v45, v45, v45 row_ror:4 row_mask:0xf bank_mask:0xf
    s_nop 1
    v_add_f32_dpp v45, v45, v45 row_ror:2 row_mask:0xf bank_mask:0xf
    s_nop 1
    v_add_f32_dpp v45, v45, v45 row_ror:1 row_mask:0xf bank_mask:0xf
    s_nop 1
    v_cndmask_b32 v44, v44, v45, s[66:67]
    s_lshl_b64 s[66:67], s[66:67], 1
    s_xor_b32 s64, s23, 528
    v_xor_b32 v46, s64, v7
    ds_read_b128 v[40:43], v46 offset:20480
    ds_read_b128 v[16:19], v46 offset:20736
    s_waitcnt lgkmcnt(2)
    v_dot2_f32_bf16 v45, v208, v32, 0
    v_dot2_f32_bf16 v45, v209, v33, v45
    v_dot2_f32_bf16 v45, v210, v34, v45
    v_dot2_f32_bf16 v45, v211, v35, v45
    v_dot2_f32_bf16 v45, v212, v36, v45
    v_dot2_f32_bf16 v45, v213, v37, v45
    v_dot2_f32_bf16 v45, v214, v38, v45
    v_dot2_f32_bf16 v45, v215, v39, v45
    s_cmp_gt_u32 s68, 12
    s_cbranch_scc0 L_ni_34
    v_add_u32_dpp v47, v24, v7 row_newbcast:12 row_mask:0xf bank_mask:0xf
    buffer_load_dwordx4 v[144:147], v47, s[32:35], 0 offen offset:0
    buffer_load_dwordx4 v[148:151], v47, s[32:35], 0 offen offset:256
L_ni_34:
    s_nop 2
    v_add_f32_dpp v45, v45, v45 row_ror:8 row_mask:0xf bank_mask:0xf
    s_nop 1
    v_add_f32_dpp v45, v45, v45 row_ror:4 row_mask:0xf bank_mask:0xf
    s_nop 1
    v_add_f32_dpp v45, v45, v45 row_ror:2 row_mask:0xf bank_mask:0xf
    s_nop 1
    v_add_f32_dpp v45, v45, v45 row_ror:1 row_mask:0xf bank_mask:0xf
    s_nop 1
    v_cndmask_b32 v44, v44, v45, s[66:67]
    s_lshl_b64 s[66:67], s[66:67], 1
    s_xor_b32 s64, s24, 0
    v_xor_b32 v46, s64, v7
    ds_read_b128 v[32:35], v46 offset:20480
    ds_read_b128 v[36:39], v46 offset:20736
    s_waitcnt lgkmcnt(2)
    v_dot2_f32_bf16 v45, v216, v40, 0
    v_dot2_f32_bf16 v45, v217, v41, v45
    v_dot2_f32_bf16 v45, v218, v42, v45
    v_dot2_f32_bf16 v45, v219, v43, v45
    v_dot2_f32_bf16 v45, v220, v16, v45
    v_dot2_f32_bf16 v45, v221, v17, v45
    v_dot2_f32_bf16 v45, v222, v18, v45
    v_dot2_f32_bf16 v45, v223, v19, v45
    s_cmp_gt_u32 s68, 13
    s_cbranch_scc0 L_ni_35
    v_add_u32_dpp v47, v24, v7 row_newbcast:13 row_mask:0xf bank_mask:0xf
    buffer_load_dwordx4 v[152:155], v47, s[32:35], 0 offen offset:0
    buffer_load_dwordx4 v[156:159], v47, s[32:35], 0 offen offset:256
L_ni_35:
    s_nop 2
    v_add_f32_dpp v45, v45, v45 row_ror:8 row_mask:0xf bank_mask:0xf
    s_nop 1
    v_add_f32_dpp v45, v45, v45 row_ror:4 row_mask:0xf bank_mask:0xf
    s_nop 1
    v_add_f32_dpp v45, v45, v45 row_ror:2 row_mask:0xf bank_mask:0xf
    s_nop 1
    v_add_f32_dpp v45, v45, v45 row_ror:1 row_mask:0xf bank_mask:0xf
    s_nop 1
    v_cndmask_b32 v44, v44, v45, s[66:67]
    s_lshl_b64 s[66:67], s[66:67], 1
    s_xor_b32 s64, s24, 528
    v_xor_b32 v46, s64, v7
    ds_read_b128 v[40:43], v46 offset:20480
    ds_read_b128 v[16:19], v46 offset:20736
    s_waitcnt lgkmcnt(2)
    v_dot2_f32_bf16 v45, v224, v32, 0
    v_dot2_f32_bf16 v45, v225, v33, v45
    v_dot2_f32_bf16 v45, v226, v34, v45
    v_dot2_f32_bf16 v45, v227, v35, v45
    v_dot2_f32_bf16 v45, v228, v36, v45
    v_dot2_f32_bf16 v45, v229, v37, v45
    v_dot2_f32_bf16 v45, v230, v38, v45
    v_dot2_f32_bf16 v45, v231, v39, v45
    s_cmp_gt_u32 s68, 14
    s_cbranch_scc0 L_ni_36
    v_add_u32_dpp v47, v24, v7 row_newbcast:14 row_mask:0xf bank_mask:0xf
    buffer_load_dwordx4 v[160:163], v47, s[32:35], 0 offen offset:0
    buffer_load_dwordx4 v[164:167], v47, s[32:35], 0 offen offset:256
L_ni_36:
    s_nop 2
    v_add_f32_dpp v45, v45, v45 row_ror:8 row_mask:0xf bank_mask:0xf
    s_nop 1
    v_add_f32_dpp v45, v45, v45 row_ror:4 row_mask:0xf bank_mask:0xf
    s_nop 1
    v_add_f32_dpp v45, v45, v45 row_ror:2 row_mask:0xf bank_mask:0xf
    s_nop 1
    v_add_f32_dpp v45, v45, v45 row_ror:1 row_mask:0xf bank_mask:0xf
    s_nop 1
    v_cndmask_b32 v44, v44, v45, s[66:67]
    s_lshl_b64 s[66:67], s[66:67], 1
    s_xor_b32 s64, s25, 0
    v_xor_b32 v46, s64, v7
    ds_read_b128 v[32:35], v46 offset:20480
    ds_read_b128 v[36:39], v46 offset:20736
    s_waitcnt lgkmcnt(2)
    v_dot2_f32_bf16 v45, v232, v40, 0
    v_dot2_f32_bf16 v45, v233, v41, v45
    v_dot2_f32_bf16 v45, v234, v42, v45
    v_dot2_f32_bf16 v45, v235, v43, v45
    v_dot2_f32_bf16 v45, v236, v16, v45
    v_dot2_f32_bf16 v45, v237, v17, v45
    v_dot2_f32_bf16 v45, v238, v18, v45
    v_dot2_f32_bf16 v45, v239, v19, v45
    s_cmp_gt_u32 s68, 15
    s_cbranch_scc0 L_ni_37
    v_add_u32_dpp v47, v24, v7 row_newbcast:15 row_mask:0xf bank_mask:0xf
    buffer_load_dwordx4 v[168:171], v47, s[32:35], 0 offen offset:0
    buffer_load_dwordx4 v[172:175], v47, s[32:35], 0 offen offset:256
L_ni_37:
    s_nop 2
    v_add_f32_dpp v45, v45, v45 row_ror:8 row_mask:0xf bank_mask:0xf
    s_nop 1
    v_add_f32_dpp v45, v45, v45 row_ror:4 row_mask:0xf bank_mask:0xf
    s_nop 1
    v_add_f32_dpp v45, v45, v45 row_ror:2 row_mask:0xf bank_mask:0xf
    s_nop 1
    v_add_f32_dpp v45, v45, v45 row_ror:1 row_mask:0xf bank_mask:0xf
    s_nop 1
    v_cndmask_b32 v44, v44, v45, s[66:67]
    s_lshl_b64 s[66:67], s[66:67], 1
    s_xor_b32 s64, s25, 528
    v_xor_b32 v46, s64, v7
    ds_read_b128 v[40:43], v46 offset:20480
    ds_read_b128 v[16:19], v46 offset:20736
    s_waitcnt lgkmcnt(2)
    v_dot2_f32_bf16 v45, v240, v32, 0
    v_dot2_f32_bf16 v45, v241, v33, v45
    v_dot2_f32_bf16 v45, v242, v34, v45
    v_dot2_f32_bf16 v45, v243, v35, v45
    v_dot2_f32_bf16 v45, v244, v36, v45
    v_dot2_f32_bf16 v45, v245, v37, v45
    v_dot2_f32_bf16 v45, v246, v38, v45
    v_dot2_f32_bf16 v45, v247, v39, v45
    s_nop 2
    v_add_f32_dpp v45, v45, v45 row_ror:8 row_mask:0xf bank_mask:0xf
    s_nop 1
    v_add_f32_dpp v45, v45, v45 row_ror:4 row_mask:0xf bank_mask:0xf
    s_nop 1
    v_add_f32_dpp v45, v45, v45 row_ror:2 row_mask:0xf bank_mask:0xf
    s_nop 1
    v_add_f32_dpp v45, v45, v45 row_ror:1 row_mask:0xf bank_mask:0xf
    s_nop 1
    v_cndmask_b32 v44, v44, v45, s[66:67]
    s_lshl_b64 s[66:67], s[66:67], 1
    s_waitcnt lgkmcnt(0)
    v_dot2_f32_bf16 v45, v248, v40, 0
    v_dot2_f32_bf16 v45, v249, v41, v45
    v_dot2_f32_bf16 v45, v250, v42, v45
    v_dot2_f32_bf16 v45, v251, v43, v45
    v_dot2_f32_bf16 v45, v252, v16, v45
    v_dot2_f32_bf16 v45, v253, v17, v45
    v_dot2_f32_bf16 v45, v254, v18, v45
    v_dot2_f32_bf16 v45, v255, v19, v45
    s_nop 2
    v_add_f32_dpp v45, v45, v45 row_ror:8 row_mask:0xf bank_mask:0xf
    s_nop 1
    v_add_f32_dpp v45, v45, v45 row_ror:4 row_mask:0xf bank_mask:0xf
    s_nop 1
    v_add_f32_dpp v45, v45, v45 row_ror:2 row_mask:0xf bank_mask:0xf
    s_nop 1
    v_add_f32_dpp v45, v45, v45 row_ror:1 row_mask:0xf bank_mask:0xf
    s_nop 1
    v_cndmask_b32 v44, v44, v45, s[66:67]
    s_lshl_b64 s[66:67], s[66:67], 1
    v_mul_f32 v44, 0x3db8aa3b, v44
    v_exp_f32 v44, v44
    s_nop 0
    v_mov_b32 v32, v44
    v_mov_b32 v33, v44
    s_nop 1
    v_permlane32_swap_b32 v32, v33
    v_add_f32 v32, v32, v33
    v_mov_b32 v33, v32
    s_nop 1
    v_permlane16_swap_b32 v32, v33
    v_add_f32 v32, v32, v33
    v_add_f32 v32, 0x3089705f, v32
    v_rcp_f32 v32, v32
    v_and_b32 v33, 1, v3
    v_lshlrev_b32 v33, 4, v33
    v_mul_f32 v44, v44, v32
    v_cvt_pk_bf16_f32 v44, v44, 0
    v_lshlrev_b32 v44, v33, v44
    s_nop 1
    v_mov_b32_dpp v46, v44 row_newbcast:0 row_mask:0xf bank_mask:0xf
    v_perm_b32 v12, v46, v46, v8
    v_perm_b32 v13, v46, v46, v9
    v_perm_b32 v14, v46, v46, v10
    v_perm_b32 v15, v46, v46, v11
    s_nop 1
    v_mfma_f32_16x16x32_bf16 v[16:19], v[12:15], v[176:179], 0
    v_mfma_f32_16x16x32_bf16 v[20:23], v[12:15], v[180:183], 0
    v_mov_b32_dpp v46, v44 row_newbcast:1 row_mask:0xf bank_mask:0xf
    v_perm_b32 v12, v46, v46, v8
    v_perm_b32 v13, v46, v46, v9
    v_perm_b32 v14, v46, v46, v10
    v_perm_b32 v15, v46, v46, v11
    s_nop 1
    v_mfma_f32_16x16x32_bf16 v[16:19], v[12:15], v[184:187], v[16:19]
    v_mfma_f32_16x16x32_bf16 v[20:23], v[12:15], v[188:191], v[20:23]
    v_mov_b32_dpp v46, v44 row_newbcast:2 row_mask:0xf bank_mask:0xf
    v_perm_b32 v12, v46, v46, v8
    v_perm_b32 v13, v46, v46, v9
    v_perm_b32 v14, v46, v46, v10
    v_perm_b32 v15, v46, v46, v11
    s_nop 1
    v_mfma_f32_16x16x32_bf16 v[32:35], v[12:15], v[192:195], 0
    v_mfma_f32_16x16x32_bf16 v[36:39], v[12:15], v[196:199], 0
    v_mov_b32_dpp v46, v44 row_newbcast:3 row_mask:0xf bank_mask:0xf
    v_perm_b32 v12, v46, v46, v8
    v_perm_b32 v13, v46, v46, v9
    v_perm_b32 v14, v46, v46, v10
    v_perm_b32 v15, v46, v46, v11
    s_nop 1
    v_mfma_f32_16x16x32_bf16 v[32:35], v[12:15], v[200:203], v[32:35]
    v_mfma_f32_16x16x32_bf16 v[36:39], v[12:15], v[204:207], v[36:39]
    v_xor_b32 v45, s21, v2
    v_cvt_pk_bf16_f32 v40, v16, v17
    v_cvt_pk_bf16_f32 v41, v18, v19
    ds_write_b64 v45, v[40:41] offset:0
    v_cvt_pk_bf16_f32 v42, v20, v21
    v_cvt_pk_bf16_f32 v43, v22, v23
    ds_write_b64 v45, v[42:43] offset:256
    v_mov_b32_dpp v46, v44 row_newbcast:4 row_mask:0xf bank_mask:0xf
    v_perm_b32 v12, v46, v46, v8
    v_perm_b32 v13, v46, v46, v9
    v_perm_b32 v14, v46, v46, v10
    v_perm_b32 v15, v46, v46, v11
    s_nop 1
    v_mfma_f32_16x16x32_bf16 v[16:19], v[12:15], v[208:211], 0
    v_mfma_f32_16x16x32_bf16 v[20:23], v[12:15], v[212:215], 0
    v_mov_b32_dpp v46, v44 row_newbcast:5 row_mask:0xf bank_mask:0xf
    v_perm_b32 v12, v46, v46, v8
    v_perm_b32 v13, v46, v46, v9
    v_perm_b32 v14, v46, v46, v10
    v_perm_b32 v15, v46, v46, v11
    s_nop 1
    v_mfma_f32_16x16x32_bf16 v[16:19], v[12:15], v[216:219], v[16:19]
    v_mfma_f32_16x16x32_bf16 v[20:23], v[12:15], v[220:223], v[20:23]
    v_xor_b32 v45, s22, v2
    v_cvt_pk_bf16_f32 v40, v32, v33
    v_cvt_pk_bf16_f32 v41, v34, v35
    ds_write_b64 v45, v[40:41] offset:0
    v_cvt_pk_bf16_f32 v42, v36, v37
    v_cvt_pk_bf16_f32 v43, v38, v39
    ds_write_b64 v45, v[42:43] offset:256
    v_mov_b32_dpp v46, v44 row_newbcast:6 row_mask:0xf bank_mask:0xf
    v_perm_b32 v12, v46, v46, v8
    v_perm_b32 v13, v46, v46, v9
    v_perm_b32 v14, v46, v46, v10
    v_perm_b32 v15, v46, v46, v11
    s_nop 1
    v_mfma_f32_16x16x32_bf16 v[32:35], v[12:15], v[224:227], 0
    v_mfma_f32_16x16x32_bf16 v[36:39], v[12:15], v[228:231], 0
    v_mov_b32_dpp v46, v44 row_newbcast:7 row_mask:0xf bank_mask:0xf
    v_perm_b32 v12, v46, v46, v8
    v_perm_b32 v13, v46, v46, v9
    v_perm_b32 v14, v46, v46, v10
    v_perm_b32 v15, v46, v46, v11
    s_nop 1
    v_mfma_f32_16x16x32_bf16 v[32:35], v[12:15], v[232:235], v[32:35]
    v_mfma_f32_16x16x32_bf16 v[36:39], v[12:15], v[236:239], v[36:39]
    v_xor_b32 v45, s23, v2
    v_cvt_pk_bf16_f32 v40, v16, v17
    v_cvt_pk_bf16_f32 v41, v18, v19
    ds_write_b64 v45, v[40:41] offset:0
    v_cvt_pk_bf16_f32 v42, v20, v21
    v_cvt_pk_bf16_f32 v43, v22, v23
    ds_write_b64 v45, v[42:43] offset:256
    v_mov_b32_dpp v46, v44 row_newbcast:8 row_mask:0xf bank_mask:0xf
    v_perm_b32 v12, v46, v46, v8
    v_perm_b32 v13, v46, v46, v9
    v_perm_b32 v14, v46, v46, v10
    v_perm_b32 v15, v46, v46, v11
    s_nop 1
    v_mfma_f32_16x16x32_bf16 v[16:19], v[12:15], v[240:243], 0
    v_mfma_f32_16x16x32_bf16 v[20:23], v[12:15], v[244:247], 0
    v_mov_b32_dpp v46, v44 row_newbcast:9 row_mask:0xf bank_mask:0xf
    v_perm_b32 v12, v46, v46, v8
    v_perm_b32 v13, v46, v46, v9
    v_perm_b32 v14, v46, v46, v10
    v_perm_b32 v15, v46, v46, v11
    s_nop 1
    v_mfma_f32_16x16x32_bf16 v[16:19], v[12:15], v[248:251], v[16:19]
    v_mfma_f32_16x16x32_bf16 v[20:23], v[12:15], v[252:255], v[20:23]
    v_xor_b32 v45, s24, v2
    v_cvt_pk_bf16_f32 v40, v32, v33
    v_cvt_pk_bf16_f32 v41, v34, v35
    ds_write_b64 v45, v[40:41] offset:0
    v_cvt_pk_bf16_f32 v42, v36, v37
    v_cvt_pk_bf16_f32 v43, v38, v39
    ds_write_b64 v45, v[42:43] offset:256
    s_nop 7
    v_xor_b32 v45, s25, v2
    v_cvt_pk_bf16_f32 v40, v16, v17
    v_cvt_pk_bf16_f32 v41, v18, v19
    ds_write_b64 v45, v[40:41] offset:0
    v_cvt_pk_bf16_f32 v42, v20, v21
    v_cvt_pk_bf16_f32 v43, v22, v23
    ds_write_b64 v45, v[42:43] offset:256
    s_mul_i32 s9, s2, 80
    s_add_u32 s9, s9, 61440
    v_and_b32 v45, 2, v4
    v_add_u32 v0, s9, v45
    s_lshl_b32 s64, s4, 2
    v_add_u32 v45, s64, v0
    v_mov_b32 v1, 0
    ds_read_u16_d16_hi v1, v45
    v_mov_b32 v16, 0
    v_mov_b32 v17, 0
    v_mov_b32 v18, 0
    v_mov_b32 v19, 0
    v_mov_b32 v20, 0
    v_mov_b32 v21, 0
    v_mov_b32 v22, 0
    v_mov_b32 v23, 0
    s_mov_b32 s70, 0
    s_mov_b32 s69, s74
    s_waitcnt lgkmcnt(0)
    s_barrier
    s_cmp_lg_u32 s71, 0
    s_cbranch_scc1 L_slow
    s_cmp_eq_u32 s68, s69
    s_cbranch_scc0 L_ring
    s_call_b64 s[72:73], L_flush
L_ring:
    s_cmp_lt_u32 s68, 16
    s_cbranch_scc0 L_w_38
    s_call_b64 s[72:73], L_ladder
L_w_38:
    v_mov_b32_dpp v46, v25 row_newbcast:0 row_mask:0xf bank_mask:0xf
    v_perm_b32 v12, v46, v46, v8
    v_perm_b32 v13, v46, v46, v9
    v_perm_b32 v14, v46, v46, v10
    v_perm_b32 v15, v46, v46, v11
    s_sub_u32 s68, s68, 1
    s_waitcnt vmcnt(30)
    v_mfma_f32_16x16x32_bf16 v[16:19], v[12:15], v[48:51], v[16:19]
    v_mfma_f32_16x16x32_bf16 v[20:23], v[12:15], v[52:55], v[20:23]
    s_cmp_ge_u32 s68, 16
    s_cbranch_scc0 L_ni_40
    v_add_u32_dpp v47, v26, v7 row_newbcast:0 row_mask:0xf bank_mask:0xf
    buffer_load_dwordx4 v[48:51], v47, s[32:35], 0 offen offset:0
    buffer_load_dwordx4 v[52:55], v47, s[32:35], 0 offen offset:256
L_ni_40:
    s_cmp_eq_u32 s68, s69
    s_cbranch_scc0 L_nf_39
    s_call_b64 s[72:73], L_flush
L_nf_39:
    s_cmp_lt_u32 s68, 16
    s_cbranch_scc0 L_w_41
    s_call_b64 s[72:73], L_ladder
L_w_41:
    v_mov_b32_dpp v46, v25 row_newbcast:1 row_mask:0xf bank_mask:0xf
    v_perm_b32 v12, v46, v46, v8
    v_perm_b32 v13, v46, v46, v9
    v_perm_b32 v14, v46, v46, v10
    v_perm_b32 v15, v46, v46, v11
    s_sub_u32 s68, s68, 1
    s_waitcnt vmcnt(30)
    v_mfma_f32_16x16x32_bf16 v[16:19], v[12:15], v[56:59], v[16:19]
    v_mfma_f32_16x16x32_bf16 v[20:23], v[12:15], v[60:63], v[20:23]
    s_cmp_ge_u32 s68, 16
    s_cbranch_scc0 L_ni_43
    v_add_u32_dpp v47, v26, v7 row_newbcast:1 row_mask:0xf bank_mask:0xf
    buffer_load_dwordx4 v[56:59], v47, s[32:35], 0 offen offset:0
    buffer_load_dwordx4 v[60:63], v47, s[32:35], 0 offen offset:256
L_ni_43:
    s_cmp_eq_u32 s68, s69
    s_cbranch_scc0 L_nf_42
    s_call_b64 s[72:73], L_flush
L_nf_42:
    s_cmp_lt_u32 s68, 16
    s_cbranch_scc0 L_w_44
    s_call_b64 s[72:73], L_ladder
L_w_44:
    v_mov_b32_dpp v46, v25 row_newbcast:2 row_mask:0xf bank_mask:0xf
    v_perm_b32 v12, v46, v46, v8
    v_perm_b32 v13, v46, v46, v9
    v_perm_b32 v14, v46, v46, v10
    v_perm_b32 v15, v46, v46, v11
    s_sub_u32 s68, s68, 1
    s_waitcnt vmcnt(30)
    v_mfma_f32_16x16x32_bf16 v[16:19], v[12:15], v[64:67], v[16:19]
    v_mfma_f32_16x16x32_bf16 v[20:23], v[12:15], v[68:71], v[20:23]
    s_cmp_ge_u32 s68, 16
    s_cbranch_scc0 L_ni_46
    v_add_u32_dpp v47, v26, v7 row_newbcast:2 row_mask:0xf bank_mask:0xf
    buffer_load_dwordx4 v[64:67], v47, s[32:35], 0 offen offset:0
    buffer_load_dwordx4 v[68:71], v47, s[32:35], 0 offen offset:256
L_ni_46:
    s_cmp_eq_u32 s68, s69
    s_cbranch_scc0 L_nf_45
    s_call_b64 s[72:73], L_flush
L_nf_45:
    s_cmp_lt_u32 s68, 16
    s_cbranch_scc0 L_w_47
    s_call_b64 s[72:73], L_ladder
L_w_47:
    v_mov_b32_dpp v46, v25 row_newbcast:3 row_mask:0xf bank_mask:0xf
    v_perm_b32 v12, v46, v46, v8
    v_perm_b32 v13, v46, v46, v9
    v_perm_b32 v14, v46, v46, v10
    v_perm_b32 v15, v46, v46, v11
    s_sub_u32 s68, s68, 1
    s_waitcnt vmcnt(30)
    v_mfma_f32_16x16x32_bf16 v[16:19], v[12:15], v[72:75], v[16:19]
    v_mfma_f32_16x16x32_bf16 v[20:23], v[12:15], v[76:79], v[20:23]
    s_cmp_ge_u32 s68, 16
    s_cbranch_scc0 L_ni_49
    v_add_u32_dpp v47, v26, v7 row_newbcast:3 row_mask:0xf bank_mask:0xf
    buffer_load_dwordx4 v[72:75], v47, s[32:35], 0 offen offset:0
    buffer_load_dwordx4 v[76:79], v47, s[32:35], 0 offen offset:256
L_ni_49:
    s_cmp_eq_u32 s68, s69
    s_cbranch_scc0 L_nf_48
    s_call_b64 s[72:73], L_flush
L_nf_48:
    s_cmp_lt_u32 s68, 16
    s_cbranch_scc0 L_w_50
    s_call_b64 s[72:73], L_ladder
L_w_50:
    v_mov_b32_dpp v46, v25 row_newbcast:4 row_mask:0xf bank_mask:0xf
    v_perm_b32 v12, v46, v46, v8
    v_perm_b32 v13, v46, v46, v9
    v_perm_b32 v14, v46, v46, v10
    v_perm_b32 v15, v46, v46, v11
    s_sub_u32 s68, s68, 1
    s_waitcnt vmcnt(30)
    v_mfma_f32_16x16x32_bf16 v[16:19], v[12:15], v[80:83], v[16:19]
    v_mfma_f32_16x16x32_bf16 v[20:23], v[12:15], v[84:87], v[20:23]
    s_cmp_ge_u32 s68, 16
    s_cbranch_scc0 L_ni_52
    v_add_u32_dpp v47, v26, v7 row_newbcast:4 row_mask:0xf bank_mask:0xf
    buffer_load_dwordx4 v[80:83], v47, s[32:35], 0 offen offset:0
    buffer_load_dwordx4 v[84:87], v47, s[32:35], 0 offen offset:256
L_ni_52:
    s_cmp_eq_u32 s68, s69
    s_cbranch_scc0 L_nf_51
    s_call_b64 s[72:73], L_flush
L_nf_51:
    s_cmp_lt_u32 s68, 16
    s_cbranch_scc0 L_w_53
    s_call_b64 s[72:73], L_ladder
L_w_53:
    v_mov_b32_dpp v46, v25 row_newbcast:5 row_mask:0xf bank_mask:0xf
    v_perm_b32 v12, v46, v46, v8
    v_perm_b32 v13, v46, v46, v9
    v_perm_b32 v14, v46, v46, v10
    v_perm_b32 v15, v46, v46, v11
    s_sub_u32 s68, s68, 1
    s_waitcnt vmcnt(30)
    v_mfma_f32_16x16x32_bf16 v[16:19], v[12:15], v[88:91], v[16:19]
    v_mfma_f32_16x16x32_bf16 v[20:23], v[12:15], v[92:95], v[20:23]
    s_cmp_ge_u32 s68, 16
    s_cbranch_scc0 L_ni_55
    v_add_u32_dpp v47, v26, v7 row_newbcast:5 row_mask:0xf bank_mask:0xf
    buffer_load_dwordx4 v[88:91], v47, s[32:35], 0 offen offset:0
    buffer_load_dwordx4 v[92:95], v47, s[32:35], 0 offen offset:256
L_ni_55:
    s_cmp_eq_u32 s68, s69
    s_cbranch_scc0 L_nf_54
    s_call_b64 s[72:73], L_flush
L_nf_54:
    s_cmp_lt_u32 s68, 16
    s_cbranch_scc0 L_w_56
    s_call_b64 s[72:73], L_ladder
L_w_56:
    v_mov_b32_dpp v46, v25 row_newbcast:6 row_mask:0xf bank_mask:0xf
    v_perm_b32 v12, v46, v46, v8
    v_perm_b32 v13, v46, v46, v9
    v_perm_b32 v14, v46, v46, v10
    v_perm_b32 v15, v46, v46, v11
    s_sub_u32 s68, s68, 1
    s_waitcnt vmcnt(30)
    v_mfma_f32_16x16x32_bf16 v[16:19], v[12:15], v[96:99], v[16:19]
    v_mfma_f32_16x16x32_bf16 v[20:23], v[12:15], v[100:103], v[20:23]
    s_cmp_ge_u32 s68, 16
    s_cbranch_scc0 L_ni_58
    v_add_u32_dpp v47, v26, v7 row_newbcast:6 row_mask:0xf bank_mask:0xf
    buffer_load_dwordx4 v[96:99], v47, s[32:35], 0 offen offset:0
    buffer_load_dwordx4 v[100:103], v47, s[32:35], 0 offen offset:256
L_ni_58:
    s_cmp_eq_u32 s68, s69
    s_cbranch_scc0 L_nf_57
    s_call_b64 s[72:73], L_flush
L_nf_57:
    s_cmp_lt_u32 s68, 16
    s_cbranch_scc0 L_w_59
    s_call_b64 s[72:73], L_ladder
L_w_59:
    v_mov_b32_dpp v46, v25 row_newbcast:7 row_mask:0xf bank_mask:0xf
    v_perm_b32 v12, v46, v46, v8
    v_perm_b32 v13, v46, v46, v9
    v_perm_b32 v14, v46, v46, v10
    v_perm_b32 v15, v46, v46, v11
    s_sub_u32 s68, s68, 1
    s_waitcnt vmcnt(30)
    v_mfma_f32_16x16x32_bf16 v[16:19], v[12:15], v[104:107], v[16:19]
    v_mfma_f32_16x16x32_bf16 v[20:23], v[12:15], v[108:111], v[20:23]
    s_cmp_ge_u32 s68, 16
    s_cbranch_scc0 L_ni_61
    v_add_u32_dpp v47, v26, v7 row_newbcast:7 row_mask:0xf bank_mask:0xf
    buffer_load_dwordx4 v[104:107], v47, s[32:35], 0 offen offset:0
    buffer_load_dwordx4 v[108:111], v47, s[32:35], 0 offen offset:256
L_ni_61:
    s_cmp_eq_u32 s68, s69
    s_cbranch_scc0 L_nf_60
    s_call_b64 s[72:73], L_flush
L_nf_60:
    s_cmp_lt_u32 s68, 16
    s_cbranch_scc0 L_w_62
    s_call_b64 s[72:73], L_ladder
L_w_62:
    v_mov_b32_dpp v46, v25 row_newbcast:8 row_mask:0xf bank_mask:0xf
    v_perm_b32 v12, v46, v46, v8
    v_perm_b32 v13, v46, v46, v9
    v_perm_b32 v14, v46, v46, v10
    v_perm_b32 v15, v46, v46, v11
    s_sub_u32 s68, s68, 1
    s_waitcnt vmcnt(30)
    v_mfma_f32_16x16x32_bf16 v[16:19], v[12:15], v[112:115], v[16:19]
    v_mfma_f32_16x16x32_bf16 v[20:23], v[12:15], v[116:119], v[20:23]
    s_cmp_ge_u32 s68, 16
    s_cbranch_scc0 L_ni_64
    v_add_u32_dpp v47, v26, v7 row_newbcast:8 row_mask:0xf bank_mask:0xf
    buffer_load_dwordx4 v[112:115], v47, s[32:35], 0 offen offset:0
    buffer_load_dwordx4 v[116:119], v47, s[32:35], 0 offen offset:256
L_ni_64:
    s_cmp_eq_u32 s68, s69
    s_cbranch_scc0 L_nf_63
    s_call_b64 s[72:73], L_flush
L_nf_63:
    s_cmp_lt_u32 s68, 16
    s_cbranch_scc0 L_w_65
    s_call_b64 s[72:73], L_ladder
L_w_65:
    v_mov_b32_dpp v46, v25 row_newbcast:9 row_mask:0xf bank_mask:0xf
    v_perm_b32 v12, v46, v46, v8
    v_perm_b32 v13, v46, v46, v9
    v_perm_b32 v14, v46, v46, v10
    v_perm_b32 v15, v46, v46, v11
    s_sub_u32 s68, s68, 1
    s_waitcnt vmcnt(30)
    v_mfma_f32_16x16x32_bf16 v[16:19], v[12:15], v[120:123], v[16:19]
    v_mfma_f32_16x16x32_bf16 v[20:23], v[12:15], v[124:127], v[20:23]
    s_cmp_ge_u32 s68, 16
    s_cbranch_scc0 L_ni_67
    v_add_u32_dpp v47, v26, v7 row_newbcast:9 row_mask:0xf bank_mask:0xf
    buffer_load_dwordx4 v[120:123], v47, s[32:35], 0 offen offset:0
    buffer_load_dwordx4 v[124:127], v47, s[32:35], 0 offen offset:256
L_ni_67:
    s_cmp_eq_u32 s68, s69
    s_cbranch_scc0 L_nf_66
    s_call_b64 s[72:73], L_flush
L_nf_66:
    s_cmp_lt_u32 s68, 16
    s_cbranch_scc0 L_w_68
    s_call_b64 s[72:73], L_ladder
L_w_68:
    v_mov_b32_dpp v46, v25 row_newbcast:10 row_mask:0xf bank_mask:0xf
    v_perm_b32 v12, v46, v46, v8
    v_perm_b32 v13, v46, v46, v9
    v_perm_b32 v14, v46, v46, v10
    v_perm_b32 v15, v46, v46, v11
    s_sub_u32 s68, s68, 1
    s_waitcnt vmcnt(30)
    v_mfma_f32_16x16x32_bf16 v[16:19], v[12:15], v[128:131], v[16:19]
    v_mfma_f32_16x16x32_bf16 v[20:23], v[12:15], v[132:135], v[20:23]
    s_cmp_ge_u32 s68, 16
    s_cbranch_scc0 L_ni_70
    v_add_u32_dpp v47, v26, v7 row_newbcast:10 row_mask:0xf bank_mask:0xf
    buffer_load_dwordx4 v[128:131], v47, s[32:35], 0 offen offset:0
    buffer_load_dwordx4 v[132:135], v47, s[32:35], 0 offen offset:256
L_ni_70:
    s_cmp_eq_u32 s68, s69
    s_cbranch_scc0 L_nf_69
    s_call_b64 s[72:73], L_flush
L_nf_69:
    s_cmp_lt_u32 s68, 16
    s_cbranch_scc0 L_w_71
    s_call_b64 s[72:73], L_ladder
L_w_71:
    v_mov_b32_dpp v46, v25 row_newbcast:11 row_mask:0xf bank_mask:0xf
    v_perm_b32 v12, v46, v46, v8
    v_perm_b32 v13, v46, v46, v9
    v_perm_b32 v14, v46, v46, v10
    v_perm_b32 v15, v46, v46, v11
    s_sub_u32 s68, s68, 1
    s_waitcnt vmcnt(30)
    v_mfma_f32_16x16x32_bf16 v[16:19], v[12:15], v[136:139], v[16:19]
    v_mfma_f32_16x16x32_bf16 v[20:23], v[12:15], v[140:143], v[20:23]
    s_cmp_ge_u32 s68, 16
    s_cbranch_scc0 L_ni_73
    v_add_u32_dpp v47, v26, v7 row_newbcast:11 row_mask:0xf bank_mask:0xf
    buffer_load_dwordx4 v[136:139], v47, s[32:35], 0 offen offset:0
    buffer_load_dwordx4 v[140:143], v47, s[32:35], 0 offen offset:256
L_ni_73:
    s_cmp_eq_u32 s68, s69
    s_cbranch_scc0 L_nf_72
    s_call_b64 s[72:73], L_flush
L_nf_72:
    s_cmp_lt_u32 s68, 16
    s_cbranch_scc0 L_w_74
    s_call_b64 s[72:73], L_ladder
L_w_74:
    v_mov_b32_dpp v46, v25 row_newbcast:12 row_mask:0xf bank_mask:0xf
    v_perm_b32 v12, v46, v46, v8
    v_perm_b32 v13, v46, v46, v9
    v_perm_b32 v14, v46, v46, v10
    v_perm_b32 v15, v46, v46, v11
    s_sub_u32 s68, s68, 1
    s_waitcnt vmcnt(30)
    v_mfma_f32_16x16x32_bf16 v[16:19], v[12:15], v[144:147], v[16:19]
    v_mfma_f32_16x16x32_bf16 v[20:23], v[12:15], v[148:151], v[20:23]
    s_cmp_ge_u32 s68, 16
    s_cbranch_scc0 L_ni_76
    v_add_u32_dpp v47, v26, v7 row_newbcast:12 row_mask:0xf bank_mask:0xf
    buffer_load_dwordx4 v[144:147], v47, s[32:35], 0 offen offset:0
    buffer_load_dwordx4 v[148:151], v47, s[32:35], 0 offen offset:256
L_ni_76:
    s_cmp_eq_u32 s68, s69
    s_cbranch_scc0 L_nf_75
    s_call_b64 s[72:73], L_flush
L_nf_75:
    s_cmp_lt_u32 s68, 16
    s_cbranch_scc0 L_w_77
    s_call_b64 s[72:73], L_ladder
L_w_77:
    v_mov_b32_dpp v46, v25 row_newbcast:13 row_mask:0xf bank_mask:0xf
    v_perm_b32 v12, v46, v46, v8
    v_perm_b32 v13, v46, v46, v9
    v_perm_b32 v14, v46, v46, v10
    v_perm_b32 v15, v46, v46, v11
    s_sub_u32 s68, s68, 1
    s_waitcnt vmcnt(30)
    v_mfma_f32_16x16x32_bf16 v[16:19], v[12:15], v[152:155], v[16:19]
    v_mfma_f32_16x16x32_bf16 v[20:23], v[12:15], v[156:159], v[20:23]
    s_cmp_ge_u32 s68, 16
    s_cbranch_scc0 L_ni_79
    v_add_u32_dpp v47, v26, v7 row_newbcast:13 row_mask:0xf bank_mask:0xf
    buffer_load_dwordx4 v[152:155], v47, s[32:35], 0 offen offset:0
    buffer_load_dwordx4 v[156:159], v47, s[32:35], 0 offen offset:256
L_ni_79:
    s_cmp_eq_u32 s68, s69
    s_cbranch_scc0 L_nf_78
    s_call_b64 s[72:73], L_flush
L_nf_78:
    s_cmp_lt_u32 s68, 16
    s_cbranch_scc0 L_w_80
    s_call_b64 s[72:73], L_ladder
L_w_80:
    v_mov_b32_dpp v46, v25 row_newbcast:14 row_mask:0xf bank_mask:0xf
    v_perm_b32 v12, v46, v46, v8
    v_perm_b32 v13, v46, v46, v9
    v_perm_b32 v14, v46, v46, v10
    v_perm_b32 v15, v46, v46, v11
    s_sub_u32 s68, s68, 1
    s_waitcnt vmcnt(30)
    v_mfma_f32_16x16x32_bf16 v[16:19], v[12:15], v[160:163], v[16:19]
    v_mfma_f32_16x16x32_bf16 v[20:23], v[12:15], v[164:167], v[20:23]
    s_cmp_ge_u32 s68, 16
    s_cbranch_scc0 L_ni_82
    v_add_u32_dpp v47, v26, v7 row_newbcast:14 row_mask:0xf bank_mask:0xf
    buffer_load_dwordx4 v[160:163], v47, s[32:35], 0 offen offset:0
    buffer_load_dwordx4 v[164:167], v47, s[32:35], 0 offen offset:256
L_ni_82:
    s_cmp_eq_u32 s68, s69
    s_cbranch_scc0 L_nf_81
    s_call_b64 s[72:73], L_flush
L_nf_81:
    s_cmp_lt_u32 s68, 16
    s_cbranch_scc0 L_w_83
    s_call_b64 s[72:73], L_ladder
L_w_83:
    v_mov_b32_dpp v46, v25 row_newbcast:15 row_mask:0xf bank_mask:0xf
    v_perm_b32 v12, v46, v46, v8
    v_perm_b32 v13, v46, v46, v9
    v_perm_b32 v14, v46, v46, v10
    v_perm_b32 v15, v46, v46, v11
    s_sub_u32 s68, s68, 1
    s_waitcnt vmcnt(30)
    v_mfma_f32_16x16x32_bf16 v[16:19], v[12:15], v[168:171], v[16:19]
    v_mfma_f32_16x16x32_bf16 v[20:23], v[12:15], v[172:175], v[20:23]
    s_cmp_ge_u32 s68, 16
    s_cbranch_scc0 L_ni_85
    v_add_u32_dpp v47, v26, v7 row_newbcast:15 row_mask:0xf bank_mask:0xf
    buffer_load_dwordx4 v[168:171], v47, s[32:35], 0 offen offset:0
    buffer_load_dwordx4 v[172:175], v47, s[32:35], 0 offen offset:256
L_ni_85:
    s_cmp_eq_u32 s68, s69
    s_cbranch_scc0 L_nf_84
    s_call_b64 s[72:73], L_flush
L_nf_84:
    v_mov_b32 v25, v27
    v_mov_b32 v26, v28
    v_mov_b32 v27, v29
    v_mov_b32 v28, v30
    v_mov_b32 v29, v31
    s_branch L_ring
L_ladder:
    s_waitcnt vmcnt(8)
    s_cmp_gt_u32 s68, 4
    s_cbranch_scc1 L_lad_ret
    s_waitcnt vmcnt(4)
    s_cmp_gt_u32 s68, 2
    s_cbranch_scc1 L_lad_ret
    s_waitcnt vmcnt(2)
    s_cmp_gt_u32 s68, 1
    s_cbranch_scc1 L_lad_ret
    s_waitcnt vmcnt(0)
L_lad_ret:
    s_setpc_b64 s[72:73]
L_flush:
    v_xor_b32 v45, s21, v2
    s_lshr_b32 s64, s70, 1
    s_lshl_b32 s64, s64, 2
    v_add_u32 v44, s64, v5
    s_lshl_b32 s64, s5, 2
    v_add_u32 v43, s64, v0
    s_nop 2
    s_waitcnt lgkmcnt(0)
    v_mul_f32 v32, v1, v16
    v_mul_f32 v33, v1, v17
    v_mul_f32 v34, v1, v18
    v_mul_f32 v35, v1, v19
    v_mul_f32 v36, v1, v20
    v_mul_f32 v37, v1, v21
    v_mul_f32 v38, v1, v22
    v_mul_f32 v39, v1, v23
    ds_read_u16_d16_hi v1, v43
    v_cvt_pk_bf16_f32 v32, v32, v33
    v_cvt_pk_bf16_f32 v33, v34, v35
    ds_write_b64 v45, v[32:33] offset:40960
    v_cvt_pk_bf16_f32 v36, v36, v37
    v_cvt_pk_bf16_f32 v37, v38, v39
    ds_write_b64 v45, v[36:37] offset:41216
    v_mov_b32 v16, 0
    v_mov_b32 v17, 0
    v_mov_b32 v18, 0
    v_mov_b32 v19, 0
    v_mov_b32 v20, 0
    v_mov_b32 v21, 0
    v_mov_b32 v22, 0
    v_mov_b32 v23, 0
    s_mov_b32 s21, s22
    s_mov_b32 s4, s5
    s_mov_b32 s74, s75
    s_mov_b32 s22, s23
    s_mov_b32 s5, s6
    s_mov_b32 s75, s76
    s_mov_b32 s23, s24
    s_mov_b32 s6, s7
    s_mov_b32 s76, s77
    s_mov_b32 s24, s25
    s_mov_b32 s7, s8
    s_mov_b32 s77, s78
    s_mov_b32 s69, s74
    s_add_u32 s70, s70, 1
    s_waitcnt lgkmcnt(0)
    s_mov_b64 exec, 1
    ds_add_u32 v44, v6 offset:16
    s_mov_b64 exec, -1
    s_cmp_eq_u32 s70, 5
    s_cbranch_scc1 L_sdone
    s_cmp_eq_u32 s68, s69
    s_cbranch_scc1 L_flush
    s_setpc_b64 s[72:73]
L_slow:
    s_mov_b32 s68, -1
    v_mbcnt_lo_u32_b32 v48, -1, 0
    v_mbcnt_hi_u32_b32 v48, -1, v48
    v_lshlrev_b32 v48, 2, v48
L_slow_pair:
    s_mul_i32 s15, s2, 40
    s_lshl_b32 s64, s4, 1
    s_add_u32 s15, s15, s64
    s_mov_b32 s16, 0
L_slow_chunk:
    buffer_load_dword v49, v48, s[44:47], s16 offen
    buffer_load_dword v50, v48, s[48:51], s16 offen
    s_waitcnt vmcnt(0)
    v_subrev_u32 v49, s15, v49
    v_cmp_gt_u32 vcc, 2, v49
    v_lshlrev_b32 v51, 1, v50
    ds_read_u16 v51, v51 offset:61440
    s_mov_b64 s[18:19], vcc
    v_lshlrev_b32 v49, 4, v49
    v_lshlrev_b32 v50, 9, v50
    s_waitcnt lgkmcnt(0)
    v_lshlrev_b32 v51, v49, v51
L_slow_edge:
    s_cmp_eq_u64 s[18:19], 0
    s_cbranch_scc1 L_slow_next
    s_ff1_i32_b64 s17, s[18:19]
    s_bitset0_b64 s[18:19], s17
    v_readlane_b32 s64, v50, s17
    v_readlane_b32 s65, v51, s17
    v_mov_b32 v46, 0
    v_mov_b32 v47, 2147483648
    s_mov_b64 exec, 0xffff
    v_mov_b32 v46, s65
    v_add_u32 v47, s64, v7
    s_mov_b64 exec, -1
    buffer_load_dwordx4 v[56:59], v47, s[32:35], 0 offen
    buffer_load_dwordx4 v[60:63], v47, s[32:35], 0 offen offset:256
    v_perm_b32 v12, v46, v46, v8
    v_perm_b32 v13, v46, v46, v9
    v_perm_b32 v14, v46, v46, v10
    v_perm_b32 v15, v46, v46, v11
    s_nop 0
    s_waitcnt vmcnt(0)
    v_mfma_f32_16x16x32_bf16 v[16:19], v[12:15], v[56:59], v[16:19]
    v_mfma_f32_16x16x32_bf16 v[20:23], v[12:15], v[60:63], v[20:23]
    s_branch L_slow_edge
L_slow_next:
    s_add_u32 s16, s16, 256
    s_cmp_lt_u32 s16, 640000
    s_cbranch_scc1 L_slow_chunk
    s_call_b64 s[72:73], L_flush
    s_branch L_slow_pair
L_sdone:
L_end:
    s_endpgm
.section .rodata,"a"
.p2align 6
.amdhsa_kernel standalone__hybrid_graph_tf_exphormer__graph_kernel
  .amdhsa_next_free_vgpr 256
  .amdhsa_next_free_sgpr 102
  .amdhsa_accum_offset 256
  .amdhsa_group_segment_fixed_size 0
  .amdhsa_kernarg_size 104
  .amdhsa_user_sgpr_count 2
  .amdhsa_user_sgpr_kernarg_segment_ptr 1
  .amdhsa_system_sgpr_workgroup_id_x 1
  .amdhsa_float_denorm_mode_32 3
.end_amdhsa_kernel
```

```asm
; @launch grid=(253,1,1) block=(512,1,1) lds=161792
.amdgcn_target "amdgcn-amd-amdhsa--gfx950"
.text
.globl standalone__hybrid_graph_tf_exphormer__graph_kernel
.p2align 8
.type standalone__hybrid_graph_tf_exphormer__graph_kernel,@function
standalone__hybrid_graph_tf_exphormer__graph_kernel:
L_begin:
    s_cmp_ge_u32 s2, 253
    s_cbranch_scc1 L_end
    s_load_dwordx16 s[4:19], s[0:1], 0
    s_load_dwordx8 s[20:27], s[0:1], 64
    s_load_dwordx2 s[28:29], s[0:1], 96
    s_cmp_ge_u32 s2, 16
    s_cbranch_scc1 L_nopf
    s_getpc_b64 s[32:33]
L_pc:
    v_lshlrev_b32 v1, 6, v0
    v_min_u32 v1, L_end-L_pc, v1
    global_load_dword v255, v1, s[32:33]
L_nopf:
    v_lshrrev_b32 v1, 6, v0
    v_lshlrev_b32 v8, 4, v0
    v_mov_b32 v12, 1966080
    v_readfirstlane_b32 s3, v1
    v_mov_b32 v13, 1966080
    v_mov_b32 v14, 1966080
    v_mov_b32 v15, 1966080
    ds_write_b128 v8, v[12:15] offset:41984
    ds_write_b128 v8, v[12:15] offset:50176
    v_subrev_u32 v9, 32, v0
    v_cmp_gt_u32 vcc, 20, v9
    v_mul_u32_u24 v9, 264, v9
    v_add_u32 v9, 148480, v9
    v_lshlrev_b32 v10, 2, v0
    v_cndmask_b32 v9, 0, v9, vcc
    ds_write_b32 v10, v9
    v_mov_b32 v16, 1310740000
    v_mov_b32 v17, 1310740000
    v_mov_b32 v18, 1310740000
    v_mov_b32 v19, 1310740000
    v_add_u32 v9, 148480, v8
    ds_write_b128 v9, v[16:19]
    v_and_b32 v2, 63, v0
    v_and_b32 v3, 15, v0
    v_bfe_u32 v4, v0, 4, 2
    v_mov_b32 v5, 0
    v_mov_b32 v6, 1
    s_mov_b32 s100, 67108864
    s_and_b32 s31, s3, 3
    s_cmp_lt_u32 s3, 4
    s_cbranch_scc1 L_gemm
    s_setprio 3
    v_and_b32 v8, 0xfff, v8
    v_and_b32 v9, 0x3ff, v10
    s_lshr_b32 s66, s2, 4
    s_lshl_b32 s66, s66, 3
    s_and_b32 s67, s2, 7
    s_or_b32 s68, s66, s67
    s_mul_i32 s64, s68, 5120
    v_add_u32 v40, s64, v8
    s_add_u32 s64, s64, 4096
    v_add_u32 v41, s64, v9
    v_lshrrev_b32 v42, 2, v3
    v_and_b32 v43, 3, v3
    v_lshl_add_u32 v46, v42, 3, v43
    v_lshl_add_u32 v42, v42, 4, v43
    s_lshl_b32 s64, s31, 1
    v_mov_b32 v43, s64
    v_lshlrev_b32 v44, 1, v43
    v_cmp_gt_u32 vcc, 8, v3
    s_mul_i32 s65, s2, 640
    v_lshlrev_b32 v7, 4, v3
    v_cndmask_b32 v43, v43, v44, vcc
    v_add_lshl_u32 v42, v42, v43, 4
    v_lshl_add_u32 v42, v4, 2, v42
    v_add_u32 v42, s65, v42
    v_min_u32 v42, 159996, v42
    s_bitcmp1_b32 s2, 3
    s_cbranch_scc0 L_mrole_1
    s_waitcnt lgkmcnt(0)
    global_load_dwordx4 v[48:51], v40, s[8:9]
    global_load_dword v52, v41, s[8:9]
    global_load_dwordx4 v[56:59], v40, s[6:7]
    global_load_dword v60, v41, s[6:7]
L_roled_2:
    global_load_dword v0, v42, s[10:11]
    s_mov_b32 s27, s68
    s_cmp_lg_u32 s31, 0
    s_cbranch_scc1 L_roled_2_b
    s_load_dword s30, s[28:29], 0
L_roled_2_b:
    s_barrier
    s_mov_b32 s32, s4
    s_and_b32 s33, s5, 0xffff
    s_mov_b32 s34, 5120000
    s_mov_b32 s35, 0x20000
    s_mov_b32 s36, s14
    s_and_b32 s37, s15, 0xffff
    s_mov_b32 s38, 20000
    s_mov_b32 s39, 0x20000
    s_add_u32 s40, s28, 1048576
    s_addc_u32 s41, s29, 0
    s_and_b32 s41, s41, 0xffff
    s_mov_b32 s42, 2048000
    s_mov_b32 s43, 0x20000
    v_lshrrev_b32 v40, 3, v3
    v_mul_u32_u24 v40, 0x0202, v40
    v_add_u32 v40, 0x0100, v40
    v_xor_b32 v40, 0x0c0c, v40
    v_lshlrev_b32 v40, v7, v40
    v_xor_b32 v40, 0x0c0c0c0c, v40
    v_mov_b32 v41, 0x0c0c0c0c
    s_mov_b32 s64, 0x03030303
    s_mov_b32 s65, 0x03030303
    v_cndmask_b32 v12, v41, v40, s[64:65]
    s_lshl_b64 s[64:65], s[64:65], 2
    v_cndmask_b32 v13, v41, v40, s[64:65]
    s_lshl_b64 s[64:65], s[64:65], 2
    v_cndmask_b32 v14, v41, v40, s[64:65]
    s_lshl_b64 s[64:65], s[64:65], 2
    v_cndmask_b32 v15, v41, v40, s[64:65]
    s_cmp_lg_u32 s31, 0
    s_cbranch_scc1 L_tagged_3
    s_waitcnt lgkmcnt(0)
    s_mul_i32 s30, s30, 0x9E3779B1
    s_add_u32 s30, s30, 0x7F4A7C15
    v_mov_b32 v40, 1
    v_mov_b32 v41, s30
    ds_write_b64 v5, v[40:41] offset:8
L_tagged_3:
    s_bitcmp1_b32 s2, 3
    s_cbranch_scc0 L_mwork_4
    v_mov_b32 v43, 4
    v_mov_b32 v44, 2031616
    s_mov_b32 s64, 0x3f0001
    v_lshrrev_b32 v40, 7, v8
    v_and_b32 v41, 0x70, v8
    v_lshl_add_u32 v40, v40, 14, v41
    s_lshl_b32 s65, s27, 7
    s_waitcnt vmcnt(3)
    v_mul_u32_u24 v64, 52429, v48
    v_lshrrev_b32 v72, 22, v64
    v_lshlrev_b32 v80, 2, v72
    ds_add_rtn_u32 v80, v80, v43 offset:512
    v_mul_u32_u24 v65, 52429, v49
    v_lshrrev_b32 v73, 22, v65
    v_lshlrev_b32 v81, 2, v73
    ds_add_rtn_u32 v81, v81, v43 offset:512
    v_mul_u32_u24 v66, 52429, v50
    v_lshrrev_b32 v74, 22, v66
    v_lshlrev_b32 v82, 2, v74
    ds_add_rtn_u32 v82, v82, v43 offset:512
    v_mul_u32_u24 v67, 52429, v51
    v_lshrrev_b32 v75, 22, v67
    v_lshlrev_b32 v83, 2, v75
    ds_add_rtn_u32 v83, v83, v43 offset:512
    v_mul_u32_u24 v68, 52429, v52
    v_lshrrev_b32 v76, 22, v68
    v_lshlrev_b32 v84, 2, v76
    ds_add_rtn_u32 v84, v84, v43 offset:512
    v_lshrrev_b32 v64, 21, v64
    v_mad_u32_u24 v64, v64, 24, v48
    v_mul_u32_u24 v64, 0x8001, v64
    v_and_b32 v88, 7, v72
    v_lshl_or_b32 v72, v72, 3, v88
    v_lshlrev_b32 v72, 4, v72
    v_lshrrev_b32 v65, 21, v65
    v_mad_u32_u24 v65, v65, 24, v49
    v_mul_u32_u24 v65, 0x8001, v65
    v_and_b32 v89, 7, v73
    v_lshl_or_b32 v73, v73, 3, v89
    v_lshlrev_b32 v73, 4, v73
    v_lshrrev_b32 v66, 21, v66
    v_mad_u32_u24 v66, v66, 24, v50
    v_mul_u32_u24 v66, 0x8001, v66
    v_and_b32 v90, 7, v74
    v_lshl_or_b32 v74, v74, 3, v90
    v_lshlrev_b32 v74, 4, v74
    v_lshrrev_b32 v67, 21, v67
    v_mad_u32_u24 v67, v67, 24, v51
    v_mul_u32_u24 v67, 0x8001, v67
    v_and_b32 v91, 7, v75
    v_lshl_or_b32 v75, v75, 3, v91
    v_lshlrev_b32 v75, 4, v75
    v_lshrrev_b32 v68, 21, v68
    v_mad_u32_u24 v68, v68, 24, v52
    v_mul_u32_u24 v68, 0x8001, v68
    v_and_b32 v92, 7, v76
    v_lshl_or_b32 v76, v76, 3, v92
    v_lshlrev_b32 v76, 4, v76
    s_waitcnt vmcnt(1)
    v_lshlrev_b32 v56, 1, v56
    v_and_or_b32 v64, v64, s64, v56
    v_lshlrev_b32 v57, 1, v57
    v_and_or_b32 v65, v65, s64, v57
    v_lshlrev_b32 v58, 1, v58
    v_and_or_b32 v66, v66, s64, v58
    v_lshlrev_b32 v59, 1, v59
    v_and_or_b32 v67, v67, s64, v59
    v_lshlrev_b32 v60, 1, v60
    v_and_or_b32 v68, v68, s64, v60
    s_waitcnt lgkmcnt(0)
    v_cmp_gt_u32 vcc, 124, v80
    v_min_u32 v80, 124, v80
    v_xor_b32 v80, v80, v72
    v_cndmask_b32 v64, v44, v64, vcc
    ds_write_b32 v80, v64 offset:41984
    v_cmp_gt_u32 vcc, 124, v81
    v_min_u32 v81, 124, v81
    v_xor_b32 v81, v81, v73
    v_cndmask_b32 v65, v44, v65, vcc
    ds_write_b32 v81, v65 offset:41984
    v_cmp_gt_u32 vcc, 124, v82
    v_min_u32 v82, 124, v82
    v_xor_b32 v82, v82, v74
    v_cndmask_b32 v66, v44, v66, vcc
    ds_write_b32 v82, v66 offset:41984
    v_cmp_gt_u32 vcc, 124, v83
    v_min_u32 v83, 124, v83
    v_xor_b32 v83, v83, v75
    v_cndmask_b32 v67, v44, v67, vcc
    ds_write_b32 v83, v67 offset:41984
    v_cmp_gt_u32 vcc, 124, v84
    v_min_u32 v84, 124, v84
    v_xor_b32 v84, v84, v76
    v_cndmask_b32 v68, v44, v68, vcc
    ds_write_b32 v84, v68 offset:41984
    s_waitcnt lgkmcnt(0)
    s_mov_b64 exec, 1
    ds_add_u32 v5, v6 offset:0
    s_mov_b64 exec, -1
L_spin_6:
    ds_read_b128 v[44:47], v5
    s_waitcnt lgkmcnt(0)
    v_readfirstlane_b32 s101, v44
    v_readfirstlane_b32 s30, v47
    s_cmp_ge_u32 s101, 4
    s_cbranch_scc0 L_retry_7
    ds_read_b128 v[48:51], v8 offset:41984
    ds_read_b128 v[52:55], v8 offset:46080
    ds_read_b128 v[56:59], v8 offset:50176
    ds_read_b128 v[60:63], v8 offset:54272
    s_and_b32 s44, s30, 0xffc00000
    s_lshl_b32 s45, s30, 10
    s_and_b32 s45, s45, 0xffc00000
    s_lshl_b32 s46, s30, 20
    s_and_b32 s46, s46, 0xffc00000
    s_lshl_b32 s47, s30, 22
    s_waitcnt lgkmcnt(3)
    v_or_b32 v48, s44, v48
    v_or_b32 v49, s45, v49
    v_or_b32 v50, s46, v50
    v_or_b32 v51, s47, v51
    buffer_store_dwordx4 v[48:51], v40, s[40:43], s65 offen sc1
    s_add_u32 s65, s65, 0x80000
    s_waitcnt lgkmcnt(2)
    v_or_b32 v52, s44, v52
    v_or_b32 v53, s45, v53
    v_or_b32 v54, s46, v54
    v_or_b32 v55, s47, v55
    buffer_store_dwordx4 v[52:55], v40, s[40:43], s65 offen sc1
    s_add_u32 s65, s65, 0x80000
    s_waitcnt lgkmcnt(1)
    v_or_b32 v56, s44, v56
    v_or_b32 v57, s45, v57
    v_or_b32 v58, s46, v58
    v_or_b32 v59, s47, v59
    buffer_store_dwordx4 v[56:59], v40, s[40:43], s65 offen sc1
    s_add_u32 s65, s65, 0x80000
    s_waitcnt lgkmcnt(0)
    v_or_b32 v60, s44, v60
    v_or_b32 v61, s45, v61
    v_or_b32 v62, s46, v62
    v_or_b32 v63, s47, v63
    buffer_store_dwordx4 v[60:63], v40, s[40:43], s65 offen sc1
    s_cmp_ge_u32 s2, 250
    s_cbranch_scc1 L_end
    s_waitcnt vmcnt(4)
L_worked_5:
    v_lshlrev_b32 v0, 9, v0
    s_setprio 1
    s_lshl_b32 s64, s31, 10
    v_add_u32_dpp v40, v0, v7 row_newbcast:0 row_mask:0xf bank_mask:0xf
    buffer_load_dwordx4 v[176:179], v40, s[32:35], 0 offen offset:0
    buffer_load_dwordx4 v[180:183], v40, s[32:35], 0 offen offset:256
    v_add_u32_dpp v40, v0, v7 row_newbcast:1 row_mask:0xf bank_mask:0xf
    buffer_load_dwordx4 v[184:187], v40, s[32:35], 0 offen offset:0
    buffer_load_dwordx4 v[188:191], v40, s[32:35], 0 offen offset:256
    s_add_u32 m0, s64, 62464
    s_mov_b32 s65, 0
    buffer_load_dwordx4 v8, s[36:39], s65 offen lds
    v_add_u32_dpp v40, v0, v7 row_newbcast:2 row_mask:0xf bank_mask:0xf
    buffer_load_dwordx4 v[192:195], v40, s[32:35], 0 offen offset:0
    buffer_load_dwordx4 v[196:199], v40, s[32:35], 0 offen offset:256
    v_add_u32_dpp v40, v0, v7 row_newbcast:3 row_mask:0xf bank_mask:0xf
    buffer_load_dwordx4 v[200:203], v40, s[32:35], 0 offen offset:0
    buffer_load_dwordx4 v[204:207], v40, s[32:35], 0 offen offset:256
    s_add_u32 m0, s64, 66560
    s_mov_b32 s65, 4096
    buffer_load_dwordx4 v8, s[36:39], s65 offen lds
    v_add_u32_dpp v40, v0, v7 row_newbcast:4 row_mask:0xf bank_mask:0xf
    buffer_load_dwordx4 v[208:211], v40, s[32:35], 0 offen offset:0
    buffer_load_dwordx4 v[212:215], v40, s[32:35], 0 offen offset:256
    v_add_u32_dpp v40, v0, v7 row_newbcast:5 row_mask:0xf bank_mask:0xf
    buffer_load_dwordx4 v[216:219], v40, s[32:35], 0 offen offset:0
    buffer_load_dwordx4 v[220:223], v40, s[32:35], 0 offen offset:256
    s_add_u32 m0, s64, 70656
    s_mov_b32 s65, 8192
    buffer_load_dwordx4 v8, s[36:39], s65 offen lds
    v_add_u32_dpp v40, v0, v7 row_newbcast:6 row_mask:0xf bank_mask:0xf
    buffer_load_dwordx4 v[224:227], v40, s[32:35], 0 offen offset:0
    buffer_load_dwordx4 v[228:231], v40, s[32:35], 0 offen offset:256
    v_add_u32_dpp v40, v0, v7 row_newbcast:7 row_mask:0xf bank_mask:0xf
    buffer_load_dwordx4 v[232:235], v40, s[32:35], 0 offen offset:0
    buffer_load_dwordx4 v[236:239], v40, s[32:35], 0 offen offset:256
    s_add_u32 m0, s64, 74752
    s_mov_b32 s65, 12288
    buffer_load_dwordx4 v8, s[36:39], s65 offen lds
    v_add_u32_dpp v40, v0, v7 row_newbcast:8 row_mask:0xf bank_mask:0xf
    buffer_load_dwordx4 v[240:243], v40, s[32:35], 0 offen offset:0
    buffer_load_dwordx4 v[244:247], v40, s[32:35], 0 offen offset:256
    v_add_u32_dpp v40, v0, v7 row_newbcast:9 row_mask:0xf bank_mask:0xf
    buffer_load_dwordx4 v[248:251], v40, s[32:35], 0 offen offset:0
    buffer_load_dwordx4 v[252:255], v40, s[32:35], 0 offen offset:256
    s_add_u32 m0, s64, 78848
    s_mov_b32 s65, 16384
    buffer_load_dwordx4 v8, s[36:39], s65 offen lds
    s_lshr_b32 s10, s2, 1
    s_lshl_b32 s10, s10, 14
    s_add_u32 s11, s10, 4096
    s_add_u32 s12, s10, 8192
    s_add_u32 s13, s10, 12288
    v_cmp_gt_u32 vcc, 0xe80, v8
    s_mov_b64 s[14:15], vcc
L_ipoll_8:
    buffer_load_dwordx4 v[48:51], v8, s[40:43], s10 offen sc1
    buffer_load_dwordx4 v[52:55], v8, s[40:43], s11 offen sc1
    buffer_load_dwordx4 v[56:59], v8, s[40:43], s12 offen sc1
    s_mov_b64 exec, s[14:15]
    buffer_load_dwordx4 v[60:63], v8, s[40:43], s13 offen sc1
    s_mov_b64 exec, -1
L_spin_9:
    ds_read_b128 v[44:47], v5
    s_waitcnt lgkmcnt(0)
    v_readfirstlane_b32 s101, v46
    v_readfirstlane_b32 s30, v47
    s_cmp_ge_u32 s101, 1
    s_cbranch_scc0 L_retry_10
    s_and_b32 s44, s30, 0xffc00000
    s_lshl_b32 s45, s30, 10
    s_and_b32 s45, s45, 0xffc00000
    s_lshl_b32 s46, s30, 20
    s_and_b32 s46, s46, 0xffc00000
    s_lshl_b32 s47, s30, 22
    s_and_b32 s64, s2, 1
    s_lshl_b32 s64, s64, 21
    s_or_b32 s44, s44, s64
    v_mov_b32 v76, 1966080
    s_or_b32 s45, s45, s64
    v_mov_b32 v77, 1966080
    s_or_b32 s46, s46, s64
    v_mov_b32 v78, 1966080
    s_or_b32 s47, s47, s64
    v_mov_b32 v79, 1966080
    s_mov_b32 s16, 1310720
    v_mov_b32 v42, 2
    s_waitcnt vmcnt(3)
    v_xor_b32 v64, s44, v48
    v_xor_b32 v65, s45, v49
    v_xor_b32 v66, s46, v50
    v_xor_b32 v67, s47, v51
    v_or3_b32 v40, v64, v65, v66
    v_or_b32 v40, v40, v67
    v_cmp_gt_u32 s[48:49], s16, v64
    v_lshlrev_b32_sdwa v80, 2, v64 dst_sel:DWORD dst_unused:UNUSED_PAD src0_sel:DWORD src1_sel:WORD_1
    v_cmp_gt_u32 s[50:51], s16, v65
    v_lshlrev_b32_sdwa v81, 2, v65 dst_sel:DWORD dst_unused:UNUSED_PAD src0_sel:DWORD src1_sel:WORD_1
    v_cmp_gt_u32 s[52:53], s16, v66
    v_lshlrev_b32_sdwa v82, 2, v66 dst_sel:DWORD dst_unused:UNUSED_PAD src0_sel:DWORD src1_sel:WORD_1
    v_cmp_gt_u32 s[54:55], s16, v67
    v_lshlrev_b32_sdwa v83, 2, v67 dst_sel:DWORD dst_unused:UNUSED_PAD src0_sel:DWORD src1_sel:WORD_1
    s_waitcnt vmcnt(2)
    v_xor_b32 v68, s44, v52
    v_xor_b32 v69, s45, v53
    v_xor_b32 v70, s46, v54
    v_xor_b32 v71, s47, v55
    v_or3_b32 v40, v40, v68, v69
    v_or3_b32 v40, v40, v70, v71
    v_cmp_gt_u32 s[56:57], s16, v68
    v_lshlrev_b32_sdwa v84, 2, v68 dst_sel:DWORD dst_unused:UNUSED_PAD src0_sel:DWORD src1_sel:WORD_1
    v_cmp_gt_u32 s[58:59], s16, v69
    v_lshlrev_b32_sdwa v85, 2, v69 dst_sel:DWORD dst_unused:UNUSED_PAD src0_sel:DWORD src1_sel:WORD_1
    v_cmp_gt_u32 s[60:61], s16, v70
    v_lshlrev_b32_sdwa v86, 2, v70 dst_sel:DWORD dst_unused:UNUSED_PAD src0_sel:DWORD src1_sel:WORD_1
    v_cmp_gt_u32 s[62:63], s16, v71
    v_lshlrev_b32_sdwa v87, 2, v71 dst_sel:DWORD dst_unused:UNUSED_PAD src0_sel:DWORD src1_sel:WORD_1
    s_waitcnt vmcnt(1)
    v_xor_b32 v72, s44, v56
    v_xor_b32 v73, s45, v57
    v_xor_b32 v74, s46, v58
    v_xor_b32 v75, s47, v59
    v_or3_b32 v40, v40, v72, v73
    v_or3_b32 v40, v40, v74, v75
    v_cmp_gt_u32 s[64:65], s16, v72
    v_lshlrev_b32_sdwa v88, 2, v72 dst_sel:DWORD dst_unused:UNUSED_PAD src0_sel:DWORD src1_sel:WORD_1
    v_cmp_gt_u32 s[66:67], s16, v73
    v_lshlrev_b32_sdwa v89, 2, v73 dst_sel:DWORD dst_unused:UNUSED_PAD src0_sel:DWORD src1_sel:WORD_1
    v_cmp_gt_u32 s[68:69], s16, v74
    v_lshlrev_b32_sdwa v90, 2, v74 dst_sel:DWORD dst_unused:UNUSED_PAD src0_sel:DWORD src1_sel:WORD_1
    v_cmp_gt_u32 s[70:71], s16, v75
    v_lshlrev_b32_sdwa v91, 2, v75 dst_sel:DWORD dst_unused:UNUSED_PAD src0_sel:DWORD src1_sel:WORD_1
    s_waitcnt vmcnt(0)
    s_mov_b64 exec, s[14:15]
    v_xor_b32 v76, s44, v60
    v_xor_b32 v77, s45, v61
    v_xor_b32 v78, s46, v62
    v_xor_b32 v79, s47, v63
    s_mov_b64 exec, -1
    v_or3_b32 v40, v40, v76, v77
    v_or3_b32 v40, v40, v78, v79
    v_cmp_gt_u32 s[72:73], s16, v76
    v_lshlrev_b32_sdwa v92, 2, v76 dst_sel:DWORD dst_unused:UNUSED_PAD src0_sel:DWORD src1_sel:WORD_1
    v_cmp_gt_u32 s[74:75], s16, v77
    v_lshlrev_b32_sdwa v93, 2, v77 dst_sel:DWORD dst_unused:UNUSED_PAD src0_sel:DWORD src1_sel:WORD_1
    v_cmp_gt_u32 s[76:77], s16, v78
    v_lshlrev_b32_sdwa v94, 2, v78 dst_sel:DWORD dst_unused:UNUSED_PAD src0_sel:DWORD src1_sel:WORD_1
    v_cmp_gt_u32 s[78:79], s16, v79
    v_lshlrev_b32_sdwa v95, 2, v79 dst_sel:DWORD dst_unused:UNUSED_PAD src0_sel:DWORD src1_sel:WORD_1
    v_cmp_le_u32 vcc, 0x400000, v40
    s_cbranch_vccnz L_retry_11
    s_mov_b64 exec, s[48:49]
    ds_add_rtn_u32 v80, v80, v42 offset:128
    s_mov_b64 exec, s[50:51]
    ds_add_rtn_u32 v81, v81, v42 offset:128
    s_mov_b64 exec, s[52:53]
    ds_add_rtn_u32 v82, v82, v42 offset:128
    s_mov_b64 exec, s[54:55]
    ds_add_rtn_u32 v83, v83, v42 offset:128
    s_mov_b64 exec, s[56:57]
    ds_add_rtn_u32 v84, v84, v42 offset:128
    s_mov_b64 exec, s[58:59]
    ds_add_rtn_u32 v85, v85, v42 offset:128
    s_mov_b64 exec, s[60:61]
    ds_add_rtn_u32 v86, v86, v42 offset:128
    s_mov_b64 exec, s[62:63]
    ds_add_rtn_u32 v87, v87, v42 offset:128
    s_mov_b64 exec, s[64:65]
    ds_add_rtn_u32 v88, v88, v42 offset:128
    s_mov_b64 exec, s[66:67]
    ds_add_rtn_u32 v89, v89, v42 offset:128
    s_mov_b64 exec, s[68:69]
    ds_add_rtn_u32 v90, v90, v42 offset:128
    s_mov_b64 exec, s[70:71]
    ds_add_rtn_u32 v91, v91, v42 offset:128
    s_mov_b64 exec, s[72:73]
    ds_add_rtn_u32 v92, v92, v42 offset:128
    s_mov_b64 exec, s[74:75]
    ds_add_rtn_u32 v93, v93, v42 offset:128
    s_mov_b64 exec, s[76:77]
    ds_add_rtn_u32 v94, v94, v42 offset:128
    s_mov_b64 exec, s[78:79]
    ds_add_rtn_u32 v95, v95, v42 offset:128
    s_mov_b64 exec, -1
    v_and_b32 v48, 2031616, v67
    v_and_b32 v49, 2031616, v71
    v_and_b32 v50, 2031616, v75
    v_and_b32 v51, 2031616, v79
    v_max3_u32 v48, v48, v49, v50
    v_max_u32 v48, v48, v51
    v_cmp_eq_u32 vcc, 2031616, v48
    s_mov_b64 s[16:17], vcc
    s_waitcnt lgkmcnt(12)
    s_mov_b64 exec, s[48:49]
    ds_write_b16 v80, v64
    s_mov_b64 exec, s[50:51]
    ds_write_b16 v81, v65
    s_mov_b64 exec, s[52:53]
    ds_write_b16 v82, v66
    s_mov_b64 exec, s[54:55]
    ds_write_b16 v83, v67
    s_waitcnt lgkmcnt(12)
    s_mov_b64 exec, s[56:57]
    ds_write_b16 v84, v68
    s_mov_b64 exec, s[58:59]
    ds_write_b16 v85, v69
    s_mov_b64 exec, s[60:61]
    ds_write_b16 v86, v70
    s_mov_b64 exec, s[62:63]
    ds_write_b16 v87, v71
    s_waitcnt lgkmcnt(12)
    s_mov_b64 exec, s[64:65]
    ds_write_b16 v88, v72
    s_mov_b64 exec, s[66:67]
    ds_write_b16 v89, v73
    s_mov_b64 exec, s[68:69]
    ds_write_b16 v90, v74
    s_mov_b64 exec, s[70:71]
    ds_write_b16 v91, v75
    s_waitcnt lgkmcnt(12)
    s_mov_b64 exec, s[72:73]
    ds_write_b16 v92, v76
    s_mov_b64 exec, s[74:75]
    ds_write_b16 v93, v77
    s_mov_b64 exec, s[76:77]
    ds_write_b16 v94, v78
    s_mov_b64 exec, s[78:79]
    ds_write_b16 v95, v79
    s_mov_b64 exec, s[16:17]
    ds_write_b32 v5, v6 offset:20
    s_waitcnt lgkmcnt(0)
    s_mov_b64 exec, 1
    ds_add_u32 v5, v6 offset:16
    s_mov_b64 exec, -1
    s_lshl_b32 s20, s31, 1
    s_add_u32 s21, s20, 1
    s_add_u32 s22, s20, 8
    s_add_u32 s23, s20, 9
    s_add_u32 s24, s31, 16
    v_lshrrev_b32 v40, 1, v3
    v_and_b32 v41, 1, v3
    v_lshl_add_u32 v40, v40, 3, v41
    v_add_u32 v40, s20, v40
    v_mov_b32 v41, s24
    v_cmp_gt_u32 vcc, 4, v3
    v_min_u32 v47, 19, v2
    v_mul_u32_u24 v46, 264, v47
    v_cndmask_b32 v40, v41, v40, vcc
    v_mul_u32_u24 v41, 264, v40
    v_add_u32 v41, 148480, v41
    v_lshlrev_b32 v40, 2, v40
    v_add_u32 v46, 148736, v46
    v_lshlrev_b32 v47, 2, v47
    v_lshlrev_b32 v43, 3, v3
    v_lshl_add_u32 v43, v4, 1, v43
L_spin_12:
    ds_read_b32 v44, v5 offset:16
    s_waitcnt lgkmcnt(0)
    v_readfirstlane_b32 s101, v44
    s_cmp_ge_u32 s101, 4
    s_cbranch_scc0 L_retry_13
    ds_read_b32 v44, v40 offset:128
    ds_read_b32 v47, v47 offset:128
    ds_read_b32 v45, v5 offset:20
    s_waitcnt lgkmcnt(2)
    v_sub_u32 v44, v44, v41
    v_add_u32 v44, 6, v44
    v_lshrrev_b32 v44, 3, v44
    s_waitcnt lgkmcnt(0)
    v_cmp_gt_u32 vcc, v47, v46
    v_add_u32_dpp v48, v44, v44 row_shr:1 row_mask:0xf bank_mask:0xf bound_ctrl:1
    v_readfirstlane_b32 s25, v45
    s_or_b32 s64, vcc_lo, vcc_hi
    v_add_u32_dpp v48, v48, v48 row_shr:2 row_mask:0xf bank_mask:0xf bound_ctrl:1
    s_or_b32 s25, s25, s64
    s_mov_b64 s[52:53], 0
    v_add_u32_dpp v48, v48, v48 row_shr:4 row_mask:0xf bank_mask:0xf bound_ctrl:1
    v_sub_u32 v44, v48, v44
    v_lshlrev_b32 v44, 3, v44
    v_sub_u32 v44, v41, v44
    v_readlane_b32 s10, v48, 0
    v_readlane_b32 s11, v48, 1
    v_readlane_b32 s12, v48, 2
    v_readlane_b32 s13, v48, 3
    v_readlane_b32 s14, v48, 4
    v_add_u32_dpp v50, v44, v43 row_newbcast:0 row_mask:0xf bank_mask:0xf
    v_add_u32_dpp v51, v44, v43 row_newbcast:1 row_mask:0xf bank_mask:0xf
    v_add_u32_dpp v52, v44, v43 row_newbcast:2 row_mask:0xf bank_mask:0xf
    v_add_u32_dpp v53, v44, v43 row_newbcast:3 row_mask:0xf bank_mask:0xf
    v_add_u32_dpp v54, v44, v43 row_newbcast:4 row_mask:0xf bank_mask:0xf
    s_mov_b32 s50, s14
    s_cmp_gt_u32 s50, 64
    s_cselect_b32 s25, 1, s25
    v_add_u32 v56, 0, v3
    v_cmp_le_u32 s[64:65], s10, v56
    v_cmp_le_u32 s[66:67], s11, v56
    v_cmp_le_u32 s[68:69], s12, v56
    v_cmp_le_u32 s[70:71], s13, v56
    v_cndmask_b32 v56, v50, v51, s[64:65]
    v_cndmask_b32 v56, v56, v52, s[66:67]
    v_cndmask_b32 v56, v56, v53, s[68:69]
    v_cndmask_b32 v56, v56, v54, s[70:71]
    ds_read_u16 v56, v56 offset:0
    v_add_u32 v57, 16, v3
    v_cmp_le_u32 s[64:65], s10, v57
    v_cmp_le_u32 s[66:67], s11, v57
    v_cmp_le_u32 s[68:69], s12, v57
    v_cmp_le_u32 s[70:71], s13, v57
    v_cndmask_b32 v57, v50, v51, s[64:65]
    v_cndmask_b32 v57, v57, v52, s[66:67]
    v_cndmask_b32 v57, v57, v53, s[68:69]
    v_cndmask_b32 v57, v57, v54, s[70:71]
    ds_read_u16 v57, v57 offset:128
    v_add_u32 v58, 32, v3
    v_cmp_le_u32 s[64:65], s10, v58
    v_cmp_le_u32 s[66:67], s11, v58
    v_cmp_le_u32 s[68:69], s12, v58
    v_cmp_le_u32 s[70:71], s13, v58
    v_cndmask_b32 v58, v50, v51, s[64:65]
    v_cndmask_b32 v58, v58, v52, s[66:67]
    v_cndmask_b32 v58, v58, v53, s[68:69]
    v_cndmask_b32 v58, v58, v54, s[70:71]
    ds_read_u16 v58, v58 offset:256
    v_add_u32 v59, 48, v3
    v_cmp_le_u32 s[64:65], s10, v59
    v_cmp_le_u32 s[66:67], s11, v59
    v_cmp_le_u32 s[68:69], s12, v59
    v_cmp_le_u32 s[70:71], s13, v59
    v_cndmask_b32 v59, v50, v51, s[64:65]
    v_cndmask_b32 v59, v59, v52, s[66:67]
    v_cndmask_b32 v59, v59, v53, s[68:69]
    v_cndmask_b32 v59, v59, v54, s[70:71]
    ds_read_u16 v59, v59 offset:384
    s_waitcnt lgkmcnt(3)
    v_and_b32 v32, 0x7ffe, v56
    ds_read_u16 v33, v32 offset:62464
    v_lshlrev_b32 v32, 8, v32
    v_lshlrev_b32 v56, 4, v56
    s_waitcnt lgkmcnt(3)
    v_and_b32 v34, 0x7ffe, v57
    ds_read_u16 v35, v34 offset:62464
    v_lshlrev_b32 v34, 8, v34
    v_lshlrev_b32 v57, 4, v57
    s_waitcnt lgkmcnt(3)
    v_and_b32 v36, 0x7ffe, v58
    ds_read_u16 v37, v36 offset:62464
    v_lshlrev_b32 v36, 8, v36
    v_lshlrev_b32 v58, 4, v58
    s_waitcnt lgkmcnt(3)
    v_and_b32 v38, 0x7ffe, v59
    ds_read_u16 v39, v38 offset:62464
    v_lshlrev_b32 v38, 8, v38
    v_lshlrev_b32 v59, 4, v59
    v_add_u32_dpp v11, v32, v7 row_newbcast:0 row_mask:0xf bank_mask:0xf
    buffer_load_dwordx4 v[112:115], v11, s[32:35], 0 offen offset:0
    buffer_load_dwordx4 v[116:119], v11, s[32:35], 0 offen offset:256
    v_add_u32_dpp v11, v32, v7 row_newbcast:1 row_mask:0xf bank_mask:0xf
    buffer_load_dwordx4 v[120:123], v11, s[32:35], 0 offen offset:0
    buffer_load_dwordx4 v[124:127], v11, s[32:35], 0 offen offset:256
    v_add_u32_dpp v11, v32, v7 row_newbcast:2 row_mask:0xf bank_mask:0xf
    buffer_load_dwordx4 v[128:131], v11, s[32:35], 0 offen offset:0
    buffer_load_dwordx4 v[132:135], v11, s[32:35], 0 offen offset:256
    v_add_u32_dpp v11, v32, v7 row_newbcast:3 row_mask:0xf bank_mask:0xf
    buffer_load_dwordx4 v[136:139], v11, s[32:35], 0 offen offset:0
    buffer_load_dwordx4 v[140:143], v11, s[32:35], 0 offen offset:256
    s_sub_u32 s64, s10, 1
    s_bitset1_b64 s[52:53], s64
    s_and_b32 s65, s20, 7
    s_lshl_b32 s65, s65, 5
    s_lshl_b32 s15, s20, 10
    s_or_b32 s15, s15, s65
    s_sub_u32 s64, s11, 1
    s_bitset1_b64 s[52:53], s64
    s_and_b32 s65, s21, 7
    s_lshl_b32 s65, s65, 5
    s_lshl_b32 s16, s21, 10
    s_or_b32 s16, s16, s65
    s_sub_u32 s64, s12, 1
    s_bitset1_b64 s[52:53], s64
    s_and_b32 s65, s22, 7
    s_lshl_b32 s65, s65, 5
    s_lshl_b32 s17, s22, 10
    s_or_b32 s17, s17, s65
    s_sub_u32 s64, s13, 1
    s_bitset1_b64 s[52:53], s64
    s_and_b32 s65, s23, 7
    s_lshl_b32 s65, s65, 5
    s_lshl_b32 s18, s23, 10
    s_or_b32 s18, s18, s65
    s_sub_u32 s64, s14, 1
    s_bitset1_b64 s[52:53], s64
    s_and_b32 s65, s24, 7
    s_lshl_b32 s65, s65, 5
    s_lshl_b32 s19, s24, 10
    s_or_b32 s19, s19, s65
    s_sub_u32 s64, s50, 9
    s_bitset1_b64 s[52:53], s64
    v_lshrrev_b32 v44, 1, v4
    v_mul_u32_u24 v44, 528, v44
    v_xor_b32 v44, v44, v7
    v_and_b32 v45, 1, v4
    v_lshl_or_b32 v2, v45, 3, v44
    v_xor_b32 v60, s15, v7
    v_xor_b32 v62, s16, v7
    v_xor_b32 v64, s19, v7
    v_xor_b32 v61, 528, v60
    v_xor_b32 v63, 528, v62
    v_xor_b32 v65, 528, v64
    s_mul_i32 s64, s2, 80
    s_add_u32 s64, s64, 62464
    v_and_b32 v45, 2, v4
    v_add_u32 v0, s64, v45
    s_lshl_b32 s64, s20, 2
    v_add_u32 v45, s64, v0
    v_mov_b32 v1, 0
    ds_read_u16_d16_hi v1, v45
    s_getpc_b64 s[56:57]
L_tabpc:
    s_add_u32 s56, s56, L_wtab-L_tabpc
    s_addc_u32 s57, s57, 0
    s_mov_b32 s26, 0
    s_mov_b32 s48, 0
    v_and_b32 v47, 8, v3
    v_lshlrev_b32 v47, 1, v47
    s_mov_b32 s66, 0x22222222
    s_mov_b32 s67, 0x22222222
    s_mov_b32 s68, 0x44444444
    s_mov_b32 s69, 0x44444444
    v_mov_b32 v66, 0
    v_mov_b32 v67, 0
    v_mov_b32 v68, 0
    v_mov_b32 v69, 0
    v_mov_b32 v70, 0
    v_mov_b32 v71, 0
    v_mov_b32 v72, 0
    v_mov_b32 v73, 0
    v_mov_b32 v74, 0
    v_mov_b32 v75, 0
    v_mov_b32 v16, 0
    v_mov_b32 v17, 0
    v_mov_b32 v18, 0
    v_mov_b32 v19, 0
    v_mov_b32 v20, 0
    v_mov_b32 v21, 0
    v_mov_b32 v22, 0
    v_mov_b32 v23, 0
    s_waitcnt lgkmcnt(0)
    v_lshlrev_b32 v33, v56, v33
    v_lshlrev_b32 v35, v57, v35
    v_lshlrev_b32 v37, v58, v37
    v_lshlrev_b32 v39, v59, v39
    s_barrier
    ds_read_b128 v[76:79], v60 offset:21504
    ds_read_b128 v[80:83], v60 offset:21760
    ds_read_b128 v[84:87], v61 offset:21504
    ds_read_b128 v[88:91], v61 offset:21760
    s_waitcnt lgkmcnt(2)
    v_dot2c_f32_bf16 v66, v176, v76
    v_dot2c_f32_bf16 v66, v177, v77
    v_dot2c_f32_bf16 v66, v178, v78
    v_dot2c_f32_bf16 v66, v179, v79
    v_dot2c_f32_bf16 v66, v180, v80
    v_dot2c_f32_bf16 v66, v181, v81
    v_dot2c_f32_bf16 v66, v182, v82
    v_dot2c_f32_bf16 v66, v183, v83
    ds_read_b128 v[76:79], v62 offset:21504
    ds_read_b128 v[80:83], v62 offset:21760
    s_waitcnt lgkmcnt(2)
    v_dot2c_f32_bf16 v67, v184, v84
    v_dot2c_f32_bf16 v67, v185, v85
    v_dot2c_f32_bf16 v67, v186, v86
    v_dot2c_f32_bf16 v67, v187, v87
    v_dot2c_f32_bf16 v67, v188, v88
    v_dot2c_f32_bf16 v67, v189, v89
    v_dot2c_f32_bf16 v67, v190, v90
    v_dot2c_f32_bf16 v67, v191, v91
    v_add_u32_dpp v11, v32, v7 row_newbcast:4 row_mask:0xf bank_mask:0xf
    buffer_load_dwordx4 v[144:147], v11, s[32:35], 0 offen offset:0
    buffer_load_dwordx4 v[148:151], v11, s[32:35], 0 offen offset:256
    ds_read_b128 v[84:87], v63 offset:21504
    ds_read_b128 v[88:91], v63 offset:21760
    s_waitcnt lgkmcnt(2)
    v_dot2c_f32_bf16 v68, v192, v76
    v_dot2c_f32_bf16 v68, v193, v77
    v_dot2c_f32_bf16 v68, v194, v78
    v_dot2c_f32_bf16 v68, v195, v79
    v_dot2c_f32_bf16 v68, v196, v80
    v_dot2c_f32_bf16 v68, v197, v81
    v_dot2c_f32_bf16 v68, v198, v82
    v_dot2c_f32_bf16 v68, v199, v83
    v_add_f32_dpp v66, v66, v66 row_ror:8 row_mask:0xf bank_mask:0x3
    v_add_f32_dpp v66, v67, v67 row_ror:8 row_mask:0xf bank_mask:0xc
    ds_read_b128 v[76:79], v60 offset:29696
    ds_read_b128 v[80:83], v60 offset:29952
    s_waitcnt lgkmcnt(2)
    v_dot2c_f32_bf16 v69, v200, v84
    v_dot2c_f32_bf16 v69, v201, v85
    v_dot2c_f32_bf16 v69, v202, v86
    v_dot2c_f32_bf16 v69, v203, v87
    v_dot2c_f32_bf16 v69, v204, v88
    v_dot2c_f32_bf16 v69, v205, v89
    v_dot2c_f32_bf16 v69, v206, v90
    v_dot2c_f32_bf16 v69, v207, v91
    v_add_u32_dpp v11, v32, v7 row_newbcast:5 row_mask:0xf bank_mask:0xf
    buffer_load_dwordx4 v[152:155], v11, s[32:35], 0 offen offset:0
    buffer_load_dwordx4 v[156:159], v11, s[32:35], 0 offen offset:256
    ds_read_b128 v[84:87], v61 offset:29696
    ds_read_b128 v[88:91], v61 offset:29952
    s_waitcnt lgkmcnt(2)
    v_dot2c_f32_bf16 v70, v208, v76
    v_dot2c_f32_bf16 v70, v209, v77
    v_dot2c_f32_bf16 v70, v210, v78
    v_dot2c_f32_bf16 v70, v211, v79
    v_dot2c_f32_bf16 v70, v212, v80
    v_dot2c_f32_bf16 v70, v213, v81
    v_dot2c_f32_bf16 v70, v214, v82
    v_dot2c_f32_bf16 v70, v215, v83
    v_add_f32_dpp v68, v68, v68 row_ror:8 row_mask:0xf bank_mask:0x3
    v_add_f32_dpp v68, v69, v69 row_ror:8 row_mask:0xf bank_mask:0xc
    ds_read_b128 v[76:79], v62 offset:29696
    ds_read_b128 v[80:83], v62 offset:29952
    s_waitcnt lgkmcnt(2)
    v_dot2c_f32_bf16 v71, v216, v84
    v_dot2c_f32_bf16 v71, v217, v85
    v_dot2c_f32_bf16 v71, v218, v86
    v_dot2c_f32_bf16 v71, v219, v87
    v_dot2c_f32_bf16 v71, v220, v88
    v_dot2c_f32_bf16 v71, v221, v89
    v_dot2c_f32_bf16 v71, v222, v90
    v_dot2c_f32_bf16 v71, v223, v91
    v_add_f32_dpp v66, v66, v66 row_half_mirror row_mask:0xf bank_mask:0x5
    v_add_f32_dpp v66, v68, v68 row_half_mirror row_mask:0xf bank_mask:0xa
    v_add_u32_dpp v11, v32, v7 row_newbcast:6 row_mask:0xf bank_mask:0xf
    buffer_load_dwordx4 v[160:163], v11, s[32:35], 0 offen offset:0
    buffer_load_dwordx4 v[164:167], v11, s[32:35], 0 offen offset:256
    ds_read_b128 v[84:87], v63 offset:29696
    ds_read_b128 v[88:91], v63 offset:29952
    s_waitcnt lgkmcnt(2)
    v_dot2c_f32_bf16 v72, v224, v76
    v_dot2c_f32_bf16 v72, v225, v77
    v_dot2c_f32_bf16 v72, v226, v78
    v_dot2c_f32_bf16 v72, v227, v79
    v_dot2c_f32_bf16 v72, v228, v80
    v_dot2c_f32_bf16 v72, v229, v81
    v_dot2c_f32_bf16 v72, v230, v82
    v_dot2c_f32_bf16 v72, v231, v83
    v_add_f32_dpp v70, v70, v70 row_ror:8 row_mask:0xf bank_mask:0x3
    v_add_f32_dpp v70, v71, v71 row_ror:8 row_mask:0xf bank_mask:0xc
    ds_read_b128 v[76:79], v64 offset:21504
    ds_read_b128 v[80:83], v64 offset:21760
    s_waitcnt lgkmcnt(2)
    v_dot2c_f32_bf16 v73, v232, v84
    v_dot2c_f32_bf16 v73, v233, v85
    v_dot2c_f32_bf16 v73, v234, v86
    v_dot2c_f32_bf16 v73, v235, v87
    v_dot2c_f32_bf16 v73, v236, v88
    v_dot2c_f32_bf16 v73, v237, v89
    v_dot2c_f32_bf16 v73, v238, v90
    v_dot2c_f32_bf16 v73, v239, v91
    v_add_u32_dpp v11, v32, v7 row_newbcast:7 row_mask:0xf bank_mask:0xf
    buffer_load_dwordx4 v[168:171], v11, s[32:35], 0 offen offset:0
    buffer_load_dwordx4 v[172:175], v11, s[32:35], 0 offen offset:256
    ds_read_b128 v[84:87], v65 offset:21504
    ds_read_b128 v[88:91], v65 offset:21760
    s_waitcnt lgkmcnt(2)
    v_dot2c_f32_bf16 v74, v240, v76
    v_dot2c_f32_bf16 v74, v241, v77
    v_dot2c_f32_bf16 v74, v242, v78
    v_dot2c_f32_bf16 v74, v243, v79
    v_dot2c_f32_bf16 v74, v244, v80
    v_dot2c_f32_bf16 v74, v245, v81
    v_dot2c_f32_bf16 v74, v246, v82
    v_dot2c_f32_bf16 v74, v247, v83
    v_add_f32_dpp v72, v72, v72 row_ror:8 row_mask:0xf bank_mask:0x3
    v_add_f32_dpp v72, v73, v73 row_ror:8 row_mask:0xf bank_mask:0xc
    s_waitcnt lgkmcnt(0)
    v_dot2c_f32_bf16 v75, v248, v84
    v_dot2c_f32_bf16 v75, v249, v85
    v_dot2c_f32_bf16 v75, v250, v86
    v_dot2c_f32_bf16 v75, v251, v87
    v_dot2c_f32_bf16 v75, v252, v88
    v_dot2c_f32_bf16 v75, v253, v89
    v_dot2c_f32_bf16 v75, v254, v90
    v_dot2c_f32_bf16 v75, v255, v91
    v_add_f32_dpp v70, v70, v70 row_half_mirror row_mask:0xf bank_mask:0x5
    v_add_f32_dpp v70, v72, v72 row_half_mirror row_mask:0xf bank_mask:0xa
    v_add_f32_dpp v66, v66, v66 quad_perm:[1,0,3,2] row_mask:0xf bank_mask:0xf
    s_nop 0
    v_add_f32_dpp v74, v74, v74 row_ror:8 row_mask:0xf bank_mask:0x3
    v_add_f32_dpp v74, v75, v75 row_ror:8 row_mask:0xf bank_mask:0xc
    v_add_f32_dpp v70, v70, v70 quad_perm:[1,0,3,2] row_mask:0xf bank_mask:0xf
    v_add_f32_dpp v66, v66, v66 quad_perm:[2,3,0,1] row_mask:0xf bank_mask:0xf
    v_add_f32_dpp v74, v74, v74 row_half_mirror row_mask:0xf bank_mask:0x5
    v_add_f32_dpp v70, v70, v70 quad_perm:[2,3,0,1] row_mask:0xf bank_mask:0xf
    s_nop 0
    v_add_f32_dpp v74, v74, v74 quad_perm:[1,0,3,2] row_mask:0xf bank_mask:0xf
    v_cndmask_b32 v66, v66, v70, s[66:67]
    s_nop 0
    v_add_f32_dpp v74, v74, v74 quad_perm:[2,3,0,1] row_mask:0xf bank_mask:0xf
    v_cndmask_b32 v66, v66, v74, s[68:69]
    v_mul_f32 v66, 0x3db8aa3b, v66
    v_exp_f32 v66, v66
    s_nop 0
    v_mov_b32 v44, v66
    v_mov_b32 v45, v66
    s_nop 1
    v_permlane32_swap_b32 v44, v45
    v_add_f32 v44, v44, v45
    v_mov_b32 v45, v44
    s_nop 1
    v_permlane16_swap_b32 v44, v45
    v_add_f32 v44, v44, v45
    v_add_f32 v44, 0x3089705f, v44
    v_rcp_f32 v44, v44
    s_nop 0
    v_mul_f32 v66, v66, v44
    v_cvt_pk_bf16_f32 v66, v66, 0
    v_lshlrev_b32 v66, v47, v66
    s_nop 1
    v_mov_b32_dpp v10, v66 row_newbcast:0 row_mask:0xf bank_mask:0xf
    v_perm_b32 v24, v10, v10, v12
    v_perm_b32 v25, v10, v10, v13
    v_perm_b32 v26, v10, v10, v14
    v_perm_b32 v27, v10, v10, v15
    v_mov_b32_dpp v10, v66 row_newbcast:8 row_mask:0xf bank_mask:0xf
    v_perm_b32 v28, v10, v10, v12
    v_mfma_f32_16x16x32_bf16 v[68:71], v[24:27], v[176:179], 0
    v_perm_b32 v29, v10, v10, v13
    v_mfma_f32_16x16x32_bf16 v[72:75], v[24:27], v[180:183], 0
    v_perm_b32 v30, v10, v10, v14
    v_perm_b32 v31, v10, v10, v15
    v_mov_b32_dpp v10, v66 row_newbcast:4 row_mask:0xf bank_mask:0xf
    v_perm_b32 v24, v10, v10, v12
    v_mfma_f32_16x16x32_bf16 v[68:71], v[28:31], v[184:187], v[68:71]
    v_perm_b32 v25, v10, v10, v13
    v_mfma_f32_16x16x32_bf16 v[72:75], v[28:31], v[188:191], v[72:75]
    v_perm_b32 v26, v10, v10, v14
    v_perm_b32 v27, v10, v10, v15
    v_mov_b32_dpp v10, v66 row_newbcast:12 row_mask:0xf bank_mask:0xf
    v_perm_b32 v28, v10, v10, v12
    v_mfma_f32_16x16x32_bf16 v[76:79], v[24:27], v[192:195], 0
    v_perm_b32 v29, v10, v10, v13
    v_mfma_f32_16x16x32_bf16 v[80:83], v[24:27], v[196:199], 0
    v_perm_b32 v30, v10, v10, v14
    v_perm_b32 v31, v10, v10, v15
    v_mov_b32_dpp v10, v66 row_newbcast:1 row_mask:0xf bank_mask:0xf
    v_perm_b32 v24, v10, v10, v12
    v_mfma_f32_16x16x32_bf16 v[76:79], v[28:31], v[200:203], v[76:79]
    v_perm_b32 v25, v10, v10, v13
    v_mfma_f32_16x16x32_bf16 v[80:83], v[28:31], v[204:207], v[80:83]
    v_perm_b32 v26, v10, v10, v14
    v_perm_b32 v27, v10, v10, v15
    v_xor_b32 v45, s15, v2
    v_cvt_pk_bf16_f32 v68, v68, v69
    v_cvt_pk_bf16_f32 v69, v70, v71
    ds_write_b64 v45, v[68:69] offset:1024
    v_cvt_pk_bf16_f32 v72, v72, v73
    v_cvt_pk_bf16_f32 v73, v74, v75
    ds_write_b64 v45, v[72:73] offset:1280
    v_mov_b32_dpp v10, v66 row_newbcast:9 row_mask:0xf bank_mask:0xf
    v_perm_b32 v28, v10, v10, v12
    v_mfma_f32_16x16x32_bf16 v[84:87], v[24:27], v[208:211], 0
    v_perm_b32 v29, v10, v10, v13
    v_mfma_f32_16x16x32_bf16 v[88:91], v[24:27], v[212:215], 0
    v_perm_b32 v30, v10, v10, v14
    v_perm_b32 v31, v10, v10, v15
    v_mov_b32_dpp v10, v66 row_newbcast:5 row_mask:0xf bank_mask:0xf
    v_perm_b32 v24, v10, v10, v12
    v_mfma_f32_16x16x32_bf16 v[84:87], v[28:31], v[216:219], v[84:87]
    v_perm_b32 v25, v10, v10, v13
    v_mfma_f32_16x16x32_bf16 v[88:91], v[28:31], v[220:223], v[88:91]
    v_perm_b32 v26, v10, v10, v14
    v_perm_b32 v27, v10, v10, v15
    v_xor_b32 v45, s16, v2
    v_cvt_pk_bf16_f32 v76, v76, v77
    v_cvt_pk_bf16_f32 v77, v78, v79
    ds_write_b64 v45, v[76:77] offset:1024
    v_cvt_pk_bf16_f32 v80, v80, v81
    v_cvt_pk_bf16_f32 v81, v82, v83
    ds_write_b64 v45, v[80:81] offset:1280
    v_mov_b32_dpp v10, v66 row_newbcast:13 row_mask:0xf bank_mask:0xf
    v_perm_b32 v28, v10, v10, v12
    v_mfma_f32_16x16x32_bf16 v[92:95], v[24:27], v[224:227], 0
    v_perm_b32 v29, v10, v10, v13
    v_mfma_f32_16x16x32_bf16 v[96:99], v[24:27], v[228:231], 0
    v_perm_b32 v30, v10, v10, v14
    v_perm_b32 v31, v10, v10, v15
    v_mov_b32_dpp v10, v66 row_newbcast:2 row_mask:0xf bank_mask:0xf
    v_perm_b32 v24, v10, v10, v12
    v_mfma_f32_16x16x32_bf16 v[92:95], v[28:31], v[232:235], v[92:95]
    v_perm_b32 v25, v10, v10, v13
    v_mfma_f32_16x16x32_bf16 v[96:99], v[28:31], v[236:239], v[96:99]
    v_perm_b32 v26, v10, v10, v14
    v_perm_b32 v27, v10, v10, v15
    v_xor_b32 v45, s17, v2
    v_cvt_pk_bf16_f32 v84, v84, v85
    v_cvt_pk_bf16_f32 v85, v86, v87
    ds_write_b64 v45, v[84:85] offset:1024
    v_cvt_pk_bf16_f32 v88, v88, v89
    v_cvt_pk_bf16_f32 v89, v90, v91
    ds_write_b64 v45, v[88:89] offset:1280
    v_mov_b32_dpp v10, v66 row_newbcast:10 row_mask:0xf bank_mask:0xf
    v_perm_b32 v28, v10, v10, v12
    v_mfma_f32_16x16x32_bf16 v[100:103], v[24:27], v[240:243], 0
    v_perm_b32 v29, v10, v10, v13
    v_mfma_f32_16x16x32_bf16 v[104:107], v[24:27], v[244:247], 0
    v_perm_b32 v30, v10, v10, v14
    v_perm_b32 v31, v10, v10, v15
    v_mov_b32_dpp v10, v33 row_newbcast:0 row_mask:0xf bank_mask:0xf
    v_perm_b32 v24, v10, v10, v12
    v_mfma_f32_16x16x32_bf16 v[100:103], v[28:31], v[248:251], v[100:103]
    v_perm_b32 v25, v10, v10, v13
    v_mfma_f32_16x16x32_bf16 v[104:107], v[28:31], v[252:255], v[104:107]
    v_perm_b32 v26, v10, v10, v14
    v_perm_b32 v27, v10, v10, v15
    v_xor_b32 v45, s18, v2
    v_cvt_pk_bf16_f32 v92, v92, v93
    v_cvt_pk_bf16_f32 v93, v94, v95
    ds_write_b64 v45, v[92:93] offset:1024
    v_cvt_pk_bf16_f32 v96, v96, v97
    v_cvt_pk_bf16_f32 v97, v98, v99
    ds_write_b64 v45, v[96:97] offset:1280
    v_xor_b32 v45, s19, v2
    v_cvt_pk_bf16_f32 v100, v100, v101
    v_cvt_pk_bf16_f32 v101, v102, v103
    ds_write_b64 v45, v[100:101] offset:1024
    v_cvt_pk_bf16_f32 v104, v104, v105
    v_cvt_pk_bf16_f32 v105, v106, v107
    ds_write_b64 v45, v[104:105] offset:1280
    s_waitcnt lgkmcnt(0)
    s_barrier
    s_cmp_lg_u32 s25, 0
    s_cbranch_scc1 L_slow
    s_mov_b32 s49, 0
    s_call_b64 s[54:55], L_event
    s_cbranch_scc1 L_dr0
L_st0:
    s_waitcnt vmcnt(14)
    v_mfma_f32_16x16x32_bf16 v[16:19], v[24:27], v[112:115], v[16:19]
    v_mov_b32_dpp v10, v33 row_newbcast:1 row_mask:0xf bank_mask:0xf
    v_perm_b32 v28, v10, v10, v12
    v_mfma_f32_16x16x32_bf16 v[20:23], v[24:27], v[116:119], v[20:23]
    v_perm_b32 v29, v10, v10, v13
    v_perm_b32 v30, v10, v10, v14
    v_perm_b32 v31, v10, v10, v15
    v_add_u32_dpp v11, v32, v7 row_newbcast:8 row_mask:0xf bank_mask:0xf
    buffer_load_dwordx4 v[112:115], v11, s[32:35], 0 offen offset:0
    buffer_load_dwordx4 v[116:119], v11, s[32:35], 0 offen offset:256
    s_bitcmp1_b32 s52, 0
    s_cbranch_scc1 L_stub0
L_st1:
    s_waitcnt vmcnt(14)
    v_mfma_f32_16x16x32_bf16 v[16:19], v[28:31], v[120:123], v[16:19]
    v_mov_b32_dpp v10, v33 row_newbcast:2 row_mask:0xf bank_mask:0xf
    v_perm_b32 v24, v10, v10, v12
    v_mfma_f32_16x16x32_bf16 v[20:23], v[28:31], v[124:127], v[20:23]
    v_perm_b32 v25, v10, v10, v13
    v_perm_b32 v26, v10, v10, v14
    v_perm_b32 v27, v10, v10, v15
    v_add_u32_dpp v11, v32, v7 row_newbcast:9 row_mask:0xf bank_mask:0xf
    buffer_load_dwordx4 v[120:123], v11, s[32:35], 0 offen offset:0
    buffer_load_dwordx4 v[124:127], v11, s[32:35], 0 offen offset:256
    s_bitcmp1_b32 s52, 1
    s_cbranch_scc1 L_stub1
L_st2:
    s_waitcnt vmcnt(14)
    v_mfma_f32_16x16x32_bf16 v[16:19], v[24:27], v[128:131], v[16:19]
    v_mov_b32_dpp v10, v33 row_newbcast:3 row_mask:0xf bank_mask:0xf
    v_perm_b32 v28, v10, v10, v12
    v_mfma_f32_16x16x32_bf16 v[20:23], v[24:27], v[132:135], v[20:23]
    v_perm_b32 v29, v10, v10, v13
    v_perm_b32 v30, v10, v10, v14
    v_perm_b32 v31, v10, v10, v15
    v_add_u32_dpp v11, v32, v7 row_newbcast:10 row_mask:0xf bank_mask:0xf
    buffer_load_dwordx4 v[128:131], v11, s[32:35], 0 offen offset:0
    buffer_load_dwordx4 v[132:135], v11, s[32:35], 0 offen offset:256
    s_bitcmp1_b32 s52, 2
    s_cbranch_scc1 L_stub2
L_st3:
    s_waitcnt vmcnt(14)
    v_mfma_f32_16x16x32_bf16 v[16:19], v[28:31], v[136:139], v[16:19]
    v_mov_b32_dpp v10, v33 row_newbcast:4 row_mask:0xf bank_mask:0xf
    v_perm_b32 v24, v10, v10, v12
    v_mfma_f32_16x16x32_bf16 v[20:23], v[28:31], v[140:143], v[20:23]
    v_perm_b32 v25, v10, v10, v13
    v_perm_b32 v26, v10, v10, v14
    v_perm_b32 v27, v10, v10, v15
    v_add_u32_dpp v11, v32, v7 row_newbcast:11 row_mask:0xf bank_mask:0xf
    buffer_load_dwordx4 v[136:139], v11, s[32:35], 0 offen offset:0
    buffer_load_dwordx4 v[140:143], v11, s[32:35], 0 offen offset:256
    s_bitcmp1_b32 s52, 3
    s_cbranch_scc1 L_stub3
L_st4:
    s_waitcnt vmcnt(14)
    v_mfma_f32_16x16x32_bf16 v[16:19], v[24:27], v[144:147], v[16:19]
    v_mov_b32_dpp v10, v33 row_newbcast:5 row_mask:0xf bank_mask:0xf
    v_perm_b32 v28, v10, v10, v12
    v_mfma_f32_16x16x32_bf16 v[20:23], v[24:27], v[148:151], v[20:23]
    v_perm_b32 v29, v10, v10, v13
    v_perm_b32 v30, v10, v10, v14
    v_perm_b32 v31, v10, v10, v15
    v_add_u32_dpp v11, v32, v7 row_newbcast:12 row_mask:0xf bank_mask:0xf
    buffer_load_dwordx4 v[144:147], v11, s[32:35], 0 offen offset:0
    buffer_load_dwordx4 v[148:151], v11, s[32:35], 0 offen offset:256
    s_bitcmp1_b32 s52, 4
    s_cbranch_scc1 L_stub4
L_st5:
    s_waitcnt vmcnt(14)
    v_mfma_f32_16x16x32_bf16 v[16:19], v[28:31], v[152:155], v[16:19]
    v_mov_b32_dpp v10, v33 row_newbcast:6 row_mask:0xf bank_mask:0xf
    v_perm_b32 v24, v10, v10, v12
    v_mfma_f32_16x16x32_bf16 v[20:23], v[28:31], v[156:159], v[20:23]
    v_perm_b32 v25, v10, v10, v13
    v_perm_b32 v26, v10, v10, v14
    v_perm_b32 v27, v10, v10, v15
    v_add_u32_dpp v11, v32, v7 row_newbcast:13 row_mask:0xf bank_mask:0xf
    buffer_load_dwordx4 v[152:155], v11, s[32:35], 0 offen offset:0
    buffer_load_dwordx4 v[156:159], v11, s[32:35], 0 offen offset:256
    s_bitcmp1_b32 s52, 5
    s_cbranch_scc1 L_stub5
L_st6:
    s_waitcnt vmcnt(14)
    v_mfma_f32_16x16x32_bf16 v[16:19], v[24:27], v[160:163], v[16:19]
    v_mov_b32_dpp v10, v33 row_newbcast:7 row_mask:0xf bank_mask:0xf
    v_perm_b32 v28, v10, v10, v12
    v_mfma_f32_16x16x32_bf16 v[20:23], v[24:27], v[164:167], v[20:23]
    v_perm_b32 v29, v10, v10, v13
    v_perm_b32 v30, v10, v10, v14
    v_perm_b32 v31, v10, v10, v15
    v_add_u32_dpp v11, v32, v7 row_newbcast:14 row_mask:0xf bank_mask:0xf
    buffer_load_dwordx4 v[160:163], v11, s[32:35], 0 offen offset:0
    buffer_load_dwordx4 v[164:167], v11, s[32:35], 0 offen offset:256
    s_bitcmp1_b32 s52, 6
    s_cbranch_scc1 L_stub6
L_st7:
    s_waitcnt vmcnt(14)
    v_mfma_f32_16x16x32_bf16 v[16:19], v[28:31], v[168:171], v[16:19]
    v_mov_b32_dpp v10, v33 row_newbcast:8 row_mask:0xf bank_mask:0xf
    v_perm_b32 v24, v10, v10, v12
    v_mfma_f32_16x16x32_bf16 v[20:23], v[28:31], v[172:175], v[20:23]
    v_perm_b32 v25, v10, v10, v13
    v_perm_b32 v26, v10, v10, v14
    v_perm_b32 v27, v10, v10, v15
    v_add_u32_dpp v11, v32, v7 row_newbcast:15 row_mask:0xf bank_mask:0xf
    buffer_load_dwordx4 v[168:171], v11, s[32:35], 0 offen offset:0
    buffer_load_dwordx4 v[172:175], v11, s[32:35], 0 offen offset:256
    s_bitcmp1_b32 s52, 7
    s_cbranch_scc1 L_stub7
L_st8:
    s_waitcnt vmcnt(14)
    v_mfma_f32_16x16x32_bf16 v[16:19], v[24:27], v[112:115], v[16:19]
    v_mov_b32_dpp v10, v33 row_newbcast:9 row_mask:0xf bank_mask:0xf
    v_perm_b32 v28, v10, v10, v12
    v_mfma_f32_16x16x32_bf16 v[20:23], v[24:27], v[116:119], v[20:23]
    v_perm_b32 v29, v10, v10, v13
    v_perm_b32 v30, v10, v10, v14
    v_perm_b32 v31, v10, v10, v15
    v_add_u32_dpp v11, v34, v7 row_newbcast:0 row_mask:0xf bank_mask:0xf
    buffer_load_dwordx4 v[112:115], v11, s[32:35], 0 offen offset:0
    buffer_load_dwordx4 v[116:119], v11, s[32:35], 0 offen offset:256
    s_bitcmp1_b32 s52, 8
    s_cbranch_scc1 L_stub8
L_st9:
    s_waitcnt vmcnt(14)
    v_mfma_f32_16x16x32_bf16 v[16:19], v[28:31], v[120:123], v[16:19]
    v_mov_b32_dpp v10, v33 row_newbcast:10 row_mask:0xf bank_mask:0xf
    v_perm_b32 v24, v10, v10, v12
    v_mfma_f32_16x16x32_bf16 v[20:23], v[28:31], v[124:127], v[20:23]
    v_perm_b32 v25, v10, v10, v13
    v_perm_b32 v26, v10, v10, v14
    v_perm_b32 v27, v10, v10, v15
    v_add_u32_dpp v11, v34, v7 row_newbcast:1 row_mask:0xf bank_mask:0xf
    buffer_load_dwordx4 v[120:123], v11, s[32:35], 0 offen offset:0
    buffer_load_dwordx4 v[124:127], v11, s[32:35], 0 offen offset:256
    s_bitcmp1_b32 s52, 9
    s_cbranch_scc1 L_stub9
L_st10:
    s_waitcnt vmcnt(14)
    v_mfma_f32_16x16x32_bf16 v[16:19], v[24:27], v[128:131], v[16:19]
    v_mov_b32_dpp v10, v33 row_newbcast:11 row_mask:0xf bank_mask:0xf
    v_perm_b32 v28, v10, v10, v12
    v_mfma_f32_16x16x32_bf16 v[20:23], v[24:27], v[132:135], v[20:23]
    v_perm_b32 v29, v10, v10, v13
    v_perm_b32 v30, v10, v10, v14
    v_perm_b32 v31, v10, v10, v15
    v_add_u32_dpp v11, v34, v7 row_newbcast:2 row_mask:0xf bank_mask:0xf
    buffer_load_dwordx4 v[128:131], v11, s[32:35], 0 offen offset:0
    buffer_load_dwordx4 v[132:135], v11, s[32:35], 0 offen offset:256
    s_bitcmp1_b32 s52, 10
    s_cbranch_scc1 L_stub10
L_st11:
    s_waitcnt vmcnt(14)
    v_mfma_f32_16x16x32_bf16 v[16:19], v[28:31], v[136:139], v[16:19]
    v_mov_b32_dpp v10, v33 row_newbcast:12 row_mask:0xf bank_mask:0xf
    v_perm_b32 v24, v10, v10, v12
    v_mfma_f32_16x16x32_bf16 v[20:23], v[28:31], v[140:143], v[20:23]
    v_perm_b32 v25, v10, v10, v13
    v_perm_b32 v26, v10, v10, v14
    v_perm_b32 v27, v10, v10, v15
    v_add_u32_dpp v11, v34, v7 row_newbcast:3 row_mask:0xf bank_mask:0xf
    buffer_load_dwordx4 v[136:139], v11, s[32:35], 0 offen offset:0
    buffer_load_dwordx4 v[140:143], v11, s[32:35], 0 offen offset:256
    s_bitcmp1_b32 s52, 11
    s_cbranch_scc1 L_stub11
L_st12:
    s_waitcnt vmcnt(14)
    v_mfma_f32_16x16x32_bf16 v[16:19], v[24:27], v[144:147], v[16:19]
    v_mov_b32_dpp v10, v33 row_newbcast:13 row_mask:0xf bank_mask:0xf
    v_perm_b32 v28, v10, v10, v12
    v_mfma_f32_16x16x32_bf16 v[20:23], v[24:27], v[148:151], v[20:23]
    v_perm_b32 v29, v10, v10, v13
    v_perm_b32 v30, v10, v10, v14
    v_perm_b32 v31, v10, v10, v15
    v_add_u32_dpp v11, v34, v7 row_newbcast:4 row_mask:0xf bank_mask:0xf
    buffer_load_dwordx4 v[144:147], v11, s[32:35], 0 offen offset:0
    buffer_load_dwordx4 v[148:151], v11, s[32:35], 0 offen offset:256
    s_bitcmp1_b32 s52, 12
    s_cbranch_scc1 L_stub12
L_st13:
    s_waitcnt vmcnt(14)
    v_mfma_f32_16x16x32_bf16 v[16:19], v[28:31], v[152:155], v[16:19]
    v_mov_b32_dpp v10, v33 row_newbcast:14 row_mask:0xf bank_mask:0xf
    v_perm_b32 v24, v10, v10, v12
    v_mfma_f32_16x16x32_bf16 v[20:23], v[28:31], v[156:159], v[20:23]
    v_perm_b32 v25, v10, v10, v13
    v_perm_b32 v26, v10, v10, v14
    v_perm_b32 v27, v10, v10, v15
    v_add_u32_dpp v11, v34, v7 row_newbcast:5 row_mask:0xf bank_mask:0xf
    buffer_load_dwordx4 v[152:155], v11, s[32:35], 0 offen offset:0
    buffer_load_dwordx4 v[156:159], v11, s[32:35], 0 offen offset:256
    s_bitcmp1_b32 s52, 13
    s_cbranch_scc1 L_stub13
L_st14:
    s_waitcnt vmcnt(14)
    v_mfma_f32_16x16x32_bf16 v[16:19], v[24:27], v[160:163], v[16:19]
    v_mov_b32_dpp v10, v33 row_newbcast:15 row_mask:0xf bank_mask:0xf
    v_perm_b32 v28, v10, v10, v12
    v_mfma_f32_16x16x32_bf16 v[20:23], v[24:27], v[164:167], v[20:23]
    v_perm_b32 v29, v10, v10, v13
    v_perm_b32 v30, v10, v10, v14
    v_perm_b32 v31, v10, v10, v15
    v_add_u32_dpp v11, v34, v7 row_newbcast:6 row_mask:0xf bank_mask:0xf
    buffer_load_dwordx4 v[160:163], v11, s[32:35], 0 offen offset:0
    buffer_load_dwordx4 v[164:167], v11, s[32:35], 0 offen offset:256
    s_bitcmp1_b32 s52, 14
    s_cbranch_scc1 L_stub14
L_st15:
    s_waitcnt vmcnt(14)
    v_mfma_f32_16x16x32_bf16 v[16:19], v[28:31], v[168:171], v[16:19]
    v_mov_b32_dpp v10, v35 row_newbcast:0 row_mask:0xf bank_mask:0xf
    v_perm_b32 v24, v10, v10, v12
    v_mfma_f32_16x16x32_bf16 v[20:23], v[28:31], v[172:175], v[20:23]
    v_perm_b32 v25, v10, v10, v13
    v_perm_b32 v26, v10, v10, v14
    v_perm_b32 v27, v10, v10, v15
    v_add_u32_dpp v11, v34, v7 row_newbcast:7 row_mask:0xf bank_mask:0xf
    buffer_load_dwordx4 v[168:171], v11, s[32:35], 0 offen offset:0
    buffer_load_dwordx4 v[172:175], v11, s[32:35], 0 offen offset:256
    s_bitcmp1_b32 s52, 15
    s_cbranch_scc1 L_stub15
L_st16:
    v_mov_b32 v32, v34
    v_mov_b32 v33, v35
    v_mov_b32 v34, v36
    v_mov_b32 v35, v37
    v_mov_b32 v36, v38
    v_mov_b32 v37, v39
    s_lshr_b64 s[52:53], s[52:53], 16
    s_add_u32 s48, s48, 16
    s_branch L_st0
L_dr0:
    s_swappc_b64 s[54:55], s[56:57]
    v_mfma_f32_16x16x32_bf16 v[16:19], v[24:27], v[112:115], v[16:19]
    v_mov_b32_dpp v10, v33 row_newbcast:1 row_mask:0xf bank_mask:0xf
    v_perm_b32 v28, v10, v10, v12
    v_mfma_f32_16x16x32_bf16 v[20:23], v[24:27], v[116:119], v[20:23]
    v_perm_b32 v29, v10, v10, v13
    v_perm_b32 v30, v10, v10, v14
    v_perm_b32 v31, v10, v10, v15
    s_bitcmp1_b32 s52, 0
    s_cbranch_scc1 L_stub0
L_dr1:
    s_swappc_b64 s[54:55], s[56:57]
    v_mfma_f32_16x16x32_bf16 v[16:19], v[28:31], v[120:123], v[16:19]
    v_mov_b32_dpp v10, v33 row_newbcast:2 row_mask:0xf bank_mask:0xf
    v_perm_b32 v24, v10, v10, v12
    v_mfma_f32_16x16x32_bf16 v[20:23], v[28:31], v[124:127], v[20:23]
    v_perm_b32 v25, v10, v10, v13
    v_perm_b32 v26, v10, v10, v14
    v_perm_b32 v27, v10, v10, v15
    s_bitcmp1_b32 s52, 1
    s_cbranch_scc1 L_stub1
L_dr2:
    s_swappc_b64 s[54:55], s[56:57]
    v_mfma_f32_16x16x32_bf16 v[16:19], v[24:27], v[128:131], v[16:19]
    v_mov_b32_dpp v10, v33 row_newbcast:3 row_mask:0xf bank_mask:0xf
    v_perm_b32 v28, v10, v10, v12
    v_mfma_f32_16x16x32_bf16 v[20:23], v[24:27], v[132:135], v[20:23]
    v_perm_b32 v29, v10, v10, v13
    v_perm_b32 v30, v10, v10, v14
    v_perm_b32 v31, v10, v10, v15
    s_bitcmp1_b32 s52, 2
    s_cbranch_scc1 L_stub2
L_dr3:
    s_swappc_b64 s[54:55], s[56:57]
    v_mfma_f32_16x16x32_bf16 v[16:19], v[28:31], v[136:139], v[16:19]
    v_mov_b32_dpp v10, v33 row_newbcast:4 row_mask:0xf bank_mask:0xf
    v_perm_b32 v24, v10, v10, v12
    v_mfma_f32_16x16x32_bf16 v[20:23], v[28:31], v[140:143], v[20:23]
    v_perm_b32 v25, v10, v10, v13
    v_perm_b32 v26, v10, v10, v14
    v_perm_b32 v27, v10, v10, v15
    s_bitcmp1_b32 s52, 3
    s_cbranch_scc1 L_stub3
L_dr4:
    s_swappc_b64 s[54:55], s[56:57]
    v_mfma_f32_16x16x32_bf16 v[16:19], v[24:27], v[144:147], v[16:19]
    v_mov_b32_dpp v10, v33 row_newbcast:5 row_mask:0xf bank_mask:0xf
    v_perm_b32 v28, v10, v10, v12
    v_mfma_f32_16x16x32_bf16 v[20:23], v[24:27], v[148:151], v[20:23]
    v_perm_b32 v29, v10, v10, v13
    v_perm_b32 v30, v10, v10, v14
    v_perm_b32 v31, v10, v10, v15
    s_bitcmp1_b32 s52, 4
    s_cbranch_scc1 L_stub4
L_dr5:
    s_swappc_b64 s[54:55], s[56:57]
    v_mfma_f32_16x16x32_bf16 v[16:19], v[28:31], v[152:155], v[16:19]
    v_mov_b32_dpp v10, v33 row_newbcast:6 row_mask:0xf bank_mask:0xf
    v_perm_b32 v24, v10, v10, v12
    v_mfma_f32_16x16x32_bf16 v[20:23], v[28:31], v[156:159], v[20:23]
    v_perm_b32 v25, v10, v10, v13
    v_perm_b32 v26, v10, v10, v14
    v_perm_b32 v27, v10, v10, v15
    s_bitcmp1_b32 s52, 5
    s_cbranch_scc1 L_stub5
L_dr6:
    s_swappc_b64 s[54:55], s[56:57]
    v_mfma_f32_16x16x32_bf16 v[16:19], v[24:27], v[160:163], v[16:19]
    v_mov_b32_dpp v10, v33 row_newbcast:7 row_mask:0xf bank_mask:0xf
    v_perm_b32 v28, v10, v10, v12
    v_mfma_f32_16x16x32_bf16 v[20:23], v[24:27], v[164:167], v[20:23]
    v_perm_b32 v29, v10, v10, v13
    v_perm_b32 v30, v10, v10, v14
    v_perm_b32 v31, v10, v10, v15
    s_bitcmp1_b32 s52, 6
    s_cbranch_scc1 L_stub6
L_dr7:
    s_swappc_b64 s[54:55], s[56:57]
    v_mfma_f32_16x16x32_bf16 v[16:19], v[28:31], v[168:171], v[16:19]
    v_mov_b32_dpp v10, v33 row_newbcast:8 row_mask:0xf bank_mask:0xf
    v_perm_b32 v24, v10, v10, v12
    v_mfma_f32_16x16x32_bf16 v[20:23], v[28:31], v[172:175], v[20:23]
    v_perm_b32 v25, v10, v10, v13
    v_perm_b32 v26, v10, v10, v14
    v_perm_b32 v27, v10, v10, v15
    s_bitcmp1_b32 s52, 7
    s_cbranch_scc1 L_stub7
L_dr8:
    s_swappc_b64 s[54:55], s[56:57]
    v_mfma_f32_16x16x32_bf16 v[16:19], v[24:27], v[112:115], v[16:19]
    v_mov_b32_dpp v10, v33 row_newbcast:9 row_mask:0xf bank_mask:0xf
    v_perm_b32 v28, v10, v10, v12
    v_mfma_f32_16x16x32_bf16 v[20:23], v[24:27], v[116:119], v[20:23]
    v_perm_b32 v29, v10, v10, v13
    v_perm_b32 v30, v10, v10, v14
    v_perm_b32 v31, v10, v10, v15
    s_bitcmp1_b32 s52, 8
    s_cbranch_scc1 L_stub8
L_dr9:
    s_swappc_b64 s[54:55], s[56:57]
    v_mfma_f32_16x16x32_bf16 v[16:19], v[28:31], v[120:123], v[16:19]
    v_mov_b32_dpp v10, v33 row_newbcast:10 row_mask:0xf bank_mask:0xf
    v_perm_b32 v24, v10, v10, v12
    v_mfma_f32_16x16x32_bf16 v[20:23], v[28:31], v[124:127], v[20:23]
    v_perm_b32 v25, v10, v10, v13
    v_perm_b32 v26, v10, v10, v14
    v_perm_b32 v27, v10, v10, v15
    s_bitcmp1_b32 s52, 9
    s_cbranch_scc1 L_stub9
L_dr10:
    s_swappc_b64 s[54:55], s[56:57]
    v_mfma_f32_16x16x32_bf16 v[16:19], v[24:27], v[128:131], v[16:19]
    v_mov_b32_dpp v10, v33 row_newbcast:11 row_mask:0xf bank_mask:0xf
    v_perm_b32 v28, v10, v10, v12
    v_mfma_f32_16x16x32_bf16 v[20:23], v[24:27], v[132:135], v[20:23]
    v_perm_b32 v29, v10, v10, v13
    v_perm_b32 v30, v10, v10, v14
    v_perm_b32 v31, v10, v10, v15
    s_bitcmp1_b32 s52, 10
    s_cbranch_scc1 L_stub10
L_dr11:
    s_swappc_b64 s[54:55], s[56:57]
    v_mfma_f32_16x16x32_bf16 v[16:19], v[28:31], v[136:139], v[16:19]
    v_mov_b32_dpp v10, v33 row_newbcast:12 row_mask:0xf bank_mask:0xf
    v_perm_b32 v24, v10, v10, v12
    v_mfma_f32_16x16x32_bf16 v[20:23], v[28:31], v[140:143], v[20:23]
    v_perm_b32 v25, v10, v10, v13
    v_perm_b32 v26, v10, v10, v14
    v_perm_b32 v27, v10, v10, v15
    s_bitcmp1_b32 s52, 11
    s_cbranch_scc1 L_stub11
L_dr12:
    s_swappc_b64 s[54:55], s[56:57]
    v_mfma_f32_16x16x32_bf16 v[16:19], v[24:27], v[144:147], v[16:19]
    v_mov_b32_dpp v10, v33 row_newbcast:13 row_mask:0xf bank_mask:0xf
    v_perm_b32 v28, v10, v10, v12
    v_mfma_f32_16x16x32_bf16 v[20:23], v[24:27], v[148:151], v[20:23]
    v_perm_b32 v29, v10, v10, v13
    v_perm_b32 v30, v10, v10, v14
    v_perm_b32 v31, v10, v10, v15
    s_bitcmp1_b32 s52, 12
    s_cbranch_scc1 L_stub12
L_dr13:
    s_swappc_b64 s[54:55], s[56:57]
    v_mfma_f32_16x16x32_bf16 v[16:19], v[28:31], v[152:155], v[16:19]
    v_mov_b32_dpp v10, v33 row_newbcast:14 row_mask:0xf bank_mask:0xf
    v_perm_b32 v24, v10, v10, v12
    v_mfma_f32_16x16x32_bf16 v[20:23], v[28:31], v[156:159], v[20:23]
    v_perm_b32 v25, v10, v10, v13
    v_perm_b32 v26, v10, v10, v14
    v_perm_b32 v27, v10, v10, v15
    s_bitcmp1_b32 s52, 13
    s_cbranch_scc1 L_stub13
L_dr14:
    s_swappc_b64 s[54:55], s[56:57]
    v_mfma_f32_16x16x32_bf16 v[16:19], v[24:27], v[160:163], v[16:19]
    v_mov_b32_dpp v10, v33 row_newbcast:15 row_mask:0xf bank_mask:0xf
    v_perm_b32 v28, v10, v10, v12
    v_mfma_f32_16x16x32_bf16 v[20:23], v[24:27], v[164:167], v[20:23]
    v_perm_b32 v29, v10, v10, v13
    v_perm_b32 v30, v10, v10, v14
    v_perm_b32 v31, v10, v10, v15
    s_bitcmp1_b32 s52, 14
    s_cbranch_scc1 L_stub14
L_dr15:
    s_swappc_b64 s[54:55], s[56:57]
    v_mfma_f32_16x16x32_bf16 v[16:19], v[28:31], v[168:171], v[16:19]
    v_mov_b32_dpp v10, v35 row_newbcast:0 row_mask:0xf bank_mask:0xf
    v_perm_b32 v24, v10, v10, v12
    v_mfma_f32_16x16x32_bf16 v[20:23], v[28:31], v[172:175], v[20:23]
    v_perm_b32 v25, v10, v10, v13
    v_perm_b32 v26, v10, v10, v14
    v_perm_b32 v27, v10, v10, v15
    s_bitcmp1_b32 s52, 15
    s_cbranch_scc1 L_stub15
L_dr16:
    v_mov_b32 v32, v34
    v_mov_b32 v33, v35
    v_mov_b32 v34, v36
    v_mov_b32 v35, v37
    v_mov_b32 v36, v38
    v_mov_b32 v37, v39
    s_lshr_b64 s[52:53], s[52:53], 16
    s_add_u32 s48, s48, 16
    s_branch L_dr0
L_stub0:
    s_mov_b32 s49, 1
    s_call_b64 s[54:55], L_event
    s_cbranch_scc1 L_dr1
    s_branch L_st1
L_stub1:
    s_mov_b32 s49, 2
    s_call_b64 s[54:55], L_event
    s_cbranch_scc1 L_dr2
    s_branch L_st2
L_stub2:
    s_mov_b32 s49, 3
    s_call_b64 s[54:55], L_event
    s_cbranch_scc1 L_dr3
    s_branch L_st3
L_stub3:
    s_mov_b32 s49, 4
    s_call_b64 s[54:55], L_event
    s_cbranch_scc1 L_dr4
    s_branch L_st4
L_stub4:
    s_mov_b32 s49, 5
    s_call_b64 s[54:55], L_event
    s_cbranch_scc1 L_dr5
    s_branch L_st5
L_stub5:
    s_mov_b32 s49, 6
    s_call_b64 s[54:55], L_event
    s_cbranch_scc1 L_dr6
    s_branch L_st6
L_stub6:
    s_mov_b32 s49, 7
    s_call_b64 s[54:55], L_event
    s_cbranch_scc1 L_dr7
    s_branch L_st7
L_stub7:
    s_mov_b32 s49, 8
    s_call_b64 s[54:55], L_event
    s_cbranch_scc1 L_dr8
    s_branch L_st8
L_stub8:
    s_mov_b32 s49, 9
    s_call_b64 s[54:55], L_event
    s_cbranch_scc1 L_dr9
    s_branch L_st9
L_stub9:
    s_mov_b32 s49, 10
    s_call_b64 s[54:55], L_event
    s_cbranch_scc1 L_dr10
    s_branch L_st10
L_stub10:
    s_mov_b32 s49, 11
    s_call_b64 s[54:55], L_event
    s_cbranch_scc1 L_dr11
    s_branch L_st11
L_stub11:
    s_mov_b32 s49, 12
    s_call_b64 s[54:55], L_event
    s_cbranch_scc1 L_dr12
    s_branch L_st12
L_stub12:
    s_mov_b32 s49, 13
    s_call_b64 s[54:55], L_event
    s_cbranch_scc1 L_dr13
    s_branch L_st13
L_stub13:
    s_mov_b32 s49, 14
    s_call_b64 s[54:55], L_event
    s_cbranch_scc1 L_dr14
    s_branch L_st14
L_stub14:
    s_mov_b32 s49, 15
    s_call_b64 s[54:55], L_event
    s_cbranch_scc1 L_dr15
    s_branch L_st15
L_stub15:
    s_mov_b32 s49, 16
    s_call_b64 s[54:55], L_event
    s_cbranch_scc1 L_dr16
    s_branch L_st16
    .p2align 7
L_wtab:
    s_add_u32 s56, s56, 12
    s_waitcnt vmcnt(14)
    s_setpc_b64 s[54:55]
    s_add_u32 s56, s56, 12
    s_waitcnt vmcnt(12)
    s_setpc_b64 s[54:55]
    s_add_u32 s56, s56, 12
    s_waitcnt vmcnt(10)
    s_setpc_b64 s[54:55]
    s_add_u32 s56, s56, 12
    s_waitcnt vmcnt(8)
    s_setpc_b64 s[54:55]
    s_add_u32 s56, s56, 12
    s_waitcnt vmcnt(6)
    s_setpc_b64 s[54:55]
    s_add_u32 s56, s56, 12
    s_waitcnt vmcnt(4)
    s_setpc_b64 s[54:55]
    s_add_u32 s56, s56, 12
    s_waitcnt vmcnt(2)
    s_setpc_b64 s[54:55]
    s_add_u32 s56, s56, 12
    s_waitcnt vmcnt(0)
    s_setpc_b64 s[54:55]
L_event:
    s_add_u32 s49, s49, s48
L_event2:
    s_cmp_lg_u32 s49, s10
    s_cbranch_scc1 L_evret
L_flush:
    v_xor_b32 v45, s15, v2
    s_and_b32 s64, s26, 6
    s_lshl_b32 s64, s64, 1
    v_mov_b32 v44, s64
    s_lshl_b32 s64, s21, 2
    v_add_u32 v43, s64, v0
    v_mul_f32 v48, v1, v16
    v_mul_f32 v49, v1, v17
    v_mul_f32 v50, v1, v18
    v_mul_f32 v51, v1, v19
    v_cvt_pk_bf16_f32 v48, v48, v49
    v_cvt_pk_bf16_f32 v49, v50, v51
    ds_write_b64 v45, v[48:49] offset:41984
    v_mul_f32 v52, v1, v20
    v_mul_f32 v53, v1, v21
    v_mul_f32 v54, v1, v22
    v_mul_f32 v55, v1, v23
    v_cvt_pk_bf16_f32 v52, v52, v53
    v_cvt_pk_bf16_f32 v53, v54, v55
    ds_write_b64 v45, v[52:53] offset:42240
    s_mov_b64 exec, 1
    ds_add_u32 v44, v6 offset:32
    s_mov_b64 exec, -1
    s_cmp_eq_u32 s26, 4
    s_cbranch_scc1 L_sdone
    ds_read_u16_d16_hi v1, v43
    s_add_u32 s26, s26, 1
    v_mov_b32 v16, 0
    v_mov_b32 v17, 0
    v_mov_b32 v18, 0
    v_mov_b32 v19, 0
    v_mov_b32 v20, 0
    v_mov_b32 v21, 0
    v_mov_b32 v22, 0
    v_mov_b32 v23, 0
    s_mov_b32 s15, s16
    s_mov_b32 s20, s21
    s_mov_b32 s10, s11
    s_mov_b32 s16, s17
    s_mov_b32 s21, s22
    s_mov_b32 s11, s12
    s_mov_b32 s17, s18
    s_mov_b32 s22, s23
    s_mov_b32 s12, s13
    s_mov_b32 s18, s19
    s_mov_b32 s23, s24
    s_mov_b32 s13, s14
    s_waitcnt lgkmcnt(0)
    s_cmp_eq_u32 s49, s10
    s_cbranch_scc1 L_flush
L_evret:
    s_add_u32 s64, s49, 8
    s_cmp_ge_u32 s64, s50
    s_setpc_b64 s[54:55]
L_slow:
    s_mov_b32 s49, -1
    v_mbcnt_lo_u32_b32 v60, -1, 0
    v_mbcnt_hi_u32_b32 v60, -1, v60
L_slow_pair:
    v_lshlrev_b32 v61, 2, v60
    s_mul_i32 s70, s2, 40
    s_lshl1_add_u32 s70, s20, s70
    s_mov_b32 s71, 0
L_slow_chunk:
    global_load_dword v62, v61, s[8:9]
    global_load_dword v63, v61, s[6:7]
    v_add_u32 v61, 0x100, v61
    s_waitcnt vmcnt(0)
    v_subrev_u32 v62, s70, v62
    v_cmp_gt_u32 vcc, 2, v62
    v_lshlrev_b32 v64, 1, v63
    ds_read_u16 v64, v64 offset:62464
    s_mov_b64 s[72:73], vcc
    v_lshlrev_b32 v62, 4, v62
    v_lshlrev_b32 v63, 9, v63
    s_waitcnt lgkmcnt(0)
    v_lshlrev_b32 v64, v62, v64
L_slow_edge:
    s_cmp_eq_u64 s[72:73], 0
    s_cbranch_scc1 L_slow_next
    s_ff1_i32_b64 s74, s[72:73]
    s_bitset0_b64 s[72:73], s74
    v_readlane_b32 s64, v63, s74
    v_readlane_b32 s65, v64, s74
    v_mov_b32 v10, 0
    v_mov_b32 v11, 2147483648
    s_mov_b64 exec, 0xffff
    v_mov_b32 v10, s65
    v_add_u32 v11, s64, v7
    s_mov_b64 exec, -1
    buffer_load_dwordx4 v[68:71], v11, s[32:35], 0 offen
    buffer_load_dwordx4 v[72:75], v11, s[32:35], 0 offen offset:256
    v_perm_b32 v24, v10, v10, v12
    v_perm_b32 v25, v10, v10, v13
    v_perm_b32 v26, v10, v10, v14
    v_perm_b32 v27, v10, v10, v15
    s_nop 0
    s_waitcnt vmcnt(0)
    v_mfma_f32_16x16x32_bf16 v[16:19], v[24:27], v[68:71], v[16:19]
    v_mfma_f32_16x16x32_bf16 v[20:23], v[24:27], v[72:75], v[20:23]
    s_branch L_slow_edge
L_slow_next:
    s_add_u32 s71, s71, 1
    s_cmp_lt_u32 s71, 2500
    s_cbranch_scc1 L_slow_chunk
    s_call_b64 s[54:55], L_flush
    s_branch L_slow_pair
L_sdone:
    s_endpgm
L_retry_7:
    s_sub_u32 s100, s100, 1
    s_cbranch_scc1 L_end
    s_sleep 1
    s_branch L_spin_6
L_retry_10:
    s_sub_u32 s100, s100, 1
    s_cbranch_scc1 L_end
    s_sleep 1
    s_branch L_spin_9
L_retry_11:
    s_sub_u32 s100, s100, 1
    s_cbranch_scc1 L_end
    s_sleep 4
    s_branch L_ipoll_8
L_retry_13:
    s_sub_u32 s100, s100, 1
    s_cbranch_scc1 L_end
    s_sleep 1
    s_branch L_spin_12
L_mrole_1:
    v_lshlrev_b32 v43, 4, v4
    v_lshl_add_u32 v46, v46, 9, v43
    s_bfe_u32 s64, s68, 0x30002
    s_lshl_b32 s64, s64, 14
    s_lshr_b32 s65, s68, 5
    s_lshl_b32 s65, s65, 15
    s_bfe_u32 s66, s68, 0x10001
    s_lshl_b32 s66, s66, 14
    s_add_u32 s65, s65, s66
    s_and_b32 s66, s68, 1
    s_lshl_b32 s66, s66, 11
    s_add_u32 s65, s65, s66
    v_add_u32 v44, s64, v46
    v_add_u32 v45, s65, v46
    s_cmp_lg_u32 s31, 0
    s_waitcnt lgkmcnt(0)
    s_cbranch_scc1 L_roled_2
    global_load_dwordx4 v[48:51], v45, s[20:21] offset:0
    global_load_dwordx4 v[52:55], v44, s[18:19] offset:0
    global_load_dwordx4 v[56:59], v44, s[18:19] offset:2048
    global_load_dwordx4 v[60:63], v45, s[20:21] offset:64
    global_load_dwordx4 v[64:67], v44, s[18:19] offset:64
    global_load_dwordx4 v[68:71], v44, s[18:19] offset:2112
    global_load_dwordx4 v[72:75], v45, s[20:21] offset:128
    global_load_dwordx4 v[76:79], v44, s[18:19] offset:128
    global_load_dwordx4 v[80:83], v44, s[18:19] offset:2176
    global_load_dwordx4 v[84:87], v45, s[20:21] offset:192
    global_load_dwordx4 v[88:91], v44, s[18:19] offset:192
    global_load_dwordx4 v[92:95], v44, s[18:19] offset:2240
    global_load_dwordx4 v[96:99], v45, s[20:21] offset:256
    global_load_dwordx4 v[100:103], v44, s[18:19] offset:256
    global_load_dwordx4 v[104:107], v44, s[18:19] offset:2304
    global_load_dwordx4 v[108:111], v45, s[20:21] offset:320
    global_load_dwordx4 v[112:115], v44, s[18:19] offset:320
    global_load_dwordx4 v[116:119], v44, s[18:19] offset:2368
    global_load_dwordx4 v[120:123], v45, s[20:21] offset:384
    global_load_dwordx4 v[124:127], v44, s[18:19] offset:384
    global_load_dwordx4 v[128:131], v44, s[18:19] offset:2432
    global_load_dwordx4 v[132:135], v45, s[20:21] offset:448
    global_load_dwordx4 v[136:139], v44, s[18:19] offset:448
    global_load_dwordx4 v[140:143], v44, s[18:19] offset:2496
    s_branch L_roled_2
L_mwork_4:
    s_cmp_lg_u32 s31, 0
    s_cbranch_scc1 L_worked_5_w
    s_waitcnt vmcnt(22)
    v_mfma_f32_16x16x32_bf16 v[16:19], v[52:55], v[48:51], 0
    v_mfma_f32_16x16x32_bf16 v[20:23], v[56:59], v[48:51], 0
    s_waitcnt vmcnt(19)
    v_mfma_f32_16x16x32_bf16 v[16:19], v[64:67], v[60:63], v[16:19]
    v_mfma_f32_16x16x32_bf16 v[20:23], v[68:71], v[60:63], v[20:23]
    s_waitcnt vmcnt(16)
    v_mfma_f32_16x16x32_bf16 v[16:19], v[76:79], v[72:75], v[16:19]
    v_mfma_f32_16x16x32_bf16 v[20:23], v[80:83], v[72:75], v[20:23]
    s_waitcnt vmcnt(13)
    v_mfma_f32_16x16x32_bf16 v[16:19], v[88:91], v[84:87], v[16:19]
    v_mfma_f32_16x16x32_bf16 v[20:23], v[92:95], v[84:87], v[20:23]
    s_waitcnt vmcnt(10)
    v_mfma_f32_16x16x32_bf16 v[16:19], v[100:103], v[96:99], v[16:19]
    v_mfma_f32_16x16x32_bf16 v[20:23], v[104:107], v[96:99], v[20:23]
    s_waitcnt vmcnt(7)
    v_mfma_f32_16x16x32_bf16 v[16:19], v[112:115], v[108:111], v[16:19]
    v_mfma_f32_16x16x32_bf16 v[20:23], v[116:119], v[108:111], v[20:23]
    s_waitcnt vmcnt(4)
    v_mfma_f32_16x16x32_bf16 v[16:19], v[124:127], v[120:123], v[16:19]
    v_mfma_f32_16x16x32_bf16 v[20:23], v[128:131], v[120:123], v[20:23]
    s_waitcnt vmcnt(1)
    v_mfma_f32_16x16x32_bf16 v[16:19], v[136:139], v[132:135], v[16:19]
    v_mfma_f32_16x16x32_bf16 v[20:23], v[140:143], v[132:135], v[20:23]
    s_lshl_b32 s64, s27, 10
    s_add_u32 s64, s64, 65536
    v_lshl_add_u32 v40, v2, 4, s64
    s_lshl_b32 s64, s27, 2
    s_add_u32 s64, s64, 4096
    v_lshl_add_u32 v41, v2, 9, s64
    v_mov_b32 v42, s30
    s_nop 1
    v_cvt_pk_bf16_f32 v44, v16, v17
    v_cvt_pk_bf16_f32 v45, v18, v19
    v_cvt_pk_bf16_f32 v46, v20, v21
    v_cvt_pk_bf16_f32 v47, v22, v23
    global_store_dwordx4 v40, v[44:47], s[28:29] sc1
    s_waitcnt vmcnt(0)
    s_mov_b64 exec, 65535
    global_store_dword v41, v42, s[28:29] sc1
    s_mov_b64 exec, -1
    s_branch L_worked_5
L_worked_5_w:
    s_waitcnt vmcnt(0)
    s_branch L_worked_5
L_gemm:
    v_lshrrev_b32 v0, 5, v2
    s_lshl_b32 s64, s31, 1
    v_add_u32 v0, s64, v0
    v_and_b32 v1, 31, v2
    v_xor_b32 v1, v1, v0
    v_lshlrev_b32 v1, 4, v1
    v_lshl_add_u32 v0, v0, 9, v1
    v_xor_b32 v1, 0x80, v0
    v_lshrrev_b32 v13, 3, v2
    v_lshrrev_b32 v15, 2, v2
    v_and_b32 v15, 4, v15
    v_and_b32 v14, 7, v2
    v_xor_b32 v15, v15, v14
    v_lshlrev_b32 v15, 4, v15
    v_lshl_add_u32 v13, v13, 9, v15
    s_lshl_b32 s64, s31, 7
    v_add_u32 v13, s64, v13
    s_mul_i32 s65, s2, 20480
    s_lshl_b32 s66, s31, 10
    s_lshl_b32 s70, s31, 14
    s_add_u32 s70, s70, 82944
    s_mov_b32 s71, 3072
    s_mov_b32 s72, 6144
    s_mov_b32 s73, 9216
    s_waitcnt lgkmcnt(0)
    s_mov_b32 s32, s4
    s_and_b32 s33, s5, 0xffff
    s_mov_b32 s34, 5120000
    s_mov_b32 s35, 0x20000
    s_mov_b32 s36, s22
    s_and_b32 s37, s23, 0xffff
    s_mov_b32 s38, 131072
    s_mov_b32 s39, 0x20000
    s_barrier
    s_cmp_ge_u32 s2, 250
    s_cbranch_scc1 L_end
    s_setprio 2
    s_add_u32 m0, s66, 1024
    s_nop 0
    buffer_load_dwordx4 v0, s[32:35], s65 offen lds
    s_add_u32 m0, s66, 5120
    s_add_u32 s65, s65, 4096
    buffer_load_dwordx4 v1, s[32:35], s65 offen lds
    s_add_u32 m0, s66, 9216
    s_add_u32 s65, s65, 4096
    buffer_load_dwordx4 v0, s[32:35], s65 offen lds
    s_add_u32 m0, s66, 13312
    s_add_u32 s65, s65, 4096
    buffer_load_dwordx4 v1, s[32:35], s65 offen lds
    s_add_u32 m0, s66, 17408
    s_add_u32 s65, s65, 4096
    buffer_load_dwordx4 v0, s[32:35], s65 offen lds
    s_add_u32 m0, s70, 0
    s_nop 0
    buffer_load_dwordx4 v13, s[36:39], 0 offen offset:0 lds
    buffer_load_dwordx4 v13, s[36:39], s71 offen offset:1024 lds
    buffer_load_dwordx4 v13, s[36:39], s72 offen offset:2048 lds
    buffer_load_dwordx4 v13, s[36:39], s73 offen offset:3072 lds
    v_add_u32 v13, 0x4000, v13
    s_mov_b32 s40, s16
    s_and_b32 s41, s17, 0xffff
    s_mov_b32 s42, 131072
    s_mov_b32 s43, 0x20000
    s_mov_b32 s44, s28
    s_and_b32 s45, s29, 0xffff
    s_mov_b32 s46, 1048576
    s_mov_b32 s47, 0x20000
    s_mov_b32 s48, s24
    s_and_b32 s49, s25, 0xffff
    s_mov_b32 s50, 5120000
    s_mov_b32 s51, 0x20000
    v_xor_b32 v15, v4, v3
    v_lshlrev_b32 v15, 4, v15
    v_lshl_add_u32 v7, v3, 9, v15
    v_xor_b32 v8, 64, v7
    v_xor_b32 v9, 0x80, v7
    v_xor_b32 v10, 0xc0, v7
    v_lshrrev_b32 v15, 2, v3
    v_lshl_add_u32 v15, v4, 3, v15
    v_lshlrev_b32 v15, 7, v15
    v_lshrrev_b32 v14, 1, v3
    v_and_b32 v14, 4, v14
    v_and_b32 v0, 3, v3
    v_xor_b32 v14, v14, v0
    v_lshl_add_u32 v15, v14, 4, v15
    v_add_u32 v11, s70, v15
    v_xor_b32 v12, 64, v11
    v_and_b32 v0, 31, v2
    v_lshlrev_b32 v0, 2, v0
    s_and_b32 s64, s2, 15
    s_lshl_b32 s64, s64, 9
    s_lshl_b32 s65, s31, 7
    s_add_u32 s64, s64, s65
    s_add_u32 s74, s64, 4096
    v_lshlrev_b32 v14, 4, v2
    s_lshl_b32 s75, s31, 15
    s_add_u32 s75, s75, 65536
    s_add_u32 m0, s70, 4096
    s_waitcnt vmcnt(5)
    buffer_load_dwordx4 v13, s[36:39], 0 offen offset:0 lds
    s_waitcnt vmcnt(5)
    buffer_load_dwordx4 v13, s[36:39], s71 offen offset:1024 lds
    s_waitcnt vmcnt(5)
    buffer_load_dwordx4 v13, s[36:39], s72 offen offset:2048 lds
    s_waitcnt vmcnt(5)
    buffer_load_dwordx4 v13, s[36:39], s73 offen offset:3072 lds
    v_add_u32 v13, 0x4000, v13
    s_add_u32 m0, s70, 8192
    s_waitcnt vmcnt(5)
    buffer_load_dwordx4 v13, s[36:39], 0 offen offset:0 lds
    s_waitcnt vmcnt(5)
    buffer_load_dwordx4 v13, s[36:39], s71 offen offset:1024 lds
    s_waitcnt vmcnt(5)
    buffer_load_dwordx4 v13, s[36:39], s72 offen offset:2048 lds
    s_waitcnt vmcnt(5)
    buffer_load_dwordx4 v13, s[36:39], s73 offen offset:3072 lds
    v_add_u32 v13, 0x4000, v13
    s_add_u32 m0, s70, 12288
    s_waitcnt vmcnt(5)
    buffer_load_dwordx4 v13, s[36:39], 0 offen offset:0 lds
    s_waitcnt vmcnt(5)
    buffer_load_dwordx4 v13, s[36:39], s71 offen offset:1024 lds
    s_waitcnt vmcnt(5)
    buffer_load_dwordx4 v13, s[36:39], s72 offen offset:2048 lds
    s_waitcnt vmcnt(5)
    buffer_load_dwordx4 v13, s[36:39], s73 offen offset:3072 lds
    v_add_u32 v13, 0x4000, v13
    s_waitcnt vmcnt(12)
    s_waitcnt lgkmcnt(0)
    s_mov_b64 exec, 1
    ds_add_u32 v5, v6 offset:4
    s_mov_b64 exec, -1
    ds_read_b64_tr_b16 v[128:129], v11 offset:0
    ds_read_b64_tr_b16 v[130:131], v11 offset:512
    ds_read_b64_tr_b16 v[132:133], v11 offset:8
    ds_read_b64_tr_b16 v[134:135], v11 offset:520
    ds_read_b64_tr_b16 v[136:137], v12 offset:0
    ds_read_b64_tr_b16 v[138:139], v12 offset:512
    ds_read_b64_tr_b16 v[140:141], v12 offset:8
    ds_read_b64_tr_b16 v[142:143], v12 offset:520
    s_waitcnt lgkmcnt(0)
    s_add_u32 m0, s70, 0
    s_waitcnt vmcnt(5)
    buffer_load_dwordx4 v13, s[36:39], 0 offen offset:0 lds
    s_waitcnt vmcnt(5)
    buffer_load_dwordx4 v13, s[36:39], s71 offen offset:1024 lds
    s_waitcnt vmcnt(5)
    buffer_load_dwordx4 v13, s[36:39], s72 offen offset:2048 lds
    s_waitcnt vmcnt(5)
    buffer_load_dwordx4 v13, s[36:39], s73 offen offset:3072 lds
    v_add_u32 v13, 0x4000, v13
    s_waitcnt vmcnt(12)
    ds_read_b64_tr_b16 v[144:145], v11 offset:4096
    ds_read_b64_tr_b16 v[146:147], v11 offset:4608
    ds_read_b64_tr_b16 v[148:149], v11 offset:4104
    ds_read_b64_tr_b16 v[150:151], v11 offset:4616
    ds_read_b64_tr_b16 v[152:153], v12 offset:4096
    ds_read_b64_tr_b16 v[154:155], v12 offset:4608
    ds_read_b64_tr_b16 v[156:157], v12 offset:4104
    ds_read_b64_tr_b16 v[158:159], v12 offset:4616
    s_waitcnt lgkmcnt(0)
    s_add_u32 m0, s70, 4096
    s_waitcnt vmcnt(5)
    buffer_load_dwordx4 v13, s[36:39], 0 offen offset:0 lds
    s_waitcnt vmcnt(5)
    buffer_load_dwordx4 v13, s[36:39], s71 offen offset:1024 lds
    s_waitcnt vmcnt(5)
    buffer_load_dwordx4 v13, s[36:39], s72 offen offset:2048 lds
    s_waitcnt vmcnt(5)
    buffer_load_dwordx4 v13, s[36:39], s73 offen offset:3072 lds
    v_add_u32 v13, 0x4000, v13
    s_waitcnt vmcnt(12)
    ds_read_b64_tr_b16 v[160:161], v11 offset:8192
    ds_read_b64_tr_b16 v[162:163], v11 offset:8704
    ds_read_b64_tr_b16 v[164:165], v11 offset:8200
    ds_read_b64_tr_b16 v[166:167], v11 offset:8712
    ds_read_b64_tr_b16 v[168:169], v12 offset:8192
    ds_read_b64_tr_b16 v[170:171], v12 offset:8704
    ds_read_b64_tr_b16 v[172:173], v12 offset:8200
    ds_read_b64_tr_b16 v[174:175], v12 offset:8712
    s_waitcnt lgkmcnt(0)
    s_add_u32 m0, s70, 8192
    s_nop 0
    buffer_load_dwordx4 v13, s[36:39], 0 offen offset:0 lds
    buffer_load_dwordx4 v13, s[36:39], s71 offen offset:1024 lds
    buffer_load_dwordx4 v13, s[36:39], s72 offen offset:2048 lds
    buffer_load_dwordx4 v13, s[36:39], s73 offen offset:3072 lds
    v_add_u32 v13, 0x4000, v13
    buffer_load_dword v1, v0, s[44:47], s74 offen sc1
    s_waitcnt vmcnt(13)
    ds_read_b64_tr_b16 v[176:177], v11 offset:12288
    ds_read_b64_tr_b16 v[178:179], v11 offset:12800
    ds_read_b64_tr_b16 v[180:181], v11 offset:12296
    ds_read_b64_tr_b16 v[182:183], v11 offset:12808
    ds_read_b64_tr_b16 v[184:185], v12 offset:12288
    ds_read_b64_tr_b16 v[186:187], v12 offset:12800
    ds_read_b64_tr_b16 v[188:189], v12 offset:12296
    ds_read_b64_tr_b16 v[190:191], v12 offset:12808
    s_waitcnt lgkmcnt(0)
    s_add_u32 m0, s70, 12288
    s_nop 0
    buffer_load_dwordx4 v13, s[36:39], 0 offen offset:0 lds
    buffer_load_dwordx4 v13, s[36:39], s71 offen offset:1024 lds
    buffer_load_dwordx4 v13, s[36:39], s72 offen offset:2048 lds
    buffer_load_dwordx4 v13, s[36:39], s73 offen offset:3072 lds
    v_add_u32 v13, 0x4000, v13
    s_waitcnt vmcnt(13)
    ds_read_b64_tr_b16 v[192:193], v11 offset:0
    ds_read_b64_tr_b16 v[194:195], v11 offset:512
    ds_read_b64_tr_b16 v[196:197], v11 offset:8
    ds_read_b64_tr_b16 v[198:199], v11 offset:520
    ds_read_b64_tr_b16 v[200:201], v12 offset:0
    ds_read_b64_tr_b16 v[202:203], v12 offset:512
    ds_read_b64_tr_b16 v[204:205], v12 offset:8
    ds_read_b64_tr_b16 v[206:207], v12 offset:520
    s_waitcnt vmcnt(9)
    ds_read_b64_tr_b16 v[208:209], v11 offset:4096
    ds_read_b64_tr_b16 v[210:211], v11 offset:4608
    ds_read_b64_tr_b16 v[212:213], v11 offset:4104
    ds_read_b64_tr_b16 v[214:215], v11 offset:4616
    ds_read_b64_tr_b16 v[216:217], v12 offset:4096
    ds_read_b64_tr_b16 v[218:219], v12 offset:4608
    ds_read_b64_tr_b16 v[220:221], v12 offset:4104
    ds_read_b64_tr_b16 v[222:223], v12 offset:4616
    s_waitcnt vmcnt(5)
    ds_read_b64_tr_b16 v[224:225], v11 offset:8192
    ds_read_b64_tr_b16 v[226:227], v11 offset:8704
    ds_read_b64_tr_b16 v[228:229], v11 offset:8200
    ds_read_b64_tr_b16 v[230:231], v11 offset:8712
    ds_read_b64_tr_b16 v[232:233], v12 offset:8192
    ds_read_b64_tr_b16 v[234:235], v12 offset:8704
    ds_read_b64_tr_b16 v[236:237], v12 offset:8200
    ds_read_b64_tr_b16 v[238:239], v12 offset:8712
    s_waitcnt vmcnt(4)
L_spin_15:
    ds_read_b128 v[16:19], v5
    s_waitcnt lgkmcnt(0)
    v_readfirstlane_b32 s101, v18
    v_readfirstlane_b32 s30, v19
    s_cmp_ge_u32 s101, 1
    s_cbranch_scc0 L_retry_16
L_mchk_14:
    v_cmp_ne_u32 vcc, s30, v1
    s_cbranch_vccnz L_mre_17
    buffer_load_dwordx4 v[40:43], v14, s[44:47], s75 offen offset:0 sc1
    buffer_load_dwordx4 v[44:47], v14, s[44:47], s75 offen offset:1024 sc1
    buffer_load_dwordx4 v[48:51], v14, s[44:47], s75 offen offset:2048 sc1
    buffer_load_dwordx4 v[52:55], v14, s[44:47], s75 offen offset:3072 sc1
    s_add_u32 s75, s75, 4096
    buffer_load_dwordx4 v[56:59], v14, s[44:47], s75 offen offset:0 sc1
    buffer_load_dwordx4 v[60:63], v14, s[44:47], s75 offen offset:1024 sc1
    buffer_load_dwordx4 v[64:67], v14, s[44:47], s75 offen offset:2048 sc1
    buffer_load_dwordx4 v[68:71], v14, s[44:47], s75 offen offset:3072 sc1
    s_add_u32 s75, s75, 4096
    buffer_load_dwordx4 v[72:75], v14, s[44:47], s75 offen offset:0 sc1
    buffer_load_dwordx4 v[76:79], v14, s[44:47], s75 offen offset:1024 sc1
    s_waitcnt vmcnt(10)
    ds_read_b64_tr_b16 v[240:241], v11 offset:12288
    ds_read_b64_tr_b16 v[242:243], v11 offset:12800
    ds_read_b64_tr_b16 v[244:245], v11 offset:12296
    ds_read_b64_tr_b16 v[246:247], v11 offset:12808
    ds_read_b64_tr_b16 v[248:249], v12 offset:12288
    ds_read_b64_tr_b16 v[250:251], v12 offset:12800
    ds_read_b64_tr_b16 v[252:253], v12 offset:12296
    ds_read_b64_tr_b16 v[254:255], v12 offset:12808
    v_subrev_u32 v13, 0x20000, v13
L_spin_18:
    ds_read_b32 v15, v5 offset:4
    s_waitcnt lgkmcnt(0)
    v_readfirstlane_b32 s101, v15
    s_cmp_ge_u32 s101, 4
    s_cbranch_scc0 L_retry_19
    ds_read_b128 v[16:19], v7 offset:1024
    ds_read_b128 v[20:23], v7 offset:9216
    ds_read_b128 v[24:27], v7 offset:17408
    ds_read_b128 v[28:31], v8 offset:1024
    ds_read_b128 v[32:35], v8 offset:9216
    ds_read_b128 v[36:39], v8 offset:17408
    s_waitcnt lgkmcnt(3)
    s_waitcnt vmcnt(9)
    v_mfma_f32_16x16x32_bf16 v[80:83], v[40:43], v[16:19], 0
    v_mfma_f32_16x16x32_bf16 v[96:99], v[40:43], v[20:23], 0
    v_mfma_f32_16x16x32_bf16 v[112:115], v[40:43], v[24:27], 0
    buffer_load_dwordx4 v[40:43], v14, s[44:47], s75 offen offset:2048 sc1
    s_waitcnt vmcnt(9)
    v_mfma_f32_16x16x32_bf16 v[84:87], v[44:47], v[16:19], 0
    v_mfma_f32_16x16x32_bf16 v[100:103], v[44:47], v[20:23], 0
    v_mfma_f32_16x16x32_bf16 v[116:119], v[44:47], v[24:27], 0
    buffer_load_dwordx4 v[44:47], v14, s[44:47], s75 offen offset:3072 sc1
    s_add_u32 s75, s75, 4096
    s_waitcnt vmcnt(9)
    v_mfma_f32_16x16x32_bf16 v[88:91], v[48:51], v[16:19], 0
    v_mfma_f32_16x16x32_bf16 v[104:107], v[48:51], v[20:23], 0
    v_mfma_f32_16x16x32_bf16 v[120:123], v[48:51], v[24:27], 0
    buffer_load_dwordx4 v[48:51], v14, s[44:47], s75 offen offset:0 sc1
    s_waitcnt vmcnt(9)
    v_mfma_f32_16x16x32_bf16 v[92:95], v[52:55], v[16:19], 0
    v_mfma_f32_16x16x32_bf16 v[108:111], v[52:55], v[20:23], 0
    v_mfma_f32_16x16x32_bf16 v[124:127], v[52:55], v[24:27], 0
    buffer_load_dwordx4 v[52:55], v14, s[44:47], s75 offen offset:1024 sc1
    ds_read_b128 v[16:19], v9 offset:1024
    ds_read_b128 v[20:23], v9 offset:9216
    ds_read_b128 v[24:27], v9 offset:17408
    s_waitcnt lgkmcnt(3)
    s_waitcnt vmcnt(9)
    v_mfma_f32_16x16x32_bf16 v[80:83], v[56:59], v[28:31], v[80:83]
    v_mfma_f32_16x16x32_bf16 v[96:99], v[56:59], v[32:35], v[96:99]
    v_mfma_f32_16x16x32_bf16 v[112:115], v[56:59], v[36:39], v[112:115]
    buffer_load_dwordx4 v[56:59], v14, s[44:47], s75 offen offset:2048 sc1
    s_waitcnt vmcnt(9)
    v_mfma_f32_16x16x32_bf16 v[84:87], v[60:63], v[28:31], v[84:87]
    v_mfma_f32_16x16x32_bf16 v[100:103], v[60:63], v[32:35], v[100:103]
    v_mfma_f32_16x16x32_bf16 v[116:119], v[60:63], v[36:39], v[116:119]
    buffer_load_dwordx4 v[60:63], v14, s[44:47], s75 offen offset:3072 sc1
    s_add_u32 s75, s75, 4096
    s_waitcnt vmcnt(9)
    v_mfma_f32_16x16x32_bf16 v[88:91], v[64:67], v[28:31], v[88:91]
    v_mfma_f32_16x16x32_bf16 v[104:107], v[64:67], v[32:35], v[104:107]
    v_mfma_f32_16x16x32_bf16 v[120:123], v[64:67], v[36:39], v[120:123]
    buffer_load_dwordx4 v[64:67], v14, s[44:47], s75 offen offset:0 sc1
    s_waitcnt vmcnt(9)
    v_mfma_f32_16x16x32_bf16 v[92:95], v[68:71], v[28:31], v[92:95]
    v_mfma_f32_16x16x32_bf16 v[108:111], v[68:71], v[32:35], v[108:111]
    v_mfma_f32_16x16x32_bf16 v[124:127], v[68:71], v[36:39], v[124:127]
    buffer_load_dwordx4 v[68:71], v14, s[44:47], s75 offen offset:1024 sc1
    ds_read_b128 v[28:31], v10 offset:1024
    ds_read_b128 v[32:35], v10 offset:9216
    ds_read_b128 v[36:39], v10 offset:17408
    s_waitcnt lgkmcnt(3)
    s_waitcnt vmcnt(9)
    v_mfma_f32_16x16x32_bf16 v[80:83], v[72:75], v[16:19], v[80:83]
    v_mfma_f32_16x16x32_bf16 v[96:99], v[72:75], v[20:23], v[96:99]
    v_mfma_f32_16x16x32_bf16 v[112:115], v[72:75], v[24:27], v[112:115]
    buffer_load_dwordx4 v[72:75], v14, s[44:47], s75 offen offset:2048 sc1
    s_waitcnt vmcnt(9)
    v_mfma_f32_16x16x32_bf16 v[84:87], v[76:79], v[16:19], v[84:87]
    v_mfma_f32_16x16x32_bf16 v[100:103], v[76:79], v[20:23], v[100:103]
    v_mfma_f32_16x16x32_bf16 v[116:119], v[76:79], v[24:27], v[116:119]
    buffer_load_dwordx4 v[76:79], v14, s[44:47], s75 offen offset:3072 sc1
    s_add_u32 s75, s75, 4096
    s_waitcnt vmcnt(9)
    v_mfma_f32_16x16x32_bf16 v[88:91], v[40:43], v[16:19], v[88:91]
    v_mfma_f32_16x16x32_bf16 v[104:107], v[40:43], v[20:23], v[104:107]
    v_mfma_f32_16x16x32_bf16 v[120:123], v[40:43], v[24:27], v[120:123]
    buffer_load_dwordx4 v[40:43], v14, s[44:47], s75 offen offset:0 sc1
    s_waitcnt vmcnt(9)
    v_mfma_f32_16x16x32_bf16 v[92:95], v[44:47], v[16:19], v[92:95]
    v_mfma_f32_16x16x32_bf16 v[108:111], v[44:47], v[20:23], v[108:111]
    v_mfma_f32_16x16x32_bf16 v[124:127], v[44:47], v[24:27], v[124:127]
    buffer_load_dwordx4 v[44:47], v14, s[44:47], s75 offen offset:1024 sc1
    ds_read_b128 v[16:19], v7 offset:1280
    ds_read_b128 v[20:23], v7 offset:9472
    ds_read_b128 v[24:27], v7 offset:17664
    s_waitcnt lgkmcnt(3)
    s_waitcnt vmcnt(9)
    v_mfma_f32_16x16x32_bf16 v[80:83], v[48:51], v[28:31], v[80:83]
    v_mfma_f32_16x16x32_bf16 v[96:99], v[48:51], v[32:35], v[96:99]
    v_mfma_f32_16x16x32_bf16 v[112:115], v[48:51], v[36:39], v[112:115]
    buffer_load_dwordx4 v[48:51], v14, s[44:47], s75 offen offset:2048 sc1
    s_waitcnt vmcnt(9)
    v_mfma_f32_16x16x32_bf16 v[84:87], v[52:55], v[28:31], v[84:87]
    v_mfma_f32_16x16x32_bf16 v[100:103], v[52:55], v[32:35], v[100:103]
    v_mfma_f32_16x16x32_bf16 v[116:119], v[52:55], v[36:39], v[116:119]
    buffer_load_dwordx4 v[52:55], v14, s[44:47], s75 offen offset:3072 sc1
    s_add_u32 s75, s75, 4096
    s_waitcnt vmcnt(9)
    v_mfma_f32_16x16x32_bf16 v[88:91], v[56:59], v[28:31], v[88:91]
    v_mfma_f32_16x16x32_bf16 v[104:107], v[56:59], v[32:35], v[104:107]
    v_mfma_f32_16x16x32_bf16 v[120:123], v[56:59], v[36:39], v[120:123]
    buffer_load_dwordx4 v[56:59], v14, s[44:47], s75 offen offset:0 sc1
    s_waitcnt vmcnt(9)
    v_mfma_f32_16x16x32_bf16 v[92:95], v[60:63], v[28:31], v[92:95]
    v_mfma_f32_16x16x32_bf16 v[108:111], v[60:63], v[32:35], v[108:111]
    v_mfma_f32_16x16x32_bf16 v[124:127], v[60:63], v[36:39], v[124:127]
    buffer_load_dwordx4 v[60:63], v14, s[44:47], s75 offen offset:1024 sc1
    ds_read_b128 v[28:31], v8 offset:1280
    ds_read_b128 v[32:35], v8 offset:9472
    ds_read_b128 v[36:39], v8 offset:17664
    s_waitcnt lgkmcnt(3)
    s_waitcnt vmcnt(9)
    v_mfma_f32_16x16x32_bf16 v[80:83], v[64:67], v[16:19], v[80:83]
    v_mfma_f32_16x16x32_bf16 v[96:99], v[64:67], v[20:23], v[96:99]
    v_mfma_f32_16x16x32_bf16 v[112:115], v[64:67], v[24:27], v[112:115]
    buffer_load_dwordx4 v[64:67], v14, s[44:47], s75 offen offset:2048 sc1
    s_waitcnt vmcnt(9)
    v_mfma_f32_16x16x32_bf16 v[84:87], v[68:71], v[16:19], v[84:87]
    v_mfma_f32_16x16x32_bf16 v[100:103], v[68:71], v[20:23], v[100:103]
    v_mfma_f32_16x16x32_bf16 v[116:119], v[68:71], v[24:27], v[116:119]
    buffer_load_dwordx4 v[68:71], v14, s[44:47], s75 offen offset:3072 sc1
    s_add_u32 s75, s75, 4096
    s_waitcnt vmcnt(9)
    v_mfma_f32_16x16x32_bf16 v[88:91], v[72:75], v[16:19], v[88:91]
    v_mfma_f32_16x16x32_bf16 v[104:107], v[72:75], v[20:23], v[104:107]
    v_mfma_f32_16x16x32_bf16 v[120:123], v[72:75], v[24:27], v[120:123]
    buffer_load_dwordx4 v[72:75], v14, s[44:47], s75 offen offset:0 sc1
    s_waitcnt vmcnt(9)
    v_mfma_f32_16x16x32_bf16 v[92:95], v[76:79], v[16:19], v[92:95]
    v_mfma_f32_16x16x32_bf16 v[108:111], v[76:79], v[20:23], v[108:111]
    v_mfma_f32_16x16x32_bf16 v[124:127], v[76:79], v[24:27], v[124:127]
    buffer_load_dwordx4 v[76:79], v14, s[44:47], s75 offen offset:1024 sc1
    ds_read_b128 v[16:19], v9 offset:1280
    ds_read_b128 v[20:23], v9 offset:9472
    ds_read_b128 v[24:27], v9 offset:17664
    s_waitcnt lgkmcnt(3)
    s_waitcnt vmcnt(9)
    v_mfma_f32_16x16x32_bf16 v[80:83], v[40:43], v[28:31], v[80:83]
    v_mfma_f32_16x16x32_bf16 v[96:99], v[40:43], v[32:35], v[96:99]
    v_mfma_f32_16x16x32_bf16 v[112:115], v[40:43], v[36:39], v[112:115]
    buffer_load_dwordx4 v[40:43], v14, s[44:47], s75 offen offset:2048 sc1
    s_waitcnt vmcnt(9)
    v_mfma_f32_16x16x32_bf16 v[84:87], v[44:47], v[28:31], v[84:87]
    v_mfma_f32_16x16x32_bf16 v[100:103], v[44:47], v[32:35], v[100:103]
    v_mfma_f32_16x16x32_bf16 v[116:119], v[44:47], v[36:39], v[116:119]
    buffer_load_dwordx4 v[44:47], v14, s[44:47], s75 offen offset:3072 sc1
    s_add_u32 s75, s75, 4096
    s_waitcnt vmcnt(9)
    v_mfma_f32_16x16x32_bf16 v[88:91], v[48:51], v[28:31], v[88:91]
    v_mfma_f32_16x16x32_bf16 v[104:107], v[48:51], v[32:35], v[104:107]
    v_mfma_f32_16x16x32_bf16 v[120:123], v[48:51], v[36:39], v[120:123]
    s_add_u32 m0, s70, 0
    s_nop 0
    buffer_load_dwordx4 v13, s[40:43], 0 offen offset:0 lds
    s_waitcnt vmcnt(9)
    v_mfma_f32_16x16x32_bf16 v[92:95], v[52:55], v[28:31], v[92:95]
    v_mfma_f32_16x16x32_bf16 v[108:111], v[52:55], v[32:35], v[108:111]
    v_mfma_f32_16x16x32_bf16 v[124:127], v[52:55], v[36:39], v[124:127]
    buffer_load_dwordx4 v13, s[40:43], s71 offen offset:1024 lds
    ds_read_b128 v[28:31], v10 offset:1280
    ds_read_b128 v[32:35], v10 offset:9472
    ds_read_b128 v[36:39], v10 offset:17664
    s_waitcnt lgkmcnt(3)
    s_waitcnt vmcnt(9)
    v_mfma_f32_16x16x32_bf16 v[80:83], v[56:59], v[16:19], v[80:83]
    v_mfma_f32_16x16x32_bf16 v[96:99], v[56:59], v[20:23], v[96:99]
    v_mfma_f32_16x16x32_bf16 v[112:115], v[56:59], v[24:27], v[112:115]
    buffer_load_dwordx4 v13, s[40:43], s72 offen offset:2048 lds
    s_waitcnt vmcnt(9)
    v_mfma_f32_16x16x32_bf16 v[84:87], v[60:63], v[16:19], v[84:87]
    v_mfma_f32_16x16x32_bf16 v[100:103], v[60:63], v[20:23], v[100:103]
    v_mfma_f32_16x16x32_bf16 v[116:119], v[60:63], v[24:27], v[116:119]
    buffer_load_dwordx4 v13, s[40:43], s73 offen offset:3072 lds
    v_add_u32 v13, 0x4000, v13
    s_waitcnt vmcnt(9)
    v_mfma_f32_16x16x32_bf16 v[88:91], v[64:67], v[16:19], v[88:91]
    v_mfma_f32_16x16x32_bf16 v[104:107], v[64:67], v[20:23], v[104:107]
    v_mfma_f32_16x16x32_bf16 v[120:123], v[64:67], v[24:27], v[120:123]
    s_add_u32 m0, s70, 4096
    s_nop 0
    buffer_load_dwordx4 v13, s[40:43], 0 offen offset:0 lds
    s_waitcnt vmcnt(9)
    v_mfma_f32_16x16x32_bf16 v[92:95], v[68:71], v[16:19], v[92:95]
    v_mfma_f32_16x16x32_bf16 v[108:111], v[68:71], v[20:23], v[108:111]
    v_mfma_f32_16x16x32_bf16 v[124:127], v[68:71], v[24:27], v[124:127]
    buffer_load_dwordx4 v13, s[40:43], s71 offen offset:1024 lds
    s_waitcnt lgkmcnt(0)
    s_waitcnt vmcnt(9)
    v_mfma_f32_16x16x32_bf16 v[80:83], v[72:75], v[28:31], v[80:83]
    v_mfma_f32_16x16x32_bf16 v[96:99], v[72:75], v[32:35], v[96:99]
    v_mfma_f32_16x16x32_bf16 v[112:115], v[72:75], v[36:39], v[112:115]
    buffer_load_dwordx4 v13, s[40:43], s72 offen offset:2048 lds
    s_waitcnt vmcnt(9)
    v_mfma_f32_16x16x32_bf16 v[84:87], v[76:79], v[28:31], v[84:87]
    v_mfma_f32_16x16x32_bf16 v[100:103], v[76:79], v[32:35], v[100:103]
    v_mfma_f32_16x16x32_bf16 v[116:119], v[76:79], v[36:39], v[116:119]
    buffer_load_dwordx4 v13, s[40:43], s73 offen offset:3072 lds
    v_add_u32 v13, 0x4000, v13
    s_waitcnt vmcnt(9)
    v_mfma_f32_16x16x32_bf16 v[88:91], v[40:43], v[28:31], v[88:91]
    v_mfma_f32_16x16x32_bf16 v[104:107], v[40:43], v[32:35], v[104:107]
    v_mfma_f32_16x16x32_bf16 v[120:123], v[40:43], v[36:39], v[120:123]
    s_add_u32 m0, s70, 8192
    s_nop 0
    buffer_load_dwordx4 v13, s[40:43], 0 offen offset:0 lds
    s_waitcnt vmcnt(9)
    v_mfma_f32_16x16x32_bf16 v[92:95], v[44:47], v[28:31], v[92:95]
    v_mfma_f32_16x16x32_bf16 v[108:111], v[44:47], v[32:35], v[108:111]
    v_mfma_f32_16x16x32_bf16 v[124:127], v[44:47], v[36:39], v[124:127]
    buffer_load_dwordx4 v13, s[40:43], s71 offen offset:1024 lds
    s_lshl_b32 s64, s31, 3
    v_add_u32 v0, s64, v4
    v_xor_b32 v0, v0, v3
    v_lshlrev_b32 v0, 4, v0
    v_lshl_add_u32 v0, v3, 9, v0
    v_xor_b32 v1, 64, v0
    s_mov_b32 s76, 0x00ff00ff
    s_mov_b32 s77, 0x00ff00ff
    v_cvt_pk_bf16_f32 v16, v80, v81
    v_cvt_pk_bf16_f32 v17, v82, v83
    v_cvt_pk_bf16_f32 v18, v84, v85
    v_cvt_pk_bf16_f32 v19, v86, v87
    ds_write_b128 v0, v[16:19] offset:21504
    v_cvt_pk_bf16_f32 v20, v88, v89
    v_cvt_pk_bf16_f32 v21, v90, v91
    v_cvt_pk_bf16_f32 v22, v92, v93
    v_cvt_pk_bf16_f32 v23, v94, v95
    ds_write_b128 v1, v[20:23] offset:21504
    v_cvt_pk_bf16_f32 v24, v96, v97
    v_cvt_pk_bf16_f32 v25, v98, v99
    v_cvt_pk_bf16_f32 v26, v100, v101
    v_cvt_pk_bf16_f32 v27, v102, v103
    ds_write_b128 v0, v[24:27] offset:29696
    v_cvt_pk_bf16_f32 v28, v104, v105
    v_cvt_pk_bf16_f32 v29, v106, v107
    v_cvt_pk_bf16_f32 v30, v108, v109
    v_cvt_pk_bf16_f32 v31, v110, v111
    ds_write_b128 v1, v[28:31] offset:29696
    s_mov_b64 exec, s[76:77]
    v_cvt_pk_bf16_f32 v32, v112, v113
    v_cvt_pk_bf16_f32 v33, v114, v115
    v_cvt_pk_bf16_f32 v34, v116, v117
    v_cvt_pk_bf16_f32 v35, v118, v119
    ds_write_b128 v0, v[32:35] offset:37888
    v_cvt_pk_bf16_f32 v36, v120, v121
    v_cvt_pk_bf16_f32 v37, v122, v123
    v_cvt_pk_bf16_f32 v38, v124, v125
    v_cvt_pk_bf16_f32 v39, v126, v127
    ds_write_b128 v1, v[36:39] offset:37888
    s_mov_b64 exec, -1
    s_waitcnt lgkmcnt(0)
    s_barrier
    buffer_load_dwordx4 v13, s[40:43], s72 offen offset:2048 lds
    buffer_load_dwordx4 v13, s[40:43], s73 offen offset:3072 lds
    v_add_u32 v13, 0x4000, v13
    s_add_u32 m0, s70, 12288
    s_nop 0
    buffer_load_dwordx4 v13, s[40:43], 0 offen offset:0 lds
    buffer_load_dwordx4 v13, s[40:43], s71 offen offset:1024 lds
    buffer_load_dwordx4 v13, s[40:43], s72 offen offset:2048 lds
    buffer_load_dwordx4 v13, s[40:43], s73 offen offset:3072 lds
    v_add_u32 v13, 0x4000, v13
    v_lshlrev_b32 v0, 4, v4
    v_lshl_add_u32 v0, v3, 9, v0
    s_mul_i32 s74, s2, 20480
    s_lshl_b32 s64, s31, 7
    s_add_u32 s74, s74, s64
    s_waitcnt vmcnt(0)
    s_barrier
    s_setprio 0
    ds_read_b128 v[16:19], v7 offset:1024
    ds_read_b128 v[20:23], v7 offset:9216
    ds_read_b128 v[24:27], v7 offset:17408
    ds_read_b128 v[28:31], v8 offset:1024
    ds_read_b128 v[32:35], v8 offset:9216
    ds_read_b128 v[36:39], v8 offset:17408
    s_waitcnt lgkmcnt(3)
    v_mfma_f32_16x16x32_bf16 v[80:83], v[128:131], v[16:19], 0
    v_mfma_f32_16x16x32_bf16 v[96:99], v[128:131], v[20:23], 0
    v_mfma_f32_16x16x32_bf16 v[112:115], v[128:131], v[24:27], 0
    v_mfma_f32_16x16x32_bf16 v[84:87], v[132:135], v[16:19], 0
    v_mfma_f32_16x16x32_bf16 v[100:103], v[132:135], v[20:23], 0
    v_mfma_f32_16x16x32_bf16 v[116:119], v[132:135], v[24:27], 0
    v_mfma_f32_16x16x32_bf16 v[88:91], v[136:139], v[16:19], 0
    v_mfma_f32_16x16x32_bf16 v[104:107], v[136:139], v[20:23], 0
    v_mfma_f32_16x16x32_bf16 v[120:123], v[136:139], v[24:27], 0
    v_mfma_f32_16x16x32_bf16 v[92:95], v[140:143], v[16:19], 0
    v_mfma_f32_16x16x32_bf16 v[108:111], v[140:143], v[20:23], 0
    v_mfma_f32_16x16x32_bf16 v[124:127], v[140:143], v[24:27], 0
    ds_read_b64_tr_b16 v[128:129], v11 offset:0
    ds_read_b64_tr_b16 v[130:131], v11 offset:512
    ds_read_b64_tr_b16 v[132:133], v11 offset:8
    ds_read_b64_tr_b16 v[134:135], v11 offset:520
    ds_read_b64_tr_b16 v[136:137], v12 offset:0
    ds_read_b64_tr_b16 v[138:139], v12 offset:512
    ds_read_b64_tr_b16 v[140:141], v12 offset:8
    ds_read_b64_tr_b16 v[142:143], v12 offset:520
    ds_read_b128 v[16:19], v9 offset:1024
    ds_read_b128 v[20:23], v9 offset:9216
    ds_read_b128 v[24:27], v9 offset:17408
    s_waitcnt lgkmcnt(11)
    v_mfma_f32_16x16x32_bf16 v[80:83], v[144:147], v[28:31], v[80:83]
    v_mfma_f32_16x16x32_bf16 v[96:99], v[144:147], v[32:35], v[96:99]
    v_mfma_f32_16x16x32_bf16 v[112:115], v[144:147], v[36:39], v[112:115]
    v_mfma_f32_16x16x32_bf16 v[84:87], v[148:151], v[28:31], v[84:87]
    v_mfma_f32_16x16x32_bf16 v[100:103], v[148:151], v[32:35], v[100:103]
    v_mfma_f32_16x16x32_bf16 v[116:119], v[148:151], v[36:39], v[116:119]
    v_mfma_f32_16x16x32_bf16 v[88:91], v[152:155], v[28:31], v[88:91]
    v_mfma_f32_16x16x32_bf16 v[104:107], v[152:155], v[32:35], v[104:107]
    v_mfma_f32_16x16x32_bf16 v[120:123], v[152:155], v[36:39], v[120:123]
    v_mfma_f32_16x16x32_bf16 v[92:95], v[156:159], v[28:31], v[92:95]
    v_mfma_f32_16x16x32_bf16 v[108:111], v[156:159], v[32:35], v[108:111]
    v_mfma_f32_16x16x32_bf16 v[124:127], v[156:159], v[36:39], v[124:127]
    s_waitcnt lgkmcnt(3)
    s_setprio 2
    s_add_u32 m0, s70, 0
    s_nop 0
    buffer_load_dwordx4 v13, s[40:43], 0 offen offset:0 lds
    buffer_load_dwordx4 v13, s[40:43], s71 offen offset:1024 lds
    buffer_load_dwordx4 v13, s[40:43], s72 offen offset:2048 lds
    buffer_load_dwordx4 v13, s[40:43], s73 offen offset:3072 lds
    v_add_u32 v13, 0x4000, v13
    s_setprio 0
    ds_read_b64_tr_b16 v[144:145], v11 offset:4096
    ds_read_b64_tr_b16 v[146:147], v11 offset:4608
    ds_read_b64_tr_b16 v[148:149], v11 offset:4104
    ds_read_b64_tr_b16 v[150:151], v11 offset:4616
    ds_read_b64_tr_b16 v[152:153], v12 offset:4096
    ds_read_b64_tr_b16 v[154:155], v12 offset:4608
    ds_read_b64_tr_b16 v[156:157], v12 offset:4104
    ds_read_b64_tr_b16 v[158:159], v12 offset:4616
    ds_read_b128 v[28:31], v10 offset:1024
    ds_read_b128 v[32:35], v10 offset:9216
    ds_read_b128 v[36:39], v10 offset:17408
    s_waitcnt lgkmcnt(11)
    v_mfma_f32_16x16x32_bf16 v[80:83], v[160:163], v[16:19], v[80:83]
    v_mfma_f32_16x16x32_bf16 v[96:99], v[160:163], v[20:23], v[96:99]
    v_mfma_f32_16x16x32_bf16 v[112:115], v[160:163], v[24:27], v[112:115]
    v_mfma_f32_16x16x32_bf16 v[84:87], v[164:167], v[16:19], v[84:87]
    v_mfma_f32_16x16x32_bf16 v[100:103], v[164:167], v[20:23], v[100:103]
    v_mfma_f32_16x16x32_bf16 v[116:119], v[164:167], v[24:27], v[116:119]
    v_mfma_f32_16x16x32_bf16 v[88:91], v[168:171], v[16:19], v[88:91]
    v_mfma_f32_16x16x32_bf16 v[104:107], v[168:171], v[20:23], v[104:107]
    v_mfma_f32_16x16x32_bf16 v[120:123], v[168:171], v[24:27], v[120:123]
    v_mfma_f32_16x16x32_bf16 v[92:95], v[172:175], v[16:19], v[92:95]
    v_mfma_f32_16x16x32_bf16 v[108:111], v[172:175], v[20:23], v[108:111]
    v_mfma_f32_16x16x32_bf16 v[124:127], v[172:175], v[24:27], v[124:127]
    s_waitcnt lgkmcnt(3)
    s_setprio 2
    s_add_u32 m0, s70, 4096
    s_nop 0
    buffer_load_dwordx4 v13, s[40:43], 0 offen offset:0 lds
    buffer_load_dwordx4 v13, s[40:43], s71 offen offset:1024 lds
    buffer_load_dwordx4 v13, s[40:43], s72 offen offset:2048 lds
    buffer_load_dwordx4 v13, s[40:43], s73 offen offset:3072 lds
    v_add_u32 v13, 0x4000, v13
    s_setprio 0
    ds_read_b64_tr_b16 v[160:161], v11 offset:8192
    ds_read_b64_tr_b16 v[162:163], v11 offset:8704
    ds_read_b64_tr_b16 v[164:165], v11 offset:8200
    ds_read_b64_tr_b16 v[166:167], v11 offset:8712
    ds_read_b64_tr_b16 v[168:169], v12 offset:8192
    ds_read_b64_tr_b16 v[170:171], v12 offset:8704
    ds_read_b64_tr_b16 v[172:173], v12 offset:8200
    ds_read_b64_tr_b16 v[174:175], v12 offset:8712
    ds_read_b128 v[16:19], v7 offset:1280
    ds_read_b128 v[20:23], v7 offset:9472
    ds_read_b128 v[24:27], v7 offset:17664
    s_waitcnt lgkmcnt(11)
    v_mfma_f32_16x16x32_bf16 v[80:83], v[176:179], v[28:31], v[80:83]
    v_mfma_f32_16x16x32_bf16 v[96:99], v[176:179], v[32:35], v[96:99]
    v_mfma_f32_16x16x32_bf16 v[112:115], v[176:179], v[36:39], v[112:115]
    v_mfma_f32_16x16x32_bf16 v[84:87], v[180:183], v[28:31], v[84:87]
    v_mfma_f32_16x16x32_bf16 v[100:103], v[180:183], v[32:35], v[100:103]
    v_mfma_f32_16x16x32_bf16 v[116:119], v[180:183], v[36:39], v[116:119]
    v_mfma_f32_16x16x32_bf16 v[88:91], v[184:187], v[28:31], v[88:91]
    v_mfma_f32_16x16x32_bf16 v[104:107], v[184:187], v[32:35], v[104:107]
    v_mfma_f32_16x16x32_bf16 v[120:123], v[184:187], v[36:39], v[120:123]
    v_mfma_f32_16x16x32_bf16 v[92:95], v[188:191], v[28:31], v[92:95]
    v_mfma_f32_16x16x32_bf16 v[108:111], v[188:191], v[32:35], v[108:111]
    v_mfma_f32_16x16x32_bf16 v[124:127], v[188:191], v[36:39], v[124:127]
    s_waitcnt lgkmcnt(3)
    s_setprio 2
    s_add_u32 m0, s70, 8192
    s_nop 0
    buffer_load_dwordx4 v13, s[40:43], 0 offen offset:0 lds
    buffer_load_dwordx4 v13, s[40:43], s71 offen offset:1024 lds
    buffer_load_dwordx4 v13, s[40:43], s72 offen offset:2048 lds
    buffer_load_dwordx4 v13, s[40:43], s73 offen offset:3072 lds
    v_add_u32 v13, 0x4000, v13
    s_setprio 0
    ds_read_b64_tr_b16 v[176:177], v11 offset:12288
    ds_read_b64_tr_b16 v[178:179], v11 offset:12800
    ds_read_b64_tr_b16 v[180:181], v11 offset:12296
    ds_read_b64_tr_b16 v[182:183], v11 offset:12808
    ds_read_b64_tr_b16 v[184:185], v12 offset:12288
    ds_read_b64_tr_b16 v[186:187], v12 offset:12800
    ds_read_b64_tr_b16 v[188:189], v12 offset:12296
    ds_read_b64_tr_b16 v[190:191], v12 offset:12808
    ds_read_b128 v[28:31], v8 offset:1280
    ds_read_b128 v[32:35], v8 offset:9472
    ds_read_b128 v[36:39], v8 offset:17664
    s_waitcnt lgkmcnt(11)
    v_mfma_f32_16x16x32_bf16 v[80:83], v[192:195], v[16:19], v[80:83]
    v_mfma_f32_16x16x32_bf16 v[96:99], v[192:195], v[20:23], v[96:99]
    v_mfma_f32_16x16x32_bf16 v[112:115], v[192:195], v[24:27], v[112:115]
    v_mfma_f32_16x16x32_bf16 v[84:87], v[196:199], v[16:19], v[84:87]
    v_mfma_f32_16x16x32_bf16 v[100:103], v[196:199], v[20:23], v[100:103]
    v_mfma_f32_16x16x32_bf16 v[116:119], v[196:199], v[24:27], v[116:119]
    v_mfma_f32_16x16x32_bf16 v[88:91], v[200:203], v[16:19], v[88:91]
    v_mfma_f32_16x16x32_bf16 v[104:107], v[200:203], v[20:23], v[104:107]
    v_mfma_f32_16x16x32_bf16 v[120:123], v[200:203], v[24:27], v[120:123]
    v_mfma_f32_16x16x32_bf16 v[92:95], v[204:207], v[16:19], v[92:95]
    v_mfma_f32_16x16x32_bf16 v[108:111], v[204:207], v[20:23], v[108:111]
    v_mfma_f32_16x16x32_bf16 v[124:127], v[204:207], v[24:27], v[124:127]
    s_waitcnt lgkmcnt(3)
    s_setprio 2
    s_add_u32 m0, s70, 12288
    s_nop 0
    buffer_load_dwordx4 v13, s[40:43], 0 offen offset:0 lds
    buffer_load_dwordx4 v13, s[40:43], s71 offen offset:1024 lds
    buffer_load_dwordx4 v13, s[40:43], s72 offen offset:2048 lds
    buffer_load_dwordx4 v13, s[40:43], s73 offen offset:3072 lds
    v_add_u32 v13, 0x4000, v13
    s_setprio 0
    ds_read_b128 v[16:19], v9 offset:1280
    ds_read_b128 v[20:23], v9 offset:9472
    ds_read_b128 v[24:27], v9 offset:17664
    s_waitcnt lgkmcnt(3)
    v_mfma_f32_16x16x32_bf16 v[80:83], v[208:211], v[28:31], v[80:83]
    v_mfma_f32_16x16x32_bf16 v[96:99], v[208:211], v[32:35], v[96:99]
    v_mfma_f32_16x16x32_bf16 v[112:115], v[208:211], v[36:39], v[112:115]
    v_mfma_f32_16x16x32_bf16 v[84:87], v[212:215], v[28:31], v[84:87]
    v_mfma_f32_16x16x32_bf16 v[100:103], v[212:215], v[32:35], v[100:103]
    v_mfma_f32_16x16x32_bf16 v[116:119], v[212:215], v[36:39], v[116:119]
    v_mfma_f32_16x16x32_bf16 v[88:91], v[216:219], v[28:31], v[88:91]
    v_mfma_f32_16x16x32_bf16 v[104:107], v[216:219], v[32:35], v[104:107]
    v_mfma_f32_16x16x32_bf16 v[120:123], v[216:219], v[36:39], v[120:123]
    v_mfma_f32_16x16x32_bf16 v[92:95], v[220:223], v[28:31], v[92:95]
    v_mfma_f32_16x16x32_bf16 v[108:111], v[220:223], v[32:35], v[108:111]
    v_mfma_f32_16x16x32_bf16 v[124:127], v[220:223], v[36:39], v[124:127]
    ds_read_b128 v[28:31], v10 offset:1280
    ds_read_b128 v[32:35], v10 offset:9472
    ds_read_b128 v[36:39], v10 offset:17664
    s_waitcnt lgkmcnt(3)
    v_mfma_f32_16x16x32_bf16 v[80:83], v[224:227], v[16:19], v[80:83]
    v_mfma_f32_16x16x32_bf16 v[96:99], v[224:227], v[20:23], v[96:99]
    v_mfma_f32_16x16x32_bf16 v[112:115], v[224:227], v[24:27], v[112:115]
    v_mfma_f32_16x16x32_bf16 v[84:87], v[228:231], v[16:19], v[84:87]
    v_mfma_f32_16x16x32_bf16 v[100:103], v[228:231], v[20:23], v[100:103]
    v_mfma_f32_16x16x32_bf16 v[116:119], v[228:231], v[24:27], v[116:119]
    v_mfma_f32_16x16x32_bf16 v[88:91], v[232:235], v[16:19], v[88:91]
    v_mfma_f32_16x16x32_bf16 v[104:107], v[232:235], v[20:23], v[104:107]
    v_mfma_f32_16x16x32_bf16 v[120:123], v[232:235], v[24:27], v[120:123]
    v_mfma_f32_16x16x32_bf16 v[92:95], v[236:239], v[16:19], v[92:95]
    v_mfma_f32_16x16x32_bf16 v[108:111], v[236:239], v[20:23], v[108:111]
    v_mfma_f32_16x16x32_bf16 v[124:127], v[236:239], v[24:27], v[124:127]
    s_waitcnt lgkmcnt(0)
    v_mfma_f32_16x16x32_bf16 v[80:83], v[240:243], v[28:31], v[80:83]
    v_mfma_f32_16x16x32_bf16 v[96:99], v[240:243], v[32:35], v[96:99]
    v_mfma_f32_16x16x32_bf16 v[112:115], v[240:243], v[36:39], v[112:115]
    v_mfma_f32_16x16x32_bf16 v[84:87], v[244:247], v[28:31], v[84:87]
    v_mfma_f32_16x16x32_bf16 v[100:103], v[244:247], v[32:35], v[100:103]
    v_mfma_f32_16x16x32_bf16 v[116:119], v[244:247], v[36:39], v[116:119]
    v_mfma_f32_16x16x32_bf16 v[88:91], v[248:251], v[28:31], v[88:91]
    v_mfma_f32_16x16x32_bf16 v[104:107], v[248:251], v[32:35], v[104:107]
    v_mfma_f32_16x16x32_bf16 v[120:123], v[248:251], v[36:39], v[120:123]
    v_mfma_f32_16x16x32_bf16 v[92:95], v[252:255], v[28:31], v[92:95]
    v_mfma_f32_16x16x32_bf16 v[108:111], v[252:255], v[32:35], v[108:111]
    v_mfma_f32_16x16x32_bf16 v[124:127], v[252:255], v[36:39], v[124:127]
    s_waitcnt vmcnt(12)
    ds_read_b64_tr_b16 v[192:193], v11 offset:0
    ds_read_b64_tr_b16 v[194:195], v11 offset:512
    ds_read_b64_tr_b16 v[196:197], v11 offset:8
    ds_read_b64_tr_b16 v[198:199], v11 offset:520
    ds_read_b64_tr_b16 v[200:201], v12 offset:0
    ds_read_b64_tr_b16 v[202:203], v12 offset:512
    ds_read_b64_tr_b16 v[204:205], v12 offset:8
    ds_read_b64_tr_b16 v[206:207], v12 offset:520
    s_waitcnt vmcnt(8)
    ds_read_b64_tr_b16 v[208:209], v11 offset:4096
    ds_read_b64_tr_b16 v[210:211], v11 offset:4608
    ds_read_b64_tr_b16 v[212:213], v11 offset:4104
    ds_read_b64_tr_b16 v[214:215], v11 offset:4616
    ds_read_b64_tr_b16 v[216:217], v12 offset:4096
    ds_read_b64_tr_b16 v[218:219], v12 offset:4608
    ds_read_b64_tr_b16 v[220:221], v12 offset:4104
    ds_read_b64_tr_b16 v[222:223], v12 offset:4616
    s_waitcnt vmcnt(4)
    ds_read_b64_tr_b16 v[224:225], v11 offset:8192
    ds_read_b64_tr_b16 v[226:227], v11 offset:8704
    ds_read_b64_tr_b16 v[228:229], v11 offset:8200
    ds_read_b64_tr_b16 v[230:231], v11 offset:8712
    ds_read_b64_tr_b16 v[232:233], v12 offset:8192
    ds_read_b64_tr_b16 v[234:235], v12 offset:8704
    ds_read_b64_tr_b16 v[236:237], v12 offset:8200
    ds_read_b64_tr_b16 v[238:239], v12 offset:8712
    s_waitcnt vmcnt(0)
    ds_read_b64_tr_b16 v[240:241], v11 offset:12288
    ds_read_b64_tr_b16 v[242:243], v11 offset:12800
    ds_read_b64_tr_b16 v[244:245], v11 offset:12296
    ds_read_b64_tr_b16 v[246:247], v11 offset:12808
    ds_read_b64_tr_b16 v[248:249], v12 offset:12288
    ds_read_b64_tr_b16 v[250:251], v12 offset:12800
    ds_read_b64_tr_b16 v[252:253], v12 offset:12296
    ds_read_b64_tr_b16 v[254:255], v12 offset:12808
L_spin_20:
    ds_read_b32 v15, v5 offset:32
    s_waitcnt lgkmcnt(0)
    v_readfirstlane_b32 s101, v15
    s_cmp_ge_u32 s101, 8
    s_cbranch_scc0 L_retry_21
    ds_read_b128 v[16:19], v7 offset:41984
    ds_read_b128 v[20:23], v8 offset:41984
    ds_read_b128 v[24:27], v9 offset:41984
    ds_read_b128 v[28:31], v10 offset:41984
    ds_read_b128 v[32:35], v7 offset:42240
    ds_read_b128 v[36:39], v8 offset:42240
    ds_read_b128 v[40:43], v9 offset:42240
    ds_read_b128 v[44:47], v10 offset:42240
    s_waitcnt lgkmcnt(7)
    v_mfma_f32_16x16x32_bf16 v[80:83], v[128:131], v[16:19], v[80:83]
    v_mfma_f32_16x16x32_bf16 v[84:87], v[132:135], v[16:19], v[84:87]
    v_mfma_f32_16x16x32_bf16 v[88:91], v[136:139], v[16:19], v[88:91]
    v_mfma_f32_16x16x32_bf16 v[92:95], v[140:143], v[16:19], v[92:95]
    s_waitcnt lgkmcnt(6)
    v_mfma_f32_16x16x32_bf16 v[80:83], v[144:147], v[20:23], v[80:83]
    v_mfma_f32_16x16x32_bf16 v[84:87], v[148:151], v[20:23], v[84:87]
    v_mfma_f32_16x16x32_bf16 v[88:91], v[152:155], v[20:23], v[88:91]
    v_mfma_f32_16x16x32_bf16 v[92:95], v[156:159], v[20:23], v[92:95]
    s_waitcnt lgkmcnt(5)
    v_mfma_f32_16x16x32_bf16 v[80:83], v[160:163], v[24:27], v[80:83]
    v_mfma_f32_16x16x32_bf16 v[84:87], v[164:167], v[24:27], v[84:87]
    v_mfma_f32_16x16x32_bf16 v[88:91], v[168:171], v[24:27], v[88:91]
    v_mfma_f32_16x16x32_bf16 v[92:95], v[172:175], v[24:27], v[92:95]
    s_waitcnt lgkmcnt(4)
    v_mfma_f32_16x16x32_bf16 v[80:83], v[176:179], v[28:31], v[80:83]
    v_mfma_f32_16x16x32_bf16 v[84:87], v[180:183], v[28:31], v[84:87]
    v_mfma_f32_16x16x32_bf16 v[88:91], v[184:187], v[28:31], v[88:91]
    v_mfma_f32_16x16x32_bf16 v[92:95], v[188:191], v[28:31], v[92:95]
    s_waitcnt lgkmcnt(3)
    v_mfma_f32_16x16x32_bf16 v[80:83], v[192:195], v[32:35], v[80:83]
    v_mfma_f32_16x16x32_bf16 v[84:87], v[196:199], v[32:35], v[84:87]
    v_mfma_f32_16x16x32_bf16 v[88:91], v[200:203], v[32:35], v[88:91]
    v_mfma_f32_16x16x32_bf16 v[92:95], v[204:207], v[32:35], v[92:95]
    s_waitcnt lgkmcnt(2)
    v_mfma_f32_16x16x32_bf16 v[80:83], v[208:211], v[36:39], v[80:83]
    v_mfma_f32_16x16x32_bf16 v[84:87], v[212:215], v[36:39], v[84:87]
    v_mfma_f32_16x16x32_bf16 v[88:91], v[216:219], v[36:39], v[88:91]
    v_mfma_f32_16x16x32_bf16 v[92:95], v[220:223], v[36:39], v[92:95]
    s_waitcnt lgkmcnt(1)
    v_mfma_f32_16x16x32_bf16 v[80:83], v[224:227], v[40:43], v[80:83]
    v_mfma_f32_16x16x32_bf16 v[84:87], v[228:231], v[40:43], v[84:87]
    v_mfma_f32_16x16x32_bf16 v[88:91], v[232:235], v[40:43], v[88:91]
    v_mfma_f32_16x16x32_bf16 v[92:95], v[236:239], v[40:43], v[92:95]
    s_waitcnt lgkmcnt(0)
    v_mfma_f32_16x16x32_bf16 v[80:83], v[240:243], v[44:47], v[80:83]
    v_mfma_f32_16x16x32_bf16 v[84:87], v[244:247], v[44:47], v[84:87]
    v_mfma_f32_16x16x32_bf16 v[88:91], v[248:251], v[44:47], v[88:91]
    v_mfma_f32_16x16x32_bf16 v[92:95], v[252:255], v[44:47], v[92:95]
    s_nop 5
    s_setprio 2
    v_cvt_pk_bf16_f32 v48, v80, v81
    v_cvt_pk_bf16_f32 v49, v82, v83
    v_cvt_pk_bf16_f32 v50, v84, v85
    v_cvt_pk_bf16_f32 v51, v86, v87
    buffer_store_dwordx4 v[48:51], v0, s[48:51], s74 offen offset:0 sc1
    v_cvt_pk_bf16_f32 v52, v88, v89
    v_cvt_pk_bf16_f32 v53, v90, v91
    v_cvt_pk_bf16_f32 v54, v92, v93
    v_cvt_pk_bf16_f32 v55, v94, v95
    buffer_store_dwordx4 v[52:55], v0, s[48:51], s74 offen offset:64 sc1
    s_add_u32 s74, s74, 8192
    s_setprio 0
L_spin_22:
    ds_read_b32 v15, v5 offset:36
    s_waitcnt lgkmcnt(0)
    v_readfirstlane_b32 s101, v15
    s_cmp_ge_u32 s101, 8
    s_cbranch_scc0 L_retry_23
    ds_read_b128 v[16:19], v7 offset:50176
    ds_read_b128 v[20:23], v8 offset:50176
    ds_read_b128 v[24:27], v9 offset:50176
    ds_read_b128 v[28:31], v10 offset:50176
    ds_read_b128 v[32:35], v7 offset:50432
    ds_read_b128 v[36:39], v8 offset:50432
    ds_read_b128 v[40:43], v9 offset:50432
    ds_read_b128 v[44:47], v10 offset:50432
    s_waitcnt lgkmcnt(7)
    v_mfma_f32_16x16x32_bf16 v[96:99], v[128:131], v[16:19], v[96:99]
    v_mfma_f32_16x16x32_bf16 v[100:103], v[132:135], v[16:19], v[100:103]
    v_mfma_f32_16x16x32_bf16 v[104:107], v[136:139], v[16:19], v[104:107]
    v_mfma_f32_16x16x32_bf16 v[108:111], v[140:143], v[16:19], v[108:111]
    s_waitcnt lgkmcnt(6)
    v_mfma_f32_16x16x32_bf16 v[96:99], v[144:147], v[20:23], v[96:99]
    v_mfma_f32_16x16x32_bf16 v[100:103], v[148:151], v[20:23], v[100:103]
    v_mfma_f32_16x16x32_bf16 v[104:107], v[152:155], v[20:23], v[104:107]
    v_mfma_f32_16x16x32_bf16 v[108:111], v[156:159], v[20:23], v[108:111]
    s_waitcnt lgkmcnt(5)
    v_mfma_f32_16x16x32_bf16 v[96:99], v[160:163], v[24:27], v[96:99]
    v_mfma_f32_16x16x32_bf16 v[100:103], v[164:167], v[24:27], v[100:103]
    v_mfma_f32_16x16x32_bf16 v[104:107], v[168:171], v[24:27], v[104:107]
    v_mfma_f32_16x16x32_bf16 v[108:111], v[172:175], v[24:27], v[108:111]
    s_waitcnt lgkmcnt(4)
    v_mfma_f32_16x16x32_bf16 v[96:99], v[176:179], v[28:31], v[96:99]
    v_mfma_f32_16x16x32_bf16 v[100:103], v[180:183], v[28:31], v[100:103]
    v_mfma_f32_16x16x32_bf16 v[104:107], v[184:187], v[28:31], v[104:107]
    v_mfma_f32_16x16x32_bf16 v[108:111], v[188:191], v[28:31], v[108:111]
    s_waitcnt lgkmcnt(3)
    v_mfma_f32_16x16x32_bf16 v[96:99], v[192:195], v[32:35], v[96:99]
    v_mfma_f32_16x16x32_bf16 v[100:103], v[196:199], v[32:35], v[100:103]
    v_mfma_f32_16x16x32_bf16 v[104:107], v[200:203], v[32:35], v[104:107]
    v_mfma_f32_16x16x32_bf16 v[108:111], v[204:207], v[32:35], v[108:111]
    s_waitcnt lgkmcnt(2)
    v_mfma_f32_16x16x32_bf16 v[96:99], v[208:211], v[36:39], v[96:99]
    v_mfma_f32_16x16x32_bf16 v[100:103], v[212:215], v[36:39], v[100:103]
    v_mfma_f32_16x16x32_bf16 v[104:107], v[216:219], v[36:39], v[104:107]
    v_mfma_f32_16x16x32_bf16 v[108:111], v[220:223], v[36:39], v[108:111]
    s_waitcnt lgkmcnt(1)
    v_mfma_f32_16x16x32_bf16 v[96:99], v[224:227], v[40:43], v[96:99]
    v_mfma_f32_16x16x32_bf16 v[100:103], v[228:231], v[40:43], v[100:103]
    v_mfma_f32_16x16x32_bf16 v[104:107], v[232:235], v[40:43], v[104:107]
    v_mfma_f32_16x16x32_bf16 v[108:111], v[236:239], v[40:43], v[108:111]
    s_waitcnt lgkmcnt(0)
    v_mfma_f32_16x16x32_bf16 v[96:99], v[240:243], v[44:47], v[96:99]
    v_mfma_f32_16x16x32_bf16 v[100:103], v[244:247], v[44:47], v[100:103]
    v_mfma_f32_16x16x32_bf16 v[104:107], v[248:251], v[44:47], v[104:107]
    v_mfma_f32_16x16x32_bf16 v[108:111], v[252:255], v[44:47], v[108:111]
    s_nop 5
    s_setprio 2
    v_cvt_pk_bf16_f32 v56, v96, v97
    v_cvt_pk_bf16_f32 v57, v98, v99
    v_cvt_pk_bf16_f32 v58, v100, v101
    v_cvt_pk_bf16_f32 v59, v102, v103
    buffer_store_dwordx4 v[56:59], v0, s[48:51], s74 offen offset:0 sc1
    v_cvt_pk_bf16_f32 v60, v104, v105
    v_cvt_pk_bf16_f32 v61, v106, v107
    v_cvt_pk_bf16_f32 v62, v108, v109
    v_cvt_pk_bf16_f32 v63, v110, v111
    buffer_store_dwordx4 v[60:63], v0, s[48:51], s74 offen offset:64 sc1
    s_add_u32 s74, s74, 8192
    s_setprio 0
L_spin_24:
    ds_read_b32 v15, v5 offset:40
    s_waitcnt lgkmcnt(0)
    v_readfirstlane_b32 s101, v15
    s_cmp_ge_u32 s101, 4
    s_cbranch_scc0 L_retry_25
    ds_read_b128 v[16:19], v7 offset:58368
    ds_read_b128 v[20:23], v8 offset:58368
    ds_read_b128 v[24:27], v9 offset:58368
    ds_read_b128 v[28:31], v10 offset:58368
    ds_read_b128 v[32:35], v7 offset:58624
    ds_read_b128 v[36:39], v8 offset:58624
    ds_read_b128 v[40:43], v9 offset:58624
    ds_read_b128 v[44:47], v10 offset:58624
    s_waitcnt lgkmcnt(7)
    v_mfma_f32_16x16x32_bf16 v[112:115], v[128:131], v[16:19], v[112:115]
    v_mfma_f32_16x16x32_bf16 v[116:119], v[132:135], v[16:19], v[116:119]
    v_mfma_f32_16x16x32_bf16 v[120:123], v[136:139], v[16:19], v[120:123]
    v_mfma_f32_16x16x32_bf16 v[124:127], v[140:143], v[16:19], v[124:127]
    s_waitcnt lgkmcnt(6)
    v_mfma_f32_16x16x32_bf16 v[112:115], v[144:147], v[20:23], v[112:115]
    v_mfma_f32_16x16x32_bf16 v[116:119], v[148:151], v[20:23], v[116:119]
    v_mfma_f32_16x16x32_bf16 v[120:123], v[152:155], v[20:23], v[120:123]
    v_mfma_f32_16x16x32_bf16 v[124:127], v[156:159], v[20:23], v[124:127]
    s_waitcnt lgkmcnt(5)
    v_mfma_f32_16x16x32_bf16 v[112:115], v[160:163], v[24:27], v[112:115]
    v_mfma_f32_16x16x32_bf16 v[116:119], v[164:167], v[24:27], v[116:119]
    v_mfma_f32_16x16x32_bf16 v[120:123], v[168:171], v[24:27], v[120:123]
    v_mfma_f32_16x16x32_bf16 v[124:127], v[172:175], v[24:27], v[124:127]
    s_waitcnt lgkmcnt(4)
    v_mfma_f32_16x16x32_bf16 v[112:115], v[176:179], v[28:31], v[112:115]
    v_mfma_f32_16x16x32_bf16 v[116:119], v[180:183], v[28:31], v[116:119]
    v_mfma_f32_16x16x32_bf16 v[120:123], v[184:187], v[28:31], v[120:123]
    v_mfma_f32_16x16x32_bf16 v[124:127], v[188:191], v[28:31], v[124:127]
    s_waitcnt lgkmcnt(3)
    v_mfma_f32_16x16x32_bf16 v[112:115], v[192:195], v[32:35], v[112:115]
    v_mfma_f32_16x16x32_bf16 v[116:119], v[196:199], v[32:35], v[116:119]
    v_mfma_f32_16x16x32_bf16 v[120:123], v[200:203], v[32:35], v[120:123]
    v_mfma_f32_16x16x32_bf16 v[124:127], v[204:207], v[32:35], v[124:127]
    s_waitcnt lgkmcnt(2)
    v_mfma_f32_16x16x32_bf16 v[112:115], v[208:211], v[36:39], v[112:115]
    v_mfma_f32_16x16x32_bf16 v[116:119], v[212:215], v[36:39], v[116:119]
    v_mfma_f32_16x16x32_bf16 v[120:123], v[216:219], v[36:39], v[120:123]
    v_mfma_f32_16x16x32_bf16 v[124:127], v[220:223], v[36:39], v[124:127]
    s_waitcnt lgkmcnt(1)
    v_mfma_f32_16x16x32_bf16 v[112:115], v[224:227], v[40:43], v[112:115]
    v_mfma_f32_16x16x32_bf16 v[116:119], v[228:231], v[40:43], v[116:119]
    v_mfma_f32_16x16x32_bf16 v[120:123], v[232:235], v[40:43], v[120:123]
    v_mfma_f32_16x16x32_bf16 v[124:127], v[236:239], v[40:43], v[124:127]
    s_waitcnt lgkmcnt(0)
    v_mfma_f32_16x16x32_bf16 v[112:115], v[240:243], v[44:47], v[112:115]
    v_mfma_f32_16x16x32_bf16 v[116:119], v[244:247], v[44:47], v[116:119]
    v_mfma_f32_16x16x32_bf16 v[120:123], v[248:251], v[44:47], v[120:123]
    v_mfma_f32_16x16x32_bf16 v[124:127], v[252:255], v[44:47], v[124:127]
    s_nop 5
    s_setprio 2
    s_mov_b64 exec, s[76:77]
    v_cvt_pk_bf16_f32 v64, v112, v113
    v_cvt_pk_bf16_f32 v65, v114, v115
    v_cvt_pk_bf16_f32 v66, v116, v117
    v_cvt_pk_bf16_f32 v67, v118, v119
    buffer_store_dwordx4 v[64:67], v0, s[48:51], s74 offen offset:0 sc1
    v_cvt_pk_bf16_f32 v68, v120, v121
    v_cvt_pk_bf16_f32 v69, v122, v123
    v_cvt_pk_bf16_f32 v70, v124, v125
    v_cvt_pk_bf16_f32 v71, v126, v127
    buffer_store_dwordx4 v[68:71], v0, s[48:51], s74 offen offset:64 sc1
    s_or_b32 s64, s2, s3
    s_cbranch_scc1 L_noepoch_26
    v_mov_b32 v1, s30
    s_mov_b64 exec, 1
    buffer_store_dword v1, v5, s[44:47], 0 offen
L_noepoch_26:
    s_endpgm
L_retry_16:
    s_sub_u32 s100, s100, 1
    s_cbranch_scc1 L_end
    s_sleep 1
    s_branch L_spin_15
L_mre_17:
    s_sub_u32 s100, s100, 1
    s_cbranch_scc1 L_end
    s_sleep 2
    buffer_load_dword v1, v0, s[44:47], s74 offen sc1
    s_waitcnt vmcnt(0)
    s_branch L_mchk_14
L_retry_19:
    s_sub_u32 s100, s100, 1
    s_cbranch_scc1 L_end
    s_sleep 1
    s_branch L_spin_18
L_retry_21:
    s_sub_u32 s100, s100, 1
    s_cbranch_scc1 L_end
    s_sleep 1
    s_branch L_spin_20
L_retry_23:
    s_sub_u32 s100, s100, 1
    s_cbranch_scc1 L_end
    s_sleep 1
    s_branch L_spin_22
L_retry_25:
    s_sub_u32 s100, s100, 1
    s_cbranch_scc1 L_end
    s_sleep 1
    s_branch L_spin_24
L_end:
    s_endpgm
.section .rodata,"a"
.p2align 6
.amdhsa_kernel standalone__hybrid_graph_tf_exphormer__graph_kernel
  .amdhsa_next_free_vgpr 256
  .amdhsa_next_free_sgpr 102
  .amdhsa_accum_offset 256
  .amdhsa_group_segment_fixed_size 0
  .amdhsa_kernarg_size 104
  .amdhsa_user_sgpr_count 2
  .amdhsa_user_sgpr_kernarg_segment_ptr 1
  .amdhsa_system_sgpr_workgroup_id_x 1
  .amdhsa_float_denorm_mode_32 3
.end_amdhsa_kernel
```

```asm
; @launch grid=(253,1,1) block=(512,1,1) lds=161792
.amdgcn_target "amdgcn-amd-amdhsa--gfx950"
.text
.globl standalone__hybrid_graph_tf_exphormer__graph_kernel
.p2align 8
.type standalone__hybrid_graph_tf_exphormer__graph_kernel,@function
standalone__hybrid_graph_tf_exphormer__graph_kernel:
L_begin:
    s_cmp_ge_u32 s2, 253
    s_cbranch_scc1 L_end
    s_load_dwordx16 s[4:19], s[0:1], 0
    s_load_dwordx8 s[20:27], s[0:1], 64
    s_load_dwordx2 s[28:29], s[0:1], 96
    s_cmp_ge_u32 s2, 16
    s_cbranch_scc1 L_nopf
    s_getpc_b64 s[32:33]
L_pc:
    v_lshlrev_b32 v1, 6, v0
    v_min_u32 v1, L_end-L_pc, v1
    global_load_dword v255, v1, s[32:33]
L_nopf:
    v_lshrrev_b32 v1, 6, v0
    v_lshlrev_b32 v8, 4, v0
    v_mov_b32 v12, 1966080
    v_readfirstlane_b32 s3, v1
    v_mov_b32 v13, 1966080
    v_mov_b32 v14, 1966080
    v_mov_b32 v15, 1966080
    ds_write_b128 v8, v[12:15] offset:41984
    ds_write_b128 v8, v[12:15] offset:50176
    v_subrev_u32 v9, 32, v0
    v_cmp_gt_u32 vcc, 20, v9
    v_mul_u32_u24 v9, 264, v9
    v_add_u32 v9, 148480, v9
    v_lshlrev_b32 v10, 2, v0
    v_cndmask_b32 v9, 0, v9, vcc
    v_min_u32 v11, 1020, v10
    ds_write_b32 v11, v9
    v_mov_b32 v16, 1310740000
    v_mov_b32 v17, 1310740000
    v_mov_b32 v18, 1310740000
    v_mov_b32 v19, 1310740000
    v_add_u32 v9, 148480, v8
    ds_write_b128 v9, v[16:19]
    v_and_b32 v2, 63, v0
    v_and_b32 v3, 15, v0
    v_bfe_u32 v4, v0, 4, 2
    v_mov_b32 v5, 0
    v_mov_b32 v6, 1
    s_mov_b32 s100, 67108864
    s_and_b32 s64, s2, 7
    s_lshl_b32 s64, s64, 1
    s_bfe_u32 s65, s2, 0x10003
    s_or_b32 s64, s64, s65
    s_and_b32 s65, s2, 0xf0
    s_or_b32 s64, s64, s65
    s_cmp_lt_u32 s2, 240
    s_cselect_b32 s1, s64, s2
    s_and_b32 s31, s3, 3
    s_cmp_lt_u32 s3, 4
    s_cbranch_scc1 L_gemm
    s_setprio 3
    v_and_b32 v8, 0xfff, v8
    v_and_b32 v9, 0x3ff, v10
    s_lshr_b32 s66, s2, 4
    s_lshl_b32 s66, s66, 3
    s_and_b32 s67, s2, 7
    s_or_b32 s68, s66, s67
    s_mul_i32 s64, s68, 5120
    v_add_u32 v40, s64, v8
    s_add_u32 s64, s64, 4096
    v_add_u32 v41, s64, v9
    v_lshrrev_b32 v42, 2, v3
    v_and_b32 v43, 3, v3
    v_lshl_add_u32 v46, v42, 3, v43
    v_lshl_add_u32 v42, v42, 4, v43
    s_lshl_b32 s64, s31, 1
    v_mov_b32 v43, s64
    v_lshlrev_b32 v44, 1, v43
    v_cmp_gt_u32 vcc, 8, v3
    s_mul_i32 s65, s1, 640
    v_lshlrev_b32 v7, 4, v3
    v_cndmask_b32 v43, v43, v44, vcc
    v_add_lshl_u32 v42, v42, v43, 4
    v_lshl_add_u32 v42, v4, 2, v42
    v_add_u32 v42, s65, v42
    v_min_u32 v42, 159996, v42
    s_bitcmp1_b32 s2, 3
    s_cbranch_scc0 L_mrole_1
    s_waitcnt lgkmcnt(0)
    global_load_dwordx4 v[48:51], v40, s[8:9]
    global_load_dword v52, v41, s[8:9]
    global_load_dwordx4 v[56:59], v40, s[6:7]
    global_load_dword v60, v41, s[6:7]
L_roled_2:
    global_load_dword v0, v42, s[10:11]
    s_mov_b32 s27, s68
    s_mov_b32 s26, 0
    s_cmp_lg_u32 s31, 0
    s_cbranch_scc1 L_roled_2_b
    s_load_dword s30, s[28:29], 0
L_roled_2_b:
    s_barrier
    s_mov_b32 s32, s4
    s_and_b32 s33, s5, 0xffff
    s_mov_b32 s34, 5120000
    s_mov_b32 s35, 0x20000
    s_mov_b32 s36, s14
    s_and_b32 s37, s15, 0xffff
    s_mov_b32 s38, 20000
    s_mov_b32 s39, 0x20000
    s_add_u32 s40, s28, 1048576
    s_addc_u32 s41, s29, 0
    s_and_b32 s41, s41, 0xffff
    s_mov_b32 s42, 2048000
    s_mov_b32 s43, 0x20000
    v_and_b32 v40, 8, v3
    v_lshlrev_b32 v40, 1, v40
    v_mov_b32 v41, 0xffff
    v_lshlrev_b32 v40, v40, v41
    s_mov_b32 s64, 0x0f0f0f0f
    s_mov_b32 s65, 0x0f0f0f0f
    v_cndmask_b32 v12, 0, v40, s[64:65]
    v_xor_b32 v13, v40, v12
    v_and_b32 v14, 3, v3
    v_mul_u32_u24 v14, 0x55, v14
    s_cmp_lg_u32 s31, 0
    s_cbranch_scc1 L_tagged_3
    s_waitcnt lgkmcnt(0)
    s_mul_i32 s30, s30, 0x9E3779B1
    s_add_u32 s30, s30, 0x7F4A7C15
    v_mov_b32 v40, 1
    v_mov_b32 v41, s30
    ds_write_b64 v5, v[40:41] offset:8
L_tagged_3:
    s_bitcmp1_b32 s2, 3
    s_cbranch_scc0 L_mwork_4
    v_mov_b32 v43, 4
    v_mov_b32 v44, 2031616
    s_mov_b32 s64, 0x3f0001
    v_lshrrev_b32 v40, 7, v8
    v_and_b32 v41, 0x70, v8
    v_lshl_add_u32 v40, v40, 14, v41
    s_lshl_b32 s65, s27, 7
    s_waitcnt vmcnt(3)
    v_mul_u32_u24 v64, 52429, v48
    v_lshrrev_b32 v72, 22, v64
    v_lshlrev_b32 v80, 2, v72
    ds_add_rtn_u32 v80, v80, v43 offset:512
    v_mul_u32_u24 v65, 52429, v49
    v_lshrrev_b32 v73, 22, v65
    v_lshlrev_b32 v81, 2, v73
    ds_add_rtn_u32 v81, v81, v43 offset:512
    v_mul_u32_u24 v66, 52429, v50
    v_lshrrev_b32 v74, 22, v66
    v_lshlrev_b32 v82, 2, v74
    ds_add_rtn_u32 v82, v82, v43 offset:512
    v_mul_u32_u24 v67, 52429, v51
    v_lshrrev_b32 v75, 22, v67
    v_lshlrev_b32 v83, 2, v75
    ds_add_rtn_u32 v83, v83, v43 offset:512
    v_mul_u32_u24 v68, 52429, v52
    v_lshrrev_b32 v76, 22, v68
    v_lshlrev_b32 v84, 2, v76
    ds_add_rtn_u32 v84, v84, v43 offset:512
    v_lshrrev_b32 v64, 21, v64
    v_mad_u32_u24 v64, v64, 24, v48
    v_mul_u32_u24 v64, 0x8001, v64
    v_and_b32 v88, 7, v72
    v_lshl_or_b32 v72, v72, 3, v88
    v_lshlrev_b32 v72, 4, v72
    v_lshrrev_b32 v65, 21, v65
    v_mad_u32_u24 v65, v65, 24, v49
    v_mul_u32_u24 v65, 0x8001, v65
    v_and_b32 v89, 7, v73
    v_lshl_or_b32 v73, v73, 3, v89
    v_lshlrev_b32 v73, 4, v73
    v_lshrrev_b32 v66, 21, v66
    v_mad_u32_u24 v66, v66, 24, v50
    v_mul_u32_u24 v66, 0x8001, v66
    v_and_b32 v90, 7, v74
    v_lshl_or_b32 v74, v74, 3, v90
    v_lshlrev_b32 v74, 4, v74
    v_lshrrev_b32 v67, 21, v67
    v_mad_u32_u24 v67, v67, 24, v51
    v_mul_u32_u24 v67, 0x8001, v67
    v_and_b32 v91, 7, v75
    v_lshl_or_b32 v75, v75, 3, v91
    v_lshlrev_b32 v75, 4, v75
    v_lshrrev_b32 v68, 21, v68
    v_mad_u32_u24 v68, v68, 24, v52
    v_mul_u32_u24 v68, 0x8001, v68
    v_and_b32 v92, 7, v76
    v_lshl_or_b32 v76, v76, 3, v92
    v_lshlrev_b32 v76, 4, v76
    s_waitcnt vmcnt(1)
    v_lshlrev_b32 v56, 1, v56
    v_and_or_b32 v64, v64, s64, v56
    v_lshlrev_b32 v57, 1, v57
    v_and_or_b32 v65, v65, s64, v57
    v_lshlrev_b32 v58, 1, v58
    v_and_or_b32 v66, v66, s64, v58
    v_lshlrev_b32 v59, 1, v59
    v_and_or_b32 v67, v67, s64, v59
    v_lshlrev_b32 v60, 1, v60
    v_and_or_b32 v68, v68, s64, v60
    s_waitcnt lgkmcnt(0)
    v_cmp_gt_u32 vcc, 124, v80
    v_min_u32 v80, 124, v80
    v_xor_b32 v80, v80, v72
    v_cndmask_b32 v64, v44, v64, vcc
    ds_write_b32 v80, v64 offset:41984
    v_cmp_gt_u32 vcc, 124, v81
    v_min_u32 v81, 124, v81
    v_xor_b32 v81, v81, v73
    v_cndmask_b32 v65, v44, v65, vcc
    ds_write_b32 v81, v65 offset:41984
    v_cmp_gt_u32 vcc, 124, v82
    v_min_u32 v82, 124, v82
    v_xor_b32 v82, v82, v74
    v_cndmask_b32 v66, v44, v66, vcc
    ds_write_b32 v82, v66 offset:41984
    v_cmp_gt_u32 vcc, 124, v83
    v_min_u32 v83, 124, v83
    v_xor_b32 v83, v83, v75
    v_cndmask_b32 v67, v44, v67, vcc
    ds_write_b32 v83, v67 offset:41984
    v_cmp_gt_u32 vcc, 124, v84
    v_min_u32 v84, 124, v84
    v_xor_b32 v84, v84, v76
    v_cndmask_b32 v68, v44, v68, vcc
    ds_write_b32 v84, v68 offset:41984
    s_waitcnt lgkmcnt(0)
    s_mov_b64 exec, 1
    ds_add_u32 v5, v6 offset:0
    s_mov_b64 exec, -1
L_spin_6:
    ds_read_b128 v[44:47], v5
    s_waitcnt lgkmcnt(0)
    v_readfirstlane_b32 s101, v44
    v_readfirstlane_b32 s30, v47
    s_cmp_ge_u32 s101, 4
    s_cbranch_scc0 L_retry_7
    ds_read_b128 v[48:51], v8 offset:41984
    ds_read_b128 v[52:55], v8 offset:46080
    ds_read_b128 v[56:59], v8 offset:50176
    ds_read_b128 v[60:63], v8 offset:54272
    s_and_b32 s44, s30, 0xffc00000
    s_lshl_b32 s45, s30, 10
    s_and_b32 s45, s45, 0xffc00000
    s_lshl_b32 s46, s30, 20
    s_and_b32 s46, s46, 0xffc00000
    s_lshl_b32 s47, s30, 22
    s_waitcnt lgkmcnt(3)
    v_or_b32 v48, s44, v48
    v_or_b32 v49, s45, v49
    v_or_b32 v50, s46, v50
    v_or_b32 v51, s47, v51
    buffer_store_dwordx4 v[48:51], v40, s[40:43], s65 offen sc1
    s_add_u32 s65, s65, 0x80000
    s_waitcnt lgkmcnt(2)
    v_or_b32 v52, s44, v52
    v_or_b32 v53, s45, v53
    v_or_b32 v54, s46, v54
    v_or_b32 v55, s47, v55
    buffer_store_dwordx4 v[52:55], v40, s[40:43], s65 offen sc1
    s_add_u32 s65, s65, 0x80000
    s_waitcnt lgkmcnt(1)
    v_or_b32 v56, s44, v56
    v_or_b32 v57, s45, v57
    v_or_b32 v58, s46, v58
    v_or_b32 v59, s47, v59
    buffer_store_dwordx4 v[56:59], v40, s[40:43], s65 offen sc1
    s_add_u32 s65, s65, 0x80000
    s_waitcnt lgkmcnt(0)
    v_or_b32 v60, s44, v60
    v_or_b32 v61, s45, v61
    v_or_b32 v62, s46, v62
    v_or_b32 v63, s47, v63
    buffer_store_dwordx4 v[60:63], v40, s[40:43], s65 offen sc1
    s_cmp_ge_u32 s2, 250
    s_cbranch_scc1 L_end
    s_waitcnt vmcnt(4)
L_worked_5:
    v_lshlrev_b32 v0, 9, v0
    s_setprio 1
    s_lshl_b32 s64, s31, 10
    s_lshr_b32 s10, s1, 1
    s_lshl_b32 s10, s10, 14
    s_add_u32 s11, s10, 4096
    s_add_u32 s12, s10, 8192
    s_add_u32 s13, s10, 12288
    v_cmp_gt_u32 vcc, 0xe80, v8
    s_mov_b64 s[14:15], vcc
    v_add_u32_dpp v9, v0, v7 row_newbcast:0 row_mask:0xf bank_mask:0xf
    s_waitcnt vmcnt(2)
    buffer_load_dwordx4 v[176:179], v9, s[32:35], 0 offen offset:0
    buffer_load_dwordx4 v[180:183], v9, s[32:35], 0 offen offset:256
    v_add_u32_dpp v9, v0, v7 row_newbcast:1 row_mask:0xf bank_mask:0xf
    s_waitcnt vmcnt(2)
    buffer_load_dwordx4 v[184:187], v9, s[32:35], 0 offen offset:0
    buffer_load_dwordx4 v[188:191], v9, s[32:35], 0 offen offset:256
    s_cmp_eq_u32 s26, 0
    s_cbranch_scc1 L_flagged_8
    s_waitcnt vmcnt(4)
    s_mov_b64 exec, 65535
    global_store_dword v41, v42, s[28:29] sc1
    s_mov_b64 exec, -1
L_flagged_8:
    s_add_u32 m0, s64, 62464
    s_mov_b32 s65, 0
    buffer_load_dwordx4 v8, s[36:39], s65 offen lds
    v_add_u32_dpp v9, v0, v7 row_newbcast:2 row_mask:0xf bank_mask:0xf
    s_waitcnt vmcnt(2)
    buffer_load_dwordx4 v[192:195], v9, s[32:35], 0 offen offset:0
    buffer_load_dwordx4 v[196:199], v9, s[32:35], 0 offen offset:256
    s_add_u32 m0, s64, 66560
    s_mov_b32 s65, 4096
    buffer_load_dwordx4 v8, s[36:39], s65 offen lds
    v_add_u32_dpp v9, v0, v7 row_newbcast:3 row_mask:0xf bank_mask:0xf
    s_waitcnt vmcnt(2)
    buffer_load_dwordx4 v[200:203], v9, s[32:35], 0 offen offset:0
    buffer_load_dwordx4 v[204:207], v9, s[32:35], 0 offen offset:256
    v_add_u32_dpp v9, v0, v7 row_newbcast:4 row_mask:0xf bank_mask:0xf
    s_waitcnt vmcnt(2)
    buffer_load_dwordx4 v[208:211], v9, s[32:35], 0 offen offset:0
    buffer_load_dwordx4 v[212:215], v9, s[32:35], 0 offen offset:256
    s_add_u32 m0, s64, 70656
    s_mov_b32 s65, 8192
    buffer_load_dwordx4 v8, s[36:39], s65 offen lds
    v_add_u32_dpp v9, v0, v7 row_newbcast:5 row_mask:0xf bank_mask:0xf
    s_waitcnt vmcnt(2)
    buffer_load_dwordx4 v[216:219], v9, s[32:35], 0 offen offset:0
    buffer_load_dwordx4 v[220:223], v9, s[32:35], 0 offen offset:256
    s_add_u32 m0, s64, 74752
    s_mov_b32 s65, 12288
    buffer_load_dwordx4 v8, s[36:39], s65 offen lds
    v_add_u32_dpp v9, v0, v7 row_newbcast:6 row_mask:0xf bank_mask:0xf
    s_waitcnt vmcnt(2)
    buffer_load_dwordx4 v[224:227], v9, s[32:35], 0 offen offset:0
    buffer_load_dwordx4 v[228:231], v9, s[32:35], 0 offen offset:256
    s_add_u32 m0, s64, 78848
    s_mov_b32 s65, 16384
    buffer_load_dwordx4 v8, s[36:39], s65 offen lds
L_ipoll_9:
    buffer_load_dwordx4 v[48:51], v8, s[40:43], s10 offen sc1
    buffer_load_dwordx4 v[52:55], v8, s[40:43], s11 offen sc1
    buffer_load_dwordx4 v[56:59], v8, s[40:43], s12 offen sc1
    s_mov_b64 exec, s[14:15]
    buffer_load_dwordx4 v[60:63], v8, s[40:43], s13 offen sc1
    s_mov_b64 exec, -1
L_spin_10:
    ds_read_b128 v[44:47], v5
    s_waitcnt lgkmcnt(0)
    v_readfirstlane_b32 s101, v46
    v_readfirstlane_b32 s30, v47
    s_cmp_ge_u32 s101, 1
    s_cbranch_scc0 L_retry_11
    s_and_b32 s44, s30, 0xffc00000
    s_lshl_b32 s45, s30, 10
    s_and_b32 s45, s45, 0xffc00000
    s_lshl_b32 s46, s30, 20
    s_and_b32 s46, s46, 0xffc00000
    s_lshl_b32 s47, s30, 22
    s_and_b32 s64, s1, 1
    s_lshl_b32 s64, s64, 21
    s_or_b32 s44, s44, s64
    v_mov_b32 v76, 1966080
    s_or_b32 s45, s45, s64
    v_mov_b32 v77, 1966080
    s_or_b32 s46, s46, s64
    v_mov_b32 v78, 1966080
    s_or_b32 s47, s47, s64
    v_mov_b32 v79, 1966080
    s_mov_b32 s16, 1310720
    v_mov_b32 v42, 2
    s_waitcnt vmcnt(3)
    v_xor_b32 v64, s44, v48
    v_xor_b32 v65, s45, v49
    v_xor_b32 v66, s46, v50
    v_xor_b32 v67, s47, v51
    v_or3_b32 v40, v64, v65, v66
    v_or_b32 v40, v40, v67
    v_cmp_gt_u32 s[48:49], s16, v64
    v_lshlrev_b32_sdwa v80, 2, v64 dst_sel:DWORD dst_unused:UNUSED_PAD src0_sel:DWORD src1_sel:WORD_1
    v_cmp_gt_u32 s[50:51], s16, v65
    v_lshlrev_b32_sdwa v81, 2, v65 dst_sel:DWORD dst_unused:UNUSED_PAD src0_sel:DWORD src1_sel:WORD_1
    v_cmp_gt_u32 s[52:53], s16, v66
    v_lshlrev_b32_sdwa v82, 2, v66 dst_sel:DWORD dst_unused:UNUSED_PAD src0_sel:DWORD src1_sel:WORD_1
    v_cmp_gt_u32 s[54:55], s16, v67
    v_lshlrev_b32_sdwa v83, 2, v67 dst_sel:DWORD dst_unused:UNUSED_PAD src0_sel:DWORD src1_sel:WORD_1
    s_waitcnt vmcnt(2)
    v_xor_b32 v68, s44, v52
    v_xor_b32 v69, s45, v53
    v_xor_b32 v70, s46, v54
    v_xor_b32 v71, s47, v55
    v_or3_b32 v40, v40, v68, v69
    v_or3_b32 v40, v40, v70, v71
    v_cmp_gt_u32 s[56:57], s16, v68
    v_lshlrev_b32_sdwa v84, 2, v68 dst_sel:DWORD dst_unused:UNUSED_PAD src0_sel:DWORD src1_sel:WORD_1
    v_cmp_gt_u32 s[58:59], s16, v69
    v_lshlrev_b32_sdwa v85, 2, v69 dst_sel:DWORD dst_unused:UNUSED_PAD src0_sel:DWORD src1_sel:WORD_1
    v_cmp_gt_u32 s[60:61], s16, v70
    v_lshlrev_b32_sdwa v86, 2, v70 dst_sel:DWORD dst_unused:UNUSED_PAD src0_sel:DWORD src1_sel:WORD_1
    v_cmp_gt_u32 s[62:63], s16, v71
    v_lshlrev_b32_sdwa v87, 2, v71 dst_sel:DWORD dst_unused:UNUSED_PAD src0_sel:DWORD src1_sel:WORD_1
    s_waitcnt vmcnt(1)
    v_xor_b32 v72, s44, v56
    v_xor_b32 v73, s45, v57
    v_xor_b32 v74, s46, v58
    v_xor_b32 v75, s47, v59
    v_or3_b32 v40, v40, v72, v73
    v_or3_b32 v40, v40, v74, v75
    v_cmp_gt_u32 s[64:65], s16, v72
    v_lshlrev_b32_sdwa v88, 2, v72 dst_sel:DWORD dst_unused:UNUSED_PAD src0_sel:DWORD src1_sel:WORD_1
    v_cmp_gt_u32 s[66:67], s16, v73
    v_lshlrev_b32_sdwa v89, 2, v73 dst_sel:DWORD dst_unused:UNUSED_PAD src0_sel:DWORD src1_sel:WORD_1
    v_cmp_gt_u32 s[68:69], s16, v74
    v_lshlrev_b32_sdwa v90, 2, v74 dst_sel:DWORD dst_unused:UNUSED_PAD src0_sel:DWORD src1_sel:WORD_1
    v_cmp_gt_u32 s[70:71], s16, v75
    v_lshlrev_b32_sdwa v91, 2, v75 dst_sel:DWORD dst_unused:UNUSED_PAD src0_sel:DWORD src1_sel:WORD_1
    s_waitcnt vmcnt(0)
    s_mov_b64 exec, s[14:15]
    v_xor_b32 v76, s44, v60
    v_xor_b32 v77, s45, v61
    v_xor_b32 v78, s46, v62
    v_xor_b32 v79, s47, v63
    s_mov_b64 exec, -1
    v_or3_b32 v40, v40, v76, v77
    v_or3_b32 v40, v40, v78, v79
    v_cmp_gt_u32 s[72:73], s16, v76
    v_lshlrev_b32_sdwa v92, 2, v76 dst_sel:DWORD dst_unused:UNUSED_PAD src0_sel:DWORD src1_sel:WORD_1
    v_cmp_gt_u32 s[74:75], s16, v77
    v_lshlrev_b32_sdwa v93, 2, v77 dst_sel:DWORD dst_unused:UNUSED_PAD src0_sel:DWORD src1_sel:WORD_1
    v_cmp_gt_u32 s[76:77], s16, v78
    v_lshlrev_b32_sdwa v94, 2, v78 dst_sel:DWORD dst_unused:UNUSED_PAD src0_sel:DWORD src1_sel:WORD_1
    v_cmp_gt_u32 s[78:79], s16, v79
    v_lshlrev_b32_sdwa v95, 2, v79 dst_sel:DWORD dst_unused:UNUSED_PAD src0_sel:DWORD src1_sel:WORD_1
    v_cmp_le_u32 vcc, 0x400000, v40
    s_cbranch_vccnz L_retry_12
    s_mov_b64 exec, s[48:49]
    ds_add_rtn_u32 v80, v80, v42 offset:128
    s_mov_b64 exec, s[50:51]
    ds_add_rtn_u32 v81, v81, v42 offset:128
    s_mov_b64 exec, s[52:53]
    ds_add_rtn_u32 v82, v82, v42 offset:128
    s_mov_b64 exec, s[54:55]
    ds_add_rtn_u32 v83, v83, v42 offset:128
    s_mov_b64 exec, s[56:57]
    ds_add_rtn_u32 v84, v84, v42 offset:128
    s_mov_b64 exec, s[58:59]
    ds_add_rtn_u32 v85, v85, v42 offset:128
    s_mov_b64 exec, s[60:61]
    ds_add_rtn_u32 v86, v86, v42 offset:128
    s_mov_b64 exec, s[62:63]
    ds_add_rtn_u32 v87, v87, v42 offset:128
    s_mov_b64 exec, s[64:65]
    ds_add_rtn_u32 v88, v88, v42 offset:128
    s_mov_b64 exec, s[66:67]
    ds_add_rtn_u32 v89, v89, v42 offset:128
    s_mov_b64 exec, s[68:69]
    ds_add_rtn_u32 v90, v90, v42 offset:128
    s_mov_b64 exec, s[70:71]
    ds_add_rtn_u32 v91, v91, v42 offset:128
    s_mov_b64 exec, s[72:73]
    ds_add_rtn_u32 v92, v92, v42 offset:128
    s_mov_b64 exec, s[74:75]
    ds_add_rtn_u32 v93, v93, v42 offset:128
    s_mov_b64 exec, s[76:77]
    ds_add_rtn_u32 v94, v94, v42 offset:128
    s_mov_b64 exec, s[78:79]
    ds_add_rtn_u32 v95, v95, v42 offset:128
    s_mov_b64 exec, -1
    v_add_u32_dpp v9, v0, v7 row_newbcast:7 row_mask:0xf bank_mask:0xf
    buffer_load_dwordx4 v[232:235], v9, s[32:35], 0 offen offset:0
    buffer_load_dwordx4 v[236:239], v9, s[32:35], 0 offen offset:256
    v_add_u32_dpp v9, v0, v7 row_newbcast:8 row_mask:0xf bank_mask:0xf
    buffer_load_dwordx4 v[240:243], v9, s[32:35], 0 offen offset:0
    buffer_load_dwordx4 v[244:247], v9, s[32:35], 0 offen offset:256
    v_and_b32 v48, 2031616, v67
    v_and_b32 v49, 2031616, v71
    v_and_b32 v50, 2031616, v75
    v_and_b32 v51, 2031616, v79
    v_max3_u32 v48, v48, v49, v50
    v_max_u32 v48, v48, v51
    v_cmp_eq_u32 vcc, 2031616, v48
    s_mov_b64 s[16:17], vcc
    s_waitcnt lgkmcnt(12)
    s_mov_b64 exec, s[48:49]
    ds_write_b16 v80, v64
    s_mov_b64 exec, s[50:51]
    ds_write_b16 v81, v65
    s_mov_b64 exec, s[52:53]
    ds_write_b16 v82, v66
    s_mov_b64 exec, s[54:55]
    ds_write_b16 v83, v67
    s_waitcnt lgkmcnt(12)
    s_mov_b64 exec, s[56:57]
    ds_write_b16 v84, v68
    s_mov_b64 exec, s[58:59]
    ds_write_b16 v85, v69
    s_mov_b64 exec, s[60:61]
    ds_write_b16 v86, v70
    s_mov_b64 exec, s[62:63]
    ds_write_b16 v87, v71
    s_waitcnt lgkmcnt(12)
    s_mov_b64 exec, s[64:65]
    ds_write_b16 v88, v72
    s_mov_b64 exec, s[66:67]
    ds_write_b16 v89, v73
    s_mov_b64 exec, s[68:69]
    ds_write_b16 v90, v74
    s_mov_b64 exec, s[70:71]
    ds_write_b16 v91, v75
    s_waitcnt lgkmcnt(12)
    s_mov_b64 exec, s[72:73]
    ds_write_b16 v92, v76
    s_mov_b64 exec, s[74:75]
    ds_write_b16 v93, v77
    s_mov_b64 exec, s[76:77]
    ds_write_b16 v94, v78
    s_mov_b64 exec, s[78:79]
    ds_write_b16 v95, v79
    s_mov_b64 exec, s[16:17]
    ds_write_b32 v5, v6 offset:20
    s_waitcnt lgkmcnt(0)
    s_mov_b64 exec, 1
    ds_add_u32 v5, v6 offset:16
    s_mov_b64 exec, -1
    v_add_u32_dpp v9, v0, v7 row_newbcast:9 row_mask:0xf bank_mask:0xf
    buffer_load_dwordx4 v[248:251], v9, s[32:35], 0 offen offset:0
    buffer_load_dwordx4 v[252:255], v9, s[32:35], 0 offen offset:256
    s_lshl_b32 s20, s31, 1
    s_add_u32 s21, s20, 1
    s_add_u32 s22, s20, 8
    s_add_u32 s23, s20, 9
    s_add_u32 s24, s31, 16
    v_add_u32 v47, -1, v3
    v_bfe_u32 v40, v47, 1, 1
    v_and_b32 v41, 1, v47
    v_lshl_add_u32 v40, v40, 3, v41
    v_add_u32 v40, s20, v40
    v_mov_b32 v41, s24
    v_cmp_ne_u32 vcc, 0, v3
    v_min_u32 v47, 19, v2
    v_mul_u32_u24 v46, 264, v47
    v_cndmask_b32 v40, v41, v40, vcc
    v_mul_u32_u24 v41, 264, v40
    v_add_u32 v41, 148480, v41
    v_lshlrev_b32 v40, 2, v40
    v_add_u32 v46, 148736, v46
    v_lshlrev_b32 v47, 2, v47
    v_lshlrev_b32 v43, 3, v3
    v_lshl_add_u32 v43, v4, 1, v43
L_spin_13:
    ds_read_b32 v44, v5 offset:16
    s_waitcnt lgkmcnt(0)
    v_readfirstlane_b32 s101, v44
    s_cmp_ge_u32 s101, 4
    s_cbranch_scc0 L_retry_14
    ds_read_b32 v44, v40 offset:128
    ds_read_b32 v47, v47 offset:128
    ds_read_b32 v45, v5 offset:20
    s_waitcnt lgkmcnt(2)
    v_sub_u32 v44, v44, v41
    v_add_u32 v44, 6, v44
    v_lshrrev_b32 v44, 3, v44
    v_max_u32 v44, 1, v44
    s_waitcnt lgkmcnt(0)
    v_cmp_gt_u32 vcc, v47, v46
    v_add_u32_dpp v48, v44, v44 row_shr:1 row_mask:0xf bank_mask:0xf bound_ctrl:1
    v_readfirstlane_b32 s25, v45
    s_or_b32 s64, vcc_lo, vcc_hi
    v_add_u32_dpp v48, v48, v48 row_shr:2 row_mask:0xf bank_mask:0xf bound_ctrl:1
    s_or_b32 s25, s25, s64
    s_mov_b64 s[58:59], 0
    v_add_u32_dpp v48, v48, v48 row_shr:4 row_mask:0xf bank_mask:0xf bound_ctrl:1
    v_sub_u32 v44, v48, v44
    v_lshlrev_b32 v44, 3, v44
    v_sub_u32 v44, v41, v44
    v_readlane_b32 s10, v48, 0
    v_readlane_b32 s11, v48, 1
    v_readlane_b32 s12, v48, 2
    v_readlane_b32 s13, v48, 3
    v_readlane_b32 s14, v48, 4
    v_add_u32_dpp v160, v44, v43 row_newbcast:0 row_mask:0xf bank_mask:0xf
    v_add_u32_dpp v161, v44, v43 row_newbcast:1 row_mask:0xf bank_mask:0xf
    v_add_u32_dpp v162, v44, v43 row_newbcast:2 row_mask:0xf bank_mask:0xf
    v_add_u32_dpp v163, v44, v43 row_newbcast:3 row_mask:0xf bank_mask:0xf
    v_add_u32_dpp v164, v44, v43 row_newbcast:4 row_mask:0xf bank_mask:0xf
    s_mov_b32 s50, s14
    s_cmp_gt_u32 s50, 64
    s_cselect_b32 s25, 1, s25
    s_max_u32 s50, s50, 24
    v_add_u32 v40, 0, v3
    v_cmp_le_u32 s[64:65], s10, v40
    v_cmp_le_u32 s[66:67], s11, v40
    v_cmp_le_u32 s[68:69], s12, v40
    v_cmp_le_u32 s[70:71], s13, v40
    v_cndmask_b32 v40, v160, v161, s[64:65]
    v_cndmask_b32 v40, v40, v162, s[66:67]
    v_cndmask_b32 v40, v40, v163, s[68:69]
    v_cndmask_b32 v40, v40, v164, s[70:71]
    ds_read_u16 v40, v40 offset:0
    v_add_u32 v41, 16, v3
    v_cmp_le_u32 s[64:65], s10, v41
    v_cmp_le_u32 s[66:67], s11, v41
    v_cmp_le_u32 s[68:69], s12, v41
    v_cmp_le_u32 s[70:71], s13, v41
    v_cndmask_b32 v41, v160, v161, s[64:65]
    v_cndmask_b32 v41, v41, v162, s[66:67]
    v_cndmask_b32 v41, v41, v163, s[68:69]
    v_cndmask_b32 v41, v41, v164, s[70:71]
    ds_read_u16 v41, v41 offset:128
    v_add_u32 v42, 32, v3
    v_cmp_le_u32 s[64:65], s10, v42
    v_cmp_le_u32 s[66:67], s11, v42
    v_cmp_le_u32 s[68:69], s12, v42
    v_cmp_le_u32 s[70:71], s13, v42
    v_cndmask_b32 v42, v160, v161, s[64:65]
    v_cndmask_b32 v42, v42, v162, s[66:67]
    v_cndmask_b32 v42, v42, v163, s[68:69]
    v_cndmask_b32 v42, v42, v164, s[70:71]
    ds_read_u16 v42, v42 offset:256
    v_add_u32 v43, 48, v3
    v_cmp_le_u32 s[64:65], s10, v43
    v_cmp_le_u32 s[66:67], s11, v43
    v_cmp_le_u32 s[68:69], s12, v43
    v_cmp_le_u32 s[70:71], s13, v43
    v_cndmask_b32 v43, v160, v161, s[64:65]
    v_cndmask_b32 v43, v43, v162, s[66:67]
    v_cndmask_b32 v43, v43, v163, s[68:69]
    v_cndmask_b32 v43, v43, v164, s[70:71]
    ds_read_u16 v43, v43 offset:384
    s_waitcnt lgkmcnt(3)
    v_and_b32 v32, 0x7ffe, v40
    ds_read_u16 v33, v32 offset:62464
    v_lshlrev_b32 v32, 8, v32
    v_lshlrev_b32 v40, 4, v40
    s_waitcnt lgkmcnt(3)
    v_and_b32 v34, 0x7ffe, v41
    ds_read_u16 v35, v34 offset:62464
    v_lshlrev_b32 v34, 8, v34
    v_lshlrev_b32 v41, 4, v41
    s_waitcnt lgkmcnt(3)
    v_and_b32 v36, 0x7ffe, v42
    ds_read_u16 v37, v36 offset:62464
    v_lshlrev_b32 v36, 8, v36
    v_lshlrev_b32 v42, 4, v42
    s_waitcnt lgkmcnt(3)
    v_and_b32 v38, 0x7ffe, v43
    ds_read_u16 v39, v38 offset:62464
    v_lshlrev_b32 v38, 8, v38
    v_lshlrev_b32 v43, 4, v43
    v_add_u32_dpp v11, v32, v7 row_newbcast:0 row_mask:0xf bank_mask:0xf
    buffer_load_dwordx4 v[48:51], v11, s[32:35], 0 offen offset:0
    buffer_load_dwordx4 v[52:55], v11, s[32:35], 0 offen offset:256
    v_add_u32_dpp v11, v32, v7 row_newbcast:1 row_mask:0xf bank_mask:0xf
    buffer_load_dwordx4 v[56:59], v11, s[32:35], 0 offen offset:0
    buffer_load_dwordx4 v[60:63], v11, s[32:35], 0 offen offset:256
    v_add_u32_dpp v11, v32, v7 row_newbcast:2 row_mask:0xf bank_mask:0xf
    buffer_load_dwordx4 v[64:67], v11, s[32:35], 0 offen offset:0
    buffer_load_dwordx4 v[68:71], v11, s[32:35], 0 offen offset:256
    v_add_u32_dpp v11, v32, v7 row_newbcast:3 row_mask:0xf bank_mask:0xf
    buffer_load_dwordx4 v[72:75], v11, s[32:35], 0 offen offset:0
    buffer_load_dwordx4 v[76:79], v11, s[32:35], 0 offen offset:256
    v_add_u32_dpp v11, v32, v7 row_newbcast:4 row_mask:0xf bank_mask:0xf
    buffer_load_dwordx4 v[80:83], v11, s[32:35], 0 offen offset:0
    buffer_load_dwordx4 v[84:87], v11, s[32:35], 0 offen offset:256
    v_add_u32_dpp v11, v32, v7 row_newbcast:5 row_mask:0xf bank_mask:0xf
    buffer_load_dwordx4 v[88:91], v11, s[32:35], 0 offen offset:0
    buffer_load_dwordx4 v[92:95], v11, s[32:35], 0 offen offset:256
    s_sub_u32 s64, s10, 1
    s_bitset1_b64 s[58:59], s64
    s_and_b32 s65, s20, 7
    s_lshl_b32 s65, s65, 5
    s_lshl_b32 s15, s20, 10
    s_or_b32 s15, s15, s65
    s_sub_u32 s64, s11, 1
    s_bitset1_b64 s[58:59], s64
    s_and_b32 s65, s21, 7
    s_lshl_b32 s65, s65, 5
    s_lshl_b32 s16, s21, 10
    s_or_b32 s16, s16, s65
    s_sub_u32 s64, s12, 1
    s_bitset1_b64 s[58:59], s64
    s_and_b32 s65, s22, 7
    s_lshl_b32 s65, s65, 5
    s_lshl_b32 s17, s22, 10
    s_or_b32 s17, s17, s65
    s_sub_u32 s64, s13, 1
    s_bitset1_b64 s[58:59], s64
    s_and_b32 s65, s23, 7
    s_lshl_b32 s65, s65, 5
    s_lshl_b32 s18, s23, 10
    s_or_b32 s18, s18, s65
    s_sub_u32 s64, s14, 1
    s_bitset1_b64 s[58:59], s64
    s_and_b32 s65, s24, 7
    s_lshl_b32 s65, s65, 5
    s_lshl_b32 s19, s24, 10
    s_or_b32 s19, s19, s65
    s_sub_u32 s64, s50, 9
    s_lshl_b64 s[60:61], 1, s64
    s_or_b64 s[52:53], s[60:61], s[58:59]
    v_lshrrev_b32 v44, 1, v4
    v_mul_u32_u24 v44, 528, v44
    v_xor_b32 v44, v44, v7
    v_and_b32 v45, 1, v4
    v_lshl_or_b32 v2, v45, 3, v44
    v_xor_b32 v144, s15, v7
    v_xor_b32 v146, s16, v7
    v_xor_b32 v148, s19, v7
    v_xor_b32 v145, 528, v144
    v_xor_b32 v147, 528, v146
    v_xor_b32 v149, 528, v148
    s_mul_i32 s64, s1, 80
    s_add_u32 s64, s64, 62464
    v_and_b32 v45, 2, v4
    v_add_u32 v0, s64, v45
    s_getpc_b64 s[72:73]
L_anc:
    s_add_u32 s56, s72, L_wtab-L_anc
    s_addc_u32 s57, s73, 0
    s_mov_b32 s62, L_fp1-L_anc
    s_mov_b32 s63, L_fp1-L_fp0
    s_mov_b32 s70, L_dr1-L_anc
    s_mov_b32 s71, L_dr1-L_dr0
    s_mov_b32 s26, 0
    v_mov_b32 v28, 0
    s_lshl_b32 s64, s31, 2
    v_mov_b32 v29, s64
    v_and_b32 v9, 8, v3
    v_lshlrev_b32 v9, 1, v9
    s_mov_b32 s66, 0x22222222
    s_mov_b32 s67, 0x22222222
    s_mov_b32 s68, 0x44444444
    s_mov_b32 s69, 0x44444444
    v_mov_b64 v[150:151], 0
    v_mov_b64 v[152:153], 0
    v_mov_b64 v[154:155], 0
    v_mov_b64 v[156:157], 0
    v_mov_b64 v[158:159], 0
    v_mov_b64 v[16:17], 0
    v_mov_b64 v[18:19], 0
    v_mov_b64 v[20:21], 0
    v_mov_b64 v[22:23], 0
    s_waitcnt lgkmcnt(0)
    v_lshlrev_b32 v33, v40, v33
    v_lshlrev_b32 v35, v41, v35
    v_lshlrev_b32 v37, v42, v37
    v_lshlrev_b32 v39, v43, v39
    s_waitcnt vmcnt(12)
    s_barrier
    ds_read_b128 v[160:163], v144 offset:21504
    ds_read_b128 v[164:167], v144 offset:21760
    ds_read_b128 v[168:171], v145 offset:21504
    ds_read_b128 v[172:175], v145 offset:21760
    s_waitcnt lgkmcnt(2)
    v_dot2c_f32_bf16 v150, v176, v160
    v_dot2c_f32_bf16 v150, v177, v161
    v_dot2c_f32_bf16 v150, v178, v162
    v_dot2c_f32_bf16 v150, v179, v163
    v_dot2c_f32_bf16 v150, v180, v164
    v_dot2c_f32_bf16 v150, v181, v165
    v_dot2c_f32_bf16 v150, v182, v166
    v_dot2c_f32_bf16 v150, v183, v167
    v_add_u32_dpp v11, v32, v7 row_newbcast:6 row_mask:0xf bank_mask:0xf
    buffer_load_dwordx4 v[96:99], v11, s[32:35], 0 offen offset:0
    buffer_load_dwordx4 v[100:103], v11, s[32:35], 0 offen offset:256
    ds_read_b128 v[160:163], v146 offset:21504
    ds_read_b128 v[164:167], v146 offset:21760
    s_waitcnt lgkmcnt(2)
    v_dot2c_f32_bf16 v151, v184, v168
    v_dot2c_f32_bf16 v151, v185, v169
    v_dot2c_f32_bf16 v151, v186, v170
    v_dot2c_f32_bf16 v151, v187, v171
    v_dot2c_f32_bf16 v151, v188, v172
    v_dot2c_f32_bf16 v151, v189, v173
    v_dot2c_f32_bf16 v151, v190, v174
    v_dot2c_f32_bf16 v151, v191, v175
    v_add_u32_dpp v11, v32, v7 row_newbcast:7 row_mask:0xf bank_mask:0xf
    buffer_load_dwordx4 v[104:107], v11, s[32:35], 0 offen offset:0
    buffer_load_dwordx4 v[108:111], v11, s[32:35], 0 offen offset:256
    ds_read_b128 v[168:171], v147 offset:21504
    ds_read_b128 v[172:175], v147 offset:21760
    s_waitcnt lgkmcnt(2)
    v_dot2c_f32_bf16 v152, v192, v160
    v_dot2c_f32_bf16 v152, v193, v161
    v_dot2c_f32_bf16 v152, v194, v162
    v_dot2c_f32_bf16 v152, v195, v163
    v_dot2c_f32_bf16 v152, v196, v164
    v_dot2c_f32_bf16 v152, v197, v165
    v_dot2c_f32_bf16 v152, v198, v166
    v_dot2c_f32_bf16 v152, v199, v167
    v_add_f32_dpp v150, v150, v150 row_ror:8 row_mask:0xf bank_mask:0x3
    v_add_f32_dpp v150, v151, v151 row_ror:8 row_mask:0xf bank_mask:0xc
    v_add_u32_dpp v11, v32, v7 row_newbcast:8 row_mask:0xf bank_mask:0xf
    buffer_load_dwordx4 v[112:115], v11, s[32:35], 0 offen offset:0
    buffer_load_dwordx4 v[116:119], v11, s[32:35], 0 offen offset:256
    ds_read_b128 v[160:163], v144 offset:29696
    ds_read_b128 v[164:167], v144 offset:29952
    s_waitcnt lgkmcnt(2)
    v_dot2c_f32_bf16 v153, v200, v168
    v_dot2c_f32_bf16 v153, v201, v169
    v_dot2c_f32_bf16 v153, v202, v170
    v_dot2c_f32_bf16 v153, v203, v171
    v_dot2c_f32_bf16 v153, v204, v172
    v_dot2c_f32_bf16 v153, v205, v173
    v_dot2c_f32_bf16 v153, v206, v174
    v_dot2c_f32_bf16 v153, v207, v175
    v_add_u32_dpp v11, v32, v7 row_newbcast:9 row_mask:0xf bank_mask:0xf
    buffer_load_dwordx4 v[120:123], v11, s[32:35], 0 offen offset:0
    buffer_load_dwordx4 v[124:127], v11, s[32:35], 0 offen offset:256
    ds_read_b128 v[168:171], v145 offset:29696
    ds_read_b128 v[172:175], v145 offset:29952
    s_waitcnt lgkmcnt(2)
    v_dot2c_f32_bf16 v154, v208, v160
    v_dot2c_f32_bf16 v154, v209, v161
    v_dot2c_f32_bf16 v154, v210, v162
    v_dot2c_f32_bf16 v154, v211, v163
    v_dot2c_f32_bf16 v154, v212, v164
    v_dot2c_f32_bf16 v154, v213, v165
    v_dot2c_f32_bf16 v154, v214, v166
    v_dot2c_f32_bf16 v154, v215, v167
    v_add_f32_dpp v152, v152, v152 row_ror:8 row_mask:0xf bank_mask:0x3
    v_add_f32_dpp v152, v153, v153 row_ror:8 row_mask:0xf bank_mask:0xc
    v_add_u32_dpp v11, v32, v7 row_newbcast:10 row_mask:0xf bank_mask:0xf
    buffer_load_dwordx4 v[128:131], v11, s[32:35], 0 offen offset:0
    buffer_load_dwordx4 v[132:135], v11, s[32:35], 0 offen offset:256
    ds_read_b128 v[160:163], v146 offset:29696
    ds_read_b128 v[164:167], v146 offset:29952
    s_waitcnt lgkmcnt(2)
    v_dot2c_f32_bf16 v155, v216, v168
    v_dot2c_f32_bf16 v155, v217, v169
    v_dot2c_f32_bf16 v155, v218, v170
    v_dot2c_f32_bf16 v155, v219, v171
    v_dot2c_f32_bf16 v155, v220, v172
    v_dot2c_f32_bf16 v155, v221, v173
    v_dot2c_f32_bf16 v155, v222, v174
    v_dot2c_f32_bf16 v155, v223, v175
    v_add_f32_dpp v150, v150, v150 row_half_mirror row_mask:0xf bank_mask:0x5
    v_add_f32_dpp v150, v152, v152 row_half_mirror row_mask:0xf bank_mask:0xa
    v_add_u32_dpp v11, v32, v7 row_newbcast:11 row_mask:0xf bank_mask:0xf
    buffer_load_dwordx4 v[136:139], v11, s[32:35], 0 offen offset:0
    buffer_load_dwordx4 v[140:143], v11, s[32:35], 0 offen offset:256
    ds_read_b128 v[168:171], v147 offset:29696
    ds_read_b128 v[172:175], v147 offset:29952
    s_waitcnt lgkmcnt(2)
    v_dot2c_f32_bf16 v156, v224, v160
    v_dot2c_f32_bf16 v156, v225, v161
    v_dot2c_f32_bf16 v156, v226, v162
    v_dot2c_f32_bf16 v156, v227, v163
    v_dot2c_f32_bf16 v156, v228, v164
    v_dot2c_f32_bf16 v156, v229, v165
    v_dot2c_f32_bf16 v156, v230, v166
    v_dot2c_f32_bf16 v156, v231, v167
    v_add_f32_dpp v154, v154, v154 row_ror:8 row_mask:0xf bank_mask:0x3
    v_add_f32_dpp v154, v155, v155 row_ror:8 row_mask:0xf bank_mask:0xc
    ds_read_b128 v[160:163], v148 offset:21504
    ds_read_b128 v[164:167], v148 offset:21760
    s_waitcnt lgkmcnt(2)
    v_dot2c_f32_bf16 v157, v232, v168
    v_dot2c_f32_bf16 v157, v233, v169
    v_dot2c_f32_bf16 v157, v234, v170
    v_dot2c_f32_bf16 v157, v235, v171
    v_dot2c_f32_bf16 v157, v236, v172
    v_dot2c_f32_bf16 v157, v237, v173
    v_dot2c_f32_bf16 v157, v238, v174
    v_dot2c_f32_bf16 v157, v239, v175
    ds_read_b128 v[168:171], v149 offset:21504
    ds_read_b128 v[172:175], v149 offset:21760
    s_waitcnt lgkmcnt(2)
    v_dot2c_f32_bf16 v158, v240, v160
    v_dot2c_f32_bf16 v158, v241, v161
    v_dot2c_f32_bf16 v158, v242, v162
    v_dot2c_f32_bf16 v158, v243, v163
    v_dot2c_f32_bf16 v158, v244, v164
    v_dot2c_f32_bf16 v158, v245, v165
    v_dot2c_f32_bf16 v158, v246, v166
    v_dot2c_f32_bf16 v158, v247, v167
    v_add_f32_dpp v156, v156, v156 row_ror:8 row_mask:0xf bank_mask:0x3
    v_add_f32_dpp v156, v157, v157 row_ror:8 row_mask:0xf bank_mask:0xc
    s_waitcnt lgkmcnt(0)
    v_dot2c_f32_bf16 v159, v248, v168
    v_dot2c_f32_bf16 v159, v249, v169
    v_dot2c_f32_bf16 v159, v250, v170
    v_dot2c_f32_bf16 v159, v251, v171
    v_dot2c_f32_bf16 v159, v252, v172
    v_dot2c_f32_bf16 v159, v253, v173
    v_dot2c_f32_bf16 v159, v254, v174
    v_dot2c_f32_bf16 v159, v255, v175
    v_add_f32_dpp v154, v154, v154 row_half_mirror row_mask:0xf bank_mask:0x5
    v_add_f32_dpp v154, v156, v156 row_half_mirror row_mask:0xf bank_mask:0xa
    v_add_f32_dpp v150, v150, v150 quad_perm:[1,0,3,2] row_mask:0xf bank_mask:0xf
    s_nop 0
    v_add_f32_dpp v158, v158, v158 row_ror:8 row_mask:0xf bank_mask:0x3
    v_add_f32_dpp v158, v159, v159 row_ror:8 row_mask:0xf bank_mask:0xc
    v_add_f32_dpp v154, v154, v154 quad_perm:[1,0,3,2] row_mask:0xf bank_mask:0xf
    v_add_f32_dpp v150, v150, v150 quad_perm:[2,3,0,1] row_mask:0xf bank_mask:0xf
    v_add_f32_dpp v158, v158, v158 row_half_mirror row_mask:0xf bank_mask:0x5
    v_add_f32_dpp v154, v154, v154 quad_perm:[2,3,0,1] row_mask:0xf bank_mask:0xf
    s_nop 0
    v_add_f32_dpp v158, v158, v158 quad_perm:[1,0,3,2] row_mask:0xf bank_mask:0xf
    v_cndmask_b32 v150, v150, v154, s[66:67]
    s_nop 0
    v_add_f32_dpp v158, v158, v158 quad_perm:[2,3,0,1] row_mask:0xf bank_mask:0xf
    v_cndmask_b32 v150, v150, v158, s[68:69]
    v_mul_f32 v150, 0x3db8aa3b, v150
    v_exp_f32 v150, v150
    s_nop 0
    v_mov_b32 v44, v150
    v_mov_b32 v45, v150
    s_nop 1
    v_permlane32_swap_b32 v44, v45
    v_add_f32 v44, v44, v45
    v_mov_b32 v45, v44
    s_nop 1
    v_permlane16_swap_b32 v44, v45
    v_add_f32 v44, v44, v45
    v_add_f32 v44, 0x3089705f, v44
    v_rcp_f32 v44, v44
    s_nop 0
    v_mul_f32 v150, v150, v44
    v_cvt_pk_bf16_f32 v150, v150, 0
    v_lshlrev_b32 v8, v9, v150
    s_nop 1
    v_and_b32_dpp v24, v8, v12 row_newbcast:0 row_mask:0xf bank_mask:0xf
    v_and_b32_dpp v25, v8, v13 row_newbcast:0 row_mask:0xf bank_mask:0xf
    v_mov_b64 v[40:41], 0
    v_mov_b64 v[42:43], 0
    v_mov_b64 v[44:45], 0
    v_mov_b64 v[46:47], 0
    v_smfmac_f32_16x16x32_bf16 v[40:43], v[24:25], v[176:179], v14
    v_and_b32_dpp v26, v8, v12 row_newbcast:8 row_mask:0xf bank_mask:0xf
    v_and_b32_dpp v27, v8, v13 row_newbcast:8 row_mask:0xf bank_mask:0xf
    v_smfmac_f32_16x16x32_bf16 v[44:47], v[24:25], v[180:183], v14
    v_add_u32_dpp v11, v32, v7 row_newbcast:12 row_mask:0xf bank_mask:0xf
    buffer_load_dwordx4 v[144:147], v11, s[32:35], 0 offen offset:0
    buffer_load_dwordx4 v[148:151], v11, s[32:35], 0 offen offset:256
    v_smfmac_f32_16x16x32_bf16 v[40:43], v[26:27], v[184:187], v14
    v_and_b32_dpp v24, v8, v12 row_newbcast:4 row_mask:0xf bank_mask:0xf
    v_and_b32_dpp v25, v8, v13 row_newbcast:4 row_mask:0xf bank_mask:0xf
    v_smfmac_f32_16x16x32_bf16 v[44:47], v[26:27], v[188:191], v14
    s_nop 0
    v_smfmac_f32_16x16x32_bf16 v[16:19], v[24:25], v[192:195], v14
    v_and_b32_dpp v26, v8, v12 row_newbcast:12 row_mask:0xf bank_mask:0xf
    v_and_b32_dpp v27, v8, v13 row_newbcast:12 row_mask:0xf bank_mask:0xf
    v_smfmac_f32_16x16x32_bf16 v[20:23], v[24:25], v[196:199], v14
    v_add_u32_dpp v11, v32, v7 row_newbcast:13 row_mask:0xf bank_mask:0xf
    buffer_load_dwordx4 v[152:155], v11, s[32:35], 0 offen offset:0
    buffer_load_dwordx4 v[156:159], v11, s[32:35], 0 offen offset:256
    v_smfmac_f32_16x16x32_bf16 v[16:19], v[26:27], v[200:203], v14
    v_and_b32_dpp v24, v8, v12 row_newbcast:1 row_mask:0xf bank_mask:0xf
    v_and_b32_dpp v25, v8, v13 row_newbcast:1 row_mask:0xf bank_mask:0xf
    v_smfmac_f32_16x16x32_bf16 v[20:23], v[26:27], v[204:207], v14
    v_xor_b32 v178, s15, v2
    s_lshl_b32 s64, s20, 2
    v_add_u32 v9, s64, v0
    v_mov_b32 v179, 0
    v_cvt_pk_bf16_f32 v30, v40, v41
    v_cvt_pk_bf16_f32 v31, v42, v43
    ds_write_b64 v178, v[30:31] offset:1024
    v_cvt_pk_bf16_f32 v30, v44, v45
    v_cvt_pk_bf16_f32 v31, v46, v47
    ds_write_b64 v178, v[30:31] offset:1280
    ds_read_u16_d16_hi v179, v9
    v_mov_b64 v[40:41], 0
    v_mov_b64 v[42:43], 0
    v_mov_b64 v[44:45], 0
    v_mov_b64 v[46:47], 0
    s_nop 0
    v_smfmac_f32_16x16x32_bf16 v[40:43], v[24:25], v[208:211], v14
    v_and_b32_dpp v26, v8, v12 row_newbcast:9 row_mask:0xf bank_mask:0xf
    v_and_b32_dpp v27, v8, v13 row_newbcast:9 row_mask:0xf bank_mask:0xf
    v_smfmac_f32_16x16x32_bf16 v[44:47], v[24:25], v[212:215], v14
    v_add_u32_dpp v11, v32, v7 row_newbcast:14 row_mask:0xf bank_mask:0xf
    buffer_load_dwordx4 v[160:163], v11, s[32:35], 0 offen offset:0
    buffer_load_dwordx4 v[164:167], v11, s[32:35], 0 offen offset:256
    v_smfmac_f32_16x16x32_bf16 v[40:43], v[26:27], v[216:219], v14
    v_and_b32_dpp v24, v8, v12 row_newbcast:5 row_mask:0xf bank_mask:0xf
    v_and_b32_dpp v25, v8, v13 row_newbcast:5 row_mask:0xf bank_mask:0xf
    v_smfmac_f32_16x16x32_bf16 v[44:47], v[26:27], v[220:223], v14
    v_xor_b32 v180, s16, v2
    s_lshl_b32 s64, s21, 2
    v_add_u32 v9, s64, v0
    v_mov_b32 v181, 0
    v_cvt_pk_bf16_f32 v30, v16, v17
    v_cvt_pk_bf16_f32 v31, v18, v19
    ds_write_b64 v180, v[30:31] offset:1024
    v_cvt_pk_bf16_f32 v30, v20, v21
    v_cvt_pk_bf16_f32 v31, v22, v23
    ds_write_b64 v180, v[30:31] offset:1280
    ds_read_u16_d16_hi v181, v9
    v_mov_b64 v[16:17], 0
    v_mov_b64 v[18:19], 0
    v_mov_b64 v[20:21], 0
    v_mov_b64 v[22:23], 0
    s_nop 0
    v_smfmac_f32_16x16x32_bf16 v[16:19], v[24:25], v[224:227], v14
    v_and_b32_dpp v26, v8, v12 row_newbcast:13 row_mask:0xf bank_mask:0xf
    v_and_b32_dpp v27, v8, v13 row_newbcast:13 row_mask:0xf bank_mask:0xf
    v_smfmac_f32_16x16x32_bf16 v[20:23], v[24:25], v[228:231], v14
    v_add_u32_dpp v11, v32, v7 row_newbcast:15 row_mask:0xf bank_mask:0xf
    buffer_load_dwordx4 v[168:171], v11, s[32:35], 0 offen offset:0
    buffer_load_dwordx4 v[172:175], v11, s[32:35], 0 offen offset:256
    v_smfmac_f32_16x16x32_bf16 v[16:19], v[26:27], v[232:235], v14
    v_and_b32_dpp v24, v8, v12 row_newbcast:2 row_mask:0xf bank_mask:0xf
    v_and_b32_dpp v25, v8, v13 row_newbcast:2 row_mask:0xf bank_mask:0xf
    v_smfmac_f32_16x16x32_bf16 v[20:23], v[26:27], v[236:239], v14
    v_xor_b32 v182, s17, v2
    s_lshl_b32 s64, s22, 2
    v_add_u32 v9, s64, v0
    v_mov_b32 v183, 0
    v_cvt_pk_bf16_f32 v30, v40, v41
    v_cvt_pk_bf16_f32 v31, v42, v43
    ds_write_b64 v182, v[30:31] offset:1024
    v_cvt_pk_bf16_f32 v30, v44, v45
    v_cvt_pk_bf16_f32 v31, v46, v47
    ds_write_b64 v182, v[30:31] offset:1280
    ds_read_u16_d16_hi v183, v9
    v_mov_b64 v[40:41], 0
    v_mov_b64 v[42:43], 0
    v_mov_b64 v[44:45], 0
    v_mov_b64 v[46:47], 0
    s_nop 0
    v_smfmac_f32_16x16x32_bf16 v[40:43], v[24:25], v[240:243], v14
    v_and_b32_dpp v26, v8, v12 row_newbcast:10 row_mask:0xf bank_mask:0xf
    v_and_b32_dpp v27, v8, v13 row_newbcast:10 row_mask:0xf bank_mask:0xf
    v_smfmac_f32_16x16x32_bf16 v[44:47], v[24:25], v[244:247], v14
    s_nop 0
    v_smfmac_f32_16x16x32_bf16 v[40:43], v[26:27], v[248:251], v14
    v_and_b32_dpp v24, v33, v12 row_newbcast:0 row_mask:0xf bank_mask:0xf
    v_and_b32_dpp v25, v33, v13 row_newbcast:0 row_mask:0xf bank_mask:0xf
    v_smfmac_f32_16x16x32_bf16 v[44:47], v[26:27], v[252:255], v14
    v_xor_b32 v184, s18, v2
    s_lshl_b32 s64, s23, 2
    v_add_u32 v9, s64, v0
    v_mov_b32 v185, 0
    v_cvt_pk_bf16_f32 v30, v16, v17
    v_cvt_pk_bf16_f32 v31, v18, v19
    ds_write_b64 v184, v[30:31] offset:1024
    v_cvt_pk_bf16_f32 v30, v20, v21
    v_cvt_pk_bf16_f32 v31, v22, v23
    ds_write_b64 v184, v[30:31] offset:1280
    ds_read_u16_d16_hi v185, v9
    v_mov_b64 v[16:17], 0
    v_mov_b64 v[18:19], 0
    v_mov_b64 v[20:21], 0
    v_mov_b64 v[22:23], 0
    s_nop 0
    v_xor_b32 v176, s19, v2
    s_lshl_b32 s64, s24, 2
    v_add_u32 v9, s64, v0
    v_mov_b32 v177, 0
    v_cvt_pk_bf16_f32 v30, v40, v41
    v_cvt_pk_bf16_f32 v31, v42, v43
    ds_write_b64 v176, v[30:31] offset:1024
    v_cvt_pk_bf16_f32 v30, v44, v45
    v_cvt_pk_bf16_f32 v31, v46, v47
    ds_write_b64 v176, v[30:31] offset:1280
    ds_read_u16_d16_hi v177, v9
    s_waitcnt lgkmcnt(0)
    s_barrier
    s_cmp_lg_u32 s25, 0
    s_cbranch_scc1 L_slow
L_fp0:
    s_bitcmp1_b32 s52, 0
    s_waitcnt vmcnt(30)
    v_smfmac_f32_16x16x32_bf16 v[16:19], v[24:25], v[48:51], v14
    v_and_b32_dpp v26, v33, v12 row_newbcast:1 row_mask:0xf bank_mask:0xf
    v_and_b32_dpp v27, v33, v13 row_newbcast:1 row_mask:0xf bank_mask:0xf
    v_smfmac_f32_16x16x32_bf16 v[20:23], v[24:25], v[52:55], v14
    v_add_u32_dpp v11, v34, v7 row_newbcast:0 row_mask:0xf bank_mask:0xf
    buffer_load_dwordx4 v[48:51], v11, s[32:35], 0 offen offset:0
    s_cbranch_scc1 L_event
L_fp1:
    s_bitcmp1_b32 s52, 1
    s_waitcnt vmcnt(29)
    v_smfmac_f32_16x16x32_bf16 v[16:19], v[26:27], v[56:59], v14
    v_and_b32_dpp v24, v33, v12 row_newbcast:2 row_mask:0xf bank_mask:0xf
    v_and_b32_dpp v25, v33, v13 row_newbcast:2 row_mask:0xf bank_mask:0xf
    v_smfmac_f32_16x16x32_bf16 v[20:23], v[26:27], v[60:63], v14
    v_add_u32_dpp v11, v34, v7 row_newbcast:0 row_mask:0xf bank_mask:0xf
    buffer_load_dwordx4 v[52:55], v11, s[32:35], 0 offen offset:256
    s_cbranch_scc1 L_event
L_fp2:
    s_bitcmp1_b32 s52, 2
    s_waitcnt vmcnt(28)
    v_smfmac_f32_16x16x32_bf16 v[16:19], v[24:25], v[64:67], v14
    v_and_b32_dpp v26, v33, v12 row_newbcast:3 row_mask:0xf bank_mask:0xf
    v_and_b32_dpp v27, v33, v13 row_newbcast:3 row_mask:0xf bank_mask:0xf
    v_smfmac_f32_16x16x32_bf16 v[20:23], v[24:25], v[68:71], v14
    v_add_u32_dpp v11, v34, v7 row_newbcast:1 row_mask:0xf bank_mask:0xf
    buffer_load_dwordx4 v[56:59], v11, s[32:35], 0 offen offset:0
    s_cbranch_scc1 L_event
L_fp3:
    s_bitcmp1_b32 s52, 3
    s_waitcnt vmcnt(27)
    v_smfmac_f32_16x16x32_bf16 v[16:19], v[26:27], v[72:75], v14
    v_and_b32_dpp v24, v33, v12 row_newbcast:4 row_mask:0xf bank_mask:0xf
    v_and_b32_dpp v25, v33, v13 row_newbcast:4 row_mask:0xf bank_mask:0xf
    v_smfmac_f32_16x16x32_bf16 v[20:23], v[26:27], v[76:79], v14
    v_add_u32_dpp v11, v34, v7 row_newbcast:1 row_mask:0xf bank_mask:0xf
    buffer_load_dwordx4 v[60:63], v11, s[32:35], 0 offen offset:256
    s_cbranch_scc1 L_event
L_fp4:
    s_bitcmp1_b32 s52, 4
    s_waitcnt vmcnt(26)
    v_smfmac_f32_16x16x32_bf16 v[16:19], v[24:25], v[80:83], v14
    v_and_b32_dpp v26, v33, v12 row_newbcast:5 row_mask:0xf bank_mask:0xf
    v_and_b32_dpp v27, v33, v13 row_newbcast:5 row_mask:0xf bank_mask:0xf
    v_smfmac_f32_16x16x32_bf16 v[20:23], v[24:25], v[84:87], v14
    v_add_u32_dpp v11, v34, v7 row_newbcast:2 row_mask:0xf bank_mask:0xf
    buffer_load_dwordx4 v[64:67], v11, s[32:35], 0 offen offset:0
    s_cbranch_scc1 L_event
L_fp5:
    s_bitcmp1_b32 s52, 5
    s_waitcnt vmcnt(25)
    v_smfmac_f32_16x16x32_bf16 v[16:19], v[26:27], v[88:91], v14
    v_and_b32_dpp v24, v33, v12 row_newbcast:6 row_mask:0xf bank_mask:0xf
    v_and_b32_dpp v25, v33, v13 row_newbcast:6 row_mask:0xf bank_mask:0xf
    v_smfmac_f32_16x16x32_bf16 v[20:23], v[26:27], v[92:95], v14
    v_add_u32_dpp v11, v34, v7 row_newbcast:2 row_mask:0xf bank_mask:0xf
    buffer_load_dwordx4 v[68:71], v11, s[32:35], 0 offen offset:256
    s_cbranch_scc1 L_event
L_fp6:
    s_bitcmp1_b32 s52, 6
    s_waitcnt vmcnt(24)
    v_smfmac_f32_16x16x32_bf16 v[16:19], v[24:25], v[96:99], v14
    v_and_b32_dpp v26, v33, v12 row_newbcast:7 row_mask:0xf bank_mask:0xf
    v_and_b32_dpp v27, v33, v13 row_newbcast:7 row_mask:0xf bank_mask:0xf
    v_smfmac_f32_16x16x32_bf16 v[20:23], v[24:25], v[100:103], v14
    v_add_u32_dpp v11, v34, v7 row_newbcast:3 row_mask:0xf bank_mask:0xf
    buffer_load_dwordx4 v[72:75], v11, s[32:35], 0 offen offset:0
    s_cbranch_scc1 L_event
L_fp7:
    s_bitcmp1_b32 s52, 7
    s_waitcnt vmcnt(23)
    v_smfmac_f32_16x16x32_bf16 v[16:19], v[26:27], v[104:107], v14
    v_and_b32_dpp v24, v33, v12 row_newbcast:8 row_mask:0xf bank_mask:0xf
    v_and_b32_dpp v25, v33, v13 row_newbcast:8 row_mask:0xf bank_mask:0xf
    v_smfmac_f32_16x16x32_bf16 v[20:23], v[26:27], v[108:111], v14
    v_add_u32_dpp v11, v34, v7 row_newbcast:3 row_mask:0xf bank_mask:0xf
    buffer_load_dwordx4 v[76:79], v11, s[32:35], 0 offen offset:256
    s_cbranch_scc1 L_event
L_fp8:
    s_bitcmp1_b32 s52, 8
    s_waitcnt vmcnt(22)
    v_smfmac_f32_16x16x32_bf16 v[16:19], v[24:25], v[112:115], v14
    v_and_b32_dpp v26, v33, v12 row_newbcast:9 row_mask:0xf bank_mask:0xf
    v_and_b32_dpp v27, v33, v13 row_newbcast:9 row_mask:0xf bank_mask:0xf
    v_smfmac_f32_16x16x32_bf16 v[20:23], v[24:25], v[116:119], v14
    v_add_u32_dpp v11, v34, v7 row_newbcast:4 row_mask:0xf bank_mask:0xf
    buffer_load_dwordx4 v[80:83], v11, s[32:35], 0 offen offset:0
    s_cbranch_scc1 L_event
L_fp9:
    s_bitcmp1_b32 s52, 9
    s_waitcnt vmcnt(21)
    v_smfmac_f32_16x16x32_bf16 v[16:19], v[26:27], v[120:123], v14
    v_and_b32_dpp v24, v33, v12 row_newbcast:10 row_mask:0xf bank_mask:0xf
    v_and_b32_dpp v25, v33, v13 row_newbcast:10 row_mask:0xf bank_mask:0xf
    v_smfmac_f32_16x16x32_bf16 v[20:23], v[26:27], v[124:127], v14
    v_add_u32_dpp v11, v34, v7 row_newbcast:4 row_mask:0xf bank_mask:0xf
    buffer_load_dwordx4 v[84:87], v11, s[32:35], 0 offen offset:256
    s_cbranch_scc1 L_event
L_fp10:
    s_bitcmp1_b32 s52, 10
    s_waitcnt vmcnt(20)
    v_smfmac_f32_16x16x32_bf16 v[16:19], v[24:25], v[128:131], v14
    v_and_b32_dpp v26, v33, v12 row_newbcast:11 row_mask:0xf bank_mask:0xf
    v_and_b32_dpp v27, v33, v13 row_newbcast:11 row_mask:0xf bank_mask:0xf
    v_smfmac_f32_16x16x32_bf16 v[20:23], v[24:25], v[132:135], v14
    v_add_u32_dpp v11, v34, v7 row_newbcast:5 row_mask:0xf bank_mask:0xf
    buffer_load_dwordx4 v[88:91], v11, s[32:35], 0 offen offset:0
    s_cbranch_scc1 L_event
L_fp11:
    s_bitcmp1_b32 s52, 11
    s_waitcnt vmcnt(19)
    v_smfmac_f32_16x16x32_bf16 v[16:19], v[26:27], v[136:139], v14
    v_and_b32_dpp v24, v33, v12 row_newbcast:12 row_mask:0xf bank_mask:0xf
    v_and_b32_dpp v25, v33, v13 row_newbcast:12 row_mask:0xf bank_mask:0xf
    v_smfmac_f32_16x16x32_bf16 v[20:23], v[26:27], v[140:143], v14
    v_add_u32_dpp v11, v34, v7 row_newbcast:5 row_mask:0xf bank_mask:0xf
    buffer_load_dwordx4 v[92:95], v11, s[32:35], 0 offen offset:256
    s_cbranch_scc1 L_event
L_fp12:
    s_bitcmp1_b32 s52, 12
    s_waitcnt vmcnt(18)
    v_smfmac_f32_16x16x32_bf16 v[16:19], v[24:25], v[144:147], v14
    v_and_b32_dpp v26, v33, v12 row_newbcast:13 row_mask:0xf bank_mask:0xf
    v_and_b32_dpp v27, v33, v13 row_newbcast:13 row_mask:0xf bank_mask:0xf
    v_smfmac_f32_16x16x32_bf16 v[20:23], v[24:25], v[148:151], v14
    v_add_u32_dpp v11, v34, v7 row_newbcast:6 row_mask:0xf bank_mask:0xf
    buffer_load_dwordx4 v[96:99], v11, s[32:35], 0 offen offset:0
    s_cbranch_scc1 L_event
L_fp13:
    s_bitcmp1_b32 s52, 13
    s_waitcnt vmcnt(17)
    v_smfmac_f32_16x16x32_bf16 v[16:19], v[26:27], v[152:155], v14
    v_and_b32_dpp v24, v33, v12 row_newbcast:14 row_mask:0xf bank_mask:0xf
    v_and_b32_dpp v25, v33, v13 row_newbcast:14 row_mask:0xf bank_mask:0xf
    v_smfmac_f32_16x16x32_bf16 v[20:23], v[26:27], v[156:159], v14
    v_add_u32_dpp v11, v34, v7 row_newbcast:6 row_mask:0xf bank_mask:0xf
    buffer_load_dwordx4 v[100:103], v11, s[32:35], 0 offen offset:256
    s_cbranch_scc1 L_event
L_fp14:
    s_bitcmp1_b32 s52, 14
    s_waitcnt vmcnt(16)
    v_smfmac_f32_16x16x32_bf16 v[16:19], v[24:25], v[160:163], v14
    v_and_b32_dpp v26, v33, v12 row_newbcast:15 row_mask:0xf bank_mask:0xf
    v_and_b32_dpp v27, v33, v13 row_newbcast:15 row_mask:0xf bank_mask:0xf
    v_smfmac_f32_16x16x32_bf16 v[20:23], v[24:25], v[164:167], v14
    v_add_u32_dpp v11, v34, v7 row_newbcast:7 row_mask:0xf bank_mask:0xf
    buffer_load_dwordx4 v[104:107], v11, s[32:35], 0 offen offset:0
    s_cbranch_scc1 L_event
L_fp15:
    s_bitcmp1_b32 s52, 15
    s_waitcnt vmcnt(15)
    v_smfmac_f32_16x16x32_bf16 v[16:19], v[26:27], v[168:171], v14
    v_and_b32_dpp v24, v35, v12 row_newbcast:0 row_mask:0xf bank_mask:0xf
    v_and_b32_dpp v25, v35, v13 row_newbcast:0 row_mask:0xf bank_mask:0xf
    v_smfmac_f32_16x16x32_bf16 v[20:23], v[26:27], v[172:175], v14
    v_add_u32_dpp v11, v34, v7 row_newbcast:7 row_mask:0xf bank_mask:0xf
    buffer_load_dwordx4 v[108:111], v11, s[32:35], 0 offen offset:256
    s_cbranch_scc1 L_event
L_fp16:
    v_mov_b64 v[32:33], v[34:35]
    v_mov_b64 v[34:35], v[36:37]
    v_mov_b64 v[36:37], v[38:39]
    s_lshr_b64 s[52:53], s[52:53], 16
    s_lshr_b64 s[58:59], s[58:59], 16
    s_lshr_b64 s[60:61], s[60:61], 16
    s_mov_b32 s62, L_st1-L_anc
    s_mov_b32 s63, L_st1-L_st0
L_st0:
    s_bitcmp1_b32 s52, 0
    s_waitcnt vmcnt(14)
    v_smfmac_f32_16x16x32_bf16 v[16:19], v[24:25], v[48:51], v14
    v_and_b32_dpp v26, v33, v12 row_newbcast:1 row_mask:0xf bank_mask:0xf
    v_and_b32_dpp v27, v33, v13 row_newbcast:1 row_mask:0xf bank_mask:0xf
    v_smfmac_f32_16x16x32_bf16 v[20:23], v[24:25], v[52:55], v14
    v_add_u32_dpp v11, v32, v7 row_newbcast:8 row_mask:0xf bank_mask:0xf
    buffer_load_dwordx4 v[112:115], v11, s[32:35], 0 offen offset:0
    buffer_load_dwordx4 v[116:119], v11, s[32:35], 0 offen offset:256
    s_cbranch_scc1 L_event
L_st1:
    s_bitcmp1_b32 s52, 1
    s_waitcnt vmcnt(14)
    v_smfmac_f32_16x16x32_bf16 v[16:19], v[26:27], v[56:59], v14
    v_and_b32_dpp v24, v33, v12 row_newbcast:2 row_mask:0xf bank_mask:0xf
    v_and_b32_dpp v25, v33, v13 row_newbcast:2 row_mask:0xf bank_mask:0xf
    v_smfmac_f32_16x16x32_bf16 v[20:23], v[26:27], v[60:63], v14
    v_add_u32_dpp v11, v32, v7 row_newbcast:9 row_mask:0xf bank_mask:0xf
    buffer_load_dwordx4 v[120:123], v11, s[32:35], 0 offen offset:0
    buffer_load_dwordx4 v[124:127], v11, s[32:35], 0 offen offset:256
    s_cbranch_scc1 L_event
L_st2:
    s_bitcmp1_b32 s52, 2
    s_waitcnt vmcnt(14)
    v_smfmac_f32_16x16x32_bf16 v[16:19], v[24:25], v[64:67], v14
    v_and_b32_dpp v26, v33, v12 row_newbcast:3 row_mask:0xf bank_mask:0xf
    v_and_b32_dpp v27, v33, v13 row_newbcast:3 row_mask:0xf bank_mask:0xf
    v_smfmac_f32_16x16x32_bf16 v[20:23], v[24:25], v[68:71], v14
    v_add_u32_dpp v11, v32, v7 row_newbcast:10 row_mask:0xf bank_mask:0xf
    buffer_load_dwordx4 v[128:131], v11, s[32:35], 0 offen offset:0
    buffer_load_dwordx4 v[132:135], v11, s[32:35], 0 offen offset:256
    s_cbranch_scc1 L_event
L_st3:
    s_bitcmp1_b32 s52, 3
    s_waitcnt vmcnt(14)
    v_smfmac_f32_16x16x32_bf16 v[16:19], v[26:27], v[72:75], v14
    v_and_b32_dpp v24, v33, v12 row_newbcast:4 row_mask:0xf bank_mask:0xf
    v_and_b32_dpp v25, v33, v13 row_newbcast:4 row_mask:0xf bank_mask:0xf
    v_smfmac_f32_16x16x32_bf16 v[20:23], v[26:27], v[76:79], v14
    v_add_u32_dpp v11, v32, v7 row_newbcast:11 row_mask:0xf bank_mask:0xf
    buffer_load_dwordx4 v[136:139], v11, s[32:35], 0 offen offset:0
    buffer_load_dwordx4 v[140:143], v11, s[32:35], 0 offen offset:256
    s_cbranch_scc1 L_event
L_st4:
    s_bitcmp1_b32 s52, 4
    s_waitcnt vmcnt(14)
    v_smfmac_f32_16x16x32_bf16 v[16:19], v[24:25], v[80:83], v14
    v_and_b32_dpp v26, v33, v12 row_newbcast:5 row_mask:0xf bank_mask:0xf
    v_and_b32_dpp v27, v33, v13 row_newbcast:5 row_mask:0xf bank_mask:0xf
    v_smfmac_f32_16x16x32_bf16 v[20:23], v[24:25], v[84:87], v14
    v_add_u32_dpp v11, v32, v7 row_newbcast:12 row_mask:0xf bank_mask:0xf
    buffer_load_dwordx4 v[144:147], v11, s[32:35], 0 offen offset:0
    buffer_load_dwordx4 v[148:151], v11, s[32:35], 0 offen offset:256
    s_cbranch_scc1 L_event
L_st5:
    s_bitcmp1_b32 s52, 5
    s_waitcnt vmcnt(14)
    v_smfmac_f32_16x16x32_bf16 v[16:19], v[26:27], v[88:91], v14
    v_and_b32_dpp v24, v33, v12 row_newbcast:6 row_mask:0xf bank_mask:0xf
    v_and_b32_dpp v25, v33, v13 row_newbcast:6 row_mask:0xf bank_mask:0xf
    v_smfmac_f32_16x16x32_bf16 v[20:23], v[26:27], v[92:95], v14
    v_add_u32_dpp v11, v32, v7 row_newbcast:13 row_mask:0xf bank_mask:0xf
    buffer_load_dwordx4 v[152:155], v11, s[32:35], 0 offen offset:0
    buffer_load_dwordx4 v[156:159], v11, s[32:35], 0 offen offset:256
    s_cbranch_scc1 L_event
L_st6:
    s_bitcmp1_b32 s52, 6
    s_waitcnt vmcnt(14)
    v_smfmac_f32_16x16x32_bf16 v[16:19], v[24:25], v[96:99], v14
    v_and_b32_dpp v26, v33, v12 row_newbcast:7 row_mask:0xf bank_mask:0xf
    v_and_b32_dpp v27, v33, v13 row_newbcast:7 row_mask:0xf bank_mask:0xf
    v_smfmac_f32_16x16x32_bf16 v[20:23], v[24:25], v[100:103], v14
    v_add_u32_dpp v11, v32, v7 row_newbcast:14 row_mask:0xf bank_mask:0xf
    buffer_load_dwordx4 v[160:163], v11, s[32:35], 0 offen offset:0
    buffer_load_dwordx4 v[164:167], v11, s[32:35], 0 offen offset:256
    s_cbranch_scc1 L_event
L_st7:
    s_bitcmp1_b32 s52, 7
    s_waitcnt vmcnt(14)
    v_smfmac_f32_16x16x32_bf16 v[16:19], v[26:27], v[104:107], v14
    v_and_b32_dpp v24, v33, v12 row_newbcast:8 row_mask:0xf bank_mask:0xf
    v_and_b32_dpp v25, v33, v13 row_newbcast:8 row_mask:0xf bank_mask:0xf
    v_smfmac_f32_16x16x32_bf16 v[20:23], v[26:27], v[108:111], v14
    v_add_u32_dpp v11, v32, v7 row_newbcast:15 row_mask:0xf bank_mask:0xf
    buffer_load_dwordx4 v[168:171], v11, s[32:35], 0 offen offset:0
    buffer_load_dwordx4 v[172:175], v11, s[32:35], 0 offen offset:256
    s_cbranch_scc1 L_event
L_st8:
    s_bitcmp1_b32 s52, 8
    s_waitcnt vmcnt(14)
    v_smfmac_f32_16x16x32_bf16 v[16:19], v[24:25], v[112:115], v14
    v_and_b32_dpp v26, v33, v12 row_newbcast:9 row_mask:0xf bank_mask:0xf
    v_and_b32_dpp v27, v33, v13 row_newbcast:9 row_mask:0xf bank_mask:0xf
    v_smfmac_f32_16x16x32_bf16 v[20:23], v[24:25], v[116:119], v14
    v_add_u32_dpp v11, v34, v7 row_newbcast:0 row_mask:0xf bank_mask:0xf
    buffer_load_dwordx4 v[48:51], v11, s[32:35], 0 offen offset:0
    buffer_load_dwordx4 v[52:55], v11, s[32:35], 0 offen offset:256
    s_cbranch_scc1 L_event
L_st9:
    s_bitcmp1_b32 s52, 9
    s_waitcnt vmcnt(14)
    v_smfmac_f32_16x16x32_bf16 v[16:19], v[26:27], v[120:123], v14
    v_and_b32_dpp v24, v33, v12 row_newbcast:10 row_mask:0xf bank_mask:0xf
    v_and_b32_dpp v25, v33, v13 row_newbcast:10 row_mask:0xf bank_mask:0xf
    v_smfmac_f32_16x16x32_bf16 v[20:23], v[26:27], v[124:127], v14
    v_add_u32_dpp v11, v34, v7 row_newbcast:1 row_mask:0xf bank_mask:0xf
    buffer_load_dwordx4 v[56:59], v11, s[32:35], 0 offen offset:0
    buffer_load_dwordx4 v[60:63], v11, s[32:35], 0 offen offset:256
    s_cbranch_scc1 L_event
L_st10:
    s_bitcmp1_b32 s52, 10
    s_waitcnt vmcnt(14)
    v_smfmac_f32_16x16x32_bf16 v[16:19], v[24:25], v[128:131], v14
    v_and_b32_dpp v26, v33, v12 row_newbcast:11 row_mask:0xf bank_mask:0xf
    v_and_b32_dpp v27, v33, v13 row_newbcast:11 row_mask:0xf bank_mask:0xf
    v_smfmac_f32_16x16x32_bf16 v[20:23], v[24:25], v[132:135], v14
    v_add_u32_dpp v11, v34, v7 row_newbcast:2 row_mask:0xf bank_mask:0xf
    buffer_load_dwordx4 v[64:67], v11, s[32:35], 0 offen offset:0
    buffer_load_dwordx4 v[68:71], v11, s[32:35], 0 offen offset:256
    s_cbranch_scc1 L_event
L_st11:
    s_bitcmp1_b32 s52, 11
    s_waitcnt vmcnt(14)
    v_smfmac_f32_16x16x32_bf16 v[16:19], v[26:27], v[136:139], v14
    v_and_b32_dpp v24, v33, v12 row_newbcast:12 row_mask:0xf bank_mask:0xf
    v_and_b32_dpp v25, v33, v13 row_newbcast:12 row_mask:0xf bank_mask:0xf
    v_smfmac_f32_16x16x32_bf16 v[20:23], v[26:27], v[140:143], v14
    v_add_u32_dpp v11, v34, v7 row_newbcast:3 row_mask:0xf bank_mask:0xf
    buffer_load_dwordx4 v[72:75], v11, s[32:35], 0 offen offset:0
    buffer_load_dwordx4 v[76:79], v11, s[32:35], 0 offen offset:256
    s_cbranch_scc1 L_event
L_st12:
    s_bitcmp1_b32 s52, 12
    s_waitcnt vmcnt(14)
    v_smfmac_f32_16x16x32_bf16 v[16:19], v[24:25], v[144:147], v14
    v_and_b32_dpp v26, v33, v12 row_newbcast:13 row_mask:0xf bank_mask:0xf
    v_and_b32_dpp v27, v33, v13 row_newbcast:13 row_mask:0xf bank_mask:0xf
    v_smfmac_f32_16x16x32_bf16 v[20:23], v[24:25], v[148:151], v14
    v_add_u32_dpp v11, v34, v7 row_newbcast:4 row_mask:0xf bank_mask:0xf
    buffer_load_dwordx4 v[80:83], v11, s[32:35], 0 offen offset:0
    buffer_load_dwordx4 v[84:87], v11, s[32:35], 0 offen offset:256
    s_cbranch_scc1 L_event
L_st13:
    s_bitcmp1_b32 s52, 13
    s_waitcnt vmcnt(14)
    v_smfmac_f32_16x16x32_bf16 v[16:19], v[26:27], v[152:155], v14
    v_and_b32_dpp v24, v33, v12 row_newbcast:14 row_mask:0xf bank_mask:0xf
    v_and_b32_dpp v25, v33, v13 row_newbcast:14 row_mask:0xf bank_mask:0xf
    v_smfmac_f32_16x16x32_bf16 v[20:23], v[26:27], v[156:159], v14
    v_add_u32_dpp v11, v34, v7 row_newbcast:5 row_mask:0xf bank_mask:0xf
    buffer_load_dwordx4 v[88:91], v11, s[32:35], 0 offen offset:0
    buffer_load_dwordx4 v[92:95], v11, s[32:35], 0 offen offset:256
    s_cbranch_scc1 L_event
L_st14:
    s_bitcmp1_b32 s52, 14
    s_waitcnt vmcnt(14)
    v_smfmac_f32_16x16x32_bf16 v[16:19], v[24:25], v[160:163], v14
    v_and_b32_dpp v26, v33, v12 row_newbcast:15 row_mask:0xf bank_mask:0xf
    v_and_b32_dpp v27, v33, v13 row_newbcast:15 row_mask:0xf bank_mask:0xf
    v_smfmac_f32_16x16x32_bf16 v[20:23], v[24:25], v[164:167], v14
    v_add_u32_dpp v11, v34, v7 row_newbcast:6 row_mask:0xf bank_mask:0xf
    buffer_load_dwordx4 v[96:99], v11, s[32:35], 0 offen offset:0
    buffer_load_dwordx4 v[100:103], v11, s[32:35], 0 offen offset:256
    s_cbranch_scc1 L_event
L_st15:
    s_bitcmp1_b32 s52, 15
    s_waitcnt vmcnt(14)
    v_smfmac_f32_16x16x32_bf16 v[16:19], v[26:27], v[168:171], v14
    v_and_b32_dpp v24, v35, v12 row_newbcast:0 row_mask:0xf bank_mask:0xf
    v_and_b32_dpp v25, v35, v13 row_newbcast:0 row_mask:0xf bank_mask:0xf
    v_smfmac_f32_16x16x32_bf16 v[20:23], v[26:27], v[172:175], v14
    v_add_u32_dpp v11, v34, v7 row_newbcast:7 row_mask:0xf bank_mask:0xf
    buffer_load_dwordx4 v[104:107], v11, s[32:35], 0 offen offset:0
    buffer_load_dwordx4 v[108:111], v11, s[32:35], 0 offen offset:256
    s_cbranch_scc1 L_event
L_st16:
    v_mov_b64 v[32:33], v[34:35]
    v_mov_b64 v[34:35], v[36:37]
    v_mov_b64 v[36:37], v[38:39]
    s_lshr_b64 s[52:53], s[52:53], 16
    s_lshr_b64 s[58:59], s[58:59], 16
    s_lshr_b64 s[60:61], s[60:61], 16
    s_branch L_st0
L_dr0:
    s_bitcmp1_b32 s52, 0
    s_waitcnt vmcnt(14)
    v_smfmac_f32_16x16x32_bf16 v[16:19], v[24:25], v[48:51], v14
    v_and_b32_dpp v26, v33, v12 row_newbcast:1 row_mask:0xf bank_mask:0xf
    v_and_b32_dpp v27, v33, v13 row_newbcast:1 row_mask:0xf bank_mask:0xf
    v_smfmac_f32_16x16x32_bf16 v[20:23], v[24:25], v[52:55], v14
    buffer_load_ubyte v15, off, s[32:35], 0
    buffer_load_ubyte v15, off, s[32:35], 0
    s_cbranch_scc1 L_event
L_dr1:
    s_bitcmp1_b32 s52, 1
    s_waitcnt vmcnt(14)
    v_smfmac_f32_16x16x32_bf16 v[16:19], v[26:27], v[56:59], v14
    v_and_b32_dpp v24, v33, v12 row_newbcast:2 row_mask:0xf bank_mask:0xf
    v_and_b32_dpp v25, v33, v13 row_newbcast:2 row_mask:0xf bank_mask:0xf
    v_smfmac_f32_16x16x32_bf16 v[20:23], v[26:27], v[60:63], v14
    buffer_load_ubyte v15, off, s[32:35], 0
    buffer_load_ubyte v15, off, s[32:35], 0
    s_cbranch_scc1 L_event
L_dr2:
    s_bitcmp1_b32 s52, 2
    s_waitcnt vmcnt(14)
    v_smfmac_f32_16x16x32_bf16 v[16:19], v[24:25], v[64:67], v14
    v_and_b32_dpp v26, v33, v12 row_newbcast:3 row_mask:0xf bank_mask:0xf
    v_and_b32_dpp v27, v33, v13 row_newbcast:3 row_mask:0xf bank_mask:0xf
    v_smfmac_f32_16x16x32_bf16 v[20:23], v[24:25], v[68:71], v14
    buffer_load_ubyte v15, off, s[32:35], 0
    buffer_load_ubyte v15, off, s[32:35], 0
    s_cbranch_scc1 L_event
L_dr3:
    s_bitcmp1_b32 s52, 3
    s_waitcnt vmcnt(14)
    v_smfmac_f32_16x16x32_bf16 v[16:19], v[26:27], v[72:75], v14
    v_and_b32_dpp v24, v33, v12 row_newbcast:4 row_mask:0xf bank_mask:0xf
    v_and_b32_dpp v25, v33, v13 row_newbcast:4 row_mask:0xf bank_mask:0xf
    v_smfmac_f32_16x16x32_bf16 v[20:23], v[26:27], v[76:79], v14
    buffer_load_ubyte v15, off, s[32:35], 0
    buffer_load_ubyte v15, off, s[32:35], 0
    s_cbranch_scc1 L_event
L_dr4:
    s_bitcmp1_b32 s52, 4
    s_waitcnt vmcnt(14)
    v_smfmac_f32_16x16x32_bf16 v[16:19], v[24:25], v[80:83], v14
    v_and_b32_dpp v26, v33, v12 row_newbcast:5 row_mask:0xf bank_mask:0xf
    v_and_b32_dpp v27, v33, v13 row_newbcast:5 row_mask:0xf bank_mask:0xf
    v_smfmac_f32_16x16x32_bf16 v[20:23], v[24:25], v[84:87], v14
    buffer_load_ubyte v15, off, s[32:35], 0
    buffer_load_ubyte v15, off, s[32:35], 0
    s_cbranch_scc1 L_event
L_dr5:
    s_bitcmp1_b32 s52, 5
    s_waitcnt vmcnt(14)
    v_smfmac_f32_16x16x32_bf16 v[16:19], v[26:27], v[88:91], v14
    v_and_b32_dpp v24, v33, v12 row_newbcast:6 row_mask:0xf bank_mask:0xf
    v_and_b32_dpp v25, v33, v13 row_newbcast:6 row_mask:0xf bank_mask:0xf
    v_smfmac_f32_16x16x32_bf16 v[20:23], v[26:27], v[92:95], v14
    buffer_load_ubyte v15, off, s[32:35], 0
    buffer_load_ubyte v15, off, s[32:35], 0
    s_cbranch_scc1 L_event
L_dr6:
    s_bitcmp1_b32 s52, 6
    s_waitcnt vmcnt(14)
    v_smfmac_f32_16x16x32_bf16 v[16:19], v[24:25], v[96:99], v14
    v_and_b32_dpp v26, v33, v12 row_newbcast:7 row_mask:0xf bank_mask:0xf
    v_and_b32_dpp v27, v33, v13 row_newbcast:7 row_mask:0xf bank_mask:0xf
    v_smfmac_f32_16x16x32_bf16 v[20:23], v[24:25], v[100:103], v14
    buffer_load_ubyte v15, off, s[32:35], 0
    buffer_load_ubyte v15, off, s[32:35], 0
    s_cbranch_scc1 L_event
L_dr7:
    s_bitcmp1_b32 s52, 7
    s_waitcnt vmcnt(14)
    v_smfmac_f32_16x16x32_bf16 v[16:19], v[26:27], v[104:107], v14
    v_and_b32_dpp v24, v33, v12 row_newbcast:8 row_mask:0xf bank_mask:0xf
    v_and_b32_dpp v25, v33, v13 row_newbcast:8 row_mask:0xf bank_mask:0xf
    v_smfmac_f32_16x16x32_bf16 v[20:23], v[26:27], v[108:111], v14
    buffer_load_ubyte v15, off, s[32:35], 0
    buffer_load_ubyte v15, off, s[32:35], 0
    s_cbranch_scc1 L_event
L_dr8:
    s_bitcmp1_b32 s52, 8
    s_waitcnt vmcnt(14)
    v_smfmac_f32_16x16x32_bf16 v[16:19], v[24:25], v[112:115], v14
    v_and_b32_dpp v26, v33, v12 row_newbcast:9 row_mask:0xf bank_mask:0xf
    v_and_b32_dpp v27, v33, v13 row_newbcast:9 row_mask:0xf bank_mask:0xf
    v_smfmac_f32_16x16x32_bf16 v[20:23], v[24:25], v[116:119], v14
    buffer_load_ubyte v15, off, s[32:35], 0
    buffer_load_ubyte v15, off, s[32:35], 0
    s_cbranch_scc1 L_event
L_dr9:
    s_bitcmp1_b32 s52, 9
    s_waitcnt vmcnt(14)
    v_smfmac_f32_16x16x32_bf16 v[16:19], v[26:27], v[120:123], v14
    v_and_b32_dpp v24, v33, v12 row_newbcast:10 row_mask:0xf bank_mask:0xf
    v_and_b32_dpp v25, v33, v13 row_newbcast:10 row_mask:0xf bank_mask:0xf
    v_smfmac_f32_16x16x32_bf16 v[20:23], v[26:27], v[124:127], v14
    buffer_load_ubyte v15, off, s[32:35], 0
    buffer_load_ubyte v15, off, s[32:35], 0
    s_cbranch_scc1 L_event
L_dr10:
    s_bitcmp1_b32 s52, 10
    s_waitcnt vmcnt(14)
    v_smfmac_f32_16x16x32_bf16 v[16:19], v[24:25], v[128:131], v14
    v_and_b32_dpp v26, v33, v12 row_newbcast:11 row_mask:0xf bank_mask:0xf
    v_and_b32_dpp v27, v33, v13 row_newbcast:11 row_mask:0xf bank_mask:0xf
    v_smfmac_f32_16x16x32_bf16 v[20:23], v[24:25], v[132:135], v14
    buffer_load_ubyte v15, off, s[32:35], 0
    buffer_load_ubyte v15, off, s[32:35], 0
    s_cbranch_scc1 L_event
L_dr11:
    s_bitcmp1_b32 s52, 11
    s_waitcnt vmcnt(14)
    v_smfmac_f32_16x16x32_bf16 v[16:19], v[26:27], v[136:139], v14
    v_and_b32_dpp v24, v33, v12 row_newbcast:12 row_mask:0xf bank_mask:0xf
    v_and_b32_dpp v25, v33, v13 row_newbcast:12 row_mask:0xf bank_mask:0xf
    v_smfmac_f32_16x16x32_bf16 v[20:23], v[26:27], v[140:143], v14
    buffer_load_ubyte v15, off, s[32:35], 0
    buffer_load_ubyte v15, off, s[32:35], 0
    s_cbranch_scc1 L_event
L_dr12:
    s_bitcmp1_b32 s52, 12
    s_waitcnt vmcnt(14)
    v_smfmac_f32_16x16x32_bf16 v[16:19], v[24:25], v[144:147], v14
    v_and_b32_dpp v26, v33, v12 row_newbcast:13 row_mask:0xf bank_mask:0xf
    v_and_b32_dpp v27, v33, v13 row_newbcast:13 row_mask:0xf bank_mask:0xf
    v_smfmac_f32_16x16x32_bf16 v[20:23], v[24:25], v[148:151], v14
    buffer_load_ubyte v15, off, s[32:35], 0
    buffer_load_ubyte v15, off, s[32:35], 0
    s_cbranch_scc1 L_event
L_dr13:
    s_bitcmp1_b32 s52, 13
    s_waitcnt vmcnt(14)
    v_smfmac_f32_16x16x32_bf16 v[16:19], v[26:27], v[152:155], v14
    v_and_b32_dpp v24, v33, v12 row_newbcast:14 row_mask:0xf bank_mask:0xf
    v_and_b32_dpp v25, v33, v13 row_newbcast:14 row_mask:0xf bank_mask:0xf
    v_smfmac_f32_16x16x32_bf16 v[20:23], v[26:27], v[156:159], v14
    buffer_load_ubyte v15, off, s[32:35], 0
    buffer_load_ubyte v15, off, s[32:35], 0
    s_cbranch_scc1 L_event
L_dr14:
    s_bitcmp1_b32 s52, 14
    s_waitcnt vmcnt(14)
    v_smfmac_f32_16x16x32_bf16 v[16:19], v[24:25], v[160:163], v14
    v_and_b32_dpp v26, v33, v12 row_newbcast:15 row_mask:0xf bank_mask:0xf
    v_and_b32_dpp v27, v33, v13 row_newbcast:15 row_mask:0xf bank_mask:0xf
    v_smfmac_f32_16x16x32_bf16 v[20:23], v[24:25], v[164:167], v14
    buffer_load_ubyte v15, off, s[32:35], 0
    buffer_load_ubyte v15, off, s[32:35], 0
    s_cbranch_scc1 L_event
L_dr15:
    s_bitcmp1_b32 s52, 15
    s_waitcnt vmcnt(14)
    v_smfmac_f32_16x16x32_bf16 v[16:19], v[26:27], v[168:171], v14
    v_and_b32_dpp v24, v35, v12 row_newbcast:0 row_mask:0xf bank_mask:0xf
    v_and_b32_dpp v25, v35, v13 row_newbcast:0 row_mask:0xf bank_mask:0xf
    v_smfmac_f32_16x16x32_bf16 v[20:23], v[26:27], v[172:175], v14
    buffer_load_ubyte v15, off, s[32:35], 0
    buffer_load_ubyte v15, off, s[32:35], 0
    s_cbranch_scc1 L_event
L_dr16:
    v_mov_b64 v[32:33], v[34:35]
    v_mov_b64 v[34:35], v[36:37]
    v_mov_b64 v[36:37], v[38:39]
    s_lshr_b64 s[52:53], s[52:53], 16
    s_lshr_b64 s[58:59], s[58:59], 16
    s_lshr_b64 s[60:61], s[60:61], 16
    s_branch L_dr0
    .p2align 8
L_wtab:
    s_add_u32 s56, s56, 12
    s_waitcnt vmcnt(14)
    s_setpc_b64 s[54:55]
    s_add_u32 s56, s56, 12
    s_waitcnt vmcnt(12)
    s_setpc_b64 s[54:55]
    s_add_u32 s56, s56, 12
    s_waitcnt vmcnt(10)
    s_setpc_b64 s[54:55]
    s_add_u32 s56, s56, 12
    s_waitcnt vmcnt(8)
    s_setpc_b64 s[54:55]
    s_add_u32 s56, s56, 12
    s_waitcnt vmcnt(6)
    s_setpc_b64 s[54:55]
    s_add_u32 s56, s56, 12
    s_waitcnt vmcnt(4)
    s_setpc_b64 s[54:55]
    s_add_u32 s56, s56, 12
    s_waitcnt vmcnt(2)
    s_setpc_b64 s[54:55]
    s_add_u32 s56, s56, 12
    s_waitcnt vmcnt(0)
    s_setpc_b64 s[54:55]
L_event:
    s_ff1_i32_b32 s49, s52
    s_bitset0_b32 s52, s49
    s_bitcmp1_b32 s60, s49
    s_cselect_b64 s[62:63], s[70:71], s[62:63]
    s_mul_i32 s64, s49, s63
    s_add_u32 s64, s64, s62
    s_add_u32 s54, s72, s64
    s_addc_u32 s55, s73, 0
    s_bitcmp1_b32 s58, s49
    s_cbranch_scc0 L_evret
L_flush:
    s_cmp_eq_u32 s26, 4
    v_add_u32 v28, 1, v28
    v_mul_f32 v40, v177, v16
    v_mul_f32 v41, v177, v17
    v_mul_f32 v42, v177, v18
    v_mul_f32 v43, v177, v19
    v_cvt_pk_bf16_f32 v40, v40, v41
    v_cvt_pk_bf16_f32 v41, v42, v43
    ds_write_b64 v176, v[40:41] offset:41984
    v_mul_f32 v44, v177, v20
    v_mul_f32 v45, v177, v21
    v_mul_f32 v46, v177, v22
    v_mul_f32 v47, v177, v23
    v_cvt_pk_bf16_f32 v44, v44, v45
    v_cvt_pk_bf16_f32 v45, v46, v47
    ds_write_b64 v176, v[44:45] offset:42240
    ds_write_b32 v29, v28 offset:32
    s_cbranch_scc1 L_sdone
    v_mov_b64 v[16:17], 0
    v_mov_b64 v[18:19], 0
    v_mov_b64 v[20:21], 0
    v_mov_b64 v[22:23], 0
    s_add_u32 s26, s26, 1
    v_mov_b64 v[176:177], v[178:179]
    v_mov_b64 v[178:179], v[180:181]
    v_mov_b64 v[180:181], v[182:183]
    v_mov_b64 v[182:183], v[184:185]
L_evret:
    s_setpc_b64 s[54:55]
L_slow:
    v_mbcnt_lo_u32_b32 v200, -1, 0
    v_mbcnt_hi_u32_b32 v200, -1, v200
L_slow_pair:
    v_lshlrev_b32 v201, 2, v200
    s_mul_i32 s70, s1, 40
    s_lshl1_add_u32 s70, s24, s70
    s_mov_b32 s71, 0
    s_mov_b32 s24, s20
    s_mov_b32 s20, s21
    s_mov_b32 s21, s22
    s_mov_b32 s22, s23
L_slow_chunk:
    global_load_dword v202, v201, s[8:9]
    global_load_dword v203, v201, s[6:7]
    v_add_u32 v201, 0x100, v201
    s_waitcnt vmcnt(0)
    v_subrev_u32 v202, s70, v202
    v_cmp_gt_u32 vcc, 2, v202
    v_lshlrev_b32 v204, 1, v203
    ds_read_u16 v204, v204 offset:62464
    s_mov_b64 s[72:73], vcc
    v_lshlrev_b32 v202, 4, v202
    v_lshlrev_b32 v203, 9, v203
    s_waitcnt lgkmcnt(0)
    v_lshlrev_b32 v204, v202, v204
L_slow_edge:
    s_cmp_eq_u64 s[72:73], 0
    s_cbranch_scc1 L_slow_next
    s_ff1_i32_b64 s74, s[72:73]
    s_bitset0_b64 s[72:73], s74
    v_readlane_b32 s64, v203, s74
    v_readlane_b32 s65, v204, s74
    v_mov_b32 v10, 0
    v_mov_b32 v11, 2147483648
    s_mov_b64 exec, 0xffff
    v_mov_b32 v10, s65
    v_add_u32 v11, s64, v7
    s_mov_b64 exec, -1
    buffer_load_dwordx4 v[208:211], v11, s[32:35], 0 offen
    buffer_load_dwordx4 v[212:215], v11, s[32:35], 0 offen offset:256
    v_and_b32 v24, v10, v12
    v_and_b32 v25, v10, v13
    s_nop 0
    s_waitcnt vmcnt(0)
    v_smfmac_f32_16x16x32_bf16 v[16:19], v[24:25], v[208:211], v14
    v_smfmac_f32_16x16x32_bf16 v[20:23], v[24:25], v[212:215], v14
    s_branch L_slow_edge
L_slow_next:
    s_add_u32 s71, s71, 1
    s_cmp_lt_u32 s71, 2500
    s_cbranch_scc1 L_slow_chunk
    s_nop 3
    s_call_b64 s[54:55], L_flush
    s_branch L_slow_pair
L_sdone:
    s_endpgm
L_retry_7:
    s_sub_u32 s100, s100, 1
    s_cbranch_scc1 L_end
    s_sleep 1
    s_branch L_spin_6
L_retry_11:
    s_sub_u32 s100, s100, 1
    s_cbranch_scc1 L_end
    s_sleep 1
    s_branch L_spin_10
L_retry_12:
    s_sub_u32 s100, s100, 1
    s_cbranch_scc1 L_end
    s_sleep 4
    s_branch L_ipoll_9
L_retry_14:
    s_sub_u32 s100, s100, 1
    s_cbranch_scc1 L_end
    s_sleep 1
    s_branch L_spin_13
L_mrole_1:
    v_lshlrev_b32 v43, 4, v4
    v_lshl_add_u32 v46, v46, 9, v43
    s_bfe_u32 s64, s68, 0x30002
    s_lshl_b32 s64, s64, 14
    s_lshr_b32 s65, s68, 5
    s_lshl_b32 s65, s65, 15
    s_bfe_u32 s66, s68, 0x10001
    s_lshl_b32 s66, s66, 14
    s_add_u32 s65, s65, s66
    s_and_b32 s66, s68, 1
    s_lshl_b32 s66, s66, 11
    s_add_u32 s65, s65, s66
    s_lshr_b32 s66, s2, 2
    s_xor_b32 s66, s66, s2
    s_and_b32 s66, s66, 0x30
    s_lshl_b32 s66, s66, 3
    v_add_u32 v46, s66, v46
    v_add_u32 v44, s64, v46
    v_add_u32 v45, s65, v46
    s_cmp_lg_u32 s31, 0
    s_waitcnt lgkmcnt(0)
    s_cbranch_scc1 L_roled_2
    global_load_dwordx4 v[48:51], v45, s[20:21] offset:0
    global_load_dwordx4 v[52:55], v44, s[18:19] offset:0
    global_load_dwordx4 v[56:59], v44, s[18:19] offset:2048
    global_load_dwordx4 v[60:63], v45, s[20:21] offset:64
    global_load_dwordx4 v[64:67], v44, s[18:19] offset:64
    global_load_dwordx4 v[68:71], v44, s[18:19] offset:2112
    v_xor_b32 v44, 128, v44
    v_xor_b32 v45, 128, v45
    global_load_dwordx4 v[72:75], v45, s[20:21] offset:0
    global_load_dwordx4 v[76:79], v44, s[18:19] offset:0
    global_load_dwordx4 v[80:83], v44, s[18:19] offset:2048
    global_load_dwordx4 v[84:87], v45, s[20:21] offset:64
    global_load_dwordx4 v[88:91], v44, s[18:19] offset:64
    global_load_dwordx4 v[92:95], v44, s[18:19] offset:2112
    v_xor_b32 v44, 384, v44
    v_xor_b32 v45, 384, v45
    global_load_dwordx4 v[96:99], v45, s[20:21] offset:0
    global_load_dwordx4 v[100:103], v44, s[18:19] offset:0
    global_load_dwordx4 v[104:107], v44, s[18:19] offset:2048
    global_load_dwordx4 v[108:111], v45, s[20:21] offset:64
    global_load_dwordx4 v[112:115], v44, s[18:19] offset:64
    global_load_dwordx4 v[116:119], v44, s[18:19] offset:2112
    v_xor_b32 v44, 128, v44
    v_xor_b32 v45, 128, v45
    global_load_dwordx4 v[120:123], v45, s[20:21] offset:0
    global_load_dwordx4 v[124:127], v44, s[18:19] offset:0
    global_load_dwordx4 v[128:131], v44, s[18:19] offset:2048
    global_load_dwordx4 v[132:135], v45, s[20:21] offset:64
    global_load_dwordx4 v[136:139], v44, s[18:19] offset:64
    global_load_dwordx4 v[140:143], v44, s[18:19] offset:2112
    s_branch L_roled_2
L_mwork_4:
    s_cmp_lg_u32 s31, 0
    s_cbranch_scc1 L_worked_5_w
    s_waitcnt vmcnt(22)
    v_mfma_f32_16x16x32_bf16 v[16:19], v[52:55], v[48:51], 0
    v_mfma_f32_16x16x32_bf16 v[20:23], v[56:59], v[48:51], 0
    s_waitcnt vmcnt(19)
    v_mfma_f32_16x16x32_bf16 v[16:19], v[64:67], v[60:63], v[16:19]
    v_mfma_f32_16x16x32_bf16 v[20:23], v[68:71], v[60:63], v[20:23]
    s_waitcnt vmcnt(16)
    v_mfma_f32_16x16x32_bf16 v[16:19], v[76:79], v[72:75], v[16:19]
    v_mfma_f32_16x16x32_bf16 v[20:23], v[80:83], v[72:75], v[20:23]
    s_waitcnt vmcnt(13)
    v_mfma_f32_16x16x32_bf16 v[16:19], v[88:91], v[84:87], v[16:19]
    v_mfma_f32_16x16x32_bf16 v[20:23], v[92:95], v[84:87], v[20:23]
    s_waitcnt vmcnt(10)
    v_mfma_f32_16x16x32_bf16 v[16:19], v[100:103], v[96:99], v[16:19]
    v_mfma_f32_16x16x32_bf16 v[20:23], v[104:107], v[96:99], v[20:23]
    s_waitcnt vmcnt(7)
    v_mfma_f32_16x16x32_bf16 v[16:19], v[112:115], v[108:111], v[16:19]
    v_mfma_f32_16x16x32_bf16 v[20:23], v[116:119], v[108:111], v[20:23]
    s_waitcnt vmcnt(4)
    v_mfma_f32_16x16x32_bf16 v[16:19], v[124:127], v[120:123], v[16:19]
    v_mfma_f32_16x16x32_bf16 v[20:23], v[128:131], v[120:123], v[20:23]
    s_waitcnt vmcnt(1)
    v_mfma_f32_16x16x32_bf16 v[16:19], v[136:139], v[132:135], v[16:19]
    v_mfma_f32_16x16x32_bf16 v[20:23], v[140:143], v[132:135], v[20:23]
    s_lshl_b32 s64, s27, 10
    s_add_u32 s64, s64, 65536
    v_lshl_add_u32 v40, v2, 4, s64
    s_lshl_b32 s64, s27, 2
    s_add_u32 s64, s64, 4096
    v_lshl_add_u32 v41, v2, 9, s64
    v_mov_b32 v42, s30
    s_nop 1
    v_cvt_pk_bf16_f32 v44, v16, v17
    v_cvt_pk_bf16_f32 v45, v18, v19
    v_cvt_pk_bf16_f32 v46, v20, v21
    v_cvt_pk_bf16_f32 v47, v22, v23
    global_store_dwordx4 v40, v[44:47], s[28:29] sc1
    s_mov_b32 s26, 1
    s_waitcnt vmcnt(1)
    s_branch L_worked_5
L_worked_5_w:
    s_waitcnt vmcnt(0)
    s_branch L_worked_5
L_gemm:
    v_lshrrev_b32 v0, 5, v2
    s_lshl_b32 s64, s31, 1
    v_add_u32 v0, s64, v0
    v_and_b32 v1, 31, v2
    v_xor_b32 v1, v1, v0
    v_lshlrev_b32 v1, 4, v1
    v_lshl_add_u32 v0, v0, 9, v1
    v_xor_b32 v1, 0x80, v0
    v_lshrrev_b32 v13, 3, v2
    v_lshrrev_b32 v15, 2, v2
    v_and_b32 v15, 4, v15
    v_and_b32 v14, 7, v2
    v_xor_b32 v15, v15, v14
    v_lshlrev_b32 v15, 4, v15
    v_lshl_add_u32 v13, v13, 9, v15
    s_lshr_b32 s67, s2, 3
    s_and_b32 s67, s67, 7
    s_lshl_b32 s64, s31, 7
    s_lshl_b32 s65, s67, 14
    s_or_b32 s64, s64, s65
    v_add_u32 v13, s64, v13
    s_mul_i32 s65, s1, 20480
    s_lshl_b32 s66, s31, 10
    s_lshl_b32 s70, s31, 14
    s_add_u32 s70, s70, 82944
    s_mov_b32 s71, 3072
    s_mov_b32 s72, 6144
    s_mov_b32 s73, 9216
    s_waitcnt lgkmcnt(0)
    s_mov_b32 s32, s4
    s_and_b32 s33, s5, 0xffff
    s_mov_b32 s34, 5120000
    s_mov_b32 s35, 0x20000
    s_mov_b32 s36, s22
    s_and_b32 s37, s23, 0xffff
    s_mov_b32 s38, 131072
    s_mov_b32 s39, 0x20000
    s_bitcmp1_b32 s2, 3
    s_cbranch_scc0 L_touched_15
    s_lshr_b32 s64, s2, 4
    s_lshl_b32 s64, s64, 3
    s_and_b32 s68, s2, 7
    s_or_b32 s64, s64, s68
    s_lshl_b32 s64, s64, 10
    v_lshl_add_u32 v16, v2, 4, s64
    s_cmp_eq_u32 s31, 1
    s_cselect_b64 s[68:69], s[22:23], s[16:17]
    s_cmp_eq_u32 s31, 2
    s_cselect_b64 s[68:69], s[18:19], s[68:69]
    s_cmp_eq_u32 s31, 3
    s_cselect_b64 s[68:69], s[20:21], s[68:69]
    global_load_dwordx4 v[20:23], v16, s[68:69]
L_touched_15:
    s_cmp_ge_u32 s2, 250
    s_cbranch_scc1 L_end
    s_mul_i32 s64, s1, 20480
    s_mov_b32 s76, 0
    s_cmp_eq_u32 s31, 0
    s_cselect_b64 s[68:69], s[24:25], s[16:17]
    s_cselect_b32 s64, s64, 0
    s_cmp_eq_u32 s31, 2
    s_cselect_b64 s[68:69], s[28:29], s[68:69]
    s_cselect_b32 s64, 0x800, s64
    s_cselect_b32 s76, 0x2f8000, s76
    s_cmp_eq_u32 s31, 3
    s_cselect_b64 s[68:69], s[4:5], s[68:69]
    s_cselect_b32 s76, 0x200000, s76
    s_cselect_b32 s77, 2, 1
    v_min_u32 v17, s77, v2
    v_mul_lo_u32 v17, v17, s76
    v_add_u32 v17, s64, v17
    global_load_dword v24, v17, s[68:69]
    s_add_u32 m0, s66, 1024
    s_nop 0
    buffer_load_dwordx4 v0, s[32:35], s65 offen lds
    s_add_u32 m0, s66, 5120
    s_add_u32 s65, s65, 4096
    buffer_load_dwordx4 v1, s[32:35], s65 offen lds
    s_add_u32 m0, s66, 9216
    s_add_u32 s65, s65, 4096
    buffer_load_dwordx4 v0, s[32:35], s65 offen lds
    s_add_u32 m0, s66, 13312
    s_add_u32 s65, s65, 4096
    buffer_load_dwordx4 v1, s[32:35], s65 offen lds
    s_add_u32 m0, s66, 17408
    s_add_u32 s65, s65, 4096
    buffer_load_dwordx4 v0, s[32:35], s65 offen lds
    s_barrier
    s_setprio 2
    s_add_u32 m0, s70, 0
    s_nop 0
    buffer_load_dwordx4 v13, s[36:39], 0 offen offset:0 lds
    buffer_load_dwordx4 v13, s[36:39], s71 offen offset:1024 lds
    buffer_load_dwordx4 v13, s[36:39], s72 offen offset:2048 lds
    buffer_load_dwordx4 v13, s[36:39], s73 offen offset:3072 lds
    v_xor_b32 v13, 16384, v13
    s_mov_b32 s40, s16
    s_and_b32 s41, s17, 0xffff
    s_mov_b32 s42, 131072
    s_mov_b32 s43, 0x20000
    s_mov_b32 s44, s28
    s_and_b32 s45, s29, 0xffff
    s_mov_b32 s46, 1048576
    s_mov_b32 s47, 0x20000
    s_mov_b32 s48, s24
    s_and_b32 s49, s25, 0xffff
    s_mov_b32 s50, 5120000
    s_mov_b32 s51, 0x20000
    v_xor_b32 v15, v4, v3
    v_lshlrev_b32 v15, 4, v15
    v_lshl_add_u32 v7, v3, 9, v15
    s_lshl_b32 s64, s67, 6
    v_xor_b32 v7, s64, v7
    v_xor_b32 v8, 64, v7
    v_xor_b32 v9, 0x80, v7
    v_xor_b32 v10, 0xc0, v7
    v_lshrrev_b32 v15, 2, v3
    v_lshl_add_u32 v15, v4, 3, v15
    v_lshlrev_b32 v15, 7, v15
    v_lshrrev_b32 v14, 1, v3
    v_and_b32 v14, 4, v14
    v_and_b32 v0, 3, v3
    v_xor_b32 v14, v14, v0
    v_lshl_add_u32 v15, v14, 4, v15
    v_add_u32 v11, s70, v15
    v_xor_b32 v12, 64, v11
    v_and_b32 v0, 31, v2
    v_lshlrev_b32 v0, 2, v0
    s_and_b32 s64, s2, 15
    s_lshl_b32 s64, s64, 9
    s_lshl_b32 s65, s31, 7
    s_add_u32 s64, s64, s65
    s_add_u32 s74, s64, 4096
    v_lshlrev_b32 v14, 4, v2
    s_lshl_b32 s75, s31, 15
    s_lshl_b32 s64, s67, 12
    s_or_b32 s75, s75, s64
    s_add_u32 s75, s75, 65536
    s_add_u32 m0, s70, 4096
    s_waitcnt vmcnt(9)
    buffer_load_dwordx4 v13, s[36:39], 0 offen offset:0 lds
    s_waitcnt vmcnt(9)
    buffer_load_dwordx4 v13, s[36:39], s71 offen offset:1024 lds
    s_waitcnt vmcnt(9)
    buffer_load_dwordx4 v13, s[36:39], s72 offen offset:2048 lds
    s_waitcnt vmcnt(9)
    buffer_load_dwordx4 v13, s[36:39], s73 offen offset:3072 lds
    v_xor_b32 v13, 49152, v13
    s_add_u32 m0, s70, 8192
    s_waitcnt vmcnt(9)
    buffer_load_dwordx4 v13, s[36:39], 0 offen offset:0 lds
    s_waitcnt vmcnt(9)
    buffer_load_dwordx4 v13, s[36:39], s71 offen offset:1024 lds
    s_waitcnt vmcnt(9)
    buffer_load_dwordx4 v13, s[36:39], s72 offen offset:2048 lds
    s_waitcnt vmcnt(9)
    buffer_load_dwordx4 v13, s[36:39], s73 offen offset:3072 lds
    v_xor_b32 v13, 16384, v13
    s_add_u32 m0, s70, 12288
    s_waitcnt vmcnt(4)
    buffer_load_dwordx4 v13, s[36:39], 0 offen offset:0 lds
    s_waitcnt vmcnt(4)
    buffer_load_dwordx4 v13, s[36:39], s71 offen offset:1024 lds
    s_waitcnt vmcnt(4)
    buffer_load_dwordx4 v13, s[36:39], s72 offen offset:2048 lds
    s_waitcnt vmcnt(4)
    buffer_load_dwordx4 v13, s[36:39], s73 offen offset:3072 lds
    v_xor_b32 v13, 114688, v13
    s_waitcnt vmcnt(12)
    s_waitcnt lgkmcnt(0)
    s_mov_b64 exec, 1
    ds_add_u32 v5, v6 offset:4
    s_mov_b64 exec, -1
    ds_read_b64_tr_b16 v[128:129], v11 offset:0
    ds_read_b64_tr_b16 v[130:131], v11 offset:512
    ds_read_b64_tr_b16 v[132:133], v11 offset:8
    ds_read_b64_tr_b16 v[134:135], v11 offset:520
    ds_read_b64_tr_b16 v[136:137], v12 offset:0
    ds_read_b64_tr_b16 v[138:139], v12 offset:512
    ds_read_b64_tr_b16 v[140:141], v12 offset:8
    ds_read_b64_tr_b16 v[142:143], v12 offset:520
    s_waitcnt lgkmcnt(0)
    s_add_u32 m0, s70, 0
    s_waitcnt vmcnt(4)
    buffer_load_dwordx4 v13, s[36:39], 0 offen offset:0 lds
    s_waitcnt vmcnt(4)
    buffer_load_dwordx4 v13, s[36:39], s71 offen offset:1024 lds
    s_waitcnt vmcnt(4)
    buffer_load_dwordx4 v13, s[36:39], s72 offen offset:2048 lds
    s_waitcnt vmcnt(4)
    buffer_load_dwordx4 v13, s[36:39], s73 offen offset:3072 lds
    v_xor_b32 v13, 16384, v13
    s_waitcnt vmcnt(12)
    ds_read_b64_tr_b16 v[144:145], v11 offset:4096
    ds_read_b64_tr_b16 v[146:147], v11 offset:4608
    ds_read_b64_tr_b16 v[148:149], v11 offset:4104
    ds_read_b64_tr_b16 v[150:151], v11 offset:4616
    ds_read_b64_tr_b16 v[152:153], v12 offset:4096
    ds_read_b64_tr_b16 v[154:155], v12 offset:4608
    ds_read_b64_tr_b16 v[156:157], v12 offset:4104
    ds_read_b64_tr_b16 v[158:159], v12 offset:4616
    s_waitcnt lgkmcnt(0)
    s_add_u32 m0, s70, 4096
    s_waitcnt vmcnt(4)
    buffer_load_dwordx4 v13, s[36:39], 0 offen offset:0 lds
    s_waitcnt vmcnt(4)
    buffer_load_dwordx4 v13, s[36:39], s71 offen offset:1024 lds
    s_waitcnt vmcnt(4)
    buffer_load_dwordx4 v13, s[36:39], s72 offen offset:2048 lds
    s_waitcnt vmcnt(4)
    buffer_load_dwordx4 v13, s[36:39], s73 offen offset:3072 lds
    v_xor_b32 v13, 49152, v13
    s_waitcnt vmcnt(12)
    ds_read_b64_tr_b16 v[160:161], v11 offset:8192
    ds_read_b64_tr_b16 v[162:163], v11 offset:8704
    ds_read_b64_tr_b16 v[164:165], v11 offset:8200
    ds_read_b64_tr_b16 v[166:167], v11 offset:8712
    ds_read_b64_tr_b16 v[168:169], v12 offset:8192
    ds_read_b64_tr_b16 v[170:171], v12 offset:8704
    ds_read_b64_tr_b16 v[172:173], v12 offset:8200
    ds_read_b64_tr_b16 v[174:175], v12 offset:8712
    s_waitcnt lgkmcnt(0)
    s_add_u32 m0, s70, 8192
    s_waitcnt vmcnt(4)
    buffer_load_dwordx4 v13, s[36:39], 0 offen offset:0 lds
    s_waitcnt vmcnt(4)
    buffer_load_dwordx4 v13, s[36:39], s71 offen offset:1024 lds
    s_waitcnt vmcnt(4)
    buffer_load_dwordx4 v13, s[36:39], s72 offen offset:2048 lds
    s_waitcnt vmcnt(4)
    buffer_load_dwordx4 v13, s[36:39], s73 offen offset:3072 lds
    v_xor_b32 v13, 16384, v13
    buffer_load_dword v1, v0, s[44:47], s74 offen sc1
    s_waitcnt vmcnt(13)
    ds_read_b64_tr_b16 v[176:177], v11 offset:12288
    ds_read_b64_tr_b16 v[178:179], v11 offset:12800
    ds_read_b64_tr_b16 v[180:181], v11 offset:12296
    ds_read_b64_tr_b16 v[182:183], v11 offset:12808
    ds_read_b64_tr_b16 v[184:185], v12 offset:12288
    ds_read_b64_tr_b16 v[186:187], v12 offset:12800
    ds_read_b64_tr_b16 v[188:189], v12 offset:12296
    ds_read_b64_tr_b16 v[190:191], v12 offset:12808
    s_waitcnt lgkmcnt(0)
    s_add_u32 m0, s70, 12288
    s_nop 0
    buffer_load_dwordx4 v13, s[36:39], 0 offen offset:0 lds
    buffer_load_dwordx4 v13, s[36:39], s71 offen offset:1024 lds
    buffer_load_dwordx4 v13, s[36:39], s72 offen offset:2048 lds
    buffer_load_dwordx4 v13, s[36:39], s73 offen offset:3072 lds
    v_xor_b32 v13, 114688, v13
    s_waitcnt vmcnt(13)
    ds_read_b64_tr_b16 v[192:193], v11 offset:0
    ds_read_b64_tr_b16 v[194:195], v11 offset:512
    ds_read_b64_tr_b16 v[196:197], v11 offset:8
    ds_read_b64_tr_b16 v[198:199], v11 offset:520
    ds_read_b64_tr_b16 v[200:201], v12 offset:0
    ds_read_b64_tr_b16 v[202:203], v12 offset:512
    ds_read_b64_tr_b16 v[204:205], v12 offset:8
    ds_read_b64_tr_b16 v[206:207], v12 offset:520
    s_waitcnt vmcnt(9)
    ds_read_b64_tr_b16 v[208:209], v11 offset:4096
    ds_read_b64_tr_b16 v[210:211], v11 offset:4608
    ds_read_b64_tr_b16 v[212:213], v11 offset:4104
    ds_read_b64_tr_b16 v[214:215], v11 offset:4616
    ds_read_b64_tr_b16 v[216:217], v12 offset:4096
    ds_read_b64_tr_b16 v[218:219], v12 offset:4608
    ds_read_b64_tr_b16 v[220:221], v12 offset:4104
    ds_read_b64_tr_b16 v[222:223], v12 offset:4616
    s_waitcnt vmcnt(5)
    ds_read_b64_tr_b16 v[224:225], v11 offset:8192
    ds_read_b64_tr_b16 v[226:227], v11 offset:8704
    ds_read_b64_tr_b16 v[228:229], v11 offset:8200
    ds_read_b64_tr_b16 v[230:231], v11 offset:8712
    ds_read_b64_tr_b16 v[232:233], v12 offset:8192
    ds_read_b64_tr_b16 v[234:235], v12 offset:8704
    ds_read_b64_tr_b16 v[236:237], v12 offset:8200
    ds_read_b64_tr_b16 v[238:239], v12 offset:8712
    s_waitcnt vmcnt(4)
L_spin_17:
    ds_read_b128 v[16:19], v5
    s_waitcnt lgkmcnt(0)
    v_readfirstlane_b32 s101, v18
    v_readfirstlane_b32 s30, v19
    s_cmp_ge_u32 s101, 1
    s_cbranch_scc0 L_retry_18
L_mchk_16:
    v_cmp_ne_u32 vcc, s30, v1
    s_cbranch_vccnz L_mre_19
    buffer_load_dwordx4 v[40:43], v14, s[44:47], s75 offen offset:0 sc1
    buffer_load_dwordx4 v[44:47], v14, s[44:47], s75 offen offset:1024 sc1
    buffer_load_dwordx4 v[48:51], v14, s[44:47], s75 offen offset:2048 sc1
    buffer_load_dwordx4 v[52:55], v14, s[44:47], s75 offen offset:3072 sc1
    s_xor_b32 s75, s75, 4096
    buffer_load_dwordx4 v[56:59], v14, s[44:47], s75 offen offset:0 sc1
    buffer_load_dwordx4 v[60:63], v14, s[44:47], s75 offen offset:1024 sc1
    buffer_load_dwordx4 v[64:67], v14, s[44:47], s75 offen offset:2048 sc1
    buffer_load_dwordx4 v[68:71], v14, s[44:47], s75 offen offset:3072 sc1
    s_xor_b32 s75, s75, 12288
    buffer_load_dwordx4 v[72:75], v14, s[44:47], s75 offen offset:0 sc1
    buffer_load_dwordx4 v[76:79], v14, s[44:47], s75 offen offset:1024 sc1
    s_waitcnt vmcnt(10)
    ds_read_b64_tr_b16 v[240:241], v11 offset:12288
    ds_read_b64_tr_b16 v[242:243], v11 offset:12800
    ds_read_b64_tr_b16 v[244:245], v11 offset:12296
    ds_read_b64_tr_b16 v[246:247], v11 offset:12808
    ds_read_b64_tr_b16 v[248:249], v12 offset:12288
    ds_read_b64_tr_b16 v[250:251], v12 offset:12800
    ds_read_b64_tr_b16 v[252:253], v12 offset:12296
    ds_read_b64_tr_b16 v[254:255], v12 offset:12808
L_spin_20:
    ds_read_b32 v15, v5 offset:4
    s_waitcnt lgkmcnt(0)
    v_readfirstlane_b32 s101, v15
    s_cmp_ge_u32 s101, 4
    s_cbranch_scc0 L_retry_21
    ds_read_b128 v[16:19], v7 offset:1024
    ds_read_b128 v[20:23], v7 offset:9216
    ds_read_b128 v[24:27], v7 offset:17408
    v_xor_b32 v7, 0x100, v7
    ds_read_b128 v[28:31], v8 offset:1024
    ds_read_b128 v[32:35], v8 offset:9216
    ds_read_b128 v[36:39], v8 offset:17408
    v_xor_b32 v8, 0x100, v8
    s_waitcnt lgkmcnt(3)
    s_waitcnt vmcnt(9)
    v_mfma_f32_16x16x32_bf16 v[80:83], v[40:43], v[16:19], 0
    v_mfma_f32_16x16x32_bf16 v[96:99], v[40:43], v[20:23], 0
    v_mfma_f32_16x16x32_bf16 v[112:115], v[40:43], v[24:27], 0
    buffer_load_dwordx4 v[40:43], v14, s[44:47], s75 offen offset:2048 sc1
    s_waitcnt vmcnt(9)
    v_mfma_f32_16x16x32_bf16 v[84:87], v[44:47], v[16:19], 0
    v_mfma_f32_16x16x32_bf16 v[100:103], v[44:47], v[20:23], 0
    v_mfma_f32_16x16x32_bf16 v[116:119], v[44:47], v[24:27], 0
    buffer_load_dwordx4 v[44:47], v14, s[44:47], s75 offen offset:3072 sc1
    s_xor_b32 s75, s75, 4096
    s_waitcnt vmcnt(9)
    v_mfma_f32_16x16x32_bf16 v[88:91], v[48:51], v[16:19], 0
    v_mfma_f32_16x16x32_bf16 v[104:107], v[48:51], v[20:23], 0
    v_mfma_f32_16x16x32_bf16 v[120:123], v[48:51], v[24:27], 0
    buffer_load_dwordx4 v[48:51], v14, s[44:47], s75 offen offset:0 sc1
    s_waitcnt vmcnt(9)
    v_mfma_f32_16x16x32_bf16 v[92:95], v[52:55], v[16:19], 0
    v_mfma_f32_16x16x32_bf16 v[108:111], v[52:55], v[20:23], 0
    v_mfma_f32_16x16x32_bf16 v[124:127], v[52:55], v[24:27], 0
    buffer_load_dwordx4 v[52:55], v14, s[44:47], s75 offen offset:1024 sc1
    ds_read_b128 v[16:19], v9 offset:1024
    ds_read_b128 v[20:23], v9 offset:9216
    ds_read_b128 v[24:27], v9 offset:17408
    v_xor_b32 v9, 0x100, v9
    s_waitcnt lgkmcnt(3)
    s_waitcnt vmcnt(9)
    v_mfma_f32_16x16x32_bf16 v[80:83], v[56:59], v[28:31], v[80:83]
    v_mfma_f32_16x16x32_bf16 v[96:99], v[56:59], v[32:35], v[96:99]
    v_mfma_f32_16x16x32_bf16 v[112:115], v[56:59], v[36:39], v[112:115]
    buffer_load_dwordx4 v[56:59], v14, s[44:47], s75 offen offset:2048 sc1
    s_waitcnt vmcnt(9)
    v_mfma_f32_16x16x32_bf16 v[84:87], v[60:63], v[28:31], v[84:87]
    v_mfma_f32_16x16x32_bf16 v[100:103], v[60:63], v[32:35], v[100:103]
    v_mfma_f32_16x16x32_bf16 v[116:119], v[60:63], v[36:39], v[116:119]
    buffer_load_dwordx4 v[60:63], v14, s[44:47], s75 offen offset:3072 sc1
    s_xor_b32 s75, s75, 28672
    s_waitcnt vmcnt(9)
    v_mfma_f32_16x16x32_bf16 v[88:91], v[64:67], v[28:31], v[88:91]
    v_mfma_f32_16x16x32_bf16 v[104:107], v[64:67], v[32:35], v[104:107]
    v_mfma_f32_16x16x32_bf16 v[120:123], v[64:67], v[36:39], v[120:123]
    buffer_load_dwordx4 v[64:67], v14, s[44:47], s75 offen offset:0 sc1
    s_waitcnt vmcnt(9)
    v_mfma_f32_16x16x32_bf16 v[92:95], v[68:71], v[28:31], v[92:95]
    v_mfma_f32_16x16x32_bf16 v[108:111], v[68:71], v[32:35], v[108:111]
    v_mfma_f32_16x16x32_bf16 v[124:127], v[68:71], v[36:39], v[124:127]
    buffer_load_dwordx4 v[68:71], v14, s[44:47], s75 offen offset:1024 sc1
    ds_read_b128 v[28:31], v10 offset:1024
    ds_read_b128 v[32:35], v10 offset:9216
    ds_read_b128 v[36:39], v10 offset:17408
    v_xor_b32 v10, 0x100, v10
    s_waitcnt lgkmcnt(3)
    s_waitcnt vmcnt(9)
    v_mfma_f32_16x16x32_bf16 v[80:83], v[72:75], v[16:19], v[80:83]
    v_mfma_f32_16x16x32_bf16 v[96:99], v[72:75], v[20:23], v[96:99]
    v_mfma_f32_16x16x32_bf16 v[112:115], v[72:75], v[24:27], v[112:115]
    buffer_load_dwordx4 v[72:75], v14, s[44:47], s75 offen offset:2048 sc1
    s_waitcnt vmcnt(9)
    v_mfma_f32_16x16x32_bf16 v[84:87], v[76:79], v[16:19], v[84:87]
    v_mfma_f32_16x16x32_bf16 v[100:103], v[76:79], v[20:23], v[100:103]
    v_mfma_f32_16x16x32_bf16 v[116:119], v[76:79], v[24:27], v[116:119]
    buffer_load_dwordx4 v[76:79], v14, s[44:47], s75 offen offset:3072 sc1
    s_xor_b32 s75, s75, 4096
    s_waitcnt vmcnt(9)
    v_mfma_f32_16x16x32_bf16 v[88:91], v[40:43], v[16:19], v[88:91]
    v_mfma_f32_16x16x32_bf16 v[104:107], v[40:43], v[20:23], v[104:107]
    v_mfma_f32_16x16x32_bf16 v[120:123], v[40:43], v[24:27], v[120:123]
    buffer_load_dwordx4 v[40:43], v14, s[44:47], s75 offen offset:0 sc1
    s_waitcnt vmcnt(9)
    v_mfma_f32_16x16x32_bf16 v[92:95], v[44:47], v[16:19], v[92:95]
    v_mfma_f32_16x16x32_bf16 v[108:111], v[44:47], v[20:23], v[108:111]
    v_mfma_f32_16x16x32_bf16 v[124:127], v[44:47], v[24:27], v[124:127]
    buffer_load_dwordx4 v[44:47], v14, s[44:47], s75 offen offset:1024 sc1
    ds_read_b128 v[16:19], v7 offset:1024
    ds_read_b128 v[20:23], v7 offset:9216
    ds_read_b128 v[24:27], v7 offset:17408
    v_xor_b32 v7, 0x100, v7
    s_waitcnt lgkmcnt(3)
    s_waitcnt vmcnt(9)
    v_mfma_f32_16x16x32_bf16 v[80:83], v[48:51], v[28:31], v[80:83]
    v_mfma_f32_16x16x32_bf16 v[96:99], v[48:51], v[32:35], v[96:99]
    v_mfma_f32_16x16x32_bf16 v[112:115], v[48:51], v[36:39], v[112:115]
    buffer_load_dwordx4 v[48:51], v14, s[44:47], s75 offen offset:2048 sc1
    s_waitcnt vmcnt(9)
    v_mfma_f32_16x16x32_bf16 v[84:87], v[52:55], v[28:31], v[84:87]
    v_mfma_f32_16x16x32_bf16 v[100:103], v[52:55], v[32:35], v[100:103]
    v_mfma_f32_16x16x32_bf16 v[116:119], v[52:55], v[36:39], v[116:119]
    buffer_load_dwordx4 v[52:55], v14, s[44:47], s75 offen offset:3072 sc1
    s_xor_b32 s75, s75, 12288
    s_waitcnt vmcnt(9)
    v_mfma_f32_16x16x32_bf16 v[88:91], v[56:59], v[28:31], v[88:91]
    v_mfma_f32_16x16x32_bf16 v[104:107], v[56:59], v[32:35], v[104:107]
    v_mfma_f32_16x16x32_bf16 v[120:123], v[56:59], v[36:39], v[120:123]
    buffer_load_dwordx4 v[56:59], v14, s[44:47], s75 offen offset:0 sc1
    s_waitcnt vmcnt(9)
    v_mfma_f32_16x16x32_bf16 v[92:95], v[60:63], v[28:31], v[92:95]
    v_mfma_f32_16x16x32_bf16 v[108:111], v[60:63], v[32:35], v[108:111]
    v_mfma_f32_16x16x32_bf16 v[124:127], v[60:63], v[36:39], v[124:127]
    buffer_load_dwordx4 v[60:63], v14, s[44:47], s75 offen offset:1024 sc1
    ds_read_b128 v[28:31], v8 offset:1024
    ds_read_b128 v[32:35], v8 offset:9216
    ds_read_b128 v[36:39], v8 offset:17408
    v_xor_b32 v8, 0x100, v8
    s_waitcnt lgkmcnt(3)
    s_waitcnt vmcnt(9)
    v_mfma_f32_16x16x32_bf16 v[80:83], v[64:67], v[16:19], v[80:83]
    v_mfma_f32_16x16x32_bf16 v[96:99], v[64:67], v[20:23], v[96:99]
    v_mfma_f32_16x16x32_bf16 v[112:115], v[64:67], v[24:27], v[112:115]
    buffer_load_dwordx4 v[64:67], v14, s[44:47], s75 offen offset:2048 sc1
    s_waitcnt vmcnt(9)
    v_mfma_f32_16x16x32_bf16 v[84:87], v[68:71], v[16:19], v[84:87]
    v_mfma_f32_16x16x32_bf16 v[100:103], v[68:71], v[20:23], v[100:103]
    v_mfma_f32_16x16x32_bf16 v[116:119], v[68:71], v[24:27], v[116:119]
    buffer_load_dwordx4 v[68:71], v14, s[44:47], s75 offen offset:3072 sc1
    s_xor_b32 s75, s75, 4096
    s_waitcnt vmcnt(9)
    v_mfma_f32_16x16x32_bf16 v[88:91], v[72:75], v[16:19], v[88:91]
    v_mfma_f32_16x16x32_bf16 v[104:107], v[72:75], v[20:23], v[104:107]
    v_mfma_f32_16x16x32_bf16 v[120:123], v[72:75], v[24:27], v[120:123]
    buffer_load_dwordx4 v[72:75], v14, s[44:47], s75 offen offset:0 sc1
    s_waitcnt vmcnt(9)
    v_mfma_f32_16x16x32_bf16 v[92:95], v[76:79], v[16:19], v[92:95]
    v_mfma_f32_16x16x32_bf16 v[108:111], v[76:79], v[20:23], v[108:111]
    v_mfma_f32_16x16x32_bf16 v[124:127], v[76:79], v[24:27], v[124:127]
    buffer_load_dwordx4 v[76:79], v14, s[44:47], s75 offen offset:1024 sc1
    ds_read_b128 v[16:19], v9 offset:1024
    ds_read_b128 v[20:23], v9 offset:9216
    ds_read_b128 v[24:27], v9 offset:17408
    v_xor_b32 v9, 0x100, v9
    s_waitcnt lgkmcnt(3)
    s_waitcnt vmcnt(9)
    v_mfma_f32_16x16x32_bf16 v[80:83], v[40:43], v[28:31], v[80:83]
    v_mfma_f32_16x16x32_bf16 v[96:99], v[40:43], v[32:35], v[96:99]
    v_mfma_f32_16x16x32_bf16 v[112:115], v[40:43], v[36:39], v[112:115]
    buffer_load_dwordx4 v[40:43], v14, s[44:47], s75 offen offset:2048 sc1
    s_waitcnt vmcnt(9)
    v_mfma_f32_16x16x32_bf16 v[84:87], v[44:47], v[28:31], v[84:87]
    v_mfma_f32_16x16x32_bf16 v[100:103], v[44:47], v[32:35], v[100:103]
    v_mfma_f32_16x16x32_bf16 v[116:119], v[44:47], v[36:39], v[116:119]
    buffer_load_dwordx4 v[44:47], v14, s[44:47], s75 offen offset:3072 sc1
    s_xor_b32 s75, s75, 28672
    s_waitcnt vmcnt(9)
    v_mfma_f32_16x16x32_bf16 v[88:91], v[48:51], v[28:31], v[88:91]
    v_mfma_f32_16x16x32_bf16 v[104:107], v[48:51], v[32:35], v[104:107]
    v_mfma_f32_16x16x32_bf16 v[120:123], v[48:51], v[36:39], v[120:123]
    s_add_u32 m0, s70, 0
    s_nop 0
    buffer_load_dwordx4 v13, s[40:43], 0 offen offset:0 lds
    s_waitcnt vmcnt(9)
    v_mfma_f32_16x16x32_bf16 v[92:95], v[52:55], v[28:31], v[92:95]
    v_mfma_f32_16x16x32_bf16 v[108:111], v[52:55], v[32:35], v[108:111]
    v_mfma_f32_16x16x32_bf16 v[124:127], v[52:55], v[36:39], v[124:127]
    buffer_load_dwordx4 v13, s[40:43], s71 offen offset:1024 lds
    ds_read_b128 v[28:31], v10 offset:1024
    ds_read_b128 v[32:35], v10 offset:9216
    ds_read_b128 v[36:39], v10 offset:17408
    v_xor_b32 v10, 0x100, v10
    s_waitcnt lgkmcnt(3)
    s_waitcnt vmcnt(9)
    v_mfma_f32_16x16x32_bf16 v[80:83], v[56:59], v[16:19], v[80:83]
    v_mfma_f32_16x16x32_bf16 v[96:99], v[56:59], v[20:23], v[96:99]
    v_mfma_f32_16x16x32_bf16 v[112:115], v[56:59], v[24:27], v[112:115]
    buffer_load_dwordx4 v13, s[40:43], s72 offen offset:2048 lds
    s_waitcnt vmcnt(9)
    v_mfma_f32_16x16x32_bf16 v[84:87], v[60:63], v[16:19], v[84:87]
    v_mfma_f32_16x16x32_bf16 v[100:103], v[60:63], v[20:23], v[100:103]
    v_mfma_f32_16x16x32_bf16 v[116:119], v[60:63], v[24:27], v[116:119]
    buffer_load_dwordx4 v13, s[40:43], s73 offen offset:3072 lds
    v_xor_b32 v13, 16384, v13
    s_waitcnt vmcnt(9)
    v_mfma_f32_16x16x32_bf16 v[88:91], v[64:67], v[16:19], v[88:91]
    v_mfma_f32_16x16x32_bf16 v[104:107], v[64:67], v[20:23], v[104:107]
    v_mfma_f32_16x16x32_bf16 v[120:123], v[64:67], v[24:27], v[120:123]
    s_add_u32 m0, s70, 4096
    s_nop 0
    buffer_load_dwordx4 v13, s[40:43], 0 offen offset:0 lds
    s_waitcnt vmcnt(9)
    v_mfma_f32_16x16x32_bf16 v[92:95], v[68:71], v[16:19], v[92:95]
    v_mfma_f32_16x16x32_bf16 v[108:111], v[68:71], v[20:23], v[108:111]
    v_mfma_f32_16x16x32_bf16 v[124:127], v[68:71], v[24:27], v[124:127]
    buffer_load_dwordx4 v13, s[40:43], s71 offen offset:1024 lds
    s_waitcnt lgkmcnt(0)
    s_waitcnt vmcnt(9)
    v_mfma_f32_16x16x32_bf16 v[80:83], v[72:75], v[28:31], v[80:83]
    v_mfma_f32_16x16x32_bf16 v[96:99], v[72:75], v[32:35], v[96:99]
    v_mfma_f32_16x16x32_bf16 v[112:115], v[72:75], v[36:39], v[112:115]
    buffer_load_dwordx4 v13, s[40:43], s72 offen offset:2048 lds
    s_waitcnt vmcnt(9)
    v_mfma_f32_16x16x32_bf16 v[84:87], v[76:79], v[28:31], v[84:87]
    v_mfma_f32_16x16x32_bf16 v[100:103], v[76:79], v[32:35], v[100:103]
    v_mfma_f32_16x16x32_bf16 v[116:119], v[76:79], v[36:39], v[116:119]
    buffer_load_dwordx4 v13, s[40:43], s73 offen offset:3072 lds
    v_xor_b32 v13, 49152, v13
    s_waitcnt vmcnt(9)
    v_mfma_f32_16x16x32_bf16 v[88:91], v[40:43], v[28:31], v[88:91]
    v_mfma_f32_16x16x32_bf16 v[104:107], v[40:43], v[32:35], v[104:107]
    v_mfma_f32_16x16x32_bf16 v[120:123], v[40:43], v[36:39], v[120:123]
    s_add_u32 m0, s70, 8192
    s_nop 0
    buffer_load_dwordx4 v13, s[40:43], 0 offen offset:0 lds
    s_waitcnt vmcnt(9)
    v_mfma_f32_16x16x32_bf16 v[92:95], v[44:47], v[28:31], v[92:95]
    v_mfma_f32_16x16x32_bf16 v[108:111], v[44:47], v[32:35], v[108:111]
    v_mfma_f32_16x16x32_bf16 v[124:127], v[44:47], v[36:39], v[124:127]
    buffer_load_dwordx4 v13, s[40:43], s71 offen offset:1024 lds
    s_lshl_b32 s64, s31, 3
    v_add_u32 v0, s64, v4
    v_xor_b32 v0, v0, v3
    v_lshlrev_b32 v0, 4, v0
    v_lshl_add_u32 v0, v3, 9, v0
    v_xor_b32 v1, 64, v0
    s_mov_b32 s76, 0x00ff00ff
    s_mov_b32 s77, 0x00ff00ff
    v_cvt_pk_bf16_f32 v16, v80, v81
    v_cvt_pk_bf16_f32 v17, v82, v83
    v_cvt_pk_bf16_f32 v18, v84, v85
    v_cvt_pk_bf16_f32 v19, v86, v87
    ds_write_b128 v0, v[16:19] offset:21504
    v_cvt_pk_bf16_f32 v20, v88, v89
    v_cvt_pk_bf16_f32 v21, v90, v91
    v_cvt_pk_bf16_f32 v22, v92, v93
    v_cvt_pk_bf16_f32 v23, v94, v95
    ds_write_b128 v1, v[20:23] offset:21504
    v_cvt_pk_bf16_f32 v24, v96, v97
    v_cvt_pk_bf16_f32 v25, v98, v99
    v_cvt_pk_bf16_f32 v26, v100, v101
    v_cvt_pk_bf16_f32 v27, v102, v103
    ds_write_b128 v0, v[24:27] offset:29696
    v_cvt_pk_bf16_f32 v28, v104, v105
    v_cvt_pk_bf16_f32 v29, v106, v107
    v_cvt_pk_bf16_f32 v30, v108, v109
    v_cvt_pk_bf16_f32 v31, v110, v111
    ds_write_b128 v1, v[28:31] offset:29696
    s_mov_b64 exec, s[76:77]
    v_cvt_pk_bf16_f32 v32, v112, v113
    v_cvt_pk_bf16_f32 v33, v114, v115
    v_cvt_pk_bf16_f32 v34, v116, v117
    v_cvt_pk_bf16_f32 v35, v118, v119
    ds_write_b128 v0, v[32:35] offset:37888
    v_cvt_pk_bf16_f32 v36, v120, v121
    v_cvt_pk_bf16_f32 v37, v122, v123
    v_cvt_pk_bf16_f32 v38, v124, v125
    v_cvt_pk_bf16_f32 v39, v126, v127
    ds_write_b128 v1, v[36:39] offset:37888
    s_mov_b64 exec, -1
    s_waitcnt lgkmcnt(0)
    s_barrier
    buffer_load_dwordx4 v13, s[40:43], s72 offen offset:2048 lds
    buffer_load_dwordx4 v13, s[40:43], s73 offen offset:3072 lds
    v_xor_b32 v13, 16384, v13
    s_add_u32 m0, s70, 12288
    s_nop 0
    buffer_load_dwordx4 v13, s[40:43], 0 offen offset:0 lds
    buffer_load_dwordx4 v13, s[40:43], s71 offen offset:1024 lds
    buffer_load_dwordx4 v13, s[40:43], s72 offen offset:2048 lds
    buffer_load_dwordx4 v13, s[40:43], s73 offen offset:3072 lds
    v_xor_b32 v13, 114688, v13
    v_lshlrev_b32 v0, 4, v4
    v_and_b32 v1, 7, v3
    v_lshl_add_u32 v0, v1, 9, v0
    v_and_b32 v1, 8, v3
    v_lshl_add_u32 v0, v1, 3, v0
    s_mul_i32 s74, s1, 20480
    s_lshl_b32 s64, s31, 7
    s_add_u32 s74, s74, s64
    s_waitcnt vmcnt(8)
    ds_read_b64_tr_b16 v[48:49], v11 offset:0
    ds_read_b64_tr_b16 v[50:51], v11 offset:512
    ds_read_b64_tr_b16 v[52:53], v11 offset:8
    ds_read_b64_tr_b16 v[54:55], v11 offset:520
    ds_read_b64_tr_b16 v[56:57], v12 offset:0
    ds_read_b64_tr_b16 v[58:59], v12 offset:512
    ds_read_b64_tr_b16 v[60:61], v12 offset:8
    ds_read_b64_tr_b16 v[62:63], v12 offset:520
    ds_read_b64_tr_b16 v[64:65], v11 offset:4096
    ds_read_b64_tr_b16 v[66:67], v11 offset:4608
    ds_read_b64_tr_b16 v[68:69], v11 offset:4104
    ds_read_b64_tr_b16 v[70:71], v11 offset:4616
    ds_read_b64_tr_b16 v[72:73], v12 offset:4096
    ds_read_b64_tr_b16 v[74:75], v12 offset:4608
    ds_read_b64_tr_b16 v[76:77], v12 offset:4104
    ds_read_b64_tr_b16 v[78:79], v12 offset:4616
    s_waitcnt lgkmcnt(8)
    s_add_u32 m0, s70, 0
    s_nop 0
    buffer_load_dwordx4 v13, s[40:43], 0 offen offset:0 lds
    buffer_load_dwordx4 v13, s[40:43], s71 offen offset:1024 lds
    buffer_load_dwordx4 v13, s[40:43], s72 offen offset:2048 lds
    buffer_load_dwordx4 v13, s[40:43], s73 offen offset:3072 lds
    v_xor_b32 v13, 16384, v13
    s_waitcnt lgkmcnt(0)
    s_add_u32 m0, s70, 4096
    s_nop 0
    buffer_load_dwordx4 v13, s[40:43], 0 offen offset:0 lds
    buffer_load_dwordx4 v13, s[40:43], s71 offen offset:1024 lds
    buffer_load_dwordx4 v13, s[40:43], s72 offen offset:2048 lds
    buffer_load_dwordx4 v13, s[40:43], s73 offen offset:3072 lds
    v_xor_b32 v13, 49152, v13
    s_lshl_b32 s64, s31, 12
    s_add_u32 s78, s64, 21504
    s_add_u32 s79, s64, 148480
    s_cmp_eq_u32 s31, 3
    s_cselect_b32 s79, 37888, s79
    s_sub_u32 s76, s78, s70
    s_sub_u32 s77, s79, s78
    v_xor_b32 v40, 0x100, v7
    v_xor_b32 v41, 0x100, v8
    v_xor_b32 v42, 0x100, v9
    v_xor_b32 v43, 0x100, v10
    s_barrier
    s_mov_b32 m0, s78
    s_nop 0
    buffer_load_dwordx4 v13, s[40:43], 0 offen offset:0 lds
    buffer_load_dwordx4 v13, s[40:43], s71 offen offset:1024 lds
    buffer_load_dwordx4 v13, s[40:43], s72 offen offset:2048 lds
    buffer_load_dwordx4 v13, s[40:43], s73 offen offset:3072 lds
    v_xor_b32 v13, 16384, v13
    s_mov_b32 m0, s79
    s_nop 0
    buffer_load_dwordx4 v13, s[40:43], 0 offen offset:0 lds
    buffer_load_dwordx4 v13, s[40:43], s71 offen offset:1024 lds
    buffer_load_dwordx4 v13, s[40:43], s72 offen offset:2048 lds
    buffer_load_dwordx4 v13, s[40:43], s73 offen offset:3072 lds
    v_xor_b32 v13, 114688, v13
    s_setprio 0
L_prog_22:
    ds_read_b128 v[16:19], v5 offset:32
    s_waitcnt lgkmcnt(0)
    v_min3_u32 v16, v16, v17, v18
    v_min_u32 v16, v16, v19
    v_cmp_gt_u32 vcc, 1, v16
    s_cbranch_vccnz L_retry_23
    ds_read_b128 v[16:19], v7 offset:1024
    ds_read_b128 v[20:23], v7 offset:9216
    ds_read_b128 v[24:27], v7 offset:17408
    s_waitcnt vmcnt(8)
    s_waitcnt lgkmcnt(0)
    v_mfma_f32_16x16x32_bf16 v[80:83], v[128:131], v[16:19], 0
    ds_read_b128 v[28:31], v8 offset:1024
    v_mfma_f32_16x16x32_bf16 v[96:99], v[128:131], v[20:23], 0
    ds_read_b128 v[32:35], v8 offset:9216
    v_mfma_f32_16x16x32_bf16 v[112:115], v[128:131], v[24:27], 0
    ds_read_b128 v[36:39], v8 offset:17408
    v_mfma_f32_16x16x32_bf16 v[84:87], v[132:135], v[16:19], 0
    v_mfma_f32_16x16x32_bf16 v[100:103], v[132:135], v[20:23], 0
    v_mfma_f32_16x16x32_bf16 v[116:119], v[132:135], v[24:27], 0
    v_mfma_f32_16x16x32_bf16 v[88:91], v[136:139], v[16:19], 0
    v_mfma_f32_16x16x32_bf16 v[104:107], v[136:139], v[20:23], 0
    v_mfma_f32_16x16x32_bf16 v[120:123], v[136:139], v[24:27], 0
    v_mfma_f32_16x16x32_bf16 v[92:95], v[140:143], v[16:19], 0
    v_mfma_f32_16x16x32_bf16 v[108:111], v[140:143], v[20:23], 0
    v_mfma_f32_16x16x32_bf16 v[124:127], v[140:143], v[24:27], 0
    s_waitcnt lgkmcnt(0)
    v_mfma_f32_16x16x32_bf16 v[80:83], v[144:147], v[28:31], v[80:83]
    ds_read_b128 v[16:19], v9 offset:1024
    v_mfma_f32_16x16x32_bf16 v[96:99], v[144:147], v[32:35], v[96:99]
    ds_read_b128 v[20:23], v9 offset:9216
    v_mfma_f32_16x16x32_bf16 v[112:115], v[144:147], v[36:39], v[112:115]
    ds_read_b128 v[24:27], v9 offset:17408
    v_mfma_f32_16x16x32_bf16 v[84:87], v[148:151], v[28:31], v[84:87]
    ds_read_b64_tr_b16 v[128:129], v11 offset:8192
    v_mfma_f32_16x16x32_bf16 v[100:103], v[148:151], v[32:35], v[100:103]
    ds_read_b64_tr_b16 v[130:131], v11 offset:8704
    v_mfma_f32_16x16x32_bf16 v[116:119], v[148:151], v[36:39], v[116:119]
    ds_read_b64_tr_b16 v[132:133], v11 offset:8200
    v_mfma_f32_16x16x32_bf16 v[88:91], v[152:155], v[28:31], v[88:91]
    ds_read_b64_tr_b16 v[134:135], v11 offset:8712
    v_mfma_f32_16x16x32_bf16 v[104:107], v[152:155], v[32:35], v[104:107]
    ds_read_b64_tr_b16 v[136:137], v12 offset:8192
    v_mfma_f32_16x16x32_bf16 v[120:123], v[152:155], v[36:39], v[120:123]
    ds_read_b64_tr_b16 v[138:139], v12 offset:8704
    v_mfma_f32_16x16x32_bf16 v[92:95], v[156:159], v[28:31], v[92:95]
    ds_read_b64_tr_b16 v[140:141], v12 offset:8200
    v_mfma_f32_16x16x32_bf16 v[108:111], v[156:159], v[32:35], v[108:111]
    ds_read_b64_tr_b16 v[142:143], v12 offset:8712
    v_mfma_f32_16x16x32_bf16 v[124:127], v[156:159], v[36:39], v[124:127]
    s_waitcnt lgkmcnt(8)
    v_mfma_f32_16x16x32_bf16 v[80:83], v[160:163], v[16:19], v[80:83]
    ds_read_b128 v[28:31], v10 offset:1024
    v_mfma_f32_16x16x32_bf16 v[96:99], v[160:163], v[20:23], v[96:99]
    ds_read_b128 v[32:35], v10 offset:9216
    v_mfma_f32_16x16x32_bf16 v[112:115], v[160:163], v[24:27], v[112:115]
    ds_read_b128 v[36:39], v10 offset:17408
    v_mfma_f32_16x16x32_bf16 v[84:87], v[164:167], v[16:19], v[84:87]
    ds_read_b64_tr_b16 v[144:145], v11 offset:12288
    v_mfma_f32_16x16x32_bf16 v[100:103], v[164:167], v[20:23], v[100:103]
    ds_read_b64_tr_b16 v[146:147], v11 offset:12800
    v_mfma_f32_16x16x32_bf16 v[116:119], v[164:167], v[24:27], v[116:119]
    ds_read_b64_tr_b16 v[148:149], v11 offset:12296
    v_mfma_f32_16x16x32_bf16 v[88:91], v[168:171], v[16:19], v[88:91]
    ds_read_b64_tr_b16 v[150:151], v11 offset:12808
    v_mfma_f32_16x16x32_bf16 v[104:107], v[168:171], v[20:23], v[104:107]
    ds_read_b64_tr_b16 v[152:153], v12 offset:12288
    v_mfma_f32_16x16x32_bf16 v[120:123], v[168:171], v[24:27], v[120:123]
    ds_read_b64_tr_b16 v[154:155], v12 offset:12800
    v_mfma_f32_16x16x32_bf16 v[92:95], v[172:175], v[16:19], v[92:95]
    ds_read_b64_tr_b16 v[156:157], v12 offset:12296
    v_mfma_f32_16x16x32_bf16 v[108:111], v[172:175], v[20:23], v[108:111]
    ds_read_b64_tr_b16 v[158:159], v12 offset:12808
    v_mfma_f32_16x16x32_bf16 v[124:127], v[172:175], v[24:27], v[124:127]
    s_waitcnt lgkmcnt(8)
    v_mfma_f32_16x16x32_bf16 v[80:83], v[176:179], v[28:31], v[80:83]
    ds_read_b128 v[16:19], v40 offset:1024
    v_mfma_f32_16x16x32_bf16 v[96:99], v[176:179], v[32:35], v[96:99]
    ds_read_b128 v[20:23], v40 offset:9216
    v_mfma_f32_16x16x32_bf16 v[112:115], v[176:179], v[36:39], v[112:115]
    ds_read_b128 v[24:27], v40 offset:17408
    v_mfma_f32_16x16x32_bf16 v[84:87], v[180:183], v[28:31], v[84:87]
    ds_read_b64_tr_b16 v[160:161], v11 offset:0
    v_mfma_f32_16x16x32_bf16 v[100:103], v[180:183], v[32:35], v[100:103]
    ds_read_b64_tr_b16 v[162:163], v11 offset:512
    v_mfma_f32_16x16x32_bf16 v[116:119], v[180:183], v[36:39], v[116:119]
    ds_read_b64_tr_b16 v[164:165], v11 offset:8
    v_mfma_f32_16x16x32_bf16 v[88:91], v[184:187], v[28:31], v[88:91]
    ds_read_b64_tr_b16 v[166:167], v11 offset:520
    v_mfma_f32_16x16x32_bf16 v[104:107], v[184:187], v[32:35], v[104:107]
    ds_read_b64_tr_b16 v[168:169], v12 offset:0
    v_mfma_f32_16x16x32_bf16 v[120:123], v[184:187], v[36:39], v[120:123]
    ds_read_b64_tr_b16 v[170:171], v12 offset:512
    v_mfma_f32_16x16x32_bf16 v[92:95], v[188:191], v[28:31], v[92:95]
    ds_read_b64_tr_b16 v[172:173], v12 offset:8
    v_mfma_f32_16x16x32_bf16 v[108:111], v[188:191], v[32:35], v[108:111]
    ds_read_b64_tr_b16 v[174:175], v12 offset:520
    v_mfma_f32_16x16x32_bf16 v[124:127], v[188:191], v[36:39], v[124:127]
    s_waitcnt lgkmcnt(8)
    v_mfma_f32_16x16x32_bf16 v[80:83], v[192:195], v[16:19], v[80:83]
    ds_read_b128 v[28:31], v41 offset:1024
    v_mfma_f32_16x16x32_bf16 v[96:99], v[192:195], v[20:23], v[96:99]
    ds_read_b128 v[32:35], v41 offset:9216
    v_mfma_f32_16x16x32_bf16 v[112:115], v[192:195], v[24:27], v[112:115]
    ds_read_b128 v[36:39], v41 offset:17408
    v_mfma_f32_16x16x32_bf16 v[84:87], v[196:199], v[16:19], v[84:87]
    ds_read_b64_tr_b16 v[176:177], v11 offset:4096
    v_mfma_f32_16x16x32_bf16 v[100:103], v[196:199], v[20:23], v[100:103]
    ds_read_b64_tr_b16 v[178:179], v11 offset:4608
    v_mfma_f32_16x16x32_bf16 v[116:119], v[196:199], v[24:27], v[116:119]
    ds_read_b64_tr_b16 v[180:181], v11 offset:4104
    v_mfma_f32_16x16x32_bf16 v[88:91], v[200:203], v[16:19], v[88:91]
    ds_read_b64_tr_b16 v[182:183], v11 offset:4616
    v_mfma_f32_16x16x32_bf16 v[104:107], v[200:203], v[20:23], v[104:107]
    ds_read_b64_tr_b16 v[184:185], v12 offset:4096
    v_mfma_f32_16x16x32_bf16 v[120:123], v[200:203], v[24:27], v[120:123]
    ds_read_b64_tr_b16 v[186:187], v12 offset:4608
    v_mfma_f32_16x16x32_bf16 v[92:95], v[204:207], v[16:19], v[92:95]
    ds_read_b64_tr_b16 v[188:189], v12 offset:4104
    v_mfma_f32_16x16x32_bf16 v[108:111], v[204:207], v[20:23], v[108:111]
    ds_read_b64_tr_b16 v[190:191], v12 offset:4616
    v_mfma_f32_16x16x32_bf16 v[124:127], v[204:207], v[24:27], v[124:127]
    s_waitcnt lgkmcnt(8)
    v_mfma_f32_16x16x32_bf16 v[80:83], v[208:211], v[28:31], v[80:83]
    ds_read_b128 v[16:19], v42 offset:1024
    v_mfma_f32_16x16x32_bf16 v[96:99], v[208:211], v[32:35], v[96:99]
    ds_read_b128 v[20:23], v42 offset:9216
    v_mfma_f32_16x16x32_bf16 v[112:115], v[208:211], v[36:39], v[112:115]
    ds_read_b128 v[24:27], v42 offset:17408
    v_mfma_f32_16x16x32_bf16 v[84:87], v[212:215], v[28:31], v[84:87]
    v_mfma_f32_16x16x32_bf16 v[100:103], v[212:215], v[32:35], v[100:103]
    v_mfma_f32_16x16x32_bf16 v[116:119], v[212:215], v[36:39], v[116:119]
    v_mfma_f32_16x16x32_bf16 v[88:91], v[216:219], v[28:31], v[88:91]
    v_mfma_f32_16x16x32_bf16 v[104:107], v[216:219], v[32:35], v[104:107]
    v_mfma_f32_16x16x32_bf16 v[120:123], v[216:219], v[36:39], v[120:123]
    v_mfma_f32_16x16x32_bf16 v[92:95], v[220:223], v[28:31], v[92:95]
    v_mfma_f32_16x16x32_bf16 v[108:111], v[220:223], v[32:35], v[108:111]
    v_mfma_f32_16x16x32_bf16 v[124:127], v[220:223], v[36:39], v[124:127]
    s_waitcnt lgkmcnt(0)
    v_mfma_f32_16x16x32_bf16 v[80:83], v[224:227], v[16:19], v[80:83]
    v_add_u32 v11, s76, v11
    v_add_u32 v12, s76, v12
    v_mfma_f32_16x16x32_bf16 v[96:99], v[224:227], v[20:23], v[96:99]
    ds_read_b128 v[28:31], v43 offset:1024
    v_mfma_f32_16x16x32_bf16 v[112:115], v[224:227], v[24:27], v[112:115]
    ds_read_b128 v[32:35], v43 offset:9216
    v_mfma_f32_16x16x32_bf16 v[84:87], v[228:231], v[16:19], v[84:87]
    ds_read_b128 v[36:39], v43 offset:17408
    v_mfma_f32_16x16x32_bf16 v[100:103], v[228:231], v[20:23], v[100:103]
    s_waitcnt vmcnt(4)
    ds_read_b64_tr_b16 v[192:193], v11 offset:0
    v_mfma_f32_16x16x32_bf16 v[116:119], v[228:231], v[24:27], v[116:119]
    ds_read_b64_tr_b16 v[194:195], v11 offset:512
    v_mfma_f32_16x16x32_bf16 v[88:91], v[232:235], v[16:19], v[88:91]
    ds_read_b64_tr_b16 v[196:197], v11 offset:8
    v_mfma_f32_16x16x32_bf16 v[104:107], v[232:235], v[20:23], v[104:107]
    ds_read_b64_tr_b16 v[198:199], v11 offset:520
    v_mfma_f32_16x16x32_bf16 v[120:123], v[232:235], v[24:27], v[120:123]
    ds_read_b64_tr_b16 v[200:201], v12 offset:0
    v_mfma_f32_16x16x32_bf16 v[92:95], v[236:239], v[16:19], v[92:95]
    ds_read_b64_tr_b16 v[202:203], v12 offset:512
    v_mfma_f32_16x16x32_bf16 v[108:111], v[236:239], v[20:23], v[108:111]
    ds_read_b64_tr_b16 v[204:205], v12 offset:8
    v_mfma_f32_16x16x32_bf16 v[124:127], v[236:239], v[24:27], v[124:127]
    ds_read_b64_tr_b16 v[206:207], v12 offset:520
    s_waitcnt lgkmcnt(8)
    v_mfma_f32_16x16x32_bf16 v[80:83], v[240:243], v[28:31], v[80:83]
    v_add_u32 v11, s77, v11
    v_add_u32 v12, s77, v12
    v_mfma_f32_16x16x32_bf16 v[96:99], v[240:243], v[32:35], v[96:99]
    s_waitcnt vmcnt(0)
    ds_read_b64_tr_b16 v[208:209], v11 offset:0
    v_mfma_f32_16x16x32_bf16 v[112:115], v[240:243], v[36:39], v[112:115]
    ds_read_b64_tr_b16 v[210:211], v11 offset:512
    v_mfma_f32_16x16x32_bf16 v[84:87], v[244:247], v[28:31], v[84:87]
    ds_read_b64_tr_b16 v[212:213], v11 offset:8
    v_mfma_f32_16x16x32_bf16 v[100:103], v[244:247], v[32:35], v[100:103]
    ds_read_b64_tr_b16 v[214:215], v11 offset:520
    v_mfma_f32_16x16x32_bf16 v[116:119], v[244:247], v[36:39], v[116:119]
    ds_read_b64_tr_b16 v[216:217], v12 offset:0
    v_mfma_f32_16x16x32_bf16 v[88:91], v[248:251], v[28:31], v[88:91]
    ds_read_b64_tr_b16 v[218:219], v12 offset:512
    v_mfma_f32_16x16x32_bf16 v[104:107], v[248:251], v[32:35], v[104:107]
    ds_read_b64_tr_b16 v[220:221], v12 offset:8
    v_mfma_f32_16x16x32_bf16 v[120:123], v[248:251], v[36:39], v[120:123]
    ds_read_b64_tr_b16 v[222:223], v12 offset:520
    v_mfma_f32_16x16x32_bf16 v[92:95], v[252:255], v[28:31], v[92:95]
    v_mfma_f32_16x16x32_bf16 v[108:111], v[252:255], v[32:35], v[108:111]
    v_mfma_f32_16x16x32_bf16 v[124:127], v[252:255], v[36:39], v[124:127]
    s_add_u32 s75, s74, 4096
    s_add_u32 s76, s74, 8192
    s_add_u32 s77, s74, 12288
    s_add_u32 s78, s74, 16384
L_prog_24:
    ds_read_b128 v[16:19], v5 offset:32
    s_waitcnt lgkmcnt(0)
    v_min3_u32 v16, v16, v17, v18
    v_min_u32 v16, v16, v19
    v_cmp_gt_u32 vcc, 1, v16
    s_cbranch_vccnz L_retry_25
    ds_read_b128 v[16:19], v7 offset:58368
    ds_read_b128 v[20:23], v8 offset:58368
    ds_read_b128 v[24:27], v9 offset:58368
    ds_read_b128 v[28:31], v10 offset:58368
    ds_read_b128 v[32:35], v40 offset:58368
    ds_read_b128 v[36:39], v41 offset:58368
    ds_read_b128 v[44:47], v42 offset:58368
    ds_read_b128 v[252:255], v43 offset:58368
    s_waitcnt lgkmcnt(7)
    v_mfma_f32_16x16x32_bf16 v[120:123], v[56:59], v[16:19], v[120:123]
    v_mfma_f32_16x16x32_bf16 v[124:127], v[60:63], v[16:19], v[124:127]
    v_mfma_f32_16x16x32_bf16 v[112:115], v[48:51], v[16:19], v[112:115]
    v_mfma_f32_16x16x32_bf16 v[116:119], v[52:55], v[16:19], v[116:119]
    s_waitcnt lgkmcnt(6)
    v_mfma_f32_16x16x32_bf16 v[120:123], v[72:75], v[20:23], v[120:123]
    v_mfma_f32_16x16x32_bf16 v[124:127], v[76:79], v[20:23], v[124:127]
    v_mfma_f32_16x16x32_bf16 v[112:115], v[64:67], v[20:23], v[112:115]
    v_mfma_f32_16x16x32_bf16 v[116:119], v[68:71], v[20:23], v[116:119]
    s_waitcnt lgkmcnt(5)
    v_mfma_f32_16x16x32_bf16 v[120:123], v[136:139], v[24:27], v[120:123]
    v_mfma_f32_16x16x32_bf16 v[124:127], v[140:143], v[24:27], v[124:127]
    v_mfma_f32_16x16x32_bf16 v[112:115], v[128:131], v[24:27], v[112:115]
    v_mfma_f32_16x16x32_bf16 v[116:119], v[132:135], v[24:27], v[116:119]
    s_waitcnt lgkmcnt(4)
    v_mfma_f32_16x16x32_bf16 v[120:123], v[152:155], v[28:31], v[120:123]
    v_mfma_f32_16x16x32_bf16 v[124:127], v[156:159], v[28:31], v[124:127]
    v_mfma_f32_16x16x32_bf16 v[112:115], v[144:147], v[28:31], v[112:115]
    v_mfma_f32_16x16x32_bf16 v[116:119], v[148:151], v[28:31], v[116:119]
    s_waitcnt lgkmcnt(3)
    v_mfma_f32_16x16x32_bf16 v[120:123], v[168:171], v[32:35], v[120:123]
    v_mfma_f32_16x16x32_bf16 v[124:127], v[172:175], v[32:35], v[124:127]
    v_mfma_f32_16x16x32_bf16 v[112:115], v[160:163], v[32:35], v[112:115]
    v_mfma_f32_16x16x32_bf16 v[116:119], v[164:167], v[32:35], v[116:119]
    s_waitcnt lgkmcnt(2)
    v_mfma_f32_16x16x32_bf16 v[120:123], v[184:187], v[36:39], v[120:123]
    v_mfma_f32_16x16x32_bf16 v[124:127], v[188:191], v[36:39], v[124:127]
    v_mfma_f32_16x16x32_bf16 v[112:115], v[176:179], v[36:39], v[112:115]
    v_mfma_f32_16x16x32_bf16 v[116:119], v[180:183], v[36:39], v[116:119]
    s_waitcnt lgkmcnt(1)
    v_mfma_f32_16x16x32_bf16 v[120:123], v[200:203], v[44:47], v[120:123]
    v_mfma_f32_16x16x32_bf16 v[124:127], v[204:207], v[44:47], v[124:127]
    v_mfma_f32_16x16x32_bf16 v[112:115], v[192:195], v[44:47], v[112:115]
    v_mfma_f32_16x16x32_bf16 v[116:119], v[196:199], v[44:47], v[116:119]
    s_waitcnt lgkmcnt(0)
    v_mfma_f32_16x16x32_bf16 v[120:123], v[216:219], v[252:255], v[120:123]
    v_mfma_f32_16x16x32_bf16 v[124:127], v[220:223], v[252:255], v[124:127]
    v_mfma_f32_16x16x32_bf16 v[112:115], v[208:211], v[252:255], v[112:115]
    v_mfma_f32_16x16x32_bf16 v[116:119], v[212:215], v[252:255], v[116:119]
L_prog_26:
    ds_read_b128 v[16:19], v5 offset:32
    s_waitcnt lgkmcnt(0)
    v_min3_u32 v16, v16, v17, v18
    v_min_u32 v16, v16, v19
    v_cmp_gt_u32 vcc, 3, v16
    s_cbranch_vccnz L_retry_27
    ds_read_b128 v[16:19], v7 offset:41984
    ds_read_b128 v[20:23], v8 offset:41984
    ds_read_b128 v[24:27], v9 offset:41984
    ds_read_b128 v[28:31], v10 offset:41984
    ds_read_b128 v[32:35], v40 offset:41984
    ds_read_b128 v[36:39], v41 offset:41984
    ds_read_b128 v[44:47], v42 offset:41984
    ds_read_b128 v[252:255], v43 offset:41984
    s_waitcnt lgkmcnt(7)
    v_mfma_f32_16x16x32_bf16 v[88:91], v[56:59], v[16:19], v[88:91]
    v_cvt_pk_bf16_f32 v248, v120, v121
    v_mfma_f32_16x16x32_bf16 v[92:95], v[60:63], v[16:19], v[92:95]
    v_cvt_pk_bf16_f32 v249, v122, v123
    v_mfma_f32_16x16x32_bf16 v[80:83], v[48:51], v[16:19], v[80:83]
    v_cvt_pk_bf16_f32 v250, v124, v125
    v_mfma_f32_16x16x32_bf16 v[84:87], v[52:55], v[16:19], v[84:87]
    v_cvt_pk_bf16_f32 v251, v126, v127
    s_waitcnt lgkmcnt(6)
    v_mfma_f32_16x16x32_bf16 v[88:91], v[72:75], v[20:23], v[88:91]
    v_cvt_pk_bf16_f32 v244, v112, v113
    v_mfma_f32_16x16x32_bf16 v[92:95], v[76:79], v[20:23], v[92:95]
    v_cvt_pk_bf16_f32 v245, v114, v115
    v_mfma_f32_16x16x32_bf16 v[80:83], v[64:67], v[20:23], v[80:83]
    v_cvt_pk_bf16_f32 v246, v116, v117
    v_mfma_f32_16x16x32_bf16 v[84:87], v[68:71], v[20:23], v[84:87]
    v_cvt_pk_bf16_f32 v247, v118, v119
    s_waitcnt lgkmcnt(5)
    v_mfma_f32_16x16x32_bf16 v[88:91], v[136:139], v[24:27], v[88:91]
    v_mov_b32_dpp v244, v248 row_ror:8 row_mask:0xf bank_mask:0xc
    v_mfma_f32_16x16x32_bf16 v[92:95], v[140:143], v[24:27], v[92:95]
    v_mov_b32_dpp v245, v249 row_ror:8 row_mask:0xf bank_mask:0xc
    v_mfma_f32_16x16x32_bf16 v[80:83], v[128:131], v[24:27], v[80:83]
    v_mov_b32_dpp v246, v250 row_ror:8 row_mask:0xf bank_mask:0xc
    v_mfma_f32_16x16x32_bf16 v[84:87], v[132:135], v[24:27], v[84:87]
    v_mov_b32_dpp v247, v251 row_ror:8 row_mask:0xf bank_mask:0xc
    s_waitcnt lgkmcnt(4)
    v_mfma_f32_16x16x32_bf16 v[88:91], v[152:155], v[28:31], v[88:91]
    v_mfma_f32_16x16x32_bf16 v[92:95], v[156:159], v[28:31], v[92:95]
    v_mfma_f32_16x16x32_bf16 v[80:83], v[144:147], v[28:31], v[80:83]
    v_mfma_f32_16x16x32_bf16 v[84:87], v[148:151], v[28:31], v[84:87]
    s_waitcnt lgkmcnt(3)
    v_mfma_f32_16x16x32_bf16 v[88:91], v[168:171], v[32:35], v[88:91]
    v_mfma_f32_16x16x32_bf16 v[92:95], v[172:175], v[32:35], v[92:95]
    v_mfma_f32_16x16x32_bf16 v[80:83], v[160:163], v[32:35], v[80:83]
    v_mfma_f32_16x16x32_bf16 v[84:87], v[164:167], v[32:35], v[84:87]
    s_waitcnt lgkmcnt(2)
    v_mfma_f32_16x16x32_bf16 v[88:91], v[184:187], v[36:39], v[88:91]
    v_mfma_f32_16x16x32_bf16 v[92:95], v[188:191], v[36:39], v[92:95]
    v_mfma_f32_16x16x32_bf16 v[80:83], v[176:179], v[36:39], v[80:83]
    v_mfma_f32_16x16x32_bf16 v[84:87], v[180:183], v[36:39], v[84:87]
    s_waitcnt lgkmcnt(1)
    v_mfma_f32_16x16x32_bf16 v[88:91], v[200:203], v[44:47], v[88:91]
    v_mfma_f32_16x16x32_bf16 v[92:95], v[204:207], v[44:47], v[92:95]
    v_mfma_f32_16x16x32_bf16 v[80:83], v[192:195], v[44:47], v[80:83]
    v_mfma_f32_16x16x32_bf16 v[84:87], v[196:199], v[44:47], v[84:87]
    s_waitcnt lgkmcnt(0)
    v_mfma_f32_16x16x32_bf16 v[88:91], v[216:219], v[252:255], v[88:91]
    v_mfma_f32_16x16x32_bf16 v[92:95], v[220:223], v[252:255], v[92:95]
    v_mfma_f32_16x16x32_bf16 v[80:83], v[208:211], v[252:255], v[80:83]
    v_mfma_f32_16x16x32_bf16 v[84:87], v[212:215], v[252:255], v[84:87]
    s_nop 4
    v_cvt_pk_bf16_f32 v228, v88, v89
    v_cvt_pk_bf16_f32 v229, v90, v91
    v_cvt_pk_bf16_f32 v230, v92, v93
    v_cvt_pk_bf16_f32 v231, v94, v95
    v_cvt_pk_bf16_f32 v224, v80, v81
    v_cvt_pk_bf16_f32 v225, v82, v83
    v_cvt_pk_bf16_f32 v226, v84, v85
    v_cvt_pk_bf16_f32 v227, v86, v87
    v_cvt_pk_bf16_f32 v240, v80, v81
    v_cvt_pk_bf16_f32 v241, v82, v83
    v_cvt_pk_bf16_f32 v242, v84, v85
    v_cvt_pk_bf16_f32 v243, v86, v87
    v_mov_b32_dpp v224, v228 row_ror:8 row_mask:0xf bank_mask:0xc
    v_mov_b32_dpp v225, v229 row_ror:8 row_mask:0xf bank_mask:0xc
    v_mov_b32_dpp v226, v230 row_ror:8 row_mask:0xf bank_mask:0xc
    v_mov_b32_dpp v227, v231 row_ror:8 row_mask:0xf bank_mask:0xc
    v_mov_b32_dpp v228, v240 row_ror:8 row_mask:0xf bank_mask:0x3
    v_mov_b32_dpp v229, v241 row_ror:8 row_mask:0xf bank_mask:0x3
    v_mov_b32_dpp v230, v242 row_ror:8 row_mask:0xf bank_mask:0x3
    v_mov_b32_dpp v231, v243 row_ror:8 row_mask:0xf bank_mask:0x3
L_prog_28:
    ds_read_b128 v[16:19], v5 offset:32
    s_waitcnt lgkmcnt(0)
    v_min3_u32 v16, v16, v17, v18
    v_min_u32 v16, v16, v19
    v_cmp_gt_u32 vcc, 4, v16
    s_cbranch_vccnz L_retry_29
    s_setprio 2
    buffer_store_dwordx4 v[244:247], v0, s[48:51], s78 offen sc1
    buffer_store_dwordx4 v[224:227], v0, s[48:51], s74 offen sc1
    buffer_store_dwordx4 v[228:231], v0, s[48:51], s75 offen sc1
    s_setprio 0
L_prog_30:
    ds_read_b128 v[16:19], v5 offset:32
    s_waitcnt lgkmcnt(0)
    v_min3_u32 v16, v16, v17, v18
    v_min_u32 v16, v16, v19
    v_cmp_gt_u32 vcc, 5, v16
    s_cbranch_vccnz L_retry_31
    s_setprio 2
    ds_read_b128 v[16:19], v7 offset:50176
    ds_read_b128 v[20:23], v8 offset:50176
    ds_read_b128 v[24:27], v9 offset:50176
    ds_read_b128 v[28:31], v10 offset:50176
    ds_read_b128 v[32:35], v40 offset:50176
    ds_read_b128 v[36:39], v41 offset:50176
    ds_read_b128 v[44:47], v42 offset:50176
    ds_read_b128 v[252:255], v43 offset:50176
    s_waitcnt lgkmcnt(7)
    v_mfma_f32_16x16x32_bf16 v[104:107], v[56:59], v[16:19], v[104:107]
    v_mfma_f32_16x16x32_bf16 v[108:111], v[60:63], v[16:19], v[108:111]
    v_mfma_f32_16x16x32_bf16 v[96:99], v[48:51], v[16:19], v[96:99]
    v_mfma_f32_16x16x32_bf16 v[100:103], v[52:55], v[16:19], v[100:103]
    s_waitcnt lgkmcnt(6)
    v_mfma_f32_16x16x32_bf16 v[104:107], v[72:75], v[20:23], v[104:107]
    v_mfma_f32_16x16x32_bf16 v[108:111], v[76:79], v[20:23], v[108:111]
    v_mfma_f32_16x16x32_bf16 v[96:99], v[64:67], v[20:23], v[96:99]
    v_mfma_f32_16x16x32_bf16 v[100:103], v[68:71], v[20:23], v[100:103]
    s_waitcnt lgkmcnt(5)
    v_mfma_f32_16x16x32_bf16 v[104:107], v[136:139], v[24:27], v[104:107]
    v_mfma_f32_16x16x32_bf16 v[108:111], v[140:143], v[24:27], v[108:111]
    v_mfma_f32_16x16x32_bf16 v[96:99], v[128:131], v[24:27], v[96:99]
    v_mfma_f32_16x16x32_bf16 v[100:103], v[132:135], v[24:27], v[100:103]
    s_waitcnt lgkmcnt(4)
    v_mfma_f32_16x16x32_bf16 v[104:107], v[152:155], v[28:31], v[104:107]
    v_mfma_f32_16x16x32_bf16 v[108:111], v[156:159], v[28:31], v[108:111]
    v_mfma_f32_16x16x32_bf16 v[96:99], v[144:147], v[28:31], v[96:99]
    v_mfma_f32_16x16x32_bf16 v[100:103], v[148:151], v[28:31], v[100:103]
    s_waitcnt lgkmcnt(3)
    v_mfma_f32_16x16x32_bf16 v[104:107], v[168:171], v[32:35], v[104:107]
    v_mfma_f32_16x16x32_bf16 v[108:111], v[172:175], v[32:35], v[108:111]
    v_mfma_f32_16x16x32_bf16 v[96:99], v[160:163], v[32:35], v[96:99]
    v_mfma_f32_16x16x32_bf16 v[100:103], v[164:167], v[32:35], v[100:103]
    s_waitcnt lgkmcnt(2)
    v_mfma_f32_16x16x32_bf16 v[104:107], v[184:187], v[36:39], v[104:107]
    v_mfma_f32_16x16x32_bf16 v[108:111], v[188:191], v[36:39], v[108:111]
    v_mfma_f32_16x16x32_bf16 v[96:99], v[176:179], v[36:39], v[96:99]
    v_mfma_f32_16x16x32_bf16 v[100:103], v[180:183], v[36:39], v[100:103]
    s_waitcnt lgkmcnt(1)
    v_mfma_f32_16x16x32_bf16 v[104:107], v[200:203], v[44:47], v[104:107]
    v_mfma_f32_16x16x32_bf16 v[108:111], v[204:207], v[44:47], v[108:111]
    v_mfma_f32_16x16x32_bf16 v[96:99], v[192:195], v[44:47], v[96:99]
    v_mfma_f32_16x16x32_bf16 v[100:103], v[196:199], v[44:47], v[100:103]
    s_waitcnt lgkmcnt(0)
    v_mfma_f32_16x16x32_bf16 v[104:107], v[216:219], v[252:255], v[104:107]
    v_mfma_f32_16x16x32_bf16 v[108:111], v[220:223], v[252:255], v[108:111]
    v_mfma_f32_16x16x32_bf16 v[96:99], v[208:211], v[252:255], v[96:99]
    v_mfma_f32_16x16x32_bf16 v[100:103], v[212:215], v[252:255], v[100:103]
    s_nop 4
    v_cvt_pk_bf16_f32 v236, v104, v105
    v_cvt_pk_bf16_f32 v237, v106, v107
    v_cvt_pk_bf16_f32 v238, v108, v109
    v_cvt_pk_bf16_f32 v239, v110, v111
    v_cvt_pk_bf16_f32 v232, v96, v97
    v_cvt_pk_bf16_f32 v233, v98, v99
    v_cvt_pk_bf16_f32 v234, v100, v101
    v_cvt_pk_bf16_f32 v235, v102, v103
    v_cvt_pk_bf16_f32 v240, v96, v97
    v_cvt_pk_bf16_f32 v241, v98, v99
    v_cvt_pk_bf16_f32 v242, v100, v101
    v_cvt_pk_bf16_f32 v243, v102, v103
    v_mov_b32_dpp v232, v236 row_ror:8 row_mask:0xf bank_mask:0xc
    v_mov_b32_dpp v233, v237 row_ror:8 row_mask:0xf bank_mask:0xc
    v_mov_b32_dpp v234, v238 row_ror:8 row_mask:0xf bank_mask:0xc
    v_mov_b32_dpp v235, v239 row_ror:8 row_mask:0xf bank_mask:0xc
    buffer_store_dwordx4 v[232:235], v0, s[48:51], s76 offen sc1
    v_mov_b32_dpp v236, v240 row_ror:8 row_mask:0xf bank_mask:0x3
    v_mov_b32_dpp v237, v241 row_ror:8 row_mask:0xf bank_mask:0x3
    v_mov_b32_dpp v238, v242 row_ror:8 row_mask:0xf bank_mask:0x3
    v_mov_b32_dpp v239, v243 row_ror:8 row_mask:0xf bank_mask:0x3
    buffer_store_dwordx4 v[236:239], v0, s[48:51], s77 offen sc1
    s_or_b32 s64, s2, s3
    s_cbranch_scc1 L_noepoch_32
    v_mov_b32 v1, s30
    s_mov_b64 exec, 1
    buffer_store_dword v1, v5, s[44:47], 0 offen
L_noepoch_32:
    s_endpgm
L_retry_18:
    s_sub_u32 s100, s100, 1
    s_cbranch_scc1 L_end
    s_sleep 1
    s_branch L_spin_17
L_mre_19:
    s_sub_u32 s100, s100, 1
    s_cbranch_scc1 L_end
    s_sleep 2
    buffer_load_dword v1, v0, s[44:47], s74 offen sc1
    s_waitcnt vmcnt(0)
    s_branch L_mchk_16
L_retry_21:
    s_sub_u32 s100, s100, 1
    s_cbranch_scc1 L_end
    s_sleep 1
    s_branch L_spin_20
L_retry_23:
    s_sub_u32 s100, s100, 1
    s_cbranch_scc1 L_end
    s_sleep 1
    s_branch L_prog_22
L_retry_25:
    s_sub_u32 s100, s100, 1
    s_cbranch_scc1 L_end
    s_sleep 1
    s_branch L_prog_24
L_retry_27:
    s_sub_u32 s100, s100, 1
    s_cbranch_scc1 L_end
    s_sleep 1
    s_branch L_prog_26
L_retry_29:
    s_sub_u32 s100, s100, 1
    s_cbranch_scc1 L_end
    s_sleep 1
    s_branch L_prog_28
L_retry_31:
    s_sub_u32 s100, s100, 1
    s_cbranch_scc1 L_end
    s_branch L_prog_30
L_end:
    s_endpgm
.section .rodata,"a"
.p2align 6
.amdhsa_kernel standalone__hybrid_graph_tf_exphormer__graph_kernel
  .amdhsa_next_free_vgpr 256
  .amdhsa_next_free_sgpr 102
  .amdhsa_accum_offset 256
  .amdhsa_group_segment_fixed_size 0
  .amdhsa_kernarg_size 104
  .amdhsa_user_sgpr_count 2
  .amdhsa_user_sgpr_kernarg_segment_ptr 1
  .amdhsa_system_sgpr_workgroup_id_x 1
  .amdhsa_float_denorm_mode_32 3
.end_amdhsa_kernel
```

```asm
; @launch grid=(253,1,1) block=(512,1,1) lds=161792
.amdgcn_target "amdgcn-amd-amdhsa--gfx950"
.text
.globl standalone__hybrid_graph_tf_exphormer__graph_kernel
.p2align 8
.type standalone__hybrid_graph_tf_exphormer__graph_kernel,@function
standalone__hybrid_graph_tf_exphormer__graph_kernel:
L_begin:
    s_cmp_ge_u32 s2, 253
    s_cbranch_scc1 L_end
    s_load_dwordx16 s[4:19], s[0:1], 0
    s_load_dwordx8 s[20:27], s[0:1], 64
    s_load_dwordx2 s[28:29], s[0:1], 96
    s_cmp_ge_u32 s2, 16
    s_cbranch_scc1 L_nopf
    s_getpc_b64 s[32:33]
L_pc:
    v_lshlrev_b32 v1, 6, v0
    v_min_u32 v1, L_end-L_pc, v1
    global_load_dword v255, v1, s[32:33]
L_nopf:
    v_lshrrev_b32 v1, 6, v0
    v_lshlrev_b32 v8, 4, v0
    v_mov_b32 v12, 1966080
    v_readfirstlane_b32 s3, v1
    v_mov_b32 v13, 1966080
    v_mov_b32 v14, 1966080
    v_mov_b32 v15, 1966080
    ds_write_b128 v8, v[12:15] offset:41984
    ds_write_b128 v8, v[12:15] offset:50176
    v_subrev_u32 v9, 32, v0
    v_cmp_gt_u32 vcc, 20, v9
    v_mul_u32_u24 v9, 264, v9
    v_add_u32 v9, 148480, v9
    v_lshlrev_b32 v10, 2, v0
    v_cndmask_b32 v9, 0, v9, vcc
    v_min_u32 v11, 1020, v10
    ds_write_b32 v11, v9
    v_mov_b32 v16, 1310740000
    v_mov_b32 v17, 1310740000
    v_mov_b32 v18, 1310740000
    v_mov_b32 v19, 1310740000
    v_add_u32 v9, 148480, v8
    ds_write_b128 v9, v[16:19]
    v_and_b32 v2, 63, v0
    v_and_b32 v3, 15, v0
    v_bfe_u32 v4, v0, 4, 2
    v_mov_b32 v5, 0
    v_mov_b32 v6, 1
    s_mov_b32 s100, 67108864
    s_and_b32 s64, s2, 7
    s_lshl_b32 s64, s64, 1
    s_bfe_u32 s65, s2, 0x10003
    s_or_b32 s64, s64, s65
    s_and_b32 s65, s2, 0xf0
    s_or_b32 s64, s64, s65
    s_cmp_lt_u32 s2, 240
    s_cselect_b32 s1, s64, s2
    s_and_b32 s31, s3, 3
    s_cmp_lt_u32 s3, 4
    s_cbranch_scc1 L_gemm
    s_setprio 3
    v_and_b32 v8, 0xfff, v8
    v_and_b32 v9, 0x3ff, v10
    s_lshr_b32 s66, s2, 4
    s_lshl_b32 s66, s66, 3
    s_and_b32 s67, s2, 7
    s_or_b32 s68, s66, s67
    s_mul_i32 s64, s68, 5120
    v_add_u32 v40, s64, v8
    s_add_u32 s64, s64, 4096
    v_add_u32 v41, s64, v9
    v_lshrrev_b32 v42, 2, v3
    v_and_b32 v43, 3, v3
    v_lshl_add_u32 v46, v42, 3, v43
    v_lshl_add_u32 v42, v42, 4, v43
    s_lshl_b32 s64, s31, 1
    v_mov_b32 v43, s64
    v_lshlrev_b32 v44, 1, v43
    v_cmp_gt_u32 vcc, 8, v3
    s_mul_i32 s65, s1, 640
    v_lshlrev_b32 v7, 4, v3
    v_cndmask_b32 v43, v43, v44, vcc
    v_add_lshl_u32 v42, v42, v43, 4
    v_lshl_add_u32 v42, v4, 2, v42
    v_add_u32 v42, s65, v42
    v_min_u32 v42, 159996, v42
    s_bitcmp1_b32 s2, 3
    s_cbranch_scc0 L_mrole_1
    s_waitcnt lgkmcnt(0)
    global_load_dword v0, v42, s[10:11]
    global_load_dwordx4 v[48:51], v40, s[8:9]
    global_load_dword v52, v41, s[8:9]
    global_load_dwordx4 v[56:59], v40, s[6:7]
    global_load_dword v60, v41, s[6:7]
L_roled_2:
    s_mov_b32 s27, s68
    s_mov_b32 s26, 0
    s_cmp_lg_u32 s31, 0
    s_cbranch_scc1 L_roled_2_b
    s_load_dword s30, s[28:29], 0
L_roled_2_b:
    s_barrier
    s_mov_b32 s32, s4
    s_and_b32 s33, s5, 0xffff
    s_mov_b32 s34, 5120000
    s_mov_b32 s35, 0x20000
    s_mov_b32 s36, s14
    s_and_b32 s37, s15, 0xffff
    s_mov_b32 s38, 20000
    s_mov_b32 s39, 0x20000
    s_add_u32 s40, s28, 1048576
    s_addc_u32 s41, s29, 0
    s_and_b32 s41, s41, 0xffff
    s_mov_b32 s42, 2048000
    s_mov_b32 s43, 0x20000
    v_and_b32 v40, 8, v3
    v_lshlrev_b32 v40, 1, v40
    v_mov_b32 v41, 0xffff
    v_lshlrev_b32 v40, v40, v41
    s_mov_b32 s64, 0x0f0f0f0f
    s_mov_b32 s65, 0x0f0f0f0f
    v_cndmask_b32 v12, 0, v40, s[64:65]
    v_xor_b32 v13, v40, v12
    v_and_b32 v14, 3, v3
    v_mul_u32_u24 v14, 0x5555, v14
    s_cmp_lg_u32 s31, 0
    s_cbranch_scc1 L_tagged_3
    s_waitcnt lgkmcnt(0)
    s_mul_i32 s30, s30, 0x9E3779B1
    s_add_u32 s30, s30, 0x7F4A7C15
    v_mov_b32 v40, 1
    v_mov_b32 v41, s30
    ds_write_b64 v5, v[40:41] offset:8
L_tagged_3:
    s_bitcmp1_b32 s2, 3
    s_cbranch_scc0 L_mwork_4
    v_mov_b32 v43, 4
    v_mov_b32 v44, 2031616
    s_mov_b32 s64, 0x3f0001
    v_lshrrev_b32 v40, 7, v8
    v_and_b32 v41, 0x70, v8
    v_lshl_add_u32 v40, v40, 14, v41
    s_lshl_b32 s65, s27, 7
    s_waitcnt vmcnt(2)
    v_mul_u32_u24 v64, 52429, v48
    v_lshrrev_b32 v72, 22, v64
    v_lshlrev_b32 v80, 2, v72
    ds_add_rtn_u32 v80, v80, v43 offset:512
    v_mul_u32_u24 v65, 52429, v49
    v_lshrrev_b32 v73, 22, v65
    v_lshlrev_b32 v81, 2, v73
    ds_add_rtn_u32 v81, v81, v43 offset:512
    v_mul_u32_u24 v66, 52429, v50
    v_lshrrev_b32 v74, 22, v66
    v_lshlrev_b32 v82, 2, v74
    ds_add_rtn_u32 v82, v82, v43 offset:512
    v_mul_u32_u24 v67, 52429, v51
    v_lshrrev_b32 v75, 22, v67
    v_lshlrev_b32 v83, 2, v75
    ds_add_rtn_u32 v83, v83, v43 offset:512
    v_mul_u32_u24 v68, 52429, v52
    v_lshrrev_b32 v76, 22, v68
    v_lshlrev_b32 v84, 2, v76
    ds_add_rtn_u32 v84, v84, v43 offset:512
    v_lshrrev_b32 v64, 21, v64
    v_mad_u32_u24 v64, v64, 24, v48
    v_mul_u32_u24 v64, 0x8001, v64
    v_and_b32 v88, 7, v72
    v_lshl_or_b32 v72, v72, 3, v88
    v_lshlrev_b32 v72, 4, v72
    v_lshrrev_b32 v65, 21, v65
    v_mad_u32_u24 v65, v65, 24, v49
    v_mul_u32_u24 v65, 0x8001, v65
    v_and_b32 v89, 7, v73
    v_lshl_or_b32 v73, v73, 3, v89
    v_lshlrev_b32 v73, 4, v73
    v_lshrrev_b32 v66, 21, v66
    v_mad_u32_u24 v66, v66, 24, v50
    v_mul_u32_u24 v66, 0x8001, v66
    v_and_b32 v90, 7, v74
    v_lshl_or_b32 v74, v74, 3, v90
    v_lshlrev_b32 v74, 4, v74
    v_lshrrev_b32 v67, 21, v67
    v_mad_u32_u24 v67, v67, 24, v51
    v_mul_u32_u24 v67, 0x8001, v67
    v_and_b32 v91, 7, v75
    v_lshl_or_b32 v75, v75, 3, v91
    v_lshlrev_b32 v75, 4, v75
    v_lshrrev_b32 v68, 21, v68
    v_mad_u32_u24 v68, v68, 24, v52
    v_mul_u32_u24 v68, 0x8001, v68
    v_and_b32 v92, 7, v76
    v_lshl_or_b32 v76, v76, 3, v92
    v_lshlrev_b32 v76, 4, v76
    s_waitcnt vmcnt(0)
    v_lshlrev_b32 v56, 1, v56
    v_and_or_b32 v64, v64, s64, v56
    v_lshlrev_b32 v57, 1, v57
    v_and_or_b32 v65, v65, s64, v57
    v_lshlrev_b32 v58, 1, v58
    v_and_or_b32 v66, v66, s64, v58
    v_lshlrev_b32 v59, 1, v59
    v_and_or_b32 v67, v67, s64, v59
    v_lshlrev_b32 v60, 1, v60
    v_and_or_b32 v68, v68, s64, v60
    s_waitcnt lgkmcnt(0)
    v_cmp_gt_u32 vcc, 124, v80
    v_min_u32 v80, 124, v80
    v_xor_b32 v80, v80, v72
    v_cndmask_b32 v64, v44, v64, vcc
    ds_write_b32 v80, v64 offset:41984
    v_cmp_gt_u32 vcc, 124, v81
    v_min_u32 v81, 124, v81
    v_xor_b32 v81, v81, v73
    v_cndmask_b32 v65, v44, v65, vcc
    ds_write_b32 v81, v65 offset:41984
    v_cmp_gt_u32 vcc, 124, v82
    v_min_u32 v82, 124, v82
    v_xor_b32 v82, v82, v74
    v_cndmask_b32 v66, v44, v66, vcc
    ds_write_b32 v82, v66 offset:41984
    v_cmp_gt_u32 vcc, 124, v83
    v_min_u32 v83, 124, v83
    v_xor_b32 v83, v83, v75
    v_cndmask_b32 v67, v44, v67, vcc
    ds_write_b32 v83, v67 offset:41984
    v_cmp_gt_u32 vcc, 124, v84
    v_min_u32 v84, 124, v84
    v_xor_b32 v84, v84, v76
    v_cndmask_b32 v68, v44, v68, vcc
    ds_write_b32 v84, v68 offset:41984
    s_waitcnt lgkmcnt(0)
    s_mov_b64 exec, 1
    ds_add_u32 v5, v6 offset:0
    s_mov_b64 exec, -1
L_spin_6:
    ds_read_b128 v[44:47], v5
    s_waitcnt lgkmcnt(0)
    v_readfirstlane_b32 s101, v44
    v_readfirstlane_b32 s30, v47
    s_cmp_ge_u32 s101, 4
    s_cbranch_scc0 L_retry_7
    ds_read_b128 v[48:51], v8 offset:41984
    ds_read_b128 v[52:55], v8 offset:46080
    ds_read_b128 v[56:59], v8 offset:50176
    ds_read_b128 v[60:63], v8 offset:54272
    s_and_b32 s44, s30, 0xffc00000
    s_lshl_b32 s45, s30, 10
    s_and_b32 s45, s45, 0xffc00000
    s_lshl_b32 s46, s30, 20
    s_and_b32 s46, s46, 0xffc00000
    s_lshl_b32 s47, s30, 22
    s_waitcnt lgkmcnt(3)
    v_or_b32 v48, s44, v48
    v_or_b32 v49, s45, v49
    v_or_b32 v50, s46, v50
    v_or_b32 v51, s47, v51
    buffer_store_dwordx4 v[48:51], v40, s[40:43], s65 offen sc1
    s_add_u32 s65, s65, 0x80000
    s_waitcnt lgkmcnt(2)
    v_or_b32 v52, s44, v52
    v_or_b32 v53, s45, v53
    v_or_b32 v54, s46, v54
    v_or_b32 v55, s47, v55
    buffer_store_dwordx4 v[52:55], v40, s[40:43], s65 offen sc1
    s_add_u32 s65, s65, 0x80000
    s_waitcnt lgkmcnt(1)
    v_or_b32 v56, s44, v56
    v_or_b32 v57, s45, v57
    v_or_b32 v58, s46, v58
    v_or_b32 v59, s47, v59
    buffer_store_dwordx4 v[56:59], v40, s[40:43], s65 offen sc1
    s_add_u32 s65, s65, 0x80000
    s_waitcnt lgkmcnt(0)
    v_or_b32 v60, s44, v60
    v_or_b32 v61, s45, v61
    v_or_b32 v62, s46, v62
    v_or_b32 v63, s47, v63
    buffer_store_dwordx4 v[60:63], v40, s[40:43], s65 offen sc1
    s_cmp_ge_u32 s2, 250
    s_cbranch_scc1 L_end
    s_waitcnt vmcnt(4)
L_worked_5:
    v_lshlrev_b32 v0, 9, v0
    s_setprio 1
    s_lshl_b32 s64, s31, 10
    s_lshr_b32 s10, s1, 1
    s_lshl_b32 s10, s10, 14
    s_add_u32 s11, s10, 4096
    s_add_u32 s12, s10, 8192
    s_add_u32 s13, s10, 12288
    v_cmp_gt_u32 vcc, 0xe80, v8
    s_mov_b64 s[14:15], vcc
    v_add_u32_dpp v9, v0, v7 row_newbcast:0 row_mask:0xf bank_mask:0xf
    buffer_load_dwordx4 v[176:179], v9, s[32:35], 0 offen offset:0
    buffer_load_dwordx4 v[180:183], v9, s[32:35], 0 offen offset:256
    v_add_u32_dpp v9, v0, v7 row_newbcast:1 row_mask:0xf bank_mask:0xf
    buffer_load_dwordx4 v[184:187], v9, s[32:35], 0 offen offset:0
    buffer_load_dwordx4 v[188:191], v9, s[32:35], 0 offen offset:256
    s_cmp_eq_u32 s26, 0
    s_cbranch_scc1 L_flagged_8
    s_waitcnt vmcnt(4)
    s_mov_b64 exec, 65535
    global_store_dword v41, v42, s[28:29] sc1
    s_mov_b64 exec, -1
L_flagged_8:
    s_add_u32 m0, s64, 62464
    s_mov_b32 s65, 0
    buffer_load_dwordx4 v8, s[36:39], s65 offen lds
    v_add_u32_dpp v9, v0, v7 row_newbcast:2 row_mask:0xf bank_mask:0xf
    s_waitcnt vmcnt(2)
    buffer_load_dwordx4 v[192:195], v9, s[32:35], 0 offen offset:0
    buffer_load_dwordx4 v[196:199], v9, s[32:35], 0 offen offset:256
    s_add_u32 m0, s64, 66560
    s_mov_b32 s65, 4096
    buffer_load_dwordx4 v8, s[36:39], s65 offen lds
    v_add_u32_dpp v9, v0, v7 row_newbcast:3 row_mask:0xf bank_mask:0xf
    s_waitcnt vmcnt(2)
    buffer_load_dwordx4 v[200:203], v9, s[32:35], 0 offen offset:0
    buffer_load_dwordx4 v[204:207], v9, s[32:35], 0 offen offset:256
    v_add_u32_dpp v9, v0, v7 row_newbcast:4 row_mask:0xf bank_mask:0xf
    s_waitcnt vmcnt(2)
    buffer_load_dwordx4 v[208:211], v9, s[32:35], 0 offen offset:0
    buffer_load_dwordx4 v[212:215], v9, s[32:35], 0 offen offset:256
    s_add_u32 m0, s64, 70656
    s_mov_b32 s65, 8192
    buffer_load_dwordx4 v8, s[36:39], s65 offen lds
    v_add_u32_dpp v9, v0, v7 row_newbcast:5 row_mask:0xf bank_mask:0xf
    s_waitcnt vmcnt(2)
    buffer_load_dwordx4 v[216:219], v9, s[32:35], 0 offen offset:0
    buffer_load_dwordx4 v[220:223], v9, s[32:35], 0 offen offset:256
    s_add_u32 m0, s64, 74752
    s_mov_b32 s65, 12288
    buffer_load_dwordx4 v8, s[36:39], s65 offen lds
    v_add_u32_dpp v9, v0, v7 row_newbcast:6 row_mask:0xf bank_mask:0xf
    s_waitcnt vmcnt(2)
    buffer_load_dwordx4 v[224:227], v9, s[32:35], 0 offen offset:0
    buffer_load_dwordx4 v[228:231], v9, s[32:35], 0 offen offset:256
    s_add_u32 m0, s64, 78848
    s_mov_b32 s65, 16384
    buffer_load_dwordx4 v8, s[36:39], s65 offen lds
L_ipoll_9:
    buffer_load_dwordx4 v[48:51], v8, s[40:43], s10 offen sc1
    buffer_load_dwordx4 v[52:55], v8, s[40:43], s11 offen sc1
    buffer_load_dwordx4 v[56:59], v8, s[40:43], s12 offen sc1
    s_mov_b64 exec, s[14:15]
    buffer_load_dwordx4 v[60:63], v8, s[40:43], s13 offen sc1
    s_mov_b64 exec, -1
L_spin_10:
    ds_read_b128 v[44:47], v5
    s_waitcnt lgkmcnt(0)
    v_readfirstlane_b32 s101, v46
    v_readfirstlane_b32 s30, v47
    s_cmp_ge_u32 s101, 1
    s_cbranch_scc0 L_retry_11
    s_and_b32 s44, s30, 0xffc00000
    s_lshl_b32 s45, s30, 10
    s_and_b32 s45, s45, 0xffc00000
    s_lshl_b32 s46, s30, 20
    s_and_b32 s46, s46, 0xffc00000
    s_lshl_b32 s47, s30, 22
    s_and_b32 s64, s1, 1
    s_lshl_b32 s64, s64, 21
    s_or_b32 s44, s44, s64
    v_mov_b32 v76, 1966080
    s_or_b32 s45, s45, s64
    v_mov_b32 v77, 1966080
    s_or_b32 s46, s46, s64
    v_mov_b32 v78, 1966080
    s_or_b32 s47, s47, s64
    v_mov_b32 v79, 1966080
    s_mov_b32 s16, 1310720
    v_mov_b32 v42, 2
    s_waitcnt vmcnt(3)
    v_xor_b32 v64, s44, v48
    v_xor_b32 v65, s45, v49
    v_xor_b32 v66, s46, v50
    v_xor_b32 v67, s47, v51
    v_or3_b32 v40, v64, v65, v66
    v_or_b32 v40, v40, v67
    v_cmp_gt_u32 s[48:49], s16, v64
    v_lshlrev_b32_sdwa v80, 2, v64 dst_sel:DWORD dst_unused:UNUSED_PAD src0_sel:DWORD src1_sel:WORD_1
    v_cmp_gt_u32 s[50:51], s16, v65
    v_lshlrev_b32_sdwa v81, 2, v65 dst_sel:DWORD dst_unused:UNUSED_PAD src0_sel:DWORD src1_sel:WORD_1
    v_cmp_gt_u32 s[52:53], s16, v66
    v_lshlrev_b32_sdwa v82, 2, v66 dst_sel:DWORD dst_unused:UNUSED_PAD src0_sel:DWORD src1_sel:WORD_1
    v_cmp_gt_u32 s[54:55], s16, v67
    v_lshlrev_b32_sdwa v83, 2, v67 dst_sel:DWORD dst_unused:UNUSED_PAD src0_sel:DWORD src1_sel:WORD_1
    s_waitcnt vmcnt(2)
    v_xor_b32 v68, s44, v52
    v_xor_b32 v69, s45, v53
    v_xor_b32 v70, s46, v54
    v_xor_b32 v71, s47, v55
    v_or3_b32 v40, v40, v68, v69
    v_or3_b32 v40, v40, v70, v71
    v_cmp_gt_u32 s[56:57], s16, v68
    v_lshlrev_b32_sdwa v84, 2, v68 dst_sel:DWORD dst_unused:UNUSED_PAD src0_sel:DWORD src1_sel:WORD_1
    v_cmp_gt_u32 s[58:59], s16, v69
    v_lshlrev_b32_sdwa v85, 2, v69 dst_sel:DWORD dst_unused:UNUSED_PAD src0_sel:DWORD src1_sel:WORD_1
    v_cmp_gt_u32 s[60:61], s16, v70
    v_lshlrev_b32_sdwa v86, 2, v70 dst_sel:DWORD dst_unused:UNUSED_PAD src0_sel:DWORD src1_sel:WORD_1
    v_cmp_gt_u32 s[62:63], s16, v71
    v_lshlrev_b32_sdwa v87, 2, v71 dst_sel:DWORD dst_unused:UNUSED_PAD src0_sel:DWORD src1_sel:WORD_1
    s_waitcnt vmcnt(1)
    v_xor_b32 v72, s44, v56
    v_xor_b32 v73, s45, v57
    v_xor_b32 v74, s46, v58
    v_xor_b32 v75, s47, v59
    v_or3_b32 v40, v40, v72, v73
    v_or3_b32 v40, v40, v74, v75
    v_cmp_gt_u32 s[64:65], s16, v72
    v_lshlrev_b32_sdwa v88, 2, v72 dst_sel:DWORD dst_unused:UNUSED_PAD src0_sel:DWORD src1_sel:WORD_1
    v_cmp_gt_u32 s[66:67], s16, v73
    v_lshlrev_b32_sdwa v89, 2, v73 dst_sel:DWORD dst_unused:UNUSED_PAD src0_sel:DWORD src1_sel:WORD_1
    v_cmp_gt_u32 s[68:69], s16, v74
    v_lshlrev_b32_sdwa v90, 2, v74 dst_sel:DWORD dst_unused:UNUSED_PAD src0_sel:DWORD src1_sel:WORD_1
    v_cmp_gt_u32 s[70:71], s16, v75
    v_lshlrev_b32_sdwa v91, 2, v75 dst_sel:DWORD dst_unused:UNUSED_PAD src0_sel:DWORD src1_sel:WORD_1
    s_waitcnt vmcnt(0)
    s_mov_b64 exec, s[14:15]
    v_xor_b32 v76, s44, v60
    v_xor_b32 v77, s45, v61
    v_xor_b32 v78, s46, v62
    v_xor_b32 v79, s47, v63
    s_mov_b64 exec, -1
    v_or3_b32 v40, v40, v76, v77
    v_or3_b32 v40, v40, v78, v79
    v_cmp_gt_u32 s[72:73], s16, v76
    v_lshlrev_b32_sdwa v92, 2, v76 dst_sel:DWORD dst_unused:UNUSED_PAD src0_sel:DWORD src1_sel:WORD_1
    v_cmp_gt_u32 s[74:75], s16, v77
    v_lshlrev_b32_sdwa v93, 2, v77 dst_sel:DWORD dst_unused:UNUSED_PAD src0_sel:DWORD src1_sel:WORD_1
    v_cmp_gt_u32 s[76:77], s16, v78
    v_lshlrev_b32_sdwa v94, 2, v78 dst_sel:DWORD dst_unused:UNUSED_PAD src0_sel:DWORD src1_sel:WORD_1
    v_cmp_gt_u32 s[78:79], s16, v79
    v_lshlrev_b32_sdwa v95, 2, v79 dst_sel:DWORD dst_unused:UNUSED_PAD src0_sel:DWORD src1_sel:WORD_1
    v_cmp_le_u32 vcc, 0x400000, v40
    s_cbranch_vccnz L_retry_12
    s_mov_b64 exec, s[48:49]
    ds_add_rtn_u32 v80, v80, v42 offset:128
    s_mov_b64 exec, s[50:51]
    ds_add_rtn_u32 v81, v81, v42 offset:128
    s_mov_b64 exec, s[52:53]
    ds_add_rtn_u32 v82, v82, v42 offset:128
    s_mov_b64 exec, s[54:55]
    ds_add_rtn_u32 v83, v83, v42 offset:128
    s_mov_b64 exec, s[56:57]
    ds_add_rtn_u32 v84, v84, v42 offset:128
    s_mov_b64 exec, s[58:59]
    ds_add_rtn_u32 v85, v85, v42 offset:128
    s_mov_b64 exec, s[60:61]
    ds_add_rtn_u32 v86, v86, v42 offset:128
    s_mov_b64 exec, s[62:63]
    ds_add_rtn_u32 v87, v87, v42 offset:128
    s_mov_b64 exec, s[64:65]
    ds_add_rtn_u32 v88, v88, v42 offset:128
    s_mov_b64 exec, s[66:67]
    ds_add_rtn_u32 v89, v89, v42 offset:128
    s_mov_b64 exec, s[68:69]
    ds_add_rtn_u32 v90, v90, v42 offset:128
    s_mov_b64 exec, s[70:71]
    ds_add_rtn_u32 v91, v91, v42 offset:128
    s_mov_b64 exec, s[72:73]
    ds_add_rtn_u32 v92, v92, v42 offset:128
    s_mov_b64 exec, s[74:75]
    ds_add_rtn_u32 v93, v93, v42 offset:128
    s_mov_b64 exec, s[76:77]
    ds_add_rtn_u32 v94, v94, v42 offset:128
    s_mov_b64 exec, s[78:79]
    ds_add_rtn_u32 v95, v95, v42 offset:128
    s_mov_b64 exec, -1
    v_add_u32_dpp v9, v0, v7 row_newbcast:7 row_mask:0xf bank_mask:0xf
    buffer_load_dwordx4 v[232:235], v9, s[32:35], 0 offen offset:0
    buffer_load_dwordx4 v[236:239], v9, s[32:35], 0 offen offset:256
    v_add_u32_dpp v9, v0, v7 row_newbcast:8 row_mask:0xf bank_mask:0xf
    buffer_load_dwordx4 v[240:243], v9, s[32:35], 0 offen offset:0
    buffer_load_dwordx4 v[244:247], v9, s[32:35], 0 offen offset:256
    v_and_b32 v48, 2031616, v67
    v_and_b32 v49, 2031616, v71
    v_and_b32 v50, 2031616, v75
    v_and_b32 v51, 2031616, v79
    v_max3_u32 v48, v48, v49, v50
    v_max_u32 v48, v48, v51
    v_cmp_eq_u32 vcc, 2031616, v48
    s_mov_b64 s[16:17], vcc
    s_waitcnt lgkmcnt(12)
    s_mov_b64 exec, s[48:49]
    ds_write_b16 v80, v64
    s_mov_b64 exec, s[50:51]
    ds_write_b16 v81, v65
    s_mov_b64 exec, s[52:53]
    ds_write_b16 v82, v66
    s_mov_b64 exec, s[54:55]
    ds_write_b16 v83, v67
    s_waitcnt lgkmcnt(12)
    s_mov_b64 exec, s[56:57]
    ds_write_b16 v84, v68
    s_mov_b64 exec, s[58:59]
    ds_write_b16 v85, v69
    s_mov_b64 exec, s[60:61]
    ds_write_b16 v86, v70
    s_mov_b64 exec, s[62:63]
    ds_write_b16 v87, v71
    s_waitcnt lgkmcnt(12)
    s_mov_b64 exec, s[64:65]
    ds_write_b16 v88, v72
    s_mov_b64 exec, s[66:67]
    ds_write_b16 v89, v73
    s_mov_b64 exec, s[68:69]
    ds_write_b16 v90, v74
    s_mov_b64 exec, s[70:71]
    ds_write_b16 v91, v75
    s_waitcnt lgkmcnt(12)
    s_mov_b64 exec, s[72:73]
    ds_write_b16 v92, v76
    s_mov_b64 exec, s[74:75]
    ds_write_b16 v93, v77
    s_mov_b64 exec, s[76:77]
    ds_write_b16 v94, v78
    s_mov_b64 exec, s[78:79]
    ds_write_b16 v95, v79
    s_mov_b64 exec, s[16:17]
    ds_write_b32 v5, v6 offset:20
    s_waitcnt lgkmcnt(0)
    s_mov_b64 exec, 1
    ds_add_u32 v5, v6 offset:16
    s_mov_b64 exec, -1
    v_add_u32_dpp v9, v0, v7 row_newbcast:9 row_mask:0xf bank_mask:0xf
    buffer_load_dwordx4 v[248:251], v9, s[32:35], 0 offen offset:0
    buffer_load_dwordx4 v[252:255], v9, s[32:35], 0 offen offset:256
    s_lshl_b32 s20, s31, 1
    s_add_u32 s21, s20, 1
    s_add_u32 s22, s20, 8
    s_add_u32 s23, s20, 9
    s_add_u32 s24, s31, 16
    v_add_u32 v47, -1, v3
    v_bfe_u32 v40, v47, 1, 1
    v_and_b32 v41, 1, v47
    v_lshl_add_u32 v40, v40, 3, v41
    v_add_u32 v40, s20, v40
    v_mov_b32 v41, s24
    v_cmp_ne_u32 vcc, 0, v3
    v_min_u32 v47, 19, v2
    v_mul_u32_u24 v46, 264, v47
    v_cndmask_b32 v40, v41, v40, vcc
    v_mul_u32_u24 v41, 264, v40
    v_add_u32 v41, 148480, v41
    v_lshlrev_b32 v40, 2, v40
    v_add_u32 v46, 148728, v46
    v_lshlrev_b32 v47, 2, v47
    v_lshlrev_b32 v43, 3, v3
    v_lshl_add_u32 v43, v4, 1, v43
L_spin_13:
    ds_read_b32 v44, v5 offset:16
    s_waitcnt lgkmcnt(0)
    v_readfirstlane_b32 s101, v44
    s_cmp_ge_u32 s101, 4
    s_cbranch_scc0 L_retry_14
    ds_read_b32 v44, v40 offset:128
    ds_read_b32 v47, v47 offset:128
    ds_read_b32 v45, v5 offset:20
    s_waitcnt lgkmcnt(2)
    v_sub_u32 v44, v44, v41
    v_max_u32 v44, 18, v44
    s_waitcnt lgkmcnt(0)
    v_cmp_gt_u32 vcc, v47, v46
    v_add_u32_dpp v48, v44, v44 row_shr:1 row_mask:0xf bank_mask:0xf bound_ctrl:1
    v_readfirstlane_b32 s25, v45
    s_or_b32 s64, vcc_lo, vcc_hi
    v_add_u32_dpp v48, v48, v48 row_shr:2 row_mask:0xf bank_mask:0xf bound_ctrl:1
    s_or_b32 s25, s25, s64
    s_mov_b32 s53, 0
    v_add_u32_dpp v48, v48, v48 row_shr:4 row_mask:0xf bank_mask:0xf bound_ctrl:1
    v_sub_u32 v44, v48, v44
    v_sub_u32 v44, v41, v44
    v_readlane_b32 s10, v48, 0
    v_readlane_b32 s11, v48, 1
    v_readlane_b32 s12, v48, 2
    v_readlane_b32 s13, v48, 3
    v_readlane_b32 s14, v48, 4
    v_add_u32_dpp v160, v44, v43 row_newbcast:0 row_mask:0xf bank_mask:0xf
    v_add_u32_dpp v161, v44, v43 row_newbcast:1 row_mask:0xf bank_mask:0xf
    v_add_u32_dpp v162, v44, v43 row_newbcast:2 row_mask:0xf bank_mask:0xf
    v_add_u32_dpp v163, v44, v43 row_newbcast:3 row_mask:0xf bank_mask:0xf
    v_add_u32_dpp v164, v44, v43 row_newbcast:4 row_mask:0xf bank_mask:0xf
    s_add_u32 s50, s14, 14
    s_lshr_b32 s50, s50, 4
    s_cmp_gt_u32 s50, 32
    s_cselect_b32 s25, 1, s25
    s_max_u32 s50, s50, 12
    v_add_u32 v40, 0, v43
    v_cmp_le_u32 s[64:65], s10, v40
    v_cmp_le_u32 s[66:67], s11, v40
    v_cmp_le_u32 s[68:69], s12, v40
    v_cmp_le_u32 s[70:71], s13, v40
    v_cndmask_b32 v40, v160, v161, s[64:65]
    v_cndmask_b32 v40, v40, v162, s[66:67]
    v_cndmask_b32 v40, v40, v163, s[68:69]
    v_cndmask_b32 v40, v40, v164, s[70:71]
    ds_read_u16 v40, v40 offset:0
    v_add_u32 v41, 128, v43
    v_cmp_le_u32 s[64:65], s10, v41
    v_cmp_le_u32 s[66:67], s11, v41
    v_cmp_le_u32 s[68:69], s12, v41
    v_cmp_le_u32 s[70:71], s13, v41
    v_cndmask_b32 v41, v160, v161, s[64:65]
    v_cndmask_b32 v41, v41, v162, s[66:67]
    v_cndmask_b32 v41, v41, v163, s[68:69]
    v_cndmask_b32 v41, v41, v164, s[70:71]
    ds_read_u16 v41, v41 offset:128
    v_add_u32 v42, 256, v43
    v_cmp_le_u32 s[64:65], s10, v42
    v_cmp_le_u32 s[66:67], s11, v42
    v_cmp_le_u32 s[68:69], s12, v42
    v_cmp_le_u32 s[70:71], s13, v42
    v_cndmask_b32 v42, v160, v161, s[64:65]
    v_cndmask_b32 v42, v42, v162, s[66:67]
    v_cndmask_b32 v42, v42, v163, s[68:69]
    v_cndmask_b32 v42, v42, v164, s[70:71]
    ds_read_u16 v42, v42 offset:256
    v_add_u32 v43, 384, v43
    v_cmp_le_u32 s[64:65], s10, v43
    v_cmp_le_u32 s[66:67], s11, v43
    v_cmp_le_u32 s[68:69], s12, v43
    v_cmp_le_u32 s[70:71], s13, v43
    v_cndmask_b32 v43, v160, v161, s[64:65]
    v_cndmask_b32 v43, v43, v162, s[66:67]
    v_cndmask_b32 v43, v43, v163, s[68:69]
    v_cndmask_b32 v43, v43, v164, s[70:71]
    ds_read_u16 v43, v43 offset:384
    s_waitcnt lgkmcnt(3)
    v_and_b32 v32, 0x7ffe, v40
    ds_read_u16 v33, v32 offset:62464
    v_lshlrev_b32 v32, 8, v32
    v_lshlrev_b32 v40, 4, v40
    s_waitcnt lgkmcnt(3)
    v_and_b32 v34, 0x7ffe, v41
    ds_read_u16 v35, v34 offset:62464
    v_lshlrev_b32 v34, 8, v34
    v_lshlrev_b32 v41, 4, v41
    s_waitcnt lgkmcnt(3)
    v_and_b32 v36, 0x7ffe, v42
    ds_read_u16 v37, v36 offset:62464
    v_lshlrev_b32 v36, 8, v36
    v_lshlrev_b32 v42, 4, v42
    s_waitcnt lgkmcnt(3)
    v_and_b32 v38, 0x7ffe, v43
    ds_read_u16 v39, v38 offset:62464
    v_lshlrev_b32 v38, 8, v38
    v_lshlrev_b32 v43, 4, v43
    v_add_u32_dpp v11, v32, v7 row_newbcast:0 row_mask:0xf bank_mask:0xf
    buffer_load_dwordx4 v[48:51], v11, s[32:35], 0 offen offset:0
    buffer_load_dwordx4 v[56:59], v11, s[32:35], 0 offen offset:256
    v_add_u32_dpp v11, v32, v7 row_newbcast:1 row_mask:0xf bank_mask:0xf
    buffer_load_dwordx4 v[52:55], v11, s[32:35], 0 offen offset:0
    buffer_load_dwordx4 v[60:63], v11, s[32:35], 0 offen offset:256
    v_add_u32_dpp v11, v32, v7 row_newbcast:2 row_mask:0xf bank_mask:0xf
    buffer_load_dwordx4 v[64:67], v11, s[32:35], 0 offen offset:0
    buffer_load_dwordx4 v[72:75], v11, s[32:35], 0 offen offset:256
    v_add_u32_dpp v11, v32, v7 row_newbcast:3 row_mask:0xf bank_mask:0xf
    buffer_load_dwordx4 v[68:71], v11, s[32:35], 0 offen offset:0
    buffer_load_dwordx4 v[76:79], v11, s[32:35], 0 offen offset:256
    v_add_u32_dpp v11, v32, v7 row_newbcast:4 row_mask:0xf bank_mask:0xf
    buffer_load_dwordx4 v[80:83], v11, s[32:35], 0 offen offset:0
    buffer_load_dwordx4 v[88:91], v11, s[32:35], 0 offen offset:256
    v_add_u32_dpp v11, v32, v7 row_newbcast:5 row_mask:0xf bank_mask:0xf
    buffer_load_dwordx4 v[84:87], v11, s[32:35], 0 offen offset:0
    buffer_load_dwordx4 v[92:95], v11, s[32:35], 0 offen offset:256
    s_mov_b32 s57, 0
    s_sub_u32 s64, s14, 18
    s_lshr_b32 s65, s64, 4
    s_bitset1_b32 s53, s65
    s_and_b32 s64, s64, 14
    s_lshl4_add_u32 s57, s57, s64
    s_and_b32 s65, s24, 7
    s_lshl_b32 s65, s65, 5
    s_lshl_b32 s19, s24, 10
    s_or_b32 s19, s19, s65
    s_sub_u32 s64, s13, 18
    s_lshr_b32 s65, s64, 4
    s_bitset1_b32 s53, s65
    s_and_b32 s64, s64, 14
    s_lshl4_add_u32 s57, s57, s64
    s_and_b32 s65, s23, 7
    s_lshl_b32 s65, s65, 5
    s_lshl_b32 s18, s23, 10
    s_or_b32 s18, s18, s65
    s_sub_u32 s64, s12, 18
    s_lshr_b32 s65, s64, 4
    s_bitset1_b32 s53, s65
    s_and_b32 s64, s64, 14
    s_lshl4_add_u32 s57, s57, s64
    s_and_b32 s65, s22, 7
    s_lshl_b32 s65, s65, 5
    s_lshl_b32 s17, s22, 10
    s_or_b32 s17, s17, s65
    s_sub_u32 s64, s11, 18
    s_lshr_b32 s65, s64, 4
    s_bitset1_b32 s53, s65
    s_and_b32 s64, s64, 14
    s_lshl4_add_u32 s57, s57, s64
    s_and_b32 s65, s21, 7
    s_lshl_b32 s65, s65, 5
    s_lshl_b32 s16, s21, 10
    s_or_b32 s16, s16, s65
    s_sub_u32 s64, s10, 18
    s_lshr_b32 s65, s64, 4
    s_bitset1_b32 s53, s65
    s_and_b32 s64, s64, 14
    s_lshl4_add_u32 s57, s57, s64
    s_and_b32 s65, s20, 7
    s_lshl_b32 s65, s65, 5
    s_lshl_b32 s15, s20, 10
    s_or_b32 s15, s15, s65
    s_sub_u32 s64, s50, 5
    s_lshl_b32 s56, 1, s64
    s_or_b32 s52, s56, s53
    v_and_b32 v46, 1, v3
    v_lshl_add_u32 v46, v4, 1, v46
    v_and_b32 v46, 3, v46
    v_and_b32 v47, 14, v3
    v_lshl_add_u32 v46, v46, 4, v47
    v_lshrrev_b32 v47, 1, v4
    v_add_lshl_u32 v46, v46, v47, 2
    v_lshrrev_b32 v44, 1, v4
    v_mul_u32_u24 v44, 528, v44
    v_xor_b32 v44, v44, v7
    v_and_b32 v45, 1, v4
    v_lshl_or_b32 v2, v45, 3, v44
    v_xor_b32 v144, s15, v7
    v_xor_b32 v146, s16, v7
    v_xor_b32 v148, s19, v7
    v_xor_b32 v145, 528, v144
    v_xor_b32 v147, 528, v146
    v_xor_b32 v149, 528, v148
    s_mul_i32 s64, s1, 80
    s_add_u32 s64, s64, 62464
    v_and_b32 v45, 2, v4
    v_add_u32 v0, s64, v45
    s_getpc_b64 s[72:73]
L_anc:
    v_lshlrev_b32 v4, 2, v4
    s_mov_b32 s62, L_fp1-L_anc
    s_mov_b32 s63, L_fp1-L_fp0
    s_mov_b32 s70, L_dr1-L_anc
    s_mov_b32 s71, L_dr1-L_dr0
    s_mov_b32 s26, 0
    v_mov_b32 v1, 0
    s_lshl_b32 s64, s31, 2
    v_mov_b32 v10, s64
    v_and_b32 v9, 8, v3
    v_lshlrev_b32 v9, 1, v9
    s_mov_b32 s66, 0x22222222
    s_mov_b32 s67, 0x22222222
    s_mov_b32 s68, 0x44444444
    s_mov_b32 s69, 0x44444444
    v_mov_b64 v[150:151], 0
    v_mov_b64 v[152:153], 0
    v_mov_b64 v[154:155], 0
    v_mov_b64 v[156:157], 0
    v_mov_b64 v[158:159], 0
    v_mov_b64 v[16:17], 0
    v_mov_b64 v[18:19], 0
    v_mov_b64 v[20:21], 0
    v_mov_b64 v[22:23], 0
    s_waitcnt lgkmcnt(0)
    v_lshlrev_b32 v33, v40, v33
    ds_bpermute_b32 v33, v46, v33
    v_lshlrev_b32 v35, v41, v35
    ds_bpermute_b32 v35, v46, v35
    v_lshlrev_b32 v37, v42, v37
    ds_bpermute_b32 v37, v46, v37
    v_lshlrev_b32 v39, v43, v39
    ds_bpermute_b32 v39, v46, v39
    s_waitcnt vmcnt(12) lgkmcnt(0)
    s_barrier
    ds_read_b128 v[160:163], v144 offset:21504
    ds_read_b128 v[164:167], v144 offset:21760
    ds_read_b128 v[168:171], v145 offset:21504
    ds_read_b128 v[172:175], v145 offset:21760
    s_waitcnt lgkmcnt(2)
    v_dot2c_f32_bf16 v150, v176, v160
    v_dot2c_f32_bf16 v150, v177, v161
    v_dot2c_f32_bf16 v150, v178, v162
    v_dot2c_f32_bf16 v150, v179, v163
    v_dot2c_f32_bf16 v150, v180, v164
    v_dot2c_f32_bf16 v150, v181, v165
    v_dot2c_f32_bf16 v150, v182, v166
    v_dot2c_f32_bf16 v150, v183, v167
    v_add_u32_dpp v11, v32, v7 row_newbcast:6 row_mask:0xf bank_mask:0xf
    buffer_load_dwordx4 v[96:99], v11, s[32:35], 0 offen offset:0
    buffer_load_dwordx4 v[104:107], v11, s[32:35], 0 offen offset:256
    ds_read_b128 v[160:163], v146 offset:21504
    ds_read_b128 v[164:167], v146 offset:21760
    s_waitcnt lgkmcnt(2)
    v_dot2c_f32_bf16 v151, v184, v168
    v_dot2c_f32_bf16 v151, v185, v169
    v_dot2c_f32_bf16 v151, v186, v170
    v_dot2c_f32_bf16 v151, v187, v171
    v_dot2c_f32_bf16 v151, v188, v172
    v_dot2c_f32_bf16 v151, v189, v173
    v_dot2c_f32_bf16 v151, v190, v174
    v_dot2c_f32_bf16 v151, v191, v175
    v_add_u32_dpp v11, v32, v7 row_newbcast:7 row_mask:0xf bank_mask:0xf
    buffer_load_dwordx4 v[100:103], v11, s[32:35], 0 offen offset:0
    buffer_load_dwordx4 v[108:111], v11, s[32:35], 0 offen offset:256
    ds_read_b128 v[168:171], v147 offset:21504
    ds_read_b128 v[172:175], v147 offset:21760
    s_waitcnt lgkmcnt(2)
    v_dot2c_f32_bf16 v152, v192, v160
    v_dot2c_f32_bf16 v152, v193, v161
    v_dot2c_f32_bf16 v152, v194, v162
    v_dot2c_f32_bf16 v152, v195, v163
    v_dot2c_f32_bf16 v152, v196, v164
    v_dot2c_f32_bf16 v152, v197, v165
    v_dot2c_f32_bf16 v152, v198, v166
    v_dot2c_f32_bf16 v152, v199, v167
    v_add_f32_dpp v150, v150, v150 row_ror:8 row_mask:0xf bank_mask:0x3
    v_add_f32_dpp v150, v151, v151 row_ror:8 row_mask:0xf bank_mask:0xc
    v_add_u32_dpp v11, v32, v7 row_newbcast:8 row_mask:0xf bank_mask:0xf
    buffer_load_dwordx4 v[112:115], v11, s[32:35], 0 offen offset:0
    buffer_load_dwordx4 v[120:123], v11, s[32:35], 0 offen offset:256
    ds_read_b128 v[160:163], v144 offset:29696
    ds_read_b128 v[164:167], v144 offset:29952
    s_waitcnt lgkmcnt(2)
    v_dot2c_f32_bf16 v153, v200, v168
    v_dot2c_f32_bf16 v153, v201, v169
    v_dot2c_f32_bf16 v153, v202, v170
    v_dot2c_f32_bf16 v153, v203, v171
    v_dot2c_f32_bf16 v153, v204, v172
    v_dot2c_f32_bf16 v153, v205, v173
    v_dot2c_f32_bf16 v153, v206, v174
    v_dot2c_f32_bf16 v153, v207, v175
    v_add_u32_dpp v11, v32, v7 row_newbcast:9 row_mask:0xf bank_mask:0xf
    buffer_load_dwordx4 v[116:119], v11, s[32:35], 0 offen offset:0
    buffer_load_dwordx4 v[124:127], v11, s[32:35], 0 offen offset:256
    ds_read_b128 v[168:171], v145 offset:29696
    ds_read_b128 v[172:175], v145 offset:29952
    s_waitcnt lgkmcnt(2)
    v_dot2c_f32_bf16 v154, v208, v160
    v_dot2c_f32_bf16 v154, v209, v161
    v_dot2c_f32_bf16 v154, v210, v162
    v_dot2c_f32_bf16 v154, v211, v163
    v_dot2c_f32_bf16 v154, v212, v164
    v_dot2c_f32_bf16 v154, v213, v165
    v_dot2c_f32_bf16 v154, v214, v166
    v_dot2c_f32_bf16 v154, v215, v167
    v_add_f32_dpp v152, v152, v152 row_ror:8 row_mask:0xf bank_mask:0x3
    v_add_f32_dpp v152, v153, v153 row_ror:8 row_mask:0xf bank_mask:0xc
    v_add_u32_dpp v11, v32, v7 row_newbcast:10 row_mask:0xf bank_mask:0xf
    buffer_load_dwordx4 v[128:131], v11, s[32:35], 0 offen offset:0
    buffer_load_dwordx4 v[136:139], v11, s[32:35], 0 offen offset:256
    ds_read_b128 v[160:163], v146 offset:29696
    ds_read_b128 v[164:167], v146 offset:29952
    s_waitcnt lgkmcnt(2)
    v_dot2c_f32_bf16 v155, v216, v168
    v_dot2c_f32_bf16 v155, v217, v169
    v_dot2c_f32_bf16 v155, v218, v170
    v_dot2c_f32_bf16 v155, v219, v171
    v_dot2c_f32_bf16 v155, v220, v172
    v_dot2c_f32_bf16 v155, v221, v173
    v_dot2c_f32_bf16 v155, v222, v174
    v_dot2c_f32_bf16 v155, v223, v175
    v_add_f32_dpp v150, v150, v150 row_half_mirror row_mask:0xf bank_mask:0x5
    v_add_f32_dpp v150, v152, v152 row_half_mirror row_mask:0xf bank_mask:0xa
    v_add_u32_dpp v11, v32, v7 row_newbcast:11 row_mask:0xf bank_mask:0xf
    buffer_load_dwordx4 v[132:135], v11, s[32:35], 0 offen offset:0
    buffer_load_dwordx4 v[140:143], v11, s[32:35], 0 offen offset:256
    ds_read_b128 v[168:171], v147 offset:29696
    ds_read_b128 v[172:175], v147 offset:29952
    s_waitcnt lgkmcnt(2)
    v_dot2c_f32_bf16 v156, v224, v160
    v_dot2c_f32_bf16 v156, v225, v161
    v_dot2c_f32_bf16 v156, v226, v162
    v_dot2c_f32_bf16 v156, v227, v163
    v_dot2c_f32_bf16 v156, v228, v164
    v_dot2c_f32_bf16 v156, v229, v165
    v_dot2c_f32_bf16 v156, v230, v166
    v_dot2c_f32_bf16 v156, v231, v167
    v_add_f32_dpp v154, v154, v154 row_ror:8 row_mask:0xf bank_mask:0x3
    v_add_f32_dpp v154, v155, v155 row_ror:8 row_mask:0xf bank_mask:0xc
    ds_read_b128 v[160:163], v148 offset:21504
    ds_read_b128 v[164:167], v148 offset:21760
    s_waitcnt lgkmcnt(2)
    v_dot2c_f32_bf16 v157, v232, v168
    v_dot2c_f32_bf16 v157, v233, v169
    v_dot2c_f32_bf16 v157, v234, v170
    v_dot2c_f32_bf16 v157, v235, v171
    v_dot2c_f32_bf16 v157, v236, v172
    v_dot2c_f32_bf16 v157, v237, v173
    v_dot2c_f32_bf16 v157, v238, v174
    v_dot2c_f32_bf16 v157, v239, v175
    ds_read_b128 v[168:171], v149 offset:21504
    ds_read_b128 v[172:175], v149 offset:21760
    s_waitcnt lgkmcnt(2)
    v_dot2c_f32_bf16 v158, v240, v160
    v_dot2c_f32_bf16 v158, v241, v161
    v_dot2c_f32_bf16 v158, v242, v162
    v_dot2c_f32_bf16 v158, v243, v163
    v_dot2c_f32_bf16 v158, v244, v164
    v_dot2c_f32_bf16 v158, v245, v165
    v_dot2c_f32_bf16 v158, v246, v166
    v_dot2c_f32_bf16 v158, v247, v167
    v_add_f32_dpp v156, v156, v156 row_ror:8 row_mask:0xf bank_mask:0x3
    v_add_f32_dpp v156, v157, v157 row_ror:8 row_mask:0xf bank_mask:0xc
    s_waitcnt lgkmcnt(0)
    v_dot2c_f32_bf16 v159, v248, v168
    v_dot2c_f32_bf16 v159, v249, v169
    v_dot2c_f32_bf16 v159, v250, v170
    v_dot2c_f32_bf16 v159, v251, v171
    v_dot2c_f32_bf16 v159, v252, v172
    v_dot2c_f32_bf16 v159, v253, v173
    v_dot2c_f32_bf16 v159, v254, v174
    v_dot2c_f32_bf16 v159, v255, v175
    v_add_f32_dpp v154, v154, v154 row_half_mirror row_mask:0xf bank_mask:0x5
    v_add_f32_dpp v154, v156, v156 row_half_mirror row_mask:0xf bank_mask:0xa
    v_add_f32_dpp v150, v150, v150 quad_perm:[1,0,3,2] row_mask:0xf bank_mask:0xf
    s_nop 0
    v_add_f32_dpp v158, v158, v158 row_ror:8 row_mask:0xf bank_mask:0x3
    v_add_f32_dpp v158, v159, v159 row_ror:8 row_mask:0xf bank_mask:0xc
    v_add_f32_dpp v154, v154, v154 quad_perm:[1,0,3,2] row_mask:0xf bank_mask:0xf
    v_add_f32_dpp v150, v150, v150 quad_perm:[2,3,0,1] row_mask:0xf bank_mask:0xf
    v_add_f32_dpp v158, v158, v158 row_half_mirror row_mask:0xf bank_mask:0x5
    v_add_f32_dpp v154, v154, v154 quad_perm:[2,3,0,1] row_mask:0xf bank_mask:0xf
    s_nop 0
    v_add_f32_dpp v158, v158, v158 quad_perm:[1,0,3,2] row_mask:0xf bank_mask:0xf
    v_cndmask_b32 v150, v150, v154, s[66:67]
    s_nop 0
    v_add_f32_dpp v158, v158, v158 quad_perm:[2,3,0,1] row_mask:0xf bank_mask:0xf
    v_cndmask_b32 v150, v150, v158, s[68:69]
    v_mul_f32 v150, 0x3db8aa3b, v150
    v_exp_f32 v150, v150
    s_nop 0
    v_mov_b32 v44, v150
    v_mov_b32 v45, v150
    s_nop 1
    v_permlane32_swap_b32 v44, v45
    v_add_f32 v44, v44, v45
    v_mov_b32 v45, v44
    s_nop 1
    v_permlane16_swap_b32 v44, v45
    v_add_f32 v44, v44, v45
    v_add_f32 v44, 0x3089705f, v44
    v_rcp_f32 v44, v44
    s_nop 0
    v_mul_f32 v150, v150, v44
    v_cvt_pk_bf16_f32 v150, v150, 0
    v_lshlrev_b32 v8, v9, v150
    s_nop 1
    v_and_b32_dpp v24, v8, v12 row_newbcast:0 row_mask:0xf bank_mask:0xf
    v_and_b32_dpp v25, v8, v13 row_newbcast:0 row_mask:0xf bank_mask:0xf
    v_mov_b64 v[40:41], 0
    v_mov_b64 v[42:43], 0
    v_mov_b64 v[44:45], 0
    v_mov_b64 v[46:47], 0
    v_smfmac_f32_16x16x32_bf16 v[40:43], v[24:25], v[176:179], v14
    v_and_b32_dpp v28, v8, v12 row_newbcast:8 row_mask:0xf bank_mask:0xf
    v_and_b32_dpp v29, v8, v13 row_newbcast:8 row_mask:0xf bank_mask:0xf
    v_smfmac_f32_16x16x32_bf16 v[44:47], v[24:25], v[180:183], v14
    v_add_u32_dpp v11, v32, v7 row_newbcast:12 row_mask:0xf bank_mask:0xf
    buffer_load_dwordx4 v[144:147], v11, s[32:35], 0 offen offset:0
    buffer_load_dwordx4 v[152:155], v11, s[32:35], 0 offen offset:256
    v_smfmac_f32_16x16x32_bf16 v[40:43], v[28:29], v[184:187], v14
    v_and_b32_dpp v24, v8, v12 row_newbcast:4 row_mask:0xf bank_mask:0xf
    v_and_b32_dpp v25, v8, v13 row_newbcast:4 row_mask:0xf bank_mask:0xf
    v_smfmac_f32_16x16x32_bf16 v[44:47], v[28:29], v[188:191], v14
    s_nop 0
    v_smfmac_f32_16x16x32_bf16 v[16:19], v[24:25], v[192:195], v14
    v_and_b32_dpp v28, v8, v12 row_newbcast:12 row_mask:0xf bank_mask:0xf
    v_and_b32_dpp v29, v8, v13 row_newbcast:12 row_mask:0xf bank_mask:0xf
    v_smfmac_f32_16x16x32_bf16 v[20:23], v[24:25], v[196:199], v14
    v_add_u32_dpp v11, v32, v7 row_newbcast:13 row_mask:0xf bank_mask:0xf
    buffer_load_dwordx4 v[148:151], v11, s[32:35], 0 offen offset:0
    buffer_load_dwordx4 v[156:159], v11, s[32:35], 0 offen offset:256
    v_smfmac_f32_16x16x32_bf16 v[16:19], v[28:29], v[200:203], v14
    v_and_b32_dpp v24, v8, v12 row_newbcast:1 row_mask:0xf bank_mask:0xf
    v_and_b32_dpp v25, v8, v13 row_newbcast:1 row_mask:0xf bank_mask:0xf
    v_smfmac_f32_16x16x32_bf16 v[20:23], v[28:29], v[204:207], v14
    v_xor_b32 v178, s15, v2
    s_lshl_b32 s64, s20, 2
    v_add_u32 v9, s64, v0
    v_mov_b32 v179, 0
    v_cvt_pk_bf16_f32 v30, v40, v41
    v_cvt_pk_bf16_f32 v31, v42, v43
    ds_write_b64 v178, v[30:31] offset:1024
    v_cvt_pk_bf16_f32 v30, v44, v45
    v_cvt_pk_bf16_f32 v31, v46, v47
    ds_write_b64 v178, v[30:31] offset:1280
    ds_read_u16_d16_hi v179, v9
    v_mov_b64 v[40:41], 0
    v_mov_b64 v[42:43], 0
    v_mov_b64 v[44:45], 0
    v_mov_b64 v[46:47], 0
    s_nop 0
    v_smfmac_f32_16x16x32_bf16 v[40:43], v[24:25], v[208:211], v14
    v_and_b32_dpp v28, v8, v12 row_newbcast:9 row_mask:0xf bank_mask:0xf
    v_and_b32_dpp v29, v8, v13 row_newbcast:9 row_mask:0xf bank_mask:0xf
    v_smfmac_f32_16x16x32_bf16 v[44:47], v[24:25], v[212:215], v14
    v_add_u32_dpp v11, v32, v7 row_newbcast:14 row_mask:0xf bank_mask:0xf
    buffer_load_dwordx4 v[160:163], v11, s[32:35], 0 offen offset:0
    buffer_load_dwordx4 v[168:171], v11, s[32:35], 0 offen offset:256
    v_smfmac_f32_16x16x32_bf16 v[40:43], v[28:29], v[216:219], v14
    v_and_b32_dpp v24, v8, v12 row_newbcast:5 row_mask:0xf bank_mask:0xf
    v_and_b32_dpp v25, v8, v13 row_newbcast:5 row_mask:0xf bank_mask:0xf
    v_smfmac_f32_16x16x32_bf16 v[44:47], v[28:29], v[220:223], v14
    v_xor_b32 v180, s16, v2
    s_lshl_b32 s64, s21, 2
    v_add_u32 v9, s64, v0
    v_mov_b32 v181, 0
    v_cvt_pk_bf16_f32 v30, v16, v17
    v_cvt_pk_bf16_f32 v31, v18, v19
    ds_write_b64 v180, v[30:31] offset:1024
    v_cvt_pk_bf16_f32 v30, v20, v21
    v_cvt_pk_bf16_f32 v31, v22, v23
    ds_write_b64 v180, v[30:31] offset:1280
    ds_read_u16_d16_hi v181, v9
    v_mov_b64 v[16:17], 0
    v_mov_b64 v[18:19], 0
    v_mov_b64 v[20:21], 0
    v_mov_b64 v[22:23], 0
    s_nop 0
    v_smfmac_f32_16x16x32_bf16 v[16:19], v[24:25], v[224:227], v14
    v_and_b32_dpp v28, v8, v12 row_newbcast:13 row_mask:0xf bank_mask:0xf
    v_and_b32_dpp v29, v8, v13 row_newbcast:13 row_mask:0xf bank_mask:0xf
    v_smfmac_f32_16x16x32_bf16 v[20:23], v[24:25], v[228:231], v14
    v_add_u32_dpp v11, v32, v7 row_newbcast:15 row_mask:0xf bank_mask:0xf
    buffer_load_dwordx4 v[164:167], v11, s[32:35], 0 offen offset:0
    buffer_load_dwordx4 v[172:175], v11, s[32:35], 0 offen offset:256
    v_smfmac_f32_16x16x32_bf16 v[16:19], v[28:29], v[232:235], v14
    v_and_b32_dpp v24, v8, v12 row_newbcast:2 row_mask:0xf bank_mask:0xf
    v_and_b32_dpp v25, v8, v13 row_newbcast:2 row_mask:0xf bank_mask:0xf
    v_smfmac_f32_16x16x32_bf16 v[20:23], v[28:29], v[236:239], v14
    v_xor_b32 v182, s17, v2
    s_lshl_b32 s64, s22, 2
    v_add_u32 v9, s64, v0
    v_mov_b32 v183, 0
    v_cvt_pk_bf16_f32 v30, v40, v41
    v_cvt_pk_bf16_f32 v31, v42, v43
    ds_write_b64 v182, v[30:31] offset:1024
    v_cvt_pk_bf16_f32 v30, v44, v45
    v_cvt_pk_bf16_f32 v31, v46, v47
    ds_write_b64 v182, v[30:31] offset:1280
    ds_read_u16_d16_hi v183, v9
    v_mov_b64 v[40:41], 0
    v_mov_b64 v[42:43], 0
    v_mov_b64 v[44:45], 0
    v_mov_b64 v[46:47], 0
    s_nop 0
    v_smfmac_f32_16x16x32_bf16 v[40:43], v[24:25], v[240:243], v14
    v_and_b32_dpp v28, v8, v12 row_newbcast:10 row_mask:0xf bank_mask:0xf
    v_and_b32_dpp v29, v8, v13 row_newbcast:10 row_mask:0xf bank_mask:0xf
    v_smfmac_f32_16x16x32_bf16 v[44:47], v[24:25], v[244:247], v14
    s_nop 0
    v_smfmac_f32_16x16x32_bf16 v[40:43], v[28:29], v[248:251], v14
    v_and_b32_dpp v24, v33, v12 row_newbcast:0 row_mask:0xf bank_mask:0xf
    v_and_b32_dpp v25, v33, v13 row_newbcast:0 row_mask:0xf bank_mask:0xf
    v_and_b32_dpp v26, v33, v12 row_newbcast:1 row_mask:0xf bank_mask:0xf
    v_and_b32_dpp v27, v33, v13 row_newbcast:1 row_mask:0xf bank_mask:0xf
    v_smfmac_f32_16x16x32_bf16 v[44:47], v[28:29], v[252:255], v14
    v_xor_b32 v184, s18, v2
    s_lshl_b32 s64, s23, 2
    v_add_u32 v9, s64, v0
    v_mov_b32 v185, 0
    v_cvt_pk_bf16_f32 v30, v16, v17
    v_cvt_pk_bf16_f32 v31, v18, v19
    ds_write_b64 v184, v[30:31] offset:1024
    v_cvt_pk_bf16_f32 v30, v20, v21
    v_cvt_pk_bf16_f32 v31, v22, v23
    ds_write_b64 v184, v[30:31] offset:1280
    ds_read_u16_d16_hi v185, v9
    v_mov_b64 v[16:17], 0
    v_mov_b64 v[18:19], 0
    v_mov_b64 v[20:21], 0
    v_mov_b64 v[22:23], 0
    s_nop 0
    v_xor_b32 v176, s19, v2
    s_lshl_b32 s64, s24, 2
    v_add_u32 v9, s64, v0
    v_mov_b32 v177, 0
    v_cvt_pk_bf16_f32 v30, v40, v41
    v_cvt_pk_bf16_f32 v31, v42, v43
    ds_write_b64 v176, v[30:31] offset:1024
    v_cvt_pk_bf16_f32 v30, v44, v45
    v_cvt_pk_bf16_f32 v31, v46, v47
    ds_write_b64 v176, v[30:31] offset:1280
    ds_read_u16_d16_hi v177, v9
    s_waitcnt lgkmcnt(0)
    s_barrier
    s_cmp_lg_u32 s25, 0
    s_cbranch_scc1 L_slow
L_fp0:
    s_bitcmp1_b32 s52, 0
    s_waitcnt vmcnt(28)
    v_smfmac_f32_16x16x64_bf16 v[16:19], v[24:27], v[48:55], v14
    v_and_b32_dpp v28, v33, v12 row_newbcast:2 row_mask:0xf bank_mask:0xf
    v_and_b32_dpp v29, v33, v13 row_newbcast:2 row_mask:0xf bank_mask:0xf
    v_smfmac_f32_16x16x64_bf16 v[20:23], v[24:27], v[56:63], v14
    v_and_b32_dpp v30, v33, v12 row_newbcast:3 row_mask:0xf bank_mask:0xf
    v_and_b32_dpp v31, v33, v13 row_newbcast:3 row_mask:0xf bank_mask:0xf
    v_add_u32_dpp v11, v34, v7 row_newbcast:0 row_mask:0xf bank_mask:0xf
    buffer_load_dwordx4 v[48:51], v11, s[32:35], 0 offen offset:0
    buffer_load_dwordx4 v[56:59], v11, s[32:35], 0 offen offset:256
    s_cbranch_scc1 L_ev0
L_fp1:
    s_bitcmp1_b32 s52, 1
    s_waitcnt vmcnt(26)
    v_smfmac_f32_16x16x64_bf16 v[16:19], v[28:31], v[64:71], v14
    v_and_b32_dpp v24, v33, v12 row_newbcast:4 row_mask:0xf bank_mask:0xf
    v_and_b32_dpp v25, v33, v13 row_newbcast:4 row_mask:0xf bank_mask:0xf
    v_smfmac_f32_16x16x64_bf16 v[20:23], v[28:31], v[72:79], v14
    v_and_b32_dpp v26, v33, v12 row_newbcast:5 row_mask:0xf bank_mask:0xf
    v_and_b32_dpp v27, v33, v13 row_newbcast:5 row_mask:0xf bank_mask:0xf
    v_add_u32_dpp v11, v34, v7 row_newbcast:1 row_mask:0xf bank_mask:0xf
    buffer_load_dwordx4 v[52:55], v11, s[32:35], 0 offen offset:0
    buffer_load_dwordx4 v[60:63], v11, s[32:35], 0 offen offset:256
    s_cbranch_scc1 L_ev1
L_fp2:
    s_bitcmp1_b32 s52, 2
    s_waitcnt vmcnt(24)
    v_smfmac_f32_16x16x64_bf16 v[16:19], v[24:27], v[80:87], v14
    v_and_b32_dpp v28, v33, v12 row_newbcast:6 row_mask:0xf bank_mask:0xf
    v_and_b32_dpp v29, v33, v13 row_newbcast:6 row_mask:0xf bank_mask:0xf
    v_smfmac_f32_16x16x64_bf16 v[20:23], v[24:27], v[88:95], v14
    v_and_b32_dpp v30, v33, v12 row_newbcast:7 row_mask:0xf bank_mask:0xf
    v_and_b32_dpp v31, v33, v13 row_newbcast:7 row_mask:0xf bank_mask:0xf
    v_add_u32_dpp v11, v34, v7 row_newbcast:2 row_mask:0xf bank_mask:0xf
    buffer_load_dwordx4 v[64:67], v11, s[32:35], 0 offen offset:0
    buffer_load_dwordx4 v[72:75], v11, s[32:35], 0 offen offset:256
    s_cbranch_scc1 L_ev2
L_fp3:
    s_bitcmp1_b32 s52, 3
    s_waitcnt vmcnt(22)
    v_smfmac_f32_16x16x64_bf16 v[16:19], v[28:31], v[96:103], v14
    v_and_b32_dpp v24, v33, v12 row_newbcast:8 row_mask:0xf bank_mask:0xf
    v_and_b32_dpp v25, v33, v13 row_newbcast:8 row_mask:0xf bank_mask:0xf
    v_smfmac_f32_16x16x64_bf16 v[20:23], v[28:31], v[104:111], v14
    v_and_b32_dpp v26, v33, v12 row_newbcast:9 row_mask:0xf bank_mask:0xf
    v_and_b32_dpp v27, v33, v13 row_newbcast:9 row_mask:0xf bank_mask:0xf
    v_add_u32_dpp v11, v34, v7 row_newbcast:3 row_mask:0xf bank_mask:0xf
    buffer_load_dwordx4 v[68:71], v11, s[32:35], 0 offen offset:0
    buffer_load_dwordx4 v[76:79], v11, s[32:35], 0 offen offset:256
    s_cbranch_scc1 L_ev3
L_fp4:
    s_bitcmp1_b32 s52, 4
    s_waitcnt vmcnt(20)
    v_smfmac_f32_16x16x64_bf16 v[16:19], v[24:27], v[112:119], v14
    v_and_b32_dpp v28, v33, v12 row_newbcast:10 row_mask:0xf bank_mask:0xf
    v_and_b32_dpp v29, v33, v13 row_newbcast:10 row_mask:0xf bank_mask:0xf
    v_smfmac_f32_16x16x64_bf16 v[20:23], v[24:27], v[120:127], v14
    v_and_b32_dpp v30, v33, v12 row_newbcast:11 row_mask:0xf bank_mask:0xf
    v_and_b32_dpp v31, v33, v13 row_newbcast:11 row_mask:0xf bank_mask:0xf
    v_add_u32_dpp v11, v34, v7 row_newbcast:4 row_mask:0xf bank_mask:0xf
    buffer_load_dwordx4 v[80:83], v11, s[32:35], 0 offen offset:0
    buffer_load_dwordx4 v[88:91], v11, s[32:35], 0 offen offset:256
    s_cbranch_scc1 L_ev4
L_fp5:
    s_bitcmp1_b32 s52, 5
    s_waitcnt vmcnt(18)
    v_smfmac_f32_16x16x64_bf16 v[16:19], v[28:31], v[128:135], v14
    v_and_b32_dpp v24, v33, v12 row_newbcast:12 row_mask:0xf bank_mask:0xf
    v_and_b32_dpp v25, v33, v13 row_newbcast:12 row_mask:0xf bank_mask:0xf
    v_smfmac_f32_16x16x64_bf16 v[20:23], v[28:31], v[136:143], v14
    v_and_b32_dpp v26, v33, v12 row_newbcast:13 row_mask:0xf bank_mask:0xf
    v_and_b32_dpp v27, v33, v13 row_newbcast:13 row_mask:0xf bank_mask:0xf
    v_add_u32_dpp v11, v34, v7 row_newbcast:5 row_mask:0xf bank_mask:0xf
    buffer_load_dwordx4 v[84:87], v11, s[32:35], 0 offen offset:0
    buffer_load_dwordx4 v[92:95], v11, s[32:35], 0 offen offset:256
    s_cbranch_scc1 L_ev5
L_fp6:
    s_bitcmp1_b32 s52, 6
    s_waitcnt vmcnt(16)
    v_smfmac_f32_16x16x64_bf16 v[16:19], v[24:27], v[144:151], v14
    v_and_b32_dpp v28, v33, v12 row_newbcast:14 row_mask:0xf bank_mask:0xf
    v_and_b32_dpp v29, v33, v13 row_newbcast:14 row_mask:0xf bank_mask:0xf
    v_smfmac_f32_16x16x64_bf16 v[20:23], v[24:27], v[152:159], v14
    v_and_b32_dpp v30, v33, v12 row_newbcast:15 row_mask:0xf bank_mask:0xf
    v_and_b32_dpp v31, v33, v13 row_newbcast:15 row_mask:0xf bank_mask:0xf
    v_add_u32_dpp v11, v34, v7 row_newbcast:6 row_mask:0xf bank_mask:0xf
    buffer_load_dwordx4 v[96:99], v11, s[32:35], 0 offen offset:0
    buffer_load_dwordx4 v[104:107], v11, s[32:35], 0 offen offset:256
    s_cbranch_scc1 L_ev6
L_fp7:
    s_bitcmp1_b32 s52, 7
    s_waitcnt vmcnt(14)
    v_smfmac_f32_16x16x64_bf16 v[16:19], v[28:31], v[160:167], v14
    v_and_b32_dpp v24, v35, v12 row_newbcast:0 row_mask:0xf bank_mask:0xf
    v_and_b32_dpp v25, v35, v13 row_newbcast:0 row_mask:0xf bank_mask:0xf
    v_smfmac_f32_16x16x64_bf16 v[20:23], v[28:31], v[168:175], v14
    v_and_b32_dpp v26, v35, v12 row_newbcast:1 row_mask:0xf bank_mask:0xf
    v_and_b32_dpp v27, v35, v13 row_newbcast:1 row_mask:0xf bank_mask:0xf
    v_add_u32_dpp v11, v34, v7 row_newbcast:7 row_mask:0xf bank_mask:0xf
    buffer_load_dwordx4 v[100:103], v11, s[32:35], 0 offen offset:0
    buffer_load_dwordx4 v[108:111], v11, s[32:35], 0 offen offset:256
    s_cbranch_scc1 L_ev7
L_fp8:
    v_mov_b64 v[32:33], v[34:35]
    v_mov_b64 v[34:35], v[36:37]
    v_mov_b64 v[36:37], v[38:39]
    s_lshr_b32 s52, s52, 8
    s_lshr_b32 s53, s53, 8
    s_lshr_b32 s56, s56, 8
    s_mov_b32 s62, L_st1-L_anc
    s_mov_b32 s63, L_st1-L_st0
L_st0:
    s_bitcmp1_b32 s52, 0
    s_waitcnt vmcnt(12)
    v_smfmac_f32_16x16x64_bf16 v[16:19], v[24:27], v[48:55], v14
    v_and_b32_dpp v28, v33, v12 row_newbcast:2 row_mask:0xf bank_mask:0xf
    v_and_b32_dpp v29, v33, v13 row_newbcast:2 row_mask:0xf bank_mask:0xf
    v_smfmac_f32_16x16x64_bf16 v[20:23], v[24:27], v[56:63], v14
    v_and_b32_dpp v30, v33, v12 row_newbcast:3 row_mask:0xf bank_mask:0xf
    v_and_b32_dpp v31, v33, v13 row_newbcast:3 row_mask:0xf bank_mask:0xf
    v_add_u32_dpp v11, v32, v7 row_newbcast:8 row_mask:0xf bank_mask:0xf
    buffer_load_dwordx4 v[112:115], v11, s[32:35], 0 offen offset:0
    buffer_load_dwordx4 v[120:123], v11, s[32:35], 0 offen offset:256
    v_add_u32_dpp v11, v32, v7 row_newbcast:9 row_mask:0xf bank_mask:0xf
    buffer_load_dwordx4 v[116:119], v11, s[32:35], 0 offen offset:0
    buffer_load_dwordx4 v[124:127], v11, s[32:35], 0 offen offset:256
    s_cbranch_scc1 L_ev0
L_st1:
    s_bitcmp1_b32 s52, 1
    s_waitcnt vmcnt(12)
    v_smfmac_f32_16x16x64_bf16 v[16:19], v[28:31], v[64:71], v14
    v_and_b32_dpp v24, v33, v12 row_newbcast:4 row_mask:0xf bank_mask:0xf
    v_and_b32_dpp v25, v33, v13 row_newbcast:4 row_mask:0xf bank_mask:0xf
    v_smfmac_f32_16x16x64_bf16 v[20:23], v[28:31], v[72:79], v14
    v_and_b32_dpp v26, v33, v12 row_newbcast:5 row_mask:0xf bank_mask:0xf
    v_and_b32_dpp v27, v33, v13 row_newbcast:5 row_mask:0xf bank_mask:0xf
    v_add_u32_dpp v11, v32, v7 row_newbcast:10 row_mask:0xf bank_mask:0xf
    buffer_load_dwordx4 v[128:131], v11, s[32:35], 0 offen offset:0
    buffer_load_dwordx4 v[136:139], v11, s[32:35], 0 offen offset:256
    v_add_u32_dpp v11, v32, v7 row_newbcast:11 row_mask:0xf bank_mask:0xf
    buffer_load_dwordx4 v[132:135], v11, s[32:35], 0 offen offset:0
    buffer_load_dwordx4 v[140:143], v11, s[32:35], 0 offen offset:256
    s_cbranch_scc1 L_ev1
L_st2:
    s_bitcmp1_b32 s52, 2
    s_waitcnt vmcnt(12)
    v_smfmac_f32_16x16x64_bf16 v[16:19], v[24:27], v[80:87], v14
    v_and_b32_dpp v28, v33, v12 row_newbcast:6 row_mask:0xf bank_mask:0xf
    v_and_b32_dpp v29, v33, v13 row_newbcast:6 row_mask:0xf bank_mask:0xf
    v_smfmac_f32_16x16x64_bf16 v[20:23], v[24:27], v[88:95], v14
    v_and_b32_dpp v30, v33, v12 row_newbcast:7 row_mask:0xf bank_mask:0xf
    v_and_b32_dpp v31, v33, v13 row_newbcast:7 row_mask:0xf bank_mask:0xf
    v_add_u32_dpp v11, v32, v7 row_newbcast:12 row_mask:0xf bank_mask:0xf
    buffer_load_dwordx4 v[144:147], v11, s[32:35], 0 offen offset:0
    buffer_load_dwordx4 v[152:155], v11, s[32:35], 0 offen offset:256
    v_add_u32_dpp v11, v32, v7 row_newbcast:13 row_mask:0xf bank_mask:0xf
    buffer_load_dwordx4 v[148:151], v11, s[32:35], 0 offen offset:0
    buffer_load_dwordx4 v[156:159], v11, s[32:35], 0 offen offset:256
    s_cbranch_scc1 L_ev2
L_st3:
    s_bitcmp1_b32 s52, 3
    s_waitcnt vmcnt(12)
    v_smfmac_f32_16x16x64_bf16 v[16:19], v[28:31], v[96:103], v14
    v_and_b32_dpp v24, v33, v12 row_newbcast:8 row_mask:0xf bank_mask:0xf
    v_and_b32_dpp v25, v33, v13 row_newbcast:8 row_mask:0xf bank_mask:0xf
    v_smfmac_f32_16x16x64_bf16 v[20:23], v[28:31], v[104:111], v14
    v_and_b32_dpp v26, v33, v12 row_newbcast:9 row_mask:0xf bank_mask:0xf
    v_and_b32_dpp v27, v33, v13 row_newbcast:9 row_mask:0xf bank_mask:0xf
    v_add_u32_dpp v11, v32, v7 row_newbcast:14 row_mask:0xf bank_mask:0xf
    buffer_load_dwordx4 v[160:163], v11, s[32:35], 0 offen offset:0
    buffer_load_dwordx4 v[168:171], v11, s[32:35], 0 offen offset:256
    v_add_u32_dpp v11, v32, v7 row_newbcast:15 row_mask:0xf bank_mask:0xf
    buffer_load_dwordx4 v[164:167], v11, s[32:35], 0 offen offset:0
    buffer_load_dwordx4 v[172:175], v11, s[32:35], 0 offen offset:256
    s_cbranch_scc1 L_ev3
L_st4:
    s_bitcmp1_b32 s52, 4
    s_waitcnt vmcnt(12)
    v_smfmac_f32_16x16x64_bf16 v[16:19], v[24:27], v[112:119], v14
    v_and_b32_dpp v28, v33, v12 row_newbcast:10 row_mask:0xf bank_mask:0xf
    v_and_b32_dpp v29, v33, v13 row_newbcast:10 row_mask:0xf bank_mask:0xf
    v_smfmac_f32_16x16x64_bf16 v[20:23], v[24:27], v[120:127], v14
    v_and_b32_dpp v30, v33, v12 row_newbcast:11 row_mask:0xf bank_mask:0xf
    v_and_b32_dpp v31, v33, v13 row_newbcast:11 row_mask:0xf bank_mask:0xf
    v_add_u32_dpp v11, v34, v7 row_newbcast:0 row_mask:0xf bank_mask:0xf
    buffer_load_dwordx4 v[48:51], v11, s[32:35], 0 offen offset:0
    buffer_load_dwordx4 v[56:59], v11, s[32:35], 0 offen offset:256
    v_add_u32_dpp v11, v34, v7 row_newbcast:1 row_mask:0xf bank_mask:0xf
    buffer_load_dwordx4 v[52:55], v11, s[32:35], 0 offen offset:0
    buffer_load_dwordx4 v[60:63], v11, s[32:35], 0 offen offset:256
    s_cbranch_scc1 L_ev4
L_st5:
    s_bitcmp1_b32 s52, 5
    s_waitcnt vmcnt(12)
    v_smfmac_f32_16x16x64_bf16 v[16:19], v[28:31], v[128:135], v14
    v_and_b32_dpp v24, v33, v12 row_newbcast:12 row_mask:0xf bank_mask:0xf
    v_and_b32_dpp v25, v33, v13 row_newbcast:12 row_mask:0xf bank_mask:0xf
    v_smfmac_f32_16x16x64_bf16 v[20:23], v[28:31], v[136:143], v14
    v_and_b32_dpp v26, v33, v12 row_newbcast:13 row_mask:0xf bank_mask:0xf
    v_and_b32_dpp v27, v33, v13 row_newbcast:13 row_mask:0xf bank_mask:0xf
    v_add_u32_dpp v11, v34, v7 row_newbcast:2 row_mask:0xf bank_mask:0xf
    buffer_load_dwordx4 v[64:67], v11, s[32:35], 0 offen offset:0
    buffer_load_dwordx4 v[72:75], v11, s[32:35], 0 offen offset:256
    v_add_u32_dpp v11, v34, v7 row_newbcast:3 row_mask:0xf bank_mask:0xf
    buffer_load_dwordx4 v[68:71], v11, s[32:35], 0 offen offset:0
    buffer_load_dwordx4 v[76:79], v11, s[32:35], 0 offen offset:256
    s_cbranch_scc1 L_ev5
L_st6:
    s_bitcmp1_b32 s52, 6
    s_waitcnt vmcnt(12)
    v_smfmac_f32_16x16x64_bf16 v[16:19], v[24:27], v[144:151], v14
    v_and_b32_dpp v28, v33, v12 row_newbcast:14 row_mask:0xf bank_mask:0xf
    v_and_b32_dpp v29, v33, v13 row_newbcast:14 row_mask:0xf bank_mask:0xf
    v_smfmac_f32_16x16x64_bf16 v[20:23], v[24:27], v[152:159], v14
    v_and_b32_dpp v30, v33, v12 row_newbcast:15 row_mask:0xf bank_mask:0xf
    v_and_b32_dpp v31, v33, v13 row_newbcast:15 row_mask:0xf bank_mask:0xf
    v_add_u32_dpp v11, v34, v7 row_newbcast:4 row_mask:0xf bank_mask:0xf
    buffer_load_dwordx4 v[80:83], v11, s[32:35], 0 offen offset:0
    buffer_load_dwordx4 v[88:91], v11, s[32:35], 0 offen offset:256
    v_add_u32_dpp v11, v34, v7 row_newbcast:5 row_mask:0xf bank_mask:0xf
    buffer_load_dwordx4 v[84:87], v11, s[32:35], 0 offen offset:0
    buffer_load_dwordx4 v[92:95], v11, s[32:35], 0 offen offset:256
    s_cbranch_scc1 L_ev6
L_st7:
    s_bitcmp1_b32 s52, 7
    s_waitcnt vmcnt(12)
    v_smfmac_f32_16x16x64_bf16 v[16:19], v[28:31], v[160:167], v14
    v_and_b32_dpp v24, v35, v12 row_newbcast:0 row_mask:0xf bank_mask:0xf
    v_and_b32_dpp v25, v35, v13 row_newbcast:0 row_mask:0xf bank_mask:0xf
    v_smfmac_f32_16x16x64_bf16 v[20:23], v[28:31], v[168:175], v14
    v_and_b32_dpp v26, v35, v12 row_newbcast:1 row_mask:0xf bank_mask:0xf
    v_and_b32_dpp v27, v35, v13 row_newbcast:1 row_mask:0xf bank_mask:0xf
    v_add_u32_dpp v11, v34, v7 row_newbcast:6 row_mask:0xf bank_mask:0xf
    buffer_load_dwordx4 v[96:99], v11, s[32:35], 0 offen offset:0
    buffer_load_dwordx4 v[104:107], v11, s[32:35], 0 offen offset:256
    v_add_u32_dpp v11, v34, v7 row_newbcast:7 row_mask:0xf bank_mask:0xf
    buffer_load_dwordx4 v[100:103], v11, s[32:35], 0 offen offset:0
    buffer_load_dwordx4 v[108:111], v11, s[32:35], 0 offen offset:256
    s_cbranch_scc1 L_ev7
L_st8:
    v_mov_b64 v[32:33], v[34:35]
    v_mov_b64 v[34:35], v[36:37]
    v_mov_b64 v[36:37], v[38:39]
    s_lshr_b32 s52, s52, 8
    s_lshr_b32 s53, s53, 8
    s_lshr_b32 s56, s56, 8
    s_branch L_st0
L_dr0:
    s_bitcmp1_b32 s52, 0
    ds_write_b32 v10, v6 offset:48
    s_waitcnt vmcnt(12)
    v_smfmac_f32_16x16x64_bf16 v[16:19], v[24:27], v[48:55], v14
    v_and_b32_dpp v28, v33, v12 row_newbcast:2 row_mask:0xf bank_mask:0xf
    v_and_b32_dpp v29, v33, v13 row_newbcast:2 row_mask:0xf bank_mask:0xf
    v_smfmac_f32_16x16x64_bf16 v[20:23], v[24:27], v[56:63], v14
    v_and_b32_dpp v30, v33, v12 row_newbcast:3 row_mask:0xf bank_mask:0xf
    v_and_b32_dpp v31, v33, v13 row_newbcast:3 row_mask:0xf bank_mask:0xf
    buffer_load_ubyte v15, off, s[32:35], 0
    buffer_load_ubyte v15, off, s[32:35], 0
    buffer_load_ubyte v15, off, s[32:35], 0
    buffer_load_ubyte v15, off, s[32:35], 0
    s_cbranch_scc1 L_ev0
L_dr1:
    s_bitcmp1_b32 s52, 1
    ds_write_b32 v10, v6 offset:48
    s_waitcnt vmcnt(12)
    v_smfmac_f32_16x16x64_bf16 v[16:19], v[28:31], v[64:71], v14
    v_and_b32_dpp v24, v33, v12 row_newbcast:4 row_mask:0xf bank_mask:0xf
    v_and_b32_dpp v25, v33, v13 row_newbcast:4 row_mask:0xf bank_mask:0xf
    v_smfmac_f32_16x16x64_bf16 v[20:23], v[28:31], v[72:79], v14
    v_and_b32_dpp v26, v33, v12 row_newbcast:5 row_mask:0xf bank_mask:0xf
    v_and_b32_dpp v27, v33, v13 row_newbcast:5 row_mask:0xf bank_mask:0xf
    buffer_load_ubyte v15, off, s[32:35], 0
    buffer_load_ubyte v15, off, s[32:35], 0
    buffer_load_ubyte v15, off, s[32:35], 0
    buffer_load_ubyte v15, off, s[32:35], 0
    s_cbranch_scc1 L_ev1
L_dr2:
    s_bitcmp1_b32 s52, 2
    ds_write_b32 v10, v6 offset:48
    s_waitcnt vmcnt(12)
    v_smfmac_f32_16x16x64_bf16 v[16:19], v[24:27], v[80:87], v14
    v_and_b32_dpp v28, v33, v12 row_newbcast:6 row_mask:0xf bank_mask:0xf
    v_and_b32_dpp v29, v33, v13 row_newbcast:6 row_mask:0xf bank_mask:0xf
    v_smfmac_f32_16x16x64_bf16 v[20:23], v[24:27], v[88:95], v14
    v_and_b32_dpp v30, v33, v12 row_newbcast:7 row_mask:0xf bank_mask:0xf
    v_and_b32_dpp v31, v33, v13 row_newbcast:7 row_mask:0xf bank_mask:0xf
    buffer_load_ubyte v15, off, s[32:35], 0
    buffer_load_ubyte v15, off, s[32:35], 0
    buffer_load_ubyte v15, off, s[32:35], 0
    buffer_load_ubyte v15, off, s[32:35], 0
    s_cbranch_scc1 L_ev2
L_dr3:
    s_bitcmp1_b32 s52, 3
    ds_write_b32 v10, v6 offset:48
    s_waitcnt vmcnt(12)
    v_smfmac_f32_16x16x64_bf16 v[16:19], v[28:31], v[96:103], v14
    v_and_b32_dpp v24, v33, v12 row_newbcast:8 row_mask:0xf bank_mask:0xf
    v_and_b32_dpp v25, v33, v13 row_newbcast:8 row_mask:0xf bank_mask:0xf
    v_smfmac_f32_16x16x64_bf16 v[20:23], v[28:31], v[104:111], v14
    v_and_b32_dpp v26, v33, v12 row_newbcast:9 row_mask:0xf bank_mask:0xf
    v_and_b32_dpp v27, v33, v13 row_newbcast:9 row_mask:0xf bank_mask:0xf
    buffer_load_ubyte v15, off, s[32:35], 0
    buffer_load_ubyte v15, off, s[32:35], 0
    buffer_load_ubyte v15, off, s[32:35], 0
    buffer_load_ubyte v15, off, s[32:35], 0
    s_cbranch_scc1 L_ev3
L_dr4:
    s_bitcmp1_b32 s52, 4
    ds_write_b32 v10, v6 offset:48
    s_waitcnt vmcnt(12)
    v_smfmac_f32_16x16x64_bf16 v[16:19], v[24:27], v[112:119], v14
    v_and_b32_dpp v28, v33, v12 row_newbcast:10 row_mask:0xf bank_mask:0xf
    v_and_b32_dpp v29, v33, v13 row_newbcast:10 row_mask:0xf bank_mask:0xf
    v_smfmac_f32_16x16x64_bf16 v[20:23], v[24:27], v[120:127], v14
    v_and_b32_dpp v30, v33, v12 row_newbcast:11 row_mask:0xf bank_mask:0xf
    v_and_b32_dpp v31, v33, v13 row_newbcast:11 row_mask:0xf bank_mask:0xf
    buffer_load_ubyte v15, off, s[32:35], 0
    buffer_load_ubyte v15, off, s[32:35], 0
    buffer_load_ubyte v15, off, s[32:35], 0
    buffer_load_ubyte v15, off, s[32:35], 0
    s_cbranch_scc1 L_ev4
L_dr5:
    s_bitcmp1_b32 s52, 5
    ds_write_b32 v10, v6 offset:48
    s_waitcnt vmcnt(12)
    v_smfmac_f32_16x16x64_bf16 v[16:19], v[28:31], v[128:135], v14
    v_and_b32_dpp v24, v33, v12 row_newbcast:12 row_mask:0xf bank_mask:0xf
    v_and_b32_dpp v25, v33, v13 row_newbcast:12 row_mask:0xf bank_mask:0xf
    v_smfmac_f32_16x16x64_bf16 v[20:23], v[28:31], v[136:143], v14
    v_and_b32_dpp v26, v33, v12 row_newbcast:13 row_mask:0xf bank_mask:0xf
    v_and_b32_dpp v27, v33, v13 row_newbcast:13 row_mask:0xf bank_mask:0xf
    buffer_load_ubyte v15, off, s[32:35], 0
    buffer_load_ubyte v15, off, s[32:35], 0
    buffer_load_ubyte v15, off, s[32:35], 0
    buffer_load_ubyte v15, off, s[32:35], 0
    s_cbranch_scc1 L_ev5
L_dr6:
    s_bitcmp1_b32 s52, 6
    ds_write_b32 v10, v6 offset:48
    s_waitcnt vmcnt(12)
    v_smfmac_f32_16x16x64_bf16 v[16:19], v[24:27], v[144:151], v14
    v_and_b32_dpp v28, v33, v12 row_newbcast:14 row_mask:0xf bank_mask:0xf
    v_and_b32_dpp v29, v33, v13 row_newbcast:14 row_mask:0xf bank_mask:0xf
    v_smfmac_f32_16x16x64_bf16 v[20:23], v[24:27], v[152:159], v14
    v_and_b32_dpp v30, v33, v12 row_newbcast:15 row_mask:0xf bank_mask:0xf
    v_and_b32_dpp v31, v33, v13 row_newbcast:15 row_mask:0xf bank_mask:0xf
    buffer_load_ubyte v15, off, s[32:35], 0
    buffer_load_ubyte v15, off, s[32:35], 0
    buffer_load_ubyte v15, off, s[32:35], 0
    buffer_load_ubyte v15, off, s[32:35], 0
    s_cbranch_scc1 L_ev6
L_dr7:
    s_bitcmp1_b32 s52, 7
    ds_write_b32 v10, v6 offset:48
    s_waitcnt vmcnt(12)
    v_smfmac_f32_16x16x64_bf16 v[16:19], v[28:31], v[160:167], v14
    v_and_b32_dpp v24, v35, v12 row_newbcast:0 row_mask:0xf bank_mask:0xf
    v_and_b32_dpp v25, v35, v13 row_newbcast:0 row_mask:0xf bank_mask:0xf
    v_smfmac_f32_16x16x64_bf16 v[20:23], v[28:31], v[168:175], v14
    v_and_b32_dpp v26, v35, v12 row_newbcast:1 row_mask:0xf bank_mask:0xf
    v_and_b32_dpp v27, v35, v13 row_newbcast:1 row_mask:0xf bank_mask:0xf
    buffer_load_ubyte v15, off, s[32:35], 0
    buffer_load_ubyte v15, off, s[32:35], 0
    buffer_load_ubyte v15, off, s[32:35], 0
    buffer_load_ubyte v15, off, s[32:35], 0
    s_cbranch_scc1 L_ev7
L_dr8:
    v_mov_b64 v[32:33], v[34:35]
    v_mov_b64 v[34:35], v[36:37]
    v_mov_b64 v[36:37], v[38:39]
    s_lshr_b32 s52, s52, 8
    s_lshr_b32 s53, s53, 8
    s_lshr_b32 s56, s56, 8
    s_branch L_dr0
L_ev0:
    s_and_b32 s65, s57, 15
    v_cmp_ge_u32 s[66:67], s65, v4
    v_cmp_gt_u32 s[68:69], s65, v4
    s_bitcmp1_b32 s56, 0
    s_cselect_b64 s[62:63], s[70:71], s[62:63]
    v_cndmask_b32 v40, 0, v28, s[66:67]
    v_cndmask_b32 v41, 0, v29, s[66:67]
    v_cndmask_b32 v42, 0, v30, s[68:69]
    v_cndmask_b32 v43, 0, v31, s[68:69]
    s_mul_i32 s64, s63, 0
    s_bitcmp1_b32 s53, 0
    s_cbranch_scc0 L_evret
    s_waitcnt vmcnt(12)
    v_smfmac_f32_16x16x64_bf16 v[16:19], v[40:43], v[64:71], v14
    v_xor_b32 v28, v28, v40
    v_xor_b32 v29, v29, v41
    v_smfmac_f32_16x16x64_bf16 v[20:23], v[40:43], v[72:79], v14
    v_xor_b32 v30, v30, v42
    v_xor_b32 v31, v31, v43
    s_branch L_flush
L_ev1:
    s_and_b32 s65, s57, 15
    v_cmp_ge_u32 s[66:67], s65, v4
    v_cmp_gt_u32 s[68:69], s65, v4
    s_bitcmp1_b32 s56, 1
    s_cselect_b64 s[62:63], s[70:71], s[62:63]
    v_cndmask_b32 v40, 0, v24, s[66:67]
    v_cndmask_b32 v41, 0, v25, s[66:67]
    v_cndmask_b32 v42, 0, v26, s[68:69]
    v_cndmask_b32 v43, 0, v27, s[68:69]
    s_mul_i32 s64, s63, 1
    s_bitcmp1_b32 s53, 1
    s_cbranch_scc0 L_evret
    s_waitcnt vmcnt(12)
    v_smfmac_f32_16x16x64_bf16 v[16:19], v[40:43], v[80:87], v14
    v_xor_b32 v24, v24, v40
    v_xor_b32 v25, v25, v41
    v_smfmac_f32_16x16x64_bf16 v[20:23], v[40:43], v[88:95], v14
    v_xor_b32 v26, v26, v42
    v_xor_b32 v27, v27, v43
    s_branch L_flush
L_ev2:
    s_and_b32 s65, s57, 15
    v_cmp_ge_u32 s[66:67], s65, v4
    v_cmp_gt_u32 s[68:69], s65, v4
    s_bitcmp1_b32 s56, 2
    s_cselect_b64 s[62:63], s[70:71], s[62:63]
    v_cndmask_b32 v40, 0, v28, s[66:67]
    v_cndmask_b32 v41, 0, v29, s[66:67]
    v_cndmask_b32 v42, 0, v30, s[68:69]
    v_cndmask_b32 v43, 0, v31, s[68:69]
    s_mul_i32 s64, s63, 2
    s_bitcmp1_b32 s53, 2
    s_cbranch_scc0 L_evret
    s_waitcnt vmcnt(12)
    v_smfmac_f32_16x16x64_bf16 v[16:19], v[40:43], v[96:103], v14
    v_xor_b32 v28, v28, v40
    v_xor_b32 v29, v29, v41
    v_smfmac_f32_16x16x64_bf16 v[20:23], v[40:43], v[104:111], v14
    v_xor_b32 v30, v30, v42
    v_xor_b32 v31, v31, v43
    s_branch L_flush
L_ev3:
    s_and_b32 s65, s57, 15
    v_cmp_ge_u32 s[66:67], s65, v4
    v_cmp_gt_u32 s[68:69], s65, v4
    s_bitcmp1_b32 s56, 3
    s_cselect_b64 s[62:63], s[70:71], s[62:63]
    v_cndmask_b32 v40, 0, v24, s[66:67]
    v_cndmask_b32 v41, 0, v25, s[66:67]
    v_cndmask_b32 v42, 0, v26, s[68:69]
    v_cndmask_b32 v43, 0, v27, s[68:69]
    s_mul_i32 s64, s63, 3
    s_bitcmp1_b32 s53, 3
    s_cbranch_scc0 L_evret
    s_waitcnt vmcnt(12)
    v_smfmac_f32_16x16x64_bf16 v[16:19], v[40:43], v[112:119], v14
    v_xor_b32 v24, v24, v40
    v_xor_b32 v25, v25, v41
    v_smfmac_f32_16x16x64_bf16 v[20:23], v[40:43], v[120:127], v14
    v_xor_b32 v26, v26, v42
    v_xor_b32 v27, v27, v43
    s_branch L_flush
L_ev4:
    s_and_b32 s65, s57, 15
    v_cmp_ge_u32 s[66:67], s65, v4
    v_cmp_gt_u32 s[68:69], s65, v4
    s_bitcmp1_b32 s56, 4
    s_cselect_b64 s[62:63], s[70:71], s[62:63]
    v_cndmask_b32 v40, 0, v28, s[66:67]
    v_cndmask_b32 v41, 0, v29, s[66:67]
    v_cndmask_b32 v42, 0, v30, s[68:69]
    v_cndmask_b32 v43, 0, v31, s[68:69]
    s_mul_i32 s64, s63, 4
    s_bitcmp1_b32 s53, 4
    s_cbranch_scc0 L_evret
    s_waitcnt vmcnt(12)
    v_smfmac_f32_16x16x64_bf16 v[16:19], v[40:43], v[128:135], v14
    v_xor_b32 v28, v28, v40
    v_xor_b32 v29, v29, v41
    v_smfmac_f32_16x16x64_bf16 v[20:23], v[40:43], v[136:143], v14
    v_xor_b32 v30, v30, v42
    v_xor_b32 v31, v31, v43
    s_branch L_flush
L_ev5:
    s_and_b32 s65, s57, 15
    v_cmp_ge_u32 s[66:67], s65, v4
    v_cmp_gt_u32 s[68:69], s65, v4
    s_bitcmp1_b32 s56, 5
    s_cselect_b64 s[62:63], s[70:71], s[62:63]
    v_cndmask_b32 v40, 0, v24, s[66:67]
    v_cndmask_b32 v41, 0, v25, s[66:67]
    v_cndmask_b32 v42, 0, v26, s[68:69]
    v_cndmask_b32 v43, 0, v27, s[68:69]
    s_mul_i32 s64, s63, 5
    s_bitcmp1_b32 s53, 5
    s_cbranch_scc0 L_evret
    s_waitcnt vmcnt(12)
    v_smfmac_f32_16x16x64_bf16 v[16:19], v[40:43], v[144:151], v14
    v_xor_b32 v24, v24, v40
    v_xor_b32 v25, v25, v41
    v_smfmac_f32_16x16x64_bf16 v[20:23], v[40:43], v[152:159], v14
    v_xor_b32 v26, v26, v42
    v_xor_b32 v27, v27, v43
    s_branch L_flush
L_ev6:
    s_and_b32 s65, s57, 15
    v_cmp_ge_u32 s[66:67], s65, v4
    v_cmp_gt_u32 s[68:69], s65, v4
    s_bitcmp1_b32 s56, 6
    s_cselect_b64 s[62:63], s[70:71], s[62:63]
    v_cndmask_b32 v40, 0, v28, s[66:67]
    v_cndmask_b32 v41, 0, v29, s[66:67]
    v_cndmask_b32 v42, 0, v30, s[68:69]
    v_cndmask_b32 v43, 0, v31, s[68:69]
    s_mul_i32 s64, s63, 6
    s_bitcmp1_b32 s53, 6
    s_cbranch_scc0 L_evret
    s_waitcnt vmcnt(12)
    v_smfmac_f32_16x16x64_bf16 v[16:19], v[40:43], v[160:167], v14
    v_xor_b32 v28, v28, v40
    v_xor_b32 v29, v29, v41
    v_smfmac_f32_16x16x64_bf16 v[20:23], v[40:43], v[168:175], v14
    v_xor_b32 v30, v30, v42
    v_xor_b32 v31, v31, v43
    s_branch L_flush
L_ev7:
    s_and_b32 s65, s57, 15
    v_cmp_ge_u32 s[66:67], s65, v4
    v_cmp_gt_u32 s[68:69], s65, v4
    s_bitcmp1_b32 s56, 7
    s_cselect_b64 s[62:63], s[70:71], s[62:63]
    v_cndmask_b32 v40, 0, v24, s[66:67]
    v_cndmask_b32 v41, 0, v25, s[66:67]
    v_cndmask_b32 v42, 0, v26, s[68:69]
    v_cndmask_b32 v43, 0, v27, s[68:69]
    s_mul_i32 s64, s63, 7
    s_bitcmp1_b32 s53, 7
    s_cbranch_scc0 L_evret
    s_waitcnt vmcnt(12)
    v_smfmac_f32_16x16x64_bf16 v[16:19], v[40:43], v[48:55], v14
    v_xor_b32 v24, v24, v40
    v_xor_b32 v25, v25, v41
    v_smfmac_f32_16x16x64_bf16 v[20:23], v[40:43], v[56:63], v14
    v_xor_b32 v26, v26, v42
    v_xor_b32 v27, v27, v43
    s_nop 0
L_flush:
    s_lshr_b32 s57, s57, 4
    s_cmp_eq_u32 s26, 4
    v_add_u32 v1, 1, v1
    v_mul_f32 v40, v177, v16
    v_mul_f32 v41, v177, v17
    v_mul_f32 v42, v177, v18
    v_mul_f32 v43, v177, v19
    v_cvt_pk_bf16_f32 v40, v40, v41
    v_cvt_pk_bf16_f32 v41, v42, v43
    ds_write_b64 v176, v[40:41] offset:41984
    v_mul_f32 v44, v177, v20
    v_mul_f32 v45, v177, v21
    v_mul_f32 v46, v177, v22
    v_mul_f32 v47, v177, v23
    v_cvt_pk_bf16_f32 v44, v44, v45
    v_cvt_pk_bf16_f32 v45, v46, v47
    ds_write_b64 v176, v[44:45] offset:42240
    ds_write_b32 v10, v1 offset:32
    s_cbranch_scc1 L_sdone
    v_mov_b64 v[16:17], 0
    v_mov_b64 v[18:19], 0
    v_mov_b64 v[20:21], 0
    v_mov_b64 v[22:23], 0
    s_add_u32 s26, s26, 1
    v_mov_b64 v[176:177], v[178:179]
    v_mov_b64 v[178:179], v[180:181]
    v_mov_b64 v[180:181], v[182:183]
    v_mov_b64 v[182:183], v[184:185]
L_evret:
    s_add_u32 s64, s64, s62
    s_add_u32 s54, s72, s64
    s_addc_u32 s55, s73, 0
    s_setpc_b64 s[54:55]
L_slow:
    s_mov_b32 s62, L_slow_pair-L_anc
    v_mbcnt_lo_u32_b32 v200, -1, 0
    v_mbcnt_hi_u32_b32 v200, -1, v200
L_slow_pair:
    v_lshlrev_b32 v201, 2, v200
    s_mul_i32 s70, s1, 40
    s_lshl1_add_u32 s70, s24, s70
    s_mov_b32 s71, 0
    s_mov_b32 s24, s20
    s_mov_b32 s20, s21
    s_mov_b32 s21, s22
    s_mov_b32 s22, s23
L_slow_chunk:
    global_load_dword v202, v201, s[8:9]
    global_load_dword v203, v201, s[6:7]
    v_add_u32 v201, 0x100, v201
    s_waitcnt vmcnt(0)
    v_subrev_u32 v202, s70, v202
    v_cmp_gt_u32 vcc, 2, v202
    v_lshlrev_b32 v204, 1, v203
    ds_read_u16 v204, v204 offset:62464
    s_mov_b64 s[76:77], vcc
    v_lshlrev_b32 v202, 4, v202
    v_lshlrev_b32 v203, 9, v203
    s_waitcnt lgkmcnt(0)
    v_lshlrev_b32 v204, v202, v204
L_slow_edge:
    s_cmp_eq_u64 s[76:77], 0
    s_cbranch_scc1 L_slow_next
    s_ff1_i32_b64 s74, s[76:77]
    s_bitset0_b64 s[76:77], s74
    v_readlane_b32 s64, v203, s74
    v_readlane_b32 s65, v204, s74
    v_mov_b32 v205, 0
    v_mov_b32 v11, 2147483648
    s_mov_b64 exec, 0xffff
    v_mov_b32 v205, s65
    v_add_u32 v11, s64, v7
    s_mov_b64 exec, -1
    buffer_load_dwordx4 v[208:211], v11, s[32:35], 0 offen
    buffer_load_dwordx4 v[212:215], v11, s[32:35], 0 offen offset:256
    v_and_b32 v24, v205, v12
    v_and_b32 v25, v205, v13
    s_nop 0
    s_waitcnt vmcnt(0)
    v_smfmac_f32_16x16x32_bf16 v[16:19], v[24:25], v[208:211], v14
    v_smfmac_f32_16x16x32_bf16 v[20:23], v[24:25], v[212:215], v14
    s_branch L_slow_edge
L_slow_next:
    s_add_u32 s71, s71, 1
    s_cmp_lt_u32 s71, 2500
    s_cbranch_scc1 L_slow_chunk
    s_mov_b32 s64, 0
    s_nop 3
    s_branch L_flush
L_sdone:
    ds_write_b32 v10, v6 offset:48
    s_endpgm
L_retry_7:
    s_sub_u32 s100, s100, 1
    s_cbranch_scc1 L_end
    s_sleep 1
    s_branch L_spin_6
L_retry_11:
    s_sub_u32 s100, s100, 1
    s_cbranch_scc1 L_end
    s_sleep 1
    s_branch L_spin_10
L_retry_12:
    s_sub_u32 s100, s100, 1
    s_cbranch_scc1 L_end
    s_sleep 4
    s_branch L_ipoll_9
L_retry_14:
    s_sub_u32 s100, s100, 1
    s_cbranch_scc1 L_end
    s_sleep 1
    s_branch L_spin_13
L_mrole_1:
    v_lshlrev_b32 v43, 4, v4
    v_lshl_add_u32 v46, v46, 9, v43
    s_bfe_u32 s64, s68, 0x30002
    s_lshl_b32 s64, s64, 14
    s_lshr_b32 s65, s68, 5
    s_lshl_b32 s65, s65, 15
    s_bfe_u32 s66, s68, 0x10001
    s_lshl_b32 s66, s66, 14
    s_add_u32 s65, s65, s66
    s_and_b32 s66, s68, 1
    s_lshl_b32 s66, s66, 11
    s_add_u32 s65, s65, s66
    s_lshr_b32 s66, s2, 2
    s_xor_b32 s66, s66, s2
    s_and_b32 s66, s66, 0x30
    s_lshl_b32 s66, s66, 3
    v_add_u32 v46, s66, v46
    v_add_u32 v44, s64, v46
    v_add_u32 v45, s65, v46
    s_cmp_lg_u32 s31, 0
    s_waitcnt lgkmcnt(0)
    global_load_dword v0, v42, s[10:11]
    s_cbranch_scc1 L_roled_2
    global_load_dwordx4 v[48:51], v45, s[20:21] offset:0
    global_load_dwordx4 v[52:55], v44, s[18:19] offset:0
    global_load_dwordx4 v[56:59], v44, s[18:19] offset:2048
    global_load_dwordx4 v[60:63], v45, s[20:21] offset:64
    global_load_dwordx4 v[64:67], v44, s[18:19] offset:64
    global_load_dwordx4 v[68:71], v44, s[18:19] offset:2112
    v_xor_b32 v44, 128, v44
    v_xor_b32 v45, 128, v45
    global_load_dwordx4 v[72:75], v45, s[20:21] offset:0
    global_load_dwordx4 v[76:79], v44, s[18:19] offset:0
    global_load_dwordx4 v[80:83], v44, s[18:19] offset:2048
    global_load_dwordx4 v[84:87], v45, s[20:21] offset:64
    global_load_dwordx4 v[88:91], v44, s[18:19] offset:64
    global_load_dwordx4 v[92:95], v44, s[18:19] offset:2112
    v_xor_b32 v44, 384, v44
    v_xor_b32 v45, 384, v45
    global_load_dwordx4 v[96:99], v45, s[20:21] offset:0
    global_load_dwordx4 v[100:103], v44, s[18:19] offset:0
    global_load_dwordx4 v[104:107], v44, s[18:19] offset:2048
    global_load_dwordx4 v[108:111], v45, s[20:21] offset:64
    global_load_dwordx4 v[112:115], v44, s[18:19] offset:64
    global_load_dwordx4 v[116:119], v44, s[18:19] offset:2112
    v_xor_b32 v44, 128, v44
    v_xor_b32 v45, 128, v45
    global_load_dwordx4 v[120:123], v45, s[20:21] offset:0
    global_load_dwordx4 v[124:127], v44, s[18:19] offset:0
    global_load_dwordx4 v[128:131], v44, s[18:19] offset:2048
    global_load_dwordx4 v[132:135], v45, s[20:21] offset:64
    global_load_dwordx4 v[136:139], v44, s[18:19] offset:64
    global_load_dwordx4 v[140:143], v44, s[18:19] offset:2112
    s_branch L_roled_2
L_mwork_4:
    s_cmp_lg_u32 s31, 0
    s_cbranch_scc1 L_worked_5_w
    s_waitcnt vmcnt(21)
    v_mfma_f32_16x16x32_bf16 v[16:19], v[52:55], v[48:51], 0
    v_mfma_f32_16x16x32_bf16 v[20:23], v[56:59], v[48:51], 0
    s_waitcnt vmcnt(18)
    v_mfma_f32_16x16x32_bf16 v[16:19], v[64:67], v[60:63], v[16:19]
    v_mfma_f32_16x16x32_bf16 v[20:23], v[68:71], v[60:63], v[20:23]
    s_waitcnt vmcnt(15)
    v_mfma_f32_16x16x32_bf16 v[16:19], v[76:79], v[72:75], v[16:19]
    v_mfma_f32_16x16x32_bf16 v[20:23], v[80:83], v[72:75], v[20:23]
    s_waitcnt vmcnt(12)
    v_mfma_f32_16x16x32_bf16 v[16:19], v[88:91], v[84:87], v[16:19]
    v_mfma_f32_16x16x32_bf16 v[20:23], v[92:95], v[84:87], v[20:23]
    s_waitcnt vmcnt(9)
    v_mfma_f32_16x16x32_bf16 v[16:19], v[100:103], v[96:99], v[16:19]
    v_mfma_f32_16x16x32_bf16 v[20:23], v[104:107], v[96:99], v[20:23]
    s_waitcnt vmcnt(6)
    v_mfma_f32_16x16x32_bf16 v[16:19], v[112:115], v[108:111], v[16:19]
    v_mfma_f32_16x16x32_bf16 v[20:23], v[116:119], v[108:111], v[20:23]
    s_waitcnt vmcnt(3)
    v_mfma_f32_16x16x32_bf16 v[16:19], v[124:127], v[120:123], v[16:19]
    v_mfma_f32_16x16x32_bf16 v[20:23], v[128:131], v[120:123], v[20:23]
    s_waitcnt vmcnt(0)
    v_mfma_f32_16x16x32_bf16 v[16:19], v[136:139], v[132:135], v[16:19]
    v_mfma_f32_16x16x32_bf16 v[20:23], v[140:143], v[132:135], v[20:23]
    s_lshl_b32 s64, s27, 10
    s_add_u32 s64, s64, 65536
    v_lshl_add_u32 v40, v2, 4, s64
    s_lshl_b32 s64, s27, 2
    s_add_u32 s64, s64, 4096
    v_lshl_add_u32 v41, v2, 9, s64
    v_mov_b32 v42, s30
    s_nop 1
    v_cvt_pk_bf16_f32 v44, v16, v17
    v_cvt_pk_bf16_f32 v45, v18, v19
    v_cvt_pk_bf16_f32 v46, v20, v21
    v_cvt_pk_bf16_f32 v47, v22, v23
    global_store_dwordx4 v40, v[44:47], s[28:29] sc1
    s_mov_b32 s26, 1
    s_waitcnt vmcnt(1)
    s_branch L_worked_5
L_worked_5_w:
    s_waitcnt vmcnt(0)
    s_branch L_worked_5
L_gemm:
    v_lshrrev_b32 v0, 5, v2
    s_lshl_b32 s64, s31, 1
    v_add_u32 v0, s64, v0
    v_and_b32 v1, 31, v2
    v_xor_b32 v1, v1, v0
    v_lshlrev_b32 v1, 4, v1
    v_lshl_add_u32 v0, v0, 9, v1
    v_xor_b32 v1, 0x80, v0
    v_lshrrev_b32 v13, 3, v2
    v_lshrrev_b32 v15, 2, v2
    v_and_b32 v15, 4, v15
    v_and_b32 v14, 7, v2
    v_xor_b32 v15, v15, v14
    v_lshlrev_b32 v15, 4, v15
    v_lshl_add_u32 v13, v13, 9, v15
    s_lshr_b32 s67, s2, 3
    s_and_b32 s67, s67, 7
    s_lshl_b32 s64, s31, 7
    s_lshl_b32 s65, s67, 14
    s_or_b32 s64, s64, s65
    v_add_u32 v13, s64, v13
    s_mul_i32 s65, s1, 20480
    s_lshl_b32 s66, s31, 10
    s_lshl_b32 s70, s31, 14
    s_add_u32 s70, s70, 82944
    s_mov_b32 s71, 3072
    s_mov_b32 s72, 6144
    s_mov_b32 s73, 9216
    s_waitcnt lgkmcnt(0)
    s_mov_b32 s32, s4
    s_and_b32 s33, s5, 0xffff
    s_mov_b32 s34, 5120000
    s_mov_b32 s35, 0x20000
    s_mov_b32 s36, s22
    s_and_b32 s37, s23, 0xffff
    s_mov_b32 s38, 131072
    s_mov_b32 s39, 0x20000
    s_bitcmp1_b32 s2, 3
    s_cbranch_scc0 L_touched_15
    s_lshr_b32 s64, s2, 4
    s_lshl_b32 s64, s64, 3
    s_and_b32 s68, s2, 7
    s_or_b32 s64, s64, s68
    s_lshl_b32 s64, s64, 10
    v_lshl_add_u32 v16, v2, 4, s64
    s_cmp_eq_u32 s31, 1
    s_cselect_b64 s[68:69], s[22:23], s[16:17]
    s_cmp_eq_u32 s31, 2
    s_cselect_b64 s[68:69], s[18:19], s[68:69]
    s_cmp_eq_u32 s31, 3
    s_cselect_b64 s[68:69], s[20:21], s[68:69]
    global_load_dwordx4 v[20:23], v16, s[68:69]
L_touched_15:
    s_cmp_ge_u32 s2, 250
    s_cbranch_scc1 L_end
    s_mul_i32 s64, s1, 20480
    s_mov_b32 s76, 0
    s_cmp_eq_u32 s31, 0
    s_cselect_b64 s[68:69], s[24:25], s[16:17]
    s_cselect_b32 s64, s64, 0
    s_cmp_eq_u32 s31, 2
    s_cselect_b64 s[68:69], s[28:29], s[68:69]
    s_cselect_b32 s64, 0x800, s64
    s_cselect_b32 s76, 0x2f8000, s76
    s_cmp_eq_u32 s31, 3
    s_cselect_b64 s[68:69], s[4:5], s[68:69]
    s_cselect_b32 s76, 0x200000, s76
    s_cselect_b32 s77, 2, 1
    v_min_u32 v17, s77, v2
    v_mul_lo_u32 v17, v17, s76
    v_add_u32 v17, s64, v17
    global_load_dword v24, v17, s[68:69]
    s_add_u32 m0, s66, 1024
    s_nop 0
    buffer_load_dwordx4 v0, s[32:35], s65 offen lds
    s_add_u32 m0, s66, 5120
    s_add_u32 s65, s65, 4096
    buffer_load_dwordx4 v1, s[32:35], s65 offen lds
    s_add_u32 m0, s66, 9216
    s_add_u32 s65, s65, 4096
    buffer_load_dwordx4 v0, s[32:35], s65 offen lds
    s_add_u32 m0, s66, 13312
    s_add_u32 s65, s65, 4096
    buffer_load_dwordx4 v1, s[32:35], s65 offen lds
    s_add_u32 m0, s66, 17408
    s_add_u32 s65, s65, 4096
    buffer_load_dwordx4 v0, s[32:35], s65 offen lds
    s_barrier
    s_setprio 2
    s_add_u32 m0, s70, 0
    s_nop 0
    buffer_load_dwordx4 v13, s[36:39], 0 offen offset:0 lds
    buffer_load_dwordx4 v13, s[36:39], s71 offen offset:1024 lds
    buffer_load_dwordx4 v13, s[36:39], s72 offen offset:2048 lds
    buffer_load_dwordx4 v13, s[36:39], s73 offen offset:3072 lds
    v_xor_b32 v13, 16384, v13
    s_mov_b32 s40, s16
    s_and_b32 s41, s17, 0xffff
    s_mov_b32 s42, 131072
    s_mov_b32 s43, 0x20000
    s_mov_b32 s44, s28
    s_and_b32 s45, s29, 0xffff
    s_mov_b32 s46, 1048576
    s_mov_b32 s47, 0x20000
    s_mov_b32 s48, s24
    s_and_b32 s49, s25, 0xffff
    s_mov_b32 s50, 5120000
    s_mov_b32 s51, 0x20000
    v_xor_b32 v15, v4, v3
    v_lshlrev_b32 v15, 4, v15
    v_lshl_add_u32 v7, v3, 9, v15
    s_lshl_b32 s64, s67, 6
    v_xor_b32 v7, s64, v7
    v_xor_b32 v8, 64, v7
    v_xor_b32 v9, 0x80, v7
    v_xor_b32 v10, 0xc0, v7
    v_lshrrev_b32 v15, 2, v3
    v_lshl_add_u32 v15, v4, 3, v15
    v_lshlrev_b32 v15, 7, v15
    v_lshrrev_b32 v14, 1, v3
    v_and_b32 v14, 4, v14
    v_and_b32 v0, 3, v3
    v_xor_b32 v14, v14, v0
    v_lshl_add_u32 v15, v14, 4, v15
    v_add_u32 v11, s70, v15
    v_xor_b32 v12, 64, v11
    v_and_b32 v0, 31, v2
    v_lshlrev_b32 v0, 2, v0
    s_and_b32 s64, s2, 15
    s_lshl_b32 s64, s64, 9
    s_lshl_b32 s65, s31, 7
    s_add_u32 s64, s64, s65
    s_add_u32 s74, s64, 4096
    v_lshlrev_b32 v14, 4, v2
    s_lshl_b32 s75, s31, 15
    s_lshl_b32 s64, s67, 12
    s_or_b32 s75, s75, s64
    s_add_u32 s75, s75, 65536
    s_add_u32 m0, s70, 4096
    s_waitcnt vmcnt(9)
    buffer_load_dwordx4 v13, s[36:39], 0 offen offset:0 lds
    s_waitcnt vmcnt(9)
    buffer_load_dwordx4 v13, s[36:39], s71 offen offset:1024 lds
    s_waitcnt vmcnt(9)
    buffer_load_dwordx4 v13, s[36:39], s72 offen offset:2048 lds
    s_waitcnt vmcnt(9)
    buffer_load_dwordx4 v13, s[36:39], s73 offen offset:3072 lds
    v_xor_b32 v13, 49152, v13
    s_add_u32 m0, s70, 8192
    s_waitcnt vmcnt(9)
    buffer_load_dwordx4 v13, s[36:39], 0 offen offset:0 lds
    s_waitcnt vmcnt(9)
    buffer_load_dwordx4 v13, s[36:39], s71 offen offset:1024 lds
    s_waitcnt vmcnt(9)
    buffer_load_dwordx4 v13, s[36:39], s72 offen offset:2048 lds
    s_waitcnt vmcnt(9)
    buffer_load_dwordx4 v13, s[36:39], s73 offen offset:3072 lds
    v_xor_b32 v13, 16384, v13
    s_add_u32 m0, s70, 12288
    s_waitcnt vmcnt(4)
    buffer_load_dwordx4 v13, s[36:39], 0 offen offset:0 lds
    s_waitcnt vmcnt(4)
    buffer_load_dwordx4 v13, s[36:39], s71 offen offset:1024 lds
    s_waitcnt vmcnt(4)
    buffer_load_dwordx4 v13, s[36:39], s72 offen offset:2048 lds
    s_waitcnt vmcnt(4)
    buffer_load_dwordx4 v13, s[36:39], s73 offen offset:3072 lds
    v_xor_b32 v13, 114688, v13
    s_waitcnt vmcnt(12)
    s_waitcnt lgkmcnt(0)
    s_mov_b64 exec, 1
    ds_add_u32 v5, v6 offset:4
    s_mov_b64 exec, -1
    ds_read_b64_tr_b16 v[128:129], v11 offset:0
    ds_read_b64_tr_b16 v[130:131], v11 offset:512
    ds_read_b64_tr_b16 v[132:133], v11 offset:8
    ds_read_b64_tr_b16 v[134:135], v11 offset:520
    ds_read_b64_tr_b16 v[136:137], v12 offset:0
    ds_read_b64_tr_b16 v[138:139], v12 offset:512
    ds_read_b64_tr_b16 v[140:141], v12 offset:8
    ds_read_b64_tr_b16 v[142:143], v12 offset:520
    s_waitcnt lgkmcnt(0)
    s_add_u32 m0, s70, 0
    s_waitcnt vmcnt(4)
    buffer_load_dwordx4 v13, s[36:39], 0 offen offset:0 lds
    s_waitcnt vmcnt(4)
    buffer_load_dwordx4 v13, s[36:39], s71 offen offset:1024 lds
    s_waitcnt vmcnt(4)
    buffer_load_dwordx4 v13, s[36:39], s72 offen offset:2048 lds
    s_waitcnt vmcnt(4)
    buffer_load_dwordx4 v13, s[36:39], s73 offen offset:3072 lds
    v_xor_b32 v13, 16384, v13
    s_waitcnt vmcnt(12)
    ds_read_b64_tr_b16 v[144:145], v11 offset:4096
    ds_read_b64_tr_b16 v[146:147], v11 offset:4608
    ds_read_b64_tr_b16 v[148:149], v11 offset:4104
    ds_read_b64_tr_b16 v[150:151], v11 offset:4616
    ds_read_b64_tr_b16 v[152:153], v12 offset:4096
    ds_read_b64_tr_b16 v[154:155], v12 offset:4608
    ds_read_b64_tr_b16 v[156:157], v12 offset:4104
    ds_read_b64_tr_b16 v[158:159], v12 offset:4616
    s_waitcnt lgkmcnt(0)
    s_add_u32 m0, s70, 4096
    s_waitcnt vmcnt(4)
    buffer_load_dwordx4 v13, s[36:39], 0 offen offset:0 lds
    s_waitcnt vmcnt(4)
    buffer_load_dwordx4 v13, s[36:39], s71 offen offset:1024 lds
    s_waitcnt vmcnt(4)
    buffer_load_dwordx4 v13, s[36:39], s72 offen offset:2048 lds
    s_waitcnt vmcnt(4)
    buffer_load_dwordx4 v13, s[36:39], s73 offen offset:3072 lds
    v_xor_b32 v13, 49152, v13
    s_waitcnt vmcnt(12)
    ds_read_b64_tr_b16 v[160:161], v11 offset:8192
    ds_read_b64_tr_b16 v[162:163], v11 offset:8704
    ds_read_b64_tr_b16 v[164:165], v11 offset:8200
    ds_read_b64_tr_b16 v[166:167], v11 offset:8712
    ds_read_b64_tr_b16 v[168:169], v12 offset:8192
    ds_read_b64_tr_b16 v[170:171], v12 offset:8704
    ds_read_b64_tr_b16 v[172:173], v12 offset:8200
    ds_read_b64_tr_b16 v[174:175], v12 offset:8712
    s_waitcnt lgkmcnt(0)
    s_add_u32 m0, s70, 8192
    s_waitcnt vmcnt(4)
    buffer_load_dwordx4 v13, s[36:39], 0 offen offset:0 lds
    s_waitcnt vmcnt(4)
    buffer_load_dwordx4 v13, s[36:39], s71 offen offset:1024 lds
    s_waitcnt vmcnt(4)
    buffer_load_dwordx4 v13, s[36:39], s72 offen offset:2048 lds
    s_waitcnt vmcnt(4)
    buffer_load_dwordx4 v13, s[36:39], s73 offen offset:3072 lds
    v_xor_b32 v13, 16384, v13
    buffer_load_dword v1, v0, s[44:47], s74 offen sc1
    s_waitcnt vmcnt(13)
    ds_read_b64_tr_b16 v[176:177], v11 offset:12288
    ds_read_b64_tr_b16 v[178:179], v11 offset:12800
    ds_read_b64_tr_b16 v[180:181], v11 offset:12296
    ds_read_b64_tr_b16 v[182:183], v11 offset:12808
    ds_read_b64_tr_b16 v[184:185], v12 offset:12288
    ds_read_b64_tr_b16 v[186:187], v12 offset:12800
    ds_read_b64_tr_b16 v[188:189], v12 offset:12296
    ds_read_b64_tr_b16 v[190:191], v12 offset:12808
    s_waitcnt lgkmcnt(0)
    s_add_u32 m0, s70, 12288
    s_nop 0
    buffer_load_dwordx4 v13, s[36:39], 0 offen offset:0 lds
    buffer_load_dwordx4 v13, s[36:39], s71 offen offset:1024 lds
    buffer_load_dwordx4 v13, s[36:39], s72 offen offset:2048 lds
    buffer_load_dwordx4 v13, s[36:39], s73 offen offset:3072 lds
    v_xor_b32 v13, 114688, v13
    s_waitcnt vmcnt(13)
    ds_read_b64_tr_b16 v[192:193], v11 offset:0
    ds_read_b64_tr_b16 v[194:195], v11 offset:512
    ds_read_b64_tr_b16 v[196:197], v11 offset:8
    ds_read_b64_tr_b16 v[198:199], v11 offset:520
    ds_read_b64_tr_b16 v[200:201], v12 offset:0
    ds_read_b64_tr_b16 v[202:203], v12 offset:512
    ds_read_b64_tr_b16 v[204:205], v12 offset:8
    ds_read_b64_tr_b16 v[206:207], v12 offset:520
    s_waitcnt vmcnt(9)
    ds_read_b64_tr_b16 v[208:209], v11 offset:4096
    ds_read_b64_tr_b16 v[210:211], v11 offset:4608
    ds_read_b64_tr_b16 v[212:213], v11 offset:4104
    ds_read_b64_tr_b16 v[214:215], v11 offset:4616
    ds_read_b64_tr_b16 v[216:217], v12 offset:4096
    ds_read_b64_tr_b16 v[218:219], v12 offset:4608
    ds_read_b64_tr_b16 v[220:221], v12 offset:4104
    ds_read_b64_tr_b16 v[222:223], v12 offset:4616
    s_waitcnt vmcnt(5)
    ds_read_b64_tr_b16 v[224:225], v11 offset:8192
    ds_read_b64_tr_b16 v[226:227], v11 offset:8704
    ds_read_b64_tr_b16 v[228:229], v11 offset:8200
    ds_read_b64_tr_b16 v[230:231], v11 offset:8712
    ds_read_b64_tr_b16 v[232:233], v12 offset:8192
    ds_read_b64_tr_b16 v[234:235], v12 offset:8704
    ds_read_b64_tr_b16 v[236:237], v12 offset:8200
    ds_read_b64_tr_b16 v[238:239], v12 offset:8712
    s_waitcnt vmcnt(4)
L_spin_17:
    ds_read_b128 v[16:19], v5
    s_waitcnt lgkmcnt(0)
    v_readfirstlane_b32 s101, v18
    v_readfirstlane_b32 s30, v19
    s_cmp_ge_u32 s101, 1
    s_cbranch_scc0 L_retry_18
L_mchk_16:
    v_cmp_ne_u32 vcc, s30, v1
    s_cbranch_vccnz L_mre_19
    buffer_load_dwordx4 v[40:43], v14, s[44:47], s75 offen offset:0 sc1
    buffer_load_dwordx4 v[44:47], v14, s[44:47], s75 offen offset:1024 sc1
    buffer_load_dwordx4 v[48:51], v14, s[44:47], s75 offen offset:2048 sc1
    buffer_load_dwordx4 v[52:55], v14, s[44:47], s75 offen offset:3072 sc1
    s_xor_b32 s75, s75, 4096
    buffer_load_dwordx4 v[56:59], v14, s[44:47], s75 offen offset:0 sc1
    buffer_load_dwordx4 v[60:63], v14, s[44:47], s75 offen offset:1024 sc1
    buffer_load_dwordx4 v[64:67], v14, s[44:47], s75 offen offset:2048 sc1
    buffer_load_dwordx4 v[68:71], v14, s[44:47], s75 offen offset:3072 sc1
    s_xor_b32 s75, s75, 12288
    buffer_load_dwordx4 v[72:75], v14, s[44:47], s75 offen offset:0 sc1
    buffer_load_dwordx4 v[76:79], v14, s[44:47], s75 offen offset:1024 sc1
    s_waitcnt vmcnt(10)
    ds_read_b64_tr_b16 v[240:241], v11 offset:12288
    ds_read_b64_tr_b16 v[242:243], v11 offset:12800
    ds_read_b64_tr_b16 v[244:245], v11 offset:12296
    ds_read_b64_tr_b16 v[246:247], v11 offset:12808
    ds_read_b64_tr_b16 v[248:249], v12 offset:12288
    ds_read_b64_tr_b16 v[250:251], v12 offset:12800
    ds_read_b64_tr_b16 v[252:253], v12 offset:12296
    ds_read_b64_tr_b16 v[254:255], v12 offset:12808
L_spin_20:
    ds_read_b32 v15, v5 offset:4
    s_waitcnt lgkmcnt(0)
    v_readfirstlane_b32 s101, v15
    s_cmp_ge_u32 s101, 4
    s_cbranch_scc0 L_retry_21
    ds_read_b128 v[16:19], v7 offset:1024
    ds_read_b128 v[20:23], v7 offset:9216
    ds_read_b128 v[24:27], v7 offset:17408
    v_xor_b32 v7, 0x100, v7
    ds_read_b128 v[28:31], v8 offset:1024
    ds_read_b128 v[32:35], v8 offset:9216
    ds_read_b128 v[36:39], v8 offset:17408
    v_xor_b32 v8, 0x100, v8
    s_waitcnt lgkmcnt(3)
    s_waitcnt vmcnt(9)
    v_mfma_f32_16x16x32_bf16 v[80:83], v[40:43], v[16:19], 0
    v_mfma_f32_16x16x32_bf16 v[96:99], v[40:43], v[20:23], 0
    v_mfma_f32_16x16x32_bf16 v[112:115], v[40:43], v[24:27], 0
    buffer_load_dwordx4 v[40:43], v14, s[44:47], s75 offen offset:2048 sc1
    s_waitcnt vmcnt(9)
    v_mfma_f32_16x16x32_bf16 v[84:87], v[44:47], v[16:19], 0
    v_mfma_f32_16x16x32_bf16 v[100:103], v[44:47], v[20:23], 0
    v_mfma_f32_16x16x32_bf16 v[116:119], v[44:47], v[24:27], 0
    buffer_load_dwordx4 v[44:47], v14, s[44:47], s75 offen offset:3072 sc1
    s_xor_b32 s75, s75, 4096
    s_waitcnt vmcnt(9)
    v_mfma_f32_16x16x32_bf16 v[88:91], v[48:51], v[16:19], 0
    v_mfma_f32_16x16x32_bf16 v[104:107], v[48:51], v[20:23], 0
    v_mfma_f32_16x16x32_bf16 v[120:123], v[48:51], v[24:27], 0
    buffer_load_dwordx4 v[48:51], v14, s[44:47], s75 offen offset:0 sc1
    s_waitcnt vmcnt(9)
    v_mfma_f32_16x16x32_bf16 v[92:95], v[52:55], v[16:19], 0
    v_mfma_f32_16x16x32_bf16 v[108:111], v[52:55], v[20:23], 0
    v_mfma_f32_16x16x32_bf16 v[124:127], v[52:55], v[24:27], 0
    buffer_load_dwordx4 v[52:55], v14, s[44:47], s75 offen offset:1024 sc1
    ds_read_b128 v[16:19], v9 offset:1024
    ds_read_b128 v[20:23], v9 offset:9216
    ds_read_b128 v[24:27], v9 offset:17408
    v_xor_b32 v9, 0x100, v9
    s_waitcnt lgkmcnt(3)
    s_waitcnt vmcnt(9)
    v_mfma_f32_16x16x32_bf16 v[80:83], v[56:59], v[28:31], v[80:83]
    v_mfma_f32_16x16x32_bf16 v[96:99], v[56:59], v[32:35], v[96:99]
    v_mfma_f32_16x16x32_bf16 v[112:115], v[56:59], v[36:39], v[112:115]
    buffer_load_dwordx4 v[56:59], v14, s[44:47], s75 offen offset:2048 sc1
    s_waitcnt vmcnt(9)
    v_mfma_f32_16x16x32_bf16 v[84:87], v[60:63], v[28:31], v[84:87]
    v_mfma_f32_16x16x32_bf16 v[100:103], v[60:63], v[32:35], v[100:103]
    v_mfma_f32_16x16x32_bf16 v[116:119], v[60:63], v[36:39], v[116:119]
    buffer_load_dwordx4 v[60:63], v14, s[44:47], s75 offen offset:3072 sc1
    s_xor_b32 s75, s75, 28672
    s_waitcnt vmcnt(9)
    v_mfma_f32_16x16x32_bf16 v[88:91], v[64:67], v[28:31], v[88:91]
    v_mfma_f32_16x16x32_bf16 v[104:107], v[64:67], v[32:35], v[104:107]
    v_mfma_f32_16x16x32_bf16 v[120:123], v[64:67], v[36:39], v[120:123]
    buffer_load_dwordx4 v[64:67], v14, s[44:47], s75 offen offset:0 sc1
    s_waitcnt vmcnt(9)
    v_mfma_f32_16x16x32_bf16 v[92:95], v[68:71], v[28:31], v[92:95]
    v_mfma_f32_16x16x32_bf16 v[108:111], v[68:71], v[32:35], v[108:111]
    v_mfma_f32_16x16x32_bf16 v[124:127], v[68:71], v[36:39], v[124:127]
    buffer_load_dwordx4 v[68:71], v14, s[44:47], s75 offen offset:1024 sc1
    ds_read_b128 v[28:31], v10 offset:1024
    ds_read_b128 v[32:35], v10 offset:9216
    ds_read_b128 v[36:39], v10 offset:17408
    v_xor_b32 v10, 0x100, v10
    s_waitcnt lgkmcnt(3)
    s_waitcnt vmcnt(9)
    v_mfma_f32_16x16x32_bf16 v[80:83], v[72:75], v[16:19], v[80:83]
    v_mfma_f32_16x16x32_bf16 v[96:99], v[72:75], v[20:23], v[96:99]
    v_mfma_f32_16x16x32_bf16 v[112:115], v[72:75], v[24:27], v[112:115]
    buffer_load_dwordx4 v[72:75], v14, s[44:47], s75 offen offset:2048 sc1
    s_waitcnt vmcnt(9)
    v_mfma_f32_16x16x32_bf16 v[84:87], v[76:79], v[16:19], v[84:87]
    v_mfma_f32_16x16x32_bf16 v[100:103], v[76:79], v[20:23], v[100:103]
    v_mfma_f32_16x16x32_bf16 v[116:119], v[76:79], v[24:27], v[116:119]
    buffer_load_dwordx4 v[76:79], v14, s[44:47], s75 offen offset:3072 sc1
    s_xor_b32 s75, s75, 4096
    s_waitcnt vmcnt(9)
    v_mfma_f32_16x16x32_bf16 v[88:91], v[40:43], v[16:19], v[88:91]
    v_mfma_f32_16x16x32_bf16 v[104:107], v[40:43], v[20:23], v[104:107]
    v_mfma_f32_16x16x32_bf16 v[120:123], v[40:43], v[24:27], v[120:123]
    buffer_load_dwordx4 v[40:43], v14, s[44:47], s75 offen offset:0 sc1
    s_waitcnt vmcnt(9)
    v_mfma_f32_16x16x32_bf16 v[92:95], v[44:47], v[16:19], v[92:95]
    v_mfma_f32_16x16x32_bf16 v[108:111], v[44:47], v[20:23], v[108:111]
    v_mfma_f32_16x16x32_bf16 v[124:127], v[44:47], v[24:27], v[124:127]
    buffer_load_dwordx4 v[44:47], v14, s[44:47], s75 offen offset:1024 sc1
    ds_read_b128 v[16:19], v7 offset:1024
    ds_read_b128 v[20:23], v7 offset:9216
    ds_read_b128 v[24:27], v7 offset:17408
    v_xor_b32 v7, 0x100, v7
    s_waitcnt lgkmcnt(3)
    s_waitcnt vmcnt(9)
    v_mfma_f32_16x16x32_bf16 v[80:83], v[48:51], v[28:31], v[80:83]
    v_mfma_f32_16x16x32_bf16 v[96:99], v[48:51], v[32:35], v[96:99]
    v_mfma_f32_16x16x32_bf16 v[112:115], v[48:51], v[36:39], v[112:115]
    buffer_load_dwordx4 v[48:51], v14, s[44:47], s75 offen offset:2048 sc1
    s_waitcnt vmcnt(9)
    v_mfma_f32_16x16x32_bf16 v[84:87], v[52:55], v[28:31], v[84:87]
    v_mfma_f32_16x16x32_bf16 v[100:103], v[52:55], v[32:35], v[100:103]
    v_mfma_f32_16x16x32_bf16 v[116:119], v[52:55], v[36:39], v[116:119]
    buffer_load_dwordx4 v[52:55], v14, s[44:47], s75 offen offset:3072 sc1
    s_xor_b32 s75, s75, 12288
    s_waitcnt vmcnt(9)
    v_mfma_f32_16x16x32_bf16 v[88:91], v[56:59], v[28:31], v[88:91]
    v_mfma_f32_16x16x32_bf16 v[104:107], v[56:59], v[32:35], v[104:107]
    v_mfma_f32_16x16x32_bf16 v[120:123], v[56:59], v[36:39], v[120:123]
    buffer_load_dwordx4 v[56:59], v14, s[44:47], s75 offen offset:0 sc1
    s_waitcnt vmcnt(9)
    v_mfma_f32_16x16x32_bf16 v[92:95], v[60:63], v[28:31], v[92:95]
    v_mfma_f32_16x16x32_bf16 v[108:111], v[60:63], v[32:35], v[108:111]
    v_mfma_f32_16x16x32_bf16 v[124:127], v[60:63], v[36:39], v[124:127]
    buffer_load_dwordx4 v[60:63], v14, s[44:47], s75 offen offset:1024 sc1
    ds_read_b128 v[28:31], v8 offset:1024
    ds_read_b128 v[32:35], v8 offset:9216
    ds_read_b128 v[36:39], v8 offset:17408
    v_xor_b32 v8, 0x100, v8
    s_waitcnt lgkmcnt(3)
    s_waitcnt vmcnt(9)
    v_mfma_f32_16x16x32_bf16 v[80:83], v[64:67], v[16:19], v[80:83]
    v_mfma_f32_16x16x32_bf16 v[96:99], v[64:67], v[20:23], v[96:99]
    v_mfma_f32_16x16x32_bf16 v[112:115], v[64:67], v[24:27], v[112:115]
    buffer_load_dwordx4 v[64:67], v14, s[44:47], s75 offen offset:2048 sc1
    s_waitcnt vmcnt(9)
    v_mfma_f32_16x16x32_bf16 v[84:87], v[68:71], v[16:19], v[84:87]
    v_mfma_f32_16x16x32_bf16 v[100:103], v[68:71], v[20:23], v[100:103]
    v_mfma_f32_16x16x32_bf16 v[116:119], v[68:71], v[24:27], v[116:119]
    buffer_load_dwordx4 v[68:71], v14, s[44:47], s75 offen offset:3072 sc1
    s_xor_b32 s75, s75, 4096
    s_waitcnt vmcnt(9)
    v_mfma_f32_16x16x32_bf16 v[88:91], v[72:75], v[16:19], v[88:91]
    v_mfma_f32_16x16x32_bf16 v[104:107], v[72:75], v[20:23], v[104:107]
    v_mfma_f32_16x16x32_bf16 v[120:123], v[72:75], v[24:27], v[120:123]
    buffer_load_dwordx4 v[72:75], v14, s[44:47], s75 offen offset:0 sc1
    s_waitcnt vmcnt(9)
    v_mfma_f32_16x16x32_bf16 v[92:95], v[76:79], v[16:19], v[92:95]
    v_mfma_f32_16x16x32_bf16 v[108:111], v[76:79], v[20:23], v[108:111]
    v_mfma_f32_16x16x32_bf16 v[124:127], v[76:79], v[24:27], v[124:127]
    buffer_load_dwordx4 v[76:79], v14, s[44:47], s75 offen offset:1024 sc1
    ds_read_b128 v[16:19], v9 offset:1024
    ds_read_b128 v[20:23], v9 offset:9216
    ds_read_b128 v[24:27], v9 offset:17408
    v_xor_b32 v9, 0x100, v9
    s_waitcnt lgkmcnt(3)
    s_waitcnt vmcnt(9)
    v_mfma_f32_16x16x32_bf16 v[80:83], v[40:43], v[28:31], v[80:83]
    v_mfma_f32_16x16x32_bf16 v[96:99], v[40:43], v[32:35], v[96:99]
    v_mfma_f32_16x16x32_bf16 v[112:115], v[40:43], v[36:39], v[112:115]
    buffer_load_dwordx4 v[40:43], v14, s[44:47], s75 offen offset:2048 sc1
    s_waitcnt vmcnt(9)
    v_mfma_f32_16x16x32_bf16 v[84:87], v[44:47], v[28:31], v[84:87]
    v_mfma_f32_16x16x32_bf16 v[100:103], v[44:47], v[32:35], v[100:103]
    v_mfma_f32_16x16x32_bf16 v[116:119], v[44:47], v[36:39], v[116:119]
    buffer_load_dwordx4 v[44:47], v14, s[44:47], s75 offen offset:3072 sc1
    s_xor_b32 s75, s75, 28672
    s_waitcnt vmcnt(9)
    v_mfma_f32_16x16x32_bf16 v[88:91], v[48:51], v[28:31], v[88:91]
    v_mfma_f32_16x16x32_bf16 v[104:107], v[48:51], v[32:35], v[104:107]
    v_mfma_f32_16x16x32_bf16 v[120:123], v[48:51], v[36:39], v[120:123]
    s_add_u32 m0, s70, 0
    s_nop 0
    buffer_load_dwordx4 v13, s[40:43], 0 offen offset:0 lds
    s_waitcnt vmcnt(9)
    v_mfma_f32_16x16x32_bf16 v[92:95], v[52:55], v[28:31], v[92:95]
    v_mfma_f32_16x16x32_bf16 v[108:111], v[52:55], v[32:35], v[108:111]
    v_mfma_f32_16x16x32_bf16 v[124:127], v[52:55], v[36:39], v[124:127]
    buffer_load_dwordx4 v13, s[40:43], s71 offen offset:1024 lds
    ds_read_b128 v[28:31], v10 offset:1024
    ds_read_b128 v[32:35], v10 offset:9216
    ds_read_b128 v[36:39], v10 offset:17408
    v_xor_b32 v10, 0x100, v10
    s_waitcnt lgkmcnt(3)
    s_waitcnt vmcnt(9)
    v_mfma_f32_16x16x32_bf16 v[80:83], v[56:59], v[16:19], v[80:83]
    v_mfma_f32_16x16x32_bf16 v[96:99], v[56:59], v[20:23], v[96:99]
    v_mfma_f32_16x16x32_bf16 v[112:115], v[56:59], v[24:27], v[112:115]
    buffer_load_dwordx4 v13, s[40:43], s72 offen offset:2048 lds
    s_waitcnt vmcnt(9)
    v_mfma_f32_16x16x32_bf16 v[84:87], v[60:63], v[16:19], v[84:87]
    v_mfma_f32_16x16x32_bf16 v[100:103], v[60:63], v[20:23], v[100:103]
    v_mfma_f32_16x16x32_bf16 v[116:119], v[60:63], v[24:27], v[116:119]
    buffer_load_dwordx4 v13, s[40:43], s73 offen offset:3072 lds
    v_xor_b32 v13, 16384, v13
    s_waitcnt vmcnt(9)
    v_mfma_f32_16x16x32_bf16 v[88:91], v[64:67], v[16:19], v[88:91]
    v_mfma_f32_16x16x32_bf16 v[104:107], v[64:67], v[20:23], v[104:107]
    v_mfma_f32_16x16x32_bf16 v[120:123], v[64:67], v[24:27], v[120:123]
    s_add_u32 m0, s70, 4096
    s_nop 0
    buffer_load_dwordx4 v13, s[40:43], 0 offen offset:0 lds
    s_waitcnt vmcnt(9)
    v_mfma_f32_16x16x32_bf16 v[92:95], v[68:71], v[16:19], v[92:95]
    v_mfma_f32_16x16x32_bf16 v[108:111], v[68:71], v[20:23], v[108:111]
    v_mfma_f32_16x16x32_bf16 v[124:127], v[68:71], v[24:27], v[124:127]
    buffer_load_dwordx4 v13, s[40:43], s71 offen offset:1024 lds
    s_waitcnt lgkmcnt(0)
    s_waitcnt vmcnt(9)
    v_mfma_f32_16x16x32_bf16 v[80:83], v[72:75], v[28:31], v[80:83]
    v_mfma_f32_16x16x32_bf16 v[96:99], v[72:75], v[32:35], v[96:99]
    v_mfma_f32_16x16x32_bf16 v[112:115], v[72:75], v[36:39], v[112:115]
    buffer_load_dwordx4 v13, s[40:43], s72 offen offset:2048 lds
    s_waitcnt vmcnt(9)
    v_mfma_f32_16x16x32_bf16 v[84:87], v[76:79], v[28:31], v[84:87]
    v_mfma_f32_16x16x32_bf16 v[100:103], v[76:79], v[32:35], v[100:103]
    v_mfma_f32_16x16x32_bf16 v[116:119], v[76:79], v[36:39], v[116:119]
    buffer_load_dwordx4 v13, s[40:43], s73 offen offset:3072 lds
    v_xor_b32 v13, 49152, v13
    s_waitcnt vmcnt(9)
    v_mfma_f32_16x16x32_bf16 v[88:91], v[40:43], v[28:31], v[88:91]
    v_mfma_f32_16x16x32_bf16 v[104:107], v[40:43], v[32:35], v[104:107]
    v_mfma_f32_16x16x32_bf16 v[120:123], v[40:43], v[36:39], v[120:123]
    s_add_u32 m0, s70, 8192
    s_nop 0
    buffer_load_dwordx4 v13, s[40:43], 0 offen offset:0 lds
    s_waitcnt vmcnt(9)
    v_mfma_f32_16x16x32_bf16 v[92:95], v[44:47], v[28:31], v[92:95]
    v_mfma_f32_16x16x32_bf16 v[108:111], v[44:47], v[32:35], v[108:111]
    v_mfma_f32_16x16x32_bf16 v[124:127], v[44:47], v[36:39], v[124:127]
    buffer_load_dwordx4 v13, s[40:43], s71 offen offset:1024 lds
    s_lshl_b32 s64, s31, 3
    v_add_u32 v0, s64, v4
    v_xor_b32 v0, v0, v3
    v_lshlrev_b32 v0, 4, v0
    v_lshl_add_u32 v0, v3, 9, v0
    v_xor_b32 v1, 64, v0
    s_mov_b32 s76, 0x00ff00ff
    s_mov_b32 s77, 0x00ff00ff
    v_cvt_pk_bf16_f32 v16, v80, v81
    v_cvt_pk_bf16_f32 v17, v82, v83
    v_cvt_pk_bf16_f32 v18, v84, v85
    v_cvt_pk_bf16_f32 v19, v86, v87
    ds_write_b128 v0, v[16:19] offset:21504
    v_cvt_pk_bf16_f32 v20, v88, v89
    v_cvt_pk_bf16_f32 v21, v90, v91
    v_cvt_pk_bf16_f32 v22, v92, v93
    v_cvt_pk_bf16_f32 v23, v94, v95
    ds_write_b128 v1, v[20:23] offset:21504
    v_cvt_pk_bf16_f32 v24, v96, v97
    v_cvt_pk_bf16_f32 v25, v98, v99
    v_cvt_pk_bf16_f32 v26, v100, v101
    v_cvt_pk_bf16_f32 v27, v102, v103
    ds_write_b128 v0, v[24:27] offset:29696
    v_cvt_pk_bf16_f32 v28, v104, v105
    v_cvt_pk_bf16_f32 v29, v106, v107
    v_cvt_pk_bf16_f32 v30, v108, v109
    v_cvt_pk_bf16_f32 v31, v110, v111
    ds_write_b128 v1, v[28:31] offset:29696
    s_mov_b64 exec, s[76:77]
    v_cvt_pk_bf16_f32 v32, v112, v113
    v_cvt_pk_bf16_f32 v33, v114, v115
    v_cvt_pk_bf16_f32 v34, v116, v117
    v_cvt_pk_bf16_f32 v35, v118, v119
    ds_write_b128 v0, v[32:35] offset:37888
    v_cvt_pk_bf16_f32 v36, v120, v121
    v_cvt_pk_bf16_f32 v37, v122, v123
    v_cvt_pk_bf16_f32 v38, v124, v125
    v_cvt_pk_bf16_f32 v39, v126, v127
    ds_write_b128 v1, v[36:39] offset:37888
    s_mov_b64 exec, -1
    s_waitcnt lgkmcnt(0)
    s_barrier
    buffer_load_dwordx4 v13, s[40:43], s72 offen offset:2048 lds
    buffer_load_dwordx4 v13, s[40:43], s73 offen offset:3072 lds
    v_xor_b32 v13, 16384, v13
    s_add_u32 m0, s70, 12288
    s_nop 0
    buffer_load_dwordx4 v13, s[40:43], 0 offen offset:0 lds
    buffer_load_dwordx4 v13, s[40:43], s71 offen offset:1024 lds
    buffer_load_dwordx4 v13, s[40:43], s72 offen offset:2048 lds
    buffer_load_dwordx4 v13, s[40:43], s73 offen offset:3072 lds
    v_xor_b32 v13, 114688, v13
    v_lshlrev_b32 v0, 4, v4
    v_and_b32 v1, 7, v3
    v_lshl_add_u32 v0, v1, 9, v0
    v_and_b32 v1, 8, v3
    v_lshl_add_u32 v0, v1, 3, v0
    s_mul_i32 s74, s1, 20480
    s_lshl_b32 s64, s31, 7
    s_add_u32 s74, s74, s64
    s_waitcnt vmcnt(8)
    ds_read_b64_tr_b16 v[48:49], v11 offset:0
    ds_read_b64_tr_b16 v[50:51], v11 offset:512
    ds_read_b64_tr_b16 v[52:53], v11 offset:8
    ds_read_b64_tr_b16 v[54:55], v11 offset:520
    ds_read_b64_tr_b16 v[56:57], v12 offset:0
    ds_read_b64_tr_b16 v[58:59], v12 offset:512
    ds_read_b64_tr_b16 v[60:61], v12 offset:8
    ds_read_b64_tr_b16 v[62:63], v12 offset:520
    ds_read_b64_tr_b16 v[64:65], v11 offset:4096
    ds_read_b64_tr_b16 v[66:67], v11 offset:4608
    ds_read_b64_tr_b16 v[68:69], v11 offset:4104
    ds_read_b64_tr_b16 v[70:71], v11 offset:4616
    ds_read_b64_tr_b16 v[72:73], v12 offset:4096
    ds_read_b64_tr_b16 v[74:75], v12 offset:4608
    ds_read_b64_tr_b16 v[76:77], v12 offset:4104
    ds_read_b64_tr_b16 v[78:79], v12 offset:4616
    s_waitcnt lgkmcnt(8)
    s_add_u32 m0, s70, 0
    s_nop 0
    buffer_load_dwordx4 v13, s[40:43], 0 offen offset:0 lds
    buffer_load_dwordx4 v13, s[40:43], s71 offen offset:1024 lds
    buffer_load_dwordx4 v13, s[40:43], s72 offen offset:2048 lds
    buffer_load_dwordx4 v13, s[40:43], s73 offen offset:3072 lds
    v_xor_b32 v13, 16384, v13
    s_waitcnt lgkmcnt(0)
    s_add_u32 m0, s70, 4096
    s_nop 0
    buffer_load_dwordx4 v13, s[40:43], 0 offen offset:0 lds
    buffer_load_dwordx4 v13, s[40:43], s71 offen offset:1024 lds
    buffer_load_dwordx4 v13, s[40:43], s72 offen offset:2048 lds
    buffer_load_dwordx4 v13, s[40:43], s73 offen offset:3072 lds
    v_xor_b32 v13, 49152, v13
    s_lshl_b32 s64, s31, 12
    s_add_u32 s78, s64, 21504
    s_add_u32 s79, s64, 148480
    s_cmp_eq_u32 s31, 3
    s_cselect_b32 s79, 37888, s79
    s_sub_u32 s76, s78, s70
    s_sub_u32 s77, s79, s78
    v_xor_b32 v40, 0x100, v7
    v_xor_b32 v41, 0x100, v8
    v_xor_b32 v42, 0x100, v9
    v_xor_b32 v43, 0x100, v10
    s_barrier
    s_mov_b32 m0, s78
    s_nop 0
    buffer_load_dwordx4 v13, s[40:43], 0 offen offset:0 lds
    buffer_load_dwordx4 v13, s[40:43], s71 offen offset:1024 lds
    buffer_load_dwordx4 v13, s[40:43], s72 offen offset:2048 lds
    buffer_load_dwordx4 v13, s[40:43], s73 offen offset:3072 lds
    v_xor_b32 v13, 16384, v13
    s_mov_b32 m0, s79
    s_nop 0
    buffer_load_dwordx4 v13, s[40:43], 0 offen offset:0 lds
    buffer_load_dwordx4 v13, s[40:43], s71 offen offset:1024 lds
    buffer_load_dwordx4 v13, s[40:43], s72 offen offset:2048 lds
    buffer_load_dwordx4 v13, s[40:43], s73 offen offset:3072 lds
    v_xor_b32 v13, 114688, v13
    s_setprio 0
L_prog_22:
    ds_read_b128 v[16:19], v5 offset:32
    s_waitcnt lgkmcnt(0)
    v_min3_u32 v16, v16, v17, v18
    v_min_u32 v16, v16, v19
    v_cmp_gt_u32 vcc, 1, v16
    s_cbranch_vccnz L_retry_23
    ds_read_b128 v[16:19], v7 offset:1024
    ds_read_b128 v[20:23], v7 offset:9216
    ds_read_b128 v[24:27], v7 offset:17408
    s_waitcnt vmcnt(8)
    s_waitcnt lgkmcnt(0)
    v_mfma_f32_16x16x32_bf16 v[80:83], v[128:131], v[16:19], 0
    ds_read_b128 v[28:31], v8 offset:1024
    v_mfma_f32_16x16x32_bf16 v[96:99], v[128:131], v[20:23], 0
    ds_read_b128 v[32:35], v8 offset:9216
    v_mfma_f32_16x16x32_bf16 v[112:115], v[128:131], v[24:27], 0
    ds_read_b128 v[36:39], v8 offset:17408
    v_mfma_f32_16x16x32_bf16 v[84:87], v[132:135], v[16:19], 0
    v_mfma_f32_16x16x32_bf16 v[100:103], v[132:135], v[20:23], 0
    v_mfma_f32_16x16x32_bf16 v[116:119], v[132:135], v[24:27], 0
    v_mfma_f32_16x16x32_bf16 v[88:91], v[136:139], v[16:19], 0
    v_mfma_f32_16x16x32_bf16 v[104:107], v[136:139], v[20:23], 0
    v_mfma_f32_16x16x32_bf16 v[120:123], v[136:139], v[24:27], 0
    v_mfma_f32_16x16x32_bf16 v[92:95], v[140:143], v[16:19], 0
    v_mfma_f32_16x16x32_bf16 v[108:111], v[140:143], v[20:23], 0
    v_mfma_f32_16x16x32_bf16 v[124:127], v[140:143], v[24:27], 0
    s_waitcnt lgkmcnt(0)
    v_mfma_f32_16x16x32_bf16 v[80:83], v[144:147], v[28:31], v[80:83]
    ds_read_b128 v[16:19], v9 offset:1024
    v_mfma_f32_16x16x32_bf16 v[96:99], v[144:147], v[32:35], v[96:99]
    ds_read_b128 v[20:23], v9 offset:9216
    v_mfma_f32_16x16x32_bf16 v[112:115], v[144:147], v[36:39], v[112:115]
    ds_read_b128 v[24:27], v9 offset:17408
    v_mfma_f32_16x16x32_bf16 v[84:87], v[148:151], v[28:31], v[84:87]
    ds_read_b64_tr_b16 v[128:129], v11 offset:8192
    v_mfma_f32_16x16x32_bf16 v[100:103], v[148:151], v[32:35], v[100:103]
    ds_read_b64_tr_b16 v[130:131], v11 offset:8704
    v_mfma_f32_16x16x32_bf16 v[116:119], v[148:151], v[36:39], v[116:119]
    ds_read_b64_tr_b16 v[132:133], v11 offset:8200
    v_mfma_f32_16x16x32_bf16 v[88:91], v[152:155], v[28:31], v[88:91]
    ds_read_b64_tr_b16 v[134:135], v11 offset:8712
    v_mfma_f32_16x16x32_bf16 v[104:107], v[152:155], v[32:35], v[104:107]
    ds_read_b64_tr_b16 v[136:137], v12 offset:8192
    v_mfma_f32_16x16x32_bf16 v[120:123], v[152:155], v[36:39], v[120:123]
    ds_read_b64_tr_b16 v[138:139], v12 offset:8704
    v_mfma_f32_16x16x32_bf16 v[92:95], v[156:159], v[28:31], v[92:95]
    ds_read_b64_tr_b16 v[140:141], v12 offset:8200
    v_mfma_f32_16x16x32_bf16 v[108:111], v[156:159], v[32:35], v[108:111]
    ds_read_b64_tr_b16 v[142:143], v12 offset:8712
    v_mfma_f32_16x16x32_bf16 v[124:127], v[156:159], v[36:39], v[124:127]
    s_waitcnt lgkmcnt(8)
    v_mfma_f32_16x16x32_bf16 v[80:83], v[160:163], v[16:19], v[80:83]
    ds_read_b128 v[28:31], v10 offset:1024
    v_mfma_f32_16x16x32_bf16 v[96:99], v[160:163], v[20:23], v[96:99]
    ds_read_b128 v[32:35], v10 offset:9216
    v_mfma_f32_16x16x32_bf16 v[112:115], v[160:163], v[24:27], v[112:115]
    ds_read_b128 v[36:39], v10 offset:17408
    v_mfma_f32_16x16x32_bf16 v[84:87], v[164:167], v[16:19], v[84:87]
    ds_read_b64_tr_b16 v[144:145], v11 offset:12288
    v_mfma_f32_16x16x32_bf16 v[100:103], v[164:167], v[20:23], v[100:103]
    ds_read_b64_tr_b16 v[146:147], v11 offset:12800
    v_mfma_f32_16x16x32_bf16 v[116:119], v[164:167], v[24:27], v[116:119]
    ds_read_b64_tr_b16 v[148:149], v11 offset:12296
    v_mfma_f32_16x16x32_bf16 v[88:91], v[168:171], v[16:19], v[88:91]
    ds_read_b64_tr_b16 v[150:151], v11 offset:12808
    v_mfma_f32_16x16x32_bf16 v[104:107], v[168:171], v[20:23], v[104:107]
    ds_read_b64_tr_b16 v[152:153], v12 offset:12288
    v_mfma_f32_16x16x32_bf16 v[120:123], v[168:171], v[24:27], v[120:123]
    ds_read_b64_tr_b16 v[154:155], v12 offset:12800
    v_mfma_f32_16x16x32_bf16 v[92:95], v[172:175], v[16:19], v[92:95]
    ds_read_b64_tr_b16 v[156:157], v12 offset:12296
    v_mfma_f32_16x16x32_bf16 v[108:111], v[172:175], v[20:23], v[108:111]
    ds_read_b64_tr_b16 v[158:159], v12 offset:12808
    v_mfma_f32_16x16x32_bf16 v[124:127], v[172:175], v[24:27], v[124:127]
    s_waitcnt lgkmcnt(8)
    v_mfma_f32_16x16x32_bf16 v[80:83], v[176:179], v[28:31], v[80:83]
    ds_read_b128 v[16:19], v40 offset:1024
    v_mfma_f32_16x16x32_bf16 v[96:99], v[176:179], v[32:35], v[96:99]
    ds_read_b128 v[20:23], v40 offset:9216
    v_mfma_f32_16x16x32_bf16 v[112:115], v[176:179], v[36:39], v[112:115]
    ds_read_b128 v[24:27], v40 offset:17408
    v_mfma_f32_16x16x32_bf16 v[84:87], v[180:183], v[28:31], v[84:87]
    ds_read_b64_tr_b16 v[160:161], v11 offset:0
    v_mfma_f32_16x16x32_bf16 v[100:103], v[180:183], v[32:35], v[100:103]
    ds_read_b64_tr_b16 v[162:163], v11 offset:512
    v_mfma_f32_16x16x32_bf16 v[116:119], v[180:183], v[36:39], v[116:119]
    ds_read_b64_tr_b16 v[164:165], v11 offset:8
    v_mfma_f32_16x16x32_bf16 v[88:91], v[184:187], v[28:31], v[88:91]
    ds_read_b64_tr_b16 v[166:167], v11 offset:520
    v_mfma_f32_16x16x32_bf16 v[104:107], v[184:187], v[32:35], v[104:107]
    ds_read_b64_tr_b16 v[168:169], v12 offset:0
    v_mfma_f32_16x16x32_bf16 v[120:123], v[184:187], v[36:39], v[120:123]
    ds_read_b64_tr_b16 v[170:171], v12 offset:512
    v_mfma_f32_16x16x32_bf16 v[92:95], v[188:191], v[28:31], v[92:95]
    ds_read_b64_tr_b16 v[172:173], v12 offset:8
    v_mfma_f32_16x16x32_bf16 v[108:111], v[188:191], v[32:35], v[108:111]
    ds_read_b64_tr_b16 v[174:175], v12 offset:520
    v_mfma_f32_16x16x32_bf16 v[124:127], v[188:191], v[36:39], v[124:127]
    s_waitcnt lgkmcnt(8)
    v_mfma_f32_16x16x32_bf16 v[80:83], v[192:195], v[16:19], v[80:83]
    ds_read_b128 v[28:31], v41 offset:1024
    v_mfma_f32_16x16x32_bf16 v[96:99], v[192:195], v[20:23], v[96:99]
    ds_read_b128 v[32:35], v41 offset:9216
    v_mfma_f32_16x16x32_bf16 v[112:115], v[192:195], v[24:27], v[112:115]
    ds_read_b128 v[36:39], v41 offset:17408
    v_mfma_f32_16x16x32_bf16 v[84:87], v[196:199], v[16:19], v[84:87]
    ds_read_b64_tr_b16 v[176:177], v11 offset:4096
    v_mfma_f32_16x16x32_bf16 v[100:103], v[196:199], v[20:23], v[100:103]
    ds_read_b64_tr_b16 v[178:179], v11 offset:4608
    v_mfma_f32_16x16x32_bf16 v[116:119], v[196:199], v[24:27], v[116:119]
    ds_read_b64_tr_b16 v[180:181], v11 offset:4104
    v_mfma_f32_16x16x32_bf16 v[88:91], v[200:203], v[16:19], v[88:91]
    ds_read_b64_tr_b16 v[182:183], v11 offset:4616
    v_mfma_f32_16x16x32_bf16 v[104:107], v[200:203], v[20:23], v[104:107]
    ds_read_b64_tr_b16 v[184:185], v12 offset:4096
    v_mfma_f32_16x16x32_bf16 v[120:123], v[200:203], v[24:27], v[120:123]
    ds_read_b64_tr_b16 v[186:187], v12 offset:4608
    v_mfma_f32_16x16x32_bf16 v[92:95], v[204:207], v[16:19], v[92:95]
    ds_read_b64_tr_b16 v[188:189], v12 offset:4104
    v_mfma_f32_16x16x32_bf16 v[108:111], v[204:207], v[20:23], v[108:111]
    ds_read_b64_tr_b16 v[190:191], v12 offset:4616
    v_mfma_f32_16x16x32_bf16 v[124:127], v[204:207], v[24:27], v[124:127]
    s_waitcnt lgkmcnt(8)
    v_mfma_f32_16x16x32_bf16 v[80:83], v[208:211], v[28:31], v[80:83]
    ds_read_b128 v[16:19], v42 offset:1024
    v_mfma_f32_16x16x32_bf16 v[96:99], v[208:211], v[32:35], v[96:99]
    ds_read_b128 v[20:23], v42 offset:9216
    v_mfma_f32_16x16x32_bf16 v[112:115], v[208:211], v[36:39], v[112:115]
    ds_read_b128 v[24:27], v42 offset:17408
    v_mfma_f32_16x16x32_bf16 v[84:87], v[212:215], v[28:31], v[84:87]
    v_mfma_f32_16x16x32_bf16 v[100:103], v[212:215], v[32:35], v[100:103]
    v_mfma_f32_16x16x32_bf16 v[116:119], v[212:215], v[36:39], v[116:119]
    v_mfma_f32_16x16x32_bf16 v[88:91], v[216:219], v[28:31], v[88:91]
    v_mfma_f32_16x16x32_bf16 v[104:107], v[216:219], v[32:35], v[104:107]
    v_mfma_f32_16x16x32_bf16 v[120:123], v[216:219], v[36:39], v[120:123]
    v_mfma_f32_16x16x32_bf16 v[92:95], v[220:223], v[28:31], v[92:95]
    v_mfma_f32_16x16x32_bf16 v[108:111], v[220:223], v[32:35], v[108:111]
    v_mfma_f32_16x16x32_bf16 v[124:127], v[220:223], v[36:39], v[124:127]
    s_waitcnt lgkmcnt(0)
    v_mfma_f32_16x16x32_bf16 v[80:83], v[224:227], v[16:19], v[80:83]
    v_add_u32 v11, s76, v11
    v_add_u32 v12, s76, v12
    v_mfma_f32_16x16x32_bf16 v[96:99], v[224:227], v[20:23], v[96:99]
    ds_read_b128 v[28:31], v43 offset:1024
    v_mfma_f32_16x16x32_bf16 v[112:115], v[224:227], v[24:27], v[112:115]
    ds_read_b128 v[32:35], v43 offset:9216
    v_mfma_f32_16x16x32_bf16 v[84:87], v[228:231], v[16:19], v[84:87]
    ds_read_b128 v[36:39], v43 offset:17408
    v_mfma_f32_16x16x32_bf16 v[100:103], v[228:231], v[20:23], v[100:103]
    s_waitcnt vmcnt(4)
    ds_read_b64_tr_b16 v[192:193], v11 offset:0
    v_mfma_f32_16x16x32_bf16 v[116:119], v[228:231], v[24:27], v[116:119]
    ds_read_b64_tr_b16 v[194:195], v11 offset:512
    v_mfma_f32_16x16x32_bf16 v[88:91], v[232:235], v[16:19], v[88:91]
    ds_read_b64_tr_b16 v[196:197], v11 offset:8
    v_mfma_f32_16x16x32_bf16 v[104:107], v[232:235], v[20:23], v[104:107]
    ds_read_b64_tr_b16 v[198:199], v11 offset:520
    v_mfma_f32_16x16x32_bf16 v[120:123], v[232:235], v[24:27], v[120:123]
    ds_read_b64_tr_b16 v[200:201], v12 offset:0
    v_mfma_f32_16x16x32_bf16 v[92:95], v[236:239], v[16:19], v[92:95]
    ds_read_b64_tr_b16 v[202:203], v12 offset:512
    v_mfma_f32_16x16x32_bf16 v[108:111], v[236:239], v[20:23], v[108:111]
    ds_read_b64_tr_b16 v[204:205], v12 offset:8
    v_mfma_f32_16x16x32_bf16 v[124:127], v[236:239], v[24:27], v[124:127]
    ds_read_b64_tr_b16 v[206:207], v12 offset:520
    s_waitcnt lgkmcnt(8)
    v_mfma_f32_16x16x32_bf16 v[80:83], v[240:243], v[28:31], v[80:83]
    v_add_u32 v11, s77, v11
    v_add_u32 v12, s77, v12
    v_mfma_f32_16x16x32_bf16 v[96:99], v[240:243], v[32:35], v[96:99]
    s_waitcnt vmcnt(0)
    ds_read_b64_tr_b16 v[208:209], v11 offset:0
    v_mfma_f32_16x16x32_bf16 v[112:115], v[240:243], v[36:39], v[112:115]
    ds_read_b64_tr_b16 v[210:211], v11 offset:512
    v_mfma_f32_16x16x32_bf16 v[84:87], v[244:247], v[28:31], v[84:87]
    ds_read_b64_tr_b16 v[212:213], v11 offset:8
    v_mfma_f32_16x16x32_bf16 v[100:103], v[244:247], v[32:35], v[100:103]
    ds_read_b64_tr_b16 v[214:215], v11 offset:520
    v_mfma_f32_16x16x32_bf16 v[116:119], v[244:247], v[36:39], v[116:119]
    ds_read_b64_tr_b16 v[216:217], v12 offset:0
    v_mfma_f32_16x16x32_bf16 v[88:91], v[248:251], v[28:31], v[88:91]
    ds_read_b64_tr_b16 v[218:219], v12 offset:512
    v_mfma_f32_16x16x32_bf16 v[104:107], v[248:251], v[32:35], v[104:107]
    ds_read_b64_tr_b16 v[220:221], v12 offset:8
    v_mfma_f32_16x16x32_bf16 v[120:123], v[248:251], v[36:39], v[120:123]
    ds_read_b64_tr_b16 v[222:223], v12 offset:520
    v_mfma_f32_16x16x32_bf16 v[92:95], v[252:255], v[28:31], v[92:95]
    v_mfma_f32_16x16x32_bf16 v[108:111], v[252:255], v[32:35], v[108:111]
    v_mfma_f32_16x16x32_bf16 v[124:127], v[252:255], v[36:39], v[124:127]
    s_add_u32 s75, s74, 4096
    s_add_u32 s76, s74, 8192
    s_add_u32 s77, s74, 12288
    s_add_u32 s78, s74, 16384
L_prog_24:
    ds_read_b128 v[16:19], v5 offset:32
    s_waitcnt lgkmcnt(0)
    v_min3_u32 v16, v16, v17, v18
    v_min_u32 v16, v16, v19
    v_cmp_gt_u32 vcc, 1, v16
    s_cbranch_vccnz L_retry_25
    ds_read_b128 v[16:19], v7 offset:58368
    ds_read_b128 v[20:23], v8 offset:58368
    ds_read_b128 v[24:27], v9 offset:58368
    ds_read_b128 v[28:31], v10 offset:58368
    ds_read_b128 v[32:35], v40 offset:58368
    ds_read_b128 v[36:39], v41 offset:58368
    ds_read_b128 v[44:47], v42 offset:58368
    ds_read_b128 v[252:255], v43 offset:58368
    s_waitcnt lgkmcnt(7)
    v_mfma_f32_16x16x32_bf16 v[120:123], v[56:59], v[16:19], v[120:123]
    v_mfma_f32_16x16x32_bf16 v[124:127], v[60:63], v[16:19], v[124:127]
    v_mfma_f32_16x16x32_bf16 v[112:115], v[48:51], v[16:19], v[112:115]
    v_mfma_f32_16x16x32_bf16 v[116:119], v[52:55], v[16:19], v[116:119]
    s_waitcnt lgkmcnt(6)
    v_mfma_f32_16x16x32_bf16 v[120:123], v[72:75], v[20:23], v[120:123]
    v_mfma_f32_16x16x32_bf16 v[124:127], v[76:79], v[20:23], v[124:127]
    v_mfma_f32_16x16x32_bf16 v[112:115], v[64:67], v[20:23], v[112:115]
    v_mfma_f32_16x16x32_bf16 v[116:119], v[68:71], v[20:23], v[116:119]
    s_waitcnt lgkmcnt(5)
    v_mfma_f32_16x16x32_bf16 v[120:123], v[136:139], v[24:27], v[120:123]
    v_mfma_f32_16x16x32_bf16 v[124:127], v[140:143], v[24:27], v[124:127]
    v_mfma_f32_16x16x32_bf16 v[112:115], v[128:131], v[24:27], v[112:115]
    v_mfma_f32_16x16x32_bf16 v[116:119], v[132:135], v[24:27], v[116:119]
    s_waitcnt lgkmcnt(4)
    v_mfma_f32_16x16x32_bf16 v[120:123], v[152:155], v[28:31], v[120:123]
    v_mfma_f32_16x16x32_bf16 v[124:127], v[156:159], v[28:31], v[124:127]
    v_mfma_f32_16x16x32_bf16 v[112:115], v[144:147], v[28:31], v[112:115]
    v_mfma_f32_16x16x32_bf16 v[116:119], v[148:151], v[28:31], v[116:119]
    s_waitcnt lgkmcnt(3)
    v_mfma_f32_16x16x32_bf16 v[120:123], v[168:171], v[32:35], v[120:123]
    v_mfma_f32_16x16x32_bf16 v[124:127], v[172:175], v[32:35], v[124:127]
    v_mfma_f32_16x16x32_bf16 v[112:115], v[160:163], v[32:35], v[112:115]
    v_mfma_f32_16x16x32_bf16 v[116:119], v[164:167], v[32:35], v[116:119]
    s_waitcnt lgkmcnt(2)
    v_mfma_f32_16x16x32_bf16 v[120:123], v[184:187], v[36:39], v[120:123]
    v_mfma_f32_16x16x32_bf16 v[124:127], v[188:191], v[36:39], v[124:127]
    v_mfma_f32_16x16x32_bf16 v[112:115], v[176:179], v[36:39], v[112:115]
    v_mfma_f32_16x16x32_bf16 v[116:119], v[180:183], v[36:39], v[116:119]
    s_waitcnt lgkmcnt(1)
    v_mfma_f32_16x16x32_bf16 v[120:123], v[200:203], v[44:47], v[120:123]
    v_mfma_f32_16x16x32_bf16 v[124:127], v[204:207], v[44:47], v[124:127]
    v_mfma_f32_16x16x32_bf16 v[112:115], v[192:195], v[44:47], v[112:115]
    v_mfma_f32_16x16x32_bf16 v[116:119], v[196:199], v[44:47], v[116:119]
    s_waitcnt lgkmcnt(0)
    v_mfma_f32_16x16x32_bf16 v[120:123], v[216:219], v[252:255], v[120:123]
    v_mfma_f32_16x16x32_bf16 v[124:127], v[220:223], v[252:255], v[124:127]
    v_mfma_f32_16x16x32_bf16 v[112:115], v[208:211], v[252:255], v[112:115]
    v_mfma_f32_16x16x32_bf16 v[116:119], v[212:215], v[252:255], v[116:119]
L_prog_26:
    ds_read_b128 v[16:19], v5 offset:32
    s_waitcnt lgkmcnt(0)
    v_min3_u32 v16, v16, v17, v18
    v_min_u32 v16, v16, v19
    v_cmp_gt_u32 vcc, 3, v16
    s_cbranch_vccnz L_retry_27
    ds_read_b128 v[16:19], v7 offset:41984
    ds_read_b128 v[20:23], v8 offset:41984
    ds_read_b128 v[24:27], v9 offset:41984
    ds_read_b128 v[28:31], v10 offset:41984
    ds_read_b128 v[32:35], v40 offset:41984
    ds_read_b128 v[36:39], v41 offset:41984
    ds_read_b128 v[44:47], v42 offset:41984
    ds_read_b128 v[252:255], v43 offset:41984
    s_waitcnt lgkmcnt(7)
    v_mfma_f32_16x16x32_bf16 v[88:91], v[56:59], v[16:19], v[88:91]
    v_cvt_pk_bf16_f32 v248, v120, v121
    v_mfma_f32_16x16x32_bf16 v[92:95], v[60:63], v[16:19], v[92:95]
    v_cvt_pk_bf16_f32 v249, v122, v123
    v_mfma_f32_16x16x32_bf16 v[80:83], v[48:51], v[16:19], v[80:83]
    v_cvt_pk_bf16_f32 v250, v124, v125
    v_mfma_f32_16x16x32_bf16 v[84:87], v[52:55], v[16:19], v[84:87]
    v_cvt_pk_bf16_f32 v251, v126, v127
    s_waitcnt lgkmcnt(6)
    v_mfma_f32_16x16x32_bf16 v[88:91], v[72:75], v[20:23], v[88:91]
    v_cvt_pk_bf16_f32 v244, v112, v113
    v_mfma_f32_16x16x32_bf16 v[92:95], v[76:79], v[20:23], v[92:95]
    v_cvt_pk_bf16_f32 v245, v114, v115
    v_mfma_f32_16x16x32_bf16 v[80:83], v[64:67], v[20:23], v[80:83]
    v_cvt_pk_bf16_f32 v246, v116, v117
    v_mfma_f32_16x16x32_bf16 v[84:87], v[68:71], v[20:23], v[84:87]
    v_cvt_pk_bf16_f32 v247, v118, v119
    s_waitcnt lgkmcnt(5)
    v_mfma_f32_16x16x32_bf16 v[88:91], v[136:139], v[24:27], v[88:91]
    v_mov_b32_dpp v244, v248 row_ror:8 row_mask:0xf bank_mask:0xc
    v_mfma_f32_16x16x32_bf16 v[92:95], v[140:143], v[24:27], v[92:95]
    v_mov_b32_dpp v245, v249 row_ror:8 row_mask:0xf bank_mask:0xc
    v_mfma_f32_16x16x32_bf16 v[80:83], v[128:131], v[24:27], v[80:83]
    v_mov_b32_dpp v246, v250 row_ror:8 row_mask:0xf bank_mask:0xc
    v_mfma_f32_16x16x32_bf16 v[84:87], v[132:135], v[24:27], v[84:87]
    v_mov_b32_dpp v247, v251 row_ror:8 row_mask:0xf bank_mask:0xc
    s_waitcnt lgkmcnt(4)
    v_mfma_f32_16x16x32_bf16 v[88:91], v[152:155], v[28:31], v[88:91]
    v_mfma_f32_16x16x32_bf16 v[92:95], v[156:159], v[28:31], v[92:95]
    v_mfma_f32_16x16x32_bf16 v[80:83], v[144:147], v[28:31], v[80:83]
    v_mfma_f32_16x16x32_bf16 v[84:87], v[148:151], v[28:31], v[84:87]
    s_waitcnt lgkmcnt(3)
    v_mfma_f32_16x16x32_bf16 v[88:91], v[168:171], v[32:35], v[88:91]
    v_mfma_f32_16x16x32_bf16 v[92:95], v[172:175], v[32:35], v[92:95]
    v_mfma_f32_16x16x32_bf16 v[80:83], v[160:163], v[32:35], v[80:83]
    v_mfma_f32_16x16x32_bf16 v[84:87], v[164:167], v[32:35], v[84:87]
    s_waitcnt lgkmcnt(2)
    v_mfma_f32_16x16x32_bf16 v[88:91], v[184:187], v[36:39], v[88:91]
    v_mfma_f32_16x16x32_bf16 v[92:95], v[188:191], v[36:39], v[92:95]
    v_mfma_f32_16x16x32_bf16 v[80:83], v[176:179], v[36:39], v[80:83]
    v_mfma_f32_16x16x32_bf16 v[84:87], v[180:183], v[36:39], v[84:87]
    s_waitcnt lgkmcnt(1)
    v_mfma_f32_16x16x32_bf16 v[88:91], v[200:203], v[44:47], v[88:91]
    v_mfma_f32_16x16x32_bf16 v[92:95], v[204:207], v[44:47], v[92:95]
    v_mfma_f32_16x16x32_bf16 v[80:83], v[192:195], v[44:47], v[80:83]
    v_mfma_f32_16x16x32_bf16 v[84:87], v[196:199], v[44:47], v[84:87]
    s_waitcnt lgkmcnt(0)
    v_mfma_f32_16x16x32_bf16 v[88:91], v[216:219], v[252:255], v[88:91]
    v_mfma_f32_16x16x32_bf16 v[92:95], v[220:223], v[252:255], v[92:95]
    v_mfma_f32_16x16x32_bf16 v[80:83], v[208:211], v[252:255], v[80:83]
    v_mfma_f32_16x16x32_bf16 v[84:87], v[212:215], v[252:255], v[84:87]
    s_nop 4
    v_cvt_pk_bf16_f32 v228, v88, v89
    v_cvt_pk_bf16_f32 v229, v90, v91
    v_cvt_pk_bf16_f32 v230, v92, v93
    v_cvt_pk_bf16_f32 v231, v94, v95
    v_cvt_pk_bf16_f32 v224, v80, v81
    v_cvt_pk_bf16_f32 v225, v82, v83
    v_cvt_pk_bf16_f32 v226, v84, v85
    v_cvt_pk_bf16_f32 v227, v86, v87
    v_cvt_pk_bf16_f32 v240, v80, v81
    v_cvt_pk_bf16_f32 v241, v82, v83
    v_cvt_pk_bf16_f32 v242, v84, v85
    v_cvt_pk_bf16_f32 v243, v86, v87
    v_mov_b32_dpp v224, v228 row_ror:8 row_mask:0xf bank_mask:0xc
    v_mov_b32_dpp v225, v229 row_ror:8 row_mask:0xf bank_mask:0xc
    v_mov_b32_dpp v226, v230 row_ror:8 row_mask:0xf bank_mask:0xc
    v_mov_b32_dpp v227, v231 row_ror:8 row_mask:0xf bank_mask:0xc
    v_mov_b32_dpp v228, v240 row_ror:8 row_mask:0xf bank_mask:0x3
    v_mov_b32_dpp v229, v241 row_ror:8 row_mask:0xf bank_mask:0x3
    v_mov_b32_dpp v230, v242 row_ror:8 row_mask:0xf bank_mask:0x3
    v_mov_b32_dpp v231, v243 row_ror:8 row_mask:0xf bank_mask:0x3
L_prog_28:
    ds_read_b128 v[16:19], v5 offset:48
    s_waitcnt lgkmcnt(0)
    v_min3_u32 v16, v16, v17, v18
    v_min_u32 v16, v16, v19
    v_cmp_gt_u32 vcc, 1, v16
    s_cbranch_vccnz L_retry_29
    s_setprio 2
    buffer_store_dwordx4 v[244:247], v0, s[48:51], s78 offen sc1
    buffer_store_dwordx4 v[224:227], v0, s[48:51], s74 offen sc1
    buffer_store_dwordx4 v[228:231], v0, s[48:51], s75 offen sc1
    s_setprio 0
L_prog_30:
    ds_read_b128 v[16:19], v5 offset:32
    s_waitcnt lgkmcnt(0)
    v_min3_u32 v16, v16, v17, v18
    v_min_u32 v16, v16, v19
    v_cmp_gt_u32 vcc, 5, v16
    s_cbranch_vccnz L_retry_31
    s_setprio 2
    ds_read_b128 v[16:19], v7 offset:50176
    ds_read_b128 v[20:23], v8 offset:50176
    ds_read_b128 v[24:27], v9 offset:50176
    ds_read_b128 v[28:31], v10 offset:50176
    ds_read_b128 v[32:35], v40 offset:50176
    ds_read_b128 v[36:39], v41 offset:50176
    ds_read_b128 v[44:47], v42 offset:50176
    ds_read_b128 v[252:255], v43 offset:50176
    s_waitcnt lgkmcnt(7)
    v_mfma_f32_16x16x32_bf16 v[104:107], v[56:59], v[16:19], v[104:107]
    v_mfma_f32_16x16x32_bf16 v[108:111], v[60:63], v[16:19], v[108:111]
    v_mfma_f32_16x16x32_bf16 v[96:99], v[48:51], v[16:19], v[96:99]
    v_mfma_f32_16x16x32_bf16 v[100:103], v[52:55], v[16:19], v[100:103]
    s_waitcnt lgkmcnt(6)
    v_mfma_f32_16x16x32_bf16 v[104:107], v[72:75], v[20:23], v[104:107]
    v_mfma_f32_16x16x32_bf16 v[108:111], v[76:79], v[20:23], v[108:111]
    v_mfma_f32_16x16x32_bf16 v[96:99], v[64:67], v[20:23], v[96:99]
    v_mfma_f32_16x16x32_bf16 v[100:103], v[68:71], v[20:23], v[100:103]
    s_waitcnt lgkmcnt(5)
    v_mfma_f32_16x16x32_bf16 v[104:107], v[136:139], v[24:27], v[104:107]
    v_mfma_f32_16x16x32_bf16 v[108:111], v[140:143], v[24:27], v[108:111]
    v_mfma_f32_16x16x32_bf16 v[96:99], v[128:131], v[24:27], v[96:99]
    v_mfma_f32_16x16x32_bf16 v[100:103], v[132:135], v[24:27], v[100:103]
    s_waitcnt lgkmcnt(4)
    v_mfma_f32_16x16x32_bf16 v[104:107], v[152:155], v[28:31], v[104:107]
    v_mfma_f32_16x16x32_bf16 v[108:111], v[156:159], v[28:31], v[108:111]
    v_mfma_f32_16x16x32_bf16 v[96:99], v[144:147], v[28:31], v[96:99]
    v_mfma_f32_16x16x32_bf16 v[100:103], v[148:151], v[28:31], v[100:103]
    s_waitcnt lgkmcnt(3)
    v_mfma_f32_16x16x32_bf16 v[104:107], v[168:171], v[32:35], v[104:107]
    v_mfma_f32_16x16x32_bf16 v[108:111], v[172:175], v[32:35], v[108:111]
    v_mfma_f32_16x16x32_bf16 v[96:99], v[160:163], v[32:35], v[96:99]
    v_mfma_f32_16x16x32_bf16 v[100:103], v[164:167], v[32:35], v[100:103]
    s_waitcnt lgkmcnt(2)
    v_mfma_f32_16x16x32_bf16 v[104:107], v[184:187], v[36:39], v[104:107]
    v_mfma_f32_16x16x32_bf16 v[108:111], v[188:191], v[36:39], v[108:111]
    v_mfma_f32_16x16x32_bf16 v[96:99], v[176:179], v[36:39], v[96:99]
    v_mfma_f32_16x16x32_bf16 v[100:103], v[180:183], v[36:39], v[100:103]
    s_waitcnt lgkmcnt(1)
    v_mfma_f32_16x16x32_bf16 v[104:107], v[200:203], v[44:47], v[104:107]
    v_mfma_f32_16x16x32_bf16 v[108:111], v[204:207], v[44:47], v[108:111]
    v_mfma_f32_16x16x32_bf16 v[96:99], v[192:195], v[44:47], v[96:99]
    v_mfma_f32_16x16x32_bf16 v[100:103], v[196:199], v[44:47], v[100:103]
    s_waitcnt lgkmcnt(0)
    v_mfma_f32_16x16x32_bf16 v[104:107], v[216:219], v[252:255], v[104:107]
    v_mfma_f32_16x16x32_bf16 v[108:111], v[220:223], v[252:255], v[108:111]
    v_mfma_f32_16x16x32_bf16 v[96:99], v[208:211], v[252:255], v[96:99]
    v_mfma_f32_16x16x32_bf16 v[100:103], v[212:215], v[252:255], v[100:103]
    s_nop 4
    v_cvt_pk_bf16_f32 v236, v104, v105
    v_cvt_pk_bf16_f32 v237, v106, v107
    v_cvt_pk_bf16_f32 v238, v108, v109
    v_cvt_pk_bf16_f32 v239, v110, v111
    v_cvt_pk_bf16_f32 v232, v96, v97
    v_cvt_pk_bf16_f32 v233, v98, v99
    v_cvt_pk_bf16_f32 v234, v100, v101
    v_cvt_pk_bf16_f32 v235, v102, v103
    v_cvt_pk_bf16_f32 v240, v96, v97
    v_cvt_pk_bf16_f32 v241, v98, v99
    v_cvt_pk_bf16_f32 v242, v100, v101
    v_cvt_pk_bf16_f32 v243, v102, v103
    v_mov_b32_dpp v232, v236 row_ror:8 row_mask:0xf bank_mask:0xc
    v_mov_b32_dpp v233, v237 row_ror:8 row_mask:0xf bank_mask:0xc
    v_mov_b32_dpp v234, v238 row_ror:8 row_mask:0xf bank_mask:0xc
    v_mov_b32_dpp v235, v239 row_ror:8 row_mask:0xf bank_mask:0xc
    buffer_store_dwordx4 v[232:235], v0, s[48:51], s76 offen sc1
    v_mov_b32_dpp v236, v240 row_ror:8 row_mask:0xf bank_mask:0x3
    v_mov_b32_dpp v237, v241 row_ror:8 row_mask:0xf bank_mask:0x3
    v_mov_b32_dpp v238, v242 row_ror:8 row_mask:0xf bank_mask:0x3
    v_mov_b32_dpp v239, v243 row_ror:8 row_mask:0xf bank_mask:0x3
    buffer_store_dwordx4 v[236:239], v0, s[48:51], s77 offen sc1
    s_or_b32 s64, s2, s3
    s_cbranch_scc1 L_noepoch_32
    v_mov_b32 v1, s30
    s_mov_b64 exec, 1
    buffer_store_dword v1, v5, s[44:47], 0 offen
L_noepoch_32:
    s_endpgm
L_retry_18:
    s_sub_u32 s100, s100, 1
    s_cbranch_scc1 L_end
    s_sleep 1
    s_branch L_spin_17
L_mre_19:
    s_sub_u32 s100, s100, 1
    s_cbranch_scc1 L_end
    s_sleep 2
    buffer_load_dword v1, v0, s[44:47], s74 offen sc1
    s_waitcnt vmcnt(0)
    s_branch L_mchk_16
L_retry_21:
    s_sub_u32 s100, s100, 1
    s_cbranch_scc1 L_end
    s_sleep 1
    s_branch L_spin_20
L_retry_23:
    s_sub_u32 s100, s100, 1
    s_cbranch_scc1 L_end
    s_sleep 1
    s_branch L_prog_22
L_retry_25:
    s_sub_u32 s100, s100, 1
    s_cbranch_scc1 L_end
    s_sleep 1
    s_branch L_prog_24
L_retry_27:
    s_sub_u32 s100, s100, 1
    s_cbranch_scc1 L_end
    s_sleep 1
    s_branch L_prog_26
L_retry_29:
    s_sub_u32 s100, s100, 1
    s_cbranch_scc1 L_end
    s_sleep 1
    s_branch L_prog_28
L_retry_31:
    s_sub_u32 s100, s100, 1
    s_cbranch_scc1 L_end
    s_branch L_prog_30
L_end:
    s_endpgm
.section .rodata,"a"
.p2align 6
.amdhsa_kernel standalone__hybrid_graph_tf_exphormer__graph_kernel
  .amdhsa_next_free_vgpr 256
  .amdhsa_next_free_sgpr 102
  .amdhsa_accum_offset 256
  .amdhsa_group_segment_fixed_size 0
  .amdhsa_kernarg_size 104
  .amdhsa_user_sgpr_count 2
  .amdhsa_user_sgpr_kernarg_segment_ptr 1
  .amdhsa_system_sgpr_workgroup_id_x 1
  .amdhsa_float_denorm_mode_32 3
.end_amdhsa_kernel
```

```asm
; @launch grid=(253,1,1) block=(512,1,1) lds=161792
.amdgcn_target "amdgcn-amd-amdhsa--gfx950"
.text
.globl standalone__hybrid_graph_tf_exphormer__graph_kernel
.p2align 8
.type standalone__hybrid_graph_tf_exphormer__graph_kernel,@function
standalone__hybrid_graph_tf_exphormer__graph_kernel:
L_begin:
    s_cmp_ge_u32 s2, 253
    s_cbranch_scc1 L_end
    s_load_dwordx16 s[4:19], s[0:1], 0
    s_load_dwordx8 s[20:27], s[0:1], 64
    s_load_dwordx2 s[28:29], s[0:1], 96
    s_cmp_ge_u32 s2, 16
    s_cbranch_scc1 L_nopf
    s_getpc_b64 s[32:33]
L_pc:
    v_lshlrev_b32 v1, 6, v0
    v_min_u32 v1, L_end-L_pc, v1
    global_load_dword v255, v1, s[32:33]
L_nopf:
    v_lshrrev_b32 v1, 6, v0
    v_lshlrev_b32 v8, 4, v0
    v_mov_b32 v12, 1966080
    v_readfirstlane_b32 s3, v1
    v_mov_b32 v13, 1966080
    v_mov_b32 v14, 1966080
    v_mov_b32 v15, 1966080
    ds_write_b128 v8, v[12:15] offset:41984
    ds_write_b128 v8, v[12:15] offset:50176
    v_subrev_u32 v9, 32, v0
    v_cmp_gt_u32 vcc, 20, v9
    v_mul_u32_u24 v9, 264, v9
    v_add_u32 v9, 148480, v9
    v_lshlrev_b32 v10, 2, v0
    v_cndmask_b32 v9, 0, v9, vcc
    v_min_u32 v11, 1020, v10
    ds_write_b32 v11, v9
    v_mov_b32 v16, 1310740000
    v_mov_b32 v17, 1310740000
    v_mov_b32 v18, 1310740000
    v_mov_b32 v19, 1310740000
    v_add_u32 v9, 148480, v8
    ds_write_b128 v9, v[16:19]
    v_and_b32 v2, 63, v0
    v_and_b32 v3, 15, v0
    v_bfe_u32 v4, v0, 4, 2
    v_mov_b32 v5, 0
    v_mov_b32 v6, 1
    s_mov_b32 s100, 67108864
    s_and_b32 s64, s2, 7
    s_lshl_b32 s64, s64, 1
    s_bfe_u32 s65, s2, 0x10003
    s_or_b32 s64, s64, s65
    s_and_b32 s65, s2, 0xf0
    s_or_b32 s64, s64, s65
    s_cmp_lt_u32 s2, 240
    s_cselect_b32 s1, s64, s2
    s_and_b32 s31, s3, 3
    s_cmp_lt_u32 s3, 4
    s_cbranch_scc1 L_gemm
    s_setprio 3
    v_and_b32 v8, 0xfff, v8
    v_and_b32 v9, 0x3ff, v10
    s_lshr_b32 s66, s2, 4
    s_lshl_b32 s66, s66, 3
    s_and_b32 s67, s2, 7
    s_or_b32 s68, s66, s67
    s_mul_i32 s64, s68, 5120
    v_add_u32 v40, s64, v8
    s_add_u32 s64, s64, 4096
    v_add_u32 v41, s64, v9
    v_lshrrev_b32 v42, 2, v3
    v_and_b32 v43, 3, v3
    v_lshl_add_u32 v46, v42, 3, v43
    v_lshl_add_u32 v42, v42, 4, v43
    s_lshl_b32 s64, s31, 1
    v_mov_b32 v43, s64
    v_lshlrev_b32 v44, 1, v43
    v_cmp_gt_u32 vcc, 8, v3
    s_mul_i32 s65, s1, 640
    v_lshlrev_b32 v7, 4, v3
    v_cndmask_b32 v43, v43, v44, vcc
    v_add_lshl_u32 v42, v42, v43, 4
    v_lshl_add_u32 v42, v4, 2, v42
    v_add_u32 v42, s65, v42
    v_min_u32 v42, 159996, v42
    s_bitcmp1_b32 s2, 3
    s_cbranch_scc0 L_mrole_1
    s_waitcnt lgkmcnt(0)
    global_load_dword v0, v42, s[10:11]
    global_load_dwordx4 v[48:51], v40, s[8:9]
    global_load_dword v52, v41, s[8:9]
    global_load_dwordx4 v[56:59], v40, s[6:7]
    global_load_dword v60, v41, s[6:7]
L_roled_2:
    s_mov_b32 s27, s68
    s_mov_b32 s26, 0
    s_cmp_lg_u32 s31, 0
    s_cbranch_scc1 L_roled_2_b
    s_load_dword s30, s[28:29], 0
L_roled_2_b:
    s_barrier
    s_mov_b32 s32, s4
    s_and_b32 s33, s5, 0xffff
    s_mov_b32 s34, 5120000
    s_mov_b32 s35, 0x20000
    s_mov_b32 s36, s14
    s_and_b32 s37, s15, 0xffff
    s_mov_b32 s38, 20000
    s_mov_b32 s39, 0x20000
    s_add_u32 s40, s28, 1048576
    s_addc_u32 s41, s29, 0
    s_and_b32 s41, s41, 0xffff
    s_mov_b32 s42, 2048000
    s_mov_b32 s43, 0x20000
    v_and_b32 v40, 8, v3
    v_lshlrev_b32 v40, 1, v40
    v_mov_b32 v41, 0xffff
    v_lshlrev_b32 v40, v40, v41
    s_mov_b32 s64, 0x0f0f0f0f
    s_mov_b32 s65, 0x0f0f0f0f
    v_cndmask_b32 v12, 0, v40, s[64:65]
    v_xor_b32 v13, v40, v12
    v_and_b32 v14, 3, v3
    v_mul_u32_u24 v14, 0x5555, v14
    s_cmp_lg_u32 s31, 0
    s_cbranch_scc1 L_tagged_3
    s_waitcnt lgkmcnt(0)
    s_mul_i32 s30, s30, 0x9E3779B1
    s_add_u32 s30, s30, 0x7F4A7C15
    v_mov_b32 v40, 1
    v_mov_b32 v41, s30
    ds_write_b64 v5, v[40:41] offset:8
L_tagged_3:
    s_bitcmp1_b32 s2, 3
    s_cbranch_scc0 L_mwork_4
    v_mov_b32 v43, 4
    v_mov_b32 v44, 2031616
    s_mov_b32 s64, 0x3f0001
    v_lshrrev_b32 v40, 7, v8
    v_and_b32 v41, 0x70, v8
    v_lshl_add_u32 v40, v40, 14, v41
    s_lshl_b32 s65, s27, 7
    s_waitcnt vmcnt(2)
    v_mul_u32_u24 v64, 52429, v48
    v_lshrrev_b32 v72, 22, v64
    v_lshlrev_b32 v80, 2, v72
    ds_add_rtn_u32 v80, v80, v43 offset:512
    v_mul_u32_u24 v65, 52429, v49
    v_lshrrev_b32 v73, 22, v65
    v_lshlrev_b32 v81, 2, v73
    ds_add_rtn_u32 v81, v81, v43 offset:512
    v_mul_u32_u24 v66, 52429, v50
    v_lshrrev_b32 v74, 22, v66
    v_lshlrev_b32 v82, 2, v74
    ds_add_rtn_u32 v82, v82, v43 offset:512
    v_mul_u32_u24 v67, 52429, v51
    v_lshrrev_b32 v75, 22, v67
    v_lshlrev_b32 v83, 2, v75
    ds_add_rtn_u32 v83, v83, v43 offset:512
    v_mul_u32_u24 v68, 52429, v52
    v_lshrrev_b32 v76, 22, v68
    v_lshlrev_b32 v84, 2, v76
    ds_add_rtn_u32 v84, v84, v43 offset:512
    v_lshrrev_b32 v64, 21, v64
    v_mad_u32_u24 v64, v64, 24, v48
    v_mul_u32_u24 v64, 0x8001, v64
    v_and_b32 v88, 7, v72
    v_lshl_or_b32 v72, v72, 3, v88
    v_lshlrev_b32 v72, 4, v72
    v_lshrrev_b32 v65, 21, v65
    v_mad_u32_u24 v65, v65, 24, v49
    v_mul_u32_u24 v65, 0x8001, v65
    v_and_b32 v89, 7, v73
    v_lshl_or_b32 v73, v73, 3, v89
    v_lshlrev_b32 v73, 4, v73
    v_lshrrev_b32 v66, 21, v66
    v_mad_u32_u24 v66, v66, 24, v50
    v_mul_u32_u24 v66, 0x8001, v66
    v_and_b32 v90, 7, v74
    v_lshl_or_b32 v74, v74, 3, v90
    v_lshlrev_b32 v74, 4, v74
    v_lshrrev_b32 v67, 21, v67
    v_mad_u32_u24 v67, v67, 24, v51
    v_mul_u32_u24 v67, 0x8001, v67
    v_and_b32 v91, 7, v75
    v_lshl_or_b32 v75, v75, 3, v91
    v_lshlrev_b32 v75, 4, v75
    v_lshrrev_b32 v68, 21, v68
    v_mad_u32_u24 v68, v68, 24, v52
    v_mul_u32_u24 v68, 0x8001, v68
    v_and_b32 v92, 7, v76
    v_lshl_or_b32 v76, v76, 3, v92
    v_lshlrev_b32 v76, 4, v76
    s_waitcnt vmcnt(0)
    v_lshlrev_b32 v56, 1, v56
    v_and_or_b32 v64, v64, s64, v56
    v_lshlrev_b32 v57, 1, v57
    v_and_or_b32 v65, v65, s64, v57
    v_lshlrev_b32 v58, 1, v58
    v_and_or_b32 v66, v66, s64, v58
    v_lshlrev_b32 v59, 1, v59
    v_and_or_b32 v67, v67, s64, v59
    v_lshlrev_b32 v60, 1, v60
    v_and_or_b32 v68, v68, s64, v60
    s_waitcnt lgkmcnt(0)
    v_cmp_gt_u32 vcc, 124, v80
    v_min_u32 v80, 124, v80
    v_xor_b32 v80, v80, v72
    v_cndmask_b32 v64, v44, v64, vcc
    ds_write_b32 v80, v64 offset:41984
    v_cmp_gt_u32 vcc, 124, v81
    v_min_u32 v81, 124, v81
    v_xor_b32 v81, v81, v73
    v_cndmask_b32 v65, v44, v65, vcc
    ds_write_b32 v81, v65 offset:41984
    v_cmp_gt_u32 vcc, 124, v82
    v_min_u32 v82, 124, v82
    v_xor_b32 v82, v82, v74
    v_cndmask_b32 v66, v44, v66, vcc
    ds_write_b32 v82, v66 offset:41984
    v_cmp_gt_u32 vcc, 124, v83
    v_min_u32 v83, 124, v83
    v_xor_b32 v83, v83, v75
    v_cndmask_b32 v67, v44, v67, vcc
    ds_write_b32 v83, v67 offset:41984
    v_cmp_gt_u32 vcc, 124, v84
    v_min_u32 v84, 124, v84
    v_xor_b32 v84, v84, v76
    v_cndmask_b32 v68, v44, v68, vcc
    ds_write_b32 v84, v68 offset:41984
    s_waitcnt lgkmcnt(0)
    s_mov_b64 exec, 1
    ds_add_u32 v5, v6 offset:0
    s_mov_b64 exec, -1
L_spin_6:
    ds_read_b128 v[44:47], v5
    s_waitcnt lgkmcnt(0)
    v_readfirstlane_b32 s101, v44
    v_readfirstlane_b32 s30, v47
    s_cmp_ge_u32 s101, 4
    s_cbranch_scc0 L_retry_7
    ds_read_b128 v[48:51], v8 offset:41984
    ds_read_b128 v[52:55], v8 offset:46080
    ds_read_b128 v[56:59], v8 offset:50176
    ds_read_b128 v[60:63], v8 offset:54272
    s_and_b32 s44, s30, 0xffc00000
    s_lshl_b32 s45, s30, 10
    s_and_b32 s45, s45, 0xffc00000
    s_lshl_b32 s46, s30, 20
    s_and_b32 s46, s46, 0xffc00000
    s_lshl_b32 s47, s30, 22
    s_waitcnt lgkmcnt(3)
    v_or_b32 v48, s44, v48
    v_or_b32 v49, s45, v49
    v_or_b32 v50, s46, v50
    v_or_b32 v51, s47, v51
    buffer_store_dwordx4 v[48:51], v40, s[40:43], s65 offen sc1
    s_add_u32 s65, s65, 0x80000
    s_waitcnt lgkmcnt(2)
    v_or_b32 v52, s44, v52
    v_or_b32 v53, s45, v53
    v_or_b32 v54, s46, v54
    v_or_b32 v55, s47, v55
    buffer_store_dwordx4 v[52:55], v40, s[40:43], s65 offen sc1
    s_add_u32 s65, s65, 0x80000
    s_waitcnt lgkmcnt(1)
    v_or_b32 v56, s44, v56
    v_or_b32 v57, s45, v57
    v_or_b32 v58, s46, v58
    v_or_b32 v59, s47, v59
    buffer_store_dwordx4 v[56:59], v40, s[40:43], s65 offen sc1
    s_add_u32 s65, s65, 0x80000
    s_waitcnt lgkmcnt(0)
    v_or_b32 v60, s44, v60
    v_or_b32 v61, s45, v61
    v_or_b32 v62, s46, v62
    v_or_b32 v63, s47, v63
    buffer_store_dwordx4 v[60:63], v40, s[40:43], s65 offen sc1
    s_cmp_ge_u32 s2, 250
    s_cbranch_scc1 L_end
    s_waitcnt vmcnt(4)
L_worked_5:
    v_lshlrev_b32 v0, 9, v0
    s_setprio 1
    s_lshl_b32 s64, s31, 10
    s_lshr_b32 s10, s1, 1
    s_lshl_b32 s10, s10, 14
    s_add_u32 s11, s10, 4096
    s_add_u32 s12, s10, 8192
    s_add_u32 s13, s10, 12288
    v_cmp_gt_u32 vcc, 0xe80, v8
    s_mov_b64 s[14:15], vcc
    v_add_u32_dpp v9, v0, v7 row_newbcast:0 row_mask:0xf bank_mask:0xf
    buffer_load_dwordx4 v[176:179], v9, s[32:35], 0 offen offset:0
    buffer_load_dwordx4 v[180:183], v9, s[32:35], 0 offen offset:256
    v_add_u32_dpp v9, v0, v7 row_newbcast:1 row_mask:0xf bank_mask:0xf
    buffer_load_dwordx4 v[184:187], v9, s[32:35], 0 offen offset:0
    buffer_load_dwordx4 v[188:191], v9, s[32:35], 0 offen offset:256
    s_cmp_eq_u32 s26, 0
    s_cbranch_scc1 L_flagged_8
    s_waitcnt vmcnt(4)
    s_mov_b64 exec, 65535
    global_store_dword v41, v42, s[28:29] sc1
    s_mov_b64 exec, -1
L_flagged_8:
    s_add_u32 m0, s64, 62464
    s_mov_b32 s65, 0
    buffer_load_dwordx4 v8, s[36:39], s65 offen lds
    v_add_u32_dpp v9, v0, v7 row_newbcast:2 row_mask:0xf bank_mask:0xf
    s_waitcnt vmcnt(2)
    buffer_load_dwordx4 v[192:195], v9, s[32:35], 0 offen offset:0
    buffer_load_dwordx4 v[196:199], v9, s[32:35], 0 offen offset:256
    s_add_u32 m0, s64, 66560
    s_mov_b32 s65, 4096
    buffer_load_dwordx4 v8, s[36:39], s65 offen lds
    v_add_u32_dpp v9, v0, v7 row_newbcast:3 row_mask:0xf bank_mask:0xf
    s_waitcnt vmcnt(2)
    buffer_load_dwordx4 v[200:203], v9, s[32:35], 0 offen offset:0
    buffer_load_dwordx4 v[204:207], v9, s[32:35], 0 offen offset:256
    v_add_u32_dpp v9, v0, v7 row_newbcast:4 row_mask:0xf bank_mask:0xf
    s_waitcnt vmcnt(2)
    buffer_load_dwordx4 v[208:211], v9, s[32:35], 0 offen offset:0
    buffer_load_dwordx4 v[212:215], v9, s[32:35], 0 offen offset:256
    s_add_u32 m0, s64, 70656
    s_mov_b32 s65, 8192
    buffer_load_dwordx4 v8, s[36:39], s65 offen lds
    v_add_u32_dpp v9, v0, v7 row_newbcast:5 row_mask:0xf bank_mask:0xf
    s_waitcnt vmcnt(2)
    buffer_load_dwordx4 v[216:219], v9, s[32:35], 0 offen offset:0
    buffer_load_dwordx4 v[220:223], v9, s[32:35], 0 offen offset:256
    s_add_u32 m0, s64, 74752
    s_mov_b32 s65, 12288
    buffer_load_dwordx4 v8, s[36:39], s65 offen lds
    v_add_u32_dpp v9, v0, v7 row_newbcast:6 row_mask:0xf bank_mask:0xf
    s_waitcnt vmcnt(2)
    buffer_load_dwordx4 v[224:227], v9, s[32:35], 0 offen offset:0
    buffer_load_dwordx4 v[228:231], v9, s[32:35], 0 offen offset:256
    s_add_u32 m0, s64, 78848
    s_mov_b32 s65, 16384
    buffer_load_dwordx4 v8, s[36:39], s65 offen lds
L_ipoll_9:
    buffer_load_dwordx4 v[48:51], v8, s[40:43], s10 offen sc1
    buffer_load_dwordx4 v[52:55], v8, s[40:43], s11 offen sc1
    buffer_load_dwordx4 v[56:59], v8, s[40:43], s12 offen sc1
    s_mov_b64 exec, s[14:15]
    buffer_load_dwordx4 v[60:63], v8, s[40:43], s13 offen sc1
    s_mov_b64 exec, -1
L_spin_10:
    ds_read_b128 v[44:47], v5
    s_waitcnt lgkmcnt(0)
    v_readfirstlane_b32 s101, v46
    v_readfirstlane_b32 s30, v47
    s_cmp_ge_u32 s101, 1
    s_cbranch_scc0 L_retry_11
    s_and_b32 s44, s30, 0xffc00000
    s_lshl_b32 s45, s30, 10
    s_and_b32 s45, s45, 0xffc00000
    s_lshl_b32 s46, s30, 20
    s_and_b32 s46, s46, 0xffc00000
    s_lshl_b32 s47, s30, 22
    s_and_b32 s64, s1, 1
    s_lshl_b32 s64, s64, 21
    s_or_b32 s44, s44, s64
    v_mov_b32 v76, 1966080
    s_or_b32 s45, s45, s64
    v_mov_b32 v77, 1966080
    s_or_b32 s46, s46, s64
    v_mov_b32 v78, 1966080
    s_or_b32 s47, s47, s64
    v_mov_b32 v79, 1966080
    s_mov_b32 s16, 1310720
    v_mov_b32 v42, 2
    s_waitcnt vmcnt(3)
    v_xor_b32 v64, s44, v48
    v_xor_b32 v65, s45, v49
    v_xor_b32 v66, s46, v50
    v_xor_b32 v67, s47, v51
    v_or3_b32 v40, v64, v65, v66
    v_or_b32 v40, v40, v67
    v_cmp_gt_u32 s[48:49], s16, v64
    v_lshlrev_b32_sdwa v80, 2, v64 dst_sel:DWORD dst_unused:UNUSED_PAD src0_sel:DWORD src1_sel:WORD_1
    v_cmp_gt_u32 s[50:51], s16, v65
    v_lshlrev_b32_sdwa v81, 2, v65 dst_sel:DWORD dst_unused:UNUSED_PAD src0_sel:DWORD src1_sel:WORD_1
    v_cmp_gt_u32 s[52:53], s16, v66
    v_lshlrev_b32_sdwa v82, 2, v66 dst_sel:DWORD dst_unused:UNUSED_PAD src0_sel:DWORD src1_sel:WORD_1
    v_cmp_gt_u32 s[54:55], s16, v67
    v_lshlrev_b32_sdwa v83, 2, v67 dst_sel:DWORD dst_unused:UNUSED_PAD src0_sel:DWORD src1_sel:WORD_1
    s_waitcnt vmcnt(2)
    v_xor_b32 v68, s44, v52
    v_xor_b32 v69, s45, v53
    v_xor_b32 v70, s46, v54
    v_xor_b32 v71, s47, v55
    v_or3_b32 v40, v40, v68, v69
    v_or3_b32 v40, v40, v70, v71
    v_cmp_gt_u32 s[56:57], s16, v68
    v_lshlrev_b32_sdwa v84, 2, v68 dst_sel:DWORD dst_unused:UNUSED_PAD src0_sel:DWORD src1_sel:WORD_1
    v_cmp_gt_u32 s[58:59], s16, v69
    v_lshlrev_b32_sdwa v85, 2, v69 dst_sel:DWORD dst_unused:UNUSED_PAD src0_sel:DWORD src1_sel:WORD_1
    v_cmp_gt_u32 s[60:61], s16, v70
    v_lshlrev_b32_sdwa v86, 2, v70 dst_sel:DWORD dst_unused:UNUSED_PAD src0_sel:DWORD src1_sel:WORD_1
    v_cmp_gt_u32 s[62:63], s16, v71
    v_lshlrev_b32_sdwa v87, 2, v71 dst_sel:DWORD dst_unused:UNUSED_PAD src0_sel:DWORD src1_sel:WORD_1
    s_waitcnt vmcnt(1)
    v_xor_b32 v72, s44, v56
    v_xor_b32 v73, s45, v57
    v_xor_b32 v74, s46, v58
    v_xor_b32 v75, s47, v59
    v_or3_b32 v40, v40, v72, v73
    v_or3_b32 v40, v40, v74, v75
    v_cmp_gt_u32 s[64:65], s16, v72
    v_lshlrev_b32_sdwa v88, 2, v72 dst_sel:DWORD dst_unused:UNUSED_PAD src0_sel:DWORD src1_sel:WORD_1
    v_cmp_gt_u32 s[66:67], s16, v73
    v_lshlrev_b32_sdwa v89, 2, v73 dst_sel:DWORD dst_unused:UNUSED_PAD src0_sel:DWORD src1_sel:WORD_1
    v_cmp_gt_u32 s[68:69], s16, v74
    v_lshlrev_b32_sdwa v90, 2, v74 dst_sel:DWORD dst_unused:UNUSED_PAD src0_sel:DWORD src1_sel:WORD_1
    v_cmp_gt_u32 s[70:71], s16, v75
    v_lshlrev_b32_sdwa v91, 2, v75 dst_sel:DWORD dst_unused:UNUSED_PAD src0_sel:DWORD src1_sel:WORD_1
    s_waitcnt vmcnt(0)
    s_mov_b64 exec, s[14:15]
    v_xor_b32 v76, s44, v60
    v_xor_b32 v77, s45, v61
    v_xor_b32 v78, s46, v62
    v_xor_b32 v79, s47, v63
    s_mov_b64 exec, -1
    v_or3_b32 v40, v40, v76, v77
    v_or3_b32 v40, v40, v78, v79
    v_cmp_gt_u32 s[72:73], s16, v76
    v_lshlrev_b32_sdwa v92, 2, v76 dst_sel:DWORD dst_unused:UNUSED_PAD src0_sel:DWORD src1_sel:WORD_1
    v_cmp_gt_u32 s[74:75], s16, v77
    v_lshlrev_b32_sdwa v93, 2, v77 dst_sel:DWORD dst_unused:UNUSED_PAD src0_sel:DWORD src1_sel:WORD_1
    v_cmp_gt_u32 s[76:77], s16, v78
    v_lshlrev_b32_sdwa v94, 2, v78 dst_sel:DWORD dst_unused:UNUSED_PAD src0_sel:DWORD src1_sel:WORD_1
    v_cmp_gt_u32 s[78:79], s16, v79
    v_lshlrev_b32_sdwa v95, 2, v79 dst_sel:DWORD dst_unused:UNUSED_PAD src0_sel:DWORD src1_sel:WORD_1
    v_cmp_le_u32 vcc, 0x400000, v40
    s_cbranch_vccnz L_retry_12
    s_mov_b64 exec, s[48:49]
    ds_add_rtn_u32 v80, v80, v42 offset:128
    s_mov_b64 exec, s[50:51]
    ds_add_rtn_u32 v81, v81, v42 offset:128
    s_mov_b64 exec, s[52:53]
    ds_add_rtn_u32 v82, v82, v42 offset:128
    s_mov_b64 exec, s[54:55]
    ds_add_rtn_u32 v83, v83, v42 offset:128
    s_mov_b64 exec, s[56:57]
    ds_add_rtn_u32 v84, v84, v42 offset:128
    s_mov_b64 exec, s[58:59]
    ds_add_rtn_u32 v85, v85, v42 offset:128
    s_mov_b64 exec, s[60:61]
    ds_add_rtn_u32 v86, v86, v42 offset:128
    s_mov_b64 exec, s[62:63]
    ds_add_rtn_u32 v87, v87, v42 offset:128
    s_mov_b64 exec, s[64:65]
    ds_add_rtn_u32 v88, v88, v42 offset:128
    s_mov_b64 exec, s[66:67]
    ds_add_rtn_u32 v89, v89, v42 offset:128
    s_mov_b64 exec, s[68:69]
    ds_add_rtn_u32 v90, v90, v42 offset:128
    s_mov_b64 exec, s[70:71]
    ds_add_rtn_u32 v91, v91, v42 offset:128
    s_mov_b64 exec, s[72:73]
    ds_add_rtn_u32 v92, v92, v42 offset:128
    s_mov_b64 exec, s[74:75]
    ds_add_rtn_u32 v93, v93, v42 offset:128
    s_mov_b64 exec, s[76:77]
    ds_add_rtn_u32 v94, v94, v42 offset:128
    s_mov_b64 exec, s[78:79]
    ds_add_rtn_u32 v95, v95, v42 offset:128
    s_mov_b64 exec, -1
    v_add_u32_dpp v9, v0, v7 row_newbcast:7 row_mask:0xf bank_mask:0xf
    buffer_load_dwordx4 v[232:235], v9, s[32:35], 0 offen offset:0
    buffer_load_dwordx4 v[236:239], v9, s[32:35], 0 offen offset:256
    v_add_u32_dpp v9, v0, v7 row_newbcast:8 row_mask:0xf bank_mask:0xf
    buffer_load_dwordx4 v[240:243], v9, s[32:35], 0 offen offset:0
    buffer_load_dwordx4 v[244:247], v9, s[32:35], 0 offen offset:256
    v_and_b32 v48, 2031616, v67
    v_and_b32 v49, 2031616, v71
    v_and_b32 v50, 2031616, v75
    v_and_b32 v51, 2031616, v79
    v_max3_u32 v48, v48, v49, v50
    v_max_u32 v48, v48, v51
    v_cmp_eq_u32 vcc, 2031616, v48
    s_mov_b64 s[16:17], vcc
    s_waitcnt lgkmcnt(12)
    s_mov_b64 exec, s[48:49]
    ds_write_b16 v80, v64
    s_mov_b64 exec, s[50:51]
    ds_write_b16 v81, v65
    s_mov_b64 exec, s[52:53]
    ds_write_b16 v82, v66
    s_mov_b64 exec, s[54:55]
    ds_write_b16 v83, v67
    s_waitcnt lgkmcnt(12)
    s_mov_b64 exec, s[56:57]
    ds_write_b16 v84, v68
    s_mov_b64 exec, s[58:59]
    ds_write_b16 v85, v69
    s_mov_b64 exec, s[60:61]
    ds_write_b16 v86, v70
    s_mov_b64 exec, s[62:63]
    ds_write_b16 v87, v71
    s_waitcnt lgkmcnt(12)
    s_mov_b64 exec, s[64:65]
    ds_write_b16 v88, v72
    s_mov_b64 exec, s[66:67]
    ds_write_b16 v89, v73
    s_mov_b64 exec, s[68:69]
    ds_write_b16 v90, v74
    s_mov_b64 exec, s[70:71]
    ds_write_b16 v91, v75
    s_waitcnt lgkmcnt(12)
    s_mov_b64 exec, s[72:73]
    ds_write_b16 v92, v76
    s_mov_b64 exec, s[74:75]
    ds_write_b16 v93, v77
    s_mov_b64 exec, s[76:77]
    ds_write_b16 v94, v78
    s_mov_b64 exec, s[78:79]
    ds_write_b16 v95, v79
    s_mov_b64 exec, s[16:17]
    ds_write_b32 v5, v6 offset:20
    s_waitcnt lgkmcnt(0)
    s_mov_b64 exec, 1
    ds_add_u32 v5, v6 offset:16
    s_mov_b64 exec, -1
    v_add_u32_dpp v9, v0, v7 row_newbcast:9 row_mask:0xf bank_mask:0xf
    buffer_load_dwordx4 v[248:251], v9, s[32:35], 0 offen offset:0
    buffer_load_dwordx4 v[252:255], v9, s[32:35], 0 offen offset:256
    s_lshl_b32 s20, s31, 1
    s_add_u32 s21, s20, 1
    s_add_u32 s22, s20, 8
    s_add_u32 s23, s20, 9
    s_add_u32 s24, s31, 16
    v_add_u32 v47, -1, v3
    v_bfe_u32 v40, v47, 1, 1
    v_and_b32 v41, 1, v47
    v_lshl_add_u32 v40, v40, 3, v41
    v_add_u32 v40, s20, v40
    v_mov_b32 v41, s24
    v_cmp_ne_u32 vcc, 0, v3
    v_min_u32 v47, 19, v2
    v_mul_u32_u24 v46, 264, v47
    v_cndmask_b32 v40, v41, v40, vcc
    v_mul_u32_u24 v41, 264, v40
    v_add_u32 v41, 148480, v41
    v_lshlrev_b32 v40, 2, v40
    v_add_u32 v46, 148728, v46
    v_lshlrev_b32 v47, 2, v47
    v_lshlrev_b32 v43, 3, v3
    v_lshl_add_u32 v43, v4, 1, v43
L_spin_13:
    ds_read_b32 v44, v5 offset:16
    s_waitcnt lgkmcnt(0)
    v_readfirstlane_b32 s101, v44
    s_cmp_ge_u32 s101, 4
    s_cbranch_scc0 L_retry_14
    ds_read_b32 v44, v40 offset:128
    ds_read_b32 v47, v47 offset:128
    ds_read_b32 v45, v5 offset:20
    s_waitcnt lgkmcnt(2)
    v_sub_u32 v44, v44, v41
    v_max_u32 v44, 18, v44
    s_waitcnt lgkmcnt(0)
    v_cmp_gt_u32 vcc, v47, v46
    v_add_u32_dpp v48, v44, v44 row_shr:1 row_mask:0xf bank_mask:0xf bound_ctrl:1
    v_readfirstlane_b32 s25, v45
    s_or_b32 s64, vcc_lo, vcc_hi
    v_add_u32_dpp v48, v48, v48 row_shr:2 row_mask:0xf bank_mask:0xf bound_ctrl:1
    s_or_b32 s25, s25, s64
    s_mov_b32 s53, 0
    v_add_u32_dpp v48, v48, v48 row_shr:4 row_mask:0xf bank_mask:0xf bound_ctrl:1
    v_sub_u32 v44, v48, v44
    v_sub_u32 v44, v41, v44
    v_readlane_b32 s10, v48, 0
    v_readlane_b32 s11, v48, 1
    v_readlane_b32 s12, v48, 2
    v_readlane_b32 s13, v48, 3
    v_readlane_b32 s14, v48, 4
    v_add_u32_dpp v160, v44, v43 row_newbcast:0 row_mask:0xf bank_mask:0xf
    v_add_u32_dpp v161, v44, v43 row_newbcast:1 row_mask:0xf bank_mask:0xf
    v_add_u32_dpp v162, v44, v43 row_newbcast:2 row_mask:0xf bank_mask:0xf
    v_add_u32_dpp v163, v44, v43 row_newbcast:3 row_mask:0xf bank_mask:0xf
    v_add_u32_dpp v164, v44, v43 row_newbcast:4 row_mask:0xf bank_mask:0xf
    s_add_u32 s50, s14, 14
    s_lshr_b32 s50, s50, 4
    s_cmp_gt_u32 s50, 32
    s_cselect_b32 s25, 1, s25
    s_max_u32 s50, s50, 12
    v_add_u32 v40, 0, v43
    v_cmp_le_u32 s[64:65], s10, v40
    v_cmp_le_u32 s[66:67], s11, v40
    v_cmp_le_u32 s[68:69], s12, v40
    v_cmp_le_u32 s[70:71], s13, v40
    v_cndmask_b32 v40, v160, v161, s[64:65]
    v_cndmask_b32 v40, v40, v162, s[66:67]
    v_cndmask_b32 v40, v40, v163, s[68:69]
    v_cndmask_b32 v40, v40, v164, s[70:71]
    ds_read_u16 v40, v40 offset:0
    v_add_u32 v41, 128, v43
    v_cmp_le_u32 s[64:65], s10, v41
    v_cmp_le_u32 s[66:67], s11, v41
    v_cmp_le_u32 s[68:69], s12, v41
    v_cmp_le_u32 s[70:71], s13, v41
    v_cndmask_b32 v41, v160, v161, s[64:65]
    v_cndmask_b32 v41, v41, v162, s[66:67]
    v_cndmask_b32 v41, v41, v163, s[68:69]
    v_cndmask_b32 v41, v41, v164, s[70:71]
    ds_read_u16 v41, v41 offset:128
    v_add_u32 v42, 256, v43
    v_cmp_le_u32 s[64:65], s10, v42
    v_cmp_le_u32 s[66:67], s11, v42
    v_cmp_le_u32 s[68:69], s12, v42
    v_cmp_le_u32 s[70:71], s13, v42
    v_cndmask_b32 v42, v160, v161, s[64:65]
    v_cndmask_b32 v42, v42, v162, s[66:67]
    v_cndmask_b32 v42, v42, v163, s[68:69]
    v_cndmask_b32 v42, v42, v164, s[70:71]
    ds_read_u16 v42, v42 offset:256
    v_add_u32 v43, 384, v43
    v_cmp_le_u32 s[64:65], s10, v43
    v_cmp_le_u32 s[66:67], s11, v43
    v_cmp_le_u32 s[68:69], s12, v43
    v_cmp_le_u32 s[70:71], s13, v43
    v_cndmask_b32 v43, v160, v161, s[64:65]
    v_cndmask_b32 v43, v43, v162, s[66:67]
    v_cndmask_b32 v43, v43, v163, s[68:69]
    v_cndmask_b32 v43, v43, v164, s[70:71]
    ds_read_u16 v43, v43 offset:384
    s_waitcnt lgkmcnt(3)
    v_and_b32 v32, 0x7ffe, v40
    ds_read_u16 v33, v32 offset:62464
    v_lshlrev_b32 v32, 8, v32
    v_lshlrev_b32 v40, 4, v40
    s_waitcnt lgkmcnt(3)
    v_and_b32 v34, 0x7ffe, v41
    ds_read_u16 v35, v34 offset:62464
    v_lshlrev_b32 v34, 8, v34
    v_lshlrev_b32 v41, 4, v41
    s_waitcnt lgkmcnt(3)
    v_and_b32 v36, 0x7ffe, v42
    ds_read_u16 v37, v36 offset:62464
    v_lshlrev_b32 v36, 8, v36
    v_lshlrev_b32 v42, 4, v42
    s_waitcnt lgkmcnt(3)
    v_and_b32 v38, 0x7ffe, v43
    ds_read_u16 v39, v38 offset:62464
    v_lshlrev_b32 v38, 8, v38
    v_lshlrev_b32 v43, 4, v43
    v_add_u32_dpp v11, v32, v7 row_newbcast:0 row_mask:0xf bank_mask:0xf
    buffer_load_dwordx4 v[48:51], v11, s[32:35], 0 offen offset:0
    buffer_load_dwordx4 v[56:59], v11, s[32:35], 0 offen offset:256
    v_add_u32_dpp v11, v32, v7 row_newbcast:1 row_mask:0xf bank_mask:0xf
    buffer_load_dwordx4 v[52:55], v11, s[32:35], 0 offen offset:0
    buffer_load_dwordx4 v[60:63], v11, s[32:35], 0 offen offset:256
    v_add_u32_dpp v11, v32, v7 row_newbcast:2 row_mask:0xf bank_mask:0xf
    buffer_load_dwordx4 v[64:67], v11, s[32:35], 0 offen offset:0
    buffer_load_dwordx4 v[72:75], v11, s[32:35], 0 offen offset:256
    v_add_u32_dpp v11, v32, v7 row_newbcast:3 row_mask:0xf bank_mask:0xf
    buffer_load_dwordx4 v[68:71], v11, s[32:35], 0 offen offset:0
    buffer_load_dwordx4 v[76:79], v11, s[32:35], 0 offen offset:256
    v_add_u32_dpp v11, v32, v7 row_newbcast:4 row_mask:0xf bank_mask:0xf
    buffer_load_dwordx4 v[80:83], v11, s[32:35], 0 offen offset:0
    buffer_load_dwordx4 v[88:91], v11, s[32:35], 0 offen offset:256
    v_add_u32_dpp v11, v32, v7 row_newbcast:5 row_mask:0xf bank_mask:0xf
    buffer_load_dwordx4 v[84:87], v11, s[32:35], 0 offen offset:0
    buffer_load_dwordx4 v[92:95], v11, s[32:35], 0 offen offset:256
    s_mov_b32 s57, 0
    s_sub_u32 s64, s14, 18
    s_lshr_b32 s65, s64, 4
    s_bitset1_b32 s53, s65
    s_and_b32 s64, s64, 14
    s_lshl4_add_u32 s57, s57, s64
    s_and_b32 s65, s24, 7
    s_lshl_b32 s65, s65, 5
    s_lshl_b32 s19, s24, 10
    s_or_b32 s19, s19, s65
    s_sub_u32 s64, s13, 18
    s_lshr_b32 s65, s64, 4
    s_bitset1_b32 s53, s65
    s_and_b32 s64, s64, 14
    s_lshl4_add_u32 s57, s57, s64
    s_and_b32 s65, s23, 7
    s_lshl_b32 s65, s65, 5
    s_lshl_b32 s18, s23, 10
    s_or_b32 s18, s18, s65
    s_sub_u32 s64, s12, 18
    s_lshr_b32 s65, s64, 4
    s_bitset1_b32 s53, s65
    s_and_b32 s64, s64, 14
    s_lshl4_add_u32 s57, s57, s64
    s_and_b32 s65, s22, 7
    s_lshl_b32 s65, s65, 5
    s_lshl_b32 s17, s22, 10
    s_or_b32 s17, s17, s65
    s_sub_u32 s64, s11, 18
    s_lshr_b32 s65, s64, 4
    s_bitset1_b32 s53, s65
    s_and_b32 s64, s64, 14
    s_lshl4_add_u32 s57, s57, s64
    s_and_b32 s65, s21, 7
    s_lshl_b32 s65, s65, 5
    s_lshl_b32 s16, s21, 10
    s_or_b32 s16, s16, s65
    s_sub_u32 s64, s10, 18
    s_lshr_b32 s65, s64, 4
    s_bitset1_b32 s53, s65
    s_and_b32 s64, s64, 14
    s_lshl4_add_u32 s57, s57, s64
    s_and_b32 s65, s20, 7
    s_lshl_b32 s65, s65, 5
    s_lshl_b32 s15, s20, 10
    s_or_b32 s15, s15, s65
    s_sub_u32 s64, s50, 5
    s_lshl_b32 s56, 1, s64
    s_or_b32 s52, s56, s53
    v_and_b32 v46, 1, v3
    v_lshl_add_u32 v46, v4, 1, v46
    v_and_b32 v46, 3, v46
    v_and_b32 v47, 14, v3
    v_lshl_add_u32 v46, v46, 4, v47
    v_lshrrev_b32 v47, 1, v4
    v_add_lshl_u32 v46, v46, v47, 2
    v_lshrrev_b32 v44, 1, v4
    v_mul_u32_u24 v44, 528, v44
    v_xor_b32 v44, v44, v7
    v_and_b32 v45, 1, v4
    v_lshl_or_b32 v2, v45, 3, v44
    v_xor_b32 v144, s15, v7
    v_xor_b32 v146, s16, v7
    v_xor_b32 v148, s19, v7
    v_xor_b32 v145, 528, v144
    v_xor_b32 v147, 528, v146
    v_xor_b32 v149, 528, v148
    s_mul_i32 s64, s1, 80
    s_add_u32 s64, s64, 62464
    v_and_b32 v45, 2, v4
    v_add_u32 v0, s64, v45
    s_getpc_b64 s[72:73]
L_anc:
    v_lshlrev_b32 v4, 2, v4
    s_mov_b32 s62, L_fp1-L_anc
    s_mov_b32 s63, L_fp1-L_fp0
    s_mov_b32 s70, L_dr1-L_anc
    s_mov_b32 s71, L_dr1-L_dr0
    s_mov_b32 s26, 0
    v_mov_b32 v1, 0
    s_lshl_b32 s64, s31, 2
    v_mov_b32 v10, s64
    v_and_b32 v9, 8, v3
    v_lshlrev_b32 v9, 1, v9
    s_mov_b32 s66, 0x22222222
    s_mov_b32 s67, 0x22222222
    s_mov_b32 s68, 0x44444444
    s_mov_b32 s69, 0x44444444
    v_mov_b64 v[150:151], 0
    v_mov_b64 v[152:153], 0
    v_mov_b64 v[154:155], 0
    v_mov_b64 v[156:157], 0
    v_mov_b64 v[158:159], 0
    v_mov_b64 v[16:17], 0
    v_mov_b64 v[18:19], 0
    v_mov_b64 v[20:21], 0
    v_mov_b64 v[22:23], 0
    s_waitcnt lgkmcnt(0)
    v_lshlrev_b32 v33, v40, v33
    ds_bpermute_b32 v33, v46, v33
    v_lshlrev_b32 v35, v41, v35
    ds_bpermute_b32 v35, v46, v35
    v_lshlrev_b32 v37, v42, v37
    ds_bpermute_b32 v37, v46, v37
    v_lshlrev_b32 v39, v43, v39
    ds_bpermute_b32 v39, v46, v39
    s_waitcnt vmcnt(12) lgkmcnt(0)
    s_barrier
    ds_read_b128 v[160:163], v144 offset:21504
    ds_read_b128 v[164:167], v144 offset:21760
    ds_read_b128 v[168:171], v145 offset:21504
    ds_read_b128 v[172:175], v145 offset:21760
    s_waitcnt lgkmcnt(2)
    v_dot2c_f32_bf16 v150, v176, v160
    v_dot2c_f32_bf16 v150, v177, v161
    v_dot2c_f32_bf16 v150, v178, v162
    v_dot2c_f32_bf16 v150, v179, v163
    v_dot2c_f32_bf16 v150, v180, v164
    v_dot2c_f32_bf16 v150, v181, v165
    v_dot2c_f32_bf16 v150, v182, v166
    v_dot2c_f32_bf16 v150, v183, v167
    v_add_u32_dpp v11, v32, v7 row_newbcast:6 row_mask:0xf bank_mask:0xf
    buffer_load_dwordx4 v[96:99], v11, s[32:35], 0 offen offset:0
    buffer_load_dwordx4 v[104:107], v11, s[32:35], 0 offen offset:256
    ds_read_b128 v[160:163], v146 offset:21504
    ds_read_b128 v[164:167], v146 offset:21760
    s_waitcnt lgkmcnt(2)
    v_dot2c_f32_bf16 v151, v184, v168
    v_dot2c_f32_bf16 v151, v185, v169
    v_dot2c_f32_bf16 v151, v186, v170
    v_dot2c_f32_bf16 v151, v187, v171
    v_dot2c_f32_bf16 v151, v188, v172
    v_dot2c_f32_bf16 v151, v189, v173
    v_dot2c_f32_bf16 v151, v190, v174
    v_dot2c_f32_bf16 v151, v191, v175
    v_add_u32_dpp v11, v32, v7 row_newbcast:7 row_mask:0xf bank_mask:0xf
    buffer_load_dwordx4 v[100:103], v11, s[32:35], 0 offen offset:0
    buffer_load_dwordx4 v[108:111], v11, s[32:35], 0 offen offset:256
    ds_read_b128 v[168:171], v147 offset:21504
    ds_read_b128 v[172:175], v147 offset:21760
    s_waitcnt lgkmcnt(2)
    v_dot2c_f32_bf16 v152, v192, v160
    v_dot2c_f32_bf16 v152, v193, v161
    v_dot2c_f32_bf16 v152, v194, v162
    v_dot2c_f32_bf16 v152, v195, v163
    v_dot2c_f32_bf16 v152, v196, v164
    v_dot2c_f32_bf16 v152, v197, v165
    v_dot2c_f32_bf16 v152, v198, v166
    v_dot2c_f32_bf16 v152, v199, v167
    v_add_f32_dpp v150, v150, v150 row_ror:8 row_mask:0xf bank_mask:0x3
    v_add_f32_dpp v150, v151, v151 row_ror:8 row_mask:0xf bank_mask:0xc
    v_add_u32_dpp v11, v32, v7 row_newbcast:8 row_mask:0xf bank_mask:0xf
    buffer_load_dwordx4 v[112:115], v11, s[32:35], 0 offen offset:0
    buffer_load_dwordx4 v[120:123], v11, s[32:35], 0 offen offset:256
    ds_read_b128 v[160:163], v144 offset:29696
    ds_read_b128 v[164:167], v144 offset:29952
    s_waitcnt lgkmcnt(2)
    v_dot2c_f32_bf16 v153, v200, v168
    v_dot2c_f32_bf16 v153, v201, v169
    v_dot2c_f32_bf16 v153, v202, v170
    v_dot2c_f32_bf16 v153, v203, v171
    v_dot2c_f32_bf16 v153, v204, v172
    v_dot2c_f32_bf16 v153, v205, v173
    v_dot2c_f32_bf16 v153, v206, v174
    v_dot2c_f32_bf16 v153, v207, v175
    v_add_u32_dpp v11, v32, v7 row_newbcast:9 row_mask:0xf bank_mask:0xf
    buffer_load_dwordx4 v[116:119], v11, s[32:35], 0 offen offset:0
    buffer_load_dwordx4 v[124:127], v11, s[32:35], 0 offen offset:256
    ds_read_b128 v[168:171], v145 offset:29696
    ds_read_b128 v[172:175], v145 offset:29952
    s_waitcnt lgkmcnt(2)
    v_dot2c_f32_bf16 v154, v208, v160
    v_dot2c_f32_bf16 v154, v209, v161
    v_dot2c_f32_bf16 v154, v210, v162
    v_dot2c_f32_bf16 v154, v211, v163
    v_dot2c_f32_bf16 v154, v212, v164
    v_dot2c_f32_bf16 v154, v213, v165
    v_dot2c_f32_bf16 v154, v214, v166
    v_dot2c_f32_bf16 v154, v215, v167
    v_add_f32_dpp v152, v152, v152 row_ror:8 row_mask:0xf bank_mask:0x3
    v_add_f32_dpp v152, v153, v153 row_ror:8 row_mask:0xf bank_mask:0xc
    v_add_u32_dpp v11, v32, v7 row_newbcast:10 row_mask:0xf bank_mask:0xf
    buffer_load_dwordx4 v[128:131], v11, s[32:35], 0 offen offset:0
    buffer_load_dwordx4 v[136:139], v11, s[32:35], 0 offen offset:256
    ds_read_b128 v[160:163], v146 offset:29696
    ds_read_b128 v[164:167], v146 offset:29952
    s_waitcnt lgkmcnt(2)
    v_dot2c_f32_bf16 v155, v216, v168
    v_dot2c_f32_bf16 v155, v217, v169
    v_dot2c_f32_bf16 v155, v218, v170
    v_dot2c_f32_bf16 v155, v219, v171
    v_dot2c_f32_bf16 v155, v220, v172
    v_dot2c_f32_bf16 v155, v221, v173
    v_dot2c_f32_bf16 v155, v222, v174
    v_dot2c_f32_bf16 v155, v223, v175
    v_add_f32_dpp v150, v150, v150 row_half_mirror row_mask:0xf bank_mask:0x5
    v_add_f32_dpp v150, v152, v152 row_half_mirror row_mask:0xf bank_mask:0xa
    v_add_u32_dpp v11, v32, v7 row_newbcast:11 row_mask:0xf bank_mask:0xf
    buffer_load_dwordx4 v[132:135], v11, s[32:35], 0 offen offset:0
    buffer_load_dwordx4 v[140:143], v11, s[32:35], 0 offen offset:256
    ds_read_b128 v[168:171], v147 offset:29696
    ds_read_b128 v[172:175], v147 offset:29952
    s_waitcnt lgkmcnt(2)
    v_dot2c_f32_bf16 v156, v224, v160
    v_dot2c_f32_bf16 v156, v225, v161
    v_dot2c_f32_bf16 v156, v226, v162
    v_dot2c_f32_bf16 v156, v227, v163
    v_dot2c_f32_bf16 v156, v228, v164
    v_dot2c_f32_bf16 v156, v229, v165
    v_dot2c_f32_bf16 v156, v230, v166
    v_dot2c_f32_bf16 v156, v231, v167
    v_add_f32_dpp v154, v154, v154 row_ror:8 row_mask:0xf bank_mask:0x3
    v_add_f32_dpp v154, v155, v155 row_ror:8 row_mask:0xf bank_mask:0xc
    ds_read_b128 v[160:163], v148 offset:21504
    ds_read_b128 v[164:167], v148 offset:21760
    s_waitcnt lgkmcnt(2)
    v_dot2c_f32_bf16 v157, v232, v168
    v_dot2c_f32_bf16 v157, v233, v169
    v_dot2c_f32_bf16 v157, v234, v170
    v_dot2c_f32_bf16 v157, v235, v171
    v_dot2c_f32_bf16 v157, v236, v172
    v_dot2c_f32_bf16 v157, v237, v173
    v_dot2c_f32_bf16 v157, v238, v174
    v_dot2c_f32_bf16 v157, v239, v175
    ds_read_b128 v[168:171], v149 offset:21504
    ds_read_b128 v[172:175], v149 offset:21760
    s_waitcnt lgkmcnt(2)
    v_dot2c_f32_bf16 v158, v240, v160
    v_dot2c_f32_bf16 v158, v241, v161
    v_dot2c_f32_bf16 v158, v242, v162
    v_dot2c_f32_bf16 v158, v243, v163
    v_dot2c_f32_bf16 v158, v244, v164
    v_dot2c_f32_bf16 v158, v245, v165
    v_dot2c_f32_bf16 v158, v246, v166
    v_dot2c_f32_bf16 v158, v247, v167
    v_add_f32_dpp v156, v156, v156 row_ror:8 row_mask:0xf bank_mask:0x3
    v_add_f32_dpp v156, v157, v157 row_ror:8 row_mask:0xf bank_mask:0xc
    s_waitcnt lgkmcnt(0)
    v_dot2c_f32_bf16 v159, v248, v168
    v_dot2c_f32_bf16 v159, v249, v169
    v_dot2c_f32_bf16 v159, v250, v170
    v_dot2c_f32_bf16 v159, v251, v171
    v_dot2c_f32_bf16 v159, v252, v172
    v_dot2c_f32_bf16 v159, v253, v173
    v_dot2c_f32_bf16 v159, v254, v174
    v_dot2c_f32_bf16 v159, v255, v175
    v_add_f32_dpp v154, v154, v154 row_half_mirror row_mask:0xf bank_mask:0x5
    v_add_f32_dpp v154, v156, v156 row_half_mirror row_mask:0xf bank_mask:0xa
    v_add_f32_dpp v150, v150, v150 quad_perm:[1,0,3,2] row_mask:0xf bank_mask:0xf
    s_nop 0
    v_add_f32_dpp v158, v158, v158 row_ror:8 row_mask:0xf bank_mask:0x3
    v_add_f32_dpp v158, v159, v159 row_ror:8 row_mask:0xf bank_mask:0xc
    v_add_f32_dpp v154, v154, v154 quad_perm:[1,0,3,2] row_mask:0xf bank_mask:0xf
    v_add_f32_dpp v150, v150, v150 quad_perm:[2,3,0,1] row_mask:0xf bank_mask:0xf
    v_add_f32_dpp v158, v158, v158 row_half_mirror row_mask:0xf bank_mask:0x5
    v_add_f32_dpp v154, v154, v154 quad_perm:[2,3,0,1] row_mask:0xf bank_mask:0xf
    s_nop 0
    v_add_f32_dpp v158, v158, v158 quad_perm:[1,0,3,2] row_mask:0xf bank_mask:0xf
    v_cndmask_b32 v150, v150, v154, s[66:67]
    s_nop 0
    v_add_f32_dpp v158, v158, v158 quad_perm:[2,3,0,1] row_mask:0xf bank_mask:0xf
    v_cndmask_b32 v150, v150, v158, s[68:69]
    v_mul_f32 v150, 0x3db8aa3b, v150
    v_exp_f32 v150, v150
    s_nop 0
    v_mov_b32 v44, v150
    v_mov_b32 v45, v150
    s_nop 1
    v_permlane32_swap_b32 v44, v45
    v_add_f32 v44, v44, v45
    v_mov_b32 v45, v44
    s_nop 1
    v_permlane16_swap_b32 v44, v45
    v_add_f32 v44, v44, v45
    v_add_f32 v44, 0x3089705f, v44
    v_rcp_f32 v44, v44
    s_nop 0
    v_mul_f32 v150, v150, v44
    v_cvt_pk_bf16_f32 v150, v150, 0
    v_lshlrev_b32 v8, v9, v150
    s_nop 1
    v_and_b32_dpp v24, v8, v12 row_newbcast:0 row_mask:0xf bank_mask:0xf
    v_and_b32_dpp v25, v8, v13 row_newbcast:0 row_mask:0xf bank_mask:0xf
    v_mov_b64 v[40:41], 0
    v_mov_b64 v[42:43], 0
    v_mov_b64 v[44:45], 0
    v_mov_b64 v[46:47], 0
    v_smfmac_f32_16x16x32_bf16 v[40:43], v[24:25], v[176:179], v14
    v_and_b32_dpp v28, v8, v12 row_newbcast:8 row_mask:0xf bank_mask:0xf
    v_and_b32_dpp v29, v8, v13 row_newbcast:8 row_mask:0xf bank_mask:0xf
    v_smfmac_f32_16x16x32_bf16 v[44:47], v[24:25], v[180:183], v14
    v_add_u32_dpp v11, v32, v7 row_newbcast:12 row_mask:0xf bank_mask:0xf
    buffer_load_dwordx4 v[144:147], v11, s[32:35], 0 offen offset:0
    buffer_load_dwordx4 v[152:155], v11, s[32:35], 0 offen offset:256
    v_smfmac_f32_16x16x32_bf16 v[40:43], v[28:29], v[184:187], v14
    v_and_b32_dpp v24, v8, v12 row_newbcast:4 row_mask:0xf bank_mask:0xf
    v_and_b32_dpp v25, v8, v13 row_newbcast:4 row_mask:0xf bank_mask:0xf
    v_smfmac_f32_16x16x32_bf16 v[44:47], v[28:29], v[188:191], v14
    s_nop 0
    v_smfmac_f32_16x16x32_bf16 v[16:19], v[24:25], v[192:195], v14
    v_and_b32_dpp v28, v8, v12 row_newbcast:12 row_mask:0xf bank_mask:0xf
    v_and_b32_dpp v29, v8, v13 row_newbcast:12 row_mask:0xf bank_mask:0xf
    v_smfmac_f32_16x16x32_bf16 v[20:23], v[24:25], v[196:199], v14
    v_add_u32_dpp v11, v32, v7 row_newbcast:13 row_mask:0xf bank_mask:0xf
    buffer_load_dwordx4 v[148:151], v11, s[32:35], 0 offen offset:0
    buffer_load_dwordx4 v[156:159], v11, s[32:35], 0 offen offset:256
    v_smfmac_f32_16x16x32_bf16 v[16:19], v[28:29], v[200:203], v14
    v_and_b32_dpp v24, v8, v12 row_newbcast:1 row_mask:0xf bank_mask:0xf
    v_and_b32_dpp v25, v8, v13 row_newbcast:1 row_mask:0xf bank_mask:0xf
    v_smfmac_f32_16x16x32_bf16 v[20:23], v[28:29], v[204:207], v14
    v_xor_b32 v178, s15, v2
    s_lshl_b32 s64, s20, 2
    v_add_u32 v9, s64, v0
    v_mov_b32 v179, 0
    v_cvt_pk_bf16_f32 v30, v40, v41
    v_cvt_pk_bf16_f32 v31, v42, v43
    ds_write_b64 v178, v[30:31] offset:1024
    v_cvt_pk_bf16_f32 v30, v44, v45
    v_cvt_pk_bf16_f32 v31, v46, v47
    ds_write_b64 v178, v[30:31] offset:1280
    ds_read_u16_d16_hi v179, v9
    v_mov_b64 v[40:41], 0
    v_mov_b64 v[42:43], 0
    v_mov_b64 v[44:45], 0
    v_mov_b64 v[46:47], 0
    s_nop 0
    v_smfmac_f32_16x16x32_bf16 v[40:43], v[24:25], v[208:211], v14
    v_and_b32_dpp v28, v8, v12 row_newbcast:9 row_mask:0xf bank_mask:0xf
    v_and_b32_dpp v29, v8, v13 row_newbcast:9 row_mask:0xf bank_mask:0xf
    v_smfmac_f32_16x16x32_bf16 v[44:47], v[24:25], v[212:215], v14
    v_add_u32_dpp v11, v32, v7 row_newbcast:14 row_mask:0xf bank_mask:0xf
    buffer_load_dwordx4 v[160:163], v11, s[32:35], 0 offen offset:0
    buffer_load_dwordx4 v[168:171], v11, s[32:35], 0 offen offset:256
    v_smfmac_f32_16x16x32_bf16 v[40:43], v[28:29], v[216:219], v14
    v_and_b32_dpp v24, v8, v12 row_newbcast:5 row_mask:0xf bank_mask:0xf
    v_and_b32_dpp v25, v8, v13 row_newbcast:5 row_mask:0xf bank_mask:0xf
    v_smfmac_f32_16x16x32_bf16 v[44:47], v[28:29], v[220:223], v14
    v_xor_b32 v180, s16, v2
    s_lshl_b32 s64, s21, 2
    v_add_u32 v9, s64, v0
    v_mov_b32 v181, 0
    v_cvt_pk_bf16_f32 v30, v16, v17
    v_cvt_pk_bf16_f32 v31, v18, v19
    ds_write_b64 v180, v[30:31] offset:1024
    v_cvt_pk_bf16_f32 v30, v20, v21
    v_cvt_pk_bf16_f32 v31, v22, v23
    ds_write_b64 v180, v[30:31] offset:1280
    ds_read_u16_d16_hi v181, v9
    v_mov_b64 v[16:17], 0
    v_mov_b64 v[18:19], 0
    v_mov_b64 v[20:21], 0
    v_mov_b64 v[22:23], 0
    s_nop 0
    v_smfmac_f32_16x16x32_bf16 v[16:19], v[24:25], v[224:227], v14
    v_and_b32_dpp v28, v8, v12 row_newbcast:13 row_mask:0xf bank_mask:0xf
    v_and_b32_dpp v29, v8, v13 row_newbcast:13 row_mask:0xf bank_mask:0xf
    v_smfmac_f32_16x16x32_bf16 v[20:23], v[24:25], v[228:231], v14
    v_add_u32_dpp v11, v32, v7 row_newbcast:15 row_mask:0xf bank_mask:0xf
    buffer_load_dwordx4 v[164:167], v11, s[32:35], 0 offen offset:0
    buffer_load_dwordx4 v[172:175], v11, s[32:35], 0 offen offset:256
    v_smfmac_f32_16x16x32_bf16 v[16:19], v[28:29], v[232:235], v14
    v_and_b32_dpp v24, v8, v12 row_newbcast:2 row_mask:0xf bank_mask:0xf
    v_and_b32_dpp v25, v8, v13 row_newbcast:2 row_mask:0xf bank_mask:0xf
    v_smfmac_f32_16x16x32_bf16 v[20:23], v[28:29], v[236:239], v14
    v_xor_b32 v182, s17, v2
    s_lshl_b32 s64, s22, 2
    v_add_u32 v9, s64, v0
    v_mov_b32 v183, 0
    v_cvt_pk_bf16_f32 v30, v40, v41
    v_cvt_pk_bf16_f32 v31, v42, v43
    ds_write_b64 v182, v[30:31] offset:1024
    v_cvt_pk_bf16_f32 v30, v44, v45
    v_cvt_pk_bf16_f32 v31, v46, v47
    ds_write_b64 v182, v[30:31] offset:1280
    ds_read_u16_d16_hi v183, v9
    v_mov_b64 v[40:41], 0
    v_mov_b64 v[42:43], 0
    v_mov_b64 v[44:45], 0
    v_mov_b64 v[46:47], 0
    s_nop 0
    v_smfmac_f32_16x16x32_bf16 v[40:43], v[24:25], v[240:243], v14
    v_and_b32_dpp v28, v8, v12 row_newbcast:10 row_mask:0xf bank_mask:0xf
    v_and_b32_dpp v29, v8, v13 row_newbcast:10 row_mask:0xf bank_mask:0xf
    v_smfmac_f32_16x16x32_bf16 v[44:47], v[24:25], v[244:247], v14
    s_nop 0
    v_smfmac_f32_16x16x32_bf16 v[40:43], v[28:29], v[248:251], v14
    v_and_b32_dpp v24, v33, v12 row_newbcast:0 row_mask:0xf bank_mask:0xf
    v_and_b32_dpp v25, v33, v13 row_newbcast:0 row_mask:0xf bank_mask:0xf
    v_and_b32_dpp v26, v33, v12 row_newbcast:1 row_mask:0xf bank_mask:0xf
    v_and_b32_dpp v27, v33, v13 row_newbcast:1 row_mask:0xf bank_mask:0xf
    v_smfmac_f32_16x16x32_bf16 v[44:47], v[28:29], v[252:255], v14
    v_xor_b32 v184, s18, v2
    s_lshl_b32 s64, s23, 2
    v_add_u32 v9, s64, v0
    v_mov_b32 v185, 0
    v_cvt_pk_bf16_f32 v30, v16, v17
    v_cvt_pk_bf16_f32 v31, v18, v19
    ds_write_b64 v184, v[30:31] offset:1024
    v_cvt_pk_bf16_f32 v30, v20, v21
    v_cvt_pk_bf16_f32 v31, v22, v23
    ds_write_b64 v184, v[30:31] offset:1280
    ds_read_u16_d16_hi v185, v9
    v_mov_b64 v[16:17], 0
    v_mov_b64 v[18:19], 0
    v_mov_b64 v[20:21], 0
    v_mov_b64 v[22:23], 0
    s_nop 0
    v_xor_b32 v176, s19, v2
    s_lshl_b32 s64, s24, 2
    v_add_u32 v9, s64, v0
    v_mov_b32 v177, 0
    v_cvt_pk_bf16_f32 v30, v40, v41
    v_cvt_pk_bf16_f32 v31, v42, v43
    ds_write_b64 v176, v[30:31] offset:1024
    v_cvt_pk_bf16_f32 v30, v44, v45
    v_cvt_pk_bf16_f32 v31, v46, v47
    ds_write_b64 v176, v[30:31] offset:1280
    ds_read_u16_d16_hi v177, v9
    s_waitcnt lgkmcnt(0)
    s_barrier
    s_cmp_lg_u32 s25, 0
    s_cbranch_scc1 L_slow
L_fp0:
    s_bitcmp1_b32 s52, 0
    s_waitcnt vmcnt(28)
    v_smfmac_f32_16x16x64_bf16 v[16:19], v[24:27], v[48:55], v14
    v_and_b32_dpp v28, v33, v12 row_newbcast:2 row_mask:0xf bank_mask:0xf
    v_and_b32_dpp v29, v33, v13 row_newbcast:2 row_mask:0xf bank_mask:0xf
    v_smfmac_f32_16x16x64_bf16 v[20:23], v[24:27], v[56:63], v14
    v_and_b32_dpp v30, v33, v12 row_newbcast:3 row_mask:0xf bank_mask:0xf
    v_and_b32_dpp v31, v33, v13 row_newbcast:3 row_mask:0xf bank_mask:0xf
    v_add_u32_dpp v11, v34, v7 row_newbcast:0 row_mask:0xf bank_mask:0xf
    buffer_load_dwordx4 v[48:51], v11, s[32:35], 0 offen offset:0
    buffer_load_dwordx4 v[56:59], v11, s[32:35], 0 offen offset:256
    s_cbranch_scc1 L_ev0
L_fp1:
    s_bitcmp1_b32 s52, 1
    s_waitcnt vmcnt(26)
    v_smfmac_f32_16x16x64_bf16 v[16:19], v[28:31], v[64:71], v14
    v_and_b32_dpp v24, v33, v12 row_newbcast:4 row_mask:0xf bank_mask:0xf
    v_and_b32_dpp v25, v33, v13 row_newbcast:4 row_mask:0xf bank_mask:0xf
    v_smfmac_f32_16x16x64_bf16 v[20:23], v[28:31], v[72:79], v14
    v_and_b32_dpp v26, v33, v12 row_newbcast:5 row_mask:0xf bank_mask:0xf
    v_and_b32_dpp v27, v33, v13 row_newbcast:5 row_mask:0xf bank_mask:0xf
    v_add_u32_dpp v11, v34, v7 row_newbcast:1 row_mask:0xf bank_mask:0xf
    buffer_load_dwordx4 v[52:55], v11, s[32:35], 0 offen offset:0
    buffer_load_dwordx4 v[60:63], v11, s[32:35], 0 offen offset:256
    s_cbranch_scc1 L_ev1
L_fp2:
    s_bitcmp1_b32 s52, 2
    s_waitcnt vmcnt(24)
    v_smfmac_f32_16x16x64_bf16 v[16:19], v[24:27], v[80:87], v14
    v_and_b32_dpp v28, v33, v12 row_newbcast:6 row_mask:0xf bank_mask:0xf
    v_and_b32_dpp v29, v33, v13 row_newbcast:6 row_mask:0xf bank_mask:0xf
    v_smfmac_f32_16x16x64_bf16 v[20:23], v[24:27], v[88:95], v14
    v_and_b32_dpp v30, v33, v12 row_newbcast:7 row_mask:0xf bank_mask:0xf
    v_and_b32_dpp v31, v33, v13 row_newbcast:7 row_mask:0xf bank_mask:0xf
    v_add_u32_dpp v11, v34, v7 row_newbcast:2 row_mask:0xf bank_mask:0xf
    buffer_load_dwordx4 v[64:67], v11, s[32:35], 0 offen offset:0
    buffer_load_dwordx4 v[72:75], v11, s[32:35], 0 offen offset:256
    s_cbranch_scc1 L_ev2
L_fp3:
    s_bitcmp1_b32 s52, 3
    s_waitcnt vmcnt(22)
    v_smfmac_f32_16x16x64_bf16 v[16:19], v[28:31], v[96:103], v14
    v_and_b32_dpp v24, v33, v12 row_newbcast:8 row_mask:0xf bank_mask:0xf
    v_and_b32_dpp v25, v33, v13 row_newbcast:8 row_mask:0xf bank_mask:0xf
    v_smfmac_f32_16x16x64_bf16 v[20:23], v[28:31], v[104:111], v14
    v_and_b32_dpp v26, v33, v12 row_newbcast:9 row_mask:0xf bank_mask:0xf
    v_and_b32_dpp v27, v33, v13 row_newbcast:9 row_mask:0xf bank_mask:0xf
    v_add_u32_dpp v11, v34, v7 row_newbcast:3 row_mask:0xf bank_mask:0xf
    buffer_load_dwordx4 v[68:71], v11, s[32:35], 0 offen offset:0
    buffer_load_dwordx4 v[76:79], v11, s[32:35], 0 offen offset:256
    s_cbranch_scc1 L_ev3
L_fp4:
    s_bitcmp1_b32 s52, 4
    s_waitcnt vmcnt(20)
    v_smfmac_f32_16x16x64_bf16 v[16:19], v[24:27], v[112:119], v14
    v_and_b32_dpp v28, v33, v12 row_newbcast:10 row_mask:0xf bank_mask:0xf
    v_and_b32_dpp v29, v33, v13 row_newbcast:10 row_mask:0xf bank_mask:0xf
    v_smfmac_f32_16x16x64_bf16 v[20:23], v[24:27], v[120:127], v14
    v_and_b32_dpp v30, v33, v12 row_newbcast:11 row_mask:0xf bank_mask:0xf
    v_and_b32_dpp v31, v33, v13 row_newbcast:11 row_mask:0xf bank_mask:0xf
    v_add_u32_dpp v11, v34, v7 row_newbcast:4 row_mask:0xf bank_mask:0xf
    buffer_load_dwordx4 v[80:83], v11, s[32:35], 0 offen offset:0
    buffer_load_dwordx4 v[88:91], v11, s[32:35], 0 offen offset:256
    s_cbranch_scc1 L_ev4
L_fp5:
    s_bitcmp1_b32 s52, 5
    s_waitcnt vmcnt(18)
    v_smfmac_f32_16x16x64_bf16 v[16:19], v[28:31], v[128:135], v14
    v_and_b32_dpp v24, v33, v12 row_newbcast:12 row_mask:0xf bank_mask:0xf
    v_and_b32_dpp v25, v33, v13 row_newbcast:12 row_mask:0xf bank_mask:0xf
    v_smfmac_f32_16x16x64_bf16 v[20:23], v[28:31], v[136:143], v14
    v_and_b32_dpp v26, v33, v12 row_newbcast:13 row_mask:0xf bank_mask:0xf
    v_and_b32_dpp v27, v33, v13 row_newbcast:13 row_mask:0xf bank_mask:0xf
    v_add_u32_dpp v11, v34, v7 row_newbcast:5 row_mask:0xf bank_mask:0xf
    buffer_load_dwordx4 v[84:87], v11, s[32:35], 0 offen offset:0
    buffer_load_dwordx4 v[92:95], v11, s[32:35], 0 offen offset:256
    s_cbranch_scc1 L_ev5
L_fp6:
    s_bitcmp1_b32 s52, 6
    s_waitcnt vmcnt(16)
    v_smfmac_f32_16x16x64_bf16 v[16:19], v[24:27], v[144:151], v14
    v_and_b32_dpp v28, v33, v12 row_newbcast:14 row_mask:0xf bank_mask:0xf
    v_and_b32_dpp v29, v33, v13 row_newbcast:14 row_mask:0xf bank_mask:0xf
    v_smfmac_f32_16x16x64_bf16 v[20:23], v[24:27], v[152:159], v14
    v_and_b32_dpp v30, v33, v12 row_newbcast:15 row_mask:0xf bank_mask:0xf
    v_and_b32_dpp v31, v33, v13 row_newbcast:15 row_mask:0xf bank_mask:0xf
    v_add_u32_dpp v11, v34, v7 row_newbcast:6 row_mask:0xf bank_mask:0xf
    buffer_load_dwordx4 v[96:99], v11, s[32:35], 0 offen offset:0
    buffer_load_dwordx4 v[104:107], v11, s[32:35], 0 offen offset:256
    s_cbranch_scc1 L_ev6
L_fp7:
    s_bitcmp1_b32 s52, 7
    s_waitcnt vmcnt(14)
    v_smfmac_f32_16x16x64_bf16 v[16:19], v[28:31], v[160:167], v14
    v_and_b32_dpp v24, v35, v12 row_newbcast:0 row_mask:0xf bank_mask:0xf
    v_and_b32_dpp v25, v35, v13 row_newbcast:0 row_mask:0xf bank_mask:0xf
    v_smfmac_f32_16x16x64_bf16 v[20:23], v[28:31], v[168:175], v14
    v_and_b32_dpp v26, v35, v12 row_newbcast:1 row_mask:0xf bank_mask:0xf
    v_and_b32_dpp v27, v35, v13 row_newbcast:1 row_mask:0xf bank_mask:0xf
    v_add_u32_dpp v11, v34, v7 row_newbcast:7 row_mask:0xf bank_mask:0xf
    buffer_load_dwordx4 v[100:103], v11, s[32:35], 0 offen offset:0
    buffer_load_dwordx4 v[108:111], v11, s[32:35], 0 offen offset:256
    s_cbranch_scc1 L_ev7
L_fp8:
    v_mov_b64 v[32:33], v[34:35]
    v_mov_b64 v[34:35], v[36:37]
    v_mov_b64 v[36:37], v[38:39]
    s_lshr_b32 s52, s52, 8
    s_lshr_b32 s53, s53, 8
    s_lshr_b32 s56, s56, 8
    s_mov_b32 s62, L_st1-L_anc
    s_mov_b32 s63, L_st1-L_st0
L_st0:
    s_bitcmp1_b32 s52, 0
    s_waitcnt vmcnt(12)
    v_smfmac_f32_16x16x64_bf16 v[16:19], v[24:27], v[48:55], v14
    v_and_b32_dpp v28, v33, v12 row_newbcast:2 row_mask:0xf bank_mask:0xf
    v_and_b32_dpp v29, v33, v13 row_newbcast:2 row_mask:0xf bank_mask:0xf
    v_smfmac_f32_16x16x64_bf16 v[20:23], v[24:27], v[56:63], v14
    v_and_b32_dpp v30, v33, v12 row_newbcast:3 row_mask:0xf bank_mask:0xf
    v_and_b32_dpp v31, v33, v13 row_newbcast:3 row_mask:0xf bank_mask:0xf
    v_add_u32_dpp v11, v32, v7 row_newbcast:8 row_mask:0xf bank_mask:0xf
    buffer_load_dwordx4 v[112:115], v11, s[32:35], 0 offen offset:0
    buffer_load_dwordx4 v[120:123], v11, s[32:35], 0 offen offset:256
    v_add_u32_dpp v11, v32, v7 row_newbcast:9 row_mask:0xf bank_mask:0xf
    buffer_load_dwordx4 v[116:119], v11, s[32:35], 0 offen offset:0
    buffer_load_dwordx4 v[124:127], v11, s[32:35], 0 offen offset:256
    s_cbranch_scc1 L_ev0
L_st1:
    s_bitcmp1_b32 s52, 1
    s_waitcnt vmcnt(12)
    v_smfmac_f32_16x16x64_bf16 v[16:19], v[28:31], v[64:71], v14
    v_and_b32_dpp v24, v33, v12 row_newbcast:4 row_mask:0xf bank_mask:0xf
    v_and_b32_dpp v25, v33, v13 row_newbcast:4 row_mask:0xf bank_mask:0xf
    v_smfmac_f32_16x16x64_bf16 v[20:23], v[28:31], v[72:79], v14
    v_and_b32_dpp v26, v33, v12 row_newbcast:5 row_mask:0xf bank_mask:0xf
    v_and_b32_dpp v27, v33, v13 row_newbcast:5 row_mask:0xf bank_mask:0xf
    v_add_u32_dpp v11, v32, v7 row_newbcast:10 row_mask:0xf bank_mask:0xf
    buffer_load_dwordx4 v[128:131], v11, s[32:35], 0 offen offset:0
    buffer_load_dwordx4 v[136:139], v11, s[32:35], 0 offen offset:256
    v_add_u32_dpp v11, v32, v7 row_newbcast:11 row_mask:0xf bank_mask:0xf
    buffer_load_dwordx4 v[132:135], v11, s[32:35], 0 offen offset:0
    buffer_load_dwordx4 v[140:143], v11, s[32:35], 0 offen offset:256
    s_cbranch_scc1 L_ev1
L_st2:
    s_bitcmp1_b32 s52, 2
    s_waitcnt vmcnt(12)
    v_smfmac_f32_16x16x64_bf16 v[16:19], v[24:27], v[80:87], v14
    v_and_b32_dpp v28, v33, v12 row_newbcast:6 row_mask:0xf bank_mask:0xf
    v_and_b32_dpp v29, v33, v13 row_newbcast:6 row_mask:0xf bank_mask:0xf
    v_smfmac_f32_16x16x64_bf16 v[20:23], v[24:27], v[88:95], v14
    v_and_b32_dpp v30, v33, v12 row_newbcast:7 row_mask:0xf bank_mask:0xf
    v_and_b32_dpp v31, v33, v13 row_newbcast:7 row_mask:0xf bank_mask:0xf
    v_add_u32_dpp v11, v32, v7 row_newbcast:12 row_mask:0xf bank_mask:0xf
    buffer_load_dwordx4 v[144:147], v11, s[32:35], 0 offen offset:0
    buffer_load_dwordx4 v[152:155], v11, s[32:35], 0 offen offset:256
    v_add_u32_dpp v11, v32, v7 row_newbcast:13 row_mask:0xf bank_mask:0xf
    buffer_load_dwordx4 v[148:151], v11, s[32:35], 0 offen offset:0
    buffer_load_dwordx4 v[156:159], v11, s[32:35], 0 offen offset:256
    s_cbranch_scc1 L_ev2
L_st3:
    s_bitcmp1_b32 s52, 3
    s_waitcnt vmcnt(12)
    v_smfmac_f32_16x16x64_bf16 v[16:19], v[28:31], v[96:103], v14
    v_and_b32_dpp v24, v33, v12 row_newbcast:8 row_mask:0xf bank_mask:0xf
    v_and_b32_dpp v25, v33, v13 row_newbcast:8 row_mask:0xf bank_mask:0xf
    v_smfmac_f32_16x16x64_bf16 v[20:23], v[28:31], v[104:111], v14
    v_and_b32_dpp v26, v33, v12 row_newbcast:9 row_mask:0xf bank_mask:0xf
    v_and_b32_dpp v27, v33, v13 row_newbcast:9 row_mask:0xf bank_mask:0xf
    v_add_u32_dpp v11, v32, v7 row_newbcast:14 row_mask:0xf bank_mask:0xf
    buffer_load_dwordx4 v[160:163], v11, s[32:35], 0 offen offset:0
    buffer_load_dwordx4 v[168:171], v11, s[32:35], 0 offen offset:256
    v_add_u32_dpp v11, v32, v7 row_newbcast:15 row_mask:0xf bank_mask:0xf
    buffer_load_dwordx4 v[164:167], v11, s[32:35], 0 offen offset:0
    buffer_load_dwordx4 v[172:175], v11, s[32:35], 0 offen offset:256
    s_cbranch_scc1 L_ev3
L_st4:
    s_bitcmp1_b32 s52, 4
    s_waitcnt vmcnt(12)
    v_smfmac_f32_16x16x64_bf16 v[16:19], v[24:27], v[112:119], v14
    v_and_b32_dpp v28, v33, v12 row_newbcast:10 row_mask:0xf bank_mask:0xf
    v_and_b32_dpp v29, v33, v13 row_newbcast:10 row_mask:0xf bank_mask:0xf
    v_smfmac_f32_16x16x64_bf16 v[20:23], v[24:27], v[120:127], v14
    v_and_b32_dpp v30, v33, v12 row_newbcast:11 row_mask:0xf bank_mask:0xf
    v_and_b32_dpp v31, v33, v13 row_newbcast:11 row_mask:0xf bank_mask:0xf
    v_add_u32_dpp v11, v34, v7 row_newbcast:0 row_mask:0xf bank_mask:0xf
    buffer_load_dwordx4 v[48:51], v11, s[32:35], 0 offen offset:0
    buffer_load_dwordx4 v[56:59], v11, s[32:35], 0 offen offset:256
    v_add_u32_dpp v11, v34, v7 row_newbcast:1 row_mask:0xf bank_mask:0xf
    buffer_load_dwordx4 v[52:55], v11, s[32:35], 0 offen offset:0
    buffer_load_dwordx4 v[60:63], v11, s[32:35], 0 offen offset:256
    s_cbranch_scc1 L_ev4
L_st5:
    s_bitcmp1_b32 s52, 5
    s_waitcnt vmcnt(12)
    v_smfmac_f32_16x16x64_bf16 v[16:19], v[28:31], v[128:135], v14
    v_and_b32_dpp v24, v33, v12 row_newbcast:12 row_mask:0xf bank_mask:0xf
    v_and_b32_dpp v25, v33, v13 row_newbcast:12 row_mask:0xf bank_mask:0xf
    v_smfmac_f32_16x16x64_bf16 v[20:23], v[28:31], v[136:143], v14
    v_and_b32_dpp v26, v33, v12 row_newbcast:13 row_mask:0xf bank_mask:0xf
    v_and_b32_dpp v27, v33, v13 row_newbcast:13 row_mask:0xf bank_mask:0xf
    v_add_u32_dpp v11, v34, v7 row_newbcast:2 row_mask:0xf bank_mask:0xf
    buffer_load_dwordx4 v[64:67], v11, s[32:35], 0 offen offset:0
    buffer_load_dwordx4 v[72:75], v11, s[32:35], 0 offen offset:256
    v_add_u32_dpp v11, v34, v7 row_newbcast:3 row_mask:0xf bank_mask:0xf
    buffer_load_dwordx4 v[68:71], v11, s[32:35], 0 offen offset:0
    buffer_load_dwordx4 v[76:79], v11, s[32:35], 0 offen offset:256
    s_cbranch_scc1 L_ev5
L_st6:
    s_bitcmp1_b32 s52, 6
    s_waitcnt vmcnt(12)
    v_smfmac_f32_16x16x64_bf16 v[16:19], v[24:27], v[144:151], v14
    v_and_b32_dpp v28, v33, v12 row_newbcast:14 row_mask:0xf bank_mask:0xf
    v_and_b32_dpp v29, v33, v13 row_newbcast:14 row_mask:0xf bank_mask:0xf
    v_smfmac_f32_16x16x64_bf16 v[20:23], v[24:27], v[152:159], v14
    v_and_b32_dpp v30, v33, v12 row_newbcast:15 row_mask:0xf bank_mask:0xf
    v_and_b32_dpp v31, v33, v13 row_newbcast:15 row_mask:0xf bank_mask:0xf
    v_add_u32_dpp v11, v34, v7 row_newbcast:4 row_mask:0xf bank_mask:0xf
    buffer_load_dwordx4 v[80:83], v11, s[32:35], 0 offen offset:0
    buffer_load_dwordx4 v[88:91], v11, s[32:35], 0 offen offset:256
    v_add_u32_dpp v11, v34, v7 row_newbcast:5 row_mask:0xf bank_mask:0xf
    buffer_load_dwordx4 v[84:87], v11, s[32:35], 0 offen offset:0
    buffer_load_dwordx4 v[92:95], v11, s[32:35], 0 offen offset:256
    s_cbranch_scc1 L_ev6
L_st7:
    s_bitcmp1_b32 s52, 7
    s_waitcnt vmcnt(12)
    v_smfmac_f32_16x16x64_bf16 v[16:19], v[28:31], v[160:167], v14
    v_and_b32_dpp v24, v35, v12 row_newbcast:0 row_mask:0xf bank_mask:0xf
    v_and_b32_dpp v25, v35, v13 row_newbcast:0 row_mask:0xf bank_mask:0xf
    v_smfmac_f32_16x16x64_bf16 v[20:23], v[28:31], v[168:175], v14
    v_and_b32_dpp v26, v35, v12 row_newbcast:1 row_mask:0xf bank_mask:0xf
    v_and_b32_dpp v27, v35, v13 row_newbcast:1 row_mask:0xf bank_mask:0xf
    v_add_u32_dpp v11, v34, v7 row_newbcast:6 row_mask:0xf bank_mask:0xf
    buffer_load_dwordx4 v[96:99], v11, s[32:35], 0 offen offset:0
    buffer_load_dwordx4 v[104:107], v11, s[32:35], 0 offen offset:256
    v_add_u32_dpp v11, v34, v7 row_newbcast:7 row_mask:0xf bank_mask:0xf
    buffer_load_dwordx4 v[100:103], v11, s[32:35], 0 offen offset:0
    buffer_load_dwordx4 v[108:111], v11, s[32:35], 0 offen offset:256
    s_cbranch_scc1 L_ev7
L_st8:
    v_mov_b64 v[32:33], v[34:35]
    v_mov_b64 v[34:35], v[36:37]
    v_mov_b64 v[36:37], v[38:39]
    s_lshr_b32 s52, s52, 8
    s_lshr_b32 s53, s53, 8
    s_lshr_b32 s56, s56, 8
    s_branch L_st0
L_dr0:
    s_bitcmp1_b32 s52, 0
    ds_write_b32 v10, v6 offset:48
    s_waitcnt vmcnt(12)
    v_smfmac_f32_16x16x64_bf16 v[16:19], v[24:27], v[48:55], v14
    v_and_b32_dpp v28, v33, v12 row_newbcast:2 row_mask:0xf bank_mask:0xf
    v_and_b32_dpp v29, v33, v13 row_newbcast:2 row_mask:0xf bank_mask:0xf
    v_smfmac_f32_16x16x64_bf16 v[20:23], v[24:27], v[56:63], v14
    v_and_b32_dpp v30, v33, v12 row_newbcast:3 row_mask:0xf bank_mask:0xf
    v_and_b32_dpp v31, v33, v13 row_newbcast:3 row_mask:0xf bank_mask:0xf
    buffer_load_ubyte v15, off, s[32:35], 0
    buffer_load_ubyte v15, off, s[32:35], 0
    buffer_load_ubyte v15, off, s[32:35], 0
    buffer_load_ubyte v15, off, s[32:35], 0
    s_cbranch_scc1 L_ev0
L_dr1:
    s_bitcmp1_b32 s52, 1
    ds_write_b32 v10, v6 offset:48
    s_waitcnt vmcnt(12)
    v_smfmac_f32_16x16x64_bf16 v[16:19], v[28:31], v[64:71], v14
    v_and_b32_dpp v24, v33, v12 row_newbcast:4 row_mask:0xf bank_mask:0xf
    v_and_b32_dpp v25, v33, v13 row_newbcast:4 row_mask:0xf bank_mask:0xf
    v_smfmac_f32_16x16x64_bf16 v[20:23], v[28:31], v[72:79], v14
    v_and_b32_dpp v26, v33, v12 row_newbcast:5 row_mask:0xf bank_mask:0xf
    v_and_b32_dpp v27, v33, v13 row_newbcast:5 row_mask:0xf bank_mask:0xf
    buffer_load_ubyte v15, off, s[32:35], 0
    buffer_load_ubyte v15, off, s[32:35], 0
    buffer_load_ubyte v15, off, s[32:35], 0
    buffer_load_ubyte v15, off, s[32:35], 0
    s_cbranch_scc1 L_ev1
L_dr2:
    s_bitcmp1_b32 s52, 2
    ds_write_b32 v10, v6 offset:48
    s_waitcnt vmcnt(12)
    v_smfmac_f32_16x16x64_bf16 v[16:19], v[24:27], v[80:87], v14
    v_and_b32_dpp v28, v33, v12 row_newbcast:6 row_mask:0xf bank_mask:0xf
    v_and_b32_dpp v29, v33, v13 row_newbcast:6 row_mask:0xf bank_mask:0xf
    v_smfmac_f32_16x16x64_bf16 v[20:23], v[24:27], v[88:95], v14
    v_and_b32_dpp v30, v33, v12 row_newbcast:7 row_mask:0xf bank_mask:0xf
    v_and_b32_dpp v31, v33, v13 row_newbcast:7 row_mask:0xf bank_mask:0xf
    buffer_load_ubyte v15, off, s[32:35], 0
    buffer_load_ubyte v15, off, s[32:35], 0
    buffer_load_ubyte v15, off, s[32:35], 0
    buffer_load_ubyte v15, off, s[32:35], 0
    s_cbranch_scc1 L_ev2
L_dr3:
    s_bitcmp1_b32 s52, 3
    ds_write_b32 v10, v6 offset:48
    s_waitcnt vmcnt(12)
    v_smfmac_f32_16x16x64_bf16 v[16:19], v[28:31], v[96:103], v14
    v_and_b32_dpp v24, v33, v12 row_newbcast:8 row_mask:0xf bank_mask:0xf
    v_and_b32_dpp v25, v33, v13 row_newbcast:8 row_mask:0xf bank_mask:0xf
    v_smfmac_f32_16x16x64_bf16 v[20:23], v[28:31], v[104:111], v14
    v_and_b32_dpp v26, v33, v12 row_newbcast:9 row_mask:0xf bank_mask:0xf
    v_and_b32_dpp v27, v33, v13 row_newbcast:9 row_mask:0xf bank_mask:0xf
    buffer_load_ubyte v15, off, s[32:35], 0
    buffer_load_ubyte v15, off, s[32:35], 0
    buffer_load_ubyte v15, off, s[32:35], 0
    buffer_load_ubyte v15, off, s[32:35], 0
    s_cbranch_scc1 L_ev3
L_dr4:
    s_bitcmp1_b32 s52, 4
    ds_write_b32 v10, v6 offset:48
    s_waitcnt vmcnt(12)
    v_smfmac_f32_16x16x64_bf16 v[16:19], v[24:27], v[112:119], v14
    v_and_b32_dpp v28, v33, v12 row_newbcast:10 row_mask:0xf bank_mask:0xf
    v_and_b32_dpp v29, v33, v13 row_newbcast:10 row_mask:0xf bank_mask:0xf
    v_smfmac_f32_16x16x64_bf16 v[20:23], v[24:27], v[120:127], v14
    v_and_b32_dpp v30, v33, v12 row_newbcast:11 row_mask:0xf bank_mask:0xf
    v_and_b32_dpp v31, v33, v13 row_newbcast:11 row_mask:0xf bank_mask:0xf
    buffer_load_ubyte v15, off, s[32:35], 0
    buffer_load_ubyte v15, off, s[32:35], 0
    buffer_load_ubyte v15, off, s[32:35], 0
    buffer_load_ubyte v15, off, s[32:35], 0
    s_cbranch_scc1 L_ev4
L_dr5:
    s_bitcmp1_b32 s52, 5
    ds_write_b32 v10, v6 offset:48
    s_waitcnt vmcnt(12)
    v_smfmac_f32_16x16x64_bf16 v[16:19], v[28:31], v[128:135], v14
    v_and_b32_dpp v24, v33, v12 row_newbcast:12 row_mask:0xf bank_mask:0xf
    v_and_b32_dpp v25, v33, v13 row_newbcast:12 row_mask:0xf bank_mask:0xf
    v_smfmac_f32_16x16x64_bf16 v[20:23], v[28:31], v[136:143], v14
    v_and_b32_dpp v26, v33, v12 row_newbcast:13 row_mask:0xf bank_mask:0xf
    v_and_b32_dpp v27, v33, v13 row_newbcast:13 row_mask:0xf bank_mask:0xf
    buffer_load_ubyte v15, off, s[32:35], 0
    buffer_load_ubyte v15, off, s[32:35], 0
    buffer_load_ubyte v15, off, s[32:35], 0
    buffer_load_ubyte v15, off, s[32:35], 0
    s_cbranch_scc1 L_ev5
L_dr6:
    s_bitcmp1_b32 s52, 6
    ds_write_b32 v10, v6 offset:48
    s_waitcnt vmcnt(12)
    v_smfmac_f32_16x16x64_bf16 v[16:19], v[24:27], v[144:151], v14
    v_and_b32_dpp v28, v33, v12 row_newbcast:14 row_mask:0xf bank_mask:0xf
    v_and_b32_dpp v29, v33, v13 row_newbcast:14 row_mask:0xf bank_mask:0xf
    v_smfmac_f32_16x16x64_bf16 v[20:23], v[24:27], v[152:159], v14
    v_and_b32_dpp v30, v33, v12 row_newbcast:15 row_mask:0xf bank_mask:0xf
    v_and_b32_dpp v31, v33, v13 row_newbcast:15 row_mask:0xf bank_mask:0xf
    buffer_load_ubyte v15, off, s[32:35], 0
    buffer_load_ubyte v15, off, s[32:35], 0
    buffer_load_ubyte v15, off, s[32:35], 0
    buffer_load_ubyte v15, off, s[32:35], 0
    s_cbranch_scc1 L_ev6
L_dr7:
    s_bitcmp1_b32 s52, 7
    ds_write_b32 v10, v6 offset:48
    s_waitcnt vmcnt(12)
    v_smfmac_f32_16x16x64_bf16 v[16:19], v[28:31], v[160:167], v14
    v_and_b32_dpp v24, v35, v12 row_newbcast:0 row_mask:0xf bank_mask:0xf
    v_and_b32_dpp v25, v35, v13 row_newbcast:0 row_mask:0xf bank_mask:0xf
    v_smfmac_f32_16x16x64_bf16 v[20:23], v[28:31], v[168:175], v14
    v_and_b32_dpp v26, v35, v12 row_newbcast:1 row_mask:0xf bank_mask:0xf
    v_and_b32_dpp v27, v35, v13 row_newbcast:1 row_mask:0xf bank_mask:0xf
    buffer_load_ubyte v15, off, s[32:35], 0
    buffer_load_ubyte v15, off, s[32:35], 0
    buffer_load_ubyte v15, off, s[32:35], 0
    buffer_load_ubyte v15, off, s[32:35], 0
    s_cbranch_scc1 L_ev7
L_dr8:
    v_mov_b64 v[32:33], v[34:35]
    v_mov_b64 v[34:35], v[36:37]
    v_mov_b64 v[36:37], v[38:39]
    s_lshr_b32 s52, s52, 8
    s_lshr_b32 s53, s53, 8
    s_lshr_b32 s56, s56, 8
    s_branch L_dr0
L_ev0:
    s_and_b32 s65, s57, 15
    v_cmp_ge_u32 s[66:67], s65, v4
    v_cmp_gt_u32 s[68:69], s65, v4
    s_bitcmp1_b32 s56, 0
    s_cselect_b64 s[62:63], s[70:71], s[62:63]
    v_cndmask_b32 v40, 0, v28, s[66:67]
    v_cndmask_b32 v41, 0, v29, s[66:67]
    v_cndmask_b32 v42, 0, v30, s[68:69]
    v_cndmask_b32 v43, 0, v31, s[68:69]
    s_mul_i32 s64, s63, 0
    s_bitcmp1_b32 s53, 0
    s_cbranch_scc0 L_evret
    s_waitcnt vmcnt(12)
    v_smfmac_f32_16x16x64_bf16 v[16:19], v[40:43], v[64:71], v14
    v_xor_b32 v28, v28, v40
    v_xor_b32 v29, v29, v41
    v_smfmac_f32_16x16x64_bf16 v[20:23], v[40:43], v[72:79], v14
    v_xor_b32 v30, v30, v42
    v_xor_b32 v31, v31, v43
    s_branch L_flush
L_ev1:
    s_and_b32 s65, s57, 15
    v_cmp_ge_u32 s[66:67], s65, v4
    v_cmp_gt_u32 s[68:69], s65, v4
    s_bitcmp1_b32 s56, 1
    s_cselect_b64 s[62:63], s[70:71], s[62:63]
    v_cndmask_b32 v40, 0, v24, s[66:67]
    v_cndmask_b32 v41, 0, v25, s[66:67]
    v_cndmask_b32 v42, 0, v26, s[68:69]
    v_cndmask_b32 v43, 0, v27, s[68:69]
    s_mul_i32 s64, s63, 1
    s_bitcmp1_b32 s53, 1
    s_cbranch_scc0 L_evret
    s_waitcnt vmcnt(12)
    v_smfmac_f32_16x16x64_bf16 v[16:19], v[40:43], v[80:87], v14
    v_xor_b32 v24, v24, v40
    v_xor_b32 v25, v25, v41
    v_smfmac_f32_16x16x64_bf16 v[20:23], v[40:43], v[88:95], v14
    v_xor_b32 v26, v26, v42
    v_xor_b32 v27, v27, v43
    s_branch L_flush
L_ev2:
    s_and_b32 s65, s57, 15
    v_cmp_ge_u32 s[66:67], s65, v4
    v_cmp_gt_u32 s[68:69], s65, v4
    s_bitcmp1_b32 s56, 2
    s_cselect_b64 s[62:63], s[70:71], s[62:63]
    v_cndmask_b32 v40, 0, v28, s[66:67]
    v_cndmask_b32 v41, 0, v29, s[66:67]
    v_cndmask_b32 v42, 0, v30, s[68:69]
    v_cndmask_b32 v43, 0, v31, s[68:69]
    s_mul_i32 s64, s63, 2
    s_bitcmp1_b32 s53, 2
    s_cbranch_scc0 L_evret
    s_waitcnt vmcnt(12)
    v_smfmac_f32_16x16x64_bf16 v[16:19], v[40:43], v[96:103], v14
    v_xor_b32 v28, v28, v40
    v_xor_b32 v29, v29, v41
    v_smfmac_f32_16x16x64_bf16 v[20:23], v[40:43], v[104:111], v14
    v_xor_b32 v30, v30, v42
    v_xor_b32 v31, v31, v43
    s_branch L_flush
L_ev3:
    s_and_b32 s65, s57, 15
    v_cmp_ge_u32 s[66:67], s65, v4
    v_cmp_gt_u32 s[68:69], s65, v4
    s_bitcmp1_b32 s56, 3
    s_cselect_b64 s[62:63], s[70:71], s[62:63]
    v_cndmask_b32 v40, 0, v24, s[66:67]
    v_cndmask_b32 v41, 0, v25, s[66:67]
    v_cndmask_b32 v42, 0, v26, s[68:69]
    v_cndmask_b32 v43, 0, v27, s[68:69]
    s_mul_i32 s64, s63, 3
    s_bitcmp1_b32 s53, 3
    s_cbranch_scc0 L_evret
    s_waitcnt vmcnt(12)
    v_smfmac_f32_16x16x64_bf16 v[16:19], v[40:43], v[112:119], v14
    v_xor_b32 v24, v24, v40
    v_xor_b32 v25, v25, v41
    v_smfmac_f32_16x16x64_bf16 v[20:23], v[40:43], v[120:127], v14
    v_xor_b32 v26, v26, v42
    v_xor_b32 v27, v27, v43
    s_branch L_flush
L_ev4:
    s_and_b32 s65, s57, 15
    v_cmp_ge_u32 s[66:67], s65, v4
    v_cmp_gt_u32 s[68:69], s65, v4
    s_bitcmp1_b32 s56, 4
    s_cselect_b64 s[62:63], s[70:71], s[62:63]
    v_cndmask_b32 v40, 0, v28, s[66:67]
    v_cndmask_b32 v41, 0, v29, s[66:67]
    v_cndmask_b32 v42, 0, v30, s[68:69]
    v_cndmask_b32 v43, 0, v31, s[68:69]
    s_mul_i32 s64, s63, 4
    s_bitcmp1_b32 s53, 4
    s_cbranch_scc0 L_evret
    s_waitcnt vmcnt(12)
    v_smfmac_f32_16x16x64_bf16 v[16:19], v[40:43], v[128:135], v14
    v_xor_b32 v28, v28, v40
    v_xor_b32 v29, v29, v41
    v_smfmac_f32_16x16x64_bf16 v[20:23], v[40:43], v[136:143], v14
    v_xor_b32 v30, v30, v42
    v_xor_b32 v31, v31, v43
    s_branch L_flush
L_ev5:
    s_and_b32 s65, s57, 15
    v_cmp_ge_u32 s[66:67], s65, v4
    v_cmp_gt_u32 s[68:69], s65, v4
    s_bitcmp1_b32 s56, 5
    s_cselect_b64 s[62:63], s[70:71], s[62:63]
    v_cndmask_b32 v40, 0, v24, s[66:67]
    v_cndmask_b32 v41, 0, v25, s[66:67]
    v_cndmask_b32 v42, 0, v26, s[68:69]
    v_cndmask_b32 v43, 0, v27, s[68:69]
    s_mul_i32 s64, s63, 5
    s_bitcmp1_b32 s53, 5
    s_cbranch_scc0 L_evret
    s_waitcnt vmcnt(12)
    v_smfmac_f32_16x16x64_bf16 v[16:19], v[40:43], v[144:151], v14
    v_xor_b32 v24, v24, v40
    v_xor_b32 v25, v25, v41
    v_smfmac_f32_16x16x64_bf16 v[20:23], v[40:43], v[152:159], v14
    v_xor_b32 v26, v26, v42
    v_xor_b32 v27, v27, v43
    s_branch L_flush
L_ev6:
    s_and_b32 s65, s57, 15
    v_cmp_ge_u32 s[66:67], s65, v4
    v_cmp_gt_u32 s[68:69], s65, v4
    s_bitcmp1_b32 s56, 6
    s_cselect_b64 s[62:63], s[70:71], s[62:63]
    v_cndmask_b32 v40, 0, v28, s[66:67]
    v_cndmask_b32 v41, 0, v29, s[66:67]
    v_cndmask_b32 v42, 0, v30, s[68:69]
    v_cndmask_b32 v43, 0, v31, s[68:69]
    s_mul_i32 s64, s63, 6
    s_bitcmp1_b32 s53, 6
    s_cbranch_scc0 L_evret
    s_waitcnt vmcnt(12)
    v_smfmac_f32_16x16x64_bf16 v[16:19], v[40:43], v[160:167], v14
    v_xor_b32 v28, v28, v40
    v_xor_b32 v29, v29, v41
    v_smfmac_f32_16x16x64_bf16 v[20:23], v[40:43], v[168:175], v14
    v_xor_b32 v30, v30, v42
    v_xor_b32 v31, v31, v43
    s_branch L_flush
L_ev7:
    s_and_b32 s65, s57, 15
    v_cmp_ge_u32 s[66:67], s65, v4
    v_cmp_gt_u32 s[68:69], s65, v4
    s_bitcmp1_b32 s56, 7
    s_cselect_b64 s[62:63], s[70:71], s[62:63]
    v_cndmask_b32 v40, 0, v24, s[66:67]
    v_cndmask_b32 v41, 0, v25, s[66:67]
    v_cndmask_b32 v42, 0, v26, s[68:69]
    v_cndmask_b32 v43, 0, v27, s[68:69]
    s_mul_i32 s64, s63, 7
    s_bitcmp1_b32 s53, 7
    s_cbranch_scc0 L_evret
    s_waitcnt vmcnt(12)
    v_smfmac_f32_16x16x64_bf16 v[16:19], v[40:43], v[48:55], v14
    v_xor_b32 v24, v24, v40
    v_xor_b32 v25, v25, v41
    v_smfmac_f32_16x16x64_bf16 v[20:23], v[40:43], v[56:63], v14
    v_xor_b32 v26, v26, v42
    v_xor_b32 v27, v27, v43
    s_nop 0
L_flush:
    s_lshr_b32 s57, s57, 4
    s_cmp_eq_u32 s26, 4
    v_add_u32 v1, 1, v1
    v_mul_f32 v40, v177, v16
    v_mul_f32 v41, v177, v17
    v_mul_f32 v42, v177, v18
    v_mul_f32 v43, v177, v19
    v_cvt_pk_bf16_f32 v40, v40, v41
    v_cvt_pk_bf16_f32 v41, v42, v43
    ds_write_b64 v176, v[40:41] offset:41984
    v_mul_f32 v44, v177, v20
    v_mul_f32 v45, v177, v21
    v_mul_f32 v46, v177, v22
    v_mul_f32 v47, v177, v23
    v_cvt_pk_bf16_f32 v44, v44, v45
    v_cvt_pk_bf16_f32 v45, v46, v47
    ds_write_b64 v176, v[44:45] offset:42240
    ds_write_b32 v10, v1 offset:32
    s_cbranch_scc1 L_sdone
    v_mov_b64 v[16:17], 0
    v_mov_b64 v[18:19], 0
    v_mov_b64 v[20:21], 0
    v_mov_b64 v[22:23], 0
    s_add_u32 s26, s26, 1
    v_mov_b64 v[176:177], v[178:179]
    v_mov_b64 v[178:179], v[180:181]
    v_mov_b64 v[180:181], v[182:183]
    v_mov_b64 v[182:183], v[184:185]
L_evret:
    s_add_u32 s64, s64, s62
    s_add_u32 s54, s72, s64
    s_addc_u32 s55, s73, 0
    s_setpc_b64 s[54:55]
L_slow:
    s_mov_b32 s62, L_slow_pair-L_anc
    v_mbcnt_lo_u32_b32 v200, -1, 0
    v_mbcnt_hi_u32_b32 v200, -1, v200
L_slow_pair:
    v_lshlrev_b32 v201, 2, v200
    s_mul_i32 s70, s1, 40
    s_lshl1_add_u32 s70, s24, s70
    s_mov_b32 s71, 0
    s_mov_b32 s24, s20
    s_mov_b32 s20, s21
    s_mov_b32 s21, s22
    s_mov_b32 s22, s23
L_slow_chunk:
    global_load_dword v202, v201, s[8:9]
    global_load_dword v203, v201, s[6:7]
    v_add_u32 v201, 0x100, v201
    s_waitcnt vmcnt(0)
    v_subrev_u32 v202, s70, v202
    v_cmp_gt_u32 vcc, 2, v202
    v_lshlrev_b32 v204, 1, v203
    ds_read_u16 v204, v204 offset:62464
    s_mov_b64 s[76:77], vcc
    v_lshlrev_b32 v202, 4, v202
    v_lshlrev_b32 v203, 9, v203
    s_waitcnt lgkmcnt(0)
    v_lshlrev_b32 v204, v202, v204
L_slow_edge:
    s_cmp_eq_u64 s[76:77], 0
    s_cbranch_scc1 L_slow_next
    s_ff1_i32_b64 s74, s[76:77]
    s_bitset0_b64 s[76:77], s74
    v_readlane_b32 s64, v203, s74
    v_readlane_b32 s65, v204, s74
    v_mov_b32 v205, 0
    v_mov_b32 v11, 2147483648
    s_mov_b64 exec, 0xffff
    v_mov_b32 v205, s65
    v_add_u32 v11, s64, v7
    s_mov_b64 exec, -1
    buffer_load_dwordx4 v[208:211], v11, s[32:35], 0 offen
    buffer_load_dwordx4 v[212:215], v11, s[32:35], 0 offen offset:256
    v_and_b32 v24, v205, v12
    v_and_b32 v25, v205, v13
    s_nop 0
    s_waitcnt vmcnt(0)
    v_smfmac_f32_16x16x32_bf16 v[16:19], v[24:25], v[208:211], v14
    v_smfmac_f32_16x16x32_bf16 v[20:23], v[24:25], v[212:215], v14
    s_branch L_slow_edge
L_slow_next:
    s_add_u32 s71, s71, 1
    s_cmp_lt_u32 s71, 2500
    s_cbranch_scc1 L_slow_chunk
    s_mov_b32 s64, 0
    s_nop 3
    s_branch L_flush
L_sdone:
    ds_write_b32 v10, v6 offset:48
    s_waitcnt lgkmcnt(0)
    s_barrier
    s_endpgm
L_retry_7:
    s_sub_u32 s100, s100, 1
    s_cbranch_scc1 L_end
    s_sleep 1
    s_branch L_spin_6
L_retry_11:
    s_sub_u32 s100, s100, 1
    s_cbranch_scc1 L_end
    s_sleep 1
    s_branch L_spin_10
L_retry_12:
    s_sub_u32 s100, s100, 1
    s_cbranch_scc1 L_end
    s_sleep 4
    s_branch L_ipoll_9
L_retry_14:
    s_sub_u32 s100, s100, 1
    s_cbranch_scc1 L_end
    s_sleep 1
    s_branch L_spin_13
L_mrole_1:
    v_lshlrev_b32 v43, 4, v4
    v_lshl_add_u32 v46, v46, 9, v43
    s_bfe_u32 s64, s68, 0x30002
    s_lshl_b32 s64, s64, 14
    s_lshr_b32 s65, s68, 5
    s_lshl_b32 s65, s65, 15
    s_bfe_u32 s66, s68, 0x10001
    s_lshl_b32 s66, s66, 14
    s_add_u32 s65, s65, s66
    s_and_b32 s66, s68, 1
    s_lshl_b32 s66, s66, 11
    s_add_u32 s65, s65, s66
    s_lshr_b32 s66, s2, 2
    s_xor_b32 s66, s66, s2
    s_and_b32 s66, s66, 0x30
    s_lshl_b32 s66, s66, 3
    v_add_u32 v46, s66, v46
    v_add_u32 v44, s64, v46
    v_add_u32 v45, s65, v46
    s_cmp_lg_u32 s31, 0
    s_waitcnt lgkmcnt(0)
    global_load_dword v0, v42, s[10:11]
    s_cbranch_scc1 L_roled_2
    global_load_dwordx4 v[48:51], v45, s[20:21] offset:0
    global_load_dwordx4 v[52:55], v44, s[18:19] offset:0
    global_load_dwordx4 v[56:59], v44, s[18:19] offset:2048
    global_load_dwordx4 v[60:63], v45, s[20:21] offset:64
    global_load_dwordx4 v[64:67], v44, s[18:19] offset:64
    global_load_dwordx4 v[68:71], v44, s[18:19] offset:2112
    v_xor_b32 v44, 128, v44
    v_xor_b32 v45, 128, v45
    global_load_dwordx4 v[72:75], v45, s[20:21] offset:0
    global_load_dwordx4 v[76:79], v44, s[18:19] offset:0
    global_load_dwordx4 v[80:83], v44, s[18:19] offset:2048
    global_load_dwordx4 v[84:87], v45, s[20:21] offset:64
    global_load_dwordx4 v[88:91], v44, s[18:19] offset:64
    global_load_dwordx4 v[92:95], v44, s[18:19] offset:2112
    v_xor_b32 v44, 384, v44
    v_xor_b32 v45, 384, v45
    global_load_dwordx4 v[96:99], v45, s[20:21] offset:0
    global_load_dwordx4 v[100:103], v44, s[18:19] offset:0
    global_load_dwordx4 v[104:107], v44, s[18:19] offset:2048
    global_load_dwordx4 v[108:111], v45, s[20:21] offset:64
    global_load_dwordx4 v[112:115], v44, s[18:19] offset:64
    global_load_dwordx4 v[116:119], v44, s[18:19] offset:2112
    v_xor_b32 v44, 128, v44
    v_xor_b32 v45, 128, v45
    global_load_dwordx4 v[120:123], v45, s[20:21] offset:0
    global_load_dwordx4 v[124:127], v44, s[18:19] offset:0
    global_load_dwordx4 v[128:131], v44, s[18:19] offset:2048
    global_load_dwordx4 v[132:135], v45, s[20:21] offset:64
    global_load_dwordx4 v[136:139], v44, s[18:19] offset:64
    global_load_dwordx4 v[140:143], v44, s[18:19] offset:2112
    s_branch L_roled_2
L_mwork_4:
    s_cmp_lg_u32 s31, 0
    s_cbranch_scc1 L_worked_5_w
    s_waitcnt vmcnt(21)
    v_mfma_f32_16x16x32_bf16 v[16:19], v[52:55], v[48:51], 0
    v_mfma_f32_16x16x32_bf16 v[20:23], v[56:59], v[48:51], 0
    s_waitcnt vmcnt(18)
    v_mfma_f32_16x16x32_bf16 v[16:19], v[64:67], v[60:63], v[16:19]
    v_mfma_f32_16x16x32_bf16 v[20:23], v[68:71], v[60:63], v[20:23]
    s_waitcnt vmcnt(15)
    v_mfma_f32_16x16x32_bf16 v[16:19], v[76:79], v[72:75], v[16:19]
    v_mfma_f32_16x16x32_bf16 v[20:23], v[80:83], v[72:75], v[20:23]
    s_waitcnt vmcnt(12)
    v_mfma_f32_16x16x32_bf16 v[16:19], v[88:91], v[84:87], v[16:19]
    v_mfma_f32_16x16x32_bf16 v[20:23], v[92:95], v[84:87], v[20:23]
    s_waitcnt vmcnt(9)
    v_mfma_f32_16x16x32_bf16 v[16:19], v[100:103], v[96:99], v[16:19]
    v_mfma_f32_16x16x32_bf16 v[20:23], v[104:107], v[96:99], v[20:23]
    s_waitcnt vmcnt(6)
    v_mfma_f32_16x16x32_bf16 v[16:19], v[112:115], v[108:111], v[16:19]
    v_mfma_f32_16x16x32_bf16 v[20:23], v[116:119], v[108:111], v[20:23]
    s_waitcnt vmcnt(3)
    v_mfma_f32_16x16x32_bf16 v[16:19], v[124:127], v[120:123], v[16:19]
    v_mfma_f32_16x16x32_bf16 v[20:23], v[128:131], v[120:123], v[20:23]
    s_waitcnt vmcnt(0)
    v_mfma_f32_16x16x32_bf16 v[16:19], v[136:139], v[132:135], v[16:19]
    v_mfma_f32_16x16x32_bf16 v[20:23], v[140:143], v[132:135], v[20:23]
    s_lshl_b32 s64, s27, 10
    s_add_u32 s64, s64, 65536
    v_lshl_add_u32 v40, v2, 4, s64
    s_lshl_b32 s64, s27, 2
    s_add_u32 s64, s64, 4096
    v_lshl_add_u32 v41, v2, 9, s64
    v_mov_b32 v42, s30
    s_nop 1
    v_cvt_pk_bf16_f32 v44, v16, v17
    v_cvt_pk_bf16_f32 v45, v18, v19
    v_cvt_pk_bf16_f32 v46, v20, v21
    v_cvt_pk_bf16_f32 v47, v22, v23
    global_store_dwordx4 v40, v[44:47], s[28:29] sc1
    s_mov_b32 s26, 1
    s_waitcnt vmcnt(1)
    s_branch L_worked_5
L_worked_5_w:
    s_waitcnt vmcnt(0)
    s_branch L_worked_5
L_gemm:
    v_lshrrev_b32 v0, 5, v2
    s_lshl_b32 s64, s31, 1
    v_add_u32 v0, s64, v0
    v_and_b32 v1, 31, v2
    v_xor_b32 v1, v1, v0
    v_lshlrev_b32 v1, 4, v1
    v_lshl_add_u32 v0, v0, 9, v1
    v_xor_b32 v1, 0x80, v0
    v_lshrrev_b32 v13, 3, v2
    v_lshrrev_b32 v15, 2, v2
    v_and_b32 v15, 4, v15
    v_and_b32 v14, 7, v2
    v_xor_b32 v15, v15, v14
    v_lshlrev_b32 v15, 4, v15
    v_lshl_add_u32 v13, v13, 9, v15
    s_lshr_b32 s67, s2, 3
    s_and_b32 s67, s67, 7
    s_lshl_b32 s64, s31, 7
    s_lshl_b32 s65, s67, 14
    s_or_b32 s64, s64, s65
    v_add_u32 v13, s64, v13
    s_mul_i32 s65, s1, 20480
    s_lshl_b32 s66, s31, 10
    s_lshl_b32 s70, s31, 14
    s_add_u32 s70, s70, 82944
    s_mov_b32 s71, 3072
    s_mov_b32 s72, 6144
    s_mov_b32 s73, 9216
    s_waitcnt lgkmcnt(0)
    s_mov_b32 s32, s4
    s_and_b32 s33, s5, 0xffff
    s_mov_b32 s34, 5120000
    s_mov_b32 s35, 0x20000
    s_mov_b32 s36, s22
    s_and_b32 s37, s23, 0xffff
    s_mov_b32 s38, 131072
    s_mov_b32 s39, 0x20000
    s_bitcmp1_b32 s2, 3
    s_cbranch_scc0 L_touched_15
    s_lshr_b32 s64, s2, 4
    s_lshl_b32 s64, s64, 3
    s_and_b32 s68, s2, 7
    s_or_b32 s64, s64, s68
    s_lshl_b32 s64, s64, 10
    v_lshl_add_u32 v16, v2, 4, s64
    s_cmp_eq_u32 s31, 1
    s_cselect_b64 s[68:69], s[22:23], s[16:17]
    s_cmp_eq_u32 s31, 2
    s_cselect_b64 s[68:69], s[18:19], s[68:69]
    s_cmp_eq_u32 s31, 3
    s_cselect_b64 s[68:69], s[20:21], s[68:69]
    global_load_dwordx4 v[20:23], v16, s[68:69]
L_touched_15:
    s_cmp_ge_u32 s2, 250
    s_cbranch_scc1 L_end
    s_mul_i32 s64, s1, 20480
    s_mov_b32 s76, 0
    s_cmp_eq_u32 s31, 0
    s_cselect_b64 s[68:69], s[24:25], s[16:17]
    s_cselect_b32 s64, s64, 0
    s_cmp_eq_u32 s31, 2
    s_cselect_b64 s[68:69], s[28:29], s[68:69]
    s_cselect_b32 s64, 0x800, s64
    s_cselect_b32 s76, 0x2f8000, s76
    s_cmp_eq_u32 s31, 3
    s_cselect_b64 s[68:69], s[4:5], s[68:69]
    s_cselect_b32 s76, 0x200000, s76
    s_cselect_b32 s77, 2, 1
    v_min_u32 v17, s77, v2
    v_mul_lo_u32 v17, v17, s76
    v_add_u32 v17, s64, v17
    global_load_dword v24, v17, s[68:69]
    s_add_u32 m0, s66, 1024
    s_nop 0
    buffer_load_dwordx4 v0, s[32:35], s65 offen lds
    s_add_u32 m0, s66, 5120
    s_add_u32 s65, s65, 4096
    buffer_load_dwordx4 v1, s[32:35], s65 offen lds
    s_add_u32 m0, s66, 9216
    s_add_u32 s65, s65, 4096
    buffer_load_dwordx4 v0, s[32:35], s65 offen lds
    s_add_u32 m0, s66, 13312
    s_add_u32 s65, s65, 4096
    buffer_load_dwordx4 v1, s[32:35], s65 offen lds
    s_add_u32 m0, s66, 17408
    s_add_u32 s65, s65, 4096
    buffer_load_dwordx4 v0, s[32:35], s65 offen lds
    s_barrier
    s_setprio 2
    s_add_u32 m0, s70, 0
    s_nop 0
    buffer_load_dwordx4 v13, s[36:39], 0 offen offset:0 lds
    buffer_load_dwordx4 v13, s[36:39], s71 offen offset:1024 lds
    buffer_load_dwordx4 v13, s[36:39], s72 offen offset:2048 lds
    buffer_load_dwordx4 v13, s[36:39], s73 offen offset:3072 lds
    v_xor_b32 v13, 16384, v13
    s_mov_b32 s40, s16
    s_and_b32 s41, s17, 0xffff
    s_mov_b32 s42, 131072
    s_mov_b32 s43, 0x20000
    s_mov_b32 s44, s28
    s_and_b32 s45, s29, 0xffff
    s_mov_b32 s46, 1048576
    s_mov_b32 s47, 0x20000
    s_mov_b32 s48, s24
    s_and_b32 s49, s25, 0xffff
    s_mov_b32 s50, 5120000
    s_mov_b32 s51, 0x20000
    v_xor_b32 v15, v4, v3
    v_lshlrev_b32 v15, 4, v15
    v_lshl_add_u32 v7, v3, 9, v15
    s_lshl_b32 s64, s67, 6
    v_xor_b32 v7, s64, v7
    v_xor_b32 v8, 64, v7
    v_xor_b32 v9, 0x80, v7
    v_xor_b32 v10, 0xc0, v7
    v_lshrrev_b32 v15, 2, v3
    v_lshl_add_u32 v15, v4, 3, v15
    v_lshlrev_b32 v15, 7, v15
    v_lshrrev_b32 v14, 1, v3
    v_and_b32 v14, 4, v14
    v_and_b32 v0, 3, v3
    v_xor_b32 v14, v14, v0
    v_lshl_add_u32 v15, v14, 4, v15
    v_add_u32 v11, s70, v15
    v_xor_b32 v12, 64, v11
    v_and_b32 v0, 31, v2
    v_lshlrev_b32 v0, 2, v0
    s_and_b32 s64, s2, 15
    s_lshl_b32 s64, s64, 9
    s_lshl_b32 s65, s31, 7
    s_add_u32 s64, s64, s65
    s_add_u32 s74, s64, 4096
    v_lshlrev_b32 v14, 4, v2
    s_lshl_b32 s75, s31, 15
    s_lshl_b32 s64, s67, 12
    s_or_b32 s75, s75, s64
    s_add_u32 s75, s75, 65536
    s_add_u32 m0, s70, 4096
    s_waitcnt vmcnt(9)
    buffer_load_dwordx4 v13, s[36:39], 0 offen offset:0 lds
    s_waitcnt vmcnt(9)
    buffer_load_dwordx4 v13, s[36:39], s71 offen offset:1024 lds
    s_waitcnt vmcnt(9)
    buffer_load_dwordx4 v13, s[36:39], s72 offen offset:2048 lds
    s_waitcnt vmcnt(9)
    buffer_load_dwordx4 v13, s[36:39], s73 offen offset:3072 lds
    v_xor_b32 v13, 49152, v13
    s_add_u32 m0, s70, 8192
    s_waitcnt vmcnt(9)
    buffer_load_dwordx4 v13, s[36:39], 0 offen offset:0 lds
    s_waitcnt vmcnt(9)
    buffer_load_dwordx4 v13, s[36:39], s71 offen offset:1024 lds
    s_waitcnt vmcnt(9)
    buffer_load_dwordx4 v13, s[36:39], s72 offen offset:2048 lds
    s_waitcnt vmcnt(9)
    buffer_load_dwordx4 v13, s[36:39], s73 offen offset:3072 lds
    v_xor_b32 v13, 16384, v13
    s_add_u32 m0, s70, 12288
    s_waitcnt vmcnt(4)
    buffer_load_dwordx4 v13, s[36:39], 0 offen offset:0 lds
    s_waitcnt vmcnt(4)
    buffer_load_dwordx4 v13, s[36:39], s71 offen offset:1024 lds
    s_waitcnt vmcnt(4)
    buffer_load_dwordx4 v13, s[36:39], s72 offen offset:2048 lds
    s_waitcnt vmcnt(4)
    buffer_load_dwordx4 v13, s[36:39], s73 offen offset:3072 lds
    v_xor_b32 v13, 114688, v13
    s_waitcnt vmcnt(12)
    s_waitcnt lgkmcnt(0)
    s_mov_b64 exec, 1
    ds_add_u32 v5, v6 offset:4
    s_mov_b64 exec, -1
    ds_read_b64_tr_b16 v[128:129], v11 offset:0
    ds_read_b64_tr_b16 v[130:131], v11 offset:512
    ds_read_b64_tr_b16 v[132:133], v11 offset:8
    ds_read_b64_tr_b16 v[134:135], v11 offset:520
    ds_read_b64_tr_b16 v[136:137], v12 offset:0
    ds_read_b64_tr_b16 v[138:139], v12 offset:512
    ds_read_b64_tr_b16 v[140:141], v12 offset:8
    ds_read_b64_tr_b16 v[142:143], v12 offset:520
    s_waitcnt lgkmcnt(0)
    s_add_u32 m0, s70, 0
    s_waitcnt vmcnt(4)
    buffer_load_dwordx4 v13, s[36:39], 0 offen offset:0 lds
    s_waitcnt vmcnt(4)
    buffer_load_dwordx4 v13, s[36:39], s71 offen offset:1024 lds
    s_waitcnt vmcnt(4)
    buffer_load_dwordx4 v13, s[36:39], s72 offen offset:2048 lds
    s_waitcnt vmcnt(4)
    buffer_load_dwordx4 v13, s[36:39], s73 offen offset:3072 lds
    v_xor_b32 v13, 16384, v13
    s_waitcnt vmcnt(12)
    ds_read_b64_tr_b16 v[144:145], v11 offset:4096
    ds_read_b64_tr_b16 v[146:147], v11 offset:4608
    ds_read_b64_tr_b16 v[148:149], v11 offset:4104
    ds_read_b64_tr_b16 v[150:151], v11 offset:4616
    ds_read_b64_tr_b16 v[152:153], v12 offset:4096
    ds_read_b64_tr_b16 v[154:155], v12 offset:4608
    ds_read_b64_tr_b16 v[156:157], v12 offset:4104
    ds_read_b64_tr_b16 v[158:159], v12 offset:4616
    s_waitcnt lgkmcnt(0)
    s_add_u32 m0, s70, 4096
    s_waitcnt vmcnt(4)
    buffer_load_dwordx4 v13, s[36:39], 0 offen offset:0 lds
    s_waitcnt vmcnt(4)
    buffer_load_dwordx4 v13, s[36:39], s71 offen offset:1024 lds
    s_waitcnt vmcnt(4)
    buffer_load_dwordx4 v13, s[36:39], s72 offen offset:2048 lds
    s_waitcnt vmcnt(4)
    buffer_load_dwordx4 v13, s[36:39], s73 offen offset:3072 lds
    v_xor_b32 v13, 49152, v13
    s_waitcnt vmcnt(12)
    ds_read_b64_tr_b16 v[160:161], v11 offset:8192
    ds_read_b64_tr_b16 v[162:163], v11 offset:8704
    ds_read_b64_tr_b16 v[164:165], v11 offset:8200
    ds_read_b64_tr_b16 v[166:167], v11 offset:8712
    ds_read_b64_tr_b16 v[168:169], v12 offset:8192
    ds_read_b64_tr_b16 v[170:171], v12 offset:8704
    ds_read_b64_tr_b16 v[172:173], v12 offset:8200
    ds_read_b64_tr_b16 v[174:175], v12 offset:8712
    s_waitcnt lgkmcnt(0)
    s_add_u32 m0, s70, 8192
    s_waitcnt vmcnt(4)
    buffer_load_dwordx4 v13, s[36:39], 0 offen offset:0 lds
    s_waitcnt vmcnt(4)
    buffer_load_dwordx4 v13, s[36:39], s71 offen offset:1024 lds
    s_waitcnt vmcnt(4)
    buffer_load_dwordx4 v13, s[36:39], s72 offen offset:2048 lds
    s_waitcnt vmcnt(4)
    buffer_load_dwordx4 v13, s[36:39], s73 offen offset:3072 lds
    v_xor_b32 v13, 16384, v13
    buffer_load_dword v1, v0, s[44:47], s74 offen sc1
    s_waitcnt vmcnt(13)
    ds_read_b64_tr_b16 v[176:177], v11 offset:12288
    ds_read_b64_tr_b16 v[178:179], v11 offset:12800
    ds_read_b64_tr_b16 v[180:181], v11 offset:12296
    ds_read_b64_tr_b16 v[182:183], v11 offset:12808
    ds_read_b64_tr_b16 v[184:185], v12 offset:12288
    ds_read_b64_tr_b16 v[186:187], v12 offset:12800
    ds_read_b64_tr_b16 v[188:189], v12 offset:12296
    ds_read_b64_tr_b16 v[190:191], v12 offset:12808
    s_waitcnt lgkmcnt(0)
    s_add_u32 m0, s70, 12288
    s_nop 0
    buffer_load_dwordx4 v13, s[36:39], 0 offen offset:0 lds
    buffer_load_dwordx4 v13, s[36:39], s71 offen offset:1024 lds
    buffer_load_dwordx4 v13, s[36:39], s72 offen offset:2048 lds
    buffer_load_dwordx4 v13, s[36:39], s73 offen offset:3072 lds
    v_xor_b32 v13, 114688, v13
    s_waitcnt vmcnt(13)
    ds_read_b64_tr_b16 v[192:193], v11 offset:0
    ds_read_b64_tr_b16 v[194:195], v11 offset:512
    ds_read_b64_tr_b16 v[196:197], v11 offset:8
    ds_read_b64_tr_b16 v[198:199], v11 offset:520
    ds_read_b64_tr_b16 v[200:201], v12 offset:0
    ds_read_b64_tr_b16 v[202:203], v12 offset:512
    ds_read_b64_tr_b16 v[204:205], v12 offset:8
    ds_read_b64_tr_b16 v[206:207], v12 offset:520
    s_waitcnt vmcnt(9)
    ds_read_b64_tr_b16 v[208:209], v11 offset:4096
    ds_read_b64_tr_b16 v[210:211], v11 offset:4608
    ds_read_b64_tr_b16 v[212:213], v11 offset:4104
    ds_read_b64_tr_b16 v[214:215], v11 offset:4616
    ds_read_b64_tr_b16 v[216:217], v12 offset:4096
    ds_read_b64_tr_b16 v[218:219], v12 offset:4608
    ds_read_b64_tr_b16 v[220:221], v12 offset:4104
    ds_read_b64_tr_b16 v[222:223], v12 offset:4616
    s_waitcnt vmcnt(5)
    ds_read_b64_tr_b16 v[224:225], v11 offset:8192
    ds_read_b64_tr_b16 v[226:227], v11 offset:8704
    ds_read_b64_tr_b16 v[228:229], v11 offset:8200
    ds_read_b64_tr_b16 v[230:231], v11 offset:8712
    ds_read_b64_tr_b16 v[232:233], v12 offset:8192
    ds_read_b64_tr_b16 v[234:235], v12 offset:8704
    ds_read_b64_tr_b16 v[236:237], v12 offset:8200
    ds_read_b64_tr_b16 v[238:239], v12 offset:8712
    s_waitcnt vmcnt(4)
L_spin_17:
    ds_read_b128 v[16:19], v5
    s_waitcnt lgkmcnt(0)
    v_readfirstlane_b32 s101, v18
    v_readfirstlane_b32 s30, v19
    s_cmp_ge_u32 s101, 1
    s_cbranch_scc0 L_retry_18
L_mchk_16:
    v_cmp_ne_u32 vcc, s30, v1
    s_cbranch_vccnz L_mre_19
    buffer_load_dwordx4 v[40:43], v14, s[44:47], s75 offen offset:0 sc1
    buffer_load_dwordx4 v[44:47], v14, s[44:47], s75 offen offset:1024 sc1
    buffer_load_dwordx4 v[48:51], v14, s[44:47], s75 offen offset:2048 sc1
    buffer_load_dwordx4 v[52:55], v14, s[44:47], s75 offen offset:3072 sc1
    s_xor_b32 s75, s75, 4096
    buffer_load_dwordx4 v[56:59], v14, s[44:47], s75 offen offset:0 sc1
    buffer_load_dwordx4 v[60:63], v14, s[44:47], s75 offen offset:1024 sc1
    buffer_load_dwordx4 v[64:67], v14, s[44:47], s75 offen offset:2048 sc1
    buffer_load_dwordx4 v[68:71], v14, s[44:47], s75 offen offset:3072 sc1
    s_xor_b32 s75, s75, 12288
    buffer_load_dwordx4 v[72:75], v14, s[44:47], s75 offen offset:0 sc1
    buffer_load_dwordx4 v[76:79], v14, s[44:47], s75 offen offset:1024 sc1
    s_waitcnt vmcnt(10)
    ds_read_b64_tr_b16 v[240:241], v11 offset:12288
    ds_read_b64_tr_b16 v[242:243], v11 offset:12800
    ds_read_b64_tr_b16 v[244:245], v11 offset:12296
    ds_read_b64_tr_b16 v[246:247], v11 offset:12808
    ds_read_b64_tr_b16 v[248:249], v12 offset:12288
    ds_read_b64_tr_b16 v[250:251], v12 offset:12800
    ds_read_b64_tr_b16 v[252:253], v12 offset:12296
    ds_read_b64_tr_b16 v[254:255], v12 offset:12808
L_spin_20:
    ds_read_b32 v15, v5 offset:4
    s_waitcnt lgkmcnt(0)
    v_readfirstlane_b32 s101, v15
    s_cmp_ge_u32 s101, 4
    s_cbranch_scc0 L_retry_21
    ds_read_b128 v[16:19], v7 offset:1024
    ds_read_b128 v[20:23], v7 offset:9216
    ds_read_b128 v[24:27], v7 offset:17408
    v_xor_b32 v7, 0x100, v7
    ds_read_b128 v[28:31], v8 offset:1024
    ds_read_b128 v[32:35], v8 offset:9216
    ds_read_b128 v[36:39], v8 offset:17408
    v_xor_b32 v8, 0x100, v8
    s_waitcnt lgkmcnt(3)
    s_waitcnt vmcnt(9)
    v_mfma_f32_16x16x32_bf16 v[80:83], v[40:43], v[16:19], 0
    v_mfma_f32_16x16x32_bf16 v[96:99], v[40:43], v[20:23], 0
    v_mfma_f32_16x16x32_bf16 v[112:115], v[40:43], v[24:27], 0
    buffer_load_dwordx4 v[40:43], v14, s[44:47], s75 offen offset:2048 sc1
    s_waitcnt vmcnt(9)
    v_mfma_f32_16x16x32_bf16 v[84:87], v[44:47], v[16:19], 0
    v_mfma_f32_16x16x32_bf16 v[100:103], v[44:47], v[20:23], 0
    v_mfma_f32_16x16x32_bf16 v[116:119], v[44:47], v[24:27], 0
    buffer_load_dwordx4 v[44:47], v14, s[44:47], s75 offen offset:3072 sc1
    s_xor_b32 s75, s75, 4096
    s_waitcnt vmcnt(9)
    v_mfma_f32_16x16x32_bf16 v[88:91], v[48:51], v[16:19], 0
    v_mfma_f32_16x16x32_bf16 v[104:107], v[48:51], v[20:23], 0
    v_mfma_f32_16x16x32_bf16 v[120:123], v[48:51], v[24:27], 0
    buffer_load_dwordx4 v[48:51], v14, s[44:47], s75 offen offset:0 sc1
    s_waitcnt vmcnt(9)
    v_mfma_f32_16x16x32_bf16 v[92:95], v[52:55], v[16:19], 0
    v_mfma_f32_16x16x32_bf16 v[108:111], v[52:55], v[20:23], 0
    v_mfma_f32_16x16x32_bf16 v[124:127], v[52:55], v[24:27], 0
    buffer_load_dwordx4 v[52:55], v14, s[44:47], s75 offen offset:1024 sc1
    ds_read_b128 v[16:19], v9 offset:1024
    ds_read_b128 v[20:23], v9 offset:9216
    ds_read_b128 v[24:27], v9 offset:17408
    v_xor_b32 v9, 0x100, v9
    s_waitcnt lgkmcnt(3)
    s_waitcnt vmcnt(9)
    v_mfma_f32_16x16x32_bf16 v[80:83], v[56:59], v[28:31], v[80:83]
    v_mfma_f32_16x16x32_bf16 v[96:99], v[56:59], v[32:35], v[96:99]
    v_mfma_f32_16x16x32_bf16 v[112:115], v[56:59], v[36:39], v[112:115]
    buffer_load_dwordx4 v[56:59], v14, s[44:47], s75 offen offset:2048 sc1
    s_waitcnt vmcnt(9)
    v_mfma_f32_16x16x32_bf16 v[84:87], v[60:63], v[28:31], v[84:87]
    v_mfma_f32_16x16x32_bf16 v[100:103], v[60:63], v[32:35], v[100:103]
    v_mfma_f32_16x16x32_bf16 v[116:119], v[60:63], v[36:39], v[116:119]
    buffer_load_dwordx4 v[60:63], v14, s[44:47], s75 offen offset:3072 sc1
    s_xor_b32 s75, s75, 28672
    s_waitcnt vmcnt(9)
    v_mfma_f32_16x16x32_bf16 v[88:91], v[64:67], v[28:31], v[88:91]
    v_mfma_f32_16x16x32_bf16 v[104:107], v[64:67], v[32:35], v[104:107]
    v_mfma_f32_16x16x32_bf16 v[120:123], v[64:67], v[36:39], v[120:123]
    buffer_load_dwordx4 v[64:67], v14, s[44:47], s75 offen offset:0 sc1
    s_waitcnt vmcnt(9)
    v_mfma_f32_16x16x32_bf16 v[92:95], v[68:71], v[28:31], v[92:95]
    v_mfma_f32_16x16x32_bf16 v[108:111], v[68:71], v[32:35], v[108:111]
    v_mfma_f32_16x16x32_bf16 v[124:127], v[68:71], v[36:39], v[124:127]
    buffer_load_dwordx4 v[68:71], v14, s[44:47], s75 offen offset:1024 sc1
    ds_read_b128 v[28:31], v10 offset:1024
    ds_read_b128 v[32:35], v10 offset:9216
    ds_read_b128 v[36:39], v10 offset:17408
    v_xor_b32 v10, 0x100, v10
    s_waitcnt lgkmcnt(3)
    s_waitcnt vmcnt(9)
    v_mfma_f32_16x16x32_bf16 v[80:83], v[72:75], v[16:19], v[80:83]
    v_mfma_f32_16x16x32_bf16 v[96:99], v[72:75], v[20:23], v[96:99]
    v_mfma_f32_16x16x32_bf16 v[112:115], v[72:75], v[24:27], v[112:115]
    buffer_load_dwordx4 v[72:75], v14, s[44:47], s75 offen offset:2048 sc1
    s_waitcnt vmcnt(9)
    v_mfma_f32_16x16x32_bf16 v[84:87], v[76:79], v[16:19], v[84:87]
    v_mfma_f32_16x16x32_bf16 v[100:103], v[76:79], v[20:23], v[100:103]
    v_mfma_f32_16x16x32_bf16 v[116:119], v[76:79], v[24:27], v[116:119]
    buffer_load_dwordx4 v[76:79], v14, s[44:47], s75 offen offset:3072 sc1
    s_xor_b32 s75, s75, 4096
    s_waitcnt vmcnt(9)
    v_mfma_f32_16x16x32_bf16 v[88:91], v[40:43], v[16:19], v[88:91]
    v_mfma_f32_16x16x32_bf16 v[104:107], v[40:43], v[20:23], v[104:107]
    v_mfma_f32_16x16x32_bf16 v[120:123], v[40:43], v[24:27], v[120:123]
    buffer_load_dwordx4 v[40:43], v14, s[44:47], s75 offen offset:0 sc1
    s_waitcnt vmcnt(9)
    v_mfma_f32_16x16x32_bf16 v[92:95], v[44:47], v[16:19], v[92:95]
    v_mfma_f32_16x16x32_bf16 v[108:111], v[44:47], v[20:23], v[108:111]
    v_mfma_f32_16x16x32_bf16 v[124:127], v[44:47], v[24:27], v[124:127]
    buffer_load_dwordx4 v[44:47], v14, s[44:47], s75 offen offset:1024 sc1
    ds_read_b128 v[16:19], v7 offset:1024
    ds_read_b128 v[20:23], v7 offset:9216
    ds_read_b128 v[24:27], v7 offset:17408
    v_xor_b32 v7, 0x100, v7
    s_waitcnt lgkmcnt(3)
    s_waitcnt vmcnt(9)
    v_mfma_f32_16x16x32_bf16 v[80:83], v[48:51], v[28:31], v[80:83]
    v_mfma_f32_16x16x32_bf16 v[96:99], v[48:51], v[32:35], v[96:99]
    v_mfma_f32_16x16x32_bf16 v[112:115], v[48:51], v[36:39], v[112:115]
    buffer_load_dwordx4 v[48:51], v14, s[44:47], s75 offen offset:2048 sc1
    s_waitcnt vmcnt(9)
    v_mfma_f32_16x16x32_bf16 v[84:87], v[52:55], v[28:31], v[84:87]
    v_mfma_f32_16x16x32_bf16 v[100:103], v[52:55], v[32:35], v[100:103]
    v_mfma_f32_16x16x32_bf16 v[116:119], v[52:55], v[36:39], v[116:119]
    buffer_load_dwordx4 v[52:55], v14, s[44:47], s75 offen offset:3072 sc1
    s_xor_b32 s75, s75, 12288
    s_waitcnt vmcnt(9)
    v_mfma_f32_16x16x32_bf16 v[88:91], v[56:59], v[28:31], v[88:91]
    v_mfma_f32_16x16x32_bf16 v[104:107], v[56:59], v[32:35], v[104:107]
    v_mfma_f32_16x16x32_bf16 v[120:123], v[56:59], v[36:39], v[120:123]
    buffer_load_dwordx4 v[56:59], v14, s[44:47], s75 offen offset:0 sc1
    s_waitcnt vmcnt(9)
    v_mfma_f32_16x16x32_bf16 v[92:95], v[60:63], v[28:31], v[92:95]
    v_mfma_f32_16x16x32_bf16 v[108:111], v[60:63], v[32:35], v[108:111]
    v_mfma_f32_16x16x32_bf16 v[124:127], v[60:63], v[36:39], v[124:127]
    buffer_load_dwordx4 v[60:63], v14, s[44:47], s75 offen offset:1024 sc1
    ds_read_b128 v[28:31], v8 offset:1024
    ds_read_b128 v[32:35], v8 offset:9216
    ds_read_b128 v[36:39], v8 offset:17408
    v_xor_b32 v8, 0x100, v8
    s_waitcnt lgkmcnt(3)
    s_waitcnt vmcnt(9)
    v_mfma_f32_16x16x32_bf16 v[80:83], v[64:67], v[16:19], v[80:83]
    v_mfma_f32_16x16x32_bf16 v[96:99], v[64:67], v[20:23], v[96:99]
    v_mfma_f32_16x16x32_bf16 v[112:115], v[64:67], v[24:27], v[112:115]
    buffer_load_dwordx4 v[64:67], v14, s[44:47], s75 offen offset:2048 sc1
    s_waitcnt vmcnt(9)
    v_mfma_f32_16x16x32_bf16 v[84:87], v[68:71], v[16:19], v[84:87]
    v_mfma_f32_16x16x32_bf16 v[100:103], v[68:71], v[20:23], v[100:103]
    v_mfma_f32_16x16x32_bf16 v[116:119], v[68:71], v[24:27], v[116:119]
    buffer_load_dwordx4 v[68:71], v14, s[44:47], s75 offen offset:3072 sc1
    s_xor_b32 s75, s75, 4096
    s_waitcnt vmcnt(9)
    v_mfma_f32_16x16x32_bf16 v[88:91], v[72:75], v[16:19], v[88:91]
    v_mfma_f32_16x16x32_bf16 v[104:107], v[72:75], v[20:23], v[104:107]
    v_mfma_f32_16x16x32_bf16 v[120:123], v[72:75], v[24:27], v[120:123]
    buffer_load_dwordx4 v[72:75], v14, s[44:47], s75 offen offset:0 sc1
    s_waitcnt vmcnt(9)
    v_mfma_f32_16x16x32_bf16 v[92:95], v[76:79], v[16:19], v[92:95]
    v_mfma_f32_16x16x32_bf16 v[108:111], v[76:79], v[20:23], v[108:111]
    v_mfma_f32_16x16x32_bf16 v[124:127], v[76:79], v[24:27], v[124:127]
    buffer_load_dwordx4 v[76:79], v14, s[44:47], s75 offen offset:1024 sc1
    ds_read_b128 v[16:19], v9 offset:1024
    ds_read_b128 v[20:23], v9 offset:9216
    ds_read_b128 v[24:27], v9 offset:17408
    v_xor_b32 v9, 0x100, v9
    s_waitcnt lgkmcnt(3)
    s_waitcnt vmcnt(9)
    v_mfma_f32_16x16x32_bf16 v[80:83], v[40:43], v[28:31], v[80:83]
    v_mfma_f32_16x16x32_bf16 v[96:99], v[40:43], v[32:35], v[96:99]
    v_mfma_f32_16x16x32_bf16 v[112:115], v[40:43], v[36:39], v[112:115]
    buffer_load_dwordx4 v[40:43], v14, s[44:47], s75 offen offset:2048 sc1
    s_waitcnt vmcnt(9)
    v_mfma_f32_16x16x32_bf16 v[84:87], v[44:47], v[28:31], v[84:87]
    v_mfma_f32_16x16x32_bf16 v[100:103], v[44:47], v[32:35], v[100:103]
    v_mfma_f32_16x16x32_bf16 v[116:119], v[44:47], v[36:39], v[116:119]
    buffer_load_dwordx4 v[44:47], v14, s[44:47], s75 offen offset:3072 sc1
    s_xor_b32 s75, s75, 28672
    s_waitcnt vmcnt(9)
    v_mfma_f32_16x16x32_bf16 v[88:91], v[48:51], v[28:31], v[88:91]
    v_mfma_f32_16x16x32_bf16 v[104:107], v[48:51], v[32:35], v[104:107]
    v_mfma_f32_16x16x32_bf16 v[120:123], v[48:51], v[36:39], v[120:123]
    s_add_u32 m0, s70, 0
    s_nop 0
    buffer_load_dwordx4 v13, s[40:43], 0 offen offset:0 lds
    s_waitcnt vmcnt(9)
    v_mfma_f32_16x16x32_bf16 v[92:95], v[52:55], v[28:31], v[92:95]
    v_mfma_f32_16x16x32_bf16 v[108:111], v[52:55], v[32:35], v[108:111]
    v_mfma_f32_16x16x32_bf16 v[124:127], v[52:55], v[36:39], v[124:127]
    buffer_load_dwordx4 v13, s[40:43], s71 offen offset:1024 lds
    ds_read_b128 v[28:31], v10 offset:1024
    ds_read_b128 v[32:35], v10 offset:9216
    ds_read_b128 v[36:39], v10 offset:17408
    v_xor_b32 v10, 0x100, v10
    s_waitcnt lgkmcnt(3)
    s_waitcnt vmcnt(9)
    v_mfma_f32_16x16x32_bf16 v[80:83], v[56:59], v[16:19], v[80:83]
    v_mfma_f32_16x16x32_bf16 v[96:99], v[56:59], v[20:23], v[96:99]
    v_mfma_f32_16x16x32_bf16 v[112:115], v[56:59], v[24:27], v[112:115]
    buffer_load_dwordx4 v13, s[40:43], s72 offen offset:2048 lds
    s_waitcnt vmcnt(9)
    v_mfma_f32_16x16x32_bf16 v[84:87], v[60:63], v[16:19], v[84:87]
    v_mfma_f32_16x16x32_bf16 v[100:103], v[60:63], v[20:23], v[100:103]
    v_mfma_f32_16x16x32_bf16 v[116:119], v[60:63], v[24:27], v[116:119]
    buffer_load_dwordx4 v13, s[40:43], s73 offen offset:3072 lds
    v_xor_b32 v13, 16384, v13
    s_waitcnt vmcnt(9)
    v_mfma_f32_16x16x32_bf16 v[88:91], v[64:67], v[16:19], v[88:91]
    v_mfma_f32_16x16x32_bf16 v[104:107], v[64:67], v[20:23], v[104:107]
    v_mfma_f32_16x16x32_bf16 v[120:123], v[64:67], v[24:27], v[120:123]
    s_add_u32 m0, s70, 4096
    s_nop 0
    buffer_load_dwordx4 v13, s[40:43], 0 offen offset:0 lds
    s_waitcnt vmcnt(9)
    v_mfma_f32_16x16x32_bf16 v[92:95], v[68:71], v[16:19], v[92:95]
    v_mfma_f32_16x16x32_bf16 v[108:111], v[68:71], v[20:23], v[108:111]
    v_mfma_f32_16x16x32_bf16 v[124:127], v[68:71], v[24:27], v[124:127]
    buffer_load_dwordx4 v13, s[40:43], s71 offen offset:1024 lds
    s_waitcnt lgkmcnt(0)
    s_waitcnt vmcnt(9)
    v_mfma_f32_16x16x32_bf16 v[80:83], v[72:75], v[28:31], v[80:83]
    v_mfma_f32_16x16x32_bf16 v[96:99], v[72:75], v[32:35], v[96:99]
    v_mfma_f32_16x16x32_bf16 v[112:115], v[72:75], v[36:39], v[112:115]
    buffer_load_dwordx4 v13, s[40:43], s72 offen offset:2048 lds
    s_waitcnt vmcnt(9)
    v_mfma_f32_16x16x32_bf16 v[84:87], v[76:79], v[28:31], v[84:87]
    v_mfma_f32_16x16x32_bf16 v[100:103], v[76:79], v[32:35], v[100:103]
    v_mfma_f32_16x16x32_bf16 v[116:119], v[76:79], v[36:39], v[116:119]
    buffer_load_dwordx4 v13, s[40:43], s73 offen offset:3072 lds
    v_xor_b32 v13, 49152, v13
    s_waitcnt vmcnt(9)
    v_mfma_f32_16x16x32_bf16 v[88:91], v[40:43], v[28:31], v[88:91]
    v_mfma_f32_16x16x32_bf16 v[104:107], v[40:43], v[32:35], v[104:107]
    v_mfma_f32_16x16x32_bf16 v[120:123], v[40:43], v[36:39], v[120:123]
    s_add_u32 m0, s70, 8192
    s_nop 0
    buffer_load_dwordx4 v13, s[40:43], 0 offen offset:0 lds
    s_waitcnt vmcnt(9)
    v_mfma_f32_16x16x32_bf16 v[92:95], v[44:47], v[28:31], v[92:95]
    v_mfma_f32_16x16x32_bf16 v[108:111], v[44:47], v[32:35], v[108:111]
    v_mfma_f32_16x16x32_bf16 v[124:127], v[44:47], v[36:39], v[124:127]
    buffer_load_dwordx4 v13, s[40:43], s71 offen offset:1024 lds
    s_lshl_b32 s64, s31, 3
    v_add_u32 v0, s64, v4
    v_xor_b32 v0, v0, v3
    v_lshlrev_b32 v0, 4, v0
    v_lshl_add_u32 v0, v3, 9, v0
    v_xor_b32 v1, 64, v0
    s_mov_b32 s76, 0x00ff00ff
    s_mov_b32 s77, 0x00ff00ff
    v_cvt_pk_bf16_f32 v16, v80, v81
    v_cvt_pk_bf16_f32 v17, v82, v83
    v_cvt_pk_bf16_f32 v18, v84, v85
    v_cvt_pk_bf16_f32 v19, v86, v87
    ds_write_b128 v0, v[16:19] offset:21504
    v_cvt_pk_bf16_f32 v20, v88, v89
    v_cvt_pk_bf16_f32 v21, v90, v91
    v_cvt_pk_bf16_f32 v22, v92, v93
    v_cvt_pk_bf16_f32 v23, v94, v95
    ds_write_b128 v1, v[20:23] offset:21504
    v_cvt_pk_bf16_f32 v24, v96, v97
    v_cvt_pk_bf16_f32 v25, v98, v99
    v_cvt_pk_bf16_f32 v26, v100, v101
    v_cvt_pk_bf16_f32 v27, v102, v103
    ds_write_b128 v0, v[24:27] offset:29696
    v_cvt_pk_bf16_f32 v28, v104, v105
    v_cvt_pk_bf16_f32 v29, v106, v107
    v_cvt_pk_bf16_f32 v30, v108, v109
    v_cvt_pk_bf16_f32 v31, v110, v111
    ds_write_b128 v1, v[28:31] offset:29696
    s_mov_b64 exec, s[76:77]
    v_cvt_pk_bf16_f32 v32, v112, v113
    v_cvt_pk_bf16_f32 v33, v114, v115
    v_cvt_pk_bf16_f32 v34, v116, v117
    v_cvt_pk_bf16_f32 v35, v118, v119
    ds_write_b128 v0, v[32:35] offset:37888
    v_cvt_pk_bf16_f32 v36, v120, v121
    v_cvt_pk_bf16_f32 v37, v122, v123
    v_cvt_pk_bf16_f32 v38, v124, v125
    v_cvt_pk_bf16_f32 v39, v126, v127
    ds_write_b128 v1, v[36:39] offset:37888
    s_mov_b64 exec, -1
    s_waitcnt lgkmcnt(0)
    s_barrier
    buffer_load_dwordx4 v13, s[40:43], s72 offen offset:2048 lds
    buffer_load_dwordx4 v13, s[40:43], s73 offen offset:3072 lds
    v_xor_b32 v13, 16384, v13
    s_add_u32 m0, s70, 12288
    s_nop 0
    buffer_load_dwordx4 v13, s[40:43], 0 offen offset:0 lds
    buffer_load_dwordx4 v13, s[40:43], s71 offen offset:1024 lds
    buffer_load_dwordx4 v13, s[40:43], s72 offen offset:2048 lds
    buffer_load_dwordx4 v13, s[40:43], s73 offen offset:3072 lds
    v_xor_b32 v13, 114688, v13
    v_lshlrev_b32 v0, 4, v4
    v_and_b32 v1, 7, v3
    v_lshl_add_u32 v0, v1, 9, v0
    v_and_b32 v1, 8, v3
    v_lshl_add_u32 v0, v1, 3, v0
    s_mul_i32 s74, s1, 20480
    s_lshl_b32 s64, s31, 7
    s_add_u32 s74, s74, s64
    s_waitcnt vmcnt(8)
    ds_read_b64_tr_b16 v[48:49], v11 offset:0
    ds_read_b64_tr_b16 v[50:51], v11 offset:512
    ds_read_b64_tr_b16 v[52:53], v11 offset:8
    ds_read_b64_tr_b16 v[54:55], v11 offset:520
    ds_read_b64_tr_b16 v[56:57], v12 offset:0
    ds_read_b64_tr_b16 v[58:59], v12 offset:512
    ds_read_b64_tr_b16 v[60:61], v12 offset:8
    ds_read_b64_tr_b16 v[62:63], v12 offset:520
    ds_read_b64_tr_b16 v[64:65], v11 offset:4096
    ds_read_b64_tr_b16 v[66:67], v11 offset:4608
    ds_read_b64_tr_b16 v[68:69], v11 offset:4104
    ds_read_b64_tr_b16 v[70:71], v11 offset:4616
    ds_read_b64_tr_b16 v[72:73], v12 offset:4096
    ds_read_b64_tr_b16 v[74:75], v12 offset:4608
    ds_read_b64_tr_b16 v[76:77], v12 offset:4104
    ds_read_b64_tr_b16 v[78:79], v12 offset:4616
    s_waitcnt lgkmcnt(8)
    s_add_u32 m0, s70, 0
    s_nop 0
    buffer_load_dwordx4 v13, s[40:43], 0 offen offset:0 lds
    buffer_load_dwordx4 v13, s[40:43], s71 offen offset:1024 lds
    buffer_load_dwordx4 v13, s[40:43], s72 offen offset:2048 lds
    buffer_load_dwordx4 v13, s[40:43], s73 offen offset:3072 lds
    v_xor_b32 v13, 16384, v13
    s_waitcnt lgkmcnt(0)
    s_add_u32 m0, s70, 4096
    s_nop 0
    buffer_load_dwordx4 v13, s[40:43], 0 offen offset:0 lds
    buffer_load_dwordx4 v13, s[40:43], s71 offen offset:1024 lds
    buffer_load_dwordx4 v13, s[40:43], s72 offen offset:2048 lds
    buffer_load_dwordx4 v13, s[40:43], s73 offen offset:3072 lds
    v_xor_b32 v13, 49152, v13
    s_lshl_b32 s64, s31, 12
    s_add_u32 s78, s64, 21504
    s_add_u32 s79, s64, 148480
    s_cmp_eq_u32 s31, 3
    s_cselect_b32 s79, 37888, s79
    s_sub_u32 s76, s78, s70
    s_sub_u32 s77, s79, s78
    v_xor_b32 v40, 0x100, v7
    v_xor_b32 v41, 0x100, v8
    v_xor_b32 v42, 0x100, v9
    v_xor_b32 v43, 0x100, v10
    s_barrier
    s_mov_b32 m0, s78
    s_nop 0
    buffer_load_dwordx4 v13, s[40:43], 0 offen offset:0 lds
    buffer_load_dwordx4 v13, s[40:43], s71 offen offset:1024 lds
    buffer_load_dwordx4 v13, s[40:43], s72 offen offset:2048 lds
    buffer_load_dwordx4 v13, s[40:43], s73 offen offset:3072 lds
    v_xor_b32 v13, 16384, v13
    s_mov_b32 m0, s79
    s_nop 0
    buffer_load_dwordx4 v13, s[40:43], 0 offen offset:0 lds
    buffer_load_dwordx4 v13, s[40:43], s71 offen offset:1024 lds
    buffer_load_dwordx4 v13, s[40:43], s72 offen offset:2048 lds
    buffer_load_dwordx4 v13, s[40:43], s73 offen offset:3072 lds
    v_xor_b32 v13, 114688, v13
    s_setprio 0
L_prog_22:
    ds_read_b128 v[16:19], v5 offset:32
    s_waitcnt lgkmcnt(0)
    v_min3_u32 v16, v16, v17, v18
    v_min_u32 v16, v16, v19
    v_cmp_gt_u32 vcc, 1, v16
    s_cbranch_vccnz L_retry_23
    ds_read_b128 v[16:19], v7 offset:1024
    ds_read_b128 v[20:23], v7 offset:9216
    ds_read_b128 v[24:27], v7 offset:17408
    s_waitcnt vmcnt(8)
    s_waitcnt lgkmcnt(0)
    v_mfma_f32_16x16x32_bf16 v[80:83], v[128:131], v[16:19], 0
    ds_read_b128 v[28:31], v8 offset:1024
    v_mfma_f32_16x16x32_bf16 v[96:99], v[128:131], v[20:23], 0
    ds_read_b128 v[32:35], v8 offset:9216
    v_mfma_f32_16x16x32_bf16 v[112:115], v[128:131], v[24:27], 0
    ds_read_b128 v[36:39], v8 offset:17408
    v_mfma_f32_16x16x32_bf16 v[84:87], v[132:135], v[16:19], 0
    v_mfma_f32_16x16x32_bf16 v[100:103], v[132:135], v[20:23], 0
    v_mfma_f32_16x16x32_bf16 v[116:119], v[132:135], v[24:27], 0
    v_mfma_f32_16x16x32_bf16 v[88:91], v[136:139], v[16:19], 0
    v_mfma_f32_16x16x32_bf16 v[104:107], v[136:139], v[20:23], 0
    v_mfma_f32_16x16x32_bf16 v[120:123], v[136:139], v[24:27], 0
    v_mfma_f32_16x16x32_bf16 v[92:95], v[140:143], v[16:19], 0
    v_mfma_f32_16x16x32_bf16 v[108:111], v[140:143], v[20:23], 0
    v_mfma_f32_16x16x32_bf16 v[124:127], v[140:143], v[24:27], 0
    s_waitcnt lgkmcnt(0)
    v_mfma_f32_16x16x32_bf16 v[80:83], v[144:147], v[28:31], v[80:83]
    ds_read_b128 v[16:19], v9 offset:1024
    v_mfma_f32_16x16x32_bf16 v[96:99], v[144:147], v[32:35], v[96:99]
    ds_read_b128 v[20:23], v9 offset:9216
    v_mfma_f32_16x16x32_bf16 v[112:115], v[144:147], v[36:39], v[112:115]
    ds_read_b128 v[24:27], v9 offset:17408
    v_mfma_f32_16x16x32_bf16 v[84:87], v[148:151], v[28:31], v[84:87]
    ds_read_b64_tr_b16 v[128:129], v11 offset:8192
    v_mfma_f32_16x16x32_bf16 v[100:103], v[148:151], v[32:35], v[100:103]
    ds_read_b64_tr_b16 v[130:131], v11 offset:8704
    v_mfma_f32_16x16x32_bf16 v[116:119], v[148:151], v[36:39], v[116:119]
    ds_read_b64_tr_b16 v[132:133], v11 offset:8200
    v_mfma_f32_16x16x32_bf16 v[88:91], v[152:155], v[28:31], v[88:91]
    ds_read_b64_tr_b16 v[134:135], v11 offset:8712
    v_mfma_f32_16x16x32_bf16 v[104:107], v[152:155], v[32:35], v[104:107]
    ds_read_b64_tr_b16 v[136:137], v12 offset:8192
    v_mfma_f32_16x16x32_bf16 v[120:123], v[152:155], v[36:39], v[120:123]
    ds_read_b64_tr_b16 v[138:139], v12 offset:8704
    v_mfma_f32_16x16x32_bf16 v[92:95], v[156:159], v[28:31], v[92:95]
    ds_read_b64_tr_b16 v[140:141], v12 offset:8200
    v_mfma_f32_16x16x32_bf16 v[108:111], v[156:159], v[32:35], v[108:111]
    ds_read_b64_tr_b16 v[142:143], v12 offset:8712
    v_mfma_f32_16x16x32_bf16 v[124:127], v[156:159], v[36:39], v[124:127]
    s_waitcnt lgkmcnt(8)
    v_mfma_f32_16x16x32_bf16 v[80:83], v[160:163], v[16:19], v[80:83]
    ds_read_b128 v[28:31], v10 offset:1024
    v_mfma_f32_16x16x32_bf16 v[96:99], v[160:163], v[20:23], v[96:99]
    ds_read_b128 v[32:35], v10 offset:9216
    v_mfma_f32_16x16x32_bf16 v[112:115], v[160:163], v[24:27], v[112:115]
    ds_read_b128 v[36:39], v10 offset:17408
    v_mfma_f32_16x16x32_bf16 v[84:87], v[164:167], v[16:19], v[84:87]
    ds_read_b64_tr_b16 v[144:145], v11 offset:12288
    v_mfma_f32_16x16x32_bf16 v[100:103], v[164:167], v[20:23], v[100:103]
    ds_read_b64_tr_b16 v[146:147], v11 offset:12800
    v_mfma_f32_16x16x32_bf16 v[116:119], v[164:167], v[24:27], v[116:119]
    ds_read_b64_tr_b16 v[148:149], v11 offset:12296
    v_mfma_f32_16x16x32_bf16 v[88:91], v[168:171], v[16:19], v[88:91]
    ds_read_b64_tr_b16 v[150:151], v11 offset:12808
    v_mfma_f32_16x16x32_bf16 v[104:107], v[168:171], v[20:23], v[104:107]
    ds_read_b64_tr_b16 v[152:153], v12 offset:12288
    v_mfma_f32_16x16x32_bf16 v[120:123], v[168:171], v[24:27], v[120:123]
    ds_read_b64_tr_b16 v[154:155], v12 offset:12800
    v_mfma_f32_16x16x32_bf16 v[92:95], v[172:175], v[16:19], v[92:95]
    ds_read_b64_tr_b16 v[156:157], v12 offset:12296
    v_mfma_f32_16x16x32_bf16 v[108:111], v[172:175], v[20:23], v[108:111]
    ds_read_b64_tr_b16 v[158:159], v12 offset:12808
    v_mfma_f32_16x16x32_bf16 v[124:127], v[172:175], v[24:27], v[124:127]
    s_waitcnt lgkmcnt(8)
    v_mfma_f32_16x16x32_bf16 v[80:83], v[176:179], v[28:31], v[80:83]
    ds_read_b128 v[16:19], v40 offset:1024
    v_mfma_f32_16x16x32_bf16 v[96:99], v[176:179], v[32:35], v[96:99]
    ds_read_b128 v[20:23], v40 offset:9216
    v_mfma_f32_16x16x32_bf16 v[112:115], v[176:179], v[36:39], v[112:115]
    ds_read_b128 v[24:27], v40 offset:17408
    v_mfma_f32_16x16x32_bf16 v[84:87], v[180:183], v[28:31], v[84:87]
    ds_read_b64_tr_b16 v[160:161], v11 offset:0
    v_mfma_f32_16x16x32_bf16 v[100:103], v[180:183], v[32:35], v[100:103]
    ds_read_b64_tr_b16 v[162:163], v11 offset:512
    v_mfma_f32_16x16x32_bf16 v[116:119], v[180:183], v[36:39], v[116:119]
    ds_read_b64_tr_b16 v[164:165], v11 offset:8
    v_mfma_f32_16x16x32_bf16 v[88:91], v[184:187], v[28:31], v[88:91]
    ds_read_b64_tr_b16 v[166:167], v11 offset:520
    v_mfma_f32_16x16x32_bf16 v[104:107], v[184:187], v[32:35], v[104:107]
    ds_read_b64_tr_b16 v[168:169], v12 offset:0
    v_mfma_f32_16x16x32_bf16 v[120:123], v[184:187], v[36:39], v[120:123]
    ds_read_b64_tr_b16 v[170:171], v12 offset:512
    v_mfma_f32_16x16x32_bf16 v[92:95], v[188:191], v[28:31], v[92:95]
    ds_read_b64_tr_b16 v[172:173], v12 offset:8
    v_mfma_f32_16x16x32_bf16 v[108:111], v[188:191], v[32:35], v[108:111]
    ds_read_b64_tr_b16 v[174:175], v12 offset:520
    v_mfma_f32_16x16x32_bf16 v[124:127], v[188:191], v[36:39], v[124:127]
    s_waitcnt lgkmcnt(8)
    v_mfma_f32_16x16x32_bf16 v[80:83], v[192:195], v[16:19], v[80:83]
    ds_read_b128 v[28:31], v41 offset:1024
    v_mfma_f32_16x16x32_bf16 v[96:99], v[192:195], v[20:23], v[96:99]
    ds_read_b128 v[32:35], v41 offset:9216
    v_mfma_f32_16x16x32_bf16 v[112:115], v[192:195], v[24:27], v[112:115]
    ds_read_b128 v[36:39], v41 offset:17408
    v_mfma_f32_16x16x32_bf16 v[84:87], v[196:199], v[16:19], v[84:87]
    ds_read_b64_tr_b16 v[176:177], v11 offset:4096
    v_mfma_f32_16x16x32_bf16 v[100:103], v[196:199], v[20:23], v[100:103]
    ds_read_b64_tr_b16 v[178:179], v11 offset:4608
    v_mfma_f32_16x16x32_bf16 v[116:119], v[196:199], v[24:27], v[116:119]
    ds_read_b64_tr_b16 v[180:181], v11 offset:4104
    v_mfma_f32_16x16x32_bf16 v[88:91], v[200:203], v[16:19], v[88:91]
    ds_read_b64_tr_b16 v[182:183], v11 offset:4616
    v_mfma_f32_16x16x32_bf16 v[104:107], v[200:203], v[20:23], v[104:107]
    ds_read_b64_tr_b16 v[184:185], v12 offset:4096
    v_mfma_f32_16x16x32_bf16 v[120:123], v[200:203], v[24:27], v[120:123]
    ds_read_b64_tr_b16 v[186:187], v12 offset:4608
    v_mfma_f32_16x16x32_bf16 v[92:95], v[204:207], v[16:19], v[92:95]
    ds_read_b64_tr_b16 v[188:189], v12 offset:4104
    v_mfma_f32_16x16x32_bf16 v[108:111], v[204:207], v[20:23], v[108:111]
    ds_read_b64_tr_b16 v[190:191], v12 offset:4616
    v_mfma_f32_16x16x32_bf16 v[124:127], v[204:207], v[24:27], v[124:127]
    s_waitcnt lgkmcnt(8)
    v_mfma_f32_16x16x32_bf16 v[80:83], v[208:211], v[28:31], v[80:83]
    ds_read_b128 v[16:19], v42 offset:1024
    v_mfma_f32_16x16x32_bf16 v[96:99], v[208:211], v[32:35], v[96:99]
    ds_read_b128 v[20:23], v42 offset:9216
    v_mfma_f32_16x16x32_bf16 v[112:115], v[208:211], v[36:39], v[112:115]
    ds_read_b128 v[24:27], v42 offset:17408
    v_mfma_f32_16x16x32_bf16 v[84:87], v[212:215], v[28:31], v[84:87]
    v_mfma_f32_16x16x32_bf16 v[100:103], v[212:215], v[32:35], v[100:103]
    v_mfma_f32_16x16x32_bf16 v[116:119], v[212:215], v[36:39], v[116:119]
    v_mfma_f32_16x16x32_bf16 v[88:91], v[216:219], v[28:31], v[88:91]
    v_mfma_f32_16x16x32_bf16 v[104:107], v[216:219], v[32:35], v[104:107]
    v_mfma_f32_16x16x32_bf16 v[120:123], v[216:219], v[36:39], v[120:123]
    v_mfma_f32_16x16x32_bf16 v[92:95], v[220:223], v[28:31], v[92:95]
    v_mfma_f32_16x16x32_bf16 v[108:111], v[220:223], v[32:35], v[108:111]
    v_mfma_f32_16x16x32_bf16 v[124:127], v[220:223], v[36:39], v[124:127]
    s_waitcnt lgkmcnt(0)
    v_mfma_f32_16x16x32_bf16 v[80:83], v[224:227], v[16:19], v[80:83]
    v_add_u32 v11, s76, v11
    v_add_u32 v12, s76, v12
    v_mfma_f32_16x16x32_bf16 v[96:99], v[224:227], v[20:23], v[96:99]
    ds_read_b128 v[28:31], v43 offset:1024
    v_mfma_f32_16x16x32_bf16 v[112:115], v[224:227], v[24:27], v[112:115]
    ds_read_b128 v[32:35], v43 offset:9216
    v_mfma_f32_16x16x32_bf16 v[84:87], v[228:231], v[16:19], v[84:87]
    ds_read_b128 v[36:39], v43 offset:17408
    v_mfma_f32_16x16x32_bf16 v[100:103], v[228:231], v[20:23], v[100:103]
    s_waitcnt vmcnt(4)
    ds_read_b64_tr_b16 v[192:193], v11 offset:0
    v_mfma_f32_16x16x32_bf16 v[116:119], v[228:231], v[24:27], v[116:119]
    ds_read_b64_tr_b16 v[194:195], v11 offset:512
    v_mfma_f32_16x16x32_bf16 v[88:91], v[232:235], v[16:19], v[88:91]
    ds_read_b64_tr_b16 v[196:197], v11 offset:8
    v_mfma_f32_16x16x32_bf16 v[104:107], v[232:235], v[20:23], v[104:107]
    ds_read_b64_tr_b16 v[198:199], v11 offset:520
    v_mfma_f32_16x16x32_bf16 v[120:123], v[232:235], v[24:27], v[120:123]
    ds_read_b64_tr_b16 v[200:201], v12 offset:0
    v_mfma_f32_16x16x32_bf16 v[92:95], v[236:239], v[16:19], v[92:95]
    ds_read_b64_tr_b16 v[202:203], v12 offset:512
    v_mfma_f32_16x16x32_bf16 v[108:111], v[236:239], v[20:23], v[108:111]
    ds_read_b64_tr_b16 v[204:205], v12 offset:8
    v_mfma_f32_16x16x32_bf16 v[124:127], v[236:239], v[24:27], v[124:127]
    ds_read_b64_tr_b16 v[206:207], v12 offset:520
    s_waitcnt lgkmcnt(8)
    v_mfma_f32_16x16x32_bf16 v[80:83], v[240:243], v[28:31], v[80:83]
    v_add_u32 v11, s77, v11
    v_add_u32 v12, s77, v12
    v_mfma_f32_16x16x32_bf16 v[96:99], v[240:243], v[32:35], v[96:99]
    s_waitcnt vmcnt(0)
    ds_read_b64_tr_b16 v[208:209], v11 offset:0
    v_mfma_f32_16x16x32_bf16 v[112:115], v[240:243], v[36:39], v[112:115]
    ds_read_b64_tr_b16 v[210:211], v11 offset:512
    v_mfma_f32_16x16x32_bf16 v[84:87], v[244:247], v[28:31], v[84:87]
    ds_read_b64_tr_b16 v[212:213], v11 offset:8
    v_mfma_f32_16x16x32_bf16 v[100:103], v[244:247], v[32:35], v[100:103]
    ds_read_b64_tr_b16 v[214:215], v11 offset:520
    v_mfma_f32_16x16x32_bf16 v[116:119], v[244:247], v[36:39], v[116:119]
    ds_read_b64_tr_b16 v[216:217], v12 offset:0
    v_mfma_f32_16x16x32_bf16 v[88:91], v[248:251], v[28:31], v[88:91]
    ds_read_b64_tr_b16 v[218:219], v12 offset:512
    v_mfma_f32_16x16x32_bf16 v[104:107], v[248:251], v[32:35], v[104:107]
    ds_read_b64_tr_b16 v[220:221], v12 offset:8
    v_mfma_f32_16x16x32_bf16 v[120:123], v[248:251], v[36:39], v[120:123]
    ds_read_b64_tr_b16 v[222:223], v12 offset:520
    v_mfma_f32_16x16x32_bf16 v[92:95], v[252:255], v[28:31], v[92:95]
    v_mfma_f32_16x16x32_bf16 v[108:111], v[252:255], v[32:35], v[108:111]
    v_mfma_f32_16x16x32_bf16 v[124:127], v[252:255], v[36:39], v[124:127]
    s_add_u32 s75, s74, 4096
    s_add_u32 s76, s74, 8192
    s_add_u32 s77, s74, 12288
    s_add_u32 s78, s74, 16384
L_prog_24:
    ds_read_b128 v[16:19], v5 offset:32
    s_waitcnt lgkmcnt(0)
    v_min3_u32 v16, v16, v17, v18
    v_min_u32 v16, v16, v19
    v_cmp_gt_u32 vcc, 1, v16
    s_cbranch_vccnz L_retry_25
    ds_read_b128 v[16:19], v7 offset:58368
    ds_read_b128 v[20:23], v8 offset:58368
    ds_read_b128 v[24:27], v9 offset:58368
    ds_read_b128 v[28:31], v10 offset:58368
    ds_read_b128 v[32:35], v40 offset:58368
    ds_read_b128 v[36:39], v41 offset:58368
    ds_read_b128 v[44:47], v42 offset:58368
    ds_read_b128 v[252:255], v43 offset:58368
    s_waitcnt lgkmcnt(7)
    v_mfma_f32_16x16x32_bf16 v[120:123], v[56:59], v[16:19], v[120:123]
    v_mfma_f32_16x16x32_bf16 v[124:127], v[60:63], v[16:19], v[124:127]
    v_mfma_f32_16x16x32_bf16 v[112:115], v[48:51], v[16:19], v[112:115]
    v_mfma_f32_16x16x32_bf16 v[116:119], v[52:55], v[16:19], v[116:119]
    s_waitcnt lgkmcnt(6)
    v_mfma_f32_16x16x32_bf16 v[120:123], v[72:75], v[20:23], v[120:123]
    v_mfma_f32_16x16x32_bf16 v[124:127], v[76:79], v[20:23], v[124:127]
    v_mfma_f32_16x16x32_bf16 v[112:115], v[64:67], v[20:23], v[112:115]
    v_mfma_f32_16x16x32_bf16 v[116:119], v[68:71], v[20:23], v[116:119]
    s_waitcnt lgkmcnt(5)
    v_mfma_f32_16x16x32_bf16 v[120:123], v[136:139], v[24:27], v[120:123]
    v_mfma_f32_16x16x32_bf16 v[124:127], v[140:143], v[24:27], v[124:127]
    v_mfma_f32_16x16x32_bf16 v[112:115], v[128:131], v[24:27], v[112:115]
    v_mfma_f32_16x16x32_bf16 v[116:119], v[132:135], v[24:27], v[116:119]
    s_waitcnt lgkmcnt(4)
    v_mfma_f32_16x16x32_bf16 v[120:123], v[152:155], v[28:31], v[120:123]
    v_mfma_f32_16x16x32_bf16 v[124:127], v[156:159], v[28:31], v[124:127]
    v_mfma_f32_16x16x32_bf16 v[112:115], v[144:147], v[28:31], v[112:115]
    v_mfma_f32_16x16x32_bf16 v[116:119], v[148:151], v[28:31], v[116:119]
    s_waitcnt lgkmcnt(3)
    v_mfma_f32_16x16x32_bf16 v[120:123], v[168:171], v[32:35], v[120:123]
    v_mfma_f32_16x16x32_bf16 v[124:127], v[172:175], v[32:35], v[124:127]
    v_mfma_f32_16x16x32_bf16 v[112:115], v[160:163], v[32:35], v[112:115]
    v_mfma_f32_16x16x32_bf16 v[116:119], v[164:167], v[32:35], v[116:119]
    s_waitcnt lgkmcnt(2)
    v_mfma_f32_16x16x32_bf16 v[120:123], v[184:187], v[36:39], v[120:123]
    v_mfma_f32_16x16x32_bf16 v[124:127], v[188:191], v[36:39], v[124:127]
    v_mfma_f32_16x16x32_bf16 v[112:115], v[176:179], v[36:39], v[112:115]
    v_mfma_f32_16x16x32_bf16 v[116:119], v[180:183], v[36:39], v[116:119]
    s_waitcnt lgkmcnt(1)
    v_mfma_f32_16x16x32_bf16 v[120:123], v[200:203], v[44:47], v[120:123]
    v_mfma_f32_16x16x32_bf16 v[124:127], v[204:207], v[44:47], v[124:127]
    v_mfma_f32_16x16x32_bf16 v[112:115], v[192:195], v[44:47], v[112:115]
    v_mfma_f32_16x16x32_bf16 v[116:119], v[196:199], v[44:47], v[116:119]
    s_waitcnt lgkmcnt(0)
    v_mfma_f32_16x16x32_bf16 v[120:123], v[216:219], v[252:255], v[120:123]
    v_mfma_f32_16x16x32_bf16 v[124:127], v[220:223], v[252:255], v[124:127]
    v_mfma_f32_16x16x32_bf16 v[112:115], v[208:211], v[252:255], v[112:115]
    v_mfma_f32_16x16x32_bf16 v[116:119], v[212:215], v[252:255], v[116:119]
L_prog_26:
    ds_read_b128 v[16:19], v5 offset:32
    s_waitcnt lgkmcnt(0)
    v_min3_u32 v16, v16, v17, v18
    v_min_u32 v16, v16, v19
    v_cmp_gt_u32 vcc, 3, v16
    s_cbranch_vccnz L_retry_27
    ds_read_b128 v[16:19], v7 offset:41984
    ds_read_b128 v[20:23], v8 offset:41984
    ds_read_b128 v[24:27], v9 offset:41984
    ds_read_b128 v[28:31], v10 offset:41984
    ds_read_b128 v[32:35], v40 offset:41984
    ds_read_b128 v[36:39], v41 offset:41984
    ds_read_b128 v[44:47], v42 offset:41984
    ds_read_b128 v[252:255], v43 offset:41984
    s_waitcnt lgkmcnt(7)
    v_mfma_f32_16x16x32_bf16 v[88:91], v[56:59], v[16:19], v[88:91]
    v_cvt_pk_bf16_f32 v248, v120, v121
    v_mfma_f32_16x16x32_bf16 v[92:95], v[60:63], v[16:19], v[92:95]
    v_cvt_pk_bf16_f32 v249, v122, v123
    v_mfma_f32_16x16x32_bf16 v[80:83], v[48:51], v[16:19], v[80:83]
    v_cvt_pk_bf16_f32 v250, v124, v125
    v_mfma_f32_16x16x32_bf16 v[84:87], v[52:55], v[16:19], v[84:87]
    v_cvt_pk_bf16_f32 v251, v126, v127
    s_waitcnt lgkmcnt(6)
    v_mfma_f32_16x16x32_bf16 v[88:91], v[72:75], v[20:23], v[88:91]
    v_cvt_pk_bf16_f32 v244, v112, v113
    v_mfma_f32_16x16x32_bf16 v[92:95], v[76:79], v[20:23], v[92:95]
    v_cvt_pk_bf16_f32 v245, v114, v115
    v_mfma_f32_16x16x32_bf16 v[80:83], v[64:67], v[20:23], v[80:83]
    v_cvt_pk_bf16_f32 v246, v116, v117
    v_mfma_f32_16x16x32_bf16 v[84:87], v[68:71], v[20:23], v[84:87]
    v_cvt_pk_bf16_f32 v247, v118, v119
    s_waitcnt lgkmcnt(5)
    v_mfma_f32_16x16x32_bf16 v[88:91], v[136:139], v[24:27], v[88:91]
    v_mov_b32_dpp v244, v248 row_ror:8 row_mask:0xf bank_mask:0xc
    v_mfma_f32_16x16x32_bf16 v[92:95], v[140:143], v[24:27], v[92:95]
    v_mov_b32_dpp v245, v249 row_ror:8 row_mask:0xf bank_mask:0xc
    v_mfma_f32_16x16x32_bf16 v[80:83], v[128:131], v[24:27], v[80:83]
    v_mov_b32_dpp v246, v250 row_ror:8 row_mask:0xf bank_mask:0xc
    v_mfma_f32_16x16x32_bf16 v[84:87], v[132:135], v[24:27], v[84:87]
    v_mov_b32_dpp v247, v251 row_ror:8 row_mask:0xf bank_mask:0xc
    s_waitcnt lgkmcnt(4)
    v_mfma_f32_16x16x32_bf16 v[88:91], v[152:155], v[28:31], v[88:91]
    v_mfma_f32_16x16x32_bf16 v[92:95], v[156:159], v[28:31], v[92:95]
    v_mfma_f32_16x16x32_bf16 v[80:83], v[144:147], v[28:31], v[80:83]
    v_mfma_f32_16x16x32_bf16 v[84:87], v[148:151], v[28:31], v[84:87]
    s_waitcnt lgkmcnt(3)
    v_mfma_f32_16x16x32_bf16 v[88:91], v[168:171], v[32:35], v[88:91]
    v_mfma_f32_16x16x32_bf16 v[92:95], v[172:175], v[32:35], v[92:95]
    v_mfma_f32_16x16x32_bf16 v[80:83], v[160:163], v[32:35], v[80:83]
    v_mfma_f32_16x16x32_bf16 v[84:87], v[164:167], v[32:35], v[84:87]
    s_waitcnt lgkmcnt(2)
    v_mfma_f32_16x16x32_bf16 v[88:91], v[184:187], v[36:39], v[88:91]
    v_mfma_f32_16x16x32_bf16 v[92:95], v[188:191], v[36:39], v[92:95]
    v_mfma_f32_16x16x32_bf16 v[80:83], v[176:179], v[36:39], v[80:83]
    v_mfma_f32_16x16x32_bf16 v[84:87], v[180:183], v[36:39], v[84:87]
    s_waitcnt lgkmcnt(1)
    v_mfma_f32_16x16x32_bf16 v[88:91], v[200:203], v[44:47], v[88:91]
    v_mfma_f32_16x16x32_bf16 v[92:95], v[204:207], v[44:47], v[92:95]
    v_mfma_f32_16x16x32_bf16 v[80:83], v[192:195], v[44:47], v[80:83]
    v_mfma_f32_16x16x32_bf16 v[84:87], v[196:199], v[44:47], v[84:87]
    s_waitcnt lgkmcnt(0)
    v_mfma_f32_16x16x32_bf16 v[88:91], v[216:219], v[252:255], v[88:91]
    v_mfma_f32_16x16x32_bf16 v[92:95], v[220:223], v[252:255], v[92:95]
    v_mfma_f32_16x16x32_bf16 v[80:83], v[208:211], v[252:255], v[80:83]
    v_mfma_f32_16x16x32_bf16 v[84:87], v[212:215], v[252:255], v[84:87]
    s_nop 4
    v_cvt_pk_bf16_f32 v228, v88, v89
    v_cvt_pk_bf16_f32 v229, v90, v91
    v_cvt_pk_bf16_f32 v230, v92, v93
    v_cvt_pk_bf16_f32 v231, v94, v95
    v_cvt_pk_bf16_f32 v224, v80, v81
    v_cvt_pk_bf16_f32 v225, v82, v83
    v_cvt_pk_bf16_f32 v226, v84, v85
    v_cvt_pk_bf16_f32 v227, v86, v87
    v_cvt_pk_bf16_f32 v240, v80, v81
    v_cvt_pk_bf16_f32 v241, v82, v83
    v_cvt_pk_bf16_f32 v242, v84, v85
    v_cvt_pk_bf16_f32 v243, v86, v87
    v_mov_b32_dpp v224, v228 row_ror:8 row_mask:0xf bank_mask:0xc
    v_mov_b32_dpp v225, v229 row_ror:8 row_mask:0xf bank_mask:0xc
    v_mov_b32_dpp v226, v230 row_ror:8 row_mask:0xf bank_mask:0xc
    v_mov_b32_dpp v227, v231 row_ror:8 row_mask:0xf bank_mask:0xc
    v_mov_b32_dpp v228, v240 row_ror:8 row_mask:0xf bank_mask:0x3
    v_mov_b32_dpp v229, v241 row_ror:8 row_mask:0xf bank_mask:0x3
    v_mov_b32_dpp v230, v242 row_ror:8 row_mask:0xf bank_mask:0x3
    v_mov_b32_dpp v231, v243 row_ror:8 row_mask:0xf bank_mask:0x3
L_prog_28:
    ds_read_b128 v[16:19], v5 offset:48
    s_waitcnt lgkmcnt(0)
    v_min3_u32 v16, v16, v17, v18
    v_min_u32 v16, v16, v19
    v_cmp_gt_u32 vcc, 1, v16
    s_cbranch_vccnz L_retry_29
    s_setprio 2
    buffer_store_dwordx4 v[244:247], v0, s[48:51], s78 offen sc1
    buffer_store_dwordx4 v[224:227], v0, s[48:51], s74 offen sc1
    buffer_store_dwordx4 v[228:231], v0, s[48:51], s75 offen sc1
    s_setprio 0
    v_lshlrev_b32 v1, 4, v4
    v_lshl_add_u32 v1, v3, 9, v1
    s_barrier
    s_setprio 2
    ds_read_b128 v[16:19], v7 offset:50176
    ds_read_b128 v[20:23], v8 offset:50176
    ds_read_b128 v[24:27], v9 offset:50176
    ds_read_b128 v[28:31], v10 offset:50176
    ds_read_b128 v[32:35], v40 offset:50176
    ds_read_b128 v[36:39], v41 offset:50176
    ds_read_b128 v[44:47], v42 offset:50176
    ds_read_b128 v[252:255], v43 offset:50176
    s_waitcnt lgkmcnt(7)
    v_mfma_f32_16x16x32_bf16 v[104:107], v[56:59], v[16:19], v[104:107]
    v_mfma_f32_16x16x32_bf16 v[108:111], v[60:63], v[16:19], v[108:111]
    s_waitcnt lgkmcnt(6)
    v_mfma_f32_16x16x32_bf16 v[104:107], v[72:75], v[20:23], v[104:107]
    v_mfma_f32_16x16x32_bf16 v[108:111], v[76:79], v[20:23], v[108:111]
    s_waitcnt lgkmcnt(5)
    v_mfma_f32_16x16x32_bf16 v[104:107], v[136:139], v[24:27], v[104:107]
    v_mfma_f32_16x16x32_bf16 v[108:111], v[140:143], v[24:27], v[108:111]
    s_waitcnt lgkmcnt(4)
    v_mfma_f32_16x16x32_bf16 v[104:107], v[152:155], v[28:31], v[104:107]
    v_mfma_f32_16x16x32_bf16 v[108:111], v[156:159], v[28:31], v[108:111]
    s_waitcnt lgkmcnt(3)
    v_mfma_f32_16x16x32_bf16 v[104:107], v[168:171], v[32:35], v[104:107]
    v_mfma_f32_16x16x32_bf16 v[108:111], v[172:175], v[32:35], v[108:111]
    s_waitcnt lgkmcnt(2)
    v_mfma_f32_16x16x32_bf16 v[104:107], v[184:187], v[36:39], v[104:107]
    v_mfma_f32_16x16x32_bf16 v[108:111], v[188:191], v[36:39], v[108:111]
    s_waitcnt lgkmcnt(1)
    v_mfma_f32_16x16x32_bf16 v[104:107], v[200:203], v[44:47], v[104:107]
    v_mfma_f32_16x16x32_bf16 v[108:111], v[204:207], v[44:47], v[108:111]
    s_waitcnt lgkmcnt(0)
    v_mfma_f32_16x16x32_bf16 v[104:107], v[216:219], v[252:255], v[104:107]
    v_mfma_f32_16x16x32_bf16 v[108:111], v[220:223], v[252:255], v[108:111]
    v_mfma_f32_16x16x32_bf16 v[96:99], v[48:51], v[16:19], v[96:99]
    v_mfma_f32_16x16x32_bf16 v[100:103], v[52:55], v[16:19], v[100:103]
    v_mfma_f32_16x16x32_bf16 v[96:99], v[64:67], v[20:23], v[96:99]
    v_mfma_f32_16x16x32_bf16 v[100:103], v[68:71], v[20:23], v[100:103]
    v_mfma_f32_16x16x32_bf16 v[96:99], v[128:131], v[24:27], v[96:99]
    v_mfma_f32_16x16x32_bf16 v[100:103], v[132:135], v[24:27], v[100:103]
    v_mfma_f32_16x16x32_bf16 v[96:99], v[144:147], v[28:31], v[96:99]
    v_mfma_f32_16x16x32_bf16 v[100:103], v[148:151], v[28:31], v[100:103]
    v_cvt_pk_bf16_f32 v236, v104, v105
    v_mfma_f32_16x16x32_bf16 v[96:99], v[160:163], v[32:35], v[96:99]
    v_cvt_pk_bf16_f32 v237, v106, v107
    v_mfma_f32_16x16x32_bf16 v[100:103], v[164:167], v[32:35], v[100:103]
    v_cvt_pk_bf16_f32 v238, v108, v109
    v_mfma_f32_16x16x32_bf16 v[96:99], v[176:179], v[36:39], v[96:99]
    v_cvt_pk_bf16_f32 v239, v110, v111
    v_mfma_f32_16x16x32_bf16 v[100:103], v[180:183], v[36:39], v[100:103]
    buffer_store_dwordx4 v[236:239], v1, s[48:51], s76 offen offset:64 sc1
    v_mfma_f32_16x16x32_bf16 v[96:99], v[192:195], v[44:47], v[96:99]
    v_mfma_f32_16x16x32_bf16 v[100:103], v[196:199], v[44:47], v[100:103]
    v_mfma_f32_16x16x32_bf16 v[96:99], v[208:211], v[252:255], v[96:99]
    v_mfma_f32_16x16x32_bf16 v[100:103], v[212:215], v[252:255], v[100:103]
    s_nop 6
    v_cvt_pk_bf16_f32 v232, v96, v97
    v_cvt_pk_bf16_f32 v233, v98, v99
    v_cvt_pk_bf16_f32 v234, v100, v101
    v_cvt_pk_bf16_f32 v235, v102, v103
    buffer_store_dwordx4 v[232:235], v1, s[48:51], s76 offen offset:0 sc1
    s_or_b32 s64, s2, s3
    s_cbranch_scc1 L_noepoch_30
    v_mov_b32 v1, s30
    s_mov_b64 exec, 1
    buffer_store_dword v1, v5, s[44:47], 0 offen
L_noepoch_30:
    s_endpgm
L_retry_18:
    s_sub_u32 s100, s100, 1
    s_cbranch_scc1 L_end
    s_sleep 1
    s_branch L_spin_17
L_mre_19:
    s_sub_u32 s100, s100, 1
    s_cbranch_scc1 L_end
    s_sleep 2
    buffer_load_dword v1, v0, s[44:47], s74 offen sc1
    s_waitcnt vmcnt(0)
    s_branch L_mchk_16
L_retry_21:
    s_sub_u32 s100, s100, 1
    s_cbranch_scc1 L_end
    s_sleep 1
    s_branch L_spin_20
L_retry_23:
    s_sub_u32 s100, s100, 1
    s_cbranch_scc1 L_end
    s_sleep 1
    s_branch L_prog_22
L_retry_25:
    s_sub_u32 s100, s100, 1
    s_cbranch_scc1 L_end
    s_sleep 1
    s_branch L_prog_24
L_retry_27:
    s_sub_u32 s100, s100, 1
    s_cbranch_scc1 L_end
    s_sleep 1
    s_branch L_prog_26
L_retry_29:
    s_sub_u32 s100, s100, 1
    s_cbranch_scc1 L_end
    s_sleep 1
    s_branch L_prog_28
L_end:
    s_endpgm
.section .rodata,"a"
.p2align 6
.amdhsa_kernel standalone__hybrid_graph_tf_exphormer__graph_kernel
  .amdhsa_next_free_vgpr 256
  .amdhsa_next_free_sgpr 102
  .amdhsa_accum_offset 256
  .amdhsa_group_segment_fixed_size 0
  .amdhsa_kernarg_size 104
  .amdhsa_user_sgpr_count 2
  .amdhsa_user_sgpr_kernarg_segment_ptr 1
  .amdhsa_system_sgpr_workgroup_id_x 1
  .amdhsa_float_denorm_mode_32 3
.end_amdhsa_kernel
```

```asm
; @launch grid=(253,1,1) block=(512,1,1) lds=161792
.amdgcn_target "amdgcn-amd-amdhsa--gfx950"
.text
.globl standalone__hybrid_graph_tf_exphormer__graph_kernel
.p2align 8
.type standalone__hybrid_graph_tf_exphormer__graph_kernel,@function
standalone__hybrid_graph_tf_exphormer__graph_kernel:
L_begin:
    s_cmp_ge_u32 s2, 253
    s_cbranch_scc1 L_end
    s_load_dwordx16 s[4:19], s[0:1], 0
    s_load_dwordx8 s[20:27], s[0:1], 64
    s_load_dwordx2 s[28:29], s[0:1], 96
    s_cmp_ge_u32 s2, 16
    s_cbranch_scc1 L_nopf
    s_getpc_b64 s[32:33]
L_pc:
    v_lshlrev_b32 v1, 6, v0
    v_min_u32 v1, L_end-L_pc, v1
    global_load_dword v255, v1, s[32:33]
L_nopf:
    v_lshrrev_b32 v1, 6, v0
    v_lshlrev_b32 v8, 4, v0
    v_mov_b32 v12, 1966080
    v_readfirstlane_b32 s3, v1
    v_mov_b32 v13, 1966080
    v_mov_b32 v14, 1966080
    v_mov_b32 v15, 1966080
    ds_write_b128 v8, v[12:15] offset:41984
    ds_write_b128 v8, v[12:15] offset:50176
    v_subrev_u32 v9, 32, v0
    v_cmp_gt_u32 vcc, 20, v9
    v_mul_u32_u24 v9, 264, v9
    v_add_u32 v9, 148480, v9
    v_lshlrev_b32 v10, 2, v0
    v_cndmask_b32 v9, 0, v9, vcc
    v_min_u32 v11, 1020, v10
    ds_write_b32 v11, v9
    v_mov_b32 v16, 1310740000
    v_mov_b32 v17, 1310740000
    v_mov_b32 v18, 1310740000
    v_mov_b32 v19, 1310740000
    v_add_u32 v9, 148480, v8
    ds_write_b128 v9, v[16:19]
    v_and_b32 v2, 63, v0
    v_and_b32 v3, 15, v0
    v_bfe_u32 v4, v0, 4, 2
    v_mov_b32 v5, 0
    v_mov_b32 v6, 1
    s_mov_b32 s100, 67108864
    s_and_b32 s64, s2, 7
    s_lshl_b32 s64, s64, 1
    s_bfe_u32 s65, s2, 0x10003
    s_or_b32 s64, s64, s65
    s_and_b32 s65, s2, 0xf0
    s_or_b32 s64, s64, s65
    s_cmp_lt_u32 s2, 240
    s_cselect_b32 s1, s64, s2
    s_and_b32 s31, s3, 3
    s_cmp_lt_u32 s3, 4
    s_cbranch_scc1 L_gemm
    s_setprio 3
    v_and_b32 v8, 0xfff, v8
    v_and_b32 v9, 0x3ff, v10
    s_lshr_b32 s66, s2, 4
    s_lshl_b32 s66, s66, 3
    s_and_b32 s67, s2, 7
    s_or_b32 s68, s66, s67
    s_mul_i32 s64, s68, 5120
    v_add_u32 v40, s64, v8
    s_add_u32 s64, s64, 4096
    v_add_u32 v41, s64, v9
    v_lshrrev_b32 v42, 2, v3
    v_and_b32 v43, 3, v3
    v_lshl_add_u32 v46, v42, 3, v43
    v_lshl_add_u32 v42, v42, 4, v43
    s_lshl_b32 s64, s31, 1
    v_mov_b32 v43, s64
    v_lshlrev_b32 v44, 1, v43
    v_cmp_gt_u32 vcc, 8, v3
    s_mul_i32 s65, s1, 640
    v_lshlrev_b32 v7, 4, v3
    v_cndmask_b32 v43, v43, v44, vcc
    v_add_lshl_u32 v42, v42, v43, 4
    v_lshl_add_u32 v42, v4, 2, v42
    v_add_u32 v42, s65, v42
    v_min_u32 v42, 159996, v42
    s_bitcmp1_b32 s2, 3
    s_cbranch_scc0 L_mrole_1
    s_waitcnt lgkmcnt(0)
    global_load_dword v0, v42, s[10:11]
    global_load_dwordx4 v[48:51], v40, s[8:9]
    global_load_dword v52, v41, s[8:9]
    global_load_dwordx4 v[56:59], v40, s[6:7]
    global_load_dword v60, v41, s[6:7]
L_roled_2:
    s_mov_b32 s27, s68
    s_mov_b32 s26, 0
    s_cmp_lg_u32 s31, 0
    s_cbranch_scc1 L_roled_2_b
    s_load_dword s30, s[28:29], 0
L_roled_2_b:
    s_barrier
    s_mov_b32 s32, s4
    s_and_b32 s33, s5, 0xffff
    s_mov_b32 s34, 5120000
    s_mov_b32 s35, 0x20000
    s_mov_b32 s36, s14
    s_and_b32 s37, s15, 0xffff
    s_mov_b32 s38, 20000
    s_mov_b32 s39, 0x20000
    s_add_u32 s40, s28, 1048576
    s_addc_u32 s41, s29, 0
    s_and_b32 s41, s41, 0xffff
    s_mov_b32 s42, 2048000
    s_mov_b32 s43, 0x20000
    v_and_b32 v40, 8, v3
    v_lshlrev_b32 v40, 1, v40
    v_mov_b32 v41, 0xffff
    v_lshlrev_b32 v40, v40, v41
    s_mov_b32 s64, 0x0f0f0f0f
    s_mov_b32 s65, 0x0f0f0f0f
    v_cndmask_b32 v12, 0, v40, s[64:65]
    v_xor_b32 v13, v40, v12
    v_and_b32 v14, 3, v3
    v_mul_u32_u24 v14, 0x5555, v14
    s_cmp_lg_u32 s31, 0
    s_cbranch_scc1 L_tagged_3
    s_waitcnt lgkmcnt(0)
    s_mul_i32 s30, s30, 0x9E3779B1
    s_add_u32 s30, s30, 0x7F4A7C15
    v_mov_b32 v40, 1
    v_mov_b32 v41, s30
    ds_write_b64 v5, v[40:41] offset:8
L_tagged_3:
    s_bitcmp1_b32 s2, 3
    s_cbranch_scc0 L_mwork_4
    v_mov_b32 v43, 4
    v_mov_b32 v44, 2031616
    s_mov_b32 s64, 0x3f0001
    v_lshrrev_b32 v40, 6, v8
    v_and_b32 v41, 0x30, v8
    v_lshl_add_u32 v40, v40, 14, v41
    s_lshl_b32 s68, s27, 6
    s_add_u32 s69, s68, 0x100000
    s_add_u32 s70, s68, 8192
    s_add_u32 s71, s69, 8192
    s_mov_b32 s65, 0x203c
    s_waitcnt vmcnt(2)
    v_mul_u32_u24 v64, 52429, v48
    v_lshrrev_b32 v72, 22, v64
    v_lshlrev_b32 v80, 2, v72
    ds_add_rtn_u32 v80, v80, v43 offset:512
    v_mul_u32_u24 v65, 52429, v49
    v_lshrrev_b32 v73, 22, v65
    v_lshlrev_b32 v81, 2, v73
    ds_add_rtn_u32 v81, v81, v43 offset:512
    v_mul_u32_u24 v66, 52429, v50
    v_lshrrev_b32 v74, 22, v66
    v_lshlrev_b32 v82, 2, v74
    ds_add_rtn_u32 v82, v82, v43 offset:512
    v_mul_u32_u24 v67, 52429, v51
    v_lshrrev_b32 v75, 22, v67
    v_lshlrev_b32 v83, 2, v75
    ds_add_rtn_u32 v83, v83, v43 offset:512
    v_mul_u32_u24 v68, 52429, v52
    v_lshrrev_b32 v76, 22, v68
    v_lshlrev_b32 v84, 2, v76
    ds_add_rtn_u32 v84, v84, v43 offset:512
    v_lshrrev_b32 v64, 21, v64
    v_mad_u32_u24 v64, v64, 24, v48
    v_mul_u32_u24 v64, 0x8001, v64
    v_bfe_u32 v88, v72, 1, 2
    v_lshl_or_b32 v72, v72, 2, v88
    v_lshlrev_b32 v72, 4, v72
    v_lshrrev_b32 v65, 21, v65
    v_mad_u32_u24 v65, v65, 24, v49
    v_mul_u32_u24 v65, 0x8001, v65
    v_bfe_u32 v89, v73, 1, 2
    v_lshl_or_b32 v73, v73, 2, v89
    v_lshlrev_b32 v73, 4, v73
    v_lshrrev_b32 v66, 21, v66
    v_mad_u32_u24 v66, v66, 24, v50
    v_mul_u32_u24 v66, 0x8001, v66
    v_bfe_u32 v90, v74, 1, 2
    v_lshl_or_b32 v74, v74, 2, v90
    v_lshlrev_b32 v74, 4, v74
    v_lshrrev_b32 v67, 21, v67
    v_mad_u32_u24 v67, v67, 24, v51
    v_mul_u32_u24 v67, 0x8001, v67
    v_bfe_u32 v91, v75, 1, 2
    v_lshl_or_b32 v75, v75, 2, v91
    v_lshlrev_b32 v75, 4, v75
    v_lshrrev_b32 v68, 21, v68
    v_mad_u32_u24 v68, v68, 24, v52
    v_mul_u32_u24 v68, 0x8001, v68
    v_bfe_u32 v92, v76, 1, 2
    v_lshl_or_b32 v76, v76, 2, v92
    v_lshlrev_b32 v76, 4, v76
    s_waitcnt vmcnt(0)
    v_lshlrev_b32 v56, 1, v56
    v_and_or_b32 v64, v64, s64, v56
    v_lshlrev_b32 v57, 1, v57
    v_and_or_b32 v65, v65, s64, v57
    v_lshlrev_b32 v58, 1, v58
    v_and_or_b32 v66, v66, s64, v58
    v_lshlrev_b32 v59, 1, v59
    v_and_or_b32 v67, v67, s64, v59
    v_lshlrev_b32 v60, 1, v60
    v_and_or_b32 v68, v68, s64, v60
    s_waitcnt lgkmcnt(0)
    v_cmp_gt_u32 vcc, 124, v80
    v_min_u32 v80, 124, v80
    v_lshl_or_b32 v80, v80, 7, v80
    v_cndmask_b32 v64, v44, v64, vcc
    v_bitop3_b32 v80, v80, s65, v72 bitop3:0x6a
    ds_write_b32 v80, v64 offset:41984
    v_cmp_gt_u32 vcc, 124, v81
    v_min_u32 v81, 124, v81
    v_lshl_or_b32 v81, v81, 7, v81
    v_cndmask_b32 v65, v44, v65, vcc
    v_bitop3_b32 v81, v81, s65, v73 bitop3:0x6a
    ds_write_b32 v81, v65 offset:41984
    v_cmp_gt_u32 vcc, 124, v82
    v_min_u32 v82, 124, v82
    v_lshl_or_b32 v82, v82, 7, v82
    v_cndmask_b32 v66, v44, v66, vcc
    v_bitop3_b32 v82, v82, s65, v74 bitop3:0x6a
    ds_write_b32 v82, v66 offset:41984
    v_cmp_gt_u32 vcc, 124, v83
    v_min_u32 v83, 124, v83
    v_lshl_or_b32 v83, v83, 7, v83
    v_cndmask_b32 v67, v44, v67, vcc
    v_bitop3_b32 v83, v83, s65, v75 bitop3:0x6a
    ds_write_b32 v83, v67 offset:41984
    v_cmp_gt_u32 vcc, 124, v84
    v_min_u32 v84, 124, v84
    v_lshl_or_b32 v84, v84, 7, v84
    v_cndmask_b32 v68, v44, v68, vcc
    v_bitop3_b32 v84, v84, s65, v76 bitop3:0x6a
    ds_write_b32 v84, v68 offset:41984
    s_waitcnt lgkmcnt(0)
    s_mov_b64 exec, 1
    ds_add_u32 v5, v6 offset:0
    s_mov_b64 exec, -1
L_spin_6:
    ds_read_b128 v[44:47], v5
    s_waitcnt lgkmcnt(0)
    v_readfirstlane_b32 s101, v44
    v_readfirstlane_b32 s30, v47
    s_cmp_ge_u32 s101, 4
    s_cbranch_scc0 L_retry_7
    ds_read_b128 v[48:51], v8 offset:41984
    ds_read_b128 v[52:55], v8 offset:46080
    ds_read_b128 v[56:59], v8 offset:50176
    ds_read_b128 v[60:63], v8 offset:54272
    s_and_b32 s44, s30, 0xffc00000
    s_lshl_b32 s45, s30, 10
    s_and_b32 s45, s45, 0xffc00000
    s_lshl_b32 s46, s30, 20
    s_and_b32 s46, s46, 0xffc00000
    s_lshl_b32 s47, s30, 22
    s_waitcnt lgkmcnt(3)
    v_cmp_eq_u32 vcc, 1966080, v51
    v_or_b32 v48, s44, v48
    v_or_b32 v49, s45, v49
    v_or_b32 v50, s46, v50
    v_or_b32 v51, s47, v51
    buffer_store_dwordx4 v[48:51], v40, s[40:43], s68 offen sc1
    s_wqm_b64 s[72:73], vcc
    s_waitcnt lgkmcnt(2)
    v_cmp_eq_u32 vcc, 1966080, v55
    v_or_b32 v52, s44, v52
    v_or_b32 v53, s45, v53
    v_or_b32 v54, s46, v54
    v_or_b32 v55, s47, v55
    buffer_store_dwordx4 v[52:55], v40, s[40:43], s69 offen sc1
    s_wqm_b64 s[74:75], vcc
    s_waitcnt lgkmcnt(1)
    s_not_b64 exec, s[72:73]
    s_cbranch_scc0 L_nosec_10
    v_or_b32 v56, s44, v56
    v_or_b32 v57, s45, v57
    v_or_b32 v58, s46, v58
    v_or_b32 v59, s47, v59
    buffer_store_dwordx4 v[56:59], v40, s[40:43], s70 offen sc1
L_nosec_10:
    s_waitcnt lgkmcnt(0)
    s_not_b64 exec, s[74:75]
    s_cbranch_scc0 L_nosec_11
    v_or_b32 v60, s44, v60
    v_or_b32 v61, s45, v61
    v_or_b32 v62, s46, v62
    v_or_b32 v63, s47, v63
    buffer_store_dwordx4 v[60:63], v40, s[40:43], s71 offen sc1
L_nosec_11:
    s_mov_b64 exec, -1
    s_cmp_ge_u32 s2, 250
    s_cbranch_scc1 L_end
L_worked_5:
    v_lshlrev_b32 v0, 9, v0
    s_setprio 1
    s_lshl_b32 s64, s31, 10
    s_lshr_b32 s10, s1, 1
    s_lshl_b32 s10, s10, 14
    s_add_u32 s11, s10, 4096
    s_add_u32 s12, s10, 8192
    s_add_u32 s13, s10, 12288
    v_cmp_gt_u32 vcc, 0xf40, v8
    s_mov_b64 s[14:15], vcc
    v_add_u32_dpp v9, v0, v7 row_newbcast:0 row_mask:0xf bank_mask:0xf
    buffer_load_dwordx4 v[176:179], v9, s[32:35], 0 offen offset:0
    buffer_load_dwordx4 v[180:183], v9, s[32:35], 0 offen offset:256
    v_add_u32_dpp v9, v0, v7 row_newbcast:1 row_mask:0xf bank_mask:0xf
    buffer_load_dwordx4 v[184:187], v9, s[32:35], 0 offen offset:0
    buffer_load_dwordx4 v[188:191], v9, s[32:35], 0 offen offset:256
    s_add_u32 m0, s64, 62464
    s_mov_b32 s65, 0
    buffer_load_dwordx4 v8, s[36:39], s65 offen lds
    v_add_u32_dpp v9, v0, v7 row_newbcast:2 row_mask:0xf bank_mask:0xf
    s_cmp_eq_u32 s26, 2
    s_cbranch_scc1 L_loose_12
    s_waitcnt vmcnt(2)
L_loose_12:
    s_waitcnt vmcnt(6)
    buffer_load_dwordx4 v[192:195], v9, s[32:35], 0 offen offset:0
    buffer_load_dwordx4 v[196:199], v9, s[32:35], 0 offen offset:256
    s_add_u32 m0, s64, 66560
    s_mov_b32 s65, 4096
    buffer_load_dwordx4 v8, s[36:39], s65 offen lds
    v_add_u32_dpp v9, v0, v7 row_newbcast:3 row_mask:0xf bank_mask:0xf
    s_cmp_eq_u32 s26, 2
    s_cbranch_scc1 L_loose_13
    s_waitcnt vmcnt(2)
L_loose_13:
    s_waitcnt vmcnt(6)
    buffer_load_dwordx4 v[200:203], v9, s[32:35], 0 offen offset:0
    buffer_load_dwordx4 v[204:207], v9, s[32:35], 0 offen offset:256
    s_add_u32 m0, s64, 70656
    s_mov_b32 s65, 8192
    buffer_load_dwordx4 v8, s[36:39], s65 offen lds
    v_add_u32_dpp v9, v0, v7 row_newbcast:4 row_mask:0xf bank_mask:0xf
    s_cmp_eq_u32 s26, 2
    s_cbranch_scc1 L_loose_14
    s_waitcnt vmcnt(2)
L_loose_14:
    s_waitcnt vmcnt(6)
    buffer_load_dwordx4 v[208:211], v9, s[32:35], 0 offen offset:0
    buffer_load_dwordx4 v[212:215], v9, s[32:35], 0 offen offset:256
    s_add_u32 m0, s64, 74752
    s_mov_b32 s65, 12288
    buffer_load_dwordx4 v8, s[36:39], s65 offen lds
    v_add_u32_dpp v9, v0, v7 row_newbcast:5 row_mask:0xf bank_mask:0xf
    s_cmp_eq_u32 s26, 2
    s_cbranch_scc1 L_loose_15
    s_waitcnt vmcnt(2)
L_loose_15:
    s_waitcnt vmcnt(6)
    buffer_load_dwordx4 v[216:219], v9, s[32:35], 0 offen offset:0
    buffer_load_dwordx4 v[220:223], v9, s[32:35], 0 offen offset:256
    s_add_u32 m0, s64, 78848
    s_mov_b32 s65, 16384
    buffer_load_dwordx4 v8, s[36:39], s65 offen lds
L_ipoll_16:
    buffer_load_dwordx4 v[48:51], v8, s[40:43], s10 offen sc1
    s_mov_b64 exec, s[14:15]
    buffer_load_dwordx4 v[52:55], v8, s[40:43], s11 offen sc1
    s_mov_b64 exec, -1
L_spin_17:
    ds_read_b128 v[44:47], v5
    s_waitcnt lgkmcnt(0)
    v_readfirstlane_b32 s101, v46
    v_readfirstlane_b32 s30, v47
    s_cmp_ge_u32 s101, 1
    s_cbranch_scc0 L_retry_18
    s_and_b32 s44, s30, 0xffc00000
    s_lshl_b32 s45, s30, 10
    s_and_b32 s45, s45, 0xffc00000
    s_lshl_b32 s46, s30, 20
    s_and_b32 s46, s46, 0xffc00000
    s_lshl_b32 s47, s30, 22
    s_and_b32 s64, s1, 1
    s_lshl_b32 s64, s64, 21
    s_xor_b32 s17, s64, 1966080
    s_or_b32 s44, s44, s64
    v_mov_b32 v68, s17
    s_or_b32 s45, s45, s64
    v_mov_b32 v69, s17
    s_or_b32 s46, s46, s64
    v_mov_b32 v70, s17
    s_or_b32 s47, s47, s64
    v_mov_b32 v71, s17
    s_mov_b32 s16, 1310720
    v_mov_b32 v42, 2
    s_waitcnt vmcnt(1)
    v_xor_b32 v64, s44, v48
    v_xor_b32 v65, s45, v49
    v_xor_b32 v66, s46, v50
    v_xor_b32 v67, s47, v51
    v_or3_b32 v40, v64, v65, v66
    v_or_b32 v40, v40, v67
    v_cmp_eq_u32 s[72:73], s17, v67
    v_cmp_gt_u32 s[48:49], s16, v64
    v_lshlrev_b32_sdwa v80, 2, v64 dst_sel:DWORD dst_unused:UNUSED_PAD src0_sel:DWORD src1_sel:WORD_1
    v_cmp_gt_u32 s[50:51], s16, v65
    v_lshlrev_b32_sdwa v81, 2, v65 dst_sel:DWORD dst_unused:UNUSED_PAD src0_sel:DWORD src1_sel:WORD_1
    v_cmp_gt_u32 s[52:53], s16, v66
    v_lshlrev_b32_sdwa v82, 2, v66 dst_sel:DWORD dst_unused:UNUSED_PAD src0_sel:DWORD src1_sel:WORD_1
    v_cmp_gt_u32 s[54:55], s16, v67
    v_lshlrev_b32_sdwa v83, 2, v67 dst_sel:DWORD dst_unused:UNUSED_PAD src0_sel:DWORD src1_sel:WORD_1
    s_waitcnt vmcnt(0)
    s_mov_b64 exec, s[14:15]
    v_xor_b32 v68, s44, v52
    v_xor_b32 v69, s45, v53
    v_xor_b32 v70, s46, v54
    v_xor_b32 v71, s47, v55
    s_mov_b64 exec, -1
    v_or3_b32 v40, v40, v68, v69
    v_or3_b32 v40, v40, v70, v71
    v_cmp_eq_u32 s[74:75], s17, v71
    v_cmp_le_u32 vcc, 0x400000, v40
    s_cbranch_vccnz L_retry_19
    s_wqm_b64 s[72:73], s[72:73]
    s_not_b64 exec, s[72:73]
    s_cbranch_scc0 L_nosec_20
    buffer_load_dwordx4 v[56:59], v8, s[40:43], s12 offen sc1
L_nosec_20:
    s_wqm_b64 s[74:75], s[74:75]
    s_not_b64 exec, s[74:75]
    s_cbranch_scc0 L_nosec_21
    buffer_load_dwordx4 v[60:63], v8, s[40:43], s13 offen sc1
L_nosec_21:
    s_mov_b64 exec, -1
    v_cmp_gt_u32 s[56:57], s16, v68
    v_lshlrev_b32_sdwa v84, 2, v68 dst_sel:DWORD dst_unused:UNUSED_PAD src0_sel:DWORD src1_sel:WORD_1
    v_cmp_gt_u32 s[58:59], s16, v69
    v_lshlrev_b32_sdwa v85, 2, v69 dst_sel:DWORD dst_unused:UNUSED_PAD src0_sel:DWORD src1_sel:WORD_1
    v_cmp_gt_u32 s[60:61], s16, v70
    v_lshlrev_b32_sdwa v86, 2, v70 dst_sel:DWORD dst_unused:UNUSED_PAD src0_sel:DWORD src1_sel:WORD_1
    v_cmp_gt_u32 s[62:63], s16, v71
    v_lshlrev_b32_sdwa v87, 2, v71 dst_sel:DWORD dst_unused:UNUSED_PAD src0_sel:DWORD src1_sel:WORD_1
    s_mov_b64 exec, s[48:49]
    ds_add_rtn_u32 v80, v80, v42 offset:128
    s_mov_b64 exec, s[50:51]
    ds_add_rtn_u32 v81, v81, v42 offset:128
    s_mov_b64 exec, s[52:53]
    ds_add_rtn_u32 v82, v82, v42 offset:128
    s_mov_b64 exec, s[54:55]
    ds_add_rtn_u32 v83, v83, v42 offset:128
    s_mov_b64 exec, s[56:57]
    ds_add_rtn_u32 v84, v84, v42 offset:128
    s_mov_b64 exec, s[58:59]
    ds_add_rtn_u32 v85, v85, v42 offset:128
    s_mov_b64 exec, s[60:61]
    ds_add_rtn_u32 v86, v86, v42 offset:128
    s_mov_b64 exec, s[62:63]
    ds_add_rtn_u32 v87, v87, v42 offset:128
    s_mov_b64 exec, -1
    v_add_u32_dpp v9, v0, v7 row_newbcast:6 row_mask:0xf bank_mask:0xf
    buffer_load_dwordx4 v[224:227], v9, s[32:35], 0 offen offset:0
    buffer_load_dwordx4 v[228:231], v9, s[32:35], 0 offen offset:256
    v_add_u32_dpp v9, v0, v7 row_newbcast:7 row_mask:0xf bank_mask:0xf
    buffer_load_dwordx4 v[232:235], v9, s[32:35], 0 offen offset:0
    buffer_load_dwordx4 v[236:239], v9, s[32:35], 0 offen offset:256
    s_waitcnt lgkmcnt(4)
    s_mov_b64 exec, s[48:49]
    ds_write_b16 v80, v64
    s_mov_b64 exec, s[50:51]
    ds_write_b16 v81, v65
    s_mov_b64 exec, s[52:53]
    ds_write_b16 v82, v66
    s_mov_b64 exec, s[54:55]
    ds_write_b16 v83, v67
    s_waitcnt lgkmcnt(4)
    s_mov_b64 exec, s[56:57]
    ds_write_b16 v84, v68
    s_mov_b64 exec, s[58:59]
    ds_write_b16 v85, v69
    s_mov_b64 exec, s[60:61]
    ds_write_b16 v86, v70
    s_mov_b64 exec, s[62:63]
    ds_write_b16 v87, v71
    s_not_b64 exec, s[72:73]
    s_cbranch_scc0 L_secdone_23
    s_waitcnt vmcnt(4)
L_sec_22:
    v_xor_b32 v72, s44, v56
    v_xor_b32 v73, s45, v57
    v_xor_b32 v74, s46, v58
    v_xor_b32 v75, s47, v59
    v_or3_b32 v40, v72, v73, v74
    v_or_b32 v40, v40, v75
    v_cmp_le_u32 vcc, 0x400000, v40
    s_cbranch_vccnz L_retry_25
    v_and_b32 v40, 2031616, v75
    v_cmp_eq_u32 vcc, 2031616, v40
    v_cmp_gt_u32 s[64:65], s16, v72
    v_lshlrev_b32_sdwa v88, 2, v72 dst_sel:DWORD dst_unused:UNUSED_PAD src0_sel:DWORD src1_sel:WORD_1
    v_cmp_gt_u32 s[66:67], s16, v73
    v_lshlrev_b32_sdwa v89, 2, v73 dst_sel:DWORD dst_unused:UNUSED_PAD src0_sel:DWORD src1_sel:WORD_1
    v_cmp_gt_u32 s[68:69], s16, v74
    v_lshlrev_b32_sdwa v90, 2, v74 dst_sel:DWORD dst_unused:UNUSED_PAD src0_sel:DWORD src1_sel:WORD_1
    v_cmp_gt_u32 s[70:71], s16, v75
    v_lshlrev_b32_sdwa v91, 2, v75 dst_sel:DWORD dst_unused:UNUSED_PAD src0_sel:DWORD src1_sel:WORD_1
    s_mov_b64 exec, s[64:65]
    ds_add_rtn_u32 v88, v88, v42 offset:128
    s_mov_b64 exec, s[66:67]
    ds_add_rtn_u32 v89, v89, v42 offset:128
    s_mov_b64 exec, s[68:69]
    ds_add_rtn_u32 v90, v90, v42 offset:128
    s_mov_b64 exec, s[70:71]
    ds_add_rtn_u32 v91, v91, v42 offset:128
    s_mov_b64 exec, vcc
    ds_write_b32 v5, v6 offset:20
    s_waitcnt lgkmcnt(0)
    s_mov_b64 exec, s[64:65]
    ds_write_b16 v88, v72
    s_mov_b64 exec, s[66:67]
    ds_write_b16 v89, v73
    s_mov_b64 exec, s[68:69]
    ds_write_b16 v90, v74
    s_mov_b64 exec, s[70:71]
    ds_write_b16 v91, v75
L_secdone_23:
    s_not_b64 exec, s[74:75]
    s_cbranch_scc0 L_secdone_27
    s_waitcnt vmcnt(4)
L_sec_26:
    v_xor_b32 v76, s44, v60
    v_xor_b32 v77, s45, v61
    v_xor_b32 v78, s46, v62
    v_xor_b32 v79, s47, v63
    v_or3_b32 v40, v76, v77, v78
    v_or_b32 v40, v40, v79
    v_cmp_le_u32 vcc, 0x400000, v40
    s_cbranch_vccnz L_retry_29
    v_and_b32 v40, 2031616, v79
    v_cmp_eq_u32 vcc, 2031616, v40
    v_cmp_gt_u32 s[64:65], s16, v76
    v_lshlrev_b32_sdwa v92, 2, v76 dst_sel:DWORD dst_unused:UNUSED_PAD src0_sel:DWORD src1_sel:WORD_1
    v_cmp_gt_u32 s[66:67], s16, v77
    v_lshlrev_b32_sdwa v93, 2, v77 dst_sel:DWORD dst_unused:UNUSED_PAD src0_sel:DWORD src1_sel:WORD_1
    v_cmp_gt_u32 s[68:69], s16, v78
    v_lshlrev_b32_sdwa v94, 2, v78 dst_sel:DWORD dst_unused:UNUSED_PAD src0_sel:DWORD src1_sel:WORD_1
    v_cmp_gt_u32 s[70:71], s16, v79
    v_lshlrev_b32_sdwa v95, 2, v79 dst_sel:DWORD dst_unused:UNUSED_PAD src0_sel:DWORD src1_sel:WORD_1
    s_mov_b64 exec, s[64:65]
    ds_add_rtn_u32 v92, v92, v42 offset:128
    s_mov_b64 exec, s[66:67]
    ds_add_rtn_u32 v93, v93, v42 offset:128
    s_mov_b64 exec, s[68:69]
    ds_add_rtn_u32 v94, v94, v42 offset:128
    s_mov_b64 exec, s[70:71]
    ds_add_rtn_u32 v95, v95, v42 offset:128
    s_mov_b64 exec, vcc
    ds_write_b32 v5, v6 offset:20
    s_waitcnt lgkmcnt(0)
    s_mov_b64 exec, s[64:65]
    ds_write_b16 v92, v76
    s_mov_b64 exec, s[66:67]
    ds_write_b16 v93, v77
    s_mov_b64 exec, s[68:69]
    ds_write_b16 v94, v78
    s_mov_b64 exec, s[70:71]
    ds_write_b16 v95, v79
L_secdone_27:
    s_waitcnt lgkmcnt(0)
    s_mov_b64 exec, 1
    ds_add_u32 v5, v6 offset:16
    s_mov_b64 exec, -1
    v_add_u32_dpp v9, v0, v7 row_newbcast:8 row_mask:0xf bank_mask:0xf
    buffer_load_dwordx4 v[240:243], v9, s[32:35], 0 offen offset:0
    buffer_load_dwordx4 v[244:247], v9, s[32:35], 0 offen offset:256
    v_add_u32_dpp v9, v0, v7 row_newbcast:9 row_mask:0xf bank_mask:0xf
    buffer_load_dwordx4 v[248:251], v9, s[32:35], 0 offen offset:0
    buffer_load_dwordx4 v[252:255], v9, s[32:35], 0 offen offset:256
    s_lshl_b32 s20, s31, 1
    s_add_u32 s21, s20, 1
    s_add_u32 s22, s20, 8
    s_add_u32 s23, s20, 9
    s_add_u32 s24, s31, 16
    v_add_u32 v47, -1, v3
    v_bfe_u32 v40, v47, 1, 1
    v_and_b32 v41, 1, v47
    v_lshl_add_u32 v40, v40, 3, v41
    v_add_u32 v40, s20, v40
    v_mov_b32 v41, s24
    v_cmp_ne_u32 vcc, 0, v3
    v_min_u32 v47, 19, v2
    v_mul_u32_u24 v46, 264, v47
    v_cndmask_b32 v40, v41, v40, vcc
    v_mul_u32_u24 v41, 264, v40
    v_add_u32 v41, 148480, v41
    v_lshlrev_b32 v40, 2, v40
    v_add_u32 v46, 148728, v46
    v_lshlrev_b32 v47, 2, v47
    v_lshlrev_b32 v43, 3, v3
    v_lshl_add_u32 v43, v4, 1, v43
L_spin_30:
    ds_read_b32 v44, v5 offset:16
    s_waitcnt lgkmcnt(0)
    v_readfirstlane_b32 s101, v44
    s_cmp_ge_u32 s101, 4
    s_cbranch_scc0 L_retry_31
    ds_read_b32 v44, v40 offset:128
    ds_read_b32 v47, v47 offset:128
    ds_read_b32 v45, v5 offset:20
    s_waitcnt lgkmcnt(2)
    v_sub_u32 v44, v44, v41
    v_max_u32 v44, 18, v44
    s_waitcnt lgkmcnt(0)
    v_cmp_gt_u32 vcc, v47, v46
    v_add_u32_dpp v48, v44, v44 row_shr:1 row_mask:0xf bank_mask:0xf bound_ctrl:1
    v_readfirstlane_b32 s25, v45
    s_or_b32 s64, vcc_lo, vcc_hi
    v_add_u32_dpp v48, v48, v48 row_shr:2 row_mask:0xf bank_mask:0xf bound_ctrl:1
    s_or_b32 s25, s25, s64
    s_mov_b32 s53, 0
    v_add_u32_dpp v48, v48, v48 row_shr:4 row_mask:0xf bank_mask:0xf bound_ctrl:1
    v_sub_u32 v44, v48, v44
    v_sub_u32 v44, v41, v44
    v_readlane_b32 s10, v48, 0
    v_readlane_b32 s11, v48, 1
    v_readlane_b32 s12, v48, 2
    v_readlane_b32 s13, v48, 3
    v_readlane_b32 s14, v48, 4
    v_add_u32_dpp v160, v44, v43 row_newbcast:0 row_mask:0xf bank_mask:0xf
    v_add_u32_dpp v161, v44, v43 row_newbcast:1 row_mask:0xf bank_mask:0xf
    v_add_u32_dpp v162, v44, v43 row_newbcast:2 row_mask:0xf bank_mask:0xf
    v_add_u32_dpp v163, v44, v43 row_newbcast:3 row_mask:0xf bank_mask:0xf
    v_add_u32_dpp v164, v44, v43 row_newbcast:4 row_mask:0xf bank_mask:0xf
    s_add_u32 s50, s14, 14
    s_lshr_b32 s50, s50, 4
    s_cmp_gt_u32 s50, 32
    s_cselect_b32 s25, 1, s25
    s_max_u32 s50, s50, 12
    v_add_u32 v40, 0, v43
    v_cmp_le_u32 s[64:65], s10, v40
    v_cmp_le_u32 s[66:67], s11, v40
    v_cmp_le_u32 s[68:69], s12, v40
    v_cmp_le_u32 s[70:71], s13, v40
    v_cndmask_b32 v40, v160, v161, s[64:65]
    v_cndmask_b32 v40, v40, v162, s[66:67]
    v_cndmask_b32 v40, v40, v163, s[68:69]
    v_cndmask_b32 v40, v40, v164, s[70:71]
    ds_read_u16 v40, v40 offset:0
    v_add_u32 v41, 128, v43
    v_cmp_le_u32 s[64:65], s10, v41
    v_cmp_le_u32 s[66:67], s11, v41
    v_cmp_le_u32 s[68:69], s12, v41
    v_cmp_le_u32 s[70:71], s13, v41
    v_cndmask_b32 v41, v160, v161, s[64:65]
    v_cndmask_b32 v41, v41, v162, s[66:67]
    v_cndmask_b32 v41, v41, v163, s[68:69]
    v_cndmask_b32 v41, v41, v164, s[70:71]
    ds_read_u16 v41, v41 offset:128
    v_add_u32 v42, 256, v43
    v_cmp_le_u32 s[64:65], s10, v42
    v_cmp_le_u32 s[66:67], s11, v42
    v_cmp_le_u32 s[68:69], s12, v42
    v_cmp_le_u32 s[70:71], s13, v42
    v_cndmask_b32 v42, v160, v161, s[64:65]
    v_cndmask_b32 v42, v42, v162, s[66:67]
    v_cndmask_b32 v42, v42, v163, s[68:69]
    v_cndmask_b32 v42, v42, v164, s[70:71]
    ds_read_u16 v42, v42 offset:256
    v_add_u32 v43, 384, v43
    v_cmp_le_u32 s[64:65], s10, v43
    v_cmp_le_u32 s[66:67], s11, v43
    v_cmp_le_u32 s[68:69], s12, v43
    v_cmp_le_u32 s[70:71], s13, v43
    v_cndmask_b32 v43, v160, v161, s[64:65]
    v_cndmask_b32 v43, v43, v162, s[66:67]
    v_cndmask_b32 v43, v43, v163, s[68:69]
    v_cndmask_b32 v43, v43, v164, s[70:71]
    ds_read_u16 v43, v43 offset:384
    s_waitcnt lgkmcnt(3)
    v_and_b32 v32, 0x7ffe, v40
    ds_read_u16 v33, v32 offset:62464
    v_lshlrev_b32 v32, 8, v32
    v_lshlrev_b32 v40, 4, v40
    s_waitcnt lgkmcnt(3)
    v_and_b32 v34, 0x7ffe, v41
    ds_read_u16 v35, v34 offset:62464
    v_lshlrev_b32 v34, 8, v34
    v_lshlrev_b32 v41, 4, v41
    s_waitcnt lgkmcnt(3)
    v_and_b32 v36, 0x7ffe, v42
    ds_read_u16 v37, v36 offset:62464
    v_lshlrev_b32 v36, 8, v36
    v_lshlrev_b32 v42, 4, v42
    s_waitcnt lgkmcnt(3)
    v_and_b32 v38, 0x7ffe, v43
    ds_read_u16 v39, v38 offset:62464
    v_lshlrev_b32 v38, 8, v38
    v_lshlrev_b32 v43, 4, v43
    v_add_u32_dpp v11, v32, v7 row_newbcast:0 row_mask:0xf bank_mask:0xf
    buffer_load_dwordx4 v[48:51], v11, s[32:35], 0 offen offset:0
    buffer_load_dwordx4 v[56:59], v11, s[32:35], 0 offen offset:256
    v_add_u32_dpp v11, v32, v7 row_newbcast:1 row_mask:0xf bank_mask:0xf
    buffer_load_dwordx4 v[52:55], v11, s[32:35], 0 offen offset:0
    buffer_load_dwordx4 v[60:63], v11, s[32:35], 0 offen offset:256
    v_add_u32_dpp v11, v32, v7 row_newbcast:2 row_mask:0xf bank_mask:0xf
    buffer_load_dwordx4 v[64:67], v11, s[32:35], 0 offen offset:0
    buffer_load_dwordx4 v[72:75], v11, s[32:35], 0 offen offset:256
    v_add_u32_dpp v11, v32, v7 row_newbcast:3 row_mask:0xf bank_mask:0xf
    buffer_load_dwordx4 v[68:71], v11, s[32:35], 0 offen offset:0
    buffer_load_dwordx4 v[76:79], v11, s[32:35], 0 offen offset:256
    v_add_u32_dpp v11, v32, v7 row_newbcast:4 row_mask:0xf bank_mask:0xf
    buffer_load_dwordx4 v[80:83], v11, s[32:35], 0 offen offset:0
    buffer_load_dwordx4 v[88:91], v11, s[32:35], 0 offen offset:256
    v_add_u32_dpp v11, v32, v7 row_newbcast:5 row_mask:0xf bank_mask:0xf
    buffer_load_dwordx4 v[84:87], v11, s[32:35], 0 offen offset:0
    buffer_load_dwordx4 v[92:95], v11, s[32:35], 0 offen offset:256
    s_mov_b32 s57, 0
    s_sub_u32 s64, s14, 18
    s_lshr_b32 s65, s64, 4
    s_bitset1_b32 s53, s65
    s_and_b32 s64, s64, 14
    s_lshl4_add_u32 s57, s57, s64
    s_and_b32 s65, s24, 7
    s_lshl_b32 s65, s65, 5
    s_lshl_b32 s19, s24, 10
    s_or_b32 s19, s19, s65
    s_sub_u32 s64, s13, 18
    s_lshr_b32 s65, s64, 4
    s_bitset1_b32 s53, s65
    s_and_b32 s64, s64, 14
    s_lshl4_add_u32 s57, s57, s64
    s_and_b32 s65, s23, 7
    s_lshl_b32 s65, s65, 5
    s_lshl_b32 s18, s23, 10
    s_or_b32 s18, s18, s65
    s_sub_u32 s64, s12, 18
    s_lshr_b32 s65, s64, 4
    s_bitset1_b32 s53, s65
    s_and_b32 s64, s64, 14
    s_lshl4_add_u32 s57, s57, s64
    s_and_b32 s65, s22, 7
    s_lshl_b32 s65, s65, 5
    s_lshl_b32 s17, s22, 10
    s_or_b32 s17, s17, s65
    s_sub_u32 s64, s11, 18
    s_lshr_b32 s65, s64, 4
    s_bitset1_b32 s53, s65
    s_and_b32 s64, s64, 14
    s_lshl4_add_u32 s57, s57, s64
    s_and_b32 s65, s21, 7
    s_lshl_b32 s65, s65, 5
    s_lshl_b32 s16, s21, 10
    s_or_b32 s16, s16, s65
    s_sub_u32 s64, s10, 18
    s_lshr_b32 s65, s64, 4
    s_bitset1_b32 s53, s65
    s_and_b32 s64, s64, 14
    s_lshl4_add_u32 s57, s57, s64
    s_and_b32 s65, s20, 7
    s_lshl_b32 s65, s65, 5
    s_lshl_b32 s15, s20, 10
    s_or_b32 s15, s15, s65
    s_sub_u32 s64, s50, 5
    s_lshl_b32 s56, 1, s64
    s_or_b32 s52, s56, s53
    v_and_b32 v46, 1, v3
    v_lshl_add_u32 v46, v4, 1, v46
    v_and_b32 v46, 3, v46
    v_and_b32 v47, 14, v3
    v_lshl_add_u32 v46, v46, 4, v47
    v_lshrrev_b32 v47, 1, v4
    v_add_lshl_u32 v46, v46, v47, 2
    v_lshrrev_b32 v44, 1, v4
    v_mul_u32_u24 v44, 528, v44
    v_xor_b32 v44, v44, v7
    v_and_b32 v45, 1, v4
    v_lshl_or_b32 v2, v45, 3, v44
    v_xor_b32 v144, s15, v7
    v_xor_b32 v146, s16, v7
    v_xor_b32 v148, s19, v7
    v_xor_b32 v145, 528, v144
    v_xor_b32 v147, 528, v146
    v_xor_b32 v149, 528, v148
    s_mul_i32 s64, s1, 80
    s_add_u32 s64, s64, 62464
    v_and_b32 v45, 2, v4
    v_add_u32 v0, s64, v45
    s_getpc_b64 s[72:73]
L_anc:
    v_lshlrev_b32 v4, 2, v4
    s_mov_b32 s62, L_fp1-L_anc
    s_mov_b32 s63, L_fp1-L_fp0
    s_mov_b32 s70, L_dr1-L_anc
    s_mov_b32 s71, L_dr1-L_dr0
    s_mov_b32 s26, 0
    v_mov_b32 v1, 0
    s_lshl_b32 s64, s31, 2
    v_mov_b32 v10, s64
    v_and_b32 v9, 8, v3
    v_lshlrev_b32 v9, 1, v9
    s_mov_b32 s66, 0x22222222
    s_mov_b32 s67, 0x22222222
    s_mov_b32 s68, 0x44444444
    s_mov_b32 s69, 0x44444444
    v_mov_b64 v[150:151], 0
    v_mov_b64 v[152:153], 0
    v_mov_b64 v[154:155], 0
    v_mov_b64 v[156:157], 0
    v_mov_b64 v[158:159], 0
    v_mov_b64 v[16:17], 0
    v_mov_b64 v[18:19], 0
    v_mov_b64 v[20:21], 0
    v_mov_b64 v[22:23], 0
    s_waitcnt lgkmcnt(0)
    v_lshlrev_b32 v33, v40, v33
    ds_bpermute_b32 v33, v46, v33
    v_lshlrev_b32 v35, v41, v35
    ds_bpermute_b32 v35, v46, v35
    v_lshlrev_b32 v37, v42, v37
    ds_bpermute_b32 v37, v46, v37
    v_lshlrev_b32 v39, v43, v39
    ds_bpermute_b32 v39, v46, v39
    s_waitcnt vmcnt(12) lgkmcnt(0)
    s_barrier
    ds_read_b128 v[160:163], v144 offset:21504
    ds_read_b128 v[164:167], v144 offset:21760
    ds_read_b128 v[168:171], v145 offset:21504
    ds_read_b128 v[172:175], v145 offset:21760
    s_waitcnt lgkmcnt(2)
    v_dot2c_f32_bf16 v150, v176, v160
    v_dot2c_f32_bf16 v150, v177, v161
    v_dot2c_f32_bf16 v150, v178, v162
    v_dot2c_f32_bf16 v150, v179, v163
    v_dot2c_f32_bf16 v150, v180, v164
    v_dot2c_f32_bf16 v150, v181, v165
    v_dot2c_f32_bf16 v150, v182, v166
    v_dot2c_f32_bf16 v150, v183, v167
    ds_read_b128 v[160:163], v146 offset:21504
    ds_read_b128 v[164:167], v146 offset:21760
    s_waitcnt lgkmcnt(2)
    v_dot2c_f32_bf16 v151, v184, v168
    v_dot2c_f32_bf16 v151, v185, v169
    v_dot2c_f32_bf16 v151, v186, v170
    v_dot2c_f32_bf16 v151, v187, v171
    v_dot2c_f32_bf16 v151, v188, v172
    v_dot2c_f32_bf16 v151, v189, v173
    v_dot2c_f32_bf16 v151, v190, v174
    v_dot2c_f32_bf16 v151, v191, v175
    ds_read_b128 v[168:171], v147 offset:21504
    ds_read_b128 v[172:175], v147 offset:21760
    s_waitcnt lgkmcnt(2)
    v_dot2c_f32_bf16 v152, v192, v160
    v_dot2c_f32_bf16 v152, v193, v161
    v_dot2c_f32_bf16 v152, v194, v162
    v_dot2c_f32_bf16 v152, v195, v163
    v_dot2c_f32_bf16 v152, v196, v164
    v_dot2c_f32_bf16 v152, v197, v165
    v_dot2c_f32_bf16 v152, v198, v166
    v_dot2c_f32_bf16 v152, v199, v167
    v_add_f32_dpp v150, v150, v150 row_ror:8 row_mask:0xf bank_mask:0x3
    v_add_f32_dpp v150, v151, v151 row_ror:8 row_mask:0xf bank_mask:0xc
    ds_read_b128 v[160:163], v144 offset:29696
    ds_read_b128 v[164:167], v144 offset:29952
    s_waitcnt lgkmcnt(2)
    v_dot2c_f32_bf16 v153, v200, v168
    v_dot2c_f32_bf16 v153, v201, v169
    v_dot2c_f32_bf16 v153, v202, v170
    v_dot2c_f32_bf16 v153, v203, v171
    v_dot2c_f32_bf16 v153, v204, v172
    v_dot2c_f32_bf16 v153, v205, v173
    v_dot2c_f32_bf16 v153, v206, v174
    v_dot2c_f32_bf16 v153, v207, v175
    ds_read_b128 v[168:171], v145 offset:29696
    ds_read_b128 v[172:175], v145 offset:29952
    s_waitcnt lgkmcnt(2)
    v_dot2c_f32_bf16 v154, v208, v160
    v_dot2c_f32_bf16 v154, v209, v161
    v_dot2c_f32_bf16 v154, v210, v162
    v_dot2c_f32_bf16 v154, v211, v163
    v_dot2c_f32_bf16 v154, v212, v164
    v_dot2c_f32_bf16 v154, v213, v165
    v_dot2c_f32_bf16 v154, v214, v166
    v_dot2c_f32_bf16 v154, v215, v167
    v_add_f32_dpp v152, v152, v152 row_ror:8 row_mask:0xf bank_mask:0x3
    v_add_f32_dpp v152, v153, v153 row_ror:8 row_mask:0xf bank_mask:0xc
    v_add_u32_dpp v11, v32, v7 row_newbcast:6 row_mask:0xf bank_mask:0xf
    buffer_load_dwordx4 v[96:99], v11, s[32:35], 0 offen offset:0
    buffer_load_dwordx4 v[104:107], v11, s[32:35], 0 offen offset:256
    ds_read_b128 v[160:163], v146 offset:29696
    ds_read_b128 v[164:167], v146 offset:29952
    s_waitcnt lgkmcnt(2)
    v_dot2c_f32_bf16 v155, v216, v168
    v_dot2c_f32_bf16 v155, v217, v169
    v_dot2c_f32_bf16 v155, v218, v170
    v_dot2c_f32_bf16 v155, v219, v171
    v_dot2c_f32_bf16 v155, v220, v172
    v_dot2c_f32_bf16 v155, v221, v173
    v_dot2c_f32_bf16 v155, v222, v174
    v_dot2c_f32_bf16 v155, v223, v175
    v_add_f32_dpp v150, v150, v150 row_half_mirror row_mask:0xf bank_mask:0x5
    v_add_f32_dpp v150, v152, v152 row_half_mirror row_mask:0xf bank_mask:0xa
    v_add_u32_dpp v11, v32, v7 row_newbcast:7 row_mask:0xf bank_mask:0xf
    buffer_load_dwordx4 v[100:103], v11, s[32:35], 0 offen offset:0
    buffer_load_dwordx4 v[108:111], v11, s[32:35], 0 offen offset:256
    ds_read_b128 v[168:171], v147 offset:29696
    ds_read_b128 v[172:175], v147 offset:29952
    s_waitcnt lgkmcnt(2)
    v_dot2c_f32_bf16 v156, v224, v160
    v_dot2c_f32_bf16 v156, v225, v161
    v_dot2c_f32_bf16 v156, v226, v162
    v_dot2c_f32_bf16 v156, v227, v163
    v_dot2c_f32_bf16 v156, v228, v164
    v_dot2c_f32_bf16 v156, v229, v165
    v_dot2c_f32_bf16 v156, v230, v166
    v_dot2c_f32_bf16 v156, v231, v167
    v_add_f32_dpp v154, v154, v154 row_ror:8 row_mask:0xf bank_mask:0x3
    v_add_f32_dpp v154, v155, v155 row_ror:8 row_mask:0xf bank_mask:0xc
    v_add_u32_dpp v11, v32, v7 row_newbcast:8 row_mask:0xf bank_mask:0xf
    buffer_load_dwordx4 v[112:115], v11, s[32:35], 0 offen offset:0
    buffer_load_dwordx4 v[120:123], v11, s[32:35], 0 offen offset:256
    ds_read_b128 v[160:163], v148 offset:21504
    ds_read_b128 v[164:167], v148 offset:21760
    s_waitcnt lgkmcnt(2)
    v_dot2c_f32_bf16 v157, v232, v168
    v_dot2c_f32_bf16 v157, v233, v169
    v_dot2c_f32_bf16 v157, v234, v170
    v_dot2c_f32_bf16 v157, v235, v171
    v_dot2c_f32_bf16 v157, v236, v172
    v_dot2c_f32_bf16 v157, v237, v173
    v_dot2c_f32_bf16 v157, v238, v174
    v_dot2c_f32_bf16 v157, v239, v175
    v_add_u32_dpp v11, v32, v7 row_newbcast:9 row_mask:0xf bank_mask:0xf
    buffer_load_dwordx4 v[116:119], v11, s[32:35], 0 offen offset:0
    buffer_load_dwordx4 v[124:127], v11, s[32:35], 0 offen offset:256
    ds_read_b128 v[168:171], v149 offset:21504
    ds_read_b128 v[172:175], v149 offset:21760
    s_waitcnt lgkmcnt(2)
    v_dot2c_f32_bf16 v158, v240, v160
    v_dot2c_f32_bf16 v158, v241, v161
    v_dot2c_f32_bf16 v158, v242, v162
    v_dot2c_f32_bf16 v158, v243, v163
    v_dot2c_f32_bf16 v158, v244, v164
    v_dot2c_f32_bf16 v158, v245, v165
    v_dot2c_f32_bf16 v158, v246, v166
    v_dot2c_f32_bf16 v158, v247, v167
    v_add_f32_dpp v156, v156, v156 row_ror:8 row_mask:0xf bank_mask:0x3
    v_add_f32_dpp v156, v157, v157 row_ror:8 row_mask:0xf bank_mask:0xc
    v_add_u32_dpp v11, v32, v7 row_newbcast:10 row_mask:0xf bank_mask:0xf
    buffer_load_dwordx4 v[128:131], v11, s[32:35], 0 offen offset:0
    buffer_load_dwordx4 v[136:139], v11, s[32:35], 0 offen offset:256
    s_waitcnt lgkmcnt(0)
    v_dot2c_f32_bf16 v159, v248, v168
    v_dot2c_f32_bf16 v159, v249, v169
    v_dot2c_f32_bf16 v159, v250, v170
    v_dot2c_f32_bf16 v159, v251, v171
    v_dot2c_f32_bf16 v159, v252, v172
    v_dot2c_f32_bf16 v159, v253, v173
    v_dot2c_f32_bf16 v159, v254, v174
    v_dot2c_f32_bf16 v159, v255, v175
    v_add_f32_dpp v154, v154, v154 row_half_mirror row_mask:0xf bank_mask:0x5
    v_add_f32_dpp v154, v156, v156 row_half_mirror row_mask:0xf bank_mask:0xa
    v_add_u32_dpp v11, v32, v7 row_newbcast:11 row_mask:0xf bank_mask:0xf
    buffer_load_dwordx4 v[132:135], v11, s[32:35], 0 offen offset:0
    buffer_load_dwordx4 v[140:143], v11, s[32:35], 0 offen offset:256
    v_add_f32_dpp v150, v150, v150 quad_perm:[1,0,3,2] row_mask:0xf bank_mask:0xf
    s_nop 0
    v_add_f32_dpp v158, v158, v158 row_ror:8 row_mask:0xf bank_mask:0x3
    v_add_f32_dpp v158, v159, v159 row_ror:8 row_mask:0xf bank_mask:0xc
    v_add_f32_dpp v154, v154, v154 quad_perm:[1,0,3,2] row_mask:0xf bank_mask:0xf
    v_add_f32_dpp v150, v150, v150 quad_perm:[2,3,0,1] row_mask:0xf bank_mask:0xf
    v_add_f32_dpp v158, v158, v158 row_half_mirror row_mask:0xf bank_mask:0x5
    v_add_f32_dpp v154, v154, v154 quad_perm:[2,3,0,1] row_mask:0xf bank_mask:0xf
    s_nop 0
    v_add_f32_dpp v158, v158, v158 quad_perm:[1,0,3,2] row_mask:0xf bank_mask:0xf
    v_cndmask_b32 v150, v150, v154, s[66:67]
    s_nop 0
    v_add_f32_dpp v158, v158, v158 quad_perm:[2,3,0,1] row_mask:0xf bank_mask:0xf
    v_cndmask_b32 v150, v150, v158, s[68:69]
    v_mul_f32 v150, 0x3db8aa3b, v150
    v_exp_f32 v150, v150
    s_nop 0
    v_mov_b32 v44, v150
    v_mov_b32 v45, v150
    s_nop 1
    v_permlane32_swap_b32 v44, v45
    v_add_f32 v44, v44, v45
    v_mov_b32 v45, v44
    s_nop 1
    v_permlane16_swap_b32 v44, v45
    v_add_f32 v44, v44, v45
    v_add_f32 v44, 0x3089705f, v44
    v_rcp_f32 v44, v44
    s_nop 0
    v_mul_f32 v150, v150, v44
    v_cvt_pk_bf16_f32 v150, v150, 0
    v_lshlrev_b32 v8, v9, v150
    s_nop 1
    v_and_b32_dpp v24, v8, v12 row_newbcast:0 row_mask:0xf bank_mask:0xf
    v_and_b32_dpp v25, v8, v13 row_newbcast:0 row_mask:0xf bank_mask:0xf
    v_mov_b64 v[40:41], 0
    v_mov_b64 v[42:43], 0
    v_mov_b64 v[44:45], 0
    v_mov_b64 v[46:47], 0
    v_smfmac_f32_16x16x32_bf16 v[40:43], v[24:25], v[176:179], v14
    v_and_b32_dpp v28, v8, v12 row_newbcast:8 row_mask:0xf bank_mask:0xf
    v_and_b32_dpp v29, v8, v13 row_newbcast:8 row_mask:0xf bank_mask:0xf
    v_smfmac_f32_16x16x32_bf16 v[44:47], v[24:25], v[180:183], v14
    v_add_u32_dpp v11, v32, v7 row_newbcast:12 row_mask:0xf bank_mask:0xf
    buffer_load_dwordx4 v[144:147], v11, s[32:35], 0 offen offset:0
    buffer_load_dwordx4 v[152:155], v11, s[32:35], 0 offen offset:256
    v_smfmac_f32_16x16x32_bf16 v[40:43], v[28:29], v[184:187], v14
    v_and_b32_dpp v24, v8, v12 row_newbcast:4 row_mask:0xf bank_mask:0xf
    v_and_b32_dpp v25, v8, v13 row_newbcast:4 row_mask:0xf bank_mask:0xf
    v_smfmac_f32_16x16x32_bf16 v[44:47], v[28:29], v[188:191], v14
    s_nop 0
    v_smfmac_f32_16x16x32_bf16 v[16:19], v[24:25], v[192:195], v14
    v_and_b32_dpp v28, v8, v12 row_newbcast:12 row_mask:0xf bank_mask:0xf
    v_and_b32_dpp v29, v8, v13 row_newbcast:12 row_mask:0xf bank_mask:0xf
    v_smfmac_f32_16x16x32_bf16 v[20:23], v[24:25], v[196:199], v14
    v_add_u32_dpp v11, v32, v7 row_newbcast:13 row_mask:0xf bank_mask:0xf
    buffer_load_dwordx4 v[148:151], v11, s[32:35], 0 offen offset:0
    buffer_load_dwordx4 v[156:159], v11, s[32:35], 0 offen offset:256
    v_smfmac_f32_16x16x32_bf16 v[16:19], v[28:29], v[200:203], v14
    v_and_b32_dpp v24, v8, v12 row_newbcast:1 row_mask:0xf bank_mask:0xf
    v_and_b32_dpp v25, v8, v13 row_newbcast:1 row_mask:0xf bank_mask:0xf
    v_smfmac_f32_16x16x32_bf16 v[20:23], v[28:29], v[204:207], v14
    v_xor_b32 v178, s15, v2
    s_lshl_b32 s64, s20, 2
    v_add_u32 v9, s64, v0
    v_mov_b32 v179, 0
    v_cvt_pk_bf16_f32 v30, v40, v41
    v_cvt_pk_bf16_f32 v31, v42, v43
    ds_write_b64 v178, v[30:31] offset:1024
    v_cvt_pk_bf16_f32 v30, v44, v45
    v_cvt_pk_bf16_f32 v31, v46, v47
    ds_write_b64 v178, v[30:31] offset:1280
    ds_read_u16_d16_hi v179, v9
    v_mov_b64 v[40:41], 0
    v_mov_b64 v[42:43], 0
    v_mov_b64 v[44:45], 0
    v_mov_b64 v[46:47], 0
    s_nop 0
    v_smfmac_f32_16x16x32_bf16 v[40:43], v[24:25], v[208:211], v14
    v_and_b32_dpp v28, v8, v12 row_newbcast:9 row_mask:0xf bank_mask:0xf
    v_and_b32_dpp v29, v8, v13 row_newbcast:9 row_mask:0xf bank_mask:0xf
    v_smfmac_f32_16x16x32_bf16 v[44:47], v[24:25], v[212:215], v14
    v_add_u32_dpp v11, v32, v7 row_newbcast:14 row_mask:0xf bank_mask:0xf
    buffer_load_dwordx4 v[160:163], v11, s[32:35], 0 offen offset:0
    buffer_load_dwordx4 v[168:171], v11, s[32:35], 0 offen offset:256
    v_smfmac_f32_16x16x32_bf16 v[40:43], v[28:29], v[216:219], v14
    v_and_b32_dpp v24, v8, v12 row_newbcast:5 row_mask:0xf bank_mask:0xf
    v_and_b32_dpp v25, v8, v13 row_newbcast:5 row_mask:0xf bank_mask:0xf
    v_smfmac_f32_16x16x32_bf16 v[44:47], v[28:29], v[220:223], v14
    v_xor_b32 v180, s16, v2
    s_lshl_b32 s64, s21, 2
    v_add_u32 v9, s64, v0
    v_mov_b32 v181, 0
    v_cvt_pk_bf16_f32 v30, v16, v17
    v_cvt_pk_bf16_f32 v31, v18, v19
    ds_write_b64 v180, v[30:31] offset:1024
    v_cvt_pk_bf16_f32 v30, v20, v21
    v_cvt_pk_bf16_f32 v31, v22, v23
    ds_write_b64 v180, v[30:31] offset:1280
    ds_read_u16_d16_hi v181, v9
    v_mov_b64 v[16:17], 0
    v_mov_b64 v[18:19], 0
    v_mov_b64 v[20:21], 0
    v_mov_b64 v[22:23], 0
    s_nop 0
    v_smfmac_f32_16x16x32_bf16 v[16:19], v[24:25], v[224:227], v14
    v_and_b32_dpp v28, v8, v12 row_newbcast:13 row_mask:0xf bank_mask:0xf
    v_and_b32_dpp v29, v8, v13 row_newbcast:13 row_mask:0xf bank_mask:0xf
    v_smfmac_f32_16x16x32_bf16 v[20:23], v[24:25], v[228:231], v14
    v_add_u32_dpp v11, v32, v7 row_newbcast:15 row_mask:0xf bank_mask:0xf
    buffer_load_dwordx4 v[164:167], v11, s[32:35], 0 offen offset:0
    buffer_load_dwordx4 v[172:175], v11, s[32:35], 0 offen offset:256
    v_smfmac_f32_16x16x32_bf16 v[16:19], v[28:29], v[232:235], v14
    v_and_b32_dpp v24, v8, v12 row_newbcast:2 row_mask:0xf bank_mask:0xf
    v_and_b32_dpp v25, v8, v13 row_newbcast:2 row_mask:0xf bank_mask:0xf
    v_smfmac_f32_16x16x32_bf16 v[20:23], v[28:29], v[236:239], v14
    v_xor_b32 v182, s17, v2
    s_lshl_b32 s64, s22, 2
    v_add_u32 v9, s64, v0
    v_mov_b32 v183, 0
    v_cvt_pk_bf16_f32 v30, v40, v41
    v_cvt_pk_bf16_f32 v31, v42, v43
    ds_write_b64 v182, v[30:31] offset:1024
    v_cvt_pk_bf16_f32 v30, v44, v45
    v_cvt_pk_bf16_f32 v31, v46, v47
    ds_write_b64 v182, v[30:31] offset:1280
    ds_read_u16_d16_hi v183, v9
    v_mov_b64 v[40:41], 0
    v_mov_b64 v[42:43], 0
    v_mov_b64 v[44:45], 0
    v_mov_b64 v[46:47], 0
    s_nop 0
    v_smfmac_f32_16x16x32_bf16 v[40:43], v[24:25], v[240:243], v14
    v_and_b32_dpp v28, v8, v12 row_newbcast:10 row_mask:0xf bank_mask:0xf
    v_and_b32_dpp v29, v8, v13 row_newbcast:10 row_mask:0xf bank_mask:0xf
    v_smfmac_f32_16x16x32_bf16 v[44:47], v[24:25], v[244:247], v14
    s_nop 0
    v_smfmac_f32_16x16x32_bf16 v[40:43], v[28:29], v[248:251], v14
    v_and_b32_dpp v24, v33, v12 row_newbcast:0 row_mask:0xf bank_mask:0xf
    v_and_b32_dpp v25, v33, v13 row_newbcast:0 row_mask:0xf bank_mask:0xf
    v_and_b32_dpp v26, v33, v12 row_newbcast:1 row_mask:0xf bank_mask:0xf
    v_and_b32_dpp v27, v33, v13 row_newbcast:1 row_mask:0xf bank_mask:0xf
    v_smfmac_f32_16x16x32_bf16 v[44:47], v[28:29], v[252:255], v14
    v_xor_b32 v184, s18, v2
    s_lshl_b32 s64, s23, 2
    v_add_u32 v9, s64, v0
    v_mov_b32 v185, 0
    v_cvt_pk_bf16_f32 v30, v16, v17
    v_cvt_pk_bf16_f32 v31, v18, v19
    ds_write_b64 v184, v[30:31] offset:1024
    v_cvt_pk_bf16_f32 v30, v20, v21
    v_cvt_pk_bf16_f32 v31, v22, v23
    ds_write_b64 v184, v[30:31] offset:1280
    ds_read_u16_d16_hi v185, v9
    v_mov_b64 v[16:17], 0
    v_mov_b64 v[18:19], 0
    v_mov_b64 v[20:21], 0
    v_mov_b64 v[22:23], 0
    s_nop 0
    v_xor_b32 v176, s19, v2
    s_lshl_b32 s64, s24, 2
    v_add_u32 v9, s64, v0
    v_mov_b32 v177, 0
    v_cvt_pk_bf16_f32 v30, v40, v41
    v_cvt_pk_bf16_f32 v31, v42, v43
    ds_write_b64 v176, v[30:31] offset:1024
    v_cvt_pk_bf16_f32 v30, v44, v45
    v_cvt_pk_bf16_f32 v31, v46, v47
    ds_write_b64 v176, v[30:31] offset:1280
    ds_read_u16_d16_hi v177, v9
    s_waitcnt lgkmcnt(0)
    s_barrier
    s_cmp_lg_u32 s25, 0
    s_cbranch_scc1 L_slow
L_fp0:
    s_bitcmp1_b32 s52, 0
    s_waitcnt vmcnt(28)
    v_smfmac_f32_16x16x64_bf16 v[16:19], v[24:27], v[48:55], v14
    v_and_b32_dpp v28, v33, v12 row_newbcast:2 row_mask:0xf bank_mask:0xf
    v_and_b32_dpp v29, v33, v13 row_newbcast:2 row_mask:0xf bank_mask:0xf
    v_smfmac_f32_16x16x64_bf16 v[20:23], v[24:27], v[56:63], v14
    v_and_b32_dpp v30, v33, v12 row_newbcast:3 row_mask:0xf bank_mask:0xf
    v_and_b32_dpp v31, v33, v13 row_newbcast:3 row_mask:0xf bank_mask:0xf
    v_add_u32_dpp v11, v34, v7 row_newbcast:0 row_mask:0xf bank_mask:0xf
    buffer_load_dwordx4 v[48:51], v11, s[32:35], 0 offen offset:0
    buffer_load_dwordx4 v[56:59], v11, s[32:35], 0 offen offset:256
    s_cbranch_scc1 L_ev0
L_fp1:
    s_bitcmp1_b32 s52, 1
    s_waitcnt vmcnt(26)
    v_smfmac_f32_16x16x64_bf16 v[16:19], v[28:31], v[64:71], v14
    v_and_b32_dpp v24, v33, v12 row_newbcast:4 row_mask:0xf bank_mask:0xf
    v_and_b32_dpp v25, v33, v13 row_newbcast:4 row_mask:0xf bank_mask:0xf
    v_smfmac_f32_16x16x64_bf16 v[20:23], v[28:31], v[72:79], v14
    v_and_b32_dpp v26, v33, v12 row_newbcast:5 row_mask:0xf bank_mask:0xf
    v_and_b32_dpp v27, v33, v13 row_newbcast:5 row_mask:0xf bank_mask:0xf
    v_add_u32_dpp v11, v34, v7 row_newbcast:1 row_mask:0xf bank_mask:0xf
    buffer_load_dwordx4 v[52:55], v11, s[32:35], 0 offen offset:0
    buffer_load_dwordx4 v[60:63], v11, s[32:35], 0 offen offset:256
    s_cbranch_scc1 L_ev1
L_fp2:
    s_bitcmp1_b32 s52, 2
    s_waitcnt vmcnt(24)
    v_smfmac_f32_16x16x64_bf16 v[16:19], v[24:27], v[80:87], v14
    v_and_b32_dpp v28, v33, v12 row_newbcast:6 row_mask:0xf bank_mask:0xf
    v_and_b32_dpp v29, v33, v13 row_newbcast:6 row_mask:0xf bank_mask:0xf
    v_smfmac_f32_16x16x64_bf16 v[20:23], v[24:27], v[88:95], v14
    v_and_b32_dpp v30, v33, v12 row_newbcast:7 row_mask:0xf bank_mask:0xf
    v_and_b32_dpp v31, v33, v13 row_newbcast:7 row_mask:0xf bank_mask:0xf
    v_add_u32_dpp v11, v34, v7 row_newbcast:2 row_mask:0xf bank_mask:0xf
    buffer_load_dwordx4 v[64:67], v11, s[32:35], 0 offen offset:0
    buffer_load_dwordx4 v[72:75], v11, s[32:35], 0 offen offset:256
    s_cbranch_scc1 L_ev2
L_fp3:
    s_bitcmp1_b32 s52, 3
    s_waitcnt vmcnt(22)
    v_smfmac_f32_16x16x64_bf16 v[16:19], v[28:31], v[96:103], v14
    v_and_b32_dpp v24, v33, v12 row_newbcast:8 row_mask:0xf bank_mask:0xf
    v_and_b32_dpp v25, v33, v13 row_newbcast:8 row_mask:0xf bank_mask:0xf
    v_smfmac_f32_16x16x64_bf16 v[20:23], v[28:31], v[104:111], v14
    v_and_b32_dpp v26, v33, v12 row_newbcast:9 row_mask:0xf bank_mask:0xf
    v_and_b32_dpp v27, v33, v13 row_newbcast:9 row_mask:0xf bank_mask:0xf
    v_add_u32_dpp v11, v34, v7 row_newbcast:3 row_mask:0xf bank_mask:0xf
    buffer_load_dwordx4 v[68:71], v11, s[32:35], 0 offen offset:0
    buffer_load_dwordx4 v[76:79], v11, s[32:35], 0 offen offset:256
    s_cbranch_scc1 L_ev3
L_fp4:
    s_bitcmp1_b32 s52, 4
    s_waitcnt vmcnt(20)
    v_smfmac_f32_16x16x64_bf16 v[16:19], v[24:27], v[112:119], v14
    v_and_b32_dpp v28, v33, v12 row_newbcast:10 row_mask:0xf bank_mask:0xf
    v_and_b32_dpp v29, v33, v13 row_newbcast:10 row_mask:0xf bank_mask:0xf
    v_smfmac_f32_16x16x64_bf16 v[20:23], v[24:27], v[120:127], v14
    v_and_b32_dpp v30, v33, v12 row_newbcast:11 row_mask:0xf bank_mask:0xf
    v_and_b32_dpp v31, v33, v13 row_newbcast:11 row_mask:0xf bank_mask:0xf
    v_add_u32_dpp v11, v34, v7 row_newbcast:4 row_mask:0xf bank_mask:0xf
    buffer_load_dwordx4 v[80:83], v11, s[32:35], 0 offen offset:0
    buffer_load_dwordx4 v[88:91], v11, s[32:35], 0 offen offset:256
    s_cbranch_scc1 L_ev4
L_fp5:
    s_bitcmp1_b32 s52, 5
    s_waitcnt vmcnt(18)
    v_smfmac_f32_16x16x64_bf16 v[16:19], v[28:31], v[128:135], v14
    v_and_b32_dpp v24, v33, v12 row_newbcast:12 row_mask:0xf bank_mask:0xf
    v_and_b32_dpp v25, v33, v13 row_newbcast:12 row_mask:0xf bank_mask:0xf
    v_smfmac_f32_16x16x64_bf16 v[20:23], v[28:31], v[136:143], v14
    v_and_b32_dpp v26, v33, v12 row_newbcast:13 row_mask:0xf bank_mask:0xf
    v_and_b32_dpp v27, v33, v13 row_newbcast:13 row_mask:0xf bank_mask:0xf
    v_add_u32_dpp v11, v34, v7 row_newbcast:5 row_mask:0xf bank_mask:0xf
    buffer_load_dwordx4 v[84:87], v11, s[32:35], 0 offen offset:0
    buffer_load_dwordx4 v[92:95], v11, s[32:35], 0 offen offset:256
    s_cbranch_scc1 L_ev5
L_fp6:
    s_bitcmp1_b32 s52, 6
    s_waitcnt vmcnt(16)
    v_smfmac_f32_16x16x64_bf16 v[16:19], v[24:27], v[144:151], v14
    v_and_b32_dpp v28, v33, v12 row_newbcast:14 row_mask:0xf bank_mask:0xf
    v_and_b32_dpp v29, v33, v13 row_newbcast:14 row_mask:0xf bank_mask:0xf
    v_smfmac_f32_16x16x64_bf16 v[20:23], v[24:27], v[152:159], v14
    v_and_b32_dpp v30, v33, v12 row_newbcast:15 row_mask:0xf bank_mask:0xf
    v_and_b32_dpp v31, v33, v13 row_newbcast:15 row_mask:0xf bank_mask:0xf
    v_add_u32_dpp v11, v34, v7 row_newbcast:6 row_mask:0xf bank_mask:0xf
    buffer_load_dwordx4 v[96:99], v11, s[32:35], 0 offen offset:0
    buffer_load_dwordx4 v[104:107], v11, s[32:35], 0 offen offset:256
    s_cbranch_scc1 L_ev6
L_fp7:
    s_bitcmp1_b32 s52, 7
    s_waitcnt vmcnt(14)
    v_smfmac_f32_16x16x64_bf16 v[16:19], v[28:31], v[160:167], v14
    v_and_b32_dpp v24, v35, v12 row_newbcast:0 row_mask:0xf bank_mask:0xf
    v_and_b32_dpp v25, v35, v13 row_newbcast:0 row_mask:0xf bank_mask:0xf
    v_smfmac_f32_16x16x64_bf16 v[20:23], v[28:31], v[168:175], v14
    v_and_b32_dpp v26, v35, v12 row_newbcast:1 row_mask:0xf bank_mask:0xf
    v_and_b32_dpp v27, v35, v13 row_newbcast:1 row_mask:0xf bank_mask:0xf
    v_add_u32_dpp v11, v34, v7 row_newbcast:7 row_mask:0xf bank_mask:0xf
    buffer_load_dwordx4 v[100:103], v11, s[32:35], 0 offen offset:0
    buffer_load_dwordx4 v[108:111], v11, s[32:35], 0 offen offset:256
    s_cbranch_scc1 L_ev7
L_fp8:
    v_mov_b64 v[32:33], v[34:35]
    v_mov_b64 v[34:35], v[36:37]
    v_mov_b64 v[36:37], v[38:39]
    s_lshr_b32 s52, s52, 8
    s_lshr_b32 s53, s53, 8
    s_lshr_b32 s56, s56, 8
    s_mov_b32 s62, L_st1-L_anc
    s_mov_b32 s63, L_st1-L_st0
L_st0:
    s_bitcmp1_b32 s52, 0
    s_waitcnt vmcnt(12)
    v_smfmac_f32_16x16x64_bf16 v[16:19], v[24:27], v[48:55], v14
    v_and_b32_dpp v28, v33, v12 row_newbcast:2 row_mask:0xf bank_mask:0xf
    v_and_b32_dpp v29, v33, v13 row_newbcast:2 row_mask:0xf bank_mask:0xf
    v_smfmac_f32_16x16x64_bf16 v[20:23], v[24:27], v[56:63], v14
    v_and_b32_dpp v30, v33, v12 row_newbcast:3 row_mask:0xf bank_mask:0xf
    v_and_b32_dpp v31, v33, v13 row_newbcast:3 row_mask:0xf bank_mask:0xf
    v_add_u32_dpp v11, v32, v7 row_newbcast:8 row_mask:0xf bank_mask:0xf
    buffer_load_dwordx4 v[112:115], v11, s[32:35], 0 offen offset:0
    buffer_load_dwordx4 v[120:123], v11, s[32:35], 0 offen offset:256
    v_add_u32_dpp v11, v32, v7 row_newbcast:9 row_mask:0xf bank_mask:0xf
    buffer_load_dwordx4 v[116:119], v11, s[32:35], 0 offen offset:0
    buffer_load_dwordx4 v[124:127], v11, s[32:35], 0 offen offset:256
    s_cbranch_scc1 L_ev0
L_st1:
    s_bitcmp1_b32 s52, 1
    s_waitcnt vmcnt(12)
    v_smfmac_f32_16x16x64_bf16 v[16:19], v[28:31], v[64:71], v14
    v_and_b32_dpp v24, v33, v12 row_newbcast:4 row_mask:0xf bank_mask:0xf
    v_and_b32_dpp v25, v33, v13 row_newbcast:4 row_mask:0xf bank_mask:0xf
    v_smfmac_f32_16x16x64_bf16 v[20:23], v[28:31], v[72:79], v14
    v_and_b32_dpp v26, v33, v12 row_newbcast:5 row_mask:0xf bank_mask:0xf
    v_and_b32_dpp v27, v33, v13 row_newbcast:5 row_mask:0xf bank_mask:0xf
    v_add_u32_dpp v11, v32, v7 row_newbcast:10 row_mask:0xf bank_mask:0xf
    buffer_load_dwordx4 v[128:131], v11, s[32:35], 0 offen offset:0
    buffer_load_dwordx4 v[136:139], v11, s[32:35], 0 offen offset:256
    v_add_u32_dpp v11, v32, v7 row_newbcast:11 row_mask:0xf bank_mask:0xf
    buffer_load_dwordx4 v[132:135], v11, s[32:35], 0 offen offset:0
    buffer_load_dwordx4 v[140:143], v11, s[32:35], 0 offen offset:256
    s_cbranch_scc1 L_ev1
L_st2:
    s_bitcmp1_b32 s52, 2
    s_waitcnt vmcnt(12)
    v_smfmac_f32_16x16x64_bf16 v[16:19], v[24:27], v[80:87], v14
    v_and_b32_dpp v28, v33, v12 row_newbcast:6 row_mask:0xf bank_mask:0xf
    v_and_b32_dpp v29, v33, v13 row_newbcast:6 row_mask:0xf bank_mask:0xf
    v_smfmac_f32_16x16x64_bf16 v[20:23], v[24:27], v[88:95], v14
    v_and_b32_dpp v30, v33, v12 row_newbcast:7 row_mask:0xf bank_mask:0xf
    v_and_b32_dpp v31, v33, v13 row_newbcast:7 row_mask:0xf bank_mask:0xf
    v_add_u32_dpp v11, v32, v7 row_newbcast:12 row_mask:0xf bank_mask:0xf
    buffer_load_dwordx4 v[144:147], v11, s[32:35], 0 offen offset:0
    buffer_load_dwordx4 v[152:155], v11, s[32:35], 0 offen offset:256
    v_add_u32_dpp v11, v32, v7 row_newbcast:13 row_mask:0xf bank_mask:0xf
    buffer_load_dwordx4 v[148:151], v11, s[32:35], 0 offen offset:0
    buffer_load_dwordx4 v[156:159], v11, s[32:35], 0 offen offset:256
    s_cbranch_scc1 L_ev2
L_st3:
    s_bitcmp1_b32 s52, 3
    s_waitcnt vmcnt(12)
    v_smfmac_f32_16x16x64_bf16 v[16:19], v[28:31], v[96:103], v14
    v_and_b32_dpp v24, v33, v12 row_newbcast:8 row_mask:0xf bank_mask:0xf
    v_and_b32_dpp v25, v33, v13 row_newbcast:8 row_mask:0xf bank_mask:0xf
    v_smfmac_f32_16x16x64_bf16 v[20:23], v[28:31], v[104:111], v14
    v_and_b32_dpp v26, v33, v12 row_newbcast:9 row_mask:0xf bank_mask:0xf
    v_and_b32_dpp v27, v33, v13 row_newbcast:9 row_mask:0xf bank_mask:0xf
    v_add_u32_dpp v11, v32, v7 row_newbcast:14 row_mask:0xf bank_mask:0xf
    buffer_load_dwordx4 v[160:163], v11, s[32:35], 0 offen offset:0
    buffer_load_dwordx4 v[168:171], v11, s[32:35], 0 offen offset:256
    v_add_u32_dpp v11, v32, v7 row_newbcast:15 row_mask:0xf bank_mask:0xf
    buffer_load_dwordx4 v[164:167], v11, s[32:35], 0 offen offset:0
    buffer_load_dwordx4 v[172:175], v11, s[32:35], 0 offen offset:256
    s_cbranch_scc1 L_ev3
L_st4:
    s_bitcmp1_b32 s52, 4
    s_waitcnt vmcnt(12)
    v_smfmac_f32_16x16x64_bf16 v[16:19], v[24:27], v[112:119], v14
    v_and_b32_dpp v28, v33, v12 row_newbcast:10 row_mask:0xf bank_mask:0xf
    v_and_b32_dpp v29, v33, v13 row_newbcast:10 row_mask:0xf bank_mask:0xf
    v_smfmac_f32_16x16x64_bf16 v[20:23], v[24:27], v[120:127], v14
    v_and_b32_dpp v30, v33, v12 row_newbcast:11 row_mask:0xf bank_mask:0xf
    v_and_b32_dpp v31, v33, v13 row_newbcast:11 row_mask:0xf bank_mask:0xf
    v_add_u32_dpp v11, v34, v7 row_newbcast:0 row_mask:0xf bank_mask:0xf
    buffer_load_dwordx4 v[48:51], v11, s[32:35], 0 offen offset:0
    buffer_load_dwordx4 v[56:59], v11, s[32:35], 0 offen offset:256
    v_add_u32_dpp v11, v34, v7 row_newbcast:1 row_mask:0xf bank_mask:0xf
    buffer_load_dwordx4 v[52:55], v11, s[32:35], 0 offen offset:0
    buffer_load_dwordx4 v[60:63], v11, s[32:35], 0 offen offset:256
    s_cbranch_scc1 L_ev4
L_st5:
    s_bitcmp1_b32 s52, 5
    s_waitcnt vmcnt(12)
    v_smfmac_f32_16x16x64_bf16 v[16:19], v[28:31], v[128:135], v14
    v_and_b32_dpp v24, v33, v12 row_newbcast:12 row_mask:0xf bank_mask:0xf
    v_and_b32_dpp v25, v33, v13 row_newbcast:12 row_mask:0xf bank_mask:0xf
    v_smfmac_f32_16x16x64_bf16 v[20:23], v[28:31], v[136:143], v14
    v_and_b32_dpp v26, v33, v12 row_newbcast:13 row_mask:0xf bank_mask:0xf
    v_and_b32_dpp v27, v33, v13 row_newbcast:13 row_mask:0xf bank_mask:0xf
    v_add_u32_dpp v11, v34, v7 row_newbcast:2 row_mask:0xf bank_mask:0xf
    buffer_load_dwordx4 v[64:67], v11, s[32:35], 0 offen offset:0
    buffer_load_dwordx4 v[72:75], v11, s[32:35], 0 offen offset:256
    v_add_u32_dpp v11, v34, v7 row_newbcast:3 row_mask:0xf bank_mask:0xf
    buffer_load_dwordx4 v[68:71], v11, s[32:35], 0 offen offset:0
    buffer_load_dwordx4 v[76:79], v11, s[32:35], 0 offen offset:256
    s_cbranch_scc1 L_ev5
L_st6:
    s_bitcmp1_b32 s52, 6
    s_waitcnt vmcnt(12)
    v_smfmac_f32_16x16x64_bf16 v[16:19], v[24:27], v[144:151], v14
    v_and_b32_dpp v28, v33, v12 row_newbcast:14 row_mask:0xf bank_mask:0xf
    v_and_b32_dpp v29, v33, v13 row_newbcast:14 row_mask:0xf bank_mask:0xf
    v_smfmac_f32_16x16x64_bf16 v[20:23], v[24:27], v[152:159], v14
    v_and_b32_dpp v30, v33, v12 row_newbcast:15 row_mask:0xf bank_mask:0xf
    v_and_b32_dpp v31, v33, v13 row_newbcast:15 row_mask:0xf bank_mask:0xf
    v_add_u32_dpp v11, v34, v7 row_newbcast:4 row_mask:0xf bank_mask:0xf
    buffer_load_dwordx4 v[80:83], v11, s[32:35], 0 offen offset:0
    buffer_load_dwordx4 v[88:91], v11, s[32:35], 0 offen offset:256
    v_add_u32_dpp v11, v34, v7 row_newbcast:5 row_mask:0xf bank_mask:0xf
    buffer_load_dwordx4 v[84:87], v11, s[32:35], 0 offen offset:0
    buffer_load_dwordx4 v[92:95], v11, s[32:35], 0 offen offset:256
    s_cbranch_scc1 L_ev6
L_st7:
    s_bitcmp1_b32 s52, 7
    s_waitcnt vmcnt(12)
    v_smfmac_f32_16x16x64_bf16 v[16:19], v[28:31], v[160:167], v14
    v_and_b32_dpp v24, v35, v12 row_newbcast:0 row_mask:0xf bank_mask:0xf
    v_and_b32_dpp v25, v35, v13 row_newbcast:0 row_mask:0xf bank_mask:0xf
    v_smfmac_f32_16x16x64_bf16 v[20:23], v[28:31], v[168:175], v14
    v_and_b32_dpp v26, v35, v12 row_newbcast:1 row_mask:0xf bank_mask:0xf
    v_and_b32_dpp v27, v35, v13 row_newbcast:1 row_mask:0xf bank_mask:0xf
    v_add_u32_dpp v11, v34, v7 row_newbcast:6 row_mask:0xf bank_mask:0xf
    buffer_load_dwordx4 v[96:99], v11, s[32:35], 0 offen offset:0
    buffer_load_dwordx4 v[104:107], v11, s[32:35], 0 offen offset:256
    v_add_u32_dpp v11, v34, v7 row_newbcast:7 row_mask:0xf bank_mask:0xf
    buffer_load_dwordx4 v[100:103], v11, s[32:35], 0 offen offset:0
    buffer_load_dwordx4 v[108:111], v11, s[32:35], 0 offen offset:256
    s_cbranch_scc1 L_ev7
L_st8:
    v_mov_b64 v[32:33], v[34:35]
    v_mov_b64 v[34:35], v[36:37]
    v_mov_b64 v[36:37], v[38:39]
    s_lshr_b32 s52, s52, 8
    s_lshr_b32 s53, s53, 8
    s_lshr_b32 s56, s56, 8
    s_branch L_st0
L_pad8:
    s_setpc_b64 s[68:69]
L_dr0:
    s_bitcmp1_b32 s52, 0
    ds_write_b32 v10, v6 offset:48
    s_waitcnt vmcnt(12)
    v_smfmac_f32_16x16x64_bf16 v[16:19], v[24:27], v[48:55], v14
    v_and_b32_dpp v28, v33, v12 row_newbcast:2 row_mask:0xf bank_mask:0xf
    v_and_b32_dpp v29, v33, v13 row_newbcast:2 row_mask:0xf bank_mask:0xf
    v_smfmac_f32_16x16x64_bf16 v[20:23], v[24:27], v[56:63], v14
    v_and_b32_dpp v30, v33, v12 row_newbcast:3 row_mask:0xf bank_mask:0xf
    v_and_b32_dpp v31, v33, v13 row_newbcast:3 row_mask:0xf bank_mask:0xf
    buffer_load_ubyte v15, off, s[32:35], 0
    buffer_load_ubyte v15, off, s[32:35], 0
    buffer_load_ubyte v15, off, s[32:35], 0
    buffer_load_ubyte v15, off, s[32:35], 0
    s_cbranch_scc1 L_ev0
L_dr1:
    s_bitcmp1_b32 s52, 1
    ds_write_b32 v10, v6 offset:48
    s_waitcnt vmcnt(12)
    v_smfmac_f32_16x16x64_bf16 v[16:19], v[28:31], v[64:71], v14
    v_and_b32_dpp v24, v33, v12 row_newbcast:4 row_mask:0xf bank_mask:0xf
    v_and_b32_dpp v25, v33, v13 row_newbcast:4 row_mask:0xf bank_mask:0xf
    v_smfmac_f32_16x16x64_bf16 v[20:23], v[28:31], v[72:79], v14
    v_and_b32_dpp v26, v33, v12 row_newbcast:5 row_mask:0xf bank_mask:0xf
    v_and_b32_dpp v27, v33, v13 row_newbcast:5 row_mask:0xf bank_mask:0xf
    buffer_load_ubyte v15, off, s[32:35], 0
    buffer_load_ubyte v15, off, s[32:35], 0
    buffer_load_ubyte v15, off, s[32:35], 0
    buffer_load_ubyte v15, off, s[32:35], 0
    s_cbranch_scc1 L_ev1
L_dr2:
    s_bitcmp1_b32 s52, 2
    ds_write_b32 v10, v6 offset:48
    s_waitcnt vmcnt(12)
    v_smfmac_f32_16x16x64_bf16 v[16:19], v[24:27], v[80:87], v14
    v_and_b32_dpp v28, v33, v12 row_newbcast:6 row_mask:0xf bank_mask:0xf
    v_and_b32_dpp v29, v33, v13 row_newbcast:6 row_mask:0xf bank_mask:0xf
    v_smfmac_f32_16x16x64_bf16 v[20:23], v[24:27], v[88:95], v14
    v_and_b32_dpp v30, v33, v12 row_newbcast:7 row_mask:0xf bank_mask:0xf
    v_and_b32_dpp v31, v33, v13 row_newbcast:7 row_mask:0xf bank_mask:0xf
    buffer_load_ubyte v15, off, s[32:35], 0
    buffer_load_ubyte v15, off, s[32:35], 0
    buffer_load_ubyte v15, off, s[32:35], 0
    buffer_load_ubyte v15, off, s[32:35], 0
    s_cbranch_scc1 L_ev2
L_dr3:
    s_bitcmp1_b32 s52, 3
    ds_write_b32 v10, v6 offset:48
    s_waitcnt vmcnt(12)
    v_smfmac_f32_16x16x64_bf16 v[16:19], v[28:31], v[96:103], v14
    v_and_b32_dpp v24, v33, v12 row_newbcast:8 row_mask:0xf bank_mask:0xf
    v_and_b32_dpp v25, v33, v13 row_newbcast:8 row_mask:0xf bank_mask:0xf
    v_smfmac_f32_16x16x64_bf16 v[20:23], v[28:31], v[104:111], v14
    v_and_b32_dpp v26, v33, v12 row_newbcast:9 row_mask:0xf bank_mask:0xf
    v_and_b32_dpp v27, v33, v13 row_newbcast:9 row_mask:0xf bank_mask:0xf
    buffer_load_ubyte v15, off, s[32:35], 0
    buffer_load_ubyte v15, off, s[32:35], 0
    buffer_load_ubyte v15, off, s[32:35], 0
    buffer_load_ubyte v15, off, s[32:35], 0
    s_cbranch_scc1 L_ev3
L_dr4:
    s_bitcmp1_b32 s52, 4
    ds_write_b32 v10, v6 offset:48
    s_waitcnt vmcnt(12)
    v_smfmac_f32_16x16x64_bf16 v[16:19], v[24:27], v[112:119], v14
    v_and_b32_dpp v28, v33, v12 row_newbcast:10 row_mask:0xf bank_mask:0xf
    v_and_b32_dpp v29, v33, v13 row_newbcast:10 row_mask:0xf bank_mask:0xf
    v_smfmac_f32_16x16x64_bf16 v[20:23], v[24:27], v[120:127], v14
    v_and_b32_dpp v30, v33, v12 row_newbcast:11 row_mask:0xf bank_mask:0xf
    v_and_b32_dpp v31, v33, v13 row_newbcast:11 row_mask:0xf bank_mask:0xf
    buffer_load_ubyte v15, off, s[32:35], 0
    buffer_load_ubyte v15, off, s[32:35], 0
    buffer_load_ubyte v15, off, s[32:35], 0
    buffer_load_ubyte v15, off, s[32:35], 0
    s_cbranch_scc1 L_ev4
L_dr5:
    s_bitcmp1_b32 s52, 5
    ds_write_b32 v10, v6 offset:48
    s_waitcnt vmcnt(12)
    v_smfmac_f32_16x16x64_bf16 v[16:19], v[28:31], v[128:135], v14
    v_and_b32_dpp v24, v33, v12 row_newbcast:12 row_mask:0xf bank_mask:0xf
    v_and_b32_dpp v25, v33, v13 row_newbcast:12 row_mask:0xf bank_mask:0xf
    v_smfmac_f32_16x16x64_bf16 v[20:23], v[28:31], v[136:143], v14
    v_and_b32_dpp v26, v33, v12 row_newbcast:13 row_mask:0xf bank_mask:0xf
    v_and_b32_dpp v27, v33, v13 row_newbcast:13 row_mask:0xf bank_mask:0xf
    buffer_load_ubyte v15, off, s[32:35], 0
    buffer_load_ubyte v15, off, s[32:35], 0
    buffer_load_ubyte v15, off, s[32:35], 0
    buffer_load_ubyte v15, off, s[32:35], 0
    s_cbranch_scc1 L_ev5
L_dr6:
    s_bitcmp1_b32 s52, 6
    ds_write_b32 v10, v6 offset:48
    s_waitcnt vmcnt(12)
    v_smfmac_f32_16x16x64_bf16 v[16:19], v[24:27], v[144:151], v14
    v_and_b32_dpp v28, v33, v12 row_newbcast:14 row_mask:0xf bank_mask:0xf
    v_and_b32_dpp v29, v33, v13 row_newbcast:14 row_mask:0xf bank_mask:0xf
    v_smfmac_f32_16x16x64_bf16 v[20:23], v[24:27], v[152:159], v14
    v_and_b32_dpp v30, v33, v12 row_newbcast:15 row_mask:0xf bank_mask:0xf
    v_and_b32_dpp v31, v33, v13 row_newbcast:15 row_mask:0xf bank_mask:0xf
    buffer_load_ubyte v15, off, s[32:35], 0
    buffer_load_ubyte v15, off, s[32:35], 0
    buffer_load_ubyte v15, off, s[32:35], 0
    buffer_load_ubyte v15, off, s[32:35], 0
    s_cbranch_scc1 L_ev6
L_dr7:
    s_bitcmp1_b32 s52, 7
    ds_write_b32 v10, v6 offset:48
    s_waitcnt vmcnt(12)
    v_smfmac_f32_16x16x64_bf16 v[16:19], v[28:31], v[160:167], v14
    v_and_b32_dpp v24, v35, v12 row_newbcast:0 row_mask:0xf bank_mask:0xf
    v_and_b32_dpp v25, v35, v13 row_newbcast:0 row_mask:0xf bank_mask:0xf
    v_smfmac_f32_16x16x64_bf16 v[20:23], v[28:31], v[168:175], v14
    v_and_b32_dpp v26, v35, v12 row_newbcast:1 row_mask:0xf bank_mask:0xf
    v_and_b32_dpp v27, v35, v13 row_newbcast:1 row_mask:0xf bank_mask:0xf
    buffer_load_ubyte v15, off, s[32:35], 0
    buffer_load_ubyte v15, off, s[32:35], 0
    buffer_load_ubyte v15, off, s[32:35], 0
    buffer_load_ubyte v15, off, s[32:35], 0
    s_cbranch_scc1 L_ev7
L_dr8:
    v_mov_b64 v[32:33], v[34:35]
    v_mov_b64 v[34:35], v[36:37]
    v_mov_b64 v[36:37], v[38:39]
    s_lshr_b32 s52, s52, 8
    s_lshr_b32 s53, s53, 8
    s_lshr_b32 s56, s56, 8
    s_branch L_dr0
L_pad0:
    s_setpc_b64 s[68:69]
L_ev0:
    s_and_b32 s65, s57, 15
    v_cmp_ge_u32 s[66:67], s65, v4
    v_cmp_gt_u32 s[68:69], s65, v4
    s_bitcmp1_b32 s56, 0
    s_cselect_b64 s[62:63], s[70:71], s[62:63]
    v_cndmask_b32 v40, 0, v28, s[66:67]
    v_cndmask_b32 v41, 0, v29, s[66:67]
    v_cndmask_b32 v42, 0, v30, s[68:69]
    v_cndmask_b32 v43, 0, v31, s[68:69]
    s_mul_i32 s64, s63, 0
    s_bitcmp1_b32 s53, 0
    s_cbranch_scc0 L_evret
    s_waitcnt vmcnt(12)
    v_smfmac_f32_16x16x64_bf16 v[16:19], v[40:43], v[64:71], v14
    v_xor_b32 v28, v28, v40
    v_xor_b32 v29, v29, v41
    v_smfmac_f32_16x16x64_bf16 v[20:23], v[40:43], v[72:79], v14
    v_xor_b32 v30, v30, v42
    v_xor_b32 v31, v31, v43
    s_branch L_flush
L_pad1:
    s_setpc_b64 s[68:69]
L_ev1:
    s_and_b32 s65, s57, 15
    v_cmp_ge_u32 s[66:67], s65, v4
    v_cmp_gt_u32 s[68:69], s65, v4
    s_bitcmp1_b32 s56, 1
    s_cselect_b64 s[62:63], s[70:71], s[62:63]
    v_cndmask_b32 v40, 0, v24, s[66:67]
    v_cndmask_b32 v41, 0, v25, s[66:67]
    v_cndmask_b32 v42, 0, v26, s[68:69]
    v_cndmask_b32 v43, 0, v27, s[68:69]
    s_mul_i32 s64, s63, 1
    s_bitcmp1_b32 s53, 1
    s_cbranch_scc0 L_evret
    s_waitcnt vmcnt(12)
    v_smfmac_f32_16x16x64_bf16 v[16:19], v[40:43], v[80:87], v14
    v_xor_b32 v24, v24, v40
    v_xor_b32 v25, v25, v41
    v_smfmac_f32_16x16x64_bf16 v[20:23], v[40:43], v[88:95], v14
    v_xor_b32 v26, v26, v42
    v_xor_b32 v27, v27, v43
    s_branch L_flush
L_pad2:
    s_setpc_b64 s[68:69]
L_ev2:
    s_and_b32 s65, s57, 15
    v_cmp_ge_u32 s[66:67], s65, v4
    v_cmp_gt_u32 s[68:69], s65, v4
    s_bitcmp1_b32 s56, 2
    s_cselect_b64 s[62:63], s[70:71], s[62:63]
    v_cndmask_b32 v40, 0, v28, s[66:67]
    v_cndmask_b32 v41, 0, v29, s[66:67]
    v_cndmask_b32 v42, 0, v30, s[68:69]
    v_cndmask_b32 v43, 0, v31, s[68:69]
    s_mul_i32 s64, s63, 2
    s_bitcmp1_b32 s53, 2
    s_cbranch_scc0 L_evret
    s_waitcnt vmcnt(12)
    v_smfmac_f32_16x16x64_bf16 v[16:19], v[40:43], v[96:103], v14
    v_xor_b32 v28, v28, v40
    v_xor_b32 v29, v29, v41
    v_smfmac_f32_16x16x64_bf16 v[20:23], v[40:43], v[104:111], v14
    v_xor_b32 v30, v30, v42
    v_xor_b32 v31, v31, v43
    s_branch L_flush
L_pad3:
    s_setpc_b64 s[68:69]
L_ev3:
    s_and_b32 s65, s57, 15
    v_cmp_ge_u32 s[66:67], s65, v4
    v_cmp_gt_u32 s[68:69], s65, v4
    s_bitcmp1_b32 s56, 3
    s_cselect_b64 s[62:63], s[70:71], s[62:63]
    v_cndmask_b32 v40, 0, v24, s[66:67]
    v_cndmask_b32 v41, 0, v25, s[66:67]
    v_cndmask_b32 v42, 0, v26, s[68:69]
    v_cndmask_b32 v43, 0, v27, s[68:69]
    s_mul_i32 s64, s63, 3
    s_bitcmp1_b32 s53, 3
    s_cbranch_scc0 L_evret
    s_waitcnt vmcnt(12)
    v_smfmac_f32_16x16x64_bf16 v[16:19], v[40:43], v[112:119], v14
    v_xor_b32 v24, v24, v40
    v_xor_b32 v25, v25, v41
    v_smfmac_f32_16x16x64_bf16 v[20:23], v[40:43], v[120:127], v14
    v_xor_b32 v26, v26, v42
    v_xor_b32 v27, v27, v43
    s_branch L_flush
L_pad4:
    s_setpc_b64 s[68:69]
L_ev4:
    s_and_b32 s65, s57, 15
    v_cmp_ge_u32 s[66:67], s65, v4
    v_cmp_gt_u32 s[68:69], s65, v4
    s_bitcmp1_b32 s56, 4
    s_cselect_b64 s[62:63], s[70:71], s[62:63]
    v_cndmask_b32 v40, 0, v28, s[66:67]
    v_cndmask_b32 v41, 0, v29, s[66:67]
    v_cndmask_b32 v42, 0, v30, s[68:69]
    v_cndmask_b32 v43, 0, v31, s[68:69]
    s_mul_i32 s64, s63, 4
    s_bitcmp1_b32 s53, 4
    s_cbranch_scc0 L_evret
    s_waitcnt vmcnt(12)
    v_smfmac_f32_16x16x64_bf16 v[16:19], v[40:43], v[128:135], v14
    v_xor_b32 v28, v28, v40
    v_xor_b32 v29, v29, v41
    v_smfmac_f32_16x16x64_bf16 v[20:23], v[40:43], v[136:143], v14
    v_xor_b32 v30, v30, v42
    v_xor_b32 v31, v31, v43
    s_branch L_flush
L_pad5:
    s_setpc_b64 s[68:69]
L_ev5:
    s_and_b32 s65, s57, 15
    v_cmp_ge_u32 s[66:67], s65, v4
    v_cmp_gt_u32 s[68:69], s65, v4
    s_bitcmp1_b32 s56, 5
    s_cselect_b64 s[62:63], s[70:71], s[62:63]
    v_cndmask_b32 v40, 0, v24, s[66:67]
    v_cndmask_b32 v41, 0, v25, s[66:67]
    v_cndmask_b32 v42, 0, v26, s[68:69]
    v_cndmask_b32 v43, 0, v27, s[68:69]
    s_mul_i32 s64, s63, 5
    s_bitcmp1_b32 s53, 5
    s_cbranch_scc0 L_evret
    s_waitcnt vmcnt(12)
    v_smfmac_f32_16x16x64_bf16 v[16:19], v[40:43], v[144:151], v14
    v_xor_b32 v24, v24, v40
    v_xor_b32 v25, v25, v41
    v_smfmac_f32_16x16x64_bf16 v[20:23], v[40:43], v[152:159], v14
    v_xor_b32 v26, v26, v42
    v_xor_b32 v27, v27, v43
    s_branch L_flush
L_pad6:
    s_setpc_b64 s[68:69]
L_ev6:
    s_and_b32 s65, s57, 15
    v_cmp_ge_u32 s[66:67], s65, v4
    v_cmp_gt_u32 s[68:69], s65, v4
    s_bitcmp1_b32 s56, 6
    s_cselect_b64 s[62:63], s[70:71], s[62:63]
    v_cndmask_b32 v40, 0, v28, s[66:67]
    v_cndmask_b32 v41, 0, v29, s[66:67]
    v_cndmask_b32 v42, 0, v30, s[68:69]
    v_cndmask_b32 v43, 0, v31, s[68:69]
    s_mul_i32 s64, s63, 6
    s_bitcmp1_b32 s53, 6
    s_cbranch_scc0 L_evret
    s_waitcnt vmcnt(12)
    v_smfmac_f32_16x16x64_bf16 v[16:19], v[40:43], v[160:167], v14
    v_xor_b32 v28, v28, v40
    v_xor_b32 v29, v29, v41
    v_smfmac_f32_16x16x64_bf16 v[20:23], v[40:43], v[168:175], v14
    v_xor_b32 v30, v30, v42
    v_xor_b32 v31, v31, v43
    s_branch L_flush
L_pad7:
    s_setpc_b64 s[68:69]
L_ev7:
    s_and_b32 s65, s57, 15
    v_cmp_ge_u32 s[66:67], s65, v4
    v_cmp_gt_u32 s[68:69], s65, v4
    s_bitcmp1_b32 s56, 7
    s_cselect_b64 s[62:63], s[70:71], s[62:63]
    v_cndmask_b32 v40, 0, v24, s[66:67]
    v_cndmask_b32 v41, 0, v25, s[66:67]
    v_cndmask_b32 v42, 0, v26, s[68:69]
    v_cndmask_b32 v43, 0, v27, s[68:69]
    s_mul_i32 s64, s63, 7
    s_bitcmp1_b32 s53, 7
    s_cbranch_scc0 L_evret
    s_waitcnt vmcnt(12)
    v_smfmac_f32_16x16x64_bf16 v[16:19], v[40:43], v[48:55], v14
    v_xor_b32 v24, v24, v40
    v_xor_b32 v25, v25, v41
    v_smfmac_f32_16x16x64_bf16 v[20:23], v[40:43], v[56:63], v14
    v_xor_b32 v26, v26, v42
    v_xor_b32 v27, v27, v43
    s_nop 0
L_flush:
    s_lshr_b32 s57, s57, 4
    s_cmp_eq_u32 s26, 4
    v_add_u32 v1, 1, v1
    v_mul_f32 v40, v177, v16
    v_mul_f32 v41, v177, v17
    v_mul_f32 v42, v177, v18
    v_mul_f32 v43, v177, v19
    v_cvt_pk_bf16_f32 v40, v40, v41
    v_cvt_pk_bf16_f32 v41, v42, v43
    ds_write_b64 v176, v[40:41] offset:41984
    v_mul_f32 v44, v177, v20
    v_mul_f32 v45, v177, v21
    v_mul_f32 v46, v177, v22
    v_mul_f32 v47, v177, v23
    v_cvt_pk_bf16_f32 v44, v44, v45
    v_cvt_pk_bf16_f32 v45, v46, v47
    ds_write_b64 v176, v[44:45] offset:42240
    ds_write_b32 v10, v1 offset:32
    s_cbranch_scc1 L_sdone
    v_mov_b64 v[16:17], 0
    v_mov_b64 v[18:19], 0
    v_mov_b64 v[20:21], 0
    v_mov_b64 v[22:23], 0
    s_add_u32 s26, s26, 1
    v_mov_b64 v[176:177], v[178:179]
    v_mov_b64 v[178:179], v[180:181]
    v_mov_b64 v[180:181], v[182:183]
    v_mov_b64 v[182:183], v[184:185]
L_evret:
    s_add_u32 s64, s64, s62
    s_add_u32 s54, s72, s64
    s_addc_u32 s55, s73, 0
    s_setpc_b64 s[54:55]
L_pad9:
    s_setpc_b64 s[68:69]
L_slow:
    s_mov_b32 s62, L_slow_pair-L_anc
    v_mbcnt_lo_u32_b32 v200, -1, 0
    v_mbcnt_hi_u32_b32 v200, -1, v200
L_slow_pair:
    v_lshlrev_b32 v201, 2, v200
    s_mul_i32 s70, s1, 40
    s_lshl1_add_u32 s70, s24, s70
    s_mov_b32 s71, 0
    s_mov_b32 s24, s20
    s_mov_b32 s20, s21
    s_mov_b32 s21, s22
    s_mov_b32 s22, s23
L_slow_chunk:
    global_load_dword v202, v201, s[8:9]
    global_load_dword v203, v201, s[6:7]
    v_add_u32 v201, 0x100, v201
    s_waitcnt vmcnt(0)
    v_subrev_u32 v202, s70, v202
    v_cmp_gt_u32 vcc, 2, v202
    v_lshlrev_b32 v204, 1, v203
    ds_read_u16 v204, v204 offset:62464
    s_mov_b64 s[76:77], vcc
    v_lshlrev_b32 v202, 4, v202
    v_lshlrev_b32 v203, 9, v203
    s_waitcnt lgkmcnt(0)
    v_lshlrev_b32 v204, v202, v204
L_slow_edge:
    s_cmp_eq_u64 s[76:77], 0
    s_cbranch_scc1 L_slow_next
    s_ff1_i32_b64 s74, s[76:77]
    s_bitset0_b64 s[76:77], s74
    v_readlane_b32 s64, v203, s74
    v_readlane_b32 s65, v204, s74
    v_mov_b32 v205, 0
    v_mov_b32 v11, 2147483648
    s_mov_b64 exec, 0xffff
    v_mov_b32 v205, s65
    v_add_u32 v11, s64, v7
    s_mov_b64 exec, -1
    buffer_load_dwordx4 v[208:211], v11, s[32:35], 0 offen
    buffer_load_dwordx4 v[212:215], v11, s[32:35], 0 offen offset:256
    v_and_b32 v24, v205, v12
    v_and_b32 v25, v205, v13
    s_nop 0
    s_waitcnt vmcnt(0)
    v_smfmac_f32_16x16x32_bf16 v[16:19], v[24:25], v[208:211], v14
    v_smfmac_f32_16x16x32_bf16 v[20:23], v[24:25], v[212:215], v14
    s_branch L_slow_edge
L_slow_next:
    s_add_u32 s71, s71, 1
    s_cmp_lt_u32 s71, 2500
    s_cbranch_scc1 L_slow_chunk
    s_mov_b32 s64, 0
    s_nop 3
    s_branch L_flush
L_sdone:
    ds_write_b32 v10, v6 offset:48
    s_waitcnt lgkmcnt(0)
    s_barrier
    s_endpgm
L_retry_7:
    s_sub_u32 s100, s100, 1
    s_cbranch_scc1 L_end
    s_sleep 1
    s_branch L_spin_6
L_retry_18:
    s_sub_u32 s100, s100, 1
    s_cbranch_scc1 L_end
    s_sleep 1
    s_branch L_spin_17
L_retry_19:
    s_sub_u32 s100, s100, 1
    s_cbranch_scc1 L_end
    s_sleep 4
    s_branch L_ipoll_16
L_retry_25:
    s_sub_u32 s100, s100, 1
    s_cbranch_scc1 L_end
    s_sleep 2
    s_branch L_secload_24
L_secload_24:
    buffer_load_dwordx4 v[56:59], v8, s[40:43], s12 offen sc1
    s_waitcnt vmcnt(0)
    s_branch L_sec_22
L_retry_29:
    s_sub_u32 s100, s100, 1
    s_cbranch_scc1 L_end
    s_sleep 2
    s_branch L_secload_28
L_secload_28:
    buffer_load_dwordx4 v[60:63], v8, s[40:43], s13 offen sc1
    s_waitcnt vmcnt(0)
    s_branch L_sec_26
L_retry_31:
    s_sub_u32 s100, s100, 1
    s_cbranch_scc1 L_end
    s_sleep 1
    s_branch L_spin_30
L_mrole_1:
    v_lshlrev_b32 v43, 4, v4
    v_lshl_add_u32 v46, v46, 9, v43
    s_bfe_u32 s64, s68, 0x30002
    s_lshl_b32 s64, s64, 14
    s_lshr_b32 s65, s68, 5
    s_lshl_b32 s65, s65, 15
    s_bfe_u32 s66, s68, 0x10001
    s_lshl_b32 s66, s66, 14
    s_add_u32 s65, s65, s66
    s_and_b32 s66, s68, 1
    s_lshl_b32 s66, s66, 11
    s_add_u32 s65, s65, s66
    s_lshr_b32 s66, s2, 2
    s_xor_b32 s66, s66, s2
    s_and_b32 s66, s66, 0x30
    s_lshl_b32 s66, s66, 3
    v_add_u32 v46, s66, v46
    v_add_u32 v44, s64, v46
    v_add_u32 v45, s65, v46
    s_cmp_lg_u32 s31, 0
    s_waitcnt lgkmcnt(0)
    global_load_dword v0, v42, s[10:11]
    s_cbranch_scc1 L_roled_2
    global_load_dwordx4 v[48:51], v45, s[20:21] offset:0
    global_load_dwordx4 v[52:55], v44, s[18:19] offset:0
    global_load_dwordx4 v[56:59], v44, s[18:19] offset:2048
    global_load_dwordx4 v[60:63], v45, s[20:21] offset:64
    global_load_dwordx4 v[64:67], v44, s[18:19] offset:64
    global_load_dwordx4 v[68:71], v44, s[18:19] offset:2112
    v_xor_b32 v44, 128, v44
    v_xor_b32 v45, 128, v45
    global_load_dwordx4 v[72:75], v45, s[20:21] offset:0
    global_load_dwordx4 v[76:79], v44, s[18:19] offset:0
    global_load_dwordx4 v[80:83], v44, s[18:19] offset:2048
    global_load_dwordx4 v[84:87], v45, s[20:21] offset:64
    global_load_dwordx4 v[88:91], v44, s[18:19] offset:64
    global_load_dwordx4 v[92:95], v44, s[18:19] offset:2112
    v_xor_b32 v44, 384, v44
    v_xor_b32 v45, 384, v45
    global_load_dwordx4 v[96:99], v45, s[20:21] offset:0
    global_load_dwordx4 v[100:103], v44, s[18:19] offset:0
    global_load_dwordx4 v[104:107], v44, s[18:19] offset:2048
    global_load_dwordx4 v[108:111], v45, s[20:21] offset:64
    global_load_dwordx4 v[112:115], v44, s[18:19] offset:64
    global_load_dwordx4 v[116:119], v44, s[18:19] offset:2112
    v_xor_b32 v44, 128, v44
    v_xor_b32 v45, 128, v45
    global_load_dwordx4 v[120:123], v45, s[20:21] offset:0
    global_load_dwordx4 v[124:127], v44, s[18:19] offset:0
    global_load_dwordx4 v[128:131], v44, s[18:19] offset:2048
    global_load_dwordx4 v[132:135], v45, s[20:21] offset:64
    global_load_dwordx4 v[136:139], v44, s[18:19] offset:64
    global_load_dwordx4 v[140:143], v44, s[18:19] offset:2112
    s_branch L_roled_2
L_mwork_4:
    s_cmp_lg_u32 s31, 0
    s_cbranch_scc1 L_worked_5_w
    s_waitcnt vmcnt(21)
    v_mfma_f32_16x16x32_bf16 v[16:19], v[52:55], v[48:51], 0
    v_mfma_f32_16x16x32_bf16 v[20:23], v[56:59], v[48:51], 0
    s_waitcnt vmcnt(18)
    v_mfma_f32_16x16x32_bf16 v[16:19], v[64:67], v[60:63], v[16:19]
    v_mfma_f32_16x16x32_bf16 v[20:23], v[68:71], v[60:63], v[20:23]
    s_waitcnt vmcnt(15)
    v_mfma_f32_16x16x32_bf16 v[16:19], v[76:79], v[72:75], v[16:19]
    v_mfma_f32_16x16x32_bf16 v[20:23], v[80:83], v[72:75], v[20:23]
    s_waitcnt vmcnt(12)
    v_mfma_f32_16x16x32_bf16 v[16:19], v[88:91], v[84:87], v[16:19]
    v_mfma_f32_16x16x32_bf16 v[20:23], v[92:95], v[84:87], v[20:23]
    s_waitcnt vmcnt(9)
    v_mfma_f32_16x16x32_bf16 v[16:19], v[100:103], v[96:99], v[16:19]
    v_mfma_f32_16x16x32_bf16 v[20:23], v[104:107], v[96:99], v[20:23]
    s_waitcnt vmcnt(6)
    v_mfma_f32_16x16x32_bf16 v[16:19], v[112:115], v[108:111], v[16:19]
    v_mfma_f32_16x16x32_bf16 v[20:23], v[116:119], v[108:111], v[20:23]
    s_waitcnt vmcnt(3)
    v_mfma_f32_16x16x32_bf16 v[16:19], v[124:127], v[120:123], v[16:19]
    v_mfma_f32_16x16x32_bf16 v[20:23], v[128:131], v[120:123], v[20:23]
    s_waitcnt vmcnt(0)
    v_mfma_f32_16x16x32_bf16 v[16:19], v[136:139], v[132:135], v[16:19]
    v_mfma_f32_16x16x32_bf16 v[20:23], v[140:143], v[132:135], v[20:23]
    s_lshl_b32 s64, s27, 10
    s_add_u32 s64, s64, 65536
    v_lshl_add_u32 v40, v2, 4, s64
    s_lshl_b32 s64, s27, 2
    s_add_u32 s64, s64, 4096
    v_lshl_add_u32 v41, v2, 9, s64
    v_mov_b32 v42, s30
    s_nop 1
    v_cvt_pk_bf16_f32 v44, v16, v17
    v_cvt_pk_bf16_f32 v45, v18, v19
    v_cvt_pk_bf16_f32 v46, v20, v21
    v_cvt_pk_bf16_f32 v47, v22, v23
    global_store_dwordx4 v40, v[44:47], s[28:29] sc1
    s_mov_b32 s26, 2
    s_waitcnt vmcnt(0)
    s_mov_b64 exec, 65535
    global_store_dword v41, v42, s[28:29] sc1
    s_mov_b64 exec, -1
    s_branch L_worked_5
L_worked_5_w:
    s_waitcnt vmcnt(0)
    s_branch L_worked_5
L_gemm:
    v_lshrrev_b32 v0, 5, v2
    s_lshl_b32 s64, s31, 1
    v_add_u32 v0, s64, v0
    v_and_b32 v1, 31, v2
    v_xor_b32 v1, v1, v0
    v_lshlrev_b32 v1, 4, v1
    v_lshl_add_u32 v30, v0, 9, v1
    v_xor_b32 v31, 0x80, v30
    v_lshrrev_b32 v13, 3, v2
    v_lshrrev_b32 v15, 2, v2
    v_and_b32 v15, 4, v15
    v_and_b32 v14, 7, v2
    v_xor_b32 v15, v15, v14
    v_lshlrev_b32 v15, 4, v15
    v_lshl_add_u32 v13, v13, 9, v15
    s_lshr_b32 s67, s2, 3
    s_and_b32 s67, s67, 7
    s_lshl_b32 s64, s31, 7
    s_lshl_b32 s65, s67, 14
    s_or_b32 s64, s64, s65
    v_add_u32 v13, s64, v13
    s_mul_i32 s63, s1, 20480
    s_lshl_b32 s66, s31, 10
    s_lshl_b32 s70, s31, 14
    s_add_u32 s70, s70, 82944
    s_mov_b32 s71, 3072
    s_mov_b32 s72, 6144
    s_mov_b32 s73, 9216
    s_waitcnt lgkmcnt(0)
    s_mov_b32 s32, s4
    s_and_b32 s33, s5, 0xffff
    s_mov_b32 s34, 5120000
    s_mov_b32 s35, 0x20000
    s_mov_b32 s36, s22
    s_and_b32 s37, s23, 0xffff
    s_mov_b32 s38, 131072
    s_mov_b32 s39, 0x20000
    s_bitcmp1_b32 s2, 3
    s_cbranch_scc0 L_touched_32
    s_lshr_b32 s64, s2, 4
    s_lshl_b32 s64, s64, 3
    s_and_b32 s68, s2, 7
    s_or_b32 s64, s64, s68
    s_lshl_b32 s64, s64, 10
    v_lshl_add_u32 v16, v2, 4, s64
    s_cmp_eq_u32 s31, 1
    s_cselect_b64 s[68:69], s[22:23], s[16:17]
    s_cmp_eq_u32 s31, 2
    s_cselect_b64 s[68:69], s[18:19], s[68:69]
    s_cmp_eq_u32 s31, 3
    s_cselect_b64 s[68:69], s[20:21], s[68:69]
    global_load_dwordx4 v[20:23], v16, s[68:69]
L_touched_32:
    s_cmp_ge_u32 s2, 250
    s_cbranch_scc1 L_end
    s_mul_i32 s64, s1, 20480
    s_mov_b32 s76, 0
    s_cmp_eq_u32 s31, 0
    s_cselect_b64 s[68:69], s[24:25], s[16:17]
    s_cselect_b32 s64, s64, 0
    s_cmp_eq_u32 s31, 2
    s_cselect_b64 s[68:69], s[28:29], s[68:69]
    s_cselect_b32 s64, 0x800, s64
    s_cselect_b32 s76, 0x2f8000, s76
    s_cmp_eq_u32 s31, 3
    s_cselect_b64 s[68:69], s[4:5], s[68:69]
    s_cselect_b32 s76, 0x200000, s76
    s_cselect_b32 s77, 2, 1
    v_min_u32 v17, s77, v2
    v_mul_lo_u32 v17, v17, s76
    v_add_u32 v17, s64, v17
    global_load_dword v24, v17, s[68:69]
    s_add_u32 m0, s66, 1024
    s_nop 0
    buffer_load_dwordx4 v30, s[32:35], s63 offen lds
    s_add_u32 m0, s66, 5120
    s_add_u32 s63, s63, 4096
    buffer_load_dwordx4 v31, s[32:35], s63 offen lds
    s_add_u32 m0, s66, 9216
    s_add_u32 s63, s63, 4096
    buffer_load_dwordx4 v30, s[32:35], s63 offen lds
    s_add_u32 m0, s66, 13312
    s_add_u32 s63, s63, 4096
    buffer_load_dwordx4 v31, s[32:35], s63 offen lds
    s_add_u32 m0, s66, 17408
    s_add_u32 s63, s63, 4096
    buffer_load_dwordx4 v30, s[32:35], s63 offen lds
L_nox_33:
L_gemm2:
    s_barrier
    s_setprio 2
    s_add_u32 m0, s70, 0
    s_nop 0
    buffer_load_dwordx4 v13, s[36:39], 0 offen offset:0 lds
    buffer_load_dwordx4 v13, s[36:39], s71 offen offset:1024 lds
    buffer_load_dwordx4 v13, s[36:39], s72 offen offset:2048 lds
    buffer_load_dwordx4 v13, s[36:39], s73 offen offset:3072 lds
    v_xor_b32 v13, 16384, v13
    s_mov_b32 s40, s16
    s_and_b32 s41, s17, 0xffff
    s_mov_b32 s42, 131072
    s_mov_b32 s43, 0x20000
    s_mov_b32 s44, s28
    s_and_b32 s45, s29, 0xffff
    s_mov_b32 s46, 1048576
    s_mov_b32 s47, 0x20000
    s_mov_b32 s48, s24
    s_and_b32 s49, s25, 0xffff
    s_mov_b32 s50, 5120000
    s_mov_b32 s51, 0x20000
    v_xor_b32 v15, v4, v3
    v_lshlrev_b32 v15, 4, v15
    v_lshl_add_u32 v7, v3, 9, v15
    s_lshl_b32 s64, s67, 6
    v_xor_b32 v7, s64, v7
    v_xor_b32 v8, 64, v7
    v_xor_b32 v9, 0x80, v7
    v_xor_b32 v10, 0xc0, v7
    v_lshrrev_b32 v15, 2, v3
    v_lshl_add_u32 v15, v4, 3, v15
    v_lshlrev_b32 v15, 7, v15
    v_lshrrev_b32 v14, 1, v3
    v_and_b32 v14, 4, v14
    v_and_b32 v0, 3, v3
    v_xor_b32 v14, v14, v0
    v_lshl_add_u32 v15, v14, 4, v15
    v_add_u32 v11, s70, v15
    v_xor_b32 v12, 64, v11
    v_and_b32 v0, 31, v2
    v_lshlrev_b32 v0, 2, v0
    s_and_b32 s64, s2, 15
    s_lshl_b32 s64, s64, 9
    s_lshl_b32 s65, s31, 7
    s_add_u32 s64, s64, s65
    s_add_u32 s74, s64, 4096
    v_lshlrev_b32 v14, 4, v2
    s_lshl_b32 s75, s31, 15
    s_lshl_b32 s64, s67, 12
    s_or_b32 s75, s75, s64
    s_add_u32 s75, s75, 65536
    s_cmp_eq_u32 s31, 0
    s_cbranch_scc0 L_nw_35
    s_call_b64 s[68:69], L_pad0
    s_call_b64 s[68:69], L_pad1
    s_call_b64 s[68:69], L_pad8
    s_branch L_warmed_34
L_nw_35:
    s_cmp_eq_u32 s31, 1
    s_cbranch_scc0 L_nw_36
    s_call_b64 s[68:69], L_pad2
    s_call_b64 s[68:69], L_pad3
    s_call_b64 s[68:69], L_pad9
    s_branch L_warmed_34
L_nw_36:
    s_cmp_eq_u32 s31, 2
    s_cbranch_scc0 L_nw_37
    s_call_b64 s[68:69], L_pad4
    s_call_b64 s[68:69], L_pad5
    s_branch L_warmed_34
L_nw_37:
    s_call_b64 s[68:69], L_pad6
    s_call_b64 s[68:69], L_pad7
L_warmed_34:
    s_add_u32 m0, s70, 4096
    s_waitcnt vmcnt(9)
    buffer_load_dwordx4 v13, s[36:39], 0 offen offset:0 lds
    s_waitcnt vmcnt(9)
    buffer_load_dwordx4 v13, s[36:39], s71 offen offset:1024 lds
    s_waitcnt vmcnt(9)
    buffer_load_dwordx4 v13, s[36:39], s72 offen offset:2048 lds
    s_waitcnt vmcnt(9)
    buffer_load_dwordx4 v13, s[36:39], s73 offen offset:3072 lds
    v_xor_b32 v13, 49152, v13
    s_add_u32 m0, s70, 8192
    s_waitcnt vmcnt(9)
    buffer_load_dwordx4 v13, s[36:39], 0 offen offset:0 lds
    s_waitcnt vmcnt(9)
    buffer_load_dwordx4 v13, s[36:39], s71 offen offset:1024 lds
    s_waitcnt vmcnt(9)
    buffer_load_dwordx4 v13, s[36:39], s72 offen offset:2048 lds
    s_waitcnt vmcnt(9)
    buffer_load_dwordx4 v13, s[36:39], s73 offen offset:3072 lds
    v_xor_b32 v13, 16384, v13
    s_add_u32 m0, s70, 12288
    s_waitcnt vmcnt(4)
    buffer_load_dwordx4 v13, s[36:39], 0 offen offset:0 lds
    s_waitcnt vmcnt(4)
    buffer_load_dwordx4 v13, s[36:39], s71 offen offset:1024 lds
    s_waitcnt vmcnt(4)
    buffer_load_dwordx4 v13, s[36:39], s72 offen offset:2048 lds
    s_waitcnt vmcnt(4)
    buffer_load_dwordx4 v13, s[36:39], s73 offen offset:3072 lds
    v_xor_b32 v13, 114688, v13
    s_waitcnt vmcnt(12)
    s_waitcnt lgkmcnt(0)
    s_mov_b64 exec, 1
    ds_add_u32 v5, v6 offset:4
    s_mov_b64 exec, -1
    ds_read_b64_tr_b16 v[128:129], v11 offset:0
    ds_read_b64_tr_b16 v[130:131], v11 offset:512
    ds_read_b64_tr_b16 v[132:133], v11 offset:8
    ds_read_b64_tr_b16 v[134:135], v11 offset:520
    ds_read_b64_tr_b16 v[136:137], v12 offset:0
    ds_read_b64_tr_b16 v[138:139], v12 offset:512
    ds_read_b64_tr_b16 v[140:141], v12 offset:8
    ds_read_b64_tr_b16 v[142:143], v12 offset:520
    s_waitcnt lgkmcnt(0)
    s_add_u32 m0, s70, 0
    s_waitcnt vmcnt(4)
    buffer_load_dwordx4 v13, s[36:39], 0 offen offset:0 lds
    s_waitcnt vmcnt(4)
    buffer_load_dwordx4 v13, s[36:39], s71 offen offset:1024 lds
    s_waitcnt vmcnt(4)
    buffer_load_dwordx4 v13, s[36:39], s72 offen offset:2048 lds
    s_waitcnt vmcnt(4)
    buffer_load_dwordx4 v13, s[36:39], s73 offen offset:3072 lds
    v_xor_b32 v13, 16384, v13
    s_waitcnt vmcnt(12)
    ds_read_b64_tr_b16 v[144:145], v11 offset:4096
    ds_read_b64_tr_b16 v[146:147], v11 offset:4608
    ds_read_b64_tr_b16 v[148:149], v11 offset:4104
    ds_read_b64_tr_b16 v[150:151], v11 offset:4616
    ds_read_b64_tr_b16 v[152:153], v12 offset:4096
    ds_read_b64_tr_b16 v[154:155], v12 offset:4608
    ds_read_b64_tr_b16 v[156:157], v12 offset:4104
    ds_read_b64_tr_b16 v[158:159], v12 offset:4616
    s_waitcnt lgkmcnt(0)
    s_add_u32 m0, s70, 4096
    s_waitcnt vmcnt(4)
    buffer_load_dwordx4 v13, s[36:39], 0 offen offset:0 lds
    s_waitcnt vmcnt(4)
    buffer_load_dwordx4 v13, s[36:39], s71 offen offset:1024 lds
    s_waitcnt vmcnt(4)
    buffer_load_dwordx4 v13, s[36:39], s72 offen offset:2048 lds
    s_waitcnt vmcnt(4)
    buffer_load_dwordx4 v13, s[36:39], s73 offen offset:3072 lds
    v_xor_b32 v13, 49152, v13
    s_waitcnt vmcnt(12)
    ds_read_b64_tr_b16 v[160:161], v11 offset:8192
    ds_read_b64_tr_b16 v[162:163], v11 offset:8704
    ds_read_b64_tr_b16 v[164:165], v11 offset:8200
    ds_read_b64_tr_b16 v[166:167], v11 offset:8712
    ds_read_b64_tr_b16 v[168:169], v12 offset:8192
    ds_read_b64_tr_b16 v[170:171], v12 offset:8704
    ds_read_b64_tr_b16 v[172:173], v12 offset:8200
    ds_read_b64_tr_b16 v[174:175], v12 offset:8712
    s_waitcnt lgkmcnt(0)
    s_add_u32 m0, s70, 8192
    s_waitcnt vmcnt(4)
    buffer_load_dwordx4 v13, s[36:39], 0 offen offset:0 lds
    s_waitcnt vmcnt(4)
    buffer_load_dwordx4 v13, s[36:39], s71 offen offset:1024 lds
    s_waitcnt vmcnt(4)
    buffer_load_dwordx4 v13, s[36:39], s72 offen offset:2048 lds
    s_waitcnt vmcnt(4)
    buffer_load_dwordx4 v13, s[36:39], s73 offen offset:3072 lds
    v_xor_b32 v13, 16384, v13
    buffer_load_dword v1, v0, s[44:47], s74 offen sc1
    s_waitcnt vmcnt(13)
    ds_read_b64_tr_b16 v[176:177], v11 offset:12288
    ds_read_b64_tr_b16 v[178:179], v11 offset:12800
    ds_read_b64_tr_b16 v[180:181], v11 offset:12296
    ds_read_b64_tr_b16 v[182:183], v11 offset:12808
    ds_read_b64_tr_b16 v[184:185], v12 offset:12288
    ds_read_b64_tr_b16 v[186:187], v12 offset:12800
    ds_read_b64_tr_b16 v[188:189], v12 offset:12296
    ds_read_b64_tr_b16 v[190:191], v12 offset:12808
    s_waitcnt lgkmcnt(0)
    s_add_u32 m0, s70, 12288
    s_nop 0
    buffer_load_dwordx4 v13, s[36:39], 0 offen offset:0 lds
    buffer_load_dwordx4 v13, s[36:39], s71 offen offset:1024 lds
    buffer_load_dwordx4 v13, s[36:39], s72 offen offset:2048 lds
    buffer_load_dwordx4 v13, s[36:39], s73 offen offset:3072 lds
    v_xor_b32 v13, 114688, v13
    s_waitcnt vmcnt(13)
    ds_read_b64_tr_b16 v[192:193], v11 offset:0
    ds_read_b64_tr_b16 v[194:195], v11 offset:512
    ds_read_b64_tr_b16 v[196:197], v11 offset:8
    ds_read_b64_tr_b16 v[198:199], v11 offset:520
    ds_read_b64_tr_b16 v[200:201], v12 offset:0
    ds_read_b64_tr_b16 v[202:203], v12 offset:512
    ds_read_b64_tr_b16 v[204:205], v12 offset:8
    ds_read_b64_tr_b16 v[206:207], v12 offset:520
    s_waitcnt vmcnt(9)
    ds_read_b64_tr_b16 v[208:209], v11 offset:4096
    ds_read_b64_tr_b16 v[210:211], v11 offset:4608
    ds_read_b64_tr_b16 v[212:213], v11 offset:4104
    ds_read_b64_tr_b16 v[214:215], v11 offset:4616
    ds_read_b64_tr_b16 v[216:217], v12 offset:4096
    ds_read_b64_tr_b16 v[218:219], v12 offset:4608
    ds_read_b64_tr_b16 v[220:221], v12 offset:4104
    ds_read_b64_tr_b16 v[222:223], v12 offset:4616
    s_waitcnt vmcnt(5)
    ds_read_b64_tr_b16 v[224:225], v11 offset:8192
    ds_read_b64_tr_b16 v[226:227], v11 offset:8704
    ds_read_b64_tr_b16 v[228:229], v11 offset:8200
    ds_read_b64_tr_b16 v[230:231], v11 offset:8712
    ds_read_b64_tr_b16 v[232:233], v12 offset:8192
    ds_read_b64_tr_b16 v[234:235], v12 offset:8704
    ds_read_b64_tr_b16 v[236:237], v12 offset:8200
    ds_read_b64_tr_b16 v[238:239], v12 offset:8712
    s_waitcnt vmcnt(4)
L_spin_40:
    ds_read_b128 v[16:19], v5
    s_waitcnt lgkmcnt(0)
    v_readfirstlane_b32 s101, v18
    v_readfirstlane_b32 s30, v19
    s_cmp_ge_u32 s101, 1
    s_cbranch_scc0 L_retry_41
L_mchk_39:
    v_cmp_ne_u32 vcc, s30, v1
    s_cbranch_vccnz L_mre_42
    buffer_load_dwordx4 v[40:43], v14, s[44:47], s75 offen offset:0 sc1
    buffer_load_dwordx4 v[44:47], v14, s[44:47], s75 offen offset:1024 sc1
    buffer_load_dwordx4 v[48:51], v14, s[44:47], s75 offen offset:2048 sc1
    buffer_load_dwordx4 v[52:55], v14, s[44:47], s75 offen offset:3072 sc1
    s_xor_b32 s75, s75, 4096
    buffer_load_dwordx4 v[56:59], v14, s[44:47], s75 offen offset:0 sc1
    buffer_load_dwordx4 v[60:63], v14, s[44:47], s75 offen offset:1024 sc1
    buffer_load_dwordx4 v[64:67], v14, s[44:47], s75 offen offset:2048 sc1
    buffer_load_dwordx4 v[68:71], v14, s[44:47], s75 offen offset:3072 sc1
    s_xor_b32 s75, s75, 12288
    buffer_load_dwordx4 v[72:75], v14, s[44:47], s75 offen offset:0 sc1
    buffer_load_dwordx4 v[76:79], v14, s[44:47], s75 offen offset:1024 sc1
    s_waitcnt vmcnt(10)
    ds_read_b64_tr_b16 v[240:241], v11 offset:12288
    ds_read_b64_tr_b16 v[242:243], v11 offset:12800
    ds_read_b64_tr_b16 v[244:245], v11 offset:12296
    ds_read_b64_tr_b16 v[246:247], v11 offset:12808
    ds_read_b64_tr_b16 v[248:249], v12 offset:12288
    ds_read_b64_tr_b16 v[250:251], v12 offset:12800
    ds_read_b64_tr_b16 v[252:253], v12 offset:12296
    ds_read_b64_tr_b16 v[254:255], v12 offset:12808
L_spin_43:
    ds_read_b32 v15, v5 offset:4
    s_waitcnt lgkmcnt(0)
    v_readfirstlane_b32 s101, v15
    s_cmp_ge_u32 s101, 4
    s_cbranch_scc0 L_retry_44
    ds_read_b128 v[16:19], v7 offset:1024
    ds_read_b128 v[20:23], v7 offset:9216
    ds_read_b128 v[24:27], v7 offset:17408
    v_xor_b32 v7, 0x100, v7
    ds_read_b128 v[28:31], v8 offset:1024
    ds_read_b128 v[32:35], v8 offset:9216
    ds_read_b128 v[36:39], v8 offset:17408
    v_xor_b32 v8, 0x100, v8
    s_waitcnt lgkmcnt(3)
    s_waitcnt vmcnt(9)
    v_mfma_f32_16x16x32_bf16 v[80:83], v[40:43], v[16:19], 0
    v_mfma_f32_16x16x32_bf16 v[96:99], v[40:43], v[20:23], 0
    v_mfma_f32_16x16x32_bf16 v[112:115], v[40:43], v[24:27], 0
    buffer_load_dwordx4 v[40:43], v14, s[44:47], s75 offen offset:2048 sc1
    s_waitcnt vmcnt(9)
    v_mfma_f32_16x16x32_bf16 v[84:87], v[44:47], v[16:19], 0
    v_mfma_f32_16x16x32_bf16 v[100:103], v[44:47], v[20:23], 0
    v_mfma_f32_16x16x32_bf16 v[116:119], v[44:47], v[24:27], 0
    buffer_load_dwordx4 v[44:47], v14, s[44:47], s75 offen offset:3072 sc1
    s_xor_b32 s75, s75, 4096
    s_waitcnt vmcnt(9)
    v_mfma_f32_16x16x32_bf16 v[88:91], v[48:51], v[16:19], 0
    v_mfma_f32_16x16x32_bf16 v[104:107], v[48:51], v[20:23], 0
    v_mfma_f32_16x16x32_bf16 v[120:123], v[48:51], v[24:27], 0
    buffer_load_dwordx4 v[48:51], v14, s[44:47], s75 offen offset:0 sc1
    s_waitcnt vmcnt(9)
    v_mfma_f32_16x16x32_bf16 v[92:95], v[52:55], v[16:19], 0
    v_mfma_f32_16x16x32_bf16 v[108:111], v[52:55], v[20:23], 0
    v_mfma_f32_16x16x32_bf16 v[124:127], v[52:55], v[24:27], 0
    buffer_load_dwordx4 v[52:55], v14, s[44:47], s75 offen offset:1024 sc1
    ds_read_b128 v[16:19], v9 offset:1024
    ds_read_b128 v[20:23], v9 offset:9216
    ds_read_b128 v[24:27], v9 offset:17408
    v_xor_b32 v9, 0x100, v9
    s_waitcnt lgkmcnt(3)
    s_waitcnt vmcnt(9)
    v_mfma_f32_16x16x32_bf16 v[80:83], v[56:59], v[28:31], v[80:83]
    v_mfma_f32_16x16x32_bf16 v[96:99], v[56:59], v[32:35], v[96:99]
    v_mfma_f32_16x16x32_bf16 v[112:115], v[56:59], v[36:39], v[112:115]
    buffer_load_dwordx4 v[56:59], v14, s[44:47], s75 offen offset:2048 sc1
    s_waitcnt vmcnt(9)
    v_mfma_f32_16x16x32_bf16 v[84:87], v[60:63], v[28:31], v[84:87]
    v_mfma_f32_16x16x32_bf16 v[100:103], v[60:63], v[32:35], v[100:103]
    v_mfma_f32_16x16x32_bf16 v[116:119], v[60:63], v[36:39], v[116:119]
    buffer_load_dwordx4 v[60:63], v14, s[44:47], s75 offen offset:3072 sc1
    s_xor_b32 s75, s75, 28672
    s_waitcnt vmcnt(9)
    v_mfma_f32_16x16x32_bf16 v[88:91], v[64:67], v[28:31], v[88:91]
    v_mfma_f32_16x16x32_bf16 v[104:107], v[64:67], v[32:35], v[104:107]
    v_mfma_f32_16x16x32_bf16 v[120:123], v[64:67], v[36:39], v[120:123]
    buffer_load_dwordx4 v[64:67], v14, s[44:47], s75 offen offset:0 sc1
    s_waitcnt vmcnt(9)
    v_mfma_f32_16x16x32_bf16 v[92:95], v[68:71], v[28:31], v[92:95]
    v_mfma_f32_16x16x32_bf16 v[108:111], v[68:71], v[32:35], v[108:111]
    v_mfma_f32_16x16x32_bf16 v[124:127], v[68:71], v[36:39], v[124:127]
    buffer_load_dwordx4 v[68:71], v14, s[44:47], s75 offen offset:1024 sc1
    ds_read_b128 v[28:31], v10 offset:1024
    ds_read_b128 v[32:35], v10 offset:9216
    ds_read_b128 v[36:39], v10 offset:17408
    v_xor_b32 v10, 0x100, v10
    s_waitcnt lgkmcnt(3)
    s_waitcnt vmcnt(9)
    v_mfma_f32_16x16x32_bf16 v[80:83], v[72:75], v[16:19], v[80:83]
    v_mfma_f32_16x16x32_bf16 v[96:99], v[72:75], v[20:23], v[96:99]
    v_mfma_f32_16x16x32_bf16 v[112:115], v[72:75], v[24:27], v[112:115]
    buffer_load_dwordx4 v[72:75], v14, s[44:47], s75 offen offset:2048 sc1
    s_waitcnt vmcnt(9)
    v_mfma_f32_16x16x32_bf16 v[84:87], v[76:79], v[16:19], v[84:87]
    v_mfma_f32_16x16x32_bf16 v[100:103], v[76:79], v[20:23], v[100:103]
    v_mfma_f32_16x16x32_bf16 v[116:119], v[76:79], v[24:27], v[116:119]
    buffer_load_dwordx4 v[76:79], v14, s[44:47], s75 offen offset:3072 sc1
    s_xor_b32 s75, s75, 4096
    s_waitcnt vmcnt(9)
    v_mfma_f32_16x16x32_bf16 v[88:91], v[40:43], v[16:19], v[88:91]
    v_mfma_f32_16x16x32_bf16 v[104:107], v[40:43], v[20:23], v[104:107]
    v_mfma_f32_16x16x32_bf16 v[120:123], v[40:43], v[24:27], v[120:123]
    buffer_load_dwordx4 v[40:43], v14, s[44:47], s75 offen offset:0 sc1
    s_waitcnt vmcnt(9)
    v_mfma_f32_16x16x32_bf16 v[92:95], v[44:47], v[16:19], v[92:95]
    v_mfma_f32_16x16x32_bf16 v[108:111], v[44:47], v[20:23], v[108:111]
    v_mfma_f32_16x16x32_bf16 v[124:127], v[44:47], v[24:27], v[124:127]
    buffer_load_dwordx4 v[44:47], v14, s[44:47], s75 offen offset:1024 sc1
    ds_read_b128 v[16:19], v7 offset:1024
    ds_read_b128 v[20:23], v7 offset:9216
    ds_read_b128 v[24:27], v7 offset:17408
    v_xor_b32 v7, 0x100, v7
    s_waitcnt lgkmcnt(3)
    s_waitcnt vmcnt(9)
    v_mfma_f32_16x16x32_bf16 v[80:83], v[48:51], v[28:31], v[80:83]
    v_mfma_f32_16x16x32_bf16 v[96:99], v[48:51], v[32:35], v[96:99]
    v_mfma_f32_16x16x32_bf16 v[112:115], v[48:51], v[36:39], v[112:115]
    buffer_load_dwordx4 v[48:51], v14, s[44:47], s75 offen offset:2048 sc1
    s_waitcnt vmcnt(9)
    v_mfma_f32_16x16x32_bf16 v[84:87], v[52:55], v[28:31], v[84:87]
    v_mfma_f32_16x16x32_bf16 v[100:103], v[52:55], v[32:35], v[100:103]
    v_mfma_f32_16x16x32_bf16 v[116:119], v[52:55], v[36:39], v[116:119]
    buffer_load_dwordx4 v[52:55], v14, s[44:47], s75 offen offset:3072 sc1
    s_xor_b32 s75, s75, 12288
    s_waitcnt vmcnt(9)
    v_mfma_f32_16x16x32_bf16 v[88:91], v[56:59], v[28:31], v[88:91]
    v_mfma_f32_16x16x32_bf16 v[104:107], v[56:59], v[32:35], v[104:107]
    v_mfma_f32_16x16x32_bf16 v[120:123], v[56:59], v[36:39], v[120:123]
    buffer_load_dwordx4 v[56:59], v14, s[44:47], s75 offen offset:0 sc1
    s_waitcnt vmcnt(9)
    v_mfma_f32_16x16x32_bf16 v[92:95], v[60:63], v[28:31], v[92:95]
    v_mfma_f32_16x16x32_bf16 v[108:111], v[60:63], v[32:35], v[108:111]
    v_mfma_f32_16x16x32_bf16 v[124:127], v[60:63], v[36:39], v[124:127]
    buffer_load_dwordx4 v[60:63], v14, s[44:47], s75 offen offset:1024 sc1
    ds_read_b128 v[28:31], v8 offset:1024
    ds_read_b128 v[32:35], v8 offset:9216
    ds_read_b128 v[36:39], v8 offset:17408
    v_xor_b32 v8, 0x100, v8
    s_waitcnt lgkmcnt(3)
    s_waitcnt vmcnt(9)
    v_mfma_f32_16x16x32_bf16 v[80:83], v[64:67], v[16:19], v[80:83]
    v_mfma_f32_16x16x32_bf16 v[96:99], v[64:67], v[20:23], v[96:99]
    v_mfma_f32_16x16x32_bf16 v[112:115], v[64:67], v[24:27], v[112:115]
    buffer_load_dwordx4 v[64:67], v14, s[44:47], s75 offen offset:2048 sc1
    s_waitcnt vmcnt(9)
    v_mfma_f32_16x16x32_bf16 v[84:87], v[68:71], v[16:19], v[84:87]
    v_mfma_f32_16x16x32_bf16 v[100:103], v[68:71], v[20:23], v[100:103]
    v_mfma_f32_16x16x32_bf16 v[116:119], v[68:71], v[24:27], v[116:119]
    buffer_load_dwordx4 v[68:71], v14, s[44:47], s75 offen offset:3072 sc1
    s_xor_b32 s75, s75, 4096
    s_waitcnt vmcnt(9)
    v_mfma_f32_16x16x32_bf16 v[88:91], v[72:75], v[16:19], v[88:91]
    v_mfma_f32_16x16x32_bf16 v[104:107], v[72:75], v[20:23], v[104:107]
    v_mfma_f32_16x16x32_bf16 v[120:123], v[72:75], v[24:27], v[120:123]
    buffer_load_dwordx4 v[72:75], v14, s[44:47], s75 offen offset:0 sc1
    s_waitcnt vmcnt(9)
    v_mfma_f32_16x16x32_bf16 v[92:95], v[76:79], v[16:19], v[92:95]
    v_mfma_f32_16x16x32_bf16 v[108:111], v[76:79], v[20:23], v[108:111]
    v_mfma_f32_16x16x32_bf16 v[124:127], v[76:79], v[24:27], v[124:127]
    buffer_load_dwordx4 v[76:79], v14, s[44:47], s75 offen offset:1024 sc1
    ds_read_b128 v[16:19], v9 offset:1024
    ds_read_b128 v[20:23], v9 offset:9216
    ds_read_b128 v[24:27], v9 offset:17408
    v_xor_b32 v9, 0x100, v9
    s_waitcnt lgkmcnt(3)
    s_waitcnt vmcnt(9)
    v_mfma_f32_16x16x32_bf16 v[80:83], v[40:43], v[28:31], v[80:83]
    v_mfma_f32_16x16x32_bf16 v[96:99], v[40:43], v[32:35], v[96:99]
    v_mfma_f32_16x16x32_bf16 v[112:115], v[40:43], v[36:39], v[112:115]
    buffer_load_dwordx4 v[40:43], v14, s[44:47], s75 offen offset:2048 sc1
    s_waitcnt vmcnt(9)
    v_mfma_f32_16x16x32_bf16 v[84:87], v[44:47], v[28:31], v[84:87]
    v_mfma_f32_16x16x32_bf16 v[100:103], v[44:47], v[32:35], v[100:103]
    v_mfma_f32_16x16x32_bf16 v[116:119], v[44:47], v[36:39], v[116:119]
    buffer_load_dwordx4 v[44:47], v14, s[44:47], s75 offen offset:3072 sc1
    s_xor_b32 s75, s75, 28672
    s_waitcnt vmcnt(9)
    v_mfma_f32_16x16x32_bf16 v[88:91], v[48:51], v[28:31], v[88:91]
    v_mfma_f32_16x16x32_bf16 v[104:107], v[48:51], v[32:35], v[104:107]
    v_mfma_f32_16x16x32_bf16 v[120:123], v[48:51], v[36:39], v[120:123]
    s_add_u32 m0, s70, 0
    s_nop 0
    buffer_load_dwordx4 v13, s[40:43], 0 offen offset:0 lds
    s_waitcnt vmcnt(9)
    v_mfma_f32_16x16x32_bf16 v[92:95], v[52:55], v[28:31], v[92:95]
    v_mfma_f32_16x16x32_bf16 v[108:111], v[52:55], v[32:35], v[108:111]
    v_mfma_f32_16x16x32_bf16 v[124:127], v[52:55], v[36:39], v[124:127]
    buffer_load_dwordx4 v13, s[40:43], s71 offen offset:1024 lds
    ds_read_b128 v[28:31], v10 offset:1024
    ds_read_b128 v[32:35], v10 offset:9216
    ds_read_b128 v[36:39], v10 offset:17408
    v_xor_b32 v10, 0x100, v10
    s_waitcnt lgkmcnt(3)
    s_waitcnt vmcnt(9)
    v_mfma_f32_16x16x32_bf16 v[80:83], v[56:59], v[16:19], v[80:83]
    v_mfma_f32_16x16x32_bf16 v[96:99], v[56:59], v[20:23], v[96:99]
    v_mfma_f32_16x16x32_bf16 v[112:115], v[56:59], v[24:27], v[112:115]
    buffer_load_dwordx4 v13, s[40:43], s72 offen offset:2048 lds
    s_waitcnt vmcnt(9)
    v_mfma_f32_16x16x32_bf16 v[84:87], v[60:63], v[16:19], v[84:87]
    v_mfma_f32_16x16x32_bf16 v[100:103], v[60:63], v[20:23], v[100:103]
    v_mfma_f32_16x16x32_bf16 v[116:119], v[60:63], v[24:27], v[116:119]
    buffer_load_dwordx4 v13, s[40:43], s73 offen offset:3072 lds
    v_xor_b32 v13, 16384, v13
    s_waitcnt vmcnt(9)
    v_mfma_f32_16x16x32_bf16 v[88:91], v[64:67], v[16:19], v[88:91]
    v_mfma_f32_16x16x32_bf16 v[104:107], v[64:67], v[20:23], v[104:107]
    v_mfma_f32_16x16x32_bf16 v[120:123], v[64:67], v[24:27], v[120:123]
    s_add_u32 m0, s70, 4096
    s_nop 0
    buffer_load_dwordx4 v13, s[40:43], 0 offen offset:0 lds
    s_waitcnt vmcnt(9)
    v_mfma_f32_16x16x32_bf16 v[92:95], v[68:71], v[16:19], v[92:95]
    v_mfma_f32_16x16x32_bf16 v[108:111], v[68:71], v[20:23], v[108:111]
    v_mfma_f32_16x16x32_bf16 v[124:127], v[68:71], v[24:27], v[124:127]
    buffer_load_dwordx4 v13, s[40:43], s71 offen offset:1024 lds
    s_waitcnt lgkmcnt(0)
    s_waitcnt vmcnt(9)
    v_mfma_f32_16x16x32_bf16 v[80:83], v[72:75], v[28:31], v[80:83]
    v_mfma_f32_16x16x32_bf16 v[96:99], v[72:75], v[32:35], v[96:99]
    v_mfma_f32_16x16x32_bf16 v[112:115], v[72:75], v[36:39], v[112:115]
    buffer_load_dwordx4 v13, s[40:43], s72 offen offset:2048 lds
    s_waitcnt vmcnt(9)
    v_mfma_f32_16x16x32_bf16 v[84:87], v[76:79], v[28:31], v[84:87]
    v_mfma_f32_16x16x32_bf16 v[100:103], v[76:79], v[32:35], v[100:103]
    v_mfma_f32_16x16x32_bf16 v[116:119], v[76:79], v[36:39], v[116:119]
    buffer_load_dwordx4 v13, s[40:43], s73 offen offset:3072 lds
    v_xor_b32 v13, 49152, v13
    s_waitcnt vmcnt(9)
    v_mfma_f32_16x16x32_bf16 v[88:91], v[40:43], v[28:31], v[88:91]
    v_mfma_f32_16x16x32_bf16 v[104:107], v[40:43], v[32:35], v[104:107]
    v_mfma_f32_16x16x32_bf16 v[120:123], v[40:43], v[36:39], v[120:123]
    s_add_u32 m0, s70, 8192
    s_nop 0
    buffer_load_dwordx4 v13, s[40:43], 0 offen offset:0 lds
    s_waitcnt vmcnt(9)
    v_mfma_f32_16x16x32_bf16 v[92:95], v[44:47], v[28:31], v[92:95]
    v_mfma_f32_16x16x32_bf16 v[108:111], v[44:47], v[32:35], v[108:111]
    v_mfma_f32_16x16x32_bf16 v[124:127], v[44:47], v[36:39], v[124:127]
    buffer_load_dwordx4 v13, s[40:43], s71 offen offset:1024 lds
    s_lshl_b32 s64, s31, 3
    v_add_u32 v0, s64, v4
    v_xor_b32 v0, v0, v3
    v_lshlrev_b32 v0, 4, v0
    v_lshl_add_u32 v0, v3, 9, v0
    v_xor_b32 v1, 64, v0
    s_mov_b32 s76, 0x00ff00ff
    s_mov_b32 s77, 0x00ff00ff
    v_cvt_pk_bf16_f32 v16, v80, v81
    v_cvt_pk_bf16_f32 v17, v82, v83
    v_cvt_pk_bf16_f32 v18, v84, v85
    v_cvt_pk_bf16_f32 v19, v86, v87
    ds_write_b128 v0, v[16:19] offset:21504
    v_cvt_pk_bf16_f32 v20, v88, v89
    v_cvt_pk_bf16_f32 v21, v90, v91
    v_cvt_pk_bf16_f32 v22, v92, v93
    v_cvt_pk_bf16_f32 v23, v94, v95
    ds_write_b128 v1, v[20:23] offset:21504
    v_cvt_pk_bf16_f32 v24, v96, v97
    v_cvt_pk_bf16_f32 v25, v98, v99
    v_cvt_pk_bf16_f32 v26, v100, v101
    v_cvt_pk_bf16_f32 v27, v102, v103
    ds_write_b128 v0, v[24:27] offset:29696
    v_cvt_pk_bf16_f32 v28, v104, v105
    v_cvt_pk_bf16_f32 v29, v106, v107
    v_cvt_pk_bf16_f32 v30, v108, v109
    v_cvt_pk_bf16_f32 v31, v110, v111
    ds_write_b128 v1, v[28:31] offset:29696
    s_mov_b64 exec, s[76:77]
    v_cvt_pk_bf16_f32 v32, v112, v113
    v_cvt_pk_bf16_f32 v33, v114, v115
    v_cvt_pk_bf16_f32 v34, v116, v117
    v_cvt_pk_bf16_f32 v35, v118, v119
    ds_write_b128 v0, v[32:35] offset:37888
    v_cvt_pk_bf16_f32 v36, v120, v121
    v_cvt_pk_bf16_f32 v37, v122, v123
    v_cvt_pk_bf16_f32 v38, v124, v125
    v_cvt_pk_bf16_f32 v39, v126, v127
    ds_write_b128 v1, v[36:39] offset:37888
    s_mov_b64 exec, -1
    s_waitcnt lgkmcnt(0)
    s_barrier
    buffer_load_dwordx4 v13, s[40:43], s72 offen offset:2048 lds
    buffer_load_dwordx4 v13, s[40:43], s73 offen offset:3072 lds
    v_xor_b32 v13, 16384, v13
    s_add_u32 m0, s70, 12288
    s_nop 0
    buffer_load_dwordx4 v13, s[40:43], 0 offen offset:0 lds
    buffer_load_dwordx4 v13, s[40:43], s71 offen offset:1024 lds
    buffer_load_dwordx4 v13, s[40:43], s72 offen offset:2048 lds
    buffer_load_dwordx4 v13, s[40:43], s73 offen offset:3072 lds
    v_xor_b32 v13, 114688, v13
    v_lshlrev_b32 v0, 4, v4
    v_and_b32 v1, 7, v3
    v_lshl_add_u32 v0, v1, 9, v0
    v_and_b32 v1, 8, v3
    v_lshl_add_u32 v0, v1, 3, v0
    s_mul_i32 s74, s1, 20480
    s_lshl_b32 s64, s31, 7
    s_add_u32 s74, s74, s64
    s_waitcnt vmcnt(8)
    ds_read_b64_tr_b16 v[48:49], v11 offset:0
    ds_read_b64_tr_b16 v[50:51], v11 offset:512
    ds_read_b64_tr_b16 v[52:53], v11 offset:8
    ds_read_b64_tr_b16 v[54:55], v11 offset:520
    ds_read_b64_tr_b16 v[56:57], v12 offset:0
    ds_read_b64_tr_b16 v[58:59], v12 offset:512
    ds_read_b64_tr_b16 v[60:61], v12 offset:8
    ds_read_b64_tr_b16 v[62:63], v12 offset:520
    ds_read_b64_tr_b16 v[64:65], v11 offset:4096
    ds_read_b64_tr_b16 v[66:67], v11 offset:4608
    ds_read_b64_tr_b16 v[68:69], v11 offset:4104
    ds_read_b64_tr_b16 v[70:71], v11 offset:4616
    ds_read_b64_tr_b16 v[72:73], v12 offset:4096
    ds_read_b64_tr_b16 v[74:75], v12 offset:4608
    ds_read_b64_tr_b16 v[76:77], v12 offset:4104
    ds_read_b64_tr_b16 v[78:79], v12 offset:4616
    s_waitcnt lgkmcnt(8)
    s_add_u32 m0, s70, 0
    s_nop 0
    buffer_load_dwordx4 v13, s[40:43], 0 offen offset:0 lds
    buffer_load_dwordx4 v13, s[40:43], s71 offen offset:1024 lds
    buffer_load_dwordx4 v13, s[40:43], s72 offen offset:2048 lds
    buffer_load_dwordx4 v13, s[40:43], s73 offen offset:3072 lds
    v_xor_b32 v13, 16384, v13
    s_waitcnt lgkmcnt(0)
    s_add_u32 m0, s70, 4096
    s_nop 0
    buffer_load_dwordx4 v13, s[40:43], 0 offen offset:0 lds
    buffer_load_dwordx4 v13, s[40:43], s71 offen offset:1024 lds
    buffer_load_dwordx4 v13, s[40:43], s72 offen offset:2048 lds
    buffer_load_dwordx4 v13, s[40:43], s73 offen offset:3072 lds
    v_xor_b32 v13, 49152, v13
    s_lshl_b32 s64, s31, 12
    s_add_u32 s78, s64, 21504
    s_add_u32 s79, s64, 148480
    s_cmp_eq_u32 s31, 3
    s_cselect_b32 s79, 37888, s79
    s_sub_u32 s76, s78, s70
    s_sub_u32 s77, s79, s78
    v_xor_b32 v40, 0x100, v7
    v_xor_b32 v41, 0x100, v8
    v_xor_b32 v42, 0x100, v9
    v_xor_b32 v43, 0x100, v10
    s_barrier
    s_mov_b32 m0, s78
    s_nop 0
    buffer_load_dwordx4 v13, s[40:43], 0 offen offset:0 lds
    buffer_load_dwordx4 v13, s[40:43], s71 offen offset:1024 lds
    buffer_load_dwordx4 v13, s[40:43], s72 offen offset:2048 lds
    buffer_load_dwordx4 v13, s[40:43], s73 offen offset:3072 lds
    v_xor_b32 v13, 16384, v13
    s_mov_b32 m0, s79
    s_nop 0
    buffer_load_dwordx4 v13, s[40:43], 0 offen offset:0 lds
    buffer_load_dwordx4 v13, s[40:43], s71 offen offset:1024 lds
    buffer_load_dwordx4 v13, s[40:43], s72 offen offset:2048 lds
    buffer_load_dwordx4 v13, s[40:43], s73 offen offset:3072 lds
    v_xor_b32 v13, 114688, v13
    s_setprio 0
L_prog_45:
    ds_read_b128 v[16:19], v5 offset:32
    s_waitcnt lgkmcnt(0)
    v_min3_u32 v16, v16, v17, v18
    v_min_u32 v16, v16, v19
    v_cmp_gt_u32 vcc, 1, v16
    s_cbranch_vccnz L_retry_46
    ds_read_b128 v[16:19], v7 offset:1024
    ds_read_b128 v[20:23], v7 offset:9216
    ds_read_b128 v[24:27], v7 offset:17408
    s_waitcnt vmcnt(8)
    s_waitcnt lgkmcnt(0)
    v_mfma_f32_16x16x32_bf16 v[80:83], v[128:131], v[16:19], 0
    ds_read_b128 v[28:31], v8 offset:1024
    v_mfma_f32_16x16x32_bf16 v[96:99], v[128:131], v[20:23], 0
    ds_read_b128 v[32:35], v8 offset:9216
    v_mfma_f32_16x16x32_bf16 v[112:115], v[128:131], v[24:27], 0
    ds_read_b128 v[36:39], v8 offset:17408
    v_mfma_f32_16x16x32_bf16 v[84:87], v[132:135], v[16:19], 0
    v_mfma_f32_16x16x32_bf16 v[100:103], v[132:135], v[20:23], 0
    v_mfma_f32_16x16x32_bf16 v[116:119], v[132:135], v[24:27], 0
    v_mfma_f32_16x16x32_bf16 v[88:91], v[136:139], v[16:19], 0
    v_mfma_f32_16x16x32_bf16 v[104:107], v[136:139], v[20:23], 0
    v_mfma_f32_16x16x32_bf16 v[120:123], v[136:139], v[24:27], 0
    v_mfma_f32_16x16x32_bf16 v[92:95], v[140:143], v[16:19], 0
    v_mfma_f32_16x16x32_bf16 v[108:111], v[140:143], v[20:23], 0
    v_mfma_f32_16x16x32_bf16 v[124:127], v[140:143], v[24:27], 0
    s_waitcnt lgkmcnt(0)
    v_mfma_f32_16x16x32_bf16 v[80:83], v[144:147], v[28:31], v[80:83]
    ds_read_b128 v[16:19], v9 offset:1024
    v_mfma_f32_16x16x32_bf16 v[96:99], v[144:147], v[32:35], v[96:99]
    ds_read_b128 v[20:23], v9 offset:9216
    v_mfma_f32_16x16x32_bf16 v[112:115], v[144:147], v[36:39], v[112:115]
    ds_read_b128 v[24:27], v9 offset:17408
    v_mfma_f32_16x16x32_bf16 v[84:87], v[148:151], v[28:31], v[84:87]
    ds_read_b64_tr_b16 v[128:129], v11 offset:8192
    v_mfma_f32_16x16x32_bf16 v[100:103], v[148:151], v[32:35], v[100:103]
    ds_read_b64_tr_b16 v[130:131], v11 offset:8704
    v_mfma_f32_16x16x32_bf16 v[116:119], v[148:151], v[36:39], v[116:119]
    ds_read_b64_tr_b16 v[132:133], v11 offset:8200
    v_mfma_f32_16x16x32_bf16 v[88:91], v[152:155], v[28:31], v[88:91]
    ds_read_b64_tr_b16 v[134:135], v11 offset:8712
    v_mfma_f32_16x16x32_bf16 v[104:107], v[152:155], v[32:35], v[104:107]
    ds_read_b64_tr_b16 v[136:137], v12 offset:8192
    v_mfma_f32_16x16x32_bf16 v[120:123], v[152:155], v[36:39], v[120:123]
    ds_read_b64_tr_b16 v[138:139], v12 offset:8704
    v_mfma_f32_16x16x32_bf16 v[92:95], v[156:159], v[28:31], v[92:95]
    ds_read_b64_tr_b16 v[140:141], v12 offset:8200
    v_mfma_f32_16x16x32_bf16 v[108:111], v[156:159], v[32:35], v[108:111]
    ds_read_b64_tr_b16 v[142:143], v12 offset:8712
    v_mfma_f32_16x16x32_bf16 v[124:127], v[156:159], v[36:39], v[124:127]
    s_waitcnt lgkmcnt(8)
    v_mfma_f32_16x16x32_bf16 v[80:83], v[160:163], v[16:19], v[80:83]
    ds_read_b128 v[28:31], v10 offset:1024
    v_mfma_f32_16x16x32_bf16 v[96:99], v[160:163], v[20:23], v[96:99]
    ds_read_b128 v[32:35], v10 offset:9216
    v_mfma_f32_16x16x32_bf16 v[112:115], v[160:163], v[24:27], v[112:115]
    ds_read_b128 v[36:39], v10 offset:17408
    v_mfma_f32_16x16x32_bf16 v[84:87], v[164:167], v[16:19], v[84:87]
    ds_read_b64_tr_b16 v[144:145], v11 offset:12288
    v_mfma_f32_16x16x32_bf16 v[100:103], v[164:167], v[20:23], v[100:103]
    ds_read_b64_tr_b16 v[146:147], v11 offset:12800
    v_mfma_f32_16x16x32_bf16 v[116:119], v[164:167], v[24:27], v[116:119]
    ds_read_b64_tr_b16 v[148:149], v11 offset:12296
    v_mfma_f32_16x16x32_bf16 v[88:91], v[168:171], v[16:19], v[88:91]
    ds_read_b64_tr_b16 v[150:151], v11 offset:12808
    v_mfma_f32_16x16x32_bf16 v[104:107], v[168:171], v[20:23], v[104:107]
    ds_read_b64_tr_b16 v[152:153], v12 offset:12288
    v_mfma_f32_16x16x32_bf16 v[120:123], v[168:171], v[24:27], v[120:123]
    ds_read_b64_tr_b16 v[154:155], v12 offset:12800
    v_mfma_f32_16x16x32_bf16 v[92:95], v[172:175], v[16:19], v[92:95]
    ds_read_b64_tr_b16 v[156:157], v12 offset:12296
    v_mfma_f32_16x16x32_bf16 v[108:111], v[172:175], v[20:23], v[108:111]
    ds_read_b64_tr_b16 v[158:159], v12 offset:12808
    v_mfma_f32_16x16x32_bf16 v[124:127], v[172:175], v[24:27], v[124:127]
    s_waitcnt lgkmcnt(8)
    v_mfma_f32_16x16x32_bf16 v[80:83], v[176:179], v[28:31], v[80:83]
    ds_read_b128 v[16:19], v40 offset:1024
    v_mfma_f32_16x16x32_bf16 v[96:99], v[176:179], v[32:35], v[96:99]
    ds_read_b128 v[20:23], v40 offset:9216
    v_mfma_f32_16x16x32_bf16 v[112:115], v[176:179], v[36:39], v[112:115]
    ds_read_b128 v[24:27], v40 offset:17408
    v_mfma_f32_16x16x32_bf16 v[84:87], v[180:183], v[28:31], v[84:87]
    ds_read_b64_tr_b16 v[160:161], v11 offset:0
    v_mfma_f32_16x16x32_bf16 v[100:103], v[180:183], v[32:35], v[100:103]
    ds_read_b64_tr_b16 v[162:163], v11 offset:512
    v_mfma_f32_16x16x32_bf16 v[116:119], v[180:183], v[36:39], v[116:119]
    ds_read_b64_tr_b16 v[164:165], v11 offset:8
    v_mfma_f32_16x16x32_bf16 v[88:91], v[184:187], v[28:31], v[88:91]
    ds_read_b64_tr_b16 v[166:167], v11 offset:520
    v_mfma_f32_16x16x32_bf16 v[104:107], v[184:187], v[32:35], v[104:107]
    ds_read_b64_tr_b16 v[168:169], v12 offset:0
    v_mfma_f32_16x16x32_bf16 v[120:123], v[184:187], v[36:39], v[120:123]
    ds_read_b64_tr_b16 v[170:171], v12 offset:512
    v_mfma_f32_16x16x32_bf16 v[92:95], v[188:191], v[28:31], v[92:95]
    ds_read_b64_tr_b16 v[172:173], v12 offset:8
    v_mfma_f32_16x16x32_bf16 v[108:111], v[188:191], v[32:35], v[108:111]
    ds_read_b64_tr_b16 v[174:175], v12 offset:520
    v_mfma_f32_16x16x32_bf16 v[124:127], v[188:191], v[36:39], v[124:127]
    s_waitcnt lgkmcnt(8)
    v_mfma_f32_16x16x32_bf16 v[80:83], v[192:195], v[16:19], v[80:83]
    ds_read_b128 v[28:31], v41 offset:1024
    v_mfma_f32_16x16x32_bf16 v[96:99], v[192:195], v[20:23], v[96:99]
    ds_read_b128 v[32:35], v41 offset:9216
    v_mfma_f32_16x16x32_bf16 v[112:115], v[192:195], v[24:27], v[112:115]
    ds_read_b128 v[36:39], v41 offset:17408
    v_mfma_f32_16x16x32_bf16 v[84:87], v[196:199], v[16:19], v[84:87]
    ds_read_b64_tr_b16 v[176:177], v11 offset:4096
    v_mfma_f32_16x16x32_bf16 v[100:103], v[196:199], v[20:23], v[100:103]
    ds_read_b64_tr_b16 v[178:179], v11 offset:4608
    v_mfma_f32_16x16x32_bf16 v[116:119], v[196:199], v[24:27], v[116:119]
    ds_read_b64_tr_b16 v[180:181], v11 offset:4104
    v_mfma_f32_16x16x32_bf16 v[88:91], v[200:203], v[16:19], v[88:91]
    ds_read_b64_tr_b16 v[182:183], v11 offset:4616
    v_mfma_f32_16x16x32_bf16 v[104:107], v[200:203], v[20:23], v[104:107]
    ds_read_b64_tr_b16 v[184:185], v12 offset:4096
    v_mfma_f32_16x16x32_bf16 v[120:123], v[200:203], v[24:27], v[120:123]
    ds_read_b64_tr_b16 v[186:187], v12 offset:4608
    v_mfma_f32_16x16x32_bf16 v[92:95], v[204:207], v[16:19], v[92:95]
    ds_read_b64_tr_b16 v[188:189], v12 offset:4104
    v_mfma_f32_16x16x32_bf16 v[108:111], v[204:207], v[20:23], v[108:111]
    ds_read_b64_tr_b16 v[190:191], v12 offset:4616
    v_mfma_f32_16x16x32_bf16 v[124:127], v[204:207], v[24:27], v[124:127]
    s_waitcnt lgkmcnt(8)
    v_mfma_f32_16x16x32_bf16 v[80:83], v[208:211], v[28:31], v[80:83]
    ds_read_b128 v[16:19], v42 offset:1024
    v_mfma_f32_16x16x32_bf16 v[96:99], v[208:211], v[32:35], v[96:99]
    ds_read_b128 v[20:23], v42 offset:9216
    v_mfma_f32_16x16x32_bf16 v[112:115], v[208:211], v[36:39], v[112:115]
    ds_read_b128 v[24:27], v42 offset:17408
    v_mfma_f32_16x16x32_bf16 v[84:87], v[212:215], v[28:31], v[84:87]
    v_mfma_f32_16x16x32_bf16 v[100:103], v[212:215], v[32:35], v[100:103]
    v_mfma_f32_16x16x32_bf16 v[116:119], v[212:215], v[36:39], v[116:119]
    v_mfma_f32_16x16x32_bf16 v[88:91], v[216:219], v[28:31], v[88:91]
    v_mfma_f32_16x16x32_bf16 v[104:107], v[216:219], v[32:35], v[104:107]
    v_mfma_f32_16x16x32_bf16 v[120:123], v[216:219], v[36:39], v[120:123]
    v_mfma_f32_16x16x32_bf16 v[92:95], v[220:223], v[28:31], v[92:95]
    v_mfma_f32_16x16x32_bf16 v[108:111], v[220:223], v[32:35], v[108:111]
    v_mfma_f32_16x16x32_bf16 v[124:127], v[220:223], v[36:39], v[124:127]
    s_waitcnt lgkmcnt(0)
    v_mfma_f32_16x16x32_bf16 v[80:83], v[224:227], v[16:19], v[80:83]
    v_add_u32 v11, s76, v11
    v_add_u32 v12, s76, v12
    v_mfma_f32_16x16x32_bf16 v[96:99], v[224:227], v[20:23], v[96:99]
    ds_read_b128 v[28:31], v43 offset:1024
    v_mfma_f32_16x16x32_bf16 v[112:115], v[224:227], v[24:27], v[112:115]
    ds_read_b128 v[32:35], v43 offset:9216
    v_mfma_f32_16x16x32_bf16 v[84:87], v[228:231], v[16:19], v[84:87]
    ds_read_b128 v[36:39], v43 offset:17408
    v_mfma_f32_16x16x32_bf16 v[100:103], v[228:231], v[20:23], v[100:103]
    s_waitcnt vmcnt(4)
    ds_read_b64_tr_b16 v[192:193], v11 offset:0
    v_mfma_f32_16x16x32_bf16 v[116:119], v[228:231], v[24:27], v[116:119]
    ds_read_b64_tr_b16 v[194:195], v11 offset:512
    v_mfma_f32_16x16x32_bf16 v[88:91], v[232:235], v[16:19], v[88:91]
    ds_read_b64_tr_b16 v[196:197], v11 offset:8
    v_mfma_f32_16x16x32_bf16 v[104:107], v[232:235], v[20:23], v[104:107]
    ds_read_b64_tr_b16 v[198:199], v11 offset:520
    v_mfma_f32_16x16x32_bf16 v[120:123], v[232:235], v[24:27], v[120:123]
    ds_read_b64_tr_b16 v[200:201], v12 offset:0
    v_mfma_f32_16x16x32_bf16 v[92:95], v[236:239], v[16:19], v[92:95]
    ds_read_b64_tr_b16 v[202:203], v12 offset:512
    v_mfma_f32_16x16x32_bf16 v[108:111], v[236:239], v[20:23], v[108:111]
    ds_read_b64_tr_b16 v[204:205], v12 offset:8
    v_mfma_f32_16x16x32_bf16 v[124:127], v[236:239], v[24:27], v[124:127]
    ds_read_b64_tr_b16 v[206:207], v12 offset:520
    s_waitcnt lgkmcnt(8)
    v_mfma_f32_16x16x32_bf16 v[80:83], v[240:243], v[28:31], v[80:83]
    v_add_u32 v11, s77, v11
    v_add_u32 v12, s77, v12
    v_mfma_f32_16x16x32_bf16 v[96:99], v[240:243], v[32:35], v[96:99]
    s_waitcnt vmcnt(0)
    ds_read_b64_tr_b16 v[208:209], v11 offset:0
    v_mfma_f32_16x16x32_bf16 v[112:115], v[240:243], v[36:39], v[112:115]
    ds_read_b64_tr_b16 v[210:211], v11 offset:512
    v_mfma_f32_16x16x32_bf16 v[84:87], v[244:247], v[28:31], v[84:87]
    ds_read_b64_tr_b16 v[212:213], v11 offset:8
    v_mfma_f32_16x16x32_bf16 v[100:103], v[244:247], v[32:35], v[100:103]
    ds_read_b64_tr_b16 v[214:215], v11 offset:520
    v_mfma_f32_16x16x32_bf16 v[116:119], v[244:247], v[36:39], v[116:119]
    ds_read_b64_tr_b16 v[216:217], v12 offset:0
    v_mfma_f32_16x16x32_bf16 v[88:91], v[248:251], v[28:31], v[88:91]
    ds_read_b64_tr_b16 v[218:219], v12 offset:512
    v_mfma_f32_16x16x32_bf16 v[104:107], v[248:251], v[32:35], v[104:107]
    ds_read_b64_tr_b16 v[220:221], v12 offset:8
    v_mfma_f32_16x16x32_bf16 v[120:123], v[248:251], v[36:39], v[120:123]
    ds_read_b64_tr_b16 v[222:223], v12 offset:520
    v_mfma_f32_16x16x32_bf16 v[92:95], v[252:255], v[28:31], v[92:95]
    v_mfma_f32_16x16x32_bf16 v[108:111], v[252:255], v[32:35], v[108:111]
    v_mfma_f32_16x16x32_bf16 v[124:127], v[252:255], v[36:39], v[124:127]
    s_add_u32 s75, s74, 4096
    s_add_u32 s76, s74, 8192
    s_add_u32 s77, s74, 12288
    s_add_u32 s78, s74, 16384
L_prog_47:
    ds_read_b128 v[16:19], v5 offset:32
    s_waitcnt lgkmcnt(0)
    v_min3_u32 v16, v16, v17, v18
    v_min_u32 v16, v16, v19
    v_cmp_gt_u32 vcc, 1, v16
    s_cbranch_vccnz L_retry_48
    ds_read_b128 v[16:19], v7 offset:58368
    ds_read_b128 v[20:23], v8 offset:58368
    ds_read_b128 v[24:27], v9 offset:58368
    ds_read_b128 v[28:31], v10 offset:58368
    ds_read_b128 v[32:35], v40 offset:58368
    ds_read_b128 v[36:39], v41 offset:58368
    ds_read_b128 v[44:47], v42 offset:58368
    ds_read_b128 v[252:255], v43 offset:58368
    s_waitcnt lgkmcnt(7)
    v_mfma_f32_16x16x32_bf16 v[120:123], v[56:59], v[16:19], v[120:123]
    v_mfma_f32_16x16x32_bf16 v[124:127], v[60:63], v[16:19], v[124:127]
    v_mfma_f32_16x16x32_bf16 v[112:115], v[48:51], v[16:19], v[112:115]
    v_mfma_f32_16x16x32_bf16 v[116:119], v[52:55], v[16:19], v[116:119]
    s_waitcnt lgkmcnt(6)
    v_mfma_f32_16x16x32_bf16 v[120:123], v[72:75], v[20:23], v[120:123]
    v_mfma_f32_16x16x32_bf16 v[124:127], v[76:79], v[20:23], v[124:127]
    v_mfma_f32_16x16x32_bf16 v[112:115], v[64:67], v[20:23], v[112:115]
    v_mfma_f32_16x16x32_bf16 v[116:119], v[68:71], v[20:23], v[116:119]
    s_waitcnt lgkmcnt(5)
    v_mfma_f32_16x16x32_bf16 v[120:123], v[136:139], v[24:27], v[120:123]
    v_mfma_f32_16x16x32_bf16 v[124:127], v[140:143], v[24:27], v[124:127]
    v_mfma_f32_16x16x32_bf16 v[112:115], v[128:131], v[24:27], v[112:115]
    v_mfma_f32_16x16x32_bf16 v[116:119], v[132:135], v[24:27], v[116:119]
    s_waitcnt lgkmcnt(4)
    v_mfma_f32_16x16x32_bf16 v[120:123], v[152:155], v[28:31], v[120:123]
    v_mfma_f32_16x16x32_bf16 v[124:127], v[156:159], v[28:31], v[124:127]
    v_mfma_f32_16x16x32_bf16 v[112:115], v[144:147], v[28:31], v[112:115]
    v_mfma_f32_16x16x32_bf16 v[116:119], v[148:151], v[28:31], v[116:119]
    s_waitcnt lgkmcnt(3)
    v_mfma_f32_16x16x32_bf16 v[120:123], v[168:171], v[32:35], v[120:123]
    v_mfma_f32_16x16x32_bf16 v[124:127], v[172:175], v[32:35], v[124:127]
    v_mfma_f32_16x16x32_bf16 v[112:115], v[160:163], v[32:35], v[112:115]
    v_mfma_f32_16x16x32_bf16 v[116:119], v[164:167], v[32:35], v[116:119]
    s_waitcnt lgkmcnt(2)
    v_mfma_f32_16x16x32_bf16 v[120:123], v[184:187], v[36:39], v[120:123]
    v_mfma_f32_16x16x32_bf16 v[124:127], v[188:191], v[36:39], v[124:127]
    v_mfma_f32_16x16x32_bf16 v[112:115], v[176:179], v[36:39], v[112:115]
    v_mfma_f32_16x16x32_bf16 v[116:119], v[180:183], v[36:39], v[116:119]
    s_waitcnt lgkmcnt(1)
    v_mfma_f32_16x16x32_bf16 v[120:123], v[200:203], v[44:47], v[120:123]
    v_mfma_f32_16x16x32_bf16 v[124:127], v[204:207], v[44:47], v[124:127]
    v_mfma_f32_16x16x32_bf16 v[112:115], v[192:195], v[44:47], v[112:115]
    v_mfma_f32_16x16x32_bf16 v[116:119], v[196:199], v[44:47], v[116:119]
    s_waitcnt lgkmcnt(0)
    v_mfma_f32_16x16x32_bf16 v[120:123], v[216:219], v[252:255], v[120:123]
    v_mfma_f32_16x16x32_bf16 v[124:127], v[220:223], v[252:255], v[124:127]
    v_mfma_f32_16x16x32_bf16 v[112:115], v[208:211], v[252:255], v[112:115]
    v_mfma_f32_16x16x32_bf16 v[116:119], v[212:215], v[252:255], v[116:119]
L_prog_49:
    ds_read_b128 v[16:19], v5 offset:32
    s_waitcnt lgkmcnt(0)
    v_min3_u32 v16, v16, v17, v18
    v_min_u32 v16, v16, v19
    v_cmp_gt_u32 vcc, 3, v16
    s_cbranch_vccnz L_retry_50
    ds_read_b128 v[16:19], v7 offset:41984
    ds_read_b128 v[20:23], v8 offset:41984
    ds_read_b128 v[24:27], v9 offset:41984
    ds_read_b128 v[28:31], v10 offset:41984
    ds_read_b128 v[32:35], v40 offset:41984
    ds_read_b128 v[36:39], v41 offset:41984
    ds_read_b128 v[44:47], v42 offset:41984
    ds_read_b128 v[252:255], v43 offset:41984
    s_waitcnt lgkmcnt(7)
    v_mfma_f32_16x16x32_bf16 v[88:91], v[56:59], v[16:19], v[88:91]
    v_cvt_pk_bf16_f32 v248, v120, v121
    v_mfma_f32_16x16x32_bf16 v[92:95], v[60:63], v[16:19], v[92:95]
    v_cvt_pk_bf16_f32 v249, v122, v123
    v_mfma_f32_16x16x32_bf16 v[80:83], v[48:51], v[16:19], v[80:83]
    v_cvt_pk_bf16_f32 v250, v124, v125
    v_mfma_f32_16x16x32_bf16 v[84:87], v[52:55], v[16:19], v[84:87]
    v_cvt_pk_bf16_f32 v251, v126, v127
    s_waitcnt lgkmcnt(6)
    v_mfma_f32_16x16x32_bf16 v[88:91], v[72:75], v[20:23], v[88:91]
    v_cvt_pk_bf16_f32 v244, v112, v113
    v_mfma_f32_16x16x32_bf16 v[92:95], v[76:79], v[20:23], v[92:95]
    v_cvt_pk_bf16_f32 v245, v114, v115
    v_mfma_f32_16x16x32_bf16 v[80:83], v[64:67], v[20:23], v[80:83]
    v_cvt_pk_bf16_f32 v246, v116, v117
    v_mfma_f32_16x16x32_bf16 v[84:87], v[68:71], v[20:23], v[84:87]
    v_cvt_pk_bf16_f32 v247, v118, v119
    s_waitcnt lgkmcnt(5)
    v_mfma_f32_16x16x32_bf16 v[88:91], v[136:139], v[24:27], v[88:91]
    v_mov_b32_dpp v244, v248 row_ror:8 row_mask:0xf bank_mask:0xc
    v_mfma_f32_16x16x32_bf16 v[92:95], v[140:143], v[24:27], v[92:95]
    v_mov_b32_dpp v245, v249 row_ror:8 row_mask:0xf bank_mask:0xc
    v_mfma_f32_16x16x32_bf16 v[80:83], v[128:131], v[24:27], v[80:83]
    v_mov_b32_dpp v246, v250 row_ror:8 row_mask:0xf bank_mask:0xc
    v_mfma_f32_16x16x32_bf16 v[84:87], v[132:135], v[24:27], v[84:87]
    v_mov_b32_dpp v247, v251 row_ror:8 row_mask:0xf bank_mask:0xc
    s_waitcnt lgkmcnt(4)
    v_mfma_f32_16x16x32_bf16 v[88:91], v[152:155], v[28:31], v[88:91]
    v_mfma_f32_16x16x32_bf16 v[92:95], v[156:159], v[28:31], v[92:95]
    v_mfma_f32_16x16x32_bf16 v[80:83], v[144:147], v[28:31], v[80:83]
    v_mfma_f32_16x16x32_bf16 v[84:87], v[148:151], v[28:31], v[84:87]
    s_waitcnt lgkmcnt(3)
    v_mfma_f32_16x16x32_bf16 v[88:91], v[168:171], v[32:35], v[88:91]
    v_mfma_f32_16x16x32_bf16 v[92:95], v[172:175], v[32:35], v[92:95]
    v_mfma_f32_16x16x32_bf16 v[80:83], v[160:163], v[32:35], v[80:83]
    v_mfma_f32_16x16x32_bf16 v[84:87], v[164:167], v[32:35], v[84:87]
    s_waitcnt lgkmcnt(2)
    v_mfma_f32_16x16x32_bf16 v[88:91], v[184:187], v[36:39], v[88:91]
    v_mfma_f32_16x16x32_bf16 v[92:95], v[188:191], v[36:39], v[92:95]
    v_mfma_f32_16x16x32_bf16 v[80:83], v[176:179], v[36:39], v[80:83]
    v_mfma_f32_16x16x32_bf16 v[84:87], v[180:183], v[36:39], v[84:87]
    s_waitcnt lgkmcnt(1)
    v_mfma_f32_16x16x32_bf16 v[88:91], v[200:203], v[44:47], v[88:91]
    v_mfma_f32_16x16x32_bf16 v[92:95], v[204:207], v[44:47], v[92:95]
    v_mfma_f32_16x16x32_bf16 v[80:83], v[192:195], v[44:47], v[80:83]
    v_mfma_f32_16x16x32_bf16 v[84:87], v[196:199], v[44:47], v[84:87]
    s_waitcnt lgkmcnt(0)
    v_mfma_f32_16x16x32_bf16 v[88:91], v[216:219], v[252:255], v[88:91]
    v_mfma_f32_16x16x32_bf16 v[92:95], v[220:223], v[252:255], v[92:95]
    v_mfma_f32_16x16x32_bf16 v[80:83], v[208:211], v[252:255], v[80:83]
    v_mfma_f32_16x16x32_bf16 v[84:87], v[212:215], v[252:255], v[84:87]
    s_nop 4
    v_cvt_pk_bf16_f32 v228, v88, v89
    v_cvt_pk_bf16_f32 v229, v90, v91
    v_cvt_pk_bf16_f32 v230, v92, v93
    v_cvt_pk_bf16_f32 v231, v94, v95
    v_cvt_pk_bf16_f32 v224, v80, v81
    v_cvt_pk_bf16_f32 v225, v82, v83
    v_cvt_pk_bf16_f32 v226, v84, v85
    v_cvt_pk_bf16_f32 v227, v86, v87
    v_cvt_pk_bf16_f32 v240, v80, v81
    v_cvt_pk_bf16_f32 v241, v82, v83
    v_cvt_pk_bf16_f32 v242, v84, v85
    v_cvt_pk_bf16_f32 v243, v86, v87
    v_mov_b32_dpp v224, v228 row_ror:8 row_mask:0xf bank_mask:0xc
    v_mov_b32_dpp v225, v229 row_ror:8 row_mask:0xf bank_mask:0xc
    v_mov_b32_dpp v226, v230 row_ror:8 row_mask:0xf bank_mask:0xc
    v_mov_b32_dpp v227, v231 row_ror:8 row_mask:0xf bank_mask:0xc
    v_mov_b32_dpp v228, v240 row_ror:8 row_mask:0xf bank_mask:0x3
    v_mov_b32_dpp v229, v241 row_ror:8 row_mask:0xf bank_mask:0x3
    v_mov_b32_dpp v230, v242 row_ror:8 row_mask:0xf bank_mask:0x3
    v_mov_b32_dpp v231, v243 row_ror:8 row_mask:0xf bank_mask:0x3
L_prog_51:
    ds_read_b128 v[16:19], v5 offset:48
    s_waitcnt lgkmcnt(0)
    v_min3_u32 v16, v16, v17, v18
    v_min_u32 v16, v16, v19
    v_cmp_gt_u32 vcc, 1, v16
    s_cbranch_vccnz L_retry_52
    s_setprio 2
    buffer_store_dwordx4 v[244:247], v0, s[48:51], s78 offen sc1
    buffer_store_dwordx4 v[224:227], v0, s[48:51], s74 offen sc1
    buffer_store_dwordx4 v[228:231], v0, s[48:51], s75 offen sc1
    s_setprio 0
    v_lshlrev_b32 v1, 4, v4
    v_lshl_add_u32 v1, v3, 9, v1
    s_barrier
    s_setprio 2
    ds_read_b128 v[16:19], v7 offset:50176
    ds_read_b128 v[20:23], v8 offset:50176
    ds_read_b128 v[24:27], v9 offset:50176
    ds_read_b128 v[28:31], v10 offset:50176
    ds_read_b128 v[32:35], v40 offset:50176
    ds_read_b128 v[36:39], v41 offset:50176
    ds_read_b128 v[44:47], v42 offset:50176
    ds_read_b128 v[252:255], v43 offset:50176
    s_waitcnt lgkmcnt(7)
    v_mfma_f32_16x16x32_bf16 v[104:107], v[56:59], v[16:19], v[104:107]
    v_mfma_f32_16x16x32_bf16 v[108:111], v[60:63], v[16:19], v[108:111]
    s_waitcnt lgkmcnt(6)
    v_mfma_f32_16x16x32_bf16 v[104:107], v[72:75], v[20:23], v[104:107]
    v_mfma_f32_16x16x32_bf16 v[108:111], v[76:79], v[20:23], v[108:111]
    s_waitcnt lgkmcnt(5)
    v_mfma_f32_16x16x32_bf16 v[104:107], v[136:139], v[24:27], v[104:107]
    v_mfma_f32_16x16x32_bf16 v[108:111], v[140:143], v[24:27], v[108:111]
    s_waitcnt lgkmcnt(4)
    v_mfma_f32_16x16x32_bf16 v[104:107], v[152:155], v[28:31], v[104:107]
    v_mfma_f32_16x16x32_bf16 v[108:111], v[156:159], v[28:31], v[108:111]
    s_waitcnt lgkmcnt(3)
    v_mfma_f32_16x16x32_bf16 v[104:107], v[168:171], v[32:35], v[104:107]
    v_mfma_f32_16x16x32_bf16 v[108:111], v[172:175], v[32:35], v[108:111]
    s_waitcnt lgkmcnt(2)
    v_mfma_f32_16x16x32_bf16 v[104:107], v[184:187], v[36:39], v[104:107]
    v_mfma_f32_16x16x32_bf16 v[108:111], v[188:191], v[36:39], v[108:111]
    s_waitcnt lgkmcnt(1)
    v_mfma_f32_16x16x32_bf16 v[104:107], v[200:203], v[44:47], v[104:107]
    v_mfma_f32_16x16x32_bf16 v[108:111], v[204:207], v[44:47], v[108:111]
    s_waitcnt lgkmcnt(0)
    v_mfma_f32_16x16x32_bf16 v[104:107], v[216:219], v[252:255], v[104:107]
    v_mfma_f32_16x16x32_bf16 v[108:111], v[220:223], v[252:255], v[108:111]
    v_mfma_f32_16x16x32_bf16 v[96:99], v[48:51], v[16:19], v[96:99]
    v_mfma_f32_16x16x32_bf16 v[100:103], v[52:55], v[16:19], v[100:103]
    v_mfma_f32_16x16x32_bf16 v[96:99], v[64:67], v[20:23], v[96:99]
    v_mfma_f32_16x16x32_bf16 v[100:103], v[68:71], v[20:23], v[100:103]
    v_mfma_f32_16x16x32_bf16 v[96:99], v[128:131], v[24:27], v[96:99]
    v_mfma_f32_16x16x32_bf16 v[100:103], v[132:135], v[24:27], v[100:103]
    v_mfma_f32_16x16x32_bf16 v[96:99], v[144:147], v[28:31], v[96:99]
    v_mfma_f32_16x16x32_bf16 v[100:103], v[148:151], v[28:31], v[100:103]
    v_cvt_pk_bf16_f32 v236, v104, v105
    v_mfma_f32_16x16x32_bf16 v[96:99], v[160:163], v[32:35], v[96:99]
    v_cvt_pk_bf16_f32 v237, v106, v107
    v_mfma_f32_16x16x32_bf16 v[100:103], v[164:167], v[32:35], v[100:103]
    v_cvt_pk_bf16_f32 v238, v108, v109
    v_mfma_f32_16x16x32_bf16 v[96:99], v[176:179], v[36:39], v[96:99]
    v_cvt_pk_bf16_f32 v239, v110, v111
    v_mfma_f32_16x16x32_bf16 v[100:103], v[180:183], v[36:39], v[100:103]
    buffer_store_dwordx4 v[236:239], v1, s[48:51], s76 offen offset:64 sc1
    v_mfma_f32_16x16x32_bf16 v[96:99], v[192:195], v[44:47], v[96:99]
    v_mfma_f32_16x16x32_bf16 v[100:103], v[196:199], v[44:47], v[100:103]
    v_mfma_f32_16x16x32_bf16 v[96:99], v[208:211], v[252:255], v[96:99]
    v_mfma_f32_16x16x32_bf16 v[100:103], v[212:215], v[252:255], v[100:103]
    s_nop 6
    v_cvt_pk_bf16_f32 v232, v96, v97
    v_cvt_pk_bf16_f32 v233, v98, v99
    v_cvt_pk_bf16_f32 v234, v100, v101
    v_cvt_pk_bf16_f32 v235, v102, v103
    buffer_store_dwordx4 v[232:235], v1, s[48:51], s76 offen offset:0 sc1
    s_or_b32 s64, s2, s3
    s_cbranch_scc1 L_noepoch_53
    v_mov_b32 v1, s30
    s_mov_b64 exec, 1
    buffer_store_dword v1, v5, s[44:47], 0 offen sc1
L_noepoch_53:
    s_endpgm
L_retry_41:
    s_sub_u32 s100, s100, 1
    s_cbranch_scc1 L_end
    s_sleep 1
    s_branch L_spin_40
L_mre_42:
    s_sub_u32 s100, s100, 1
    s_cbranch_scc1 L_end
    s_sleep 2
    buffer_load_dword v1, v0, s[44:47], s74 offen sc1
    s_waitcnt vmcnt(0)
    s_branch L_mchk_39
L_retry_44:
    s_sub_u32 s100, s100, 1
    s_cbranch_scc1 L_end
    s_sleep 1
    s_branch L_spin_43
L_retry_46:
    s_sub_u32 s100, s100, 1
    s_cbranch_scc1 L_end
    s_sleep 1
    s_branch L_prog_45
L_retry_48:
    s_sub_u32 s100, s100, 1
    s_cbranch_scc1 L_end
    s_sleep 1
    s_branch L_prog_47
L_retry_50:
    s_sub_u32 s100, s100, 1
    s_cbranch_scc1 L_end
    s_sleep 1
    s_branch L_prog_49
L_retry_52:
    s_sub_u32 s100, s100, 1
    s_cbranch_scc1 L_end
    s_sleep 1
    s_branch L_prog_51
L_end:
    s_endpgm
.section .rodata,"a"
.p2align 6
.amdhsa_kernel standalone__hybrid_graph_tf_exphormer__graph_kernel
  .amdhsa_next_free_vgpr 256
  .amdhsa_next_free_sgpr 102
  .amdhsa_accum_offset 256
  .amdhsa_group_segment_fixed_size 0
  .amdhsa_kernarg_size 104
  .amdhsa_user_sgpr_count 2
  .amdhsa_user_sgpr_kernarg_segment_ptr 1
  .amdhsa_system_sgpr_workgroup_id_x 1
  .amdhsa_float_denorm_mode_32 3
.end_amdhsa_kernel
```

```asm
; @launch grid=(253,1,1) block=(512,1,1) lds=161792
.amdgcn_target "amdgcn-amd-amdhsa--gfx950"
.text
.globl standalone__hybrid_graph_tf_exphormer__graph_kernel
.p2align 8
.type standalone__hybrid_graph_tf_exphormer__graph_kernel,@function
standalone__hybrid_graph_tf_exphormer__graph_kernel:
L_begin:
    s_cmp_ge_u32 s2, 253
    s_cbranch_scc1 L_end
    s_load_dwordx16 s[4:19], s[0:1], 0
    s_load_dwordx8 s[20:27], s[0:1], 64
    s_load_dwordx2 s[28:29], s[0:1], 96
    s_cmp_ge_u32 s2, 16
    s_cbranch_scc1 L_nopf
    s_getpc_b64 s[32:33]
L_pc:
    v_lshlrev_b32 v1, 6, v0
    v_min_u32 v1, L_end-L_pc, v1
    global_load_dword v255, v1, s[32:33]
L_nopf:
    v_lshrrev_b32 v1, 6, v0
    v_lshlrev_b32 v8, 4, v0
    v_mov_b32 v12, 1966080
    v_readfirstlane_b32 s3, v1
    v_mov_b32 v13, 1966080
    v_mov_b32 v14, 1966080
    v_mov_b32 v15, 1966080
    ds_write_b128 v8, v[12:15] offset:41984
    ds_write_b128 v8, v[12:15] offset:50176
    v_subrev_u32 v9, 32, v0
    v_cmp_gt_u32 vcc, 20, v9
    v_mul_u32_u24 v9, 264, v9
    v_add_u32 v9, 148480, v9
    v_lshlrev_b32 v10, 2, v0
    v_cndmask_b32 v9, 0, v9, vcc
    v_min_u32 v11, 1020, v10
    ds_write_b32 v11, v9
    v_mov_b32 v16, 1310740000
    v_mov_b32 v17, 1310740000
    v_mov_b32 v18, 1310740000
    v_mov_b32 v19, 1310740000
    v_add_u32 v9, 148480, v8
    ds_write_b128 v9, v[16:19]
    v_and_b32 v2, 63, v0
    v_and_b32 v3, 15, v0
    v_bfe_u32 v4, v0, 4, 2
    v_mov_b32 v5, 0
    v_mov_b32 v6, 1
    s_mov_b32 s100, 67108864
    s_and_b32 s64, s2, 7
    s_lshl_b32 s64, s64, 1
    s_bfe_u32 s65, s2, 0x10003
    s_or_b32 s64, s64, s65
    s_and_b32 s65, s2, 0xf0
    s_or_b32 s64, s64, s65
    s_cmp_lt_u32 s2, 240
    s_cselect_b32 s1, s64, s2
    s_and_b32 s31, s3, 3
    s_cmp_lt_u32 s3, 4
    s_cbranch_scc1 L_gemm
    s_setprio 3
    v_and_b32 v8, 0xfff, v8
    v_and_b32 v9, 0x3ff, v10
    s_lshr_b32 s66, s2, 4
    s_lshl_b32 s66, s66, 3
    s_and_b32 s67, s2, 7
    s_or_b32 s68, s66, s67
    s_mul_i32 s64, s68, 5120
    v_add_u32 v40, s64, v8
    s_add_u32 s64, s64, 4096
    v_add_u32 v41, s64, v9
    v_lshrrev_b32 v42, 2, v3
    v_and_b32 v43, 3, v3
    v_lshl_add_u32 v46, v42, 3, v43
    v_lshl_add_u32 v42, v42, 4, v43
    s_lshl_b32 s64, s31, 1
    v_mov_b32 v43, s64
    v_lshlrev_b32 v44, 1, v43
    v_cmp_gt_u32 vcc, 8, v3
    s_mul_i32 s65, s1, 640
    v_lshlrev_b32 v7, 4, v3
    v_cndmask_b32 v43, v43, v44, vcc
    v_add_lshl_u32 v42, v42, v43, 4
    v_lshl_add_u32 v42, v4, 2, v42
    v_add_u32 v42, s65, v42
    v_min_u32 v42, 159996, v42
    s_bitcmp1_b32 s2, 3
    s_cbranch_scc0 L_mrole_1
    s_waitcnt lgkmcnt(0)
    global_load_dword v0, v42, s[10:11]
    global_load_dwordx4 v[48:51], v40, s[8:9]
    global_load_dword v52, v41, s[8:9]
    global_load_dwordx4 v[56:59], v40, s[6:7]
    global_load_dword v60, v41, s[6:7]
L_roled_2:
    s_mov_b32 s27, s68
    s_mov_b32 s26, 0
    s_cmp_lg_u32 s31, 0
    s_cbranch_scc1 L_roled_2_b
    s_load_dword s30, s[28:29], 0
L_roled_2_b:
    s_barrier
    s_branch L_pastm
L_mrole_1:
    v_lshlrev_b32 v43, 4, v4
    v_lshl_add_u32 v46, v46, 9, v43
    s_bfe_u32 s64, s68, 0x30002
    s_lshl_b32 s64, s64, 14
    s_lshr_b32 s65, s68, 5
    s_lshl_b32 s65, s65, 15
    s_bfe_u32 s66, s68, 0x10001
    s_lshl_b32 s66, s66, 14
    s_add_u32 s65, s65, s66
    s_and_b32 s66, s68, 1
    s_lshl_b32 s66, s66, 11
    s_add_u32 s65, s65, s66
    s_lshr_b32 s66, s2, 2
    s_xor_b32 s66, s66, s2
    s_and_b32 s66, s66, 0x30
    s_lshl_b32 s66, s66, 3
    v_add_u32 v46, s66, v46
    v_add_u32 v44, s64, v46
    v_add_u32 v45, s65, v46
    s_cmp_lg_u32 s31, 0
    s_waitcnt lgkmcnt(0)
    global_load_dword v0, v42, s[10:11]
    s_cbranch_scc1 L_roled_2
    global_load_dwordx4 v[48:51], v45, s[20:21] offset:0
    global_load_dwordx4 v[52:55], v44, s[18:19] offset:0
    global_load_dwordx4 v[56:59], v44, s[18:19] offset:2048
    global_load_dwordx4 v[60:63], v45, s[20:21] offset:64
    global_load_dwordx4 v[64:67], v44, s[18:19] offset:64
    global_load_dwordx4 v[68:71], v44, s[18:19] offset:2112
    v_xor_b32 v44, 128, v44
    v_xor_b32 v45, 128, v45
    global_load_dwordx4 v[72:75], v45, s[20:21] offset:0
    global_load_dwordx4 v[76:79], v44, s[18:19] offset:0
    global_load_dwordx4 v[80:83], v44, s[18:19] offset:2048
    global_load_dwordx4 v[84:87], v45, s[20:21] offset:64
    global_load_dwordx4 v[88:91], v44, s[18:19] offset:64
    global_load_dwordx4 v[92:95], v44, s[18:19] offset:2112
    v_xor_b32 v44, 384, v44
    v_xor_b32 v45, 384, v45
    global_load_dwordx4 v[96:99], v45, s[20:21] offset:0
    global_load_dwordx4 v[100:103], v44, s[18:19] offset:0
    global_load_dwordx4 v[104:107], v44, s[18:19] offset:2048
    global_load_dwordx4 v[108:111], v45, s[20:21] offset:64
    global_load_dwordx4 v[112:115], v44, s[18:19] offset:64
    global_load_dwordx4 v[116:119], v44, s[18:19] offset:2112
    v_xor_b32 v44, 128, v44
    v_xor_b32 v45, 128, v45
    global_load_dwordx4 v[120:123], v45, s[20:21] offset:0
    global_load_dwordx4 v[124:127], v44, s[18:19] offset:0
    global_load_dwordx4 v[128:131], v44, s[18:19] offset:2048
    global_load_dwordx4 v[132:135], v45, s[20:21] offset:64
    global_load_dwordx4 v[136:139], v44, s[18:19] offset:64
    global_load_dwordx4 v[140:143], v44, s[18:19] offset:2112
    s_branch L_roled_2
L_pastm:
    s_mov_b32 s32, s4
    s_and_b32 s33, s5, 0xffff
    s_mov_b32 s34, 5120000
    s_mov_b32 s35, 0x20000
    s_mov_b32 s36, s14
    s_and_b32 s37, s15, 0xffff
    s_mov_b32 s38, 20000
    s_mov_b32 s39, 0x20000
    s_add_u32 s40, s28, 1048576
    s_addc_u32 s41, s29, 0
    s_and_b32 s41, s41, 0xffff
    s_mov_b32 s42, 2048000
    s_mov_b32 s43, 0x20000
    v_and_b32 v40, 8, v3
    v_lshlrev_b32 v40, 1, v40
    v_mov_b32 v41, 0xffff
    v_lshlrev_b32 v40, v40, v41
    s_mov_b32 s64, 0x0f0f0f0f
    s_mov_b32 s65, 0x0f0f0f0f
    v_cndmask_b32 v12, 0, v40, s[64:65]
    v_xor_b32 v13, v40, v12
    v_and_b32 v14, 3, v3
    v_mul_u32_u24 v14, 0x5555, v14
    s_cmp_lg_u32 s31, 0
    s_cbranch_scc1 L_tagged_3
    s_waitcnt lgkmcnt(0)
    s_mul_i32 s30, s30, 0x9E3779B1
    s_add_u32 s30, s30, 0x7F4A7C15
    v_mov_b32 v40, 1
    v_mov_b32 v41, s30
    ds_write_b64 v5, v[40:41] offset:8
L_tagged_3:
    s_bitcmp1_b32 s2, 3
    s_cbranch_scc0 L_mwork_4
    v_mov_b32 v43, 4
    v_mov_b32 v44, 2031616
    s_mov_b32 s64, 0x3f0001
    v_lshrrev_b32 v40, 6, v8
    v_and_b32 v41, 0x30, v8
    v_lshl_add_u32 v40, v40, 14, v41
    s_lshl_b32 s68, s27, 6
    s_add_u32 s69, s68, 0x100000
    s_add_u32 s70, s68, 8192
    s_add_u32 s71, s69, 8192
    s_mov_b32 s65, 0x203c
    s_waitcnt vmcnt(2)
    v_mul_u32_u24 v64, 52429, v48
    v_lshrrev_b32 v72, 22, v64
    v_lshlrev_b32 v80, 2, v72
    ds_add_rtn_u32 v80, v80, v43 offset:512
    v_mul_u32_u24 v65, 52429, v49
    v_lshrrev_b32 v73, 22, v65
    v_lshlrev_b32 v81, 2, v73
    ds_add_rtn_u32 v81, v81, v43 offset:512
    v_mul_u32_u24 v66, 52429, v50
    v_lshrrev_b32 v74, 22, v66
    v_lshlrev_b32 v82, 2, v74
    ds_add_rtn_u32 v82, v82, v43 offset:512
    v_mul_u32_u24 v67, 52429, v51
    v_lshrrev_b32 v75, 22, v67
    v_lshlrev_b32 v83, 2, v75
    ds_add_rtn_u32 v83, v83, v43 offset:512
    v_mul_u32_u24 v68, 52429, v52
    v_lshrrev_b32 v76, 22, v68
    v_lshlrev_b32 v84, 2, v76
    ds_add_rtn_u32 v84, v84, v43 offset:512
    v_lshrrev_b32 v64, 21, v64
    v_mad_u32_u24 v64, v64, 24, v48
    v_mul_u32_u24 v64, 0x8001, v64
    v_bfe_u32 v88, v72, 1, 2
    v_lshl_or_b32 v72, v72, 2, v88
    v_lshlrev_b32 v72, 4, v72
    v_lshrrev_b32 v65, 21, v65
    v_mad_u32_u24 v65, v65, 24, v49
    v_mul_u32_u24 v65, 0x8001, v65
    v_bfe_u32 v89, v73, 1, 2
    v_lshl_or_b32 v73, v73, 2, v89
    v_lshlrev_b32 v73, 4, v73
    v_lshrrev_b32 v66, 21, v66
    v_mad_u32_u24 v66, v66, 24, v50
    v_mul_u32_u24 v66, 0x8001, v66
    v_bfe_u32 v90, v74, 1, 2
    v_lshl_or_b32 v74, v74, 2, v90
    v_lshlrev_b32 v74, 4, v74
    v_lshrrev_b32 v67, 21, v67
    v_mad_u32_u24 v67, v67, 24, v51
    v_mul_u32_u24 v67, 0x8001, v67
    v_bfe_u32 v91, v75, 1, 2
    v_lshl_or_b32 v75, v75, 2, v91
    v_lshlrev_b32 v75, 4, v75
    v_lshrrev_b32 v68, 21, v68
    v_mad_u32_u24 v68, v68, 24, v52
    v_mul_u32_u24 v68, 0x8001, v68
    v_bfe_u32 v92, v76, 1, 2
    v_lshl_or_b32 v76, v76, 2, v92
    v_lshlrev_b32 v76, 4, v76
    s_waitcnt vmcnt(0)
    v_lshlrev_b32 v56, 1, v56
    v_and_or_b32 v64, v64, s64, v56
    v_lshlrev_b32 v57, 1, v57
    v_and_or_b32 v65, v65, s64, v57
    v_lshlrev_b32 v58, 1, v58
    v_and_or_b32 v66, v66, s64, v58
    v_lshlrev_b32 v59, 1, v59
    v_and_or_b32 v67, v67, s64, v59
    v_lshlrev_b32 v60, 1, v60
    v_and_or_b32 v68, v68, s64, v60
    s_waitcnt lgkmcnt(0)
    v_cmp_gt_u32 vcc, 124, v80
    v_min_u32 v80, 124, v80
    v_lshl_or_b32 v80, v80, 7, v80
    v_cndmask_b32 v64, v44, v64, vcc
    v_bitop3_b32 v80, v80, s65, v72 bitop3:0x6a
    ds_write_b32 v80, v64 offset:41984
    v_cmp_gt_u32 vcc, 124, v81
    v_min_u32 v81, 124, v81
    v_lshl_or_b32 v81, v81, 7, v81
    v_cndmask_b32 v65, v44, v65, vcc
    v_bitop3_b32 v81, v81, s65, v73 bitop3:0x6a
    ds_write_b32 v81, v65 offset:41984
    v_cmp_gt_u32 vcc, 124, v82
    v_min_u32 v82, 124, v82
    v_lshl_or_b32 v82, v82, 7, v82
    v_cndmask_b32 v66, v44, v66, vcc
    v_bitop3_b32 v82, v82, s65, v74 bitop3:0x6a
    ds_write_b32 v82, v66 offset:41984
    v_cmp_gt_u32 vcc, 124, v83
    v_min_u32 v83, 124, v83
    v_lshl_or_b32 v83, v83, 7, v83
    v_cndmask_b32 v67, v44, v67, vcc
    v_bitop3_b32 v83, v83, s65, v75 bitop3:0x6a
    ds_write_b32 v83, v67 offset:41984
    v_cmp_gt_u32 vcc, 124, v84
    v_min_u32 v84, 124, v84
    v_lshl_or_b32 v84, v84, 7, v84
    v_cndmask_b32 v68, v44, v68, vcc
    v_bitop3_b32 v84, v84, s65, v76 bitop3:0x6a
    ds_write_b32 v84, v68 offset:41984
    s_waitcnt lgkmcnt(0)
    s_mov_b64 exec, 1
    ds_add_u32 v5, v6 offset:0
    s_mov_b64 exec, -1
L_spin_6:
    ds_read_b128 v[44:47], v5
    s_waitcnt lgkmcnt(0)
    v_readfirstlane_b32 s101, v44
    v_readfirstlane_b32 s30, v47
    s_cmp_ge_u32 s101, 4
    s_cbranch_scc0 L_retry_7
    ds_read_b128 v[48:51], v8 offset:41984
    ds_read_b128 v[52:55], v8 offset:46080
    ds_read_b128 v[56:59], v8 offset:50176
    ds_read_b128 v[60:63], v8 offset:54272
    s_and_b32 s44, s30, 0xffc00000
    s_lshl_b32 s45, s30, 10
    s_and_b32 s45, s45, 0xffc00000
    s_lshl_b32 s46, s30, 20
    s_and_b32 s46, s46, 0xffc00000
    s_lshl_b32 s47, s30, 22
    s_waitcnt lgkmcnt(3)
    v_cmp_eq_u32 vcc, 1966080, v51
    v_or_b32 v48, s44, v48
    v_or_b32 v49, s45, v49
    v_or_b32 v50, s46, v50
    v_or_b32 v51, s47, v51
    buffer_store_dwordx4 v[48:51], v40, s[40:43], s68 offen sc1
    s_wqm_b64 s[72:73], vcc
    s_waitcnt lgkmcnt(2)
    v_cmp_eq_u32 vcc, 1966080, v55
    v_or_b32 v52, s44, v52
    v_or_b32 v53, s45, v53
    v_or_b32 v54, s46, v54
    v_or_b32 v55, s47, v55
    buffer_store_dwordx4 v[52:55], v40, s[40:43], s69 offen sc1
    s_wqm_b64 s[74:75], vcc
    s_waitcnt lgkmcnt(1)
    s_not_b64 exec, s[72:73]
    s_cbranch_scc0 L_nosec_10
    v_or_b32 v56, s44, v56
    v_or_b32 v57, s45, v57
    v_or_b32 v58, s46, v58
    v_or_b32 v59, s47, v59
    buffer_store_dwordx4 v[56:59], v40, s[40:43], s70 offen sc1
L_nosec_10:
    s_waitcnt lgkmcnt(0)
    s_not_b64 exec, s[74:75]
    s_cbranch_scc0 L_nosec_11
    v_or_b32 v60, s44, v60
    v_or_b32 v61, s45, v61
    v_or_b32 v62, s46, v62
    v_or_b32 v63, s47, v63
    buffer_store_dwordx4 v[60:63], v40, s[40:43], s71 offen sc1
L_nosec_11:
    s_mov_b64 exec, -1
    s_cmp_ge_u32 s2, 250
    s_cbranch_scc1 L_end
L_worked_5:
    v_lshlrev_b32 v0, 9, v0
    s_setprio 1
    s_lshl_b32 s64, s31, 10
    s_lshr_b32 s10, s1, 1
    s_lshl_b32 s10, s10, 14
    s_add_u32 s11, s10, 4096
    s_add_u32 s12, s10, 8192
    s_add_u32 s13, s10, 12288
    v_cmp_gt_u32 vcc, 0xf40, v8
    s_mov_b64 s[14:15], vcc
    v_add_u32_dpp v9, v0, v7 row_newbcast:0 row_mask:0xf bank_mask:0xf
    buffer_load_dwordx4 v[176:179], v9, s[32:35], 0 offen offset:0
    buffer_load_dwordx4 v[180:183], v9, s[32:35], 0 offen offset:256
    v_add_u32_dpp v9, v0, v7 row_newbcast:1 row_mask:0xf bank_mask:0xf
    buffer_load_dwordx4 v[184:187], v9, s[32:35], 0 offen offset:0
    buffer_load_dwordx4 v[188:191], v9, s[32:35], 0 offen offset:256
    s_add_u32 m0, s64, 62464
    s_mov_b32 s65, 0
    buffer_load_dwordx4 v8, s[36:39], s65 offen lds
    v_add_u32_dpp v9, v0, v7 row_newbcast:2 row_mask:0xf bank_mask:0xf
    s_cmp_eq_u32 s26, 2
    s_cbranch_scc1 L_loose_12
    s_waitcnt vmcnt(2)
L_loose_12:
    s_waitcnt vmcnt(6)
    buffer_load_dwordx4 v[192:195], v9, s[32:35], 0 offen offset:0
    buffer_load_dwordx4 v[196:199], v9, s[32:35], 0 offen offset:256
    s_add_u32 m0, s64, 66560
    s_mov_b32 s65, 4096
    buffer_load_dwordx4 v8, s[36:39], s65 offen lds
    v_add_u32_dpp v9, v0, v7 row_newbcast:3 row_mask:0xf bank_mask:0xf
    s_cmp_eq_u32 s26, 2
    s_cbranch_scc1 L_loose_13
    s_waitcnt vmcnt(2)
L_loose_13:
    s_waitcnt vmcnt(6)
    buffer_load_dwordx4 v[200:203], v9, s[32:35], 0 offen offset:0
    buffer_load_dwordx4 v[204:207], v9, s[32:35], 0 offen offset:256
    s_add_u32 m0, s64, 70656
    s_mov_b32 s65, 8192
    buffer_load_dwordx4 v8, s[36:39], s65 offen lds
    v_add_u32_dpp v9, v0, v7 row_newbcast:4 row_mask:0xf bank_mask:0xf
    s_cmp_eq_u32 s26, 2
    s_cbranch_scc1 L_loose_14
    s_waitcnt vmcnt(2)
L_loose_14:
    s_waitcnt vmcnt(6)
    buffer_load_dwordx4 v[208:211], v9, s[32:35], 0 offen offset:0
    buffer_load_dwordx4 v[212:215], v9, s[32:35], 0 offen offset:256
    s_add_u32 m0, s64, 74752
    s_mov_b32 s65, 12288
    buffer_load_dwordx4 v8, s[36:39], s65 offen lds
    v_add_u32_dpp v9, v0, v7 row_newbcast:5 row_mask:0xf bank_mask:0xf
    s_cmp_eq_u32 s26, 2
    s_cbranch_scc1 L_loose_15
    s_waitcnt vmcnt(2)
L_loose_15:
    s_waitcnt vmcnt(6)
    buffer_load_dwordx4 v[216:219], v9, s[32:35], 0 offen offset:0
    buffer_load_dwordx4 v[220:223], v9, s[32:35], 0 offen offset:256
    s_add_u32 m0, s64, 78848
    s_mov_b32 s65, 16384
    buffer_load_dwordx4 v8, s[36:39], s65 offen lds
L_ipoll_16:
    buffer_load_dwordx4 v[48:51], v8, s[40:43], s10 offen sc1
    s_mov_b64 exec, s[14:15]
    buffer_load_dwordx4 v[52:55], v8, s[40:43], s11 offen sc1
    s_mov_b64 exec, -1
L_spin_17:
    ds_read_b128 v[44:47], v5
    s_waitcnt lgkmcnt(0)
    v_readfirstlane_b32 s101, v46
    v_readfirstlane_b32 s30, v47
    s_cmp_ge_u32 s101, 1
    s_cbranch_scc0 L_retry_18
    s_and_b32 s44, s30, 0xffc00000
    s_lshl_b32 s45, s30, 10
    s_and_b32 s45, s45, 0xffc00000
    s_lshl_b32 s46, s30, 20
    s_and_b32 s46, s46, 0xffc00000
    s_lshl_b32 s47, s30, 22
    s_and_b32 s64, s1, 1
    s_lshl_b32 s64, s64, 21
    s_xor_b32 s17, s64, 1966080
    s_or_b32 s44, s44, s64
    v_mov_b32 v68, s17
    s_or_b32 s45, s45, s64
    v_mov_b32 v69, s17
    s_or_b32 s46, s46, s64
    v_mov_b32 v70, s17
    s_or_b32 s47, s47, s64
    v_mov_b32 v71, s17
    s_mov_b32 s16, 1310720
    v_mov_b32 v42, 2
    s_waitcnt vmcnt(1)
    v_xor_b32 v64, s44, v48
    v_xor_b32 v65, s45, v49
    v_xor_b32 v66, s46, v50
    v_xor_b32 v67, s47, v51
    v_or3_b32 v40, v64, v65, v66
    v_or_b32 v40, v40, v67
    v_cmp_eq_u32 s[72:73], s17, v67
    v_cmp_gt_u32 s[48:49], s16, v64
    v_lshlrev_b32_sdwa v80, 2, v64 dst_sel:DWORD dst_unused:UNUSED_PAD src0_sel:DWORD src1_sel:WORD_1
    v_cmp_gt_u32 s[50:51], s16, v65
    v_lshlrev_b32_sdwa v81, 2, v65 dst_sel:DWORD dst_unused:UNUSED_PAD src0_sel:DWORD src1_sel:WORD_1
    v_cmp_gt_u32 s[52:53], s16, v66
    v_lshlrev_b32_sdwa v82, 2, v66 dst_sel:DWORD dst_unused:UNUSED_PAD src0_sel:DWORD src1_sel:WORD_1
    v_cmp_gt_u32 s[54:55], s16, v67
    v_lshlrev_b32_sdwa v83, 2, v67 dst_sel:DWORD dst_unused:UNUSED_PAD src0_sel:DWORD src1_sel:WORD_1
    s_waitcnt vmcnt(0)
    s_mov_b64 exec, s[14:15]
    v_xor_b32 v68, s44, v52
    v_xor_b32 v69, s45, v53
    v_xor_b32 v70, s46, v54
    v_xor_b32 v71, s47, v55
    s_mov_b64 exec, -1
    v_or3_b32 v40, v40, v68, v69
    v_or3_b32 v40, v40, v70, v71
    v_cmp_eq_u32 s[74:75], s17, v71
    v_cmp_le_u32 vcc, 0x400000, v40
    s_cbranch_vccnz L_retry_19
    s_wqm_b64 s[72:73], s[72:73]
    s_not_b64 exec, s[72:73]
    s_cbranch_scc0 L_nosec_20
    buffer_load_dwordx4 v[56:59], v8, s[40:43], s12 offen sc1
L_nosec_20:
    s_wqm_b64 s[74:75], s[74:75]
    s_not_b64 exec, s[74:75]
    s_cbranch_scc0 L_nosec_21
    buffer_load_dwordx4 v[60:63], v8, s[40:43], s13 offen sc1
L_nosec_21:
    s_mov_b64 exec, -1
    v_cmp_gt_u32 s[56:57], s16, v68
    v_lshlrev_b32_sdwa v84, 2, v68 dst_sel:DWORD dst_unused:UNUSED_PAD src0_sel:DWORD src1_sel:WORD_1
    v_cmp_gt_u32 s[58:59], s16, v69
    v_lshlrev_b32_sdwa v85, 2, v69 dst_sel:DWORD dst_unused:UNUSED_PAD src0_sel:DWORD src1_sel:WORD_1
    v_cmp_gt_u32 s[60:61], s16, v70
    v_lshlrev_b32_sdwa v86, 2, v70 dst_sel:DWORD dst_unused:UNUSED_PAD src0_sel:DWORD src1_sel:WORD_1
    v_cmp_gt_u32 s[62:63], s16, v71
    v_lshlrev_b32_sdwa v87, 2, v71 dst_sel:DWORD dst_unused:UNUSED_PAD src0_sel:DWORD src1_sel:WORD_1
    s_mov_b64 exec, s[48:49]
    ds_add_rtn_u32 v80, v80, v42 offset:128
    s_mov_b64 exec, s[50:51]
    ds_add_rtn_u32 v81, v81, v42 offset:128
    s_mov_b64 exec, s[52:53]
    ds_add_rtn_u32 v82, v82, v42 offset:128
    s_mov_b64 exec, s[54:55]
    ds_add_rtn_u32 v83, v83, v42 offset:128
    s_mov_b64 exec, s[56:57]
    ds_add_rtn_u32 v84, v84, v42 offset:128
    s_mov_b64 exec, s[58:59]
    ds_add_rtn_u32 v85, v85, v42 offset:128
    s_mov_b64 exec, s[60:61]
    ds_add_rtn_u32 v86, v86, v42 offset:128
    s_mov_b64 exec, s[62:63]
    ds_add_rtn_u32 v87, v87, v42 offset:128
    s_mov_b64 exec, -1
    v_add_u32_dpp v9, v0, v7 row_newbcast:6 row_mask:0xf bank_mask:0xf
    buffer_load_dwordx4 v[224:227], v9, s[32:35], 0 offen offset:0
    buffer_load_dwordx4 v[228:231], v9, s[32:35], 0 offen offset:256
    v_add_u32_dpp v9, v0, v7 row_newbcast:7 row_mask:0xf bank_mask:0xf
    buffer_load_dwordx4 v[232:235], v9, s[32:35], 0 offen offset:0
    buffer_load_dwordx4 v[236:239], v9, s[32:35], 0 offen offset:256
    s_waitcnt lgkmcnt(4)
    s_mov_b64 exec, s[48:49]
    ds_write_b16 v80, v64
    s_mov_b64 exec, s[50:51]
    ds_write_b16 v81, v65
    s_mov_b64 exec, s[52:53]
    ds_write_b16 v82, v66
    s_mov_b64 exec, s[54:55]
    ds_write_b16 v83, v67
    s_waitcnt lgkmcnt(4)
    s_mov_b64 exec, s[56:57]
    ds_write_b16 v84, v68
    s_mov_b64 exec, s[58:59]
    ds_write_b16 v85, v69
    s_mov_b64 exec, s[60:61]
    ds_write_b16 v86, v70
    s_mov_b64 exec, s[62:63]
    ds_write_b16 v87, v71
    s_not_b64 exec, s[72:73]
    s_cbranch_scc0 L_secdone_23
    s_waitcnt vmcnt(4)
L_sec_22:
    v_xor_b32 v72, s44, v56
    v_xor_b32 v73, s45, v57
    v_xor_b32 v74, s46, v58
    v_xor_b32 v75, s47, v59
    v_or3_b32 v40, v72, v73, v74
    v_or_b32 v40, v40, v75
    v_cmp_le_u32 vcc, 0x400000, v40
    s_cbranch_vccnz L_retry_25
    v_and_b32 v40, 2031616, v75
    v_cmp_eq_u32 vcc, 2031616, v40
    v_cmp_gt_u32 s[64:65], s16, v72
    v_lshlrev_b32_sdwa v88, 2, v72 dst_sel:DWORD dst_unused:UNUSED_PAD src0_sel:DWORD src1_sel:WORD_1
    v_cmp_gt_u32 s[66:67], s16, v73
    v_lshlrev_b32_sdwa v89, 2, v73 dst_sel:DWORD dst_unused:UNUSED_PAD src0_sel:DWORD src1_sel:WORD_1
    v_cmp_gt_u32 s[68:69], s16, v74
    v_lshlrev_b32_sdwa v90, 2, v74 dst_sel:DWORD dst_unused:UNUSED_PAD src0_sel:DWORD src1_sel:WORD_1
    v_cmp_gt_u32 s[70:71], s16, v75
    v_lshlrev_b32_sdwa v91, 2, v75 dst_sel:DWORD dst_unused:UNUSED_PAD src0_sel:DWORD src1_sel:WORD_1
    s_mov_b64 exec, s[64:65]
    ds_add_rtn_u32 v88, v88, v42 offset:128
    s_mov_b64 exec, s[66:67]
    ds_add_rtn_u32 v89, v89, v42 offset:128
    s_mov_b64 exec, s[68:69]
    ds_add_rtn_u32 v90, v90, v42 offset:128
    s_mov_b64 exec, s[70:71]
    ds_add_rtn_u32 v91, v91, v42 offset:128
    s_mov_b64 exec, vcc
    ds_write_b32 v5, v6 offset:20
    s_waitcnt lgkmcnt(0)
    s_mov_b64 exec, s[64:65]
    ds_write_b16 v88, v72
    s_mov_b64 exec, s[66:67]
    ds_write_b16 v89, v73
    s_mov_b64 exec, s[68:69]
    ds_write_b16 v90, v74
    s_mov_b64 exec, s[70:71]
    ds_write_b16 v91, v75
L_secdone_23:
    s_not_b64 exec, s[74:75]
    s_cbranch_scc0 L_secdone_27
    s_waitcnt vmcnt(4)
L_sec_26:
    v_xor_b32 v76, s44, v60
    v_xor_b32 v77, s45, v61
    v_xor_b32 v78, s46, v62
    v_xor_b32 v79, s47, v63
    v_or3_b32 v40, v76, v77, v78
    v_or_b32 v40, v40, v79
    v_cmp_le_u32 vcc, 0x400000, v40
    s_cbranch_vccnz L_retry_29
    v_and_b32 v40, 2031616, v79
    v_cmp_eq_u32 vcc, 2031616, v40
    v_cmp_gt_u32 s[64:65], s16, v76
    v_lshlrev_b32_sdwa v92, 2, v76 dst_sel:DWORD dst_unused:UNUSED_PAD src0_sel:DWORD src1_sel:WORD_1
    v_cmp_gt_u32 s[66:67], s16, v77
    v_lshlrev_b32_sdwa v93, 2, v77 dst_sel:DWORD dst_unused:UNUSED_PAD src0_sel:DWORD src1_sel:WORD_1
    v_cmp_gt_u32 s[68:69], s16, v78
    v_lshlrev_b32_sdwa v94, 2, v78 dst_sel:DWORD dst_unused:UNUSED_PAD src0_sel:DWORD src1_sel:WORD_1
    v_cmp_gt_u32 s[70:71], s16, v79
    v_lshlrev_b32_sdwa v95, 2, v79 dst_sel:DWORD dst_unused:UNUSED_PAD src0_sel:DWORD src1_sel:WORD_1
    s_mov_b64 exec, s[64:65]
    ds_add_rtn_u32 v92, v92, v42 offset:128
    s_mov_b64 exec, s[66:67]
    ds_add_rtn_u32 v93, v93, v42 offset:128
    s_mov_b64 exec, s[68:69]
    ds_add_rtn_u32 v94, v94, v42 offset:128
    s_mov_b64 exec, s[70:71]
    ds_add_rtn_u32 v95, v95, v42 offset:128
    s_mov_b64 exec, vcc
    ds_write_b32 v5, v6 offset:20
    s_waitcnt lgkmcnt(0)
    s_mov_b64 exec, s[64:65]
    ds_write_b16 v92, v76
    s_mov_b64 exec, s[66:67]
    ds_write_b16 v93, v77
    s_mov_b64 exec, s[68:69]
    ds_write_b16 v94, v78
    s_mov_b64 exec, s[70:71]
    ds_write_b16 v95, v79
L_secdone_27:
    s_waitcnt lgkmcnt(0)
    s_mov_b64 exec, 1
    ds_add_u32 v5, v6 offset:16
    s_mov_b64 exec, -1
    v_add_u32_dpp v9, v0, v7 row_newbcast:8 row_mask:0xf bank_mask:0xf
    buffer_load_dwordx4 v[240:243], v9, s[32:35], 0 offen offset:0
    buffer_load_dwordx4 v[244:247], v9, s[32:35], 0 offen offset:256
    v_add_u32_dpp v9, v0, v7 row_newbcast:9 row_mask:0xf bank_mask:0xf
    buffer_load_dwordx4 v[248:251], v9, s[32:35], 0 offen offset:0
    buffer_load_dwordx4 v[252:255], v9, s[32:35], 0 offen offset:256
    s_lshl_b32 s20, s31, 1
    s_add_u32 s21, s20, 1
    s_add_u32 s22, s20, 8
    s_add_u32 s23, s20, 9
    s_add_u32 s24, s31, 16
    v_add_u32 v47, -1, v3
    v_bfe_u32 v40, v47, 1, 1
    v_and_b32 v41, 1, v47
    v_lshl_add_u32 v40, v40, 3, v41
    v_add_u32 v40, s20, v40
    v_mov_b32 v41, s24
    v_cmp_ne_u32 vcc, 0, v3
    v_min_u32 v47, 19, v2
    v_mul_u32_u24 v46, 264, v47
    v_cndmask_b32 v40, v41, v40, vcc
    v_mul_u32_u24 v41, 264, v40
    v_add_u32 v41, 148480, v41
    v_lshlrev_b32 v40, 2, v40
    v_add_u32 v46, 148728, v46
    v_lshlrev_b32 v47, 2, v47
    v_lshlrev_b32 v43, 3, v3
    v_lshl_add_u32 v43, v4, 1, v43
L_spin_30:
    ds_read_b32 v44, v5 offset:16
    s_waitcnt lgkmcnt(0)
    v_readfirstlane_b32 s101, v44
    s_cmp_ge_u32 s101, 4
    s_cbranch_scc0 L_retry_31
    ds_read_b32 v44, v40 offset:128
    ds_read_b32 v47, v47 offset:128
    ds_read_b32 v45, v5 offset:20
    s_waitcnt lgkmcnt(2)
    v_sub_u32 v44, v44, v41
    v_max_u32 v44, 18, v44
    s_waitcnt lgkmcnt(0)
    v_cmp_gt_u32 vcc, v47, v46
    v_add_u32_dpp v48, v44, v44 row_shr:1 row_mask:0xf bank_mask:0xf bound_ctrl:1
    v_readfirstlane_b32 s25, v45
    s_or_b32 s64, vcc_lo, vcc_hi
    v_add_u32_dpp v48, v48, v48 row_shr:2 row_mask:0xf bank_mask:0xf bound_ctrl:1
    s_or_b32 s25, s25, s64
    s_mov_b32 s53, 0
    v_add_u32_dpp v48, v48, v48 row_shr:4 row_mask:0xf bank_mask:0xf bound_ctrl:1
    v_sub_u32 v44, v48, v44
    v_sub_u32 v44, v41, v44
    v_readlane_b32 s10, v48, 0
    v_readlane_b32 s11, v48, 1
    v_readlane_b32 s12, v48, 2
    v_readlane_b32 s13, v48, 3
    v_readlane_b32 s14, v48, 4
    v_add_u32_dpp v160, v44, v43 row_newbcast:0 row_mask:0xf bank_mask:0xf
    v_add_u32_dpp v161, v44, v43 row_newbcast:1 row_mask:0xf bank_mask:0xf
    v_add_u32_dpp v162, v44, v43 row_newbcast:2 row_mask:0xf bank_mask:0xf
    v_add_u32_dpp v163, v44, v43 row_newbcast:3 row_mask:0xf bank_mask:0xf
    v_add_u32_dpp v164, v44, v43 row_newbcast:4 row_mask:0xf bank_mask:0xf
    s_add_u32 s50, s14, 14
    s_lshr_b32 s50, s50, 4
    s_cmp_gt_u32 s50, 32
    s_cselect_b32 s25, 1, s25
    s_max_u32 s50, s50, 12
    v_add_u32 v40, 0, v43
    v_cmp_le_u32 s[64:65], s10, v40
    v_cmp_le_u32 s[66:67], s11, v40
    v_cmp_le_u32 s[68:69], s12, v40
    v_cmp_le_u32 s[70:71], s13, v40
    v_cndmask_b32 v40, v160, v161, s[64:65]
    v_cndmask_b32 v40, v40, v162, s[66:67]
    v_cndmask_b32 v40, v40, v163, s[68:69]
    v_cndmask_b32 v40, v40, v164, s[70:71]
    ds_read_u16 v40, v40 offset:0
    v_add_u32 v41, 128, v43
    v_cmp_le_u32 s[64:65], s10, v41
    v_cmp_le_u32 s[66:67], s11, v41
    v_cmp_le_u32 s[68:69], s12, v41
    v_cmp_le_u32 s[70:71], s13, v41
    v_cndmask_b32 v41, v160, v161, s[64:65]
    v_cndmask_b32 v41, v41, v162, s[66:67]
    v_cndmask_b32 v41, v41, v163, s[68:69]
    v_cndmask_b32 v41, v41, v164, s[70:71]
    ds_read_u16 v41, v41 offset:128
    v_add_u32 v42, 256, v43
    v_cmp_le_u32 s[64:65], s10, v42
    v_cmp_le_u32 s[66:67], s11, v42
    v_cmp_le_u32 s[68:69], s12, v42
    v_cmp_le_u32 s[70:71], s13, v42
    v_cndmask_b32 v42, v160, v161, s[64:65]
    v_cndmask_b32 v42, v42, v162, s[66:67]
    v_cndmask_b32 v42, v42, v163, s[68:69]
    v_cndmask_b32 v42, v42, v164, s[70:71]
    ds_read_u16 v42, v42 offset:256
    v_add_u32 v43, 384, v43
    v_cmp_le_u32 s[64:65], s10, v43
    v_cmp_le_u32 s[66:67], s11, v43
    v_cmp_le_u32 s[68:69], s12, v43
    v_cmp_le_u32 s[70:71], s13, v43
    v_cndmask_b32 v43, v160, v161, s[64:65]
    v_cndmask_b32 v43, v43, v162, s[66:67]
    v_cndmask_b32 v43, v43, v163, s[68:69]
    v_cndmask_b32 v43, v43, v164, s[70:71]
    ds_read_u16 v43, v43 offset:384
    s_waitcnt lgkmcnt(3)
    v_and_b32 v32, 0x7ffe, v40
    ds_read_u16 v33, v32 offset:62464
    v_lshlrev_b32 v32, 8, v32
    v_lshlrev_b32 v40, 4, v40
    s_waitcnt lgkmcnt(3)
    v_and_b32 v34, 0x7ffe, v41
    ds_read_u16 v35, v34 offset:62464
    v_lshlrev_b32 v34, 8, v34
    v_lshlrev_b32 v41, 4, v41
    s_waitcnt lgkmcnt(3)
    v_and_b32 v36, 0x7ffe, v42
    ds_read_u16 v37, v36 offset:62464
    v_lshlrev_b32 v36, 8, v36
    v_lshlrev_b32 v42, 4, v42
    s_waitcnt lgkmcnt(3)
    v_and_b32 v38, 0x7ffe, v43
    ds_read_u16 v39, v38 offset:62464
    v_lshlrev_b32 v38, 8, v38
    v_lshlrev_b32 v43, 4, v43
    v_add_u32_dpp v11, v32, v7 row_newbcast:0 row_mask:0xf bank_mask:0xf
    buffer_load_dwordx4 v[48:51], v11, s[32:35], 0 offen offset:0
    buffer_load_dwordx4 v[56:59], v11, s[32:35], 0 offen offset:256
    v_add_u32_dpp v11, v32, v7 row_newbcast:1 row_mask:0xf bank_mask:0xf
    buffer_load_dwordx4 v[52:55], v11, s[32:35], 0 offen offset:0
    buffer_load_dwordx4 v[60:63], v11, s[32:35], 0 offen offset:256
    v_add_u32_dpp v11, v32, v7 row_newbcast:2 row_mask:0xf bank_mask:0xf
    buffer_load_dwordx4 v[64:67], v11, s[32:35], 0 offen offset:0
    buffer_load_dwordx4 v[72:75], v11, s[32:35], 0 offen offset:256
    v_add_u32_dpp v11, v32, v7 row_newbcast:3 row_mask:0xf bank_mask:0xf
    buffer_load_dwordx4 v[68:71], v11, s[32:35], 0 offen offset:0
    buffer_load_dwordx4 v[76:79], v11, s[32:35], 0 offen offset:256
    v_add_u32_dpp v11, v32, v7 row_newbcast:4 row_mask:0xf bank_mask:0xf
    buffer_load_dwordx4 v[80:83], v11, s[32:35], 0 offen offset:0
    buffer_load_dwordx4 v[88:91], v11, s[32:35], 0 offen offset:256
    v_add_u32_dpp v11, v32, v7 row_newbcast:5 row_mask:0xf bank_mask:0xf
    buffer_load_dwordx4 v[84:87], v11, s[32:35], 0 offen offset:0
    buffer_load_dwordx4 v[92:95], v11, s[32:35], 0 offen offset:256
    s_mov_b32 s57, 0
    s_sub_u32 s64, s14, 18
    s_lshr_b32 s65, s64, 4
    s_bitset1_b32 s53, s65
    s_and_b32 s64, s64, 14
    s_lshl4_add_u32 s57, s57, s64
    s_and_b32 s65, s24, 7
    s_lshl_b32 s65, s65, 5
    s_lshl_b32 s19, s24, 10
    s_or_b32 s19, s19, s65
    s_sub_u32 s64, s13, 18
    s_lshr_b32 s65, s64, 4
    s_bitset1_b32 s53, s65
    s_and_b32 s64, s64, 14
    s_lshl4_add_u32 s57, s57, s64
    s_and_b32 s65, s23, 7
    s_lshl_b32 s65, s65, 5
    s_lshl_b32 s18, s23, 10
    s_or_b32 s18, s18, s65
    s_sub_u32 s64, s12, 18
    s_lshr_b32 s65, s64, 4
    s_bitset1_b32 s53, s65
    s_and_b32 s64, s64, 14
    s_lshl4_add_u32 s57, s57, s64
    s_and_b32 s65, s22, 7
    s_lshl_b32 s65, s65, 5
    s_lshl_b32 s17, s22, 10
    s_or_b32 s17, s17, s65
    s_sub_u32 s64, s11, 18
    s_lshr_b32 s65, s64, 4
    s_bitset1_b32 s53, s65
    s_and_b32 s64, s64, 14
    s_lshl4_add_u32 s57, s57, s64
    s_and_b32 s65, s21, 7
    s_lshl_b32 s65, s65, 5
    s_lshl_b32 s16, s21, 10
    s_or_b32 s16, s16, s65
    s_sub_u32 s64, s10, 18
    s_lshr_b32 s65, s64, 4
    s_bitset1_b32 s53, s65
    s_and_b32 s64, s64, 14
    s_lshl4_add_u32 s57, s57, s64
    s_and_b32 s65, s20, 7
    s_lshl_b32 s65, s65, 5
    s_lshl_b32 s15, s20, 10
    s_or_b32 s15, s15, s65
    s_sub_u32 s64, s50, 5
    s_lshl_b32 s56, 1, s64
    s_or_b32 s52, s56, s53
    v_and_b32 v46, 1, v3
    v_lshl_add_u32 v46, v4, 1, v46
    v_and_b32 v46, 3, v46
    v_and_b32 v47, 14, v3
    v_lshl_add_u32 v46, v46, 4, v47
    v_lshrrev_b32 v47, 1, v4
    v_add_lshl_u32 v46, v46, v47, 2
    v_lshrrev_b32 v44, 1, v4
    v_mul_u32_u24 v44, 528, v44
    v_xor_b32 v44, v44, v7
    v_and_b32 v45, 1, v4
    v_lshl_or_b32 v2, v45, 3, v44
    v_xor_b32 v144, s15, v7
    v_xor_b32 v146, s16, v7
    v_xor_b32 v148, s19, v7
    v_xor_b32 v145, 528, v144
    v_xor_b32 v147, 528, v146
    v_xor_b32 v149, 528, v148
    s_mul_i32 s64, s1, 80
    s_add_u32 s64, s64, 62464
    v_and_b32 v45, 2, v4
    v_add_u32 v0, s64, v45
    s_getpc_b64 s[72:73]
L_anc:
    v_lshlrev_b32 v4, 2, v4
    s_mov_b32 s62, L_fp1-L_anc
    s_mov_b32 s63, L_fp1-L_fp0
    s_mov_b32 s70, L_dr1-L_anc
    s_mov_b32 s71, L_dr1-L_dr0
    s_mov_b32 s26, 0
    v_mov_b32 v1, 0
    s_lshl_b32 s64, s31, 2
    v_mov_b32 v10, s64
    v_and_b32 v9, 8, v3
    v_lshlrev_b32 v9, 1, v9
    s_mov_b32 s66, 0x22222222
    s_mov_b32 s67, 0x22222222
    s_mov_b32 s68, 0x44444444
    s_mov_b32 s69, 0x44444444
    v_mov_b64 v[150:151], 0
    v_mov_b64 v[152:153], 0
    v_mov_b64 v[154:155], 0
    v_mov_b64 v[156:157], 0
    v_mov_b64 v[158:159], 0
    v_mov_b64 v[16:17], 0
    v_mov_b64 v[18:19], 0
    v_mov_b64 v[20:21], 0
    v_mov_b64 v[22:23], 0
    s_waitcnt lgkmcnt(0)
    v_lshlrev_b32 v33, v40, v33
    ds_bpermute_b32 v33, v46, v33
    v_lshlrev_b32 v35, v41, v35
    ds_bpermute_b32 v35, v46, v35
    v_lshlrev_b32 v37, v42, v37
    ds_bpermute_b32 v37, v46, v37
    v_lshlrev_b32 v39, v43, v39
    ds_bpermute_b32 v39, v46, v39
    s_waitcnt vmcnt(12) lgkmcnt(0)
    s_barrier
    ds_read_b128 v[160:163], v144 offset:21504
    ds_read_b128 v[164:167], v144 offset:21760
    ds_read_b128 v[168:171], v145 offset:21504
    ds_read_b128 v[172:175], v145 offset:21760
    s_waitcnt lgkmcnt(2)
    v_dot2c_f32_bf16 v150, v176, v160
    v_dot2c_f32_bf16 v150, v177, v161
    v_dot2c_f32_bf16 v150, v178, v162
    v_dot2c_f32_bf16 v150, v179, v163
    v_dot2c_f32_bf16 v150, v180, v164
    v_dot2c_f32_bf16 v150, v181, v165
    v_dot2c_f32_bf16 v150, v182, v166
    v_dot2c_f32_bf16 v150, v183, v167
    ds_read_b128 v[160:163], v146 offset:21504
    ds_read_b128 v[164:167], v146 offset:21760
    s_waitcnt lgkmcnt(2)
    v_dot2c_f32_bf16 v151, v184, v168
    v_dot2c_f32_bf16 v151, v185, v169
    v_dot2c_f32_bf16 v151, v186, v170
    v_dot2c_f32_bf16 v151, v187, v171
    v_dot2c_f32_bf16 v151, v188, v172
    v_dot2c_f32_bf16 v151, v189, v173
    v_dot2c_f32_bf16 v151, v190, v174
    v_dot2c_f32_bf16 v151, v191, v175
    ds_read_b128 v[168:171], v147 offset:21504
    ds_read_b128 v[172:175], v147 offset:21760
    s_waitcnt lgkmcnt(2)
    v_dot2c_f32_bf16 v152, v192, v160
    v_dot2c_f32_bf16 v152, v193, v161
    v_dot2c_f32_bf16 v152, v194, v162
    v_dot2c_f32_bf16 v152, v195, v163
    v_dot2c_f32_bf16 v152, v196, v164
    v_dot2c_f32_bf16 v152, v197, v165
    v_dot2c_f32_bf16 v152, v198, v166
    v_dot2c_f32_bf16 v152, v199, v167
    v_add_f32_dpp v150, v150, v150 row_ror:8 row_mask:0xf bank_mask:0x3
    v_add_f32_dpp v150, v151, v151 row_ror:8 row_mask:0xf bank_mask:0xc
    ds_read_b128 v[160:163], v144 offset:29696
    ds_read_b128 v[164:167], v144 offset:29952
    s_waitcnt lgkmcnt(2)
    v_dot2c_f32_bf16 v153, v200, v168
    v_dot2c_f32_bf16 v153, v201, v169
    v_dot2c_f32_bf16 v153, v202, v170
    v_dot2c_f32_bf16 v153, v203, v171
    v_dot2c_f32_bf16 v153, v204, v172
    v_dot2c_f32_bf16 v153, v205, v173
    v_dot2c_f32_bf16 v153, v206, v174
    v_dot2c_f32_bf16 v153, v207, v175
    ds_read_b128 v[168:171], v145 offset:29696
    ds_read_b128 v[172:175], v145 offset:29952
    s_waitcnt lgkmcnt(2)
    v_dot2c_f32_bf16 v154, v208, v160
    v_dot2c_f32_bf16 v154, v209, v161
    v_dot2c_f32_bf16 v154, v210, v162
    v_dot2c_f32_bf16 v154, v211, v163
    v_dot2c_f32_bf16 v154, v212, v164
    v_dot2c_f32_bf16 v154, v213, v165
    v_dot2c_f32_bf16 v154, v214, v166
    v_dot2c_f32_bf16 v154, v215, v167
    v_add_f32_dpp v152, v152, v152 row_ror:8 row_mask:0xf bank_mask:0x3
    v_add_f32_dpp v152, v153, v153 row_ror:8 row_mask:0xf bank_mask:0xc
    v_add_u32_dpp v11, v32, v7 row_newbcast:6 row_mask:0xf bank_mask:0xf
    buffer_load_dwordx4 v[96:99], v11, s[32:35], 0 offen offset:0
    buffer_load_dwordx4 v[104:107], v11, s[32:35], 0 offen offset:256
    ds_read_b128 v[160:163], v146 offset:29696
    ds_read_b128 v[164:167], v146 offset:29952
    s_waitcnt lgkmcnt(2)
    v_dot2c_f32_bf16 v155, v216, v168
    v_dot2c_f32_bf16 v155, v217, v169
    v_dot2c_f32_bf16 v155, v218, v170
    v_dot2c_f32_bf16 v155, v219, v171
    v_dot2c_f32_bf16 v155, v220, v172
    v_dot2c_f32_bf16 v155, v221, v173
    v_dot2c_f32_bf16 v155, v222, v174
    v_dot2c_f32_bf16 v155, v223, v175
    v_add_f32_dpp v150, v150, v150 row_half_mirror row_mask:0xf bank_mask:0x5
    v_add_f32_dpp v150, v152, v152 row_half_mirror row_mask:0xf bank_mask:0xa
    v_add_u32_dpp v11, v32, v7 row_newbcast:7 row_mask:0xf bank_mask:0xf
    buffer_load_dwordx4 v[100:103], v11, s[32:35], 0 offen offset:0
    buffer_load_dwordx4 v[108:111], v11, s[32:35], 0 offen offset:256
    ds_read_b128 v[168:171], v147 offset:29696
    ds_read_b128 v[172:175], v147 offset:29952
    s_waitcnt lgkmcnt(2)
    v_dot2c_f32_bf16 v156, v224, v160
    v_dot2c_f32_bf16 v156, v225, v161
    v_dot2c_f32_bf16 v156, v226, v162
    v_dot2c_f32_bf16 v156, v227, v163
    v_dot2c_f32_bf16 v156, v228, v164
    v_dot2c_f32_bf16 v156, v229, v165
    v_dot2c_f32_bf16 v156, v230, v166
    v_dot2c_f32_bf16 v156, v231, v167
    v_add_f32_dpp v154, v154, v154 row_ror:8 row_mask:0xf bank_mask:0x3
    v_add_f32_dpp v154, v155, v155 row_ror:8 row_mask:0xf bank_mask:0xc
    v_add_u32_dpp v11, v32, v7 row_newbcast:8 row_mask:0xf bank_mask:0xf
    buffer_load_dwordx4 v[112:115], v11, s[32:35], 0 offen offset:0
    buffer_load_dwordx4 v[120:123], v11, s[32:35], 0 offen offset:256
    ds_read_b128 v[160:163], v148 offset:21504
    ds_read_b128 v[164:167], v148 offset:21760
    s_waitcnt lgkmcnt(2)
    v_dot2c_f32_bf16 v157, v232, v168
    v_dot2c_f32_bf16 v157, v233, v169
    v_dot2c_f32_bf16 v157, v234, v170
    v_dot2c_f32_bf16 v157, v235, v171
    v_dot2c_f32_bf16 v157, v236, v172
    v_dot2c_f32_bf16 v157, v237, v173
    v_dot2c_f32_bf16 v157, v238, v174
    v_dot2c_f32_bf16 v157, v239, v175
    v_add_u32_dpp v11, v32, v7 row_newbcast:9 row_mask:0xf bank_mask:0xf
    buffer_load_dwordx4 v[116:119], v11, s[32:35], 0 offen offset:0
    buffer_load_dwordx4 v[124:127], v11, s[32:35], 0 offen offset:256
    ds_read_b128 v[168:171], v149 offset:21504
    ds_read_b128 v[172:175], v149 offset:21760
    s_waitcnt lgkmcnt(2)
    v_dot2c_f32_bf16 v158, v240, v160
    v_dot2c_f32_bf16 v158, v241, v161
    v_dot2c_f32_bf16 v158, v242, v162
    v_dot2c_f32_bf16 v158, v243, v163
    v_dot2c_f32_bf16 v158, v244, v164
    v_dot2c_f32_bf16 v158, v245, v165
    v_dot2c_f32_bf16 v158, v246, v166
    v_dot2c_f32_bf16 v158, v247, v167
    v_add_f32_dpp v156, v156, v156 row_ror:8 row_mask:0xf bank_mask:0x3
    v_add_f32_dpp v156, v157, v157 row_ror:8 row_mask:0xf bank_mask:0xc
    v_add_u32_dpp v11, v32, v7 row_newbcast:10 row_mask:0xf bank_mask:0xf
    buffer_load_dwordx4 v[128:131], v11, s[32:35], 0 offen offset:0
    buffer_load_dwordx4 v[136:139], v11, s[32:35], 0 offen offset:256
    s_waitcnt lgkmcnt(0)
    v_dot2c_f32_bf16 v159, v248, v168
    v_dot2c_f32_bf16 v159, v249, v169
    v_dot2c_f32_bf16 v159, v250, v170
    v_dot2c_f32_bf16 v159, v251, v171
    v_dot2c_f32_bf16 v159, v252, v172
    v_dot2c_f32_bf16 v159, v253, v173
    v_dot2c_f32_bf16 v159, v254, v174
    v_dot2c_f32_bf16 v159, v255, v175
    v_add_f32_dpp v154, v154, v154 row_half_mirror row_mask:0xf bank_mask:0x5
    v_add_f32_dpp v154, v156, v156 row_half_mirror row_mask:0xf bank_mask:0xa
    v_add_u32_dpp v11, v32, v7 row_newbcast:11 row_mask:0xf bank_mask:0xf
    buffer_load_dwordx4 v[132:135], v11, s[32:35], 0 offen offset:0
    buffer_load_dwordx4 v[140:143], v11, s[32:35], 0 offen offset:256
    v_add_f32_dpp v150, v150, v150 quad_perm:[1,0,3,2] row_mask:0xf bank_mask:0xf
    s_nop 0
    v_add_f32_dpp v158, v158, v158 row_ror:8 row_mask:0xf bank_mask:0x3
    v_add_f32_dpp v158, v159, v159 row_ror:8 row_mask:0xf bank_mask:0xc
    v_add_f32_dpp v154, v154, v154 quad_perm:[1,0,3,2] row_mask:0xf bank_mask:0xf
    v_add_f32_dpp v150, v150, v150 quad_perm:[2,3,0,1] row_mask:0xf bank_mask:0xf
    v_add_f32_dpp v158, v158, v158 row_half_mirror row_mask:0xf bank_mask:0x5
    v_add_f32_dpp v154, v154, v154 quad_perm:[2,3,0,1] row_mask:0xf bank_mask:0xf
    s_nop 0
    v_add_f32_dpp v158, v158, v158 quad_perm:[1,0,3,2] row_mask:0xf bank_mask:0xf
    v_cndmask_b32 v150, v150, v154, s[66:67]
    s_nop 0
    v_add_f32_dpp v158, v158, v158 quad_perm:[2,3,0,1] row_mask:0xf bank_mask:0xf
    v_cndmask_b32 v150, v150, v158, s[68:69]
    v_mul_f32 v150, 0x3db8aa3b, v150
    v_exp_f32 v150, v150
    s_nop 0
    v_mov_b32 v44, v150
    v_mov_b32 v45, v150
    s_nop 1
    v_permlane32_swap_b32 v44, v45
    v_add_f32 v44, v44, v45
    v_mov_b32 v45, v44
    s_nop 1
    v_permlane16_swap_b32 v44, v45
    v_add_f32 v44, v44, v45
    v_add_f32 v44, 0x3089705f, v44
    v_rcp_f32 v44, v44
    s_nop 0
    v_mul_f32 v150, v150, v44
    v_cvt_pk_bf16_f32 v150, v150, 0
    v_lshlrev_b32 v8, v9, v150
    s_nop 1
    v_and_b32_dpp v24, v8, v12 row_newbcast:0 row_mask:0xf bank_mask:0xf
    v_and_b32_dpp v25, v8, v13 row_newbcast:0 row_mask:0xf bank_mask:0xf
    v_mov_b64 v[40:41], 0
    v_mov_b64 v[42:43], 0
    v_mov_b64 v[44:45], 0
    v_mov_b64 v[46:47], 0
    v_smfmac_f32_16x16x32_bf16 v[40:43], v[24:25], v[176:179], v14
    v_and_b32_dpp v28, v8, v12 row_newbcast:8 row_mask:0xf bank_mask:0xf
    v_and_b32_dpp v29, v8, v13 row_newbcast:8 row_mask:0xf bank_mask:0xf
    v_smfmac_f32_16x16x32_bf16 v[44:47], v[24:25], v[180:183], v14
    v_add_u32_dpp v11, v32, v7 row_newbcast:12 row_mask:0xf bank_mask:0xf
    buffer_load_dwordx4 v[144:147], v11, s[32:35], 0 offen offset:0
    buffer_load_dwordx4 v[152:155], v11, s[32:35], 0 offen offset:256
    v_smfmac_f32_16x16x32_bf16 v[40:43], v[28:29], v[184:187], v14
    v_and_b32_dpp v24, v8, v12 row_newbcast:4 row_mask:0xf bank_mask:0xf
    v_and_b32_dpp v25, v8, v13 row_newbcast:4 row_mask:0xf bank_mask:0xf
    v_smfmac_f32_16x16x32_bf16 v[44:47], v[28:29], v[188:191], v14
    s_nop 0
    v_smfmac_f32_16x16x32_bf16 v[16:19], v[24:25], v[192:195], v14
    v_and_b32_dpp v28, v8, v12 row_newbcast:12 row_mask:0xf bank_mask:0xf
    v_and_b32_dpp v29, v8, v13 row_newbcast:12 row_mask:0xf bank_mask:0xf
    v_smfmac_f32_16x16x32_bf16 v[20:23], v[24:25], v[196:199], v14
    v_add_u32_dpp v11, v32, v7 row_newbcast:13 row_mask:0xf bank_mask:0xf
    buffer_load_dwordx4 v[148:151], v11, s[32:35], 0 offen offset:0
    buffer_load_dwordx4 v[156:159], v11, s[32:35], 0 offen offset:256
    v_smfmac_f32_16x16x32_bf16 v[16:19], v[28:29], v[200:203], v14
    v_and_b32_dpp v24, v8, v12 row_newbcast:1 row_mask:0xf bank_mask:0xf
    v_and_b32_dpp v25, v8, v13 row_newbcast:1 row_mask:0xf bank_mask:0xf
    v_smfmac_f32_16x16x32_bf16 v[20:23], v[28:29], v[204:207], v14
    v_xor_b32 v178, s15, v2
    s_lshl_b32 s64, s20, 2
    v_add_u32 v9, s64, v0
    v_mov_b32 v179, 0
    v_cvt_pk_bf16_f32 v30, v40, v41
    v_cvt_pk_bf16_f32 v31, v42, v43
    ds_write_b64 v178, v[30:31] offset:1024
    v_cvt_pk_bf16_f32 v30, v44, v45
    v_cvt_pk_bf16_f32 v31, v46, v47
    ds_write_b64 v178, v[30:31] offset:1280
    ds_read_u16_d16_hi v179, v9
    v_mov_b64 v[40:41], 0
    v_mov_b64 v[42:43], 0
    v_mov_b64 v[44:45], 0
    v_mov_b64 v[46:47], 0
    s_nop 0
    v_smfmac_f32_16x16x32_bf16 v[40:43], v[24:25], v[208:211], v14
    v_and_b32_dpp v28, v8, v12 row_newbcast:9 row_mask:0xf bank_mask:0xf
    v_and_b32_dpp v29, v8, v13 row_newbcast:9 row_mask:0xf bank_mask:0xf
    v_smfmac_f32_16x16x32_bf16 v[44:47], v[24:25], v[212:215], v14
    v_add_u32_dpp v11, v32, v7 row_newbcast:14 row_mask:0xf bank_mask:0xf
    buffer_load_dwordx4 v[160:163], v11, s[32:35], 0 offen offset:0
    buffer_load_dwordx4 v[168:171], v11, s[32:35], 0 offen offset:256
    v_smfmac_f32_16x16x32_bf16 v[40:43], v[28:29], v[216:219], v14
    v_and_b32_dpp v24, v8, v12 row_newbcast:5 row_mask:0xf bank_mask:0xf
    v_and_b32_dpp v25, v8, v13 row_newbcast:5 row_mask:0xf bank_mask:0xf
    v_smfmac_f32_16x16x32_bf16 v[44:47], v[28:29], v[220:223], v14
    v_xor_b32 v180, s16, v2
    s_lshl_b32 s64, s21, 2
    v_add_u32 v9, s64, v0
    v_mov_b32 v181, 0
    v_cvt_pk_bf16_f32 v30, v16, v17
    v_cvt_pk_bf16_f32 v31, v18, v19
    ds_write_b64 v180, v[30:31] offset:1024
    v_cvt_pk_bf16_f32 v30, v20, v21
    v_cvt_pk_bf16_f32 v31, v22, v23
    ds_write_b64 v180, v[30:31] offset:1280
    ds_read_u16_d16_hi v181, v9
    v_mov_b64 v[16:17], 0
    v_mov_b64 v[18:19], 0
    v_mov_b64 v[20:21], 0
    v_mov_b64 v[22:23], 0
    s_nop 0
    v_smfmac_f32_16x16x32_bf16 v[16:19], v[24:25], v[224:227], v14
    v_and_b32_dpp v28, v8, v12 row_newbcast:13 row_mask:0xf bank_mask:0xf
    v_and_b32_dpp v29, v8, v13 row_newbcast:13 row_mask:0xf bank_mask:0xf
    v_smfmac_f32_16x16x32_bf16 v[20:23], v[24:25], v[228:231], v14
    v_add_u32_dpp v11, v32, v7 row_newbcast:15 row_mask:0xf bank_mask:0xf
    buffer_load_dwordx4 v[164:167], v11, s[32:35], 0 offen offset:0
    buffer_load_dwordx4 v[172:175], v11, s[32:35], 0 offen offset:256
    v_smfmac_f32_16x16x32_bf16 v[16:19], v[28:29], v[232:235], v14
    v_and_b32_dpp v24, v8, v12 row_newbcast:2 row_mask:0xf bank_mask:0xf
    v_and_b32_dpp v25, v8, v13 row_newbcast:2 row_mask:0xf bank_mask:0xf
    v_smfmac_f32_16x16x32_bf16 v[20:23], v[28:29], v[236:239], v14
    v_xor_b32 v182, s17, v2
    s_lshl_b32 s64, s22, 2
    v_add_u32 v9, s64, v0
    v_mov_b32 v183, 0
    v_cvt_pk_bf16_f32 v30, v40, v41
    v_cvt_pk_bf16_f32 v31, v42, v43
    ds_write_b64 v182, v[30:31] offset:1024
    v_cvt_pk_bf16_f32 v30, v44, v45
    v_cvt_pk_bf16_f32 v31, v46, v47
    ds_write_b64 v182, v[30:31] offset:1280
    ds_read_u16_d16_hi v183, v9
    v_mov_b64 v[40:41], 0
    v_mov_b64 v[42:43], 0
    v_mov_b64 v[44:45], 0
    v_mov_b64 v[46:47], 0
    s_nop 0
    v_smfmac_f32_16x16x32_bf16 v[40:43], v[24:25], v[240:243], v14
    v_and_b32_dpp v28, v8, v12 row_newbcast:10 row_mask:0xf bank_mask:0xf
    v_and_b32_dpp v29, v8, v13 row_newbcast:10 row_mask:0xf bank_mask:0xf
    v_smfmac_f32_16x16x32_bf16 v[44:47], v[24:25], v[244:247], v14
    s_nop 0
    v_smfmac_f32_16x16x32_bf16 v[40:43], v[28:29], v[248:251], v14
    v_and_b32_dpp v24, v33, v12 row_newbcast:0 row_mask:0xf bank_mask:0xf
    v_and_b32_dpp v25, v33, v13 row_newbcast:0 row_mask:0xf bank_mask:0xf
    v_and_b32_dpp v26, v33, v12 row_newbcast:1 row_mask:0xf bank_mask:0xf
    v_and_b32_dpp v27, v33, v13 row_newbcast:1 row_mask:0xf bank_mask:0xf
    v_smfmac_f32_16x16x32_bf16 v[44:47], v[28:29], v[252:255], v14
    v_xor_b32 v184, s18, v2
    s_lshl_b32 s64, s23, 2
    v_add_u32 v9, s64, v0
    v_mov_b32 v185, 0
    v_cvt_pk_bf16_f32 v30, v16, v17
    v_cvt_pk_bf16_f32 v31, v18, v19
    ds_write_b64 v184, v[30:31] offset:1024
    v_cvt_pk_bf16_f32 v30, v20, v21
    v_cvt_pk_bf16_f32 v31, v22, v23
    ds_write_b64 v184, v[30:31] offset:1280
    ds_read_u16_d16_hi v185, v9
    v_mov_b64 v[16:17], 0
    v_mov_b64 v[18:19], 0
    v_mov_b64 v[20:21], 0
    v_mov_b64 v[22:23], 0
    s_nop 0
    v_xor_b32 v176, s19, v2
    s_lshl_b32 s64, s24, 2
    v_add_u32 v9, s64, v0
    v_mov_b32 v177, 0
    v_cvt_pk_bf16_f32 v30, v40, v41
    v_cvt_pk_bf16_f32 v31, v42, v43
    ds_write_b64 v176, v[30:31] offset:1024
    v_cvt_pk_bf16_f32 v30, v44, v45
    v_cvt_pk_bf16_f32 v31, v46, v47
    ds_write_b64 v176, v[30:31] offset:1280
    ds_read_u16_d16_hi v177, v9
    s_waitcnt lgkmcnt(0)
    s_barrier
    s_cmp_lg_u32 s25, 0
    s_cbranch_scc1 L_slow
L_fp0:
    s_bitcmp1_b32 s52, 0
    s_waitcnt vmcnt(28)
    v_smfmac_f32_16x16x64_bf16 v[16:19], v[24:27], v[48:55], v14
    v_and_b32_dpp v28, v33, v12 row_newbcast:2 row_mask:0xf bank_mask:0xf
    v_and_b32_dpp v29, v33, v13 row_newbcast:2 row_mask:0xf bank_mask:0xf
    v_smfmac_f32_16x16x64_bf16 v[20:23], v[24:27], v[56:63], v14
    v_and_b32_dpp v30, v33, v12 row_newbcast:3 row_mask:0xf bank_mask:0xf
    v_and_b32_dpp v31, v33, v13 row_newbcast:3 row_mask:0xf bank_mask:0xf
    v_add_u32_dpp v11, v34, v7 row_newbcast:0 row_mask:0xf bank_mask:0xf
    buffer_load_dwordx4 v[48:51], v11, s[32:35], 0 offen offset:0
    buffer_load_dwordx4 v[56:59], v11, s[32:35], 0 offen offset:256
    s_cbranch_scc1 L_ev0
L_fp1:
    s_bitcmp1_b32 s52, 1
    s_waitcnt vmcnt(26)
    v_smfmac_f32_16x16x64_bf16 v[16:19], v[28:31], v[64:71], v14
    v_and_b32_dpp v24, v33, v12 row_newbcast:4 row_mask:0xf bank_mask:0xf
    v_and_b32_dpp v25, v33, v13 row_newbcast:4 row_mask:0xf bank_mask:0xf
    v_smfmac_f32_16x16x64_bf16 v[20:23], v[28:31], v[72:79], v14
    v_and_b32_dpp v26, v33, v12 row_newbcast:5 row_mask:0xf bank_mask:0xf
    v_and_b32_dpp v27, v33, v13 row_newbcast:5 row_mask:0xf bank_mask:0xf
    v_add_u32_dpp v11, v34, v7 row_newbcast:1 row_mask:0xf bank_mask:0xf
    buffer_load_dwordx4 v[52:55], v11, s[32:35], 0 offen offset:0
    buffer_load_dwordx4 v[60:63], v11, s[32:35], 0 offen offset:256
    s_cbranch_scc1 L_ev1
L_fp2:
    s_bitcmp1_b32 s52, 2
    s_waitcnt vmcnt(24)
    v_smfmac_f32_16x16x64_bf16 v[16:19], v[24:27], v[80:87], v14
    v_and_b32_dpp v28, v33, v12 row_newbcast:6 row_mask:0xf bank_mask:0xf
    v_and_b32_dpp v29, v33, v13 row_newbcast:6 row_mask:0xf bank_mask:0xf
    v_smfmac_f32_16x16x64_bf16 v[20:23], v[24:27], v[88:95], v14
    v_and_b32_dpp v30, v33, v12 row_newbcast:7 row_mask:0xf bank_mask:0xf
    v_and_b32_dpp v31, v33, v13 row_newbcast:7 row_mask:0xf bank_mask:0xf
    v_add_u32_dpp v11, v34, v7 row_newbcast:2 row_mask:0xf bank_mask:0xf
    buffer_load_dwordx4 v[64:67], v11, s[32:35], 0 offen offset:0
    buffer_load_dwordx4 v[72:75], v11, s[32:35], 0 offen offset:256
    s_cbranch_scc1 L_ev2
L_fp3:
    s_bitcmp1_b32 s52, 3
    s_waitcnt vmcnt(22)
    v_smfmac_f32_16x16x64_bf16 v[16:19], v[28:31], v[96:103], v14
    v_and_b32_dpp v24, v33, v12 row_newbcast:8 row_mask:0xf bank_mask:0xf
    v_and_b32_dpp v25, v33, v13 row_newbcast:8 row_mask:0xf bank_mask:0xf
    v_smfmac_f32_16x16x64_bf16 v[20:23], v[28:31], v[104:111], v14
    v_and_b32_dpp v26, v33, v12 row_newbcast:9 row_mask:0xf bank_mask:0xf
    v_and_b32_dpp v27, v33, v13 row_newbcast:9 row_mask:0xf bank_mask:0xf
    v_add_u32_dpp v11, v34, v7 row_newbcast:3 row_mask:0xf bank_mask:0xf
    buffer_load_dwordx4 v[68:71], v11, s[32:35], 0 offen offset:0
    buffer_load_dwordx4 v[76:79], v11, s[32:35], 0 offen offset:256
    s_cbranch_scc1 L_ev3
L_fp4:
    s_bitcmp1_b32 s52, 4
    s_waitcnt vmcnt(20)
    v_smfmac_f32_16x16x64_bf16 v[16:19], v[24:27], v[112:119], v14
    v_and_b32_dpp v28, v33, v12 row_newbcast:10 row_mask:0xf bank_mask:0xf
    v_and_b32_dpp v29, v33, v13 row_newbcast:10 row_mask:0xf bank_mask:0xf
    v_smfmac_f32_16x16x64_bf16 v[20:23], v[24:27], v[120:127], v14
    v_and_b32_dpp v30, v33, v12 row_newbcast:11 row_mask:0xf bank_mask:0xf
    v_and_b32_dpp v31, v33, v13 row_newbcast:11 row_mask:0xf bank_mask:0xf
    v_add_u32_dpp v11, v34, v7 row_newbcast:4 row_mask:0xf bank_mask:0xf
    buffer_load_dwordx4 v[80:83], v11, s[32:35], 0 offen offset:0
    buffer_load_dwordx4 v[88:91], v11, s[32:35], 0 offen offset:256
    s_cbranch_scc1 L_ev4
L_fp5:
    s_bitcmp1_b32 s52, 5
    s_waitcnt vmcnt(18)
    v_smfmac_f32_16x16x64_bf16 v[16:19], v[28:31], v[128:135], v14
    v_and_b32_dpp v24, v33, v12 row_newbcast:12 row_mask:0xf bank_mask:0xf
    v_and_b32_dpp v25, v33, v13 row_newbcast:12 row_mask:0xf bank_mask:0xf
    v_smfmac_f32_16x16x64_bf16 v[20:23], v[28:31], v[136:143], v14
    v_and_b32_dpp v26, v33, v12 row_newbcast:13 row_mask:0xf bank_mask:0xf
    v_and_b32_dpp v27, v33, v13 row_newbcast:13 row_mask:0xf bank_mask:0xf
    v_add_u32_dpp v11, v34, v7 row_newbcast:5 row_mask:0xf bank_mask:0xf
    buffer_load_dwordx4 v[84:87], v11, s[32:35], 0 offen offset:0
    buffer_load_dwordx4 v[92:95], v11, s[32:35], 0 offen offset:256
    s_cbranch_scc1 L_ev5
L_fp6:
    s_bitcmp1_b32 s52, 6
    s_waitcnt vmcnt(16)
    v_smfmac_f32_16x16x64_bf16 v[16:19], v[24:27], v[144:151], v14
    v_and_b32_dpp v28, v33, v12 row_newbcast:14 row_mask:0xf bank_mask:0xf
    v_and_b32_dpp v29, v33, v13 row_newbcast:14 row_mask:0xf bank_mask:0xf
    v_smfmac_f32_16x16x64_bf16 v[20:23], v[24:27], v[152:159], v14
    v_and_b32_dpp v30, v33, v12 row_newbcast:15 row_mask:0xf bank_mask:0xf
    v_and_b32_dpp v31, v33, v13 row_newbcast:15 row_mask:0xf bank_mask:0xf
    v_add_u32_dpp v11, v34, v7 row_newbcast:6 row_mask:0xf bank_mask:0xf
    buffer_load_dwordx4 v[96:99], v11, s[32:35], 0 offen offset:0
    buffer_load_dwordx4 v[104:107], v11, s[32:35], 0 offen offset:256
    s_cbranch_scc1 L_ev6
L_fp7:
    s_bitcmp1_b32 s52, 7
    s_waitcnt vmcnt(14)
    v_smfmac_f32_16x16x64_bf16 v[16:19], v[28:31], v[160:167], v14
    v_and_b32_dpp v24, v35, v12 row_newbcast:0 row_mask:0xf bank_mask:0xf
    v_and_b32_dpp v25, v35, v13 row_newbcast:0 row_mask:0xf bank_mask:0xf
    v_smfmac_f32_16x16x64_bf16 v[20:23], v[28:31], v[168:175], v14
    v_and_b32_dpp v26, v35, v12 row_newbcast:1 row_mask:0xf bank_mask:0xf
    v_and_b32_dpp v27, v35, v13 row_newbcast:1 row_mask:0xf bank_mask:0xf
    v_add_u32_dpp v11, v34, v7 row_newbcast:7 row_mask:0xf bank_mask:0xf
    buffer_load_dwordx4 v[100:103], v11, s[32:35], 0 offen offset:0
    buffer_load_dwordx4 v[108:111], v11, s[32:35], 0 offen offset:256
    s_cbranch_scc1 L_ev7
L_fp8:
    v_mov_b64 v[32:33], v[34:35]
    v_mov_b64 v[34:35], v[36:37]
    v_mov_b64 v[36:37], v[38:39]
    s_lshr_b32 s52, s52, 8
    s_lshr_b32 s53, s53, 8
    s_lshr_b32 s56, s56, 8
    s_mov_b32 s62, L_st1-L_anc
    s_mov_b32 s63, L_st1-L_st0
L_st0:
    s_bitcmp1_b32 s52, 0
    s_waitcnt vmcnt(12)
    v_smfmac_f32_16x16x64_bf16 v[16:19], v[24:27], v[48:55], v14
    v_and_b32_dpp v28, v33, v12 row_newbcast:2 row_mask:0xf bank_mask:0xf
    v_and_b32_dpp v29, v33, v13 row_newbcast:2 row_mask:0xf bank_mask:0xf
    v_smfmac_f32_16x16x64_bf16 v[20:23], v[24:27], v[56:63], v14
    v_and_b32_dpp v30, v33, v12 row_newbcast:3 row_mask:0xf bank_mask:0xf
    v_and_b32_dpp v31, v33, v13 row_newbcast:3 row_mask:0xf bank_mask:0xf
    v_add_u32_dpp v11, v32, v7 row_newbcast:8 row_mask:0xf bank_mask:0xf
    buffer_load_dwordx4 v[112:115], v11, s[32:35], 0 offen offset:0
    buffer_load_dwordx4 v[120:123], v11, s[32:35], 0 offen offset:256
    v_add_u32_dpp v11, v32, v7 row_newbcast:9 row_mask:0xf bank_mask:0xf
    buffer_load_dwordx4 v[116:119], v11, s[32:35], 0 offen offset:0
    buffer_load_dwordx4 v[124:127], v11, s[32:35], 0 offen offset:256
    s_cbranch_scc1 L_ev0
L_st1:
    s_bitcmp1_b32 s52, 1
    s_waitcnt vmcnt(12)
    v_smfmac_f32_16x16x64_bf16 v[16:19], v[28:31], v[64:71], v14
    v_and_b32_dpp v24, v33, v12 row_newbcast:4 row_mask:0xf bank_mask:0xf
    v_and_b32_dpp v25, v33, v13 row_newbcast:4 row_mask:0xf bank_mask:0xf
    v_smfmac_f32_16x16x64_bf16 v[20:23], v[28:31], v[72:79], v14
    v_and_b32_dpp v26, v33, v12 row_newbcast:5 row_mask:0xf bank_mask:0xf
    v_and_b32_dpp v27, v33, v13 row_newbcast:5 row_mask:0xf bank_mask:0xf
    v_add_u32_dpp v11, v32, v7 row_newbcast:10 row_mask:0xf bank_mask:0xf
    buffer_load_dwordx4 v[128:131], v11, s[32:35], 0 offen offset:0
    buffer_load_dwordx4 v[136:139], v11, s[32:35], 0 offen offset:256
    v_add_u32_dpp v11, v32, v7 row_newbcast:11 row_mask:0xf bank_mask:0xf
    buffer_load_dwordx4 v[132:135], v11, s[32:35], 0 offen offset:0
    buffer_load_dwordx4 v[140:143], v11, s[32:35], 0 offen offset:256
    s_cbranch_scc1 L_ev1
L_st2:
    s_bitcmp1_b32 s52, 2
    s_waitcnt vmcnt(12)
    v_smfmac_f32_16x16x64_bf16 v[16:19], v[24:27], v[80:87], v14
    v_and_b32_dpp v28, v33, v12 row_newbcast:6 row_mask:0xf bank_mask:0xf
    v_and_b32_dpp v29, v33, v13 row_newbcast:6 row_mask:0xf bank_mask:0xf
    v_smfmac_f32_16x16x64_bf16 v[20:23], v[24:27], v[88:95], v14
    v_and_b32_dpp v30, v33, v12 row_newbcast:7 row_mask:0xf bank_mask:0xf
    v_and_b32_dpp v31, v33, v13 row_newbcast:7 row_mask:0xf bank_mask:0xf
    v_add_u32_dpp v11, v32, v7 row_newbcast:12 row_mask:0xf bank_mask:0xf
    buffer_load_dwordx4 v[144:147], v11, s[32:35], 0 offen offset:0
    buffer_load_dwordx4 v[152:155], v11, s[32:35], 0 offen offset:256
    v_add_u32_dpp v11, v32, v7 row_newbcast:13 row_mask:0xf bank_mask:0xf
    buffer_load_dwordx4 v[148:151], v11, s[32:35], 0 offen offset:0
    buffer_load_dwordx4 v[156:159], v11, s[32:35], 0 offen offset:256
    s_cbranch_scc1 L_ev2
L_st3:
    s_bitcmp1_b32 s52, 3
    s_waitcnt vmcnt(12)
    v_smfmac_f32_16x16x64_bf16 v[16:19], v[28:31], v[96:103], v14
    v_and_b32_dpp v24, v33, v12 row_newbcast:8 row_mask:0xf bank_mask:0xf
    v_and_b32_dpp v25, v33, v13 row_newbcast:8 row_mask:0xf bank_mask:0xf
    v_smfmac_f32_16x16x64_bf16 v[20:23], v[28:31], v[104:111], v14
    v_and_b32_dpp v26, v33, v12 row_newbcast:9 row_mask:0xf bank_mask:0xf
    v_and_b32_dpp v27, v33, v13 row_newbcast:9 row_mask:0xf bank_mask:0xf
    v_add_u32_dpp v11, v32, v7 row_newbcast:14 row_mask:0xf bank_mask:0xf
    buffer_load_dwordx4 v[160:163], v11, s[32:35], 0 offen offset:0
    buffer_load_dwordx4 v[168:171], v11, s[32:35], 0 offen offset:256
    v_add_u32_dpp v11, v32, v7 row_newbcast:15 row_mask:0xf bank_mask:0xf
    buffer_load_dwordx4 v[164:167], v11, s[32:35], 0 offen offset:0
    buffer_load_dwordx4 v[172:175], v11, s[32:35], 0 offen offset:256
    s_cbranch_scc1 L_ev3
L_st4:
    s_bitcmp1_b32 s52, 4
    s_waitcnt vmcnt(12)
    v_smfmac_f32_16x16x64_bf16 v[16:19], v[24:27], v[112:119], v14
    v_and_b32_dpp v28, v33, v12 row_newbcast:10 row_mask:0xf bank_mask:0xf
    v_and_b32_dpp v29, v33, v13 row_newbcast:10 row_mask:0xf bank_mask:0xf
    v_smfmac_f32_16x16x64_bf16 v[20:23], v[24:27], v[120:127], v14
    v_and_b32_dpp v30, v33, v12 row_newbcast:11 row_mask:0xf bank_mask:0xf
    v_and_b32_dpp v31, v33, v13 row_newbcast:11 row_mask:0xf bank_mask:0xf
    v_add_u32_dpp v11, v34, v7 row_newbcast:0 row_mask:0xf bank_mask:0xf
    buffer_load_dwordx4 v[48:51], v11, s[32:35], 0 offen offset:0
    buffer_load_dwordx4 v[56:59], v11, s[32:35], 0 offen offset:256
    v_add_u32_dpp v11, v34, v7 row_newbcast:1 row_mask:0xf bank_mask:0xf
    buffer_load_dwordx4 v[52:55], v11, s[32:35], 0 offen offset:0
    buffer_load_dwordx4 v[60:63], v11, s[32:35], 0 offen offset:256
    s_cbranch_scc1 L_ev4
L_st5:
    s_bitcmp1_b32 s52, 5
    s_waitcnt vmcnt(12)
    v_smfmac_f32_16x16x64_bf16 v[16:19], v[28:31], v[128:135], v14
    v_and_b32_dpp v24, v33, v12 row_newbcast:12 row_mask:0xf bank_mask:0xf
    v_and_b32_dpp v25, v33, v13 row_newbcast:12 row_mask:0xf bank_mask:0xf
    v_smfmac_f32_16x16x64_bf16 v[20:23], v[28:31], v[136:143], v14
    v_and_b32_dpp v26, v33, v12 row_newbcast:13 row_mask:0xf bank_mask:0xf
    v_and_b32_dpp v27, v33, v13 row_newbcast:13 row_mask:0xf bank_mask:0xf
    v_add_u32_dpp v11, v34, v7 row_newbcast:2 row_mask:0xf bank_mask:0xf
    buffer_load_dwordx4 v[64:67], v11, s[32:35], 0 offen offset:0
    buffer_load_dwordx4 v[72:75], v11, s[32:35], 0 offen offset:256
    v_add_u32_dpp v11, v34, v7 row_newbcast:3 row_mask:0xf bank_mask:0xf
    buffer_load_dwordx4 v[68:71], v11, s[32:35], 0 offen offset:0
    buffer_load_dwordx4 v[76:79], v11, s[32:35], 0 offen offset:256
    s_cbranch_scc1 L_ev5
L_st6:
    s_bitcmp1_b32 s52, 6
    s_waitcnt vmcnt(12)
    v_smfmac_f32_16x16x64_bf16 v[16:19], v[24:27], v[144:151], v14
    v_and_b32_dpp v28, v33, v12 row_newbcast:14 row_mask:0xf bank_mask:0xf
    v_and_b32_dpp v29, v33, v13 row_newbcast:14 row_mask:0xf bank_mask:0xf
    v_smfmac_f32_16x16x64_bf16 v[20:23], v[24:27], v[152:159], v14
    v_and_b32_dpp v30, v33, v12 row_newbcast:15 row_mask:0xf bank_mask:0xf
    v_and_b32_dpp v31, v33, v13 row_newbcast:15 row_mask:0xf bank_mask:0xf
    v_add_u32_dpp v11, v34, v7 row_newbcast:4 row_mask:0xf bank_mask:0xf
    buffer_load_dwordx4 v[80:83], v11, s[32:35], 0 offen offset:0
    buffer_load_dwordx4 v[88:91], v11, s[32:35], 0 offen offset:256
    v_add_u32_dpp v11, v34, v7 row_newbcast:5 row_mask:0xf bank_mask:0xf
    buffer_load_dwordx4 v[84:87], v11, s[32:35], 0 offen offset:0
    buffer_load_dwordx4 v[92:95], v11, s[32:35], 0 offen offset:256
    s_cbranch_scc1 L_ev6
L_st7:
    s_bitcmp1_b32 s52, 7
    s_waitcnt vmcnt(12)
    v_smfmac_f32_16x16x64_bf16 v[16:19], v[28:31], v[160:167], v14
    v_and_b32_dpp v24, v35, v12 row_newbcast:0 row_mask:0xf bank_mask:0xf
    v_and_b32_dpp v25, v35, v13 row_newbcast:0 row_mask:0xf bank_mask:0xf
    v_smfmac_f32_16x16x64_bf16 v[20:23], v[28:31], v[168:175], v14
    v_and_b32_dpp v26, v35, v12 row_newbcast:1 row_mask:0xf bank_mask:0xf
    v_and_b32_dpp v27, v35, v13 row_newbcast:1 row_mask:0xf bank_mask:0xf
    v_add_u32_dpp v11, v34, v7 row_newbcast:6 row_mask:0xf bank_mask:0xf
    buffer_load_dwordx4 v[96:99], v11, s[32:35], 0 offen offset:0
    buffer_load_dwordx4 v[104:107], v11, s[32:35], 0 offen offset:256
    v_add_u32_dpp v11, v34, v7 row_newbcast:7 row_mask:0xf bank_mask:0xf
    buffer_load_dwordx4 v[100:103], v11, s[32:35], 0 offen offset:0
    buffer_load_dwordx4 v[108:111], v11, s[32:35], 0 offen offset:256
    s_cbranch_scc1 L_ev7
L_st8:
    v_mov_b64 v[32:33], v[34:35]
    v_mov_b64 v[34:35], v[36:37]
    v_mov_b64 v[36:37], v[38:39]
    s_lshr_b32 s52, s52, 8
    s_lshr_b32 s53, s53, 8
    s_lshr_b32 s56, s56, 8
    s_branch L_st0
L_pad8:
    s_setpc_b64 s[68:69]
L_dr0:
    s_bitcmp1_b32 s52, 0
    ds_write_b32 v10, v6 offset:48
    s_waitcnt vmcnt(12)
    v_smfmac_f32_16x16x64_bf16 v[16:19], v[24:27], v[48:55], v14
    v_and_b32_dpp v28, v33, v12 row_newbcast:2 row_mask:0xf bank_mask:0xf
    v_and_b32_dpp v29, v33, v13 row_newbcast:2 row_mask:0xf bank_mask:0xf
    v_smfmac_f32_16x16x64_bf16 v[20:23], v[24:27], v[56:63], v14
    v_and_b32_dpp v30, v33, v12 row_newbcast:3 row_mask:0xf bank_mask:0xf
    v_and_b32_dpp v31, v33, v13 row_newbcast:3 row_mask:0xf bank_mask:0xf
    buffer_load_ubyte v15, off, s[32:35], 0
    buffer_load_ubyte v15, off, s[32:35], 0
    buffer_load_ubyte v15, off, s[32:35], 0
    buffer_load_ubyte v15, off, s[32:35], 0
    s_cbranch_scc1 L_ev0
L_dr1:
    s_bitcmp1_b32 s52, 1
    ds_write_b32 v10, v6 offset:48
    s_waitcnt vmcnt(12)
    v_smfmac_f32_16x16x64_bf16 v[16:19], v[28:31], v[64:71], v14
    v_and_b32_dpp v24, v33, v12 row_newbcast:4 row_mask:0xf bank_mask:0xf
    v_and_b32_dpp v25, v33, v13 row_newbcast:4 row_mask:0xf bank_mask:0xf
    v_smfmac_f32_16x16x64_bf16 v[20:23], v[28:31], v[72:79], v14
    v_and_b32_dpp v26, v33, v12 row_newbcast:5 row_mask:0xf bank_mask:0xf
    v_and_b32_dpp v27, v33, v13 row_newbcast:5 row_mask:0xf bank_mask:0xf
    buffer_load_ubyte v15, off, s[32:35], 0
    buffer_load_ubyte v15, off, s[32:35], 0
    buffer_load_ubyte v15, off, s[32:35], 0
    buffer_load_ubyte v15, off, s[32:35], 0
    s_cbranch_scc1 L_ev1
L_dr2:
    s_bitcmp1_b32 s52, 2
    ds_write_b32 v10, v6 offset:48
    s_waitcnt vmcnt(12)
    v_smfmac_f32_16x16x64_bf16 v[16:19], v[24:27], v[80:87], v14
    v_and_b32_dpp v28, v33, v12 row_newbcast:6 row_mask:0xf bank_mask:0xf
    v_and_b32_dpp v29, v33, v13 row_newbcast:6 row_mask:0xf bank_mask:0xf
    v_smfmac_f32_16x16x64_bf16 v[20:23], v[24:27], v[88:95], v14
    v_and_b32_dpp v30, v33, v12 row_newbcast:7 row_mask:0xf bank_mask:0xf
    v_and_b32_dpp v31, v33, v13 row_newbcast:7 row_mask:0xf bank_mask:0xf
    buffer_load_ubyte v15, off, s[32:35], 0
    buffer_load_ubyte v15, off, s[32:35], 0
    buffer_load_ubyte v15, off, s[32:35], 0
    buffer_load_ubyte v15, off, s[32:35], 0
    s_cbranch_scc1 L_ev2
L_dr3:
    s_bitcmp1_b32 s52, 3
    ds_write_b32 v10, v6 offset:48
    s_waitcnt vmcnt(12)
    v_smfmac_f32_16x16x64_bf16 v[16:19], v[28:31], v[96:103], v14
    v_and_b32_dpp v24, v33, v12 row_newbcast:8 row_mask:0xf bank_mask:0xf
    v_and_b32_dpp v25, v33, v13 row_newbcast:8 row_mask:0xf bank_mask:0xf
    v_smfmac_f32_16x16x64_bf16 v[20:23], v[28:31], v[104:111], v14
    v_and_b32_dpp v26, v33, v12 row_newbcast:9 row_mask:0xf bank_mask:0xf
    v_and_b32_dpp v27, v33, v13 row_newbcast:9 row_mask:0xf bank_mask:0xf
    buffer_load_ubyte v15, off, s[32:35], 0
    buffer_load_ubyte v15, off, s[32:35], 0
    buffer_load_ubyte v15, off, s[32:35], 0
    buffer_load_ubyte v15, off, s[32:35], 0
    s_cbranch_scc1 L_ev3
L_dr4:
    s_bitcmp1_b32 s52, 4
    ds_write_b32 v10, v6 offset:48
    s_waitcnt vmcnt(12)
    v_smfmac_f32_16x16x64_bf16 v[16:19], v[24:27], v[112:119], v14
    v_and_b32_dpp v28, v33, v12 row_newbcast:10 row_mask:0xf bank_mask:0xf
    v_and_b32_dpp v29, v33, v13 row_newbcast:10 row_mask:0xf bank_mask:0xf
    v_smfmac_f32_16x16x64_bf16 v[20:23], v[24:27], v[120:127], v14
    v_and_b32_dpp v30, v33, v12 row_newbcast:11 row_mask:0xf bank_mask:0xf
    v_and_b32_dpp v31, v33, v13 row_newbcast:11 row_mask:0xf bank_mask:0xf
    buffer_load_ubyte v15, off, s[32:35], 0
    buffer_load_ubyte v15, off, s[32:35], 0
    buffer_load_ubyte v15, off, s[32:35], 0
    buffer_load_ubyte v15, off, s[32:35], 0
    s_cbranch_scc1 L_ev4
L_dr5:
    s_bitcmp1_b32 s52, 5
    ds_write_b32 v10, v6 offset:48
    s_waitcnt vmcnt(12)
    v_smfmac_f32_16x16x64_bf16 v[16:19], v[28:31], v[128:135], v14
    v_and_b32_dpp v24, v33, v12 row_newbcast:12 row_mask:0xf bank_mask:0xf
    v_and_b32_dpp v25, v33, v13 row_newbcast:12 row_mask:0xf bank_mask:0xf
    v_smfmac_f32_16x16x64_bf16 v[20:23], v[28:31], v[136:143], v14
    v_and_b32_dpp v26, v33, v12 row_newbcast:13 row_mask:0xf bank_mask:0xf
    v_and_b32_dpp v27, v33, v13 row_newbcast:13 row_mask:0xf bank_mask:0xf
    buffer_load_ubyte v15, off, s[32:35], 0
    buffer_load_ubyte v15, off, s[32:35], 0
    buffer_load_ubyte v15, off, s[32:35], 0
    buffer_load_ubyte v15, off, s[32:35], 0
    s_cbranch_scc1 L_ev5
L_dr6:
    s_bitcmp1_b32 s52, 6
    ds_write_b32 v10, v6 offset:48
    s_waitcnt vmcnt(12)
    v_smfmac_f32_16x16x64_bf16 v[16:19], v[24:27], v[144:151], v14
    v_and_b32_dpp v28, v33, v12 row_newbcast:14 row_mask:0xf bank_mask:0xf
    v_and_b32_dpp v29, v33, v13 row_newbcast:14 row_mask:0xf bank_mask:0xf
    v_smfmac_f32_16x16x64_bf16 v[20:23], v[24:27], v[152:159], v14
    v_and_b32_dpp v30, v33, v12 row_newbcast:15 row_mask:0xf bank_mask:0xf
    v_and_b32_dpp v31, v33, v13 row_newbcast:15 row_mask:0xf bank_mask:0xf
    buffer_load_ubyte v15, off, s[32:35], 0
    buffer_load_ubyte v15, off, s[32:35], 0
    buffer_load_ubyte v15, off, s[32:35], 0
    buffer_load_ubyte v15, off, s[32:35], 0
    s_cbranch_scc1 L_ev6
L_dr7:
    s_bitcmp1_b32 s52, 7
    ds_write_b32 v10, v6 offset:48
    s_waitcnt vmcnt(12)
    v_smfmac_f32_16x16x64_bf16 v[16:19], v[28:31], v[160:167], v14
    v_and_b32_dpp v24, v35, v12 row_newbcast:0 row_mask:0xf bank_mask:0xf
    v_and_b32_dpp v25, v35, v13 row_newbcast:0 row_mask:0xf bank_mask:0xf
    v_smfmac_f32_16x16x64_bf16 v[20:23], v[28:31], v[168:175], v14
    v_and_b32_dpp v26, v35, v12 row_newbcast:1 row_mask:0xf bank_mask:0xf
    v_and_b32_dpp v27, v35, v13 row_newbcast:1 row_mask:0xf bank_mask:0xf
    buffer_load_ubyte v15, off, s[32:35], 0
    buffer_load_ubyte v15, off, s[32:35], 0
    buffer_load_ubyte v15, off, s[32:35], 0
    buffer_load_ubyte v15, off, s[32:35], 0
    s_cbranch_scc1 L_ev7
L_dr8:
    v_mov_b64 v[32:33], v[34:35]
    v_mov_b64 v[34:35], v[36:37]
    v_mov_b64 v[36:37], v[38:39]
    s_lshr_b32 s52, s52, 8
    s_lshr_b32 s53, s53, 8
    s_lshr_b32 s56, s56, 8
    s_branch L_dr0
L_pad0:
    s_setpc_b64 s[68:69]
L_ev0:
    s_and_b32 s65, s57, 15
    v_cmp_ge_u32 s[66:67], s65, v4
    v_cmp_gt_u32 s[68:69], s65, v4
    s_bitcmp1_b32 s56, 0
    s_cselect_b64 s[62:63], s[70:71], s[62:63]
    v_cndmask_b32 v40, 0, v28, s[66:67]
    v_cndmask_b32 v41, 0, v29, s[66:67]
    v_cndmask_b32 v42, 0, v30, s[68:69]
    v_cndmask_b32 v43, 0, v31, s[68:69]
    s_mul_i32 s64, s63, 0
    s_bitcmp1_b32 s53, 0
    s_cbranch_scc0 L_evret
    s_waitcnt vmcnt(12)
    v_smfmac_f32_16x16x64_bf16 v[16:19], v[40:43], v[64:71], v14
    v_xor_b32 v28, v28, v40
    v_xor_b32 v29, v29, v41
    v_smfmac_f32_16x16x64_bf16 v[20:23], v[40:43], v[72:79], v14
    v_xor_b32 v30, v30, v42
    v_xor_b32 v31, v31, v43
    s_branch L_flush
L_pad1:
    s_setpc_b64 s[68:69]
L_ev1:
    s_and_b32 s65, s57, 15
    v_cmp_ge_u32 s[66:67], s65, v4
    v_cmp_gt_u32 s[68:69], s65, v4
    s_bitcmp1_b32 s56, 1
    s_cselect_b64 s[62:63], s[70:71], s[62:63]
    v_cndmask_b32 v40, 0, v24, s[66:67]
    v_cndmask_b32 v41, 0, v25, s[66:67]
    v_cndmask_b32 v42, 0, v26, s[68:69]
    v_cndmask_b32 v43, 0, v27, s[68:69]
    s_mul_i32 s64, s63, 1
    s_bitcmp1_b32 s53, 1
    s_cbranch_scc0 L_evret
    s_waitcnt vmcnt(12)
    v_smfmac_f32_16x16x64_bf16 v[16:19], v[40:43], v[80:87], v14
    v_xor_b32 v24, v24, v40
    v_xor_b32 v25, v25, v41
    v_smfmac_f32_16x16x64_bf16 v[20:23], v[40:43], v[88:95], v14
    v_xor_b32 v26, v26, v42
    v_xor_b32 v27, v27, v43
    s_branch L_flush
L_pad2:
    s_setpc_b64 s[68:69]
L_ev2:
    s_and_b32 s65, s57, 15
    v_cmp_ge_u32 s[66:67], s65, v4
    v_cmp_gt_u32 s[68:69], s65, v4
    s_bitcmp1_b32 s56, 2
    s_cselect_b64 s[62:63], s[70:71], s[62:63]
    v_cndmask_b32 v40, 0, v28, s[66:67]
    v_cndmask_b32 v41, 0, v29, s[66:67]
    v_cndmask_b32 v42, 0, v30, s[68:69]
    v_cndmask_b32 v43, 0, v31, s[68:69]
    s_mul_i32 s64, s63, 2
    s_bitcmp1_b32 s53, 2
    s_cbranch_scc0 L_evret
    s_waitcnt vmcnt(12)
    v_smfmac_f32_16x16x64_bf16 v[16:19], v[40:43], v[96:103], v14
    v_xor_b32 v28, v28, v40
    v_xor_b32 v29, v29, v41
    v_smfmac_f32_16x16x64_bf16 v[20:23], v[40:43], v[104:111], v14
    v_xor_b32 v30, v30, v42
    v_xor_b32 v31, v31, v43
    s_branch L_flush
L_pad3:
    s_setpc_b64 s[68:69]
L_ev3:
    s_and_b32 s65, s57, 15
    v_cmp_ge_u32 s[66:67], s65, v4
    v_cmp_gt_u32 s[68:69], s65, v4
    s_bitcmp1_b32 s56, 3
    s_cselect_b64 s[62:63], s[70:71], s[62:63]
    v_cndmask_b32 v40, 0, v24, s[66:67]
    v_cndmask_b32 v41, 0, v25, s[66:67]
    v_cndmask_b32 v42, 0, v26, s[68:69]
    v_cndmask_b32 v43, 0, v27, s[68:69]
    s_mul_i32 s64, s63, 3
    s_bitcmp1_b32 s53, 3
    s_cbranch_scc0 L_evret
    s_waitcnt vmcnt(12)
    v_smfmac_f32_16x16x64_bf16 v[16:19], v[40:43], v[112:119], v14
    v_xor_b32 v24, v24, v40
    v_xor_b32 v25, v25, v41
    v_smfmac_f32_16x16x64_bf16 v[20:23], v[40:43], v[120:127], v14
    v_xor_b32 v26, v26, v42
    v_xor_b32 v27, v27, v43
    s_branch L_flush
L_pad4:
    s_setpc_b64 s[68:69]
L_ev4:
    s_and_b32 s65, s57, 15
    v_cmp_ge_u32 s[66:67], s65, v4
    v_cmp_gt_u32 s[68:69], s65, v4
    s_bitcmp1_b32 s56, 4
    s_cselect_b64 s[62:63], s[70:71], s[62:63]
    v_cndmask_b32 v40, 0, v28, s[66:67]
    v_cndmask_b32 v41, 0, v29, s[66:67]
    v_cndmask_b32 v42, 0, v30, s[68:69]
    v_cndmask_b32 v43, 0, v31, s[68:69]
    s_mul_i32 s64, s63, 4
    s_bitcmp1_b32 s53, 4
    s_cbranch_scc0 L_evret
    s_waitcnt vmcnt(12)
    v_smfmac_f32_16x16x64_bf16 v[16:19], v[40:43], v[128:135], v14
    v_xor_b32 v28, v28, v40
    v_xor_b32 v29, v29, v41
    v_smfmac_f32_16x16x64_bf16 v[20:23], v[40:43], v[136:143], v14
    v_xor_b32 v30, v30, v42
    v_xor_b32 v31, v31, v43
    s_branch L_flush
L_pad5:
    s_setpc_b64 s[68:69]
L_ev5:
    s_and_b32 s65, s57, 15
    v_cmp_ge_u32 s[66:67], s65, v4
    v_cmp_gt_u32 s[68:69], s65, v4
    s_bitcmp1_b32 s56, 5
    s_cselect_b64 s[62:63], s[70:71], s[62:63]
    v_cndmask_b32 v40, 0, v24, s[66:67]
    v_cndmask_b32 v41, 0, v25, s[66:67]
    v_cndmask_b32 v42, 0, v26, s[68:69]
    v_cndmask_b32 v43, 0, v27, s[68:69]
    s_mul_i32 s64, s63, 5
    s_bitcmp1_b32 s53, 5
    s_cbranch_scc0 L_evret
    s_waitcnt vmcnt(12)
    v_smfmac_f32_16x16x64_bf16 v[16:19], v[40:43], v[144:151], v14
    v_xor_b32 v24, v24, v40
    v_xor_b32 v25, v25, v41
    v_smfmac_f32_16x16x64_bf16 v[20:23], v[40:43], v[152:159], v14
    v_xor_b32 v26, v26, v42
    v_xor_b32 v27, v27, v43
    s_branch L_flush
L_pad6:
    s_setpc_b64 s[68:69]
L_ev6:
    s_and_b32 s65, s57, 15
    v_cmp_ge_u32 s[66:67], s65, v4
    v_cmp_gt_u32 s[68:69], s65, v4
    s_bitcmp1_b32 s56, 6
    s_cselect_b64 s[62:63], s[70:71], s[62:63]
    v_cndmask_b32 v40, 0, v28, s[66:67]
    v_cndmask_b32 v41, 0, v29, s[66:67]
    v_cndmask_b32 v42, 0, v30, s[68:69]
    v_cndmask_b32 v43, 0, v31, s[68:69]
    s_mul_i32 s64, s63, 6
    s_bitcmp1_b32 s53, 6
    s_cbranch_scc0 L_evret
    s_waitcnt vmcnt(12)
    v_smfmac_f32_16x16x64_bf16 v[16:19], v[40:43], v[160:167], v14
    v_xor_b32 v28, v28, v40
    v_xor_b32 v29, v29, v41
    v_smfmac_f32_16x16x64_bf16 v[20:23], v[40:43], v[168:175], v14
    v_xor_b32 v30, v30, v42
    v_xor_b32 v31, v31, v43
    s_branch L_flush
L_pad7:
    s_setpc_b64 s[68:69]
L_ev7:
    s_and_b32 s65, s57, 15
    v_cmp_ge_u32 s[66:67], s65, v4
    v_cmp_gt_u32 s[68:69], s65, v4
    s_bitcmp1_b32 s56, 7
    s_cselect_b64 s[62:63], s[70:71], s[62:63]
    v_cndmask_b32 v40, 0, v24, s[66:67]
    v_cndmask_b32 v41, 0, v25, s[66:67]
    v_cndmask_b32 v42, 0, v26, s[68:69]
    v_cndmask_b32 v43, 0, v27, s[68:69]
    s_mul_i32 s64, s63, 7
    s_bitcmp1_b32 s53, 7
    s_cbranch_scc0 L_evret
    s_waitcnt vmcnt(12)
    v_smfmac_f32_16x16x64_bf16 v[16:19], v[40:43], v[48:55], v14
    v_xor_b32 v24, v24, v40
    v_xor_b32 v25, v25, v41
    v_smfmac_f32_16x16x64_bf16 v[20:23], v[40:43], v[56:63], v14
    v_xor_b32 v26, v26, v42
    v_xor_b32 v27, v27, v43
    s_nop 0
L_flush:
    s_lshr_b32 s57, s57, 4
    s_cmp_eq_u32 s26, 4
    v_add_u32 v1, 1, v1
    v_mul_f32 v40, v177, v16
    v_mul_f32 v41, v177, v17
    v_mul_f32 v42, v177, v18
    v_mul_f32 v43, v177, v19
    v_cvt_pk_bf16_f32 v40, v40, v41
    v_cvt_pk_bf16_f32 v41, v42, v43
    ds_write_b64 v176, v[40:41] offset:41984
    v_mul_f32 v44, v177, v20
    v_mul_f32 v45, v177, v21
    v_mul_f32 v46, v177, v22
    v_mul_f32 v47, v177, v23
    v_cvt_pk_bf16_f32 v44, v44, v45
    v_cvt_pk_bf16_f32 v45, v46, v47
    ds_write_b64 v176, v[44:45] offset:42240
    ds_write_b32 v10, v1 offset:32
    s_cbranch_scc1 L_sdone
    v_mov_b64 v[16:17], 0
    v_mov_b64 v[18:19], 0
    v_mov_b64 v[20:21], 0
    v_mov_b64 v[22:23], 0
    s_add_u32 s26, s26, 1
    v_mov_b64 v[176:177], v[178:179]
    v_mov_b64 v[178:179], v[180:181]
    v_mov_b64 v[180:181], v[182:183]
    v_mov_b64 v[182:183], v[184:185]
L_evret:
    s_add_u32 s64, s64, s62
    s_add_u32 s54, s72, s64
    s_addc_u32 s55, s73, 0
    s_setpc_b64 s[54:55]
L_pad9:
    s_setpc_b64 s[68:69]
L_slow:
    s_mov_b32 s62, L_slow_pair-L_anc
    v_mbcnt_lo_u32_b32 v200, -1, 0
    v_mbcnt_hi_u32_b32 v200, -1, v200
L_slow_pair:
    v_lshlrev_b32 v201, 2, v200
    s_mul_i32 s70, s1, 40
    s_lshl1_add_u32 s70, s24, s70
    s_mov_b32 s71, 0
    s_mov_b32 s24, s20
    s_mov_b32 s20, s21
    s_mov_b32 s21, s22
    s_mov_b32 s22, s23
L_slow_chunk:
    global_load_dword v202, v201, s[8:9]
    global_load_dword v203, v201, s[6:7]
    v_add_u32 v201, 0x100, v201
    s_waitcnt vmcnt(0)
    v_subrev_u32 v202, s70, v202
    v_cmp_gt_u32 vcc, 2, v202
    v_lshlrev_b32 v204, 1, v203
    ds_read_u16 v204, v204 offset:62464
    s_mov_b64 s[76:77], vcc
    v_lshlrev_b32 v202, 4, v202
    v_lshlrev_b32 v203, 9, v203
    s_waitcnt lgkmcnt(0)
    v_lshlrev_b32 v204, v202, v204
L_slow_edge:
    s_cmp_eq_u64 s[76:77], 0
    s_cbranch_scc1 L_slow_next
    s_ff1_i32_b64 s74, s[76:77]
    s_bitset0_b64 s[76:77], s74
    v_readlane_b32 s64, v203, s74
    v_readlane_b32 s65, v204, s74
    v_mov_b32 v205, 0
    v_mov_b32 v11, 2147483648
    s_mov_b64 exec, 0xffff
    v_mov_b32 v205, s65
    v_add_u32 v11, s64, v7
    s_mov_b64 exec, -1
    buffer_load_dwordx4 v[208:211], v11, s[32:35], 0 offen
    buffer_load_dwordx4 v[212:215], v11, s[32:35], 0 offen offset:256
    v_and_b32 v24, v205, v12
    v_and_b32 v25, v205, v13
    s_nop 0
    s_waitcnt vmcnt(0)
    v_smfmac_f32_16x16x32_bf16 v[16:19], v[24:25], v[208:211], v14
    v_smfmac_f32_16x16x32_bf16 v[20:23], v[24:25], v[212:215], v14
    s_branch L_slow_edge
L_slow_next:
    s_add_u32 s71, s71, 1
    s_cmp_lt_u32 s71, 2500
    s_cbranch_scc1 L_slow_chunk
    s_mov_b32 s64, 0
    s_nop 3
    s_branch L_flush
L_sdone:
    ds_write_b32 v10, v6 offset:48
    s_waitcnt lgkmcnt(0)
    s_barrier
    s_endpgm
L_retry_7:
    s_sub_u32 s100, s100, 1
    s_cbranch_scc1 L_end
    s_sleep 1
    s_branch L_spin_6
L_retry_18:
    s_sub_u32 s100, s100, 1
    s_cbranch_scc1 L_end
    s_sleep 1
    s_branch L_spin_17
L_retry_19:
    s_sub_u32 s100, s100, 1
    s_cbranch_scc1 L_end
    s_sleep 4
    s_branch L_ipoll_16
L_retry_25:
    s_sub_u32 s100, s100, 1
    s_cbranch_scc1 L_end
    s_sleep 2
    s_branch L_secload_24
L_secload_24:
    buffer_load_dwordx4 v[56:59], v8, s[40:43], s12 offen sc1
    s_waitcnt vmcnt(0)
    s_branch L_sec_22
L_retry_29:
    s_sub_u32 s100, s100, 1
    s_cbranch_scc1 L_end
    s_sleep 2
    s_branch L_secload_28
L_secload_28:
    buffer_load_dwordx4 v[60:63], v8, s[40:43], s13 offen sc1
    s_waitcnt vmcnt(0)
    s_branch L_sec_26
L_retry_31:
    s_sub_u32 s100, s100, 1
    s_cbranch_scc1 L_end
    s_sleep 1
    s_branch L_spin_30
L_mwork_4:
    s_cmp_lg_u32 s31, 0
    s_cbranch_scc1 L_worked_5_w
    s_waitcnt vmcnt(21)
    v_mfma_f32_16x16x32_bf16 v[16:19], v[52:55], v[48:51], 0
    v_mfma_f32_16x16x32_bf16 v[20:23], v[56:59], v[48:51], 0
    s_waitcnt vmcnt(18)
    v_mfma_f32_16x16x32_bf16 v[16:19], v[64:67], v[60:63], v[16:19]
    v_mfma_f32_16x16x32_bf16 v[20:23], v[68:71], v[60:63], v[20:23]
    s_waitcnt vmcnt(15)
    v_mfma_f32_16x16x32_bf16 v[16:19], v[76:79], v[72:75], v[16:19]
    v_mfma_f32_16x16x32_bf16 v[20:23], v[80:83], v[72:75], v[20:23]
    s_waitcnt vmcnt(12)
    v_mfma_f32_16x16x32_bf16 v[16:19], v[88:91], v[84:87], v[16:19]
    v_mfma_f32_16x16x32_bf16 v[20:23], v[92:95], v[84:87], v[20:23]
    s_waitcnt vmcnt(9)
    v_mfma_f32_16x16x32_bf16 v[16:19], v[100:103], v[96:99], v[16:19]
    v_mfma_f32_16x16x32_bf16 v[20:23], v[104:107], v[96:99], v[20:23]
    s_waitcnt vmcnt(6)
    v_mfma_f32_16x16x32_bf16 v[16:19], v[112:115], v[108:111], v[16:19]
    v_mfma_f32_16x16x32_bf16 v[20:23], v[116:119], v[108:111], v[20:23]
    s_waitcnt vmcnt(3)
    v_mfma_f32_16x16x32_bf16 v[16:19], v[124:127], v[120:123], v[16:19]
    v_mfma_f32_16x16x32_bf16 v[20:23], v[128:131], v[120:123], v[20:23]
    s_waitcnt vmcnt(0)
    v_mfma_f32_16x16x32_bf16 v[16:19], v[136:139], v[132:135], v[16:19]
    v_mfma_f32_16x16x32_bf16 v[20:23], v[140:143], v[132:135], v[20:23]
    s_lshl_b32 s64, s27, 10
    s_add_u32 s64, s64, 65536
    v_lshl_add_u32 v40, v2, 4, s64
    s_lshl_b32 s64, s27, 2
    s_add_u32 s64, s64, 4096
    v_lshl_add_u32 v41, v2, 9, s64
    v_mov_b32 v42, s30
    s_nop 1
    v_cvt_pk_bf16_f32 v44, v16, v17
    v_cvt_pk_bf16_f32 v45, v18, v19
    v_cvt_pk_bf16_f32 v46, v20, v21
    v_cvt_pk_bf16_f32 v47, v22, v23
    global_store_dwordx4 v40, v[44:47], s[28:29] sc1
    s_mov_b32 s26, 2
    s_waitcnt vmcnt(0)
    s_mov_b64 exec, 0xff
    global_store_dword v41, v42, s[28:29] sc1
    s_mov_b64 exec, -1
    s_branch L_worked_5
L_worked_5_w:
    s_waitcnt vmcnt(0)
    s_branch L_worked_5
L_gemm:
    v_lshrrev_b32 v0, 5, v2
    s_lshl_b32 s64, s31, 1
    v_add_u32 v0, s64, v0
    v_and_b32 v1, 31, v2
    v_xor_b32 v1, v1, v0
    v_lshlrev_b32 v1, 4, v1
    v_lshl_add_u32 v30, v0, 9, v1
    v_xor_b32 v31, 0x80, v30
    v_lshrrev_b32 v13, 3, v2
    v_lshrrev_b32 v15, 2, v2
    v_and_b32 v15, 4, v15
    v_and_b32 v14, 7, v2
    v_xor_b32 v15, v15, v14
    v_lshlrev_b32 v15, 4, v15
    v_lshl_add_u32 v13, v13, 9, v15
    s_lshr_b32 s67, s2, 3
    s_and_b32 s67, s67, 7
    s_lshl_b32 s64, s31, 7
    s_lshl_b32 s65, s67, 14
    s_or_b32 s64, s64, s65
    v_add_u32 v13, s64, v13
    s_mul_i32 s63, s1, 20480
    s_lshl_b32 s66, s31, 10
    s_lshl_b32 s70, s31, 14
    s_add_u32 s70, s70, 82944
    s_mov_b32 s71, 3072
    s_mov_b32 s72, 6144
    s_mov_b32 s73, 9216
    s_waitcnt lgkmcnt(0)
    s_mov_b32 s32, s4
    s_and_b32 s33, s5, 0xffff
    s_mov_b32 s34, 5120000
    s_mov_b32 s35, 0x20000
    s_mov_b32 s36, s22
    s_and_b32 s37, s23, 0xffff
    s_mov_b32 s38, 131072
    s_mov_b32 s39, 0x20000
    s_bitcmp1_b32 s2, 3
    s_cbranch_scc0 L_touched_32
    s_lshr_b32 s64, s2, 4
    s_lshl_b32 s64, s64, 3
    s_and_b32 s68, s2, 7
    s_or_b32 s64, s64, s68
    s_lshl_b32 s64, s64, 10
    v_lshl_add_u32 v16, v2, 4, s64
    s_cmp_eq_u32 s31, 1
    s_cselect_b64 s[68:69], s[22:23], s[16:17]
    s_cmp_eq_u32 s31, 2
    s_cselect_b64 s[68:69], s[18:19], s[68:69]
    s_cmp_eq_u32 s31, 3
    s_cselect_b64 s[68:69], s[20:21], s[68:69]
    global_load_dwordx4 v[20:23], v16, s[68:69]
L_touched_32:
    s_cmp_ge_u32 s2, 250
    s_cbranch_scc1 L_end
    s_mul_i32 s64, s1, 20480
    s_mov_b32 s76, 0
    s_cmp_eq_u32 s31, 0
    s_cselect_b64 s[68:69], s[24:25], s[16:17]
    s_cselect_b32 s64, s64, 0
    s_cmp_eq_u32 s31, 2
    s_cselect_b64 s[68:69], s[28:29], s[68:69]
    s_cselect_b32 s64, 0x800, s64
    s_cselect_b32 s76, 0x2f8000, s76
    s_cmp_eq_u32 s31, 3
    s_cselect_b64 s[68:69], s[4:5], s[68:69]
    s_cselect_b32 s76, 0x200000, s76
    s_cselect_b32 s77, 2, 1
    v_min_u32 v17, s77, v2
    v_mul_lo_u32 v17, v17, s76
    v_add_u32 v17, s64, v17
    global_load_dword v24, v17, s[68:69]
    s_barrier
    s_setprio 2
    s_add_u32 m0, s66, 1024
    s_nop 0
    buffer_load_dwordx4 v30, s[32:35], s63 offen lds
    s_add_u32 m0, s66, 5120
    s_add_u32 s63, s63, 4096
    buffer_load_dwordx4 v31, s[32:35], s63 offen lds
    s_add_u32 m0, s66, 9216
    s_add_u32 s63, s63, 4096
    buffer_load_dwordx4 v30, s[32:35], s63 offen lds
    s_add_u32 m0, s66, 13312
    s_add_u32 s63, s63, 4096
    buffer_load_dwordx4 v31, s[32:35], s63 offen lds
    s_add_u32 m0, s66, 17408
    s_add_u32 s63, s63, 4096
    buffer_load_dwordx4 v30, s[32:35], s63 offen lds
    s_add_u32 m0, s70, 0
    s_nop 0
    buffer_load_dwordx4 v13, s[36:39], 0 offen offset:0 lds
    buffer_load_dwordx4 v13, s[36:39], s71 offen offset:1024 lds
    buffer_load_dwordx4 v13, s[36:39], s72 offen offset:2048 lds
    buffer_load_dwordx4 v13, s[36:39], s73 offen offset:3072 lds
    v_xor_b32 v13, 16384, v13
    s_mov_b32 s40, s16
    s_and_b32 s41, s17, 0xffff
    s_mov_b32 s42, 131072
    s_mov_b32 s43, 0x20000
    s_mov_b32 s44, s28
    s_and_b32 s45, s29, 0xffff
    s_mov_b32 s46, 1048576
    s_mov_b32 s47, 0x20000
    s_mov_b32 s48, s24
    s_and_b32 s49, s25, 0xffff
    s_mov_b32 s50, 5120000
    s_mov_b32 s51, 0x20000
    v_xor_b32 v15, v4, v3
    v_lshlrev_b32 v15, 4, v15
    v_lshl_add_u32 v7, v3, 9, v15
    s_lshl_b32 s64, s67, 6
    v_xor_b32 v7, s64, v7
    v_xor_b32 v8, 64, v7
    v_xor_b32 v9, 0x80, v7
    v_xor_b32 v10, 0xc0, v7
    v_lshrrev_b32 v15, 2, v3
    v_lshl_add_u32 v15, v4, 3, v15
    v_lshlrev_b32 v15, 7, v15
    v_lshrrev_b32 v14, 1, v3
    v_and_b32 v14, 4, v14
    v_and_b32 v0, 3, v3
    v_xor_b32 v14, v14, v0
    v_lshl_add_u32 v15, v14, 4, v15
    v_add_u32 v11, s70, v15
    v_xor_b32 v12, 64, v11
    v_and_b32 v0, 31, v2
    v_lshlrev_b32 v0, 2, v0
    s_and_b32 s64, s2, 7
    s_lshl_b32 s64, s64, 9
    s_lshl_b32 s65, s31, 7
    s_add_u32 s64, s64, s65
    s_add_u32 s74, s64, 4096
    v_lshlrev_b32 v14, 4, v2
    s_lshl_b32 s75, s31, 15
    s_lshl_b32 s64, s67, 12
    s_or_b32 s75, s75, s64
    s_add_u32 s75, s75, 65536
    s_cmp_eq_u32 s31, 0
    s_cbranch_scc0 L_nw_34
    s_call_b64 s[68:69], L_pad0
    s_call_b64 s[68:69], L_pad1
    s_call_b64 s[68:69], L_pad8
    s_branch L_warmed_33
L_nw_34:
    s_cmp_eq_u32 s31, 1
    s_cbranch_scc0 L_nw_35
    s_call_b64 s[68:69], L_pad2
    s_call_b64 s[68:69], L_pad3
    s_call_b64 s[68:69], L_pad9
    s_branch L_warmed_33
L_nw_35:
    s_cmp_eq_u32 s31, 2
    s_cbranch_scc0 L_nw_36
    s_call_b64 s[68:69], L_pad4
    s_call_b64 s[68:69], L_pad5
    s_branch L_warmed_33
L_nw_36:
    s_call_b64 s[68:69], L_pad6
    s_call_b64 s[68:69], L_pad7
L_warmed_33:
    s_add_u32 m0, s70, 4096
    s_waitcnt vmcnt(9)
    buffer_load_dwordx4 v13, s[36:39], 0 offen offset:0 lds
    s_waitcnt vmcnt(9)
    buffer_load_dwordx4 v13, s[36:39], s71 offen offset:1024 lds
    s_waitcnt vmcnt(9)
    buffer_load_dwordx4 v13, s[36:39], s72 offen offset:2048 lds
    s_waitcnt vmcnt(9)
    buffer_load_dwordx4 v13, s[36:39], s73 offen offset:3072 lds
    v_xor_b32 v13, 49152, v13
    s_add_u32 m0, s70, 8192
    s_waitcnt vmcnt(4)
    buffer_load_dwordx4 v13, s[36:39], 0 offen offset:0 lds
    s_waitcnt vmcnt(4)
    buffer_load_dwordx4 v13, s[36:39], s71 offen offset:1024 lds
    s_waitcnt vmcnt(4)
    buffer_load_dwordx4 v13, s[36:39], s72 offen offset:2048 lds
    s_waitcnt vmcnt(4)
    buffer_load_dwordx4 v13, s[36:39], s73 offen offset:3072 lds
    v_xor_b32 v13, 16384, v13
    s_add_u32 m0, s70, 12288
    s_waitcnt vmcnt(4)
    buffer_load_dwordx4 v13, s[36:39], 0 offen offset:0 lds
    s_waitcnt vmcnt(4)
    buffer_load_dwordx4 v13, s[36:39], s71 offen offset:1024 lds
    s_waitcnt vmcnt(4)
    buffer_load_dwordx4 v13, s[36:39], s72 offen offset:2048 lds
    s_waitcnt vmcnt(4)
    buffer_load_dwordx4 v13, s[36:39], s73 offen offset:3072 lds
    v_xor_b32 v13, 114688, v13
    s_waitcnt vmcnt(12)
    s_waitcnt lgkmcnt(0)
    s_mov_b64 exec, 1
    ds_add_u32 v5, v6 offset:4
    s_mov_b64 exec, -1
    ds_read_b64_tr_b16 v[128:129], v11 offset:0
    ds_read_b64_tr_b16 v[130:131], v11 offset:512
    ds_read_b64_tr_b16 v[132:133], v11 offset:8
    ds_read_b64_tr_b16 v[134:135], v11 offset:520
    ds_read_b64_tr_b16 v[136:137], v12 offset:0
    ds_read_b64_tr_b16 v[138:139], v12 offset:512
    ds_read_b64_tr_b16 v[140:141], v12 offset:8
    ds_read_b64_tr_b16 v[142:143], v12 offset:520
    s_waitcnt lgkmcnt(0)
    s_add_u32 m0, s70, 0
    s_waitcnt vmcnt(4)
    buffer_load_dwordx4 v13, s[36:39], 0 offen offset:0 lds
    s_waitcnt vmcnt(4)
    buffer_load_dwordx4 v13, s[36:39], s71 offen offset:1024 lds
    s_waitcnt vmcnt(4)
    buffer_load_dwordx4 v13, s[36:39], s72 offen offset:2048 lds
    s_waitcnt vmcnt(4)
    buffer_load_dwordx4 v13, s[36:39], s73 offen offset:3072 lds
    v_xor_b32 v13, 16384, v13
    s_waitcnt vmcnt(12)
    ds_read_b64_tr_b16 v[144:145], v11 offset:4096
    ds_read_b64_tr_b16 v[146:147], v11 offset:4608
    ds_read_b64_tr_b16 v[148:149], v11 offset:4104
    ds_read_b64_tr_b16 v[150:151], v11 offset:4616
    ds_read_b64_tr_b16 v[152:153], v12 offset:4096
    ds_read_b64_tr_b16 v[154:155], v12 offset:4608
    ds_read_b64_tr_b16 v[156:157], v12 offset:4104
    ds_read_b64_tr_b16 v[158:159], v12 offset:4616
    s_waitcnt lgkmcnt(0)
    s_add_u32 m0, s70, 4096
    s_waitcnt vmcnt(4)
    buffer_load_dwordx4 v13, s[36:39], 0 offen offset:0 lds
    s_waitcnt vmcnt(4)
    buffer_load_dwordx4 v13, s[36:39], s71 offen offset:1024 lds
    s_waitcnt vmcnt(4)
    buffer_load_dwordx4 v13, s[36:39], s72 offen offset:2048 lds
    s_waitcnt vmcnt(4)
    buffer_load_dwordx4 v13, s[36:39], s73 offen offset:3072 lds
    v_xor_b32 v13, 49152, v13
    s_waitcnt vmcnt(12)
    ds_read_b64_tr_b16 v[160:161], v11 offset:8192
    ds_read_b64_tr_b16 v[162:163], v11 offset:8704
    ds_read_b64_tr_b16 v[164:165], v11 offset:8200
    ds_read_b64_tr_b16 v[166:167], v11 offset:8712
    ds_read_b64_tr_b16 v[168:169], v12 offset:8192
    ds_read_b64_tr_b16 v[170:171], v12 offset:8704
    ds_read_b64_tr_b16 v[172:173], v12 offset:8200
    ds_read_b64_tr_b16 v[174:175], v12 offset:8712
    s_waitcnt lgkmcnt(0)
    s_add_u32 m0, s70, 8192
    s_waitcnt vmcnt(4)
    buffer_load_dwordx4 v13, s[36:39], 0 offen offset:0 lds
    s_waitcnt vmcnt(4)
    buffer_load_dwordx4 v13, s[36:39], s71 offen offset:1024 lds
    s_waitcnt vmcnt(4)
    buffer_load_dwordx4 v13, s[36:39], s72 offen offset:2048 lds
    s_waitcnt vmcnt(4)
    buffer_load_dwordx4 v13, s[36:39], s73 offen offset:3072 lds
    v_xor_b32 v13, 16384, v13
    buffer_load_dword v1, v0, s[44:47], s74 offen sc1
    s_waitcnt vmcnt(13)
    ds_read_b64_tr_b16 v[176:177], v11 offset:12288
    ds_read_b64_tr_b16 v[178:179], v11 offset:12800
    ds_read_b64_tr_b16 v[180:181], v11 offset:12296
    ds_read_b64_tr_b16 v[182:183], v11 offset:12808
    ds_read_b64_tr_b16 v[184:185], v12 offset:12288
    ds_read_b64_tr_b16 v[186:187], v12 offset:12800
    ds_read_b64_tr_b16 v[188:189], v12 offset:12296
    ds_read_b64_tr_b16 v[190:191], v12 offset:12808
    s_waitcnt lgkmcnt(0)
    s_add_u32 m0, s70, 12288
    s_nop 0
    buffer_load_dwordx4 v13, s[36:39], 0 offen offset:0 lds
    buffer_load_dwordx4 v13, s[36:39], s71 offen offset:1024 lds
    buffer_load_dwordx4 v13, s[36:39], s72 offen offset:2048 lds
    buffer_load_dwordx4 v13, s[36:39], s73 offen offset:3072 lds
    v_xor_b32 v13, 114688, v13
    s_waitcnt vmcnt(13)
    ds_read_b64_tr_b16 v[192:193], v11 offset:0
    ds_read_b64_tr_b16 v[194:195], v11 offset:512
    ds_read_b64_tr_b16 v[196:197], v11 offset:8
    ds_read_b64_tr_b16 v[198:199], v11 offset:520
    ds_read_b64_tr_b16 v[200:201], v12 offset:0
    ds_read_b64_tr_b16 v[202:203], v12 offset:512
    ds_read_b64_tr_b16 v[204:205], v12 offset:8
    ds_read_b64_tr_b16 v[206:207], v12 offset:520
    s_waitcnt vmcnt(9)
    ds_read_b64_tr_b16 v[208:209], v11 offset:4096
    ds_read_b64_tr_b16 v[210:211], v11 offset:4608
    ds_read_b64_tr_b16 v[212:213], v11 offset:4104
    ds_read_b64_tr_b16 v[214:215], v11 offset:4616
    ds_read_b64_tr_b16 v[216:217], v12 offset:4096
    ds_read_b64_tr_b16 v[218:219], v12 offset:4608
    ds_read_b64_tr_b16 v[220:221], v12 offset:4104
    ds_read_b64_tr_b16 v[222:223], v12 offset:4616
    s_waitcnt vmcnt(5)
    ds_read_b64_tr_b16 v[224:225], v11 offset:8192
    ds_read_b64_tr_b16 v[226:227], v11 offset:8704
    ds_read_b64_tr_b16 v[228:229], v11 offset:8200
    ds_read_b64_tr_b16 v[230:231], v11 offset:8712
    ds_read_b64_tr_b16 v[232:233], v12 offset:8192
    ds_read_b64_tr_b16 v[234:235], v12 offset:8704
    ds_read_b64_tr_b16 v[236:237], v12 offset:8200
    ds_read_b64_tr_b16 v[238:239], v12 offset:8712
    s_waitcnt vmcnt(4)
L_spin_39:
    ds_read_b128 v[16:19], v5
    s_waitcnt lgkmcnt(0)
    v_readfirstlane_b32 s101, v18
    v_readfirstlane_b32 s30, v19
    s_cmp_ge_u32 s101, 1
    s_cbranch_scc0 L_retry_40
L_mchk_38:
    v_cmp_ne_u32 vcc, s30, v1
    s_cbranch_vccnz L_mre_41
    buffer_load_dwordx4 v[40:43], v14, s[44:47], s75 offen offset:0 sc1
    buffer_load_dwordx4 v[44:47], v14, s[44:47], s75 offen offset:1024 sc1
    buffer_load_dwordx4 v[48:51], v14, s[44:47], s75 offen offset:2048 sc1
    buffer_load_dwordx4 v[52:55], v14, s[44:47], s75 offen offset:3072 sc1
    s_xor_b32 s75, s75, 4096
    buffer_load_dwordx4 v[56:59], v14, s[44:47], s75 offen offset:0 sc1
    buffer_load_dwordx4 v[60:63], v14, s[44:47], s75 offen offset:1024 sc1
    buffer_load_dwordx4 v[64:67], v14, s[44:47], s75 offen offset:2048 sc1
    buffer_load_dwordx4 v[68:71], v14, s[44:47], s75 offen offset:3072 sc1
    s_xor_b32 s75, s75, 12288
    buffer_load_dwordx4 v[72:75], v14, s[44:47], s75 offen offset:0 sc1
    buffer_load_dwordx4 v[76:79], v14, s[44:47], s75 offen offset:1024 sc1
    s_waitcnt vmcnt(10)
    ds_read_b64_tr_b16 v[240:241], v11 offset:12288
    ds_read_b64_tr_b16 v[242:243], v11 offset:12800
    ds_read_b64_tr_b16 v[244:245], v11 offset:12296
    ds_read_b64_tr_b16 v[246:247], v11 offset:12808
    ds_read_b64_tr_b16 v[248:249], v12 offset:12288
    ds_read_b64_tr_b16 v[250:251], v12 offset:12800
    ds_read_b64_tr_b16 v[252:253], v12 offset:12296
    ds_read_b64_tr_b16 v[254:255], v12 offset:12808
L_spin_42:
    ds_read_b32 v15, v5 offset:4
    s_waitcnt lgkmcnt(0)
    v_readfirstlane_b32 s101, v15
    s_cmp_ge_u32 s101, 4
    s_cbranch_scc0 L_retry_43
    ds_read_b128 v[16:19], v7 offset:1024
    ds_read_b128 v[20:23], v7 offset:9216
    ds_read_b128 v[24:27], v7 offset:17408
    v_xor_b32 v7, 0x100, v7
    ds_read_b128 v[28:31], v8 offset:1024
    ds_read_b128 v[32:35], v8 offset:9216
    ds_read_b128 v[36:39], v8 offset:17408
    v_xor_b32 v8, 0x100, v8
    s_waitcnt lgkmcnt(3)
    s_waitcnt vmcnt(9)
    v_mfma_f32_16x16x32_bf16 v[80:83], v[40:43], v[16:19], 0
    v_mfma_f32_16x16x32_bf16 v[96:99], v[40:43], v[20:23], 0
    v_mfma_f32_16x16x32_bf16 v[112:115], v[40:43], v[24:27], 0
    buffer_load_dwordx4 v[40:43], v14, s[44:47], s75 offen offset:2048 sc1
    s_waitcnt vmcnt(9)
    v_mfma_f32_16x16x32_bf16 v[84:87], v[44:47], v[16:19], 0
    v_mfma_f32_16x16x32_bf16 v[100:103], v[44:47], v[20:23], 0
    v_mfma_f32_16x16x32_bf16 v[116:119], v[44:47], v[24:27], 0
    buffer_load_dwordx4 v[44:47], v14, s[44:47], s75 offen offset:3072 sc1
    s_xor_b32 s75, s75, 4096
    s_waitcnt vmcnt(9)
    v_mfma_f32_16x16x32_bf16 v[88:91], v[48:51], v[16:19], 0
    v_mfma_f32_16x16x32_bf16 v[104:107], v[48:51], v[20:23], 0
    v_mfma_f32_16x16x32_bf16 v[120:123], v[48:51], v[24:27], 0
    buffer_load_dwordx4 v[48:51], v14, s[44:47], s75 offen offset:0 sc1
    s_waitcnt vmcnt(9)
    v_mfma_f32_16x16x32_bf16 v[92:95], v[52:55], v[16:19], 0
    v_mfma_f32_16x16x32_bf16 v[108:111], v[52:55], v[20:23], 0
    v_mfma_f32_16x16x32_bf16 v[124:127], v[52:55], v[24:27], 0
    buffer_load_dwordx4 v[52:55], v14, s[44:47], s75 offen offset:1024 sc1
    ds_read_b128 v[16:19], v9 offset:1024
    ds_read_b128 v[20:23], v9 offset:9216
    ds_read_b128 v[24:27], v9 offset:17408
    v_xor_b32 v9, 0x100, v9
    s_waitcnt lgkmcnt(3)
    s_waitcnt vmcnt(9)
    v_mfma_f32_16x16x32_bf16 v[80:83], v[56:59], v[28:31], v[80:83]
    v_mfma_f32_16x16x32_bf16 v[96:99], v[56:59], v[32:35], v[96:99]
    v_mfma_f32_16x16x32_bf16 v[112:115], v[56:59], v[36:39], v[112:115]
    buffer_load_dwordx4 v[56:59], v14, s[44:47], s75 offen offset:2048 sc1
    s_waitcnt vmcnt(9)
    v_mfma_f32_16x16x32_bf16 v[84:87], v[60:63], v[28:31], v[84:87]
    v_mfma_f32_16x16x32_bf16 v[100:103], v[60:63], v[32:35], v[100:103]
    v_mfma_f32_16x16x32_bf16 v[116:119], v[60:63], v[36:39], v[116:119]
    buffer_load_dwordx4 v[60:63], v14, s[44:47], s75 offen offset:3072 sc1
    s_xor_b32 s75, s75, 28672
    s_waitcnt vmcnt(9)
    v_mfma_f32_16x16x32_bf16 v[88:91], v[64:67], v[28:31], v[88:91]
    v_mfma_f32_16x16x32_bf16 v[104:107], v[64:67], v[32:35], v[104:107]
    v_mfma_f32_16x16x32_bf16 v[120:123], v[64:67], v[36:39], v[120:123]
    buffer_load_dwordx4 v[64:67], v14, s[44:47], s75 offen offset:0 sc1
    s_waitcnt vmcnt(9)
    v_mfma_f32_16x16x32_bf16 v[92:95], v[68:71], v[28:31], v[92:95]
    v_mfma_f32_16x16x32_bf16 v[108:111], v[68:71], v[32:35], v[108:111]
    v_mfma_f32_16x16x32_bf16 v[124:127], v[68:71], v[36:39], v[124:127]
    buffer_load_dwordx4 v[68:71], v14, s[44:47], s75 offen offset:1024 sc1
    ds_read_b128 v[28:31], v10 offset:1024
    ds_read_b128 v[32:35], v10 offset:9216
    ds_read_b128 v[36:39], v10 offset:17408
    v_xor_b32 v10, 0x100, v10
    s_waitcnt lgkmcnt(3)
    s_waitcnt vmcnt(9)
    v_mfma_f32_16x16x32_bf16 v[80:83], v[72:75], v[16:19], v[80:83]
    v_mfma_f32_16x16x32_bf16 v[96:99], v[72:75], v[20:23], v[96:99]
    v_mfma_f32_16x16x32_bf16 v[112:115], v[72:75], v[24:27], v[112:115]
    buffer_load_dwordx4 v[72:75], v14, s[44:47], s75 offen offset:2048 sc1
    s_waitcnt vmcnt(9)
    v_mfma_f32_16x16x32_bf16 v[84:87], v[76:79], v[16:19], v[84:87]
    v_mfma_f32_16x16x32_bf16 v[100:103], v[76:79], v[20:23], v[100:103]
    v_mfma_f32_16x16x32_bf16 v[116:119], v[76:79], v[24:27], v[116:119]
    buffer_load_dwordx4 v[76:79], v14, s[44:47], s75 offen offset:3072 sc1
    s_xor_b32 s75, s75, 4096
    s_waitcnt vmcnt(9)
    v_mfma_f32_16x16x32_bf16 v[88:91], v[40:43], v[16:19], v[88:91]
    v_mfma_f32_16x16x32_bf16 v[104:107], v[40:43], v[20:23], v[104:107]
    v_mfma_f32_16x16x32_bf16 v[120:123], v[40:43], v[24:27], v[120:123]
    buffer_load_dwordx4 v[40:43], v14, s[44:47], s75 offen offset:0 sc1
    s_waitcnt vmcnt(9)
    v_mfma_f32_16x16x32_bf16 v[92:95], v[44:47], v[16:19], v[92:95]
    v_mfma_f32_16x16x32_bf16 v[108:111], v[44:47], v[20:23], v[108:111]
    v_mfma_f32_16x16x32_bf16 v[124:127], v[44:47], v[24:27], v[124:127]
    buffer_load_dwordx4 v[44:47], v14, s[44:47], s75 offen offset:1024 sc1
    ds_read_b128 v[16:19], v7 offset:1024
    ds_read_b128 v[20:23], v7 offset:9216
    ds_read_b128 v[24:27], v7 offset:17408
    v_xor_b32 v7, 0x100, v7
    s_waitcnt lgkmcnt(3)
    s_waitcnt vmcnt(9)
    v_mfma_f32_16x16x32_bf16 v[80:83], v[48:51], v[28:31], v[80:83]
    v_mfma_f32_16x16x32_bf16 v[96:99], v[48:51], v[32:35], v[96:99]
    v_mfma_f32_16x16x32_bf16 v[112:115], v[48:51], v[36:39], v[112:115]
    buffer_load_dwordx4 v[48:51], v14, s[44:47], s75 offen offset:2048 sc1
    s_waitcnt vmcnt(9)
    v_mfma_f32_16x16x32_bf16 v[84:87], v[52:55], v[28:31], v[84:87]
    v_mfma_f32_16x16x32_bf16 v[100:103], v[52:55], v[32:35], v[100:103]
    v_mfma_f32_16x16x32_bf16 v[116:119], v[52:55], v[36:39], v[116:119]
    buffer_load_dwordx4 v[52:55], v14, s[44:47], s75 offen offset:3072 sc1
    s_xor_b32 s75, s75, 12288
    s_waitcnt vmcnt(9)
    v_mfma_f32_16x16x32_bf16 v[88:91], v[56:59], v[28:31], v[88:91]
    v_mfma_f32_16x16x32_bf16 v[104:107], v[56:59], v[32:35], v[104:107]
    v_mfma_f32_16x16x32_bf16 v[120:123], v[56:59], v[36:39], v[120:123]
    buffer_load_dwordx4 v[56:59], v14, s[44:47], s75 offen offset:0 sc1
    s_waitcnt vmcnt(9)
    v_mfma_f32_16x16x32_bf16 v[92:95], v[60:63], v[28:31], v[92:95]
    v_mfma_f32_16x16x32_bf16 v[108:111], v[60:63], v[32:35], v[108:111]
    v_mfma_f32_16x16x32_bf16 v[124:127], v[60:63], v[36:39], v[124:127]
    buffer_load_dwordx4 v[60:63], v14, s[44:47], s75 offen offset:1024 sc1
    ds_read_b128 v[28:31], v8 offset:1024
    ds_read_b128 v[32:35], v8 offset:9216
    ds_read_b128 v[36:39], v8 offset:17408
    v_xor_b32 v8, 0x100, v8
    s_waitcnt lgkmcnt(3)
    s_waitcnt vmcnt(9)
    v_mfma_f32_16x16x32_bf16 v[80:83], v[64:67], v[16:19], v[80:83]
    v_mfma_f32_16x16x32_bf16 v[96:99], v[64:67], v[20:23], v[96:99]
    v_mfma_f32_16x16x32_bf16 v[112:115], v[64:67], v[24:27], v[112:115]
    buffer_load_dwordx4 v[64:67], v14, s[44:47], s75 offen offset:2048 sc1
    s_waitcnt vmcnt(9)
    v_mfma_f32_16x16x32_bf16 v[84:87], v[68:71], v[16:19], v[84:87]
    v_mfma_f32_16x16x32_bf16 v[100:103], v[68:71], v[20:23], v[100:103]
    v_mfma_f32_16x16x32_bf16 v[116:119], v[68:71], v[24:27], v[116:119]
    buffer_load_dwordx4 v[68:71], v14, s[44:47], s75 offen offset:3072 sc1
    s_xor_b32 s75, s75, 4096
    s_waitcnt vmcnt(9)
    v_mfma_f32_16x16x32_bf16 v[88:91], v[72:75], v[16:19], v[88:91]
    v_mfma_f32_16x16x32_bf16 v[104:107], v[72:75], v[20:23], v[104:107]
    v_mfma_f32_16x16x32_bf16 v[120:123], v[72:75], v[24:27], v[120:123]
    buffer_load_dwordx4 v[72:75], v14, s[44:47], s75 offen offset:0 sc1
    s_waitcnt vmcnt(9)
    v_mfma_f32_16x16x32_bf16 v[92:95], v[76:79], v[16:19], v[92:95]
    v_mfma_f32_16x16x32_bf16 v[108:111], v[76:79], v[20:23], v[108:111]
    v_mfma_f32_16x16x32_bf16 v[124:127], v[76:79], v[24:27], v[124:127]
    buffer_load_dwordx4 v[76:79], v14, s[44:47], s75 offen offset:1024 sc1
    ds_read_b128 v[16:19], v9 offset:1024
    ds_read_b128 v[20:23], v9 offset:9216
    ds_read_b128 v[24:27], v9 offset:17408
    v_xor_b32 v9, 0x100, v9
    s_waitcnt lgkmcnt(3)
    s_waitcnt vmcnt(9)
    v_mfma_f32_16x16x32_bf16 v[80:83], v[40:43], v[28:31], v[80:83]
    v_mfma_f32_16x16x32_bf16 v[96:99], v[40:43], v[32:35], v[96:99]
    v_mfma_f32_16x16x32_bf16 v[112:115], v[40:43], v[36:39], v[112:115]
    buffer_load_dwordx4 v[40:43], v14, s[44:47], s75 offen offset:2048 sc1
    s_waitcnt vmcnt(9)
    v_mfma_f32_16x16x32_bf16 v[84:87], v[44:47], v[28:31], v[84:87]
    v_mfma_f32_16x16x32_bf16 v[100:103], v[44:47], v[32:35], v[100:103]
    v_mfma_f32_16x16x32_bf16 v[116:119], v[44:47], v[36:39], v[116:119]
    buffer_load_dwordx4 v[44:47], v14, s[44:47], s75 offen offset:3072 sc1
    s_xor_b32 s75, s75, 28672
    s_waitcnt vmcnt(9)
    v_mfma_f32_16x16x32_bf16 v[88:91], v[48:51], v[28:31], v[88:91]
    v_mfma_f32_16x16x32_bf16 v[104:107], v[48:51], v[32:35], v[104:107]
    v_mfma_f32_16x16x32_bf16 v[120:123], v[48:51], v[36:39], v[120:123]
    s_add_u32 m0, s70, 0
    s_nop 0
    buffer_load_dwordx4 v13, s[40:43], 0 offen offset:0 lds
    s_waitcnt vmcnt(9)
    v_mfma_f32_16x16x32_bf16 v[92:95], v[52:55], v[28:31], v[92:95]
    v_mfma_f32_16x16x32_bf16 v[108:111], v[52:55], v[32:35], v[108:111]
    v_mfma_f32_16x16x32_bf16 v[124:127], v[52:55], v[36:39], v[124:127]
    buffer_load_dwordx4 v13, s[40:43], s71 offen offset:1024 lds
    ds_read_b128 v[28:31], v10 offset:1024
    ds_read_b128 v[32:35], v10 offset:9216
    ds_read_b128 v[36:39], v10 offset:17408
    v_xor_b32 v10, 0x100, v10
    s_waitcnt lgkmcnt(3)
    s_waitcnt vmcnt(9)
    v_mfma_f32_16x16x32_bf16 v[80:83], v[56:59], v[16:19], v[80:83]
    v_mfma_f32_16x16x32_bf16 v[96:99], v[56:59], v[20:23], v[96:99]
    v_mfma_f32_16x16x32_bf16 v[112:115], v[56:59], v[24:27], v[112:115]
    buffer_load_dwordx4 v13, s[40:43], s72 offen offset:2048 lds
    s_waitcnt vmcnt(9)
    v_mfma_f32_16x16x32_bf16 v[84:87], v[60:63], v[16:19], v[84:87]
    v_mfma_f32_16x16x32_bf16 v[100:103], v[60:63], v[20:23], v[100:103]
    v_mfma_f32_16x16x32_bf16 v[116:119], v[60:63], v[24:27], v[116:119]
    buffer_load_dwordx4 v13, s[40:43], s73 offen offset:3072 lds
    v_xor_b32 v13, 16384, v13
    s_waitcnt vmcnt(9)
    v_mfma_f32_16x16x32_bf16 v[88:91], v[64:67], v[16:19], v[88:91]
    v_mfma_f32_16x16x32_bf16 v[104:107], v[64:67], v[20:23], v[104:107]
    v_mfma_f32_16x16x32_bf16 v[120:123], v[64:67], v[24:27], v[120:123]
    s_add_u32 m0, s70, 4096
    s_nop 0
    buffer_load_dwordx4 v13, s[40:43], 0 offen offset:0 lds
    s_waitcnt vmcnt(9)
    v_mfma_f32_16x16x32_bf16 v[92:95], v[68:71], v[16:19], v[92:95]
    v_mfma_f32_16x16x32_bf16 v[108:111], v[68:71], v[20:23], v[108:111]
    v_mfma_f32_16x16x32_bf16 v[124:127], v[68:71], v[24:27], v[124:127]
    buffer_load_dwordx4 v13, s[40:43], s71 offen offset:1024 lds
    s_waitcnt lgkmcnt(0)
    s_waitcnt vmcnt(9)
    v_mfma_f32_16x16x32_bf16 v[80:83], v[72:75], v[28:31], v[80:83]
    v_mfma_f32_16x16x32_bf16 v[96:99], v[72:75], v[32:35], v[96:99]
    v_mfma_f32_16x16x32_bf16 v[112:115], v[72:75], v[36:39], v[112:115]
    buffer_load_dwordx4 v13, s[40:43], s72 offen offset:2048 lds
    s_waitcnt vmcnt(9)
    v_mfma_f32_16x16x32_bf16 v[84:87], v[76:79], v[28:31], v[84:87]
    v_mfma_f32_16x16x32_bf16 v[100:103], v[76:79], v[32:35], v[100:103]
    v_mfma_f32_16x16x32_bf16 v[116:119], v[76:79], v[36:39], v[116:119]
    buffer_load_dwordx4 v13, s[40:43], s73 offen offset:3072 lds
    v_xor_b32 v13, 49152, v13
    s_waitcnt vmcnt(9)
    v_mfma_f32_16x16x32_bf16 v[88:91], v[40:43], v[28:31], v[88:91]
    v_mfma_f32_16x16x32_bf16 v[104:107], v[40:43], v[32:35], v[104:107]
    v_mfma_f32_16x16x32_bf16 v[120:123], v[40:43], v[36:39], v[120:123]
    s_add_u32 m0, s70, 8192
    s_nop 0
    buffer_load_dwordx4 v13, s[40:43], 0 offen offset:0 lds
    s_waitcnt vmcnt(9)
    v_mfma_f32_16x16x32_bf16 v[92:95], v[44:47], v[28:31], v[92:95]
    v_mfma_f32_16x16x32_bf16 v[108:111], v[44:47], v[32:35], v[108:111]
    v_mfma_f32_16x16x32_bf16 v[124:127], v[44:47], v[36:39], v[124:127]
    buffer_load_dwordx4 v13, s[40:43], s71 offen offset:1024 lds
    s_lshl_b32 s64, s31, 3
    v_add_u32 v0, s64, v4
    v_xor_b32 v0, v0, v3
    v_lshlrev_b32 v0, 4, v0
    v_lshl_add_u32 v0, v3, 9, v0
    v_xor_b32 v1, 64, v0
    s_mov_b32 s76, 0x00ff00ff
    s_mov_b32 s77, 0x00ff00ff
    v_cvt_pk_bf16_f32 v16, v80, v81
    v_cvt_pk_bf16_f32 v17, v82, v83
    v_cvt_pk_bf16_f32 v18, v84, v85
    v_cvt_pk_bf16_f32 v19, v86, v87
    ds_write_b128 v0, v[16:19] offset:21504
    v_cvt_pk_bf16_f32 v20, v88, v89
    v_cvt_pk_bf16_f32 v21, v90, v91
    v_cvt_pk_bf16_f32 v22, v92, v93
    v_cvt_pk_bf16_f32 v23, v94, v95
    ds_write_b128 v1, v[20:23] offset:21504
    v_cvt_pk_bf16_f32 v24, v96, v97
    v_cvt_pk_bf16_f32 v25, v98, v99
    v_cvt_pk_bf16_f32 v26, v100, v101
    v_cvt_pk_bf16_f32 v27, v102, v103
    ds_write_b128 v0, v[24:27] offset:29696
    v_cvt_pk_bf16_f32 v28, v104, v105
    v_cvt_pk_bf16_f32 v29, v106, v107
    v_cvt_pk_bf16_f32 v30, v108, v109
    v_cvt_pk_bf16_f32 v31, v110, v111
    ds_write_b128 v1, v[28:31] offset:29696
    s_mov_b64 exec, s[76:77]
    v_cvt_pk_bf16_f32 v32, v112, v113
    v_cvt_pk_bf16_f32 v33, v114, v115
    v_cvt_pk_bf16_f32 v34, v116, v117
    v_cvt_pk_bf16_f32 v35, v118, v119
    ds_write_b128 v0, v[32:35] offset:37888
    v_cvt_pk_bf16_f32 v36, v120, v121
    v_cvt_pk_bf16_f32 v37, v122, v123
    v_cvt_pk_bf16_f32 v38, v124, v125
    v_cvt_pk_bf16_f32 v39, v126, v127
    ds_write_b128 v1, v[36:39] offset:37888
    s_mov_b64 exec, -1
    s_waitcnt lgkmcnt(0)
    s_barrier
    buffer_load_dwordx4 v13, s[40:43], s72 offen offset:2048 lds
    buffer_load_dwordx4 v13, s[40:43], s73 offen offset:3072 lds
    v_xor_b32 v13, 16384, v13
    s_add_u32 m0, s70, 12288
    s_nop 0
    buffer_load_dwordx4 v13, s[40:43], 0 offen offset:0 lds
    buffer_load_dwordx4 v13, s[40:43], s71 offen offset:1024 lds
    buffer_load_dwordx4 v13, s[40:43], s72 offen offset:2048 lds
    buffer_load_dwordx4 v13, s[40:43], s73 offen offset:3072 lds
    v_xor_b32 v13, 114688, v13
    v_lshlrev_b32 v0, 4, v4
    v_and_b32 v1, 7, v3
    v_lshl_add_u32 v0, v1, 9, v0
    v_and_b32 v1, 8, v3
    v_lshl_add_u32 v0, v1, 3, v0
    s_mul_i32 s74, s1, 20480
    s_lshl_b32 s64, s31, 7
    s_add_u32 s74, s74, s64
    s_waitcnt vmcnt(8)
    ds_read_b64_tr_b16 v[48:49], v11 offset:0
    ds_read_b64_tr_b16 v[50:51], v11 offset:512
    ds_read_b64_tr_b16 v[52:53], v11 offset:8
    ds_read_b64_tr_b16 v[54:55], v11 offset:520
    ds_read_b64_tr_b16 v[56:57], v12 offset:0
    ds_read_b64_tr_b16 v[58:59], v12 offset:512
    ds_read_b64_tr_b16 v[60:61], v12 offset:8
    ds_read_b64_tr_b16 v[62:63], v12 offset:520
    ds_read_b64_tr_b16 v[64:65], v11 offset:4096
    ds_read_b64_tr_b16 v[66:67], v11 offset:4608
    ds_read_b64_tr_b16 v[68:69], v11 offset:4104
    ds_read_b64_tr_b16 v[70:71], v11 offset:4616
    ds_read_b64_tr_b16 v[72:73], v12 offset:4096
    ds_read_b64_tr_b16 v[74:75], v12 offset:4608
    ds_read_b64_tr_b16 v[76:77], v12 offset:4104
    ds_read_b64_tr_b16 v[78:79], v12 offset:4616
    s_waitcnt lgkmcnt(8)
    s_add_u32 m0, s70, 0
    s_nop 0
    buffer_load_dwordx4 v13, s[40:43], 0 offen offset:0 lds
    buffer_load_dwordx4 v13, s[40:43], s71 offen offset:1024 lds
    buffer_load_dwordx4 v13, s[40:43], s72 offen offset:2048 lds
    buffer_load_dwordx4 v13, s[40:43], s73 offen offset:3072 lds
    v_xor_b32 v13, 16384, v13
    s_waitcnt lgkmcnt(0)
    s_add_u32 m0, s70, 4096
    s_nop 0
    buffer_load_dwordx4 v13, s[40:43], 0 offen offset:0 lds
    buffer_load_dwordx4 v13, s[40:43], s71 offen offset:1024 lds
    buffer_load_dwordx4 v13, s[40:43], s72 offen offset:2048 lds
    buffer_load_dwordx4 v13, s[40:43], s73 offen offset:3072 lds
    v_xor_b32 v13, 49152, v13
    s_lshl_b32 s64, s31, 12
    s_add_u32 s78, s64, 21504
    s_add_u32 s79, s64, 148480
    s_cmp_eq_u32 s31, 3
    s_cselect_b32 s79, 37888, s79
    s_sub_u32 s76, s78, s70
    s_sub_u32 s77, s79, s78
    v_xor_b32 v40, 0x100, v7
    v_xor_b32 v41, 0x100, v8
    v_xor_b32 v42, 0x100, v9
    v_xor_b32 v43, 0x100, v10
    s_barrier
    s_mov_b32 m0, s78
    s_nop 0
    buffer_load_dwordx4 v13, s[40:43], 0 offen offset:0 lds
    buffer_load_dwordx4 v13, s[40:43], s71 offen offset:1024 lds
    buffer_load_dwordx4 v13, s[40:43], s72 offen offset:2048 lds
    buffer_load_dwordx4 v13, s[40:43], s73 offen offset:3072 lds
    v_xor_b32 v13, 16384, v13
    s_mov_b32 m0, s79
    s_nop 0
    buffer_load_dwordx4 v13, s[40:43], 0 offen offset:0 lds
    buffer_load_dwordx4 v13, s[40:43], s71 offen offset:1024 lds
    buffer_load_dwordx4 v13, s[40:43], s72 offen offset:2048 lds
    buffer_load_dwordx4 v13, s[40:43], s73 offen offset:3072 lds
    v_xor_b32 v13, 114688, v13
    s_setprio 0
L_prog_44:
    ds_read_b128 v[16:19], v5 offset:32
    s_waitcnt lgkmcnt(0)
    v_min3_u32 v16, v16, v17, v18
    v_min_u32 v16, v16, v19
    v_cmp_gt_u32 vcc, 1, v16
    s_cbranch_vccnz L_retry_45
    ds_read_b128 v[16:19], v7 offset:1024
    ds_read_b128 v[20:23], v7 offset:9216
    ds_read_b128 v[24:27], v7 offset:17408
    s_waitcnt vmcnt(8)
    s_waitcnt lgkmcnt(0)
    v_mfma_f32_16x16x32_bf16 v[80:83], v[128:131], v[16:19], 0
    ds_read_b128 v[28:31], v8 offset:1024
    v_mfma_f32_16x16x32_bf16 v[96:99], v[128:131], v[20:23], 0
    ds_read_b128 v[32:35], v8 offset:9216
    v_mfma_f32_16x16x32_bf16 v[112:115], v[128:131], v[24:27], 0
    ds_read_b128 v[36:39], v8 offset:17408
    v_mfma_f32_16x16x32_bf16 v[84:87], v[132:135], v[16:19], 0
    v_mfma_f32_16x16x32_bf16 v[100:103], v[132:135], v[20:23], 0
    v_mfma_f32_16x16x32_bf16 v[116:119], v[132:135], v[24:27], 0
    v_mfma_f32_16x16x32_bf16 v[88:91], v[136:139], v[16:19], 0
    v_mfma_f32_16x16x32_bf16 v[104:107], v[136:139], v[20:23], 0
    v_mfma_f32_16x16x32_bf16 v[120:123], v[136:139], v[24:27], 0
    v_mfma_f32_16x16x32_bf16 v[92:95], v[140:143], v[16:19], 0
    v_mfma_f32_16x16x32_bf16 v[108:111], v[140:143], v[20:23], 0
    v_mfma_f32_16x16x32_bf16 v[124:127], v[140:143], v[24:27], 0
    s_waitcnt lgkmcnt(0)
    v_mfma_f32_16x16x32_bf16 v[80:83], v[144:147], v[28:31], v[80:83]
    ds_read_b128 v[16:19], v9 offset:1024
    v_mfma_f32_16x16x32_bf16 v[96:99], v[144:147], v[32:35], v[96:99]
    ds_read_b128 v[20:23], v9 offset:9216
    v_mfma_f32_16x16x32_bf16 v[112:115], v[144:147], v[36:39], v[112:115]
    ds_read_b128 v[24:27], v9 offset:17408
    v_mfma_f32_16x16x32_bf16 v[84:87], v[148:151], v[28:31], v[84:87]
    ds_read_b64_tr_b16 v[128:129], v11 offset:8192
    v_mfma_f32_16x16x32_bf16 v[100:103], v[148:151], v[32:35], v[100:103]
    ds_read_b64_tr_b16 v[130:131], v11 offset:8704
    v_mfma_f32_16x16x32_bf16 v[116:119], v[148:151], v[36:39], v[116:119]
    ds_read_b64_tr_b16 v[132:133], v11 offset:8200
    v_mfma_f32_16x16x32_bf16 v[88:91], v[152:155], v[28:31], v[88:91]
    ds_read_b64_tr_b16 v[134:135], v11 offset:8712
    v_mfma_f32_16x16x32_bf16 v[104:107], v[152:155], v[32:35], v[104:107]
    ds_read_b64_tr_b16 v[136:137], v12 offset:8192
    v_mfma_f32_16x16x32_bf16 v[120:123], v[152:155], v[36:39], v[120:123]
    ds_read_b64_tr_b16 v[138:139], v12 offset:8704
    v_mfma_f32_16x16x32_bf16 v[92:95], v[156:159], v[28:31], v[92:95]
    ds_read_b64_tr_b16 v[140:141], v12 offset:8200
    v_mfma_f32_16x16x32_bf16 v[108:111], v[156:159], v[32:35], v[108:111]
    ds_read_b64_tr_b16 v[142:143], v12 offset:8712
    v_mfma_f32_16x16x32_bf16 v[124:127], v[156:159], v[36:39], v[124:127]
    s_waitcnt lgkmcnt(8)
    v_mfma_f32_16x16x32_bf16 v[80:83], v[160:163], v[16:19], v[80:83]
    ds_read_b128 v[28:31], v10 offset:1024
    v_mfma_f32_16x16x32_bf16 v[96:99], v[160:163], v[20:23], v[96:99]
    ds_read_b128 v[32:35], v10 offset:9216
    v_mfma_f32_16x16x32_bf16 v[112:115], v[160:163], v[24:27], v[112:115]
    ds_read_b128 v[36:39], v10 offset:17408
    v_mfma_f32_16x16x32_bf16 v[84:87], v[164:167], v[16:19], v[84:87]
    ds_read_b64_tr_b16 v[144:145], v11 offset:12288
    v_mfma_f32_16x16x32_bf16 v[100:103], v[164:167], v[20:23], v[100:103]
    ds_read_b64_tr_b16 v[146:147], v11 offset:12800
    v_mfma_f32_16x16x32_bf16 v[116:119], v[164:167], v[24:27], v[116:119]
    ds_read_b64_tr_b16 v[148:149], v11 offset:12296
    v_mfma_f32_16x16x32_bf16 v[88:91], v[168:171], v[16:19], v[88:91]
    ds_read_b64_tr_b16 v[150:151], v11 offset:12808
    v_mfma_f32_16x16x32_bf16 v[104:107], v[168:171], v[20:23], v[104:107]
    ds_read_b64_tr_b16 v[152:153], v12 offset:12288
    v_mfma_f32_16x16x32_bf16 v[120:123], v[168:171], v[24:27], v[120:123]
    ds_read_b64_tr_b16 v[154:155], v12 offset:12800
    v_mfma_f32_16x16x32_bf16 v[92:95], v[172:175], v[16:19], v[92:95]
    ds_read_b64_tr_b16 v[156:157], v12 offset:12296
    v_mfma_f32_16x16x32_bf16 v[108:111], v[172:175], v[20:23], v[108:111]
    ds_read_b64_tr_b16 v[158:159], v12 offset:12808
    v_mfma_f32_16x16x32_bf16 v[124:127], v[172:175], v[24:27], v[124:127]
    s_waitcnt lgkmcnt(8)
    v_mfma_f32_16x16x32_bf16 v[80:83], v[176:179], v[28:31], v[80:83]
    ds_read_b128 v[16:19], v40 offset:1024
    v_mfma_f32_16x16x32_bf16 v[96:99], v[176:179], v[32:35], v[96:99]
    ds_read_b128 v[20:23], v40 offset:9216
    v_mfma_f32_16x16x32_bf16 v[112:115], v[176:179], v[36:39], v[112:115]
    ds_read_b128 v[24:27], v40 offset:17408
    v_mfma_f32_16x16x32_bf16 v[84:87], v[180:183], v[28:31], v[84:87]
    ds_read_b64_tr_b16 v[160:161], v11 offset:0
    v_mfma_f32_16x16x32_bf16 v[100:103], v[180:183], v[32:35], v[100:103]
    ds_read_b64_tr_b16 v[162:163], v11 offset:512
    v_mfma_f32_16x16x32_bf16 v[116:119], v[180:183], v[36:39], v[116:119]
    ds_read_b64_tr_b16 v[164:165], v11 offset:8
    v_mfma_f32_16x16x32_bf16 v[88:91], v[184:187], v[28:31], v[88:91]
    ds_read_b64_tr_b16 v[166:167], v11 offset:520
    v_mfma_f32_16x16x32_bf16 v[104:107], v[184:187], v[32:35], v[104:107]
    ds_read_b64_tr_b16 v[168:169], v12 offset:0
    v_mfma_f32_16x16x32_bf16 v[120:123], v[184:187], v[36:39], v[120:123]
    ds_read_b64_tr_b16 v[170:171], v12 offset:512
    v_mfma_f32_16x16x32_bf16 v[92:95], v[188:191], v[28:31], v[92:95]
    ds_read_b64_tr_b16 v[172:173], v12 offset:8
    v_mfma_f32_16x16x32_bf16 v[108:111], v[188:191], v[32:35], v[108:111]
    ds_read_b64_tr_b16 v[174:175], v12 offset:520
    v_mfma_f32_16x16x32_bf16 v[124:127], v[188:191], v[36:39], v[124:127]
    s_waitcnt lgkmcnt(8)
    v_mfma_f32_16x16x32_bf16 v[80:83], v[192:195], v[16:19], v[80:83]
    ds_read_b128 v[28:31], v41 offset:1024
    v_mfma_f32_16x16x32_bf16 v[96:99], v[192:195], v[20:23], v[96:99]
    ds_read_b128 v[32:35], v41 offset:9216
    v_mfma_f32_16x16x32_bf16 v[112:115], v[192:195], v[24:27], v[112:115]
    ds_read_b128 v[36:39], v41 offset:17408
    v_mfma_f32_16x16x32_bf16 v[84:87], v[196:199], v[16:19], v[84:87]
    ds_read_b64_tr_b16 v[176:177], v11 offset:4096
    v_mfma_f32_16x16x32_bf16 v[100:103], v[196:199], v[20:23], v[100:103]
    ds_read_b64_tr_b16 v[178:179], v11 offset:4608
    v_mfma_f32_16x16x32_bf16 v[116:119], v[196:199], v[24:27], v[116:119]
    ds_read_b64_tr_b16 v[180:181], v11 offset:4104
    v_mfma_f32_16x16x32_bf16 v[88:91], v[200:203], v[16:19], v[88:91]
    ds_read_b64_tr_b16 v[182:183], v11 offset:4616
    v_mfma_f32_16x16x32_bf16 v[104:107], v[200:203], v[20:23], v[104:107]
    ds_read_b64_tr_b16 v[184:185], v12 offset:4096
    v_mfma_f32_16x16x32_bf16 v[120:123], v[200:203], v[24:27], v[120:123]
    ds_read_b64_tr_b16 v[186:187], v12 offset:4608
    v_mfma_f32_16x16x32_bf16 v[92:95], v[204:207], v[16:19], v[92:95]
    ds_read_b64_tr_b16 v[188:189], v12 offset:4104
    v_mfma_f32_16x16x32_bf16 v[108:111], v[204:207], v[20:23], v[108:111]
    ds_read_b64_tr_b16 v[190:191], v12 offset:4616
    v_mfma_f32_16x16x32_bf16 v[124:127], v[204:207], v[24:27], v[124:127]
    s_waitcnt lgkmcnt(8)
    v_mfma_f32_16x16x32_bf16 v[80:83], v[208:211], v[28:31], v[80:83]
    ds_read_b128 v[16:19], v42 offset:1024
    v_mfma_f32_16x16x32_bf16 v[96:99], v[208:211], v[32:35], v[96:99]
    ds_read_b128 v[20:23], v42 offset:9216
    v_mfma_f32_16x16x32_bf16 v[112:115], v[208:211], v[36:39], v[112:115]
    ds_read_b128 v[24:27], v42 offset:17408
    v_mfma_f32_16x16x32_bf16 v[84:87], v[212:215], v[28:31], v[84:87]
    v_mfma_f32_16x16x32_bf16 v[100:103], v[212:215], v[32:35], v[100:103]
    v_mfma_f32_16x16x32_bf16 v[116:119], v[212:215], v[36:39], v[116:119]
    v_mfma_f32_16x16x32_bf16 v[88:91], v[216:219], v[28:31], v[88:91]
    v_mfma_f32_16x16x32_bf16 v[104:107], v[216:219], v[32:35], v[104:107]
    v_mfma_f32_16x16x32_bf16 v[120:123], v[216:219], v[36:39], v[120:123]
    v_mfma_f32_16x16x32_bf16 v[92:95], v[220:223], v[28:31], v[92:95]
    v_mfma_f32_16x16x32_bf16 v[108:111], v[220:223], v[32:35], v[108:111]
    v_mfma_f32_16x16x32_bf16 v[124:127], v[220:223], v[36:39], v[124:127]
    s_waitcnt lgkmcnt(0)
    v_mfma_f32_16x16x32_bf16 v[80:83], v[224:227], v[16:19], v[80:83]
    v_add_u32 v11, s76, v11
    v_add_u32 v12, s76, v12
    v_mfma_f32_16x16x32_bf16 v[96:99], v[224:227], v[20:23], v[96:99]
    ds_read_b128 v[28:31], v43 offset:1024
    v_mfma_f32_16x16x32_bf16 v[112:115], v[224:227], v[24:27], v[112:115]
    ds_read_b128 v[32:35], v43 offset:9216
    v_mfma_f32_16x16x32_bf16 v[84:87], v[228:231], v[16:19], v[84:87]
    ds_read_b128 v[36:39], v43 offset:17408
    v_mfma_f32_16x16x32_bf16 v[100:103], v[228:231], v[20:23], v[100:103]
    s_waitcnt vmcnt(4)
    ds_read_b64_tr_b16 v[192:193], v11 offset:0
    v_mfma_f32_16x16x32_bf16 v[116:119], v[228:231], v[24:27], v[116:119]
    ds_read_b64_tr_b16 v[194:195], v11 offset:512
    v_mfma_f32_16x16x32_bf16 v[88:91], v[232:235], v[16:19], v[88:91]
    ds_read_b64_tr_b16 v[196:197], v11 offset:8
    v_mfma_f32_16x16x32_bf16 v[104:107], v[232:235], v[20:23], v[104:107]
    ds_read_b64_tr_b16 v[198:199], v11 offset:520
    v_mfma_f32_16x16x32_bf16 v[120:123], v[232:235], v[24:27], v[120:123]
    ds_read_b64_tr_b16 v[200:201], v12 offset:0
    v_mfma_f32_16x16x32_bf16 v[92:95], v[236:239], v[16:19], v[92:95]
    ds_read_b64_tr_b16 v[202:203], v12 offset:512
    v_mfma_f32_16x16x32_bf16 v[108:111], v[236:239], v[20:23], v[108:111]
    ds_read_b64_tr_b16 v[204:205], v12 offset:8
    v_mfma_f32_16x16x32_bf16 v[124:127], v[236:239], v[24:27], v[124:127]
    ds_read_b64_tr_b16 v[206:207], v12 offset:520
    s_waitcnt lgkmcnt(8)
    v_mfma_f32_16x16x32_bf16 v[80:83], v[240:243], v[28:31], v[80:83]
    v_add_u32 v11, s77, v11
    v_add_u32 v12, s77, v12
    v_mfma_f32_16x16x32_bf16 v[96:99], v[240:243], v[32:35], v[96:99]
    s_waitcnt vmcnt(0)
    ds_read_b64_tr_b16 v[208:209], v11 offset:0
    v_mfma_f32_16x16x32_bf16 v[112:115], v[240:243], v[36:39], v[112:115]
    ds_read_b64_tr_b16 v[210:211], v11 offset:512
    v_mfma_f32_16x16x32_bf16 v[84:87], v[244:247], v[28:31], v[84:87]
    ds_read_b64_tr_b16 v[212:213], v11 offset:8
    v_mfma_f32_16x16x32_bf16 v[100:103], v[244:247], v[32:35], v[100:103]
    ds_read_b64_tr_b16 v[214:215], v11 offset:520
    v_mfma_f32_16x16x32_bf16 v[116:119], v[244:247], v[36:39], v[116:119]
    ds_read_b64_tr_b16 v[216:217], v12 offset:0
    v_mfma_f32_16x16x32_bf16 v[88:91], v[248:251], v[28:31], v[88:91]
    ds_read_b64_tr_b16 v[218:219], v12 offset:512
    v_mfma_f32_16x16x32_bf16 v[104:107], v[248:251], v[32:35], v[104:107]
    ds_read_b64_tr_b16 v[220:221], v12 offset:8
    v_mfma_f32_16x16x32_bf16 v[120:123], v[248:251], v[36:39], v[120:123]
    ds_read_b64_tr_b16 v[222:223], v12 offset:520
    v_mfma_f32_16x16x32_bf16 v[92:95], v[252:255], v[28:31], v[92:95]
    v_mfma_f32_16x16x32_bf16 v[108:111], v[252:255], v[32:35], v[108:111]
    v_mfma_f32_16x16x32_bf16 v[124:127], v[252:255], v[36:39], v[124:127]
    s_add_u32 s75, s74, 4096
    s_add_u32 s76, s74, 8192
    s_add_u32 s77, s74, 12288
    s_add_u32 s78, s74, 16384
L_prog_46:
    ds_read_b128 v[16:19], v5 offset:32
    s_waitcnt lgkmcnt(0)
    v_min3_u32 v16, v16, v17, v18
    v_min_u32 v16, v16, v19
    v_cmp_gt_u32 vcc, 1, v16
    s_cbranch_vccnz L_retry_47
    ds_read_b128 v[16:19], v7 offset:58368
    ds_read_b128 v[20:23], v8 offset:58368
    ds_read_b128 v[24:27], v9 offset:58368
    ds_read_b128 v[28:31], v10 offset:58368
    ds_read_b128 v[32:35], v40 offset:58368
    ds_read_b128 v[36:39], v41 offset:58368
    ds_read_b128 v[44:47], v42 offset:58368
    ds_read_b128 v[252:255], v43 offset:58368
    s_waitcnt lgkmcnt(7)
    v_mfma_f32_16x16x32_bf16 v[120:123], v[56:59], v[16:19], v[120:123]
    v_mfma_f32_16x16x32_bf16 v[124:127], v[60:63], v[16:19], v[124:127]
    v_mfma_f32_16x16x32_bf16 v[112:115], v[48:51], v[16:19], v[112:115]
    v_mfma_f32_16x16x32_bf16 v[116:119], v[52:55], v[16:19], v[116:119]
    s_waitcnt lgkmcnt(6)
    v_mfma_f32_16x16x32_bf16 v[120:123], v[72:75], v[20:23], v[120:123]
    v_mfma_f32_16x16x32_bf16 v[124:127], v[76:79], v[20:23], v[124:127]
    v_mfma_f32_16x16x32_bf16 v[112:115], v[64:67], v[20:23], v[112:115]
    v_mfma_f32_16x16x32_bf16 v[116:119], v[68:71], v[20:23], v[116:119]
    s_waitcnt lgkmcnt(5)
    v_mfma_f32_16x16x32_bf16 v[120:123], v[136:139], v[24:27], v[120:123]
    v_mfma_f32_16x16x32_bf16 v[124:127], v[140:143], v[24:27], v[124:127]
    v_mfma_f32_16x16x32_bf16 v[112:115], v[128:131], v[24:27], v[112:115]
    v_mfma_f32_16x16x32_bf16 v[116:119], v[132:135], v[24:27], v[116:119]
    s_waitcnt lgkmcnt(4)
    v_mfma_f32_16x16x32_bf16 v[120:123], v[152:155], v[28:31], v[120:123]
    v_mfma_f32_16x16x32_bf16 v[124:127], v[156:159], v[28:31], v[124:127]
    v_mfma_f32_16x16x32_bf16 v[112:115], v[144:147], v[28:31], v[112:115]
    v_mfma_f32_16x16x32_bf16 v[116:119], v[148:151], v[28:31], v[116:119]
    s_waitcnt lgkmcnt(3)
    v_mfma_f32_16x16x32_bf16 v[120:123], v[168:171], v[32:35], v[120:123]
    v_mfma_f32_16x16x32_bf16 v[124:127], v[172:175], v[32:35], v[124:127]
    v_mfma_f32_16x16x32_bf16 v[112:115], v[160:163], v[32:35], v[112:115]
    v_mfma_f32_16x16x32_bf16 v[116:119], v[164:167], v[32:35], v[116:119]
    s_waitcnt lgkmcnt(2)
    v_mfma_f32_16x16x32_bf16 v[120:123], v[184:187], v[36:39], v[120:123]
    v_mfma_f32_16x16x32_bf16 v[124:127], v[188:191], v[36:39], v[124:127]
    v_mfma_f32_16x16x32_bf16 v[112:115], v[176:179], v[36:39], v[112:115]
    v_mfma_f32_16x16x32_bf16 v[116:119], v[180:183], v[36:39], v[116:119]
    s_waitcnt lgkmcnt(1)
    v_mfma_f32_16x16x32_bf16 v[120:123], v[200:203], v[44:47], v[120:123]
    v_mfma_f32_16x16x32_bf16 v[124:127], v[204:207], v[44:47], v[124:127]
    v_mfma_f32_16x16x32_bf16 v[112:115], v[192:195], v[44:47], v[112:115]
    v_mfma_f32_16x16x32_bf16 v[116:119], v[196:199], v[44:47], v[116:119]
    s_waitcnt lgkmcnt(0)
    v_mfma_f32_16x16x32_bf16 v[120:123], v[216:219], v[252:255], v[120:123]
    v_mfma_f32_16x16x32_bf16 v[124:127], v[220:223], v[252:255], v[124:127]
    v_mfma_f32_16x16x32_bf16 v[112:115], v[208:211], v[252:255], v[112:115]
    v_mfma_f32_16x16x32_bf16 v[116:119], v[212:215], v[252:255], v[116:119]
L_prog_48:
    ds_read_b128 v[16:19], v5 offset:32
    s_waitcnt lgkmcnt(0)
    v_min3_u32 v16, v16, v17, v18
    v_min_u32 v16, v16, v19
    v_cmp_gt_u32 vcc, 3, v16
    s_cbranch_vccnz L_retry_49
    ds_read_b128 v[16:19], v7 offset:41984
    ds_read_b128 v[20:23], v8 offset:41984
    ds_read_b128 v[24:27], v9 offset:41984
    ds_read_b128 v[28:31], v10 offset:41984
    ds_read_b128 v[32:35], v40 offset:41984
    ds_read_b128 v[36:39], v41 offset:41984
    ds_read_b128 v[44:47], v42 offset:41984
    ds_read_b128 v[252:255], v43 offset:41984
    s_waitcnt lgkmcnt(7)
    v_mfma_f32_16x16x32_bf16 v[88:91], v[56:59], v[16:19], v[88:91]
    v_cvt_pk_bf16_f32 v248, v120, v121
    v_mfma_f32_16x16x32_bf16 v[92:95], v[60:63], v[16:19], v[92:95]
    v_cvt_pk_bf16_f32 v249, v122, v123
    v_mfma_f32_16x16x32_bf16 v[80:83], v[48:51], v[16:19], v[80:83]
    v_cvt_pk_bf16_f32 v250, v124, v125
    v_mfma_f32_16x16x32_bf16 v[84:87], v[52:55], v[16:19], v[84:87]
    v_cvt_pk_bf16_f32 v251, v126, v127
    s_waitcnt lgkmcnt(6)
    v_mfma_f32_16x16x32_bf16 v[88:91], v[72:75], v[20:23], v[88:91]
    v_cvt_pk_bf16_f32 v244, v112, v113
    v_mfma_f32_16x16x32_bf16 v[92:95], v[76:79], v[20:23], v[92:95]
    v_cvt_pk_bf16_f32 v245, v114, v115
    v_mfma_f32_16x16x32_bf16 v[80:83], v[64:67], v[20:23], v[80:83]
    v_cvt_pk_bf16_f32 v246, v116, v117
    v_mfma_f32_16x16x32_bf16 v[84:87], v[68:71], v[20:23], v[84:87]
    v_cvt_pk_bf16_f32 v247, v118, v119
    s_waitcnt lgkmcnt(5)
    v_mfma_f32_16x16x32_bf16 v[88:91], v[136:139], v[24:27], v[88:91]
    v_mov_b32_dpp v244, v248 row_ror:8 row_mask:0xf bank_mask:0xc
    v_mfma_f32_16x16x32_bf16 v[92:95], v[140:143], v[24:27], v[92:95]
    v_mov_b32_dpp v245, v249 row_ror:8 row_mask:0xf bank_mask:0xc
    v_mfma_f32_16x16x32_bf16 v[80:83], v[128:131], v[24:27], v[80:83]
    v_mov_b32_dpp v246, v250 row_ror:8 row_mask:0xf bank_mask:0xc
    v_mfma_f32_16x16x32_bf16 v[84:87], v[132:135], v[24:27], v[84:87]
    v_mov_b32_dpp v247, v251 row_ror:8 row_mask:0xf bank_mask:0xc
    s_waitcnt lgkmcnt(4)
    v_mfma_f32_16x16x32_bf16 v[88:91], v[152:155], v[28:31], v[88:91]
    v_mfma_f32_16x16x32_bf16 v[92:95], v[156:159], v[28:31], v[92:95]
    v_mfma_f32_16x16x32_bf16 v[80:83], v[144:147], v[28:31], v[80:83]
    v_mfma_f32_16x16x32_bf16 v[84:87], v[148:151], v[28:31], v[84:87]
    s_waitcnt lgkmcnt(3)
    v_mfma_f32_16x16x32_bf16 v[88:91], v[168:171], v[32:35], v[88:91]
    v_mfma_f32_16x16x32_bf16 v[92:95], v[172:175], v[32:35], v[92:95]
    v_mfma_f32_16x16x32_bf16 v[80:83], v[160:163], v[32:35], v[80:83]
    v_mfma_f32_16x16x32_bf16 v[84:87], v[164:167], v[32:35], v[84:87]
    s_waitcnt lgkmcnt(2)
    v_mfma_f32_16x16x32_bf16 v[88:91], v[184:187], v[36:39], v[88:91]
    v_mfma_f32_16x16x32_bf16 v[92:95], v[188:191], v[36:39], v[92:95]
    v_mfma_f32_16x16x32_bf16 v[80:83], v[176:179], v[36:39], v[80:83]
    v_mfma_f32_16x16x32_bf16 v[84:87], v[180:183], v[36:39], v[84:87]
    s_waitcnt lgkmcnt(1)
    v_mfma_f32_16x16x32_bf16 v[88:91], v[200:203], v[44:47], v[88:91]
    v_mfma_f32_16x16x32_bf16 v[92:95], v[204:207], v[44:47], v[92:95]
    v_mfma_f32_16x16x32_bf16 v[80:83], v[192:195], v[44:47], v[80:83]
    v_mfma_f32_16x16x32_bf16 v[84:87], v[196:199], v[44:47], v[84:87]
    s_waitcnt lgkmcnt(0)
    v_mfma_f32_16x16x32_bf16 v[88:91], v[216:219], v[252:255], v[88:91]
    v_mfma_f32_16x16x32_bf16 v[92:95], v[220:223], v[252:255], v[92:95]
    v_mfma_f32_16x16x32_bf16 v[80:83], v[208:211], v[252:255], v[80:83]
    v_mfma_f32_16x16x32_bf16 v[84:87], v[212:215], v[252:255], v[84:87]
    s_nop 4
    v_cvt_pk_bf16_f32 v228, v88, v89
    v_cvt_pk_bf16_f32 v229, v90, v91
    v_cvt_pk_bf16_f32 v230, v92, v93
    v_cvt_pk_bf16_f32 v231, v94, v95
    v_cvt_pk_bf16_f32 v224, v80, v81
    v_cvt_pk_bf16_f32 v225, v82, v83
    v_cvt_pk_bf16_f32 v226, v84, v85
    v_cvt_pk_bf16_f32 v227, v86, v87
    v_cvt_pk_bf16_f32 v240, v80, v81
    v_cvt_pk_bf16_f32 v241, v82, v83
    v_cvt_pk_bf16_f32 v242, v84, v85
    v_cvt_pk_bf16_f32 v243, v86, v87
    v_mov_b32_dpp v224, v228 row_ror:8 row_mask:0xf bank_mask:0xc
    v_mov_b32_dpp v225, v229 row_ror:8 row_mask:0xf bank_mask:0xc
    v_mov_b32_dpp v226, v230 row_ror:8 row_mask:0xf bank_mask:0xc
    v_mov_b32_dpp v227, v231 row_ror:8 row_mask:0xf bank_mask:0xc
    v_mov_b32_dpp v228, v240 row_ror:8 row_mask:0xf bank_mask:0x3
    v_mov_b32_dpp v229, v241 row_ror:8 row_mask:0xf bank_mask:0x3
    v_mov_b32_dpp v230, v242 row_ror:8 row_mask:0xf bank_mask:0x3
    v_mov_b32_dpp v231, v243 row_ror:8 row_mask:0xf bank_mask:0x3
L_prog_50:
    ds_read_b128 v[16:19], v5 offset:48
    s_waitcnt lgkmcnt(0)
    v_min3_u32 v16, v16, v17, v18
    v_min_u32 v16, v16, v19
    v_cmp_gt_u32 vcc, 1, v16
    s_cbranch_vccnz L_retry_51
    s_setprio 2
    buffer_store_dwordx4 v[244:247], v0, s[48:51], s78 offen sc1
    buffer_store_dwordx4 v[224:227], v0, s[48:51], s74 offen sc1
    buffer_store_dwordx4 v[228:231], v0, s[48:51], s75 offen sc1
    s_setprio 0
    v_lshlrev_b32 v1, 4, v4
    v_lshl_add_u32 v1, v3, 9, v1
    s_barrier
    s_setprio 2
    ds_read_b128 v[16:19], v7 offset:50176
    ds_read_b128 v[20:23], v8 offset:50176
    ds_read_b128 v[24:27], v9 offset:50176
    ds_read_b128 v[28:31], v10 offset:50176
    ds_read_b128 v[32:35], v40 offset:50176
    ds_read_b128 v[36:39], v41 offset:50176
    ds_read_b128 v[44:47], v42 offset:50176
    ds_read_b128 v[252:255], v43 offset:50176
    s_waitcnt lgkmcnt(7)
    v_mfma_f32_16x16x32_bf16 v[104:107], v[56:59], v[16:19], v[104:107]
    v_mfma_f32_16x16x32_bf16 v[108:111], v[60:63], v[16:19], v[108:111]
    s_waitcnt lgkmcnt(6)
    v_mfma_f32_16x16x32_bf16 v[104:107], v[72:75], v[20:23], v[104:107]
    v_mfma_f32_16x16x32_bf16 v[108:111], v[76:79], v[20:23], v[108:111]
    s_waitcnt lgkmcnt(5)
    v_mfma_f32_16x16x32_bf16 v[104:107], v[136:139], v[24:27], v[104:107]
    v_mfma_f32_16x16x32_bf16 v[108:111], v[140:143], v[24:27], v[108:111]
    s_waitcnt lgkmcnt(4)
    v_mfma_f32_16x16x32_bf16 v[104:107], v[152:155], v[28:31], v[104:107]
    v_mfma_f32_16x16x32_bf16 v[108:111], v[156:159], v[28:31], v[108:111]
    s_waitcnt lgkmcnt(3)
    v_mfma_f32_16x16x32_bf16 v[104:107], v[168:171], v[32:35], v[104:107]
    v_mfma_f32_16x16x32_bf16 v[108:111], v[172:175], v[32:35], v[108:111]
    s_waitcnt lgkmcnt(2)
    v_mfma_f32_16x16x32_bf16 v[104:107], v[184:187], v[36:39], v[104:107]
    v_mfma_f32_16x16x32_bf16 v[108:111], v[188:191], v[36:39], v[108:111]
    s_waitcnt lgkmcnt(1)
    v_mfma_f32_16x16x32_bf16 v[104:107], v[200:203], v[44:47], v[104:107]
    v_mfma_f32_16x16x32_bf16 v[108:111], v[204:207], v[44:47], v[108:111]
    s_waitcnt lgkmcnt(0)
    v_mfma_f32_16x16x32_bf16 v[104:107], v[216:219], v[252:255], v[104:107]
    v_mfma_f32_16x16x32_bf16 v[108:111], v[220:223], v[252:255], v[108:111]
    v_mfma_f32_16x16x32_bf16 v[96:99], v[48:51], v[16:19], v[96:99]
    v_mfma_f32_16x16x32_bf16 v[100:103], v[52:55], v[16:19], v[100:103]
    v_mfma_f32_16x16x32_bf16 v[96:99], v[64:67], v[20:23], v[96:99]
    v_mfma_f32_16x16x32_bf16 v[100:103], v[68:71], v[20:23], v[100:103]
    v_mfma_f32_16x16x32_bf16 v[96:99], v[128:131], v[24:27], v[96:99]
    v_mfma_f32_16x16x32_bf16 v[100:103], v[132:135], v[24:27], v[100:103]
    v_mfma_f32_16x16x32_bf16 v[96:99], v[144:147], v[28:31], v[96:99]
    v_mfma_f32_16x16x32_bf16 v[100:103], v[148:151], v[28:31], v[100:103]
    v_cvt_pk_bf16_f32 v236, v104, v105
    v_mfma_f32_16x16x32_bf16 v[96:99], v[160:163], v[32:35], v[96:99]
    v_cvt_pk_bf16_f32 v237, v106, v107
    v_mfma_f32_16x16x32_bf16 v[100:103], v[164:167], v[32:35], v[100:103]
    v_cvt_pk_bf16_f32 v238, v108, v109
    v_mfma_f32_16x16x32_bf16 v[96:99], v[176:179], v[36:39], v[96:99]
    v_cvt_pk_bf16_f32 v239, v110, v111
    v_mfma_f32_16x16x32_bf16 v[100:103], v[180:183], v[36:39], v[100:103]
    buffer_store_dwordx4 v[236:239], v1, s[48:51], s76 offen offset:64 sc1
    v_mfma_f32_16x16x32_bf16 v[96:99], v[192:195], v[44:47], v[96:99]
    v_mfma_f32_16x16x32_bf16 v[100:103], v[196:199], v[44:47], v[100:103]
    v_mfma_f32_16x16x32_bf16 v[96:99], v[208:211], v[252:255], v[96:99]
    v_mfma_f32_16x16x32_bf16 v[100:103], v[212:215], v[252:255], v[100:103]
    s_nop 6
    v_cvt_pk_bf16_f32 v232, v96, v97
    v_cvt_pk_bf16_f32 v233, v98, v99
    v_cvt_pk_bf16_f32 v234, v100, v101
    v_cvt_pk_bf16_f32 v235, v102, v103
    buffer_store_dwordx4 v[232:235], v1, s[48:51], s76 offen offset:0 sc1
    s_or_b32 s64, s2, s3
    s_cbranch_scc1 L_noepoch_52
    v_mov_b32 v1, s30
    s_mov_b64 exec, 1
    buffer_store_dword v1, v5, s[44:47], 0 offen sc1
L_noepoch_52:
    s_endpgm
L_retry_40:
    s_sub_u32 s100, s100, 1
    s_cbranch_scc1 L_end
    s_sleep 1
    s_branch L_spin_39
L_mre_41:
    s_sub_u32 s100, s100, 1
    s_cbranch_scc1 L_end
    s_sleep 2
    buffer_load_dword v1, v0, s[44:47], s74 offen sc1
    s_waitcnt vmcnt(0)
    s_branch L_mchk_38
L_retry_43:
    s_sub_u32 s100, s100, 1
    s_cbranch_scc1 L_end
    s_sleep 1
    s_branch L_spin_42
L_retry_45:
    s_sub_u32 s100, s100, 1
    s_cbranch_scc1 L_end
    s_sleep 1
    s_branch L_prog_44
L_retry_47:
    s_sub_u32 s100, s100, 1
    s_cbranch_scc1 L_end
    s_sleep 1
    s_branch L_prog_46
L_retry_49:
    s_sub_u32 s100, s100, 1
    s_cbranch_scc1 L_end
    s_sleep 1
    s_branch L_prog_48
L_retry_51:
    s_sub_u32 s100, s100, 1
    s_cbranch_scc1 L_end
    s_sleep 1
    s_branch L_prog_50
L_end:
    s_endpgm
.section .rodata,"a"
.p2align 6
.amdhsa_kernel standalone__hybrid_graph_tf_exphormer__graph_kernel
  .amdhsa_next_free_vgpr 256
  .amdhsa_next_free_sgpr 102
  .amdhsa_accum_offset 256
  .amdhsa_group_segment_fixed_size 0
  .amdhsa_kernarg_size 104
  .amdhsa_user_sgpr_count 2
  .amdhsa_user_sgpr_kernarg_segment_ptr 1
  .amdhsa_system_sgpr_workgroup_id_x 1
  .amdhsa_float_denorm_mode_32 3
.end_amdhsa_kernel
```

```asm
; @launch grid=(253,1,1) block=(512,1,1) lds=161792
.amdgcn_target "amdgcn-amd-amdhsa--gfx950"
.text
.globl standalone__hybrid_graph_tf_exphormer__graph_kernel
.p2align 8
.type standalone__hybrid_graph_tf_exphormer__graph_kernel,@function
standalone__hybrid_graph_tf_exphormer__graph_kernel:
L_begin:
    s_cmp_ge_u32 s2, 253
    s_cbranch_scc1 L_end
    s_load_dwordx16 s[4:19], s[0:1], 0
    s_load_dwordx8 s[20:27], s[0:1], 64
    s_load_dwordx2 s[28:29], s[0:1], 96
    s_and_b32 s64, s2, 0xf8
    s_cmp_lg_u32 s64, 8
    s_cbranch_scc1 L_nopf
    s_getpc_b64 s[32:33]
L_pc:
    v_lshlrev_b32 v1, 6, v0
    v_min_u32 v1, L_end-L_pc, v1
    global_load_dword v255, v1, s[32:33]
L_nopf:
    v_lshrrev_b32 v1, 6, v0
    v_lshlrev_b32 v8, 4, v0
    v_mov_b32 v12, 1966080
    v_readfirstlane_b32 s3, v1
    v_mov_b32 v13, 1966080
    v_mov_b32 v14, 1966080
    v_mov_b32 v15, 1966080
    ds_write_b128 v8, v[12:15] offset:41984
    ds_write_b128 v8, v[12:15] offset:50176
    v_subrev_u32 v9, 32, v0
    v_cmp_gt_u32 vcc, 20, v9
    v_mul_u32_u24 v9, 264, v9
    v_add_u32 v9, 148480, v9
    v_lshlrev_b32 v10, 2, v0
    v_cndmask_b32 v9, 0, v9, vcc
    v_min_u32 v11, 1020, v10
    ds_write_b32 v11, v9
    v_mov_b32 v16, 1310740000
    v_mov_b32 v17, 1310740000
    v_mov_b32 v18, 1310740000
    v_mov_b32 v19, 1310740000
    v_add_u32 v9, 148480, v8
    ds_write_b128 v9, v[16:19]
    v_and_b32 v2, 63, v0
    v_and_b32 v3, 15, v0
    v_bfe_u32 v4, v0, 4, 2
    v_mov_b32 v5, 0
    v_mov_b32 v6, 1
    s_mov_b32 s100, 67108864
    s_and_b32 s64, s2, 7
    s_lshl_b32 s64, s64, 1
    s_bfe_u32 s65, s2, 0x10003
    s_or_b32 s64, s64, s65
    s_and_b32 s65, s2, 0xf0
    s_or_b32 s64, s64, s65
    s_cmp_lt_u32 s2, 240
    s_cselect_b32 s1, s64, s2
    s_and_b32 s31, s3, 3
    s_cmp_lt_u32 s3, 4
    s_cbranch_scc1 L_gemm
    s_setprio 3
    v_and_b32 v8, 0xfff, v8
    v_and_b32 v9, 0x3ff, v10
    s_lshr_b32 s66, s2, 4
    s_lshl_b32 s66, s66, 3
    s_and_b32 s67, s2, 7
    s_or_b32 s68, s66, s67
    s_mul_i32 s64, s68, 5120
    v_add_u32 v40, s64, v8
    s_add_u32 s64, s64, 4096
    v_add_u32 v41, s64, v9
    v_lshrrev_b32 v42, 2, v3
    v_and_b32 v43, 3, v3
    v_lshl_add_u32 v42, v42, 4, v43
    s_lshl_b32 s64, s31, 1
    v_mov_b32 v43, s64
    v_lshlrev_b32 v44, 1, v43
    v_cmp_gt_u32 vcc, 8, v3
    s_mul_i32 s65, s1, 640
    v_lshlrev_b32 v7, 4, v3
    v_cndmask_b32 v43, v43, v44, vcc
    v_add_lshl_u32 v42, v42, v43, 4
    v_lshl_add_u32 v42, v4, 2, v42
    v_add_u32 v42, s65, v42
    v_min_u32 v42, 159996, v42
    s_bitcmp1_b32 s2, 3
    s_cbranch_scc0 L_mrole_1
    s_waitcnt lgkmcnt(0)
    global_load_dword v0, v42, s[10:11]
    global_load_dwordx4 v[48:51], v40, s[8:9]
    global_load_dword v52, v41, s[8:9]
    global_load_dwordx4 v[56:59], v40, s[6:7]
    global_load_dword v60, v41, s[6:7]
L_roled_2:
    s_mov_b32 s27, s68
    s_mov_b32 s26, 0
    s_cmp_lg_u32 s31, 0
    s_cbranch_scc1 L_roled_2_b
    s_load_dword s30, s[28:29], 0
L_roled_2_b:
    s_barrier
    s_branch L_pastm
L_mrole_1:
    v_lshrrev_b32 v43, 5, v2
    s_lshl_b32 s66, s31, 2
    v_add_u32 v44, s66, v43
    v_and_b32 v46, 31, v2
    v_xor_b32 v46, v46, v44
    v_lshlrev_b32 v46, 4, v46
    v_lshl_add_u32 v46, v43, 9, v46
    s_bfe_u32 s64, s68, 0x30002
    s_lshl_b32 s64, s64, 14
    s_lshr_b32 s65, s68, 5
    s_lshl_b32 s65, s65, 15
    s_bfe_u32 s66, s68, 0x10001
    s_lshl_b32 s66, s66, 14
    s_add_u32 s65, s65, s66
    s_and_b32 s66, s68, 1
    s_lshl_b32 s66, s66, 11
    s_add_u32 s65, s65, s66
    s_lshl_b32 s66, s31, 12
    v_add_u32 v46, s66, v46
    v_add_u32 v44, s64, v46
    v_add_u32 v46, s65, v46
    v_xor_b32 v45, 0x420, v44
    v_xor_b32 v47, 0x420, v46
    s_lshl_b32 s66, s31, 11
    s_waitcnt lgkmcnt(0)
    global_load_dword v0, v42, s[10:11]
    s_add_u32 m0, s66, 62464
    s_nop 0
    global_load_lds_dwordx4 v46, s[20:21] offset:0
    s_add_u32 m0, s66, 63488
    s_nop 0
    global_load_lds_dwordx4 v47, s[20:21] offset:0
    s_add_u32 m0, s66, 21504
    s_nop 0
    global_load_lds_dwordx4 v44, s[18:19] offset:0
    s_add_u32 m0, s66, 22528
    s_nop 0
    global_load_lds_dwordx4 v45, s[18:19] offset:0
    s_add_u32 m0, s66, 27648
    s_nop 0
    global_load_lds_dwordx4 v44, s[18:19] offset:2048
    s_add_u32 m0, s66, 28672
    s_nop 0
    global_load_lds_dwordx4 v45, s[18:19] offset:2048
    s_branch L_roled_2
L_pastm:
    s_mov_b32 s32, s4
    s_and_b32 s33, s5, 0xffff
    s_mov_b32 s34, 5120000
    s_mov_b32 s35, 0x20000
    s_mov_b32 s36, s14
    s_and_b32 s37, s15, 0xffff
    s_mov_b32 s38, 20000
    s_mov_b32 s39, 0x20000
    s_add_u32 s40, s28, 1048576
    s_addc_u32 s41, s29, 0
    s_and_b32 s41, s41, 0xffff
    s_mov_b32 s42, 2048000
    s_mov_b32 s43, 0x20000
    v_and_b32 v40, 8, v3
    v_lshlrev_b32 v40, 1, v40
    v_mov_b32 v41, 0xffff
    v_lshlrev_b32 v40, v40, v41
    s_mov_b32 s64, 0x0f0f0f0f
    s_mov_b32 s65, 0x0f0f0f0f
    v_cndmask_b32 v12, 0, v40, s[64:65]
    v_xor_b32 v13, v40, v12
    v_and_b32 v14, 3, v3
    v_mul_u32_u24 v14, 0x5555, v14
    s_cmp_lg_u32 s31, 0
    s_cbranch_scc1 L_tagged_3
    s_waitcnt lgkmcnt(0)
    s_mul_i32 s30, s30, 0x9E3779B1
    s_add_u32 s30, s30, 0x7F4A7C15
    v_mov_b32 v40, 1
    v_mov_b32 v41, s30
    ds_write_b64 v5, v[40:41] offset:8
L_tagged_3:
    s_bitcmp1_b32 s2, 3
    s_cbranch_scc0 L_mwork_4
    v_mov_b32 v43, 4
    v_mov_b32 v44, 2031616
    s_mov_b32 s64, 0x3f0001
    v_lshrrev_b32 v40, 6, v8
    v_and_b32 v41, 0x30, v8
    v_lshl_add_u32 v40, v40, 14, v41
    s_lshl_b32 s68, s27, 6
    s_add_u32 s69, s68, 0x100000
    s_add_u32 s70, s68, 8192
    s_add_u32 s71, s69, 8192
    s_mov_b32 s65, 0x203c
    s_waitcnt vmcnt(2)
    v_mul_u32_u24 v64, 52429, v48
    v_lshrrev_b32 v72, 22, v64
    v_lshlrev_b32 v80, 2, v72
    ds_add_rtn_u32 v80, v80, v43 offset:512
    v_mul_u32_u24 v65, 52429, v49
    v_lshrrev_b32 v73, 22, v65
    v_lshlrev_b32 v81, 2, v73
    ds_add_rtn_u32 v81, v81, v43 offset:512
    v_mul_u32_u24 v66, 52429, v50
    v_lshrrev_b32 v74, 22, v66
    v_lshlrev_b32 v82, 2, v74
    ds_add_rtn_u32 v82, v82, v43 offset:512
    v_mul_u32_u24 v67, 52429, v51
    v_lshrrev_b32 v75, 22, v67
    v_lshlrev_b32 v83, 2, v75
    ds_add_rtn_u32 v83, v83, v43 offset:512
    v_mul_u32_u24 v68, 52429, v52
    v_lshrrev_b32 v76, 22, v68
    v_lshlrev_b32 v84, 2, v76
    ds_add_rtn_u32 v84, v84, v43 offset:512
    v_lshrrev_b32 v64, 21, v64
    v_mad_u32_u24 v64, v64, 24, v48
    v_mul_u32_u24 v64, 0x8001, v64
    v_bfe_u32 v88, v72, 1, 2
    v_lshl_or_b32 v72, v72, 2, v88
    v_lshlrev_b32 v72, 4, v72
    v_lshrrev_b32 v65, 21, v65
    v_mad_u32_u24 v65, v65, 24, v49
    v_mul_u32_u24 v65, 0x8001, v65
    v_bfe_u32 v89, v73, 1, 2
    v_lshl_or_b32 v73, v73, 2, v89
    v_lshlrev_b32 v73, 4, v73
    v_lshrrev_b32 v66, 21, v66
    v_mad_u32_u24 v66, v66, 24, v50
    v_mul_u32_u24 v66, 0x8001, v66
    v_bfe_u32 v90, v74, 1, 2
    v_lshl_or_b32 v74, v74, 2, v90
    v_lshlrev_b32 v74, 4, v74
    v_lshrrev_b32 v67, 21, v67
    v_mad_u32_u24 v67, v67, 24, v51
    v_mul_u32_u24 v67, 0x8001, v67
    v_bfe_u32 v91, v75, 1, 2
    v_lshl_or_b32 v75, v75, 2, v91
    v_lshlrev_b32 v75, 4, v75
    v_lshrrev_b32 v68, 21, v68
    v_mad_u32_u24 v68, v68, 24, v52
    v_mul_u32_u24 v68, 0x8001, v68
    v_bfe_u32 v92, v76, 1, 2
    v_lshl_or_b32 v76, v76, 2, v92
    v_lshlrev_b32 v76, 4, v76
    s_waitcnt vmcnt(0)
    v_lshlrev_b32 v56, 1, v56
    v_and_or_b32 v64, v64, s64, v56
    v_lshlrev_b32 v57, 1, v57
    v_and_or_b32 v65, v65, s64, v57
    v_lshlrev_b32 v58, 1, v58
    v_and_or_b32 v66, v66, s64, v58
    v_lshlrev_b32 v59, 1, v59
    v_and_or_b32 v67, v67, s64, v59
    v_lshlrev_b32 v60, 1, v60
    v_and_or_b32 v68, v68, s64, v60
    s_waitcnt lgkmcnt(0)
    v_cmp_gt_u32 vcc, 124, v80
    v_min_u32 v80, 124, v80
    v_lshl_or_b32 v80, v80, 7, v80
    v_cndmask_b32 v64, v44, v64, vcc
    v_bitop3_b32 v80, v80, s65, v72 bitop3:0x6a
    ds_write_b32 v80, v64 offset:41984
    v_cmp_gt_u32 vcc, 124, v81
    v_min_u32 v81, 124, v81
    v_lshl_or_b32 v81, v81, 7, v81
    v_cndmask_b32 v65, v44, v65, vcc
    v_bitop3_b32 v81, v81, s65, v73 bitop3:0x6a
    ds_write_b32 v81, v65 offset:41984
    v_cmp_gt_u32 vcc, 124, v82
    v_min_u32 v82, 124, v82
    v_lshl_or_b32 v82, v82, 7, v82
    v_cndmask_b32 v66, v44, v66, vcc
    v_bitop3_b32 v82, v82, s65, v74 bitop3:0x6a
    ds_write_b32 v82, v66 offset:41984
    v_cmp_gt_u32 vcc, 124, v83
    v_min_u32 v83, 124, v83
    v_lshl_or_b32 v83, v83, 7, v83
    v_cndmask_b32 v67, v44, v67, vcc
    v_bitop3_b32 v83, v83, s65, v75 bitop3:0x6a
    ds_write_b32 v83, v67 offset:41984
    v_cmp_gt_u32 vcc, 124, v84
    v_min_u32 v84, 124, v84
    v_lshl_or_b32 v84, v84, 7, v84
    v_cndmask_b32 v68, v44, v68, vcc
    v_bitop3_b32 v84, v84, s65, v76 bitop3:0x6a
    ds_write_b32 v84, v68 offset:41984
    s_waitcnt lgkmcnt(0)
    s_barrier
    ds_read_b32 v44, v5 offset:12
    ds_read_b128 v[48:51], v8 offset:41984
    ds_read_b128 v[52:55], v8 offset:46080
    ds_read_b128 v[56:59], v8 offset:50176
    ds_read_b128 v[60:63], v8 offset:54272
    s_waitcnt lgkmcnt(4)
    v_readfirstlane_b32 s30, v44
    s_nop 0
    s_and_b32 s44, s30, 0xffc00000
    s_lshl_b32 s45, s30, 10
    s_and_b32 s45, s45, 0xffc00000
    s_lshl_b32 s46, s30, 20
    s_and_b32 s46, s46, 0xffc00000
    s_lshl_b32 s47, s30, 22
    s_waitcnt lgkmcnt(3)
    v_cmp_eq_u32 vcc, 1966080, v51
    v_or_b32 v48, s44, v48
    v_or_b32 v49, s45, v49
    v_or_b32 v50, s46, v50
    v_or_b32 v51, s47, v51
    buffer_store_dwordx4 v[48:51], v40, s[40:43], s68 offen sc1
    s_wqm_b64 s[72:73], vcc
    s_waitcnt lgkmcnt(2)
    v_cmp_eq_u32 vcc, 1966080, v55
    v_or_b32 v52, s44, v52
    v_or_b32 v53, s45, v53
    v_or_b32 v54, s46, v54
    v_or_b32 v55, s47, v55
    buffer_store_dwordx4 v[52:55], v40, s[40:43], s69 offen sc1
    s_wqm_b64 s[74:75], vcc
    s_waitcnt lgkmcnt(1)
    s_not_b64 exec, s[72:73]
    s_cbranch_scc0 L_nosec_8
    v_or_b32 v56, s44, v56
    v_or_b32 v57, s45, v57
    v_or_b32 v58, s46, v58
    v_or_b32 v59, s47, v59
    buffer_store_dwordx4 v[56:59], v40, s[40:43], s70 offen sc1
L_nosec_8:
    s_waitcnt lgkmcnt(0)
    s_not_b64 exec, s[74:75]
    s_cbranch_scc0 L_nosec_9
    v_or_b32 v60, s44, v60
    v_or_b32 v61, s45, v61
    v_or_b32 v62, s46, v62
    v_or_b32 v63, s47, v63
    buffer_store_dwordx4 v[60:63], v40, s[40:43], s71 offen sc1
L_nosec_9:
    s_mov_b64 exec, -1
    s_cmp_ge_u32 s2, 250
    s_cbranch_scc1 L_end
L_worked_5:
    v_lshlrev_b32 v0, 9, v0
    s_setprio 1
    s_lshl_b32 s64, s31, 10
    s_lshr_b32 s10, s1, 1
    s_lshl_b32 s10, s10, 14
    s_add_u32 s11, s10, 4096
    s_add_u32 s12, s10, 8192
    s_add_u32 s13, s10, 12288
    v_cmp_gt_u32 vcc, 0xf40, v8
    s_mov_b64 s[14:15], vcc
    v_add_u32_dpp v9, v0, v7 row_newbcast:0 row_mask:0xf bank_mask:0xf
    buffer_load_dwordx4 v[176:179], v9, s[32:35], 0 offen offset:0
    buffer_load_dwordx4 v[180:183], v9, s[32:35], 0 offen offset:256
    v_add_u32_dpp v9, v0, v7 row_newbcast:1 row_mask:0xf bank_mask:0xf
    buffer_load_dwordx4 v[184:187], v9, s[32:35], 0 offen offset:0
    buffer_load_dwordx4 v[188:191], v9, s[32:35], 0 offen offset:256
    s_add_u32 m0, s64, 62464
    s_mov_b32 s65, 0
    buffer_load_dwordx4 v8, s[36:39], s65 offen lds
    v_add_u32_dpp v9, v0, v7 row_newbcast:2 row_mask:0xf bank_mask:0xf
    s_cmp_eq_u32 s26, 2
    s_cbranch_scc1 L_loose_10
    s_waitcnt vmcnt(2)
L_loose_10:
    s_waitcnt vmcnt(6)
    buffer_load_dwordx4 v[192:195], v9, s[32:35], 0 offen offset:0
    buffer_load_dwordx4 v[196:199], v9, s[32:35], 0 offen offset:256
    s_add_u32 m0, s64, 66560
    s_mov_b32 s65, 4096
    buffer_load_dwordx4 v8, s[36:39], s65 offen lds
    v_add_u32_dpp v9, v0, v7 row_newbcast:3 row_mask:0xf bank_mask:0xf
    s_cmp_eq_u32 s26, 2
    s_cbranch_scc1 L_loose_11
    s_waitcnt vmcnt(2)
L_loose_11:
    s_waitcnt vmcnt(6)
    buffer_load_dwordx4 v[200:203], v9, s[32:35], 0 offen offset:0
    buffer_load_dwordx4 v[204:207], v9, s[32:35], 0 offen offset:256
    s_add_u32 m0, s64, 70656
    s_mov_b32 s65, 8192
    buffer_load_dwordx4 v8, s[36:39], s65 offen lds
    v_add_u32_dpp v9, v0, v7 row_newbcast:4 row_mask:0xf bank_mask:0xf
    s_cmp_eq_u32 s26, 2
    s_cbranch_scc1 L_loose_12
    s_waitcnt vmcnt(2)
L_loose_12:
    s_waitcnt vmcnt(6)
    buffer_load_dwordx4 v[208:211], v9, s[32:35], 0 offen offset:0
    buffer_load_dwordx4 v[212:215], v9, s[32:35], 0 offen offset:256
    s_add_u32 m0, s64, 74752
    s_mov_b32 s65, 12288
    buffer_load_dwordx4 v8, s[36:39], s65 offen lds
    v_add_u32_dpp v9, v0, v7 row_newbcast:5 row_mask:0xf bank_mask:0xf
    s_cmp_eq_u32 s26, 2
    s_cbranch_scc1 L_loose_13
    s_waitcnt vmcnt(2)
L_loose_13:
    s_waitcnt vmcnt(6)
    buffer_load_dwordx4 v[216:219], v9, s[32:35], 0 offen offset:0
    buffer_load_dwordx4 v[220:223], v9, s[32:35], 0 offen offset:256
    s_add_u32 m0, s64, 78848
    s_mov_b32 s65, 16384
    buffer_load_dwordx4 v8, s[36:39], s65 offen lds
L_ipoll_14:
    buffer_load_dwordx4 v[48:51], v8, s[40:43], s10 offen sc1
    s_mov_b64 exec, s[14:15]
    buffer_load_dwordx4 v[52:55], v8, s[40:43], s11 offen sc1
    s_mov_b64 exec, -1
L_spin_15:
    ds_read_b128 v[44:47], v5
    s_waitcnt lgkmcnt(0)
    v_readfirstlane_b32 s101, v46
    v_readfirstlane_b32 s30, v47
    s_cmp_ge_u32 s101, 1
    s_cbranch_scc0 L_retry_16
    s_and_b32 s44, s30, 0xffc00000
    s_lshl_b32 s45, s30, 10
    s_and_b32 s45, s45, 0xffc00000
    s_lshl_b32 s46, s30, 20
    s_and_b32 s46, s46, 0xffc00000
    s_lshl_b32 s47, s30, 22
    s_and_b32 s64, s1, 1
    s_lshl_b32 s64, s64, 21
    s_xor_b32 s17, s64, 1966080
    s_or_b32 s44, s44, s64
    v_mov_b32 v68, s17
    s_or_b32 s45, s45, s64
    v_mov_b32 v69, s17
    s_or_b32 s46, s46, s64
    v_mov_b32 v70, s17
    s_or_b32 s47, s47, s64
    v_mov_b32 v71, s17
    s_mov_b32 s16, 1310720
    v_mov_b32 v42, 2
    s_waitcnt vmcnt(1)
    v_xor_b32 v64, s44, v48
    v_xor_b32 v65, s45, v49
    v_xor_b32 v66, s46, v50
    v_xor_b32 v67, s47, v51
    v_or3_b32 v40, v64, v65, v66
    v_or_b32 v40, v40, v67
    v_cmp_eq_u32 s[72:73], s17, v67
    v_cmp_gt_u32 s[48:49], s16, v64
    v_lshlrev_b32_sdwa v80, 2, v64 dst_sel:DWORD dst_unused:UNUSED_PAD src0_sel:DWORD src1_sel:WORD_1
    v_cmp_gt_u32 s[50:51], s16, v65
    v_lshlrev_b32_sdwa v81, 2, v65 dst_sel:DWORD dst_unused:UNUSED_PAD src0_sel:DWORD src1_sel:WORD_1
    v_cmp_gt_u32 s[52:53], s16, v66
    v_lshlrev_b32_sdwa v82, 2, v66 dst_sel:DWORD dst_unused:UNUSED_PAD src0_sel:DWORD src1_sel:WORD_1
    v_cmp_gt_u32 s[54:55], s16, v67
    v_lshlrev_b32_sdwa v83, 2, v67 dst_sel:DWORD dst_unused:UNUSED_PAD src0_sel:DWORD src1_sel:WORD_1
    s_waitcnt vmcnt(0)
    s_mov_b64 exec, s[14:15]
    v_xor_b32 v68, s44, v52
    v_xor_b32 v69, s45, v53
    v_xor_b32 v70, s46, v54
    v_xor_b32 v71, s47, v55
    s_mov_b64 exec, -1
    v_or3_b32 v40, v40, v68, v69
    v_or3_b32 v40, v40, v70, v71
    v_cmp_eq_u32 s[74:75], s17, v71
    v_cmp_le_u32 vcc, 0x400000, v40
    s_cbranch_vccnz L_retry_17
    s_wqm_b64 s[72:73], s[72:73]
    s_not_b64 exec, s[72:73]
    s_cbranch_scc0 L_nosec_18
    buffer_load_dwordx4 v[56:59], v8, s[40:43], s12 offen sc1
L_nosec_18:
    s_wqm_b64 s[74:75], s[74:75]
    s_not_b64 exec, s[74:75]
    s_cbranch_scc0 L_nosec_19
    buffer_load_dwordx4 v[60:63], v8, s[40:43], s13 offen sc1
L_nosec_19:
    s_mov_b64 exec, -1
    v_cmp_gt_u32 s[56:57], s16, v68
    v_lshlrev_b32_sdwa v84, 2, v68 dst_sel:DWORD dst_unused:UNUSED_PAD src0_sel:DWORD src1_sel:WORD_1
    v_cmp_gt_u32 s[58:59], s16, v69
    v_lshlrev_b32_sdwa v85, 2, v69 dst_sel:DWORD dst_unused:UNUSED_PAD src0_sel:DWORD src1_sel:WORD_1
    v_cmp_gt_u32 s[60:61], s16, v70
    v_lshlrev_b32_sdwa v86, 2, v70 dst_sel:DWORD dst_unused:UNUSED_PAD src0_sel:DWORD src1_sel:WORD_1
    v_cmp_gt_u32 s[62:63], s16, v71
    v_lshlrev_b32_sdwa v87, 2, v71 dst_sel:DWORD dst_unused:UNUSED_PAD src0_sel:DWORD src1_sel:WORD_1
    s_mov_b64 exec, s[48:49]
    ds_add_rtn_u32 v80, v80, v42 offset:128
    s_mov_b64 exec, s[50:51]
    ds_add_rtn_u32 v81, v81, v42 offset:128
    s_mov_b64 exec, s[52:53]
    ds_add_rtn_u32 v82, v82, v42 offset:128
    s_mov_b64 exec, s[54:55]
    ds_add_rtn_u32 v83, v83, v42 offset:128
    s_mov_b64 exec, s[56:57]
    ds_add_rtn_u32 v84, v84, v42 offset:128
    s_mov_b64 exec, s[58:59]
    ds_add_rtn_u32 v85, v85, v42 offset:128
    s_mov_b64 exec, s[60:61]
    ds_add_rtn_u32 v86, v86, v42 offset:128
    s_mov_b64 exec, s[62:63]
    ds_add_rtn_u32 v87, v87, v42 offset:128
    s_mov_b64 exec, -1
    v_add_u32_dpp v9, v0, v7 row_newbcast:6 row_mask:0xf bank_mask:0xf
    buffer_load_dwordx4 v[224:227], v9, s[32:35], 0 offen offset:0
    buffer_load_dwordx4 v[228:231], v9, s[32:35], 0 offen offset:256
    v_add_u32_dpp v9, v0, v7 row_newbcast:7 row_mask:0xf bank_mask:0xf
    buffer_load_dwordx4 v[232:235], v9, s[32:35], 0 offen offset:0
    buffer_load_dwordx4 v[236:239], v9, s[32:35], 0 offen offset:256
    s_waitcnt lgkmcnt(4)
    s_mov_b64 exec, s[48:49]
    ds_write_b16 v80, v64
    s_mov_b64 exec, s[50:51]
    ds_write_b16 v81, v65
    s_mov_b64 exec, s[52:53]
    ds_write_b16 v82, v66
    s_mov_b64 exec, s[54:55]
    ds_write_b16 v83, v67
    s_waitcnt lgkmcnt(4)
    s_mov_b64 exec, s[56:57]
    ds_write_b16 v84, v68
    s_mov_b64 exec, s[58:59]
    ds_write_b16 v85, v69
    s_mov_b64 exec, s[60:61]
    ds_write_b16 v86, v70
    s_mov_b64 exec, s[62:63]
    ds_write_b16 v87, v71
    s_not_b64 exec, s[72:73]
    s_cbranch_scc0 L_secdone_21
    s_waitcnt vmcnt(4)
L_sec_20:
    v_xor_b32 v72, s44, v56
    v_xor_b32 v73, s45, v57
    v_xor_b32 v74, s46, v58
    v_xor_b32 v75, s47, v59
    v_or3_b32 v40, v72, v73, v74
    v_or_b32 v40, v40, v75
    v_cmp_le_u32 vcc, 0x400000, v40
    s_cbranch_vccnz L_retry_23
    v_and_b32 v40, 2031616, v75
    v_cmp_eq_u32 vcc, 2031616, v40
    v_cmp_gt_u32 s[64:65], s16, v72
    v_lshlrev_b32_sdwa v88, 2, v72 dst_sel:DWORD dst_unused:UNUSED_PAD src0_sel:DWORD src1_sel:WORD_1
    v_cmp_gt_u32 s[66:67], s16, v73
    v_lshlrev_b32_sdwa v89, 2, v73 dst_sel:DWORD dst_unused:UNUSED_PAD src0_sel:DWORD src1_sel:WORD_1
    v_cmp_gt_u32 s[68:69], s16, v74
    v_lshlrev_b32_sdwa v90, 2, v74 dst_sel:DWORD dst_unused:UNUSED_PAD src0_sel:DWORD src1_sel:WORD_1
    v_cmp_gt_u32 s[70:71], s16, v75
    v_lshlrev_b32_sdwa v91, 2, v75 dst_sel:DWORD dst_unused:UNUSED_PAD src0_sel:DWORD src1_sel:WORD_1
    s_mov_b64 exec, s[64:65]
    ds_add_rtn_u32 v88, v88, v42 offset:128
    s_mov_b64 exec, s[66:67]
    ds_add_rtn_u32 v89, v89, v42 offset:128
    s_mov_b64 exec, s[68:69]
    ds_add_rtn_u32 v90, v90, v42 offset:128
    s_mov_b64 exec, s[70:71]
    ds_add_rtn_u32 v91, v91, v42 offset:128
    s_mov_b64 exec, vcc
    ds_write_b32 v5, v6 offset:20
    s_waitcnt lgkmcnt(0)
    s_mov_b64 exec, s[64:65]
    ds_write_b16 v88, v72
    s_mov_b64 exec, s[66:67]
    ds_write_b16 v89, v73
    s_mov_b64 exec, s[68:69]
    ds_write_b16 v90, v74
    s_mov_b64 exec, s[70:71]
    ds_write_b16 v91, v75
L_secdone_21:
    s_not_b64 exec, s[74:75]
    s_cbranch_scc0 L_secdone_25
    s_waitcnt vmcnt(4)
L_sec_24:
    v_xor_b32 v76, s44, v60
    v_xor_b32 v77, s45, v61
    v_xor_b32 v78, s46, v62
    v_xor_b32 v79, s47, v63
    v_or3_b32 v40, v76, v77, v78
    v_or_b32 v40, v40, v79
    v_cmp_le_u32 vcc, 0x400000, v40
    s_cbranch_vccnz L_retry_27
    v_and_b32 v40, 2031616, v79
    v_cmp_eq_u32 vcc, 2031616, v40
    v_cmp_gt_u32 s[64:65], s16, v76
    v_lshlrev_b32_sdwa v92, 2, v76 dst_sel:DWORD dst_unused:UNUSED_PAD src0_sel:DWORD src1_sel:WORD_1
    v_cmp_gt_u32 s[66:67], s16, v77
    v_lshlrev_b32_sdwa v93, 2, v77 dst_sel:DWORD dst_unused:UNUSED_PAD src0_sel:DWORD src1_sel:WORD_1
    v_cmp_gt_u32 s[68:69], s16, v78
    v_lshlrev_b32_sdwa v94, 2, v78 dst_sel:DWORD dst_unused:UNUSED_PAD src0_sel:DWORD src1_sel:WORD_1
    v_cmp_gt_u32 s[70:71], s16, v79
    v_lshlrev_b32_sdwa v95, 2, v79 dst_sel:DWORD dst_unused:UNUSED_PAD src0_sel:DWORD src1_sel:WORD_1
    s_mov_b64 exec, s[64:65]
    ds_add_rtn_u32 v92, v92, v42 offset:128
    s_mov_b64 exec, s[66:67]
    ds_add_rtn_u32 v93, v93, v42 offset:128
    s_mov_b64 exec, s[68:69]
    ds_add_rtn_u32 v94, v94, v42 offset:128
    s_mov_b64 exec, s[70:71]
    ds_add_rtn_u32 v95, v95, v42 offset:128
    s_mov_b64 exec, vcc
    ds_write_b32 v5, v6 offset:20
    s_waitcnt lgkmcnt(0)
    s_mov_b64 exec, s[64:65]
    ds_write_b16 v92, v76
    s_mov_b64 exec, s[66:67]
    ds_write_b16 v93, v77
    s_mov_b64 exec, s[68:69]
    ds_write_b16 v94, v78
    s_mov_b64 exec, s[70:71]
    ds_write_b16 v95, v79
L_secdone_25:
    s_waitcnt lgkmcnt(0)
    s_mov_b64 exec, 1
    ds_add_u32 v5, v6 offset:16
    s_mov_b64 exec, -1
    v_add_u32_dpp v9, v0, v7 row_newbcast:8 row_mask:0xf bank_mask:0xf
    buffer_load_dwordx4 v[240:243], v9, s[32:35], 0 offen offset:0
    buffer_load_dwordx4 v[244:247], v9, s[32:35], 0 offen offset:256
    v_add_u32_dpp v9, v0, v7 row_newbcast:9 row_mask:0xf bank_mask:0xf
    buffer_load_dwordx4 v[248:251], v9, s[32:35], 0 offen offset:0
    buffer_load_dwordx4 v[252:255], v9, s[32:35], 0 offen offset:256
    s_lshl_b32 s20, s31, 1
    s_add_u32 s21, s20, 1
    s_add_u32 s22, s20, 8
    s_add_u32 s23, s20, 9
    s_add_u32 s24, s31, 16
    v_add_u32 v47, -1, v3
    v_bfe_u32 v40, v47, 1, 1
    v_and_b32 v41, 1, v47
    v_lshl_add_u32 v40, v40, 3, v41
    v_add_u32 v40, s20, v40
    v_mov_b32 v41, s24
    v_cmp_ne_u32 vcc, 0, v3
    v_min_u32 v47, 19, v2
    v_mul_u32_u24 v46, 264, v47
    v_cndmask_b32 v40, v41, v40, vcc
    v_mul_u32_u24 v41, 264, v40
    v_add_u32 v41, 148480, v41
    v_lshlrev_b32 v40, 2, v40
    v_add_u32 v46, 148728, v46
    v_lshlrev_b32 v47, 2, v47
    v_lshlrev_b32 v43, 3, v3
    v_lshl_add_u32 v43, v4, 1, v43
L_spin_28:
    ds_read_b32 v44, v5 offset:16
    s_waitcnt lgkmcnt(0)
    v_readfirstlane_b32 s101, v44
    s_cmp_ge_u32 s101, 4
    s_cbranch_scc0 L_retry_29
    ds_read_b32 v44, v40 offset:128
    ds_read_b32 v47, v47 offset:128
    ds_read_b32 v45, v5 offset:20
    s_waitcnt lgkmcnt(2)
    v_sub_u32 v44, v44, v41
    v_max_u32 v44, 18, v44
    s_waitcnt lgkmcnt(0)
    v_cmp_gt_u32 vcc, v47, v46
    v_add_u32_dpp v48, v44, v44 row_shr:1 row_mask:0xf bank_mask:0xf bound_ctrl:1
    v_readfirstlane_b32 s25, v45
    s_or_b32 s64, vcc_lo, vcc_hi
    v_add_u32_dpp v48, v48, v48 row_shr:2 row_mask:0xf bank_mask:0xf bound_ctrl:1
    s_or_b32 s25, s25, s64
    s_mov_b32 s53, 0
    v_add_u32_dpp v48, v48, v48 row_shr:4 row_mask:0xf bank_mask:0xf bound_ctrl:1
    v_sub_u32 v44, v48, v44
    v_sub_u32 v44, v41, v44
    v_readlane_b32 s10, v48, 0
    v_readlane_b32 s11, v48, 1
    v_readlane_b32 s12, v48, 2
    v_readlane_b32 s13, v48, 3
    v_readlane_b32 s14, v48, 4
    v_add_u32_dpp v160, v44, v43 row_newbcast:0 row_mask:0xf bank_mask:0xf
    v_add_u32_dpp v161, v44, v43 row_newbcast:1 row_mask:0xf bank_mask:0xf
    v_add_u32_dpp v162, v44, v43 row_newbcast:2 row_mask:0xf bank_mask:0xf
    v_add_u32_dpp v163, v44, v43 row_newbcast:3 row_mask:0xf bank_mask:0xf
    v_add_u32_dpp v164, v44, v43 row_newbcast:4 row_mask:0xf bank_mask:0xf
    s_add_u32 s50, s14, 14
    s_lshr_b32 s50, s50, 4
    s_cmp_gt_u32 s50, 32
    s_cselect_b32 s25, 1, s25
    s_max_u32 s50, s50, 12
    v_add_u32 v40, 0, v43
    v_cmp_le_u32 s[64:65], s10, v40
    v_cmp_le_u32 s[66:67], s11, v40
    v_cmp_le_u32 s[68:69], s12, v40
    v_cmp_le_u32 s[70:71], s13, v40
    v_cndmask_b32 v40, v160, v161, s[64:65]
    v_cndmask_b32 v40, v40, v162, s[66:67]
    v_cndmask_b32 v40, v40, v163, s[68:69]
    v_cndmask_b32 v40, v40, v164, s[70:71]
    ds_read_u16 v40, v40 offset:0
    v_add_u32 v41, 128, v43
    v_cmp_le_u32 s[64:65], s10, v41
    v_cmp_le_u32 s[66:67], s11, v41
    v_cmp_le_u32 s[68:69], s12, v41
    v_cmp_le_u32 s[70:71], s13, v41
    v_cndmask_b32 v41, v160, v161, s[64:65]
    v_cndmask_b32 v41, v41, v162, s[66:67]
    v_cndmask_b32 v41, v41, v163, s[68:69]
    v_cndmask_b32 v41, v41, v164, s[70:71]
    ds_read_u16 v41, v41 offset:128
    v_add_u32 v42, 256, v43
    v_cmp_le_u32 s[64:65], s10, v42
    v_cmp_le_u32 s[66:67], s11, v42
    v_cmp_le_u32 s[68:69], s12, v42
    v_cmp_le_u32 s[70:71], s13, v42
    v_cndmask_b32 v42, v160, v161, s[64:65]
    v_cndmask_b32 v42, v42, v162, s[66:67]
    v_cndmask_b32 v42, v42, v163, s[68:69]
    v_cndmask_b32 v42, v42, v164, s[70:71]
    ds_read_u16 v42, v42 offset:256
    v_add_u32 v43, 384, v43
    v_cmp_le_u32 s[64:65], s10, v43
    v_cmp_le_u32 s[66:67], s11, v43
    v_cmp_le_u32 s[68:69], s12, v43
    v_cmp_le_u32 s[70:71], s13, v43
    v_cndmask_b32 v43, v160, v161, s[64:65]
    v_cndmask_b32 v43, v43, v162, s[66:67]
    v_cndmask_b32 v43, v43, v163, s[68:69]
    v_cndmask_b32 v43, v43, v164, s[70:71]
    ds_read_u16 v43, v43 offset:384
    s_waitcnt lgkmcnt(3)
    v_and_b32 v32, 0x7ffe, v40
    ds_read_u16 v33, v32 offset:62464
    v_lshlrev_b32 v32, 8, v32
    v_lshlrev_b32 v40, 4, v40
    s_waitcnt lgkmcnt(3)
    v_and_b32 v34, 0x7ffe, v41
    ds_read_u16 v35, v34 offset:62464
    v_lshlrev_b32 v34, 8, v34
    v_lshlrev_b32 v41, 4, v41
    s_waitcnt lgkmcnt(3)
    v_and_b32 v36, 0x7ffe, v42
    ds_read_u16 v37, v36 offset:62464
    v_lshlrev_b32 v36, 8, v36
    v_lshlrev_b32 v42, 4, v42
    s_waitcnt lgkmcnt(3)
    v_and_b32 v38, 0x7ffe, v43
    ds_read_u16 v39, v38 offset:62464
    v_lshlrev_b32 v38, 8, v38
    v_lshlrev_b32 v43, 4, v43
    v_add_u32_dpp v11, v32, v7 row_newbcast:0 row_mask:0xf bank_mask:0xf
    buffer_load_dwordx4 v[48:51], v11, s[32:35], 0 offen offset:0
    buffer_load_dwordx4 v[56:59], v11, s[32:35], 0 offen offset:256
    v_add_u32_dpp v11, v32, v7 row_newbcast:1 row_mask:0xf bank_mask:0xf
    buffer_load_dwordx4 v[52:55], v11, s[32:35], 0 offen offset:0
    buffer_load_dwordx4 v[60:63], v11, s[32:35], 0 offen offset:256
    v_add_u32_dpp v11, v32, v7 row_newbcast:2 row_mask:0xf bank_mask:0xf
    buffer_load_dwordx4 v[64:67], v11, s[32:35], 0 offen offset:0
    buffer_load_dwordx4 v[72:75], v11, s[32:35], 0 offen offset:256
    v_add_u32_dpp v11, v32, v7 row_newbcast:3 row_mask:0xf bank_mask:0xf
    buffer_load_dwordx4 v[68:71], v11, s[32:35], 0 offen offset:0
    buffer_load_dwordx4 v[76:79], v11, s[32:35], 0 offen offset:256
    v_add_u32_dpp v11, v32, v7 row_newbcast:4 row_mask:0xf bank_mask:0xf
    buffer_load_dwordx4 v[80:83], v11, s[32:35], 0 offen offset:0
    buffer_load_dwordx4 v[88:91], v11, s[32:35], 0 offen offset:256
    v_add_u32_dpp v11, v32, v7 row_newbcast:5 row_mask:0xf bank_mask:0xf
    buffer_load_dwordx4 v[84:87], v11, s[32:35], 0 offen offset:0
    buffer_load_dwordx4 v[92:95], v11, s[32:35], 0 offen offset:256
    s_mov_b32 s57, 0
    s_sub_u32 s64, s14, 18
    s_lshr_b32 s65, s64, 4
    s_bitset1_b32 s53, s65
    s_and_b32 s64, s64, 14
    s_lshl4_add_u32 s57, s57, s64
    s_and_b32 s65, s24, 7
    s_lshl_b32 s65, s65, 5
    s_lshl_b32 s19, s24, 10
    s_or_b32 s19, s19, s65
    s_sub_u32 s64, s13, 18
    s_lshr_b32 s65, s64, 4
    s_bitset1_b32 s53, s65
    s_and_b32 s64, s64, 14
    s_lshl4_add_u32 s57, s57, s64
    s_and_b32 s65, s23, 7
    s_lshl_b32 s65, s65, 5
    s_lshl_b32 s18, s23, 10
    s_or_b32 s18, s18, s65
    s_sub_u32 s64, s12, 18
    s_lshr_b32 s65, s64, 4
    s_bitset1_b32 s53, s65
    s_and_b32 s64, s64, 14
    s_lshl4_add_u32 s57, s57, s64
    s_and_b32 s65, s22, 7
    s_lshl_b32 s65, s65, 5
    s_lshl_b32 s17, s22, 10
    s_or_b32 s17, s17, s65
    s_sub_u32 s64, s11, 18
    s_lshr_b32 s65, s64, 4
    s_bitset1_b32 s53, s65
    s_and_b32 s64, s64, 14
    s_lshl4_add_u32 s57, s57, s64
    s_and_b32 s65, s21, 7
    s_lshl_b32 s65, s65, 5
    s_lshl_b32 s16, s21, 10
    s_or_b32 s16, s16, s65
    s_sub_u32 s64, s10, 18
    s_lshr_b32 s65, s64, 4
    s_bitset1_b32 s53, s65
    s_and_b32 s64, s64, 14
    s_lshl4_add_u32 s57, s57, s64
    s_and_b32 s65, s20, 7
    s_lshl_b32 s65, s65, 5
    s_lshl_b32 s15, s20, 10
    s_or_b32 s15, s15, s65
    s_sub_u32 s64, s50, 5
    s_lshl_b32 s56, 1, s64
    s_or_b32 s52, s56, s53
    v_and_b32 v46, 1, v3
    v_lshl_add_u32 v46, v4, 1, v46
    v_and_b32 v46, 3, v46
    v_and_b32 v47, 14, v3
    v_lshl_add_u32 v46, v46, 4, v47
    v_lshrrev_b32 v47, 1, v4
    v_add_lshl_u32 v46, v46, v47, 2
    v_lshrrev_b32 v44, 1, v4
    v_mul_u32_u24 v44, 528, v44
    v_xor_b32 v44, v44, v7
    v_and_b32 v45, 1, v4
    v_lshl_or_b32 v2, v45, 3, v44
    v_xor_b32 v144, s15, v7
    v_xor_b32 v146, s16, v7
    v_xor_b32 v148, s19, v7
    v_xor_b32 v145, 528, v144
    v_xor_b32 v147, 528, v146
    v_xor_b32 v149, 528, v148
    s_mul_i32 s64, s1, 80
    s_add_u32 s64, s64, 62464
    v_and_b32 v45, 2, v4
    v_add_u32 v0, s64, v45
    s_getpc_b64 s[72:73]
L_anc:
    v_lshlrev_b32 v4, 2, v4
    s_mov_b32 s62, L_fp1-L_anc
    s_mov_b32 s63, L_fp1-L_fp0
    s_mov_b32 s70, L_dr1-L_anc
    s_mov_b32 s71, L_dr1-L_dr0
    s_mov_b32 s26, 0
    v_mov_b32 v1, 0
    s_lshl_b32 s64, s31, 2
    v_mov_b32 v10, s64
    v_and_b32 v9, 8, v3
    v_lshlrev_b32 v9, 1, v9
    s_mov_b32 s66, 0x22222222
    s_mov_b32 s67, 0x22222222
    s_mov_b32 s68, 0x44444444
    s_mov_b32 s69, 0x44444444
    v_mov_b64 v[150:151], 0
    v_mov_b64 v[152:153], 0
    v_mov_b64 v[154:155], 0
    v_mov_b64 v[156:157], 0
    v_mov_b64 v[158:159], 0
    v_mov_b64 v[16:17], 0
    v_mov_b64 v[18:19], 0
    v_mov_b64 v[20:21], 0
    v_mov_b64 v[22:23], 0
    s_waitcnt lgkmcnt(0)
    v_lshlrev_b32 v33, v40, v33
    ds_bpermute_b32 v33, v46, v33
    v_lshlrev_b32 v35, v41, v35
    ds_bpermute_b32 v35, v46, v35
    v_lshlrev_b32 v37, v42, v37
    ds_bpermute_b32 v37, v46, v37
    v_lshlrev_b32 v39, v43, v39
    ds_bpermute_b32 v39, v46, v39
    s_waitcnt vmcnt(12) lgkmcnt(0)
    s_barrier
    ds_read_b128 v[160:163], v144 offset:21504
    ds_read_b128 v[164:167], v144 offset:21760
    ds_read_b128 v[168:171], v145 offset:21504
    ds_read_b128 v[172:175], v145 offset:21760
    s_waitcnt lgkmcnt(2)
    v_dot2c_f32_bf16 v150, v176, v160
    v_dot2c_f32_bf16 v150, v177, v161
    v_dot2c_f32_bf16 v150, v178, v162
    v_dot2c_f32_bf16 v150, v179, v163
    v_dot2c_f32_bf16 v150, v180, v164
    v_dot2c_f32_bf16 v150, v181, v165
    v_dot2c_f32_bf16 v150, v182, v166
    v_dot2c_f32_bf16 v150, v183, v167
    ds_read_b128 v[160:163], v146 offset:21504
    ds_read_b128 v[164:167], v146 offset:21760
    s_waitcnt lgkmcnt(2)
    v_dot2c_f32_bf16 v151, v184, v168
    v_dot2c_f32_bf16 v151, v185, v169
    v_dot2c_f32_bf16 v151, v186, v170
    v_dot2c_f32_bf16 v151, v187, v171
    v_dot2c_f32_bf16 v151, v188, v172
    v_dot2c_f32_bf16 v151, v189, v173
    v_dot2c_f32_bf16 v151, v190, v174
    v_dot2c_f32_bf16 v151, v191, v175
    ds_read_b128 v[168:171], v147 offset:21504
    ds_read_b128 v[172:175], v147 offset:21760
    s_waitcnt lgkmcnt(2)
    v_dot2c_f32_bf16 v152, v192, v160
    v_dot2c_f32_bf16 v152, v193, v161
    v_dot2c_f32_bf16 v152, v194, v162
    v_dot2c_f32_bf16 v152, v195, v163
    v_dot2c_f32_bf16 v152, v196, v164
    v_dot2c_f32_bf16 v152, v197, v165
    v_dot2c_f32_bf16 v152, v198, v166
    v_dot2c_f32_bf16 v152, v199, v167
    v_add_f32_dpp v150, v150, v150 row_ror:8 row_mask:0xf bank_mask:0x3
    v_add_f32_dpp v150, v151, v151 row_ror:8 row_mask:0xf bank_mask:0xc
    ds_read_b128 v[160:163], v144 offset:29696
    ds_read_b128 v[164:167], v144 offset:29952
    s_waitcnt lgkmcnt(2)
    v_dot2c_f32_bf16 v153, v200, v168
    v_dot2c_f32_bf16 v153, v201, v169
    v_dot2c_f32_bf16 v153, v202, v170
    v_dot2c_f32_bf16 v153, v203, v171
    v_dot2c_f32_bf16 v153, v204, v172
    v_dot2c_f32_bf16 v153, v205, v173
    v_dot2c_f32_bf16 v153, v206, v174
    v_dot2c_f32_bf16 v153, v207, v175
    ds_read_b128 v[168:171], v145 offset:29696
    ds_read_b128 v[172:175], v145 offset:29952
    s_waitcnt lgkmcnt(2)
    v_dot2c_f32_bf16 v154, v208, v160
    v_dot2c_f32_bf16 v154, v209, v161
    v_dot2c_f32_bf16 v154, v210, v162
    v_dot2c_f32_bf16 v154, v211, v163
    v_dot2c_f32_bf16 v154, v212, v164
    v_dot2c_f32_bf16 v154, v213, v165
    v_dot2c_f32_bf16 v154, v214, v166
    v_dot2c_f32_bf16 v154, v215, v167
    v_add_f32_dpp v152, v152, v152 row_ror:8 row_mask:0xf bank_mask:0x3
    v_add_f32_dpp v152, v153, v153 row_ror:8 row_mask:0xf bank_mask:0xc
    v_add_u32_dpp v11, v32, v7 row_newbcast:6 row_mask:0xf bank_mask:0xf
    buffer_load_dwordx4 v[96:99], v11, s[32:35], 0 offen offset:0
    buffer_load_dwordx4 v[104:107], v11, s[32:35], 0 offen offset:256
    ds_read_b128 v[160:163], v146 offset:29696
    ds_read_b128 v[164:167], v146 offset:29952
    s_waitcnt lgkmcnt(2)
    v_dot2c_f32_bf16 v155, v216, v168
    v_dot2c_f32_bf16 v155, v217, v169
    v_dot2c_f32_bf16 v155, v218, v170
    v_dot2c_f32_bf16 v155, v219, v171
    v_dot2c_f32_bf16 v155, v220, v172
    v_dot2c_f32_bf16 v155, v221, v173
    v_dot2c_f32_bf16 v155, v222, v174
    v_dot2c_f32_bf16 v155, v223, v175
    v_add_f32_dpp v150, v150, v150 row_half_mirror row_mask:0xf bank_mask:0x5
    v_add_f32_dpp v150, v152, v152 row_half_mirror row_mask:0xf bank_mask:0xa
    v_add_u32_dpp v11, v32, v7 row_newbcast:7 row_mask:0xf bank_mask:0xf
    buffer_load_dwordx4 v[100:103], v11, s[32:35], 0 offen offset:0
    buffer_load_dwordx4 v[108:111], v11, s[32:35], 0 offen offset:256
    ds_read_b128 v[168:171], v147 offset:29696
    ds_read_b128 v[172:175], v147 offset:29952
    s_waitcnt lgkmcnt(2)
    v_dot2c_f32_bf16 v156, v224, v160
    v_dot2c_f32_bf16 v156, v225, v161
    v_dot2c_f32_bf16 v156, v226, v162
    v_dot2c_f32_bf16 v156, v227, v163
    v_dot2c_f32_bf16 v156, v228, v164
    v_dot2c_f32_bf16 v156, v229, v165
    v_dot2c_f32_bf16 v156, v230, v166
    v_dot2c_f32_bf16 v156, v231, v167
    v_add_f32_dpp v154, v154, v154 row_ror:8 row_mask:0xf bank_mask:0x3
    v_add_f32_dpp v154, v155, v155 row_ror:8 row_mask:0xf bank_mask:0xc
    v_add_u32_dpp v11, v32, v7 row_newbcast:8 row_mask:0xf bank_mask:0xf
    buffer_load_dwordx4 v[112:115], v11, s[32:35], 0 offen offset:0
    buffer_load_dwordx4 v[120:123], v11, s[32:35], 0 offen offset:256
    ds_read_b128 v[160:163], v148 offset:21504
    ds_read_b128 v[164:167], v148 offset:21760
    s_waitcnt lgkmcnt(2)
    v_dot2c_f32_bf16 v157, v232, v168
    v_dot2c_f32_bf16 v157, v233, v169
    v_dot2c_f32_bf16 v157, v234, v170
    v_dot2c_f32_bf16 v157, v235, v171
    v_dot2c_f32_bf16 v157, v236, v172
    v_dot2c_f32_bf16 v157, v237, v173
    v_dot2c_f32_bf16 v157, v238, v174
    v_dot2c_f32_bf16 v157, v239, v175
    v_add_u32_dpp v11, v32, v7 row_newbcast:9 row_mask:0xf bank_mask:0xf
    buffer_load_dwordx4 v[116:119], v11, s[32:35], 0 offen offset:0
    buffer_load_dwordx4 v[124:127], v11, s[32:35], 0 offen offset:256
    ds_read_b128 v[168:171], v149 offset:21504
    ds_read_b128 v[172:175], v149 offset:21760
    s_waitcnt lgkmcnt(2)
    v_dot2c_f32_bf16 v158, v240, v160
    v_dot2c_f32_bf16 v158, v241, v161
    v_dot2c_f32_bf16 v158, v242, v162
    v_dot2c_f32_bf16 v158, v243, v163
    v_dot2c_f32_bf16 v158, v244, v164
    v_dot2c_f32_bf16 v158, v245, v165
    v_dot2c_f32_bf16 v158, v246, v166
    v_dot2c_f32_bf16 v158, v247, v167
    v_add_f32_dpp v156, v156, v156 row_ror:8 row_mask:0xf bank_mask:0x3
    v_add_f32_dpp v156, v157, v157 row_ror:8 row_mask:0xf bank_mask:0xc
    v_add_u32_dpp v11, v32, v7 row_newbcast:10 row_mask:0xf bank_mask:0xf
    buffer_load_dwordx4 v[128:131], v11, s[32:35], 0 offen offset:0
    buffer_load_dwordx4 v[136:139], v11, s[32:35], 0 offen offset:256
    s_waitcnt lgkmcnt(0)
    v_dot2c_f32_bf16 v159, v248, v168
    v_dot2c_f32_bf16 v159, v249, v169
    v_dot2c_f32_bf16 v159, v250, v170
    v_dot2c_f32_bf16 v159, v251, v171
    v_dot2c_f32_bf16 v159, v252, v172
    v_dot2c_f32_bf16 v159, v253, v173
    v_dot2c_f32_bf16 v159, v254, v174
    v_dot2c_f32_bf16 v159, v255, v175
    v_add_f32_dpp v154, v154, v154 row_half_mirror row_mask:0xf bank_mask:0x5
    v_add_f32_dpp v154, v156, v156 row_half_mirror row_mask:0xf bank_mask:0xa
    v_add_u32_dpp v11, v32, v7 row_newbcast:11 row_mask:0xf bank_mask:0xf
    buffer_load_dwordx4 v[132:135], v11, s[32:35], 0 offen offset:0
    buffer_load_dwordx4 v[140:143], v11, s[32:35], 0 offen offset:256
    v_add_f32_dpp v150, v150, v150 quad_perm:[1,0,3,2] row_mask:0xf bank_mask:0xf
    s_nop 0
    v_add_f32_dpp v158, v158, v158 row_ror:8 row_mask:0xf bank_mask:0x3
    v_add_f32_dpp v158, v159, v159 row_ror:8 row_mask:0xf bank_mask:0xc
    v_add_f32_dpp v154, v154, v154 quad_perm:[1,0,3,2] row_mask:0xf bank_mask:0xf
    v_add_f32_dpp v150, v150, v150 quad_perm:[2,3,0,1] row_mask:0xf bank_mask:0xf
    v_add_f32_dpp v158, v158, v158 row_half_mirror row_mask:0xf bank_mask:0x5
    v_add_f32_dpp v154, v154, v154 quad_perm:[2,3,0,1] row_mask:0xf bank_mask:0xf
    s_nop 0
    v_add_f32_dpp v158, v158, v158 quad_perm:[1,0,3,2] row_mask:0xf bank_mask:0xf
    v_cndmask_b32 v150, v150, v154, s[66:67]
    s_nop 0
    v_add_f32_dpp v158, v158, v158 quad_perm:[2,3,0,1] row_mask:0xf bank_mask:0xf
    v_cndmask_b32 v150, v150, v158, s[68:69]
    v_mul_f32 v150, 0x3db8aa3b, v150
    v_exp_f32 v150, v150
    s_nop 0
    v_mov_b32 v44, v150
    v_mov_b32 v45, v150
    s_nop 1
    v_permlane32_swap_b32 v44, v45
    v_add_f32 v44, v44, v45
    v_mov_b32 v45, v44
    s_nop 1
    v_permlane16_swap_b32 v44, v45
    v_add_f32 v44, v44, v45
    v_add_f32 v44, 0x3089705f, v44
    v_rcp_f32 v44, v44
    s_nop 0
    v_mul_f32 v150, v150, v44
    v_cvt_pk_bf16_f32 v150, v150, 0
    v_lshlrev_b32 v8, v9, v150
    s_nop 1
    v_and_b32_dpp v24, v8, v12 row_newbcast:0 row_mask:0xf bank_mask:0xf
    v_and_b32_dpp v25, v8, v13 row_newbcast:0 row_mask:0xf bank_mask:0xf
    v_mov_b64 v[40:41], 0
    v_mov_b64 v[42:43], 0
    v_mov_b64 v[44:45], 0
    v_mov_b64 v[46:47], 0
    v_smfmac_f32_16x16x32_bf16 v[40:43], v[24:25], v[176:179], v14
    v_and_b32_dpp v28, v8, v12 row_newbcast:8 row_mask:0xf bank_mask:0xf
    v_and_b32_dpp v29, v8, v13 row_newbcast:8 row_mask:0xf bank_mask:0xf
    v_smfmac_f32_16x16x32_bf16 v[44:47], v[24:25], v[180:183], v14
    v_add_u32_dpp v11, v32, v7 row_newbcast:12 row_mask:0xf bank_mask:0xf
    buffer_load_dwordx4 v[144:147], v11, s[32:35], 0 offen offset:0
    buffer_load_dwordx4 v[152:155], v11, s[32:35], 0 offen offset:256
    v_smfmac_f32_16x16x32_bf16 v[40:43], v[28:29], v[184:187], v14
    v_and_b32_dpp v24, v8, v12 row_newbcast:4 row_mask:0xf bank_mask:0xf
    v_and_b32_dpp v25, v8, v13 row_newbcast:4 row_mask:0xf bank_mask:0xf
    v_smfmac_f32_16x16x32_bf16 v[44:47], v[28:29], v[188:191], v14
    s_nop 0
    v_smfmac_f32_16x16x32_bf16 v[16:19], v[24:25], v[192:195], v14
    v_and_b32_dpp v28, v8, v12 row_newbcast:12 row_mask:0xf bank_mask:0xf
    v_and_b32_dpp v29, v8, v13 row_newbcast:12 row_mask:0xf bank_mask:0xf
    v_smfmac_f32_16x16x32_bf16 v[20:23], v[24:25], v[196:199], v14
    v_add_u32_dpp v11, v32, v7 row_newbcast:13 row_mask:0xf bank_mask:0xf
    buffer_load_dwordx4 v[148:151], v11, s[32:35], 0 offen offset:0
    buffer_load_dwordx4 v[156:159], v11, s[32:35], 0 offen offset:256
    v_smfmac_f32_16x16x32_bf16 v[16:19], v[28:29], v[200:203], v14
    v_and_b32_dpp v24, v8, v12 row_newbcast:1 row_mask:0xf bank_mask:0xf
    v_and_b32_dpp v25, v8, v13 row_newbcast:1 row_mask:0xf bank_mask:0xf
    v_smfmac_f32_16x16x32_bf16 v[20:23], v[28:29], v[204:207], v14
    v_xor_b32 v178, s15, v2
    s_lshl_b32 s64, s20, 2
    v_add_u32 v9, s64, v0
    v_mov_b32 v179, 0
    v_cvt_pk_bf16_f32 v30, v40, v41
    v_cvt_pk_bf16_f32 v31, v42, v43
    ds_write_b64 v178, v[30:31] offset:1024
    v_cvt_pk_bf16_f32 v30, v44, v45
    v_cvt_pk_bf16_f32 v31, v46, v47
    ds_write_b64 v178, v[30:31] offset:1280
    ds_read_u16_d16_hi v179, v9
    v_mov_b64 v[40:41], 0
    v_mov_b64 v[42:43], 0
    v_mov_b64 v[44:45], 0
    v_mov_b64 v[46:47], 0
    s_nop 0
    v_smfmac_f32_16x16x32_bf16 v[40:43], v[24:25], v[208:211], v14
    v_and_b32_dpp v28, v8, v12 row_newbcast:9 row_mask:0xf bank_mask:0xf
    v_and_b32_dpp v29, v8, v13 row_newbcast:9 row_mask:0xf bank_mask:0xf
    v_smfmac_f32_16x16x32_bf16 v[44:47], v[24:25], v[212:215], v14
    v_add_u32_dpp v11, v32, v7 row_newbcast:14 row_mask:0xf bank_mask:0xf
    buffer_load_dwordx4 v[160:163], v11, s[32:35], 0 offen offset:0
    buffer_load_dwordx4 v[168:171], v11, s[32:35], 0 offen offset:256
    v_smfmac_f32_16x16x32_bf16 v[40:43], v[28:29], v[216:219], v14
    v_and_b32_dpp v24, v8, v12 row_newbcast:5 row_mask:0xf bank_mask:0xf
    v_and_b32_dpp v25, v8, v13 row_newbcast:5 row_mask:0xf bank_mask:0xf
    v_smfmac_f32_16x16x32_bf16 v[44:47], v[28:29], v[220:223], v14
    v_xor_b32 v180, s16, v2
    s_lshl_b32 s64, s21, 2
    v_add_u32 v9, s64, v0
    v_mov_b32 v181, 0
    v_cvt_pk_bf16_f32 v30, v16, v17
    v_cvt_pk_bf16_f32 v31, v18, v19
    ds_write_b64 v180, v[30:31] offset:1024
    v_cvt_pk_bf16_f32 v30, v20, v21
    v_cvt_pk_bf16_f32 v31, v22, v23
    ds_write_b64 v180, v[30:31] offset:1280
    ds_read_u16_d16_hi v181, v9
    v_mov_b64 v[16:17], 0
    v_mov_b64 v[18:19], 0
    v_mov_b64 v[20:21], 0
    v_mov_b64 v[22:23], 0
    s_nop 0
    v_smfmac_f32_16x16x32_bf16 v[16:19], v[24:25], v[224:227], v14
    v_and_b32_dpp v28, v8, v12 row_newbcast:13 row_mask:0xf bank_mask:0xf
    v_and_b32_dpp v29, v8, v13 row_newbcast:13 row_mask:0xf bank_mask:0xf
    v_smfmac_f32_16x16x32_bf16 v[20:23], v[24:25], v[228:231], v14
    v_add_u32_dpp v11, v32, v7 row_newbcast:15 row_mask:0xf bank_mask:0xf
    buffer_load_dwordx4 v[164:167], v11, s[32:35], 0 offen offset:0
    buffer_load_dwordx4 v[172:175], v11, s[32:35], 0 offen offset:256
    v_smfmac_f32_16x16x32_bf16 v[16:19], v[28:29], v[232:235], v14
    v_and_b32_dpp v24, v8, v12 row_newbcast:2 row_mask:0xf bank_mask:0xf
    v_and_b32_dpp v25, v8, v13 row_newbcast:2 row_mask:0xf bank_mask:0xf
    v_smfmac_f32_16x16x32_bf16 v[20:23], v[28:29], v[236:239], v14
    v_xor_b32 v182, s17, v2
    s_lshl_b32 s64, s22, 2
    v_add_u32 v9, s64, v0
    v_mov_b32 v183, 0
    v_cvt_pk_bf16_f32 v30, v40, v41
    v_cvt_pk_bf16_f32 v31, v42, v43
    ds_write_b64 v182, v[30:31] offset:1024
    v_cvt_pk_bf16_f32 v30, v44, v45
    v_cvt_pk_bf16_f32 v31, v46, v47
    ds_write_b64 v182, v[30:31] offset:1280
    ds_read_u16_d16_hi v183, v9
    v_mov_b64 v[40:41], 0
    v_mov_b64 v[42:43], 0
    v_mov_b64 v[44:45], 0
    v_mov_b64 v[46:47], 0
    s_nop 0
    v_smfmac_f32_16x16x32_bf16 v[40:43], v[24:25], v[240:243], v14
    v_and_b32_dpp v28, v8, v12 row_newbcast:10 row_mask:0xf bank_mask:0xf
    v_and_b32_dpp v29, v8, v13 row_newbcast:10 row_mask:0xf bank_mask:0xf
    v_smfmac_f32_16x16x32_bf16 v[44:47], v[24:25], v[244:247], v14
    s_nop 0
    v_smfmac_f32_16x16x32_bf16 v[40:43], v[28:29], v[248:251], v14
    v_and_b32_dpp v24, v33, v12 row_newbcast:0 row_mask:0xf bank_mask:0xf
    v_and_b32_dpp v25, v33, v13 row_newbcast:0 row_mask:0xf bank_mask:0xf
    v_and_b32_dpp v26, v33, v12 row_newbcast:1 row_mask:0xf bank_mask:0xf
    v_and_b32_dpp v27, v33, v13 row_newbcast:1 row_mask:0xf bank_mask:0xf
    v_smfmac_f32_16x16x32_bf16 v[44:47], v[28:29], v[252:255], v14
    v_xor_b32 v184, s18, v2
    s_lshl_b32 s64, s23, 2
    v_add_u32 v9, s64, v0
    v_mov_b32 v185, 0
    v_cvt_pk_bf16_f32 v30, v16, v17
    v_cvt_pk_bf16_f32 v31, v18, v19
    ds_write_b64 v184, v[30:31] offset:1024
    v_cvt_pk_bf16_f32 v30, v20, v21
    v_cvt_pk_bf16_f32 v31, v22, v23
    ds_write_b64 v184, v[30:31] offset:1280
    ds_read_u16_d16_hi v185, v9
    v_mov_b64 v[16:17], 0
    v_mov_b64 v[18:19], 0
    v_mov_b64 v[20:21], 0
    v_mov_b64 v[22:23], 0
    s_nop 0
    v_xor_b32 v176, s19, v2
    s_lshl_b32 s64, s24, 2
    v_add_u32 v9, s64, v0
    v_mov_b32 v177, 0
    v_cvt_pk_bf16_f32 v30, v40, v41
    v_cvt_pk_bf16_f32 v31, v42, v43
    ds_write_b64 v176, v[30:31] offset:1024
    v_cvt_pk_bf16_f32 v30, v44, v45
    v_cvt_pk_bf16_f32 v31, v46, v47
    ds_write_b64 v176, v[30:31] offset:1280
    ds_read_u16_d16_hi v177, v9
    s_waitcnt lgkmcnt(0)
    s_barrier
    s_cmp_lg_u32 s25, 0
    s_cbranch_scc1 L_slow
L_fp0:
    s_bitcmp1_b32 s52, 0
    s_waitcnt vmcnt(28)
    v_smfmac_f32_16x16x64_bf16 v[16:19], v[24:27], v[48:55], v14
    v_and_b32_dpp v28, v33, v12 row_newbcast:2 row_mask:0xf bank_mask:0xf
    v_and_b32_dpp v29, v33, v13 row_newbcast:2 row_mask:0xf bank_mask:0xf
    v_smfmac_f32_16x16x64_bf16 v[20:23], v[24:27], v[56:63], v14
    v_and_b32_dpp v30, v33, v12 row_newbcast:3 row_mask:0xf bank_mask:0xf
    v_and_b32_dpp v31, v33, v13 row_newbcast:3 row_mask:0xf bank_mask:0xf
    v_add_u32_dpp v11, v34, v7 row_newbcast:0 row_mask:0xf bank_mask:0xf
    buffer_load_dwordx4 v[48:51], v11, s[32:35], 0 offen offset:0
    buffer_load_dwordx4 v[56:59], v11, s[32:35], 0 offen offset:256
    s_cbranch_scc1 L_ev0
L_fp1:
    s_bitcmp1_b32 s52, 1
    s_waitcnt vmcnt(26)
    v_smfmac_f32_16x16x64_bf16 v[16:19], v[28:31], v[64:71], v14
    v_and_b32_dpp v24, v33, v12 row_newbcast:4 row_mask:0xf bank_mask:0xf
    v_and_b32_dpp v25, v33, v13 row_newbcast:4 row_mask:0xf bank_mask:0xf
    v_smfmac_f32_16x16x64_bf16 v[20:23], v[28:31], v[72:79], v14
    v_and_b32_dpp v26, v33, v12 row_newbcast:5 row_mask:0xf bank_mask:0xf
    v_and_b32_dpp v27, v33, v13 row_newbcast:5 row_mask:0xf bank_mask:0xf
    v_add_u32_dpp v11, v34, v7 row_newbcast:1 row_mask:0xf bank_mask:0xf
    buffer_load_dwordx4 v[52:55], v11, s[32:35], 0 offen offset:0
    buffer_load_dwordx4 v[60:63], v11, s[32:35], 0 offen offset:256
    s_cbranch_scc1 L_ev1
L_fp2:
    s_bitcmp1_b32 s52, 2
    s_waitcnt vmcnt(24)
    v_smfmac_f32_16x16x64_bf16 v[16:19], v[24:27], v[80:87], v14
    v_and_b32_dpp v28, v33, v12 row_newbcast:6 row_mask:0xf bank_mask:0xf
    v_and_b32_dpp v29, v33, v13 row_newbcast:6 row_mask:0xf bank_mask:0xf
    v_smfmac_f32_16x16x64_bf16 v[20:23], v[24:27], v[88:95], v14
    v_and_b32_dpp v30, v33, v12 row_newbcast:7 row_mask:0xf bank_mask:0xf
    v_and_b32_dpp v31, v33, v13 row_newbcast:7 row_mask:0xf bank_mask:0xf
    v_add_u32_dpp v11, v34, v7 row_newbcast:2 row_mask:0xf bank_mask:0xf
    buffer_load_dwordx4 v[64:67], v11, s[32:35], 0 offen offset:0
    buffer_load_dwordx4 v[72:75], v11, s[32:35], 0 offen offset:256
    s_cbranch_scc1 L_ev2
L_fp3:
    s_bitcmp1_b32 s52, 3
    s_waitcnt vmcnt(22)
    v_smfmac_f32_16x16x64_bf16 v[16:19], v[28:31], v[96:103], v14
    v_and_b32_dpp v24, v33, v12 row_newbcast:8 row_mask:0xf bank_mask:0xf
    v_and_b32_dpp v25, v33, v13 row_newbcast:8 row_mask:0xf bank_mask:0xf
    v_smfmac_f32_16x16x64_bf16 v[20:23], v[28:31], v[104:111], v14
    v_and_b32_dpp v26, v33, v12 row_newbcast:9 row_mask:0xf bank_mask:0xf
    v_and_b32_dpp v27, v33, v13 row_newbcast:9 row_mask:0xf bank_mask:0xf
    v_add_u32_dpp v11, v34, v7 row_newbcast:3 row_mask:0xf bank_mask:0xf
    buffer_load_dwordx4 v[68:71], v11, s[32:35], 0 offen offset:0
    buffer_load_dwordx4 v[76:79], v11, s[32:35], 0 offen offset:256
    s_cbranch_scc1 L_ev3
L_fp4:
    s_bitcmp1_b32 s52, 4
    s_waitcnt vmcnt(20)
    v_smfmac_f32_16x16x64_bf16 v[16:19], v[24:27], v[112:119], v14
    v_and_b32_dpp v28, v33, v12 row_newbcast:10 row_mask:0xf bank_mask:0xf
    v_and_b32_dpp v29, v33, v13 row_newbcast:10 row_mask:0xf bank_mask:0xf
    v_smfmac_f32_16x16x64_bf16 v[20:23], v[24:27], v[120:127], v14
    v_and_b32_dpp v30, v33, v12 row_newbcast:11 row_mask:0xf bank_mask:0xf
    v_and_b32_dpp v31, v33, v13 row_newbcast:11 row_mask:0xf bank_mask:0xf
    v_add_u32_dpp v11, v34, v7 row_newbcast:4 row_mask:0xf bank_mask:0xf
    buffer_load_dwordx4 v[80:83], v11, s[32:35], 0 offen offset:0
    buffer_load_dwordx4 v[88:91], v11, s[32:35], 0 offen offset:256
    s_cbranch_scc1 L_ev4
L_fp5:
    s_bitcmp1_b32 s52, 5
    s_waitcnt vmcnt(18)
    v_smfmac_f32_16x16x64_bf16 v[16:19], v[28:31], v[128:135], v14
    v_and_b32_dpp v24, v33, v12 row_newbcast:12 row_mask:0xf bank_mask:0xf
    v_and_b32_dpp v25, v33, v13 row_newbcast:12 row_mask:0xf bank_mask:0xf
    v_smfmac_f32_16x16x64_bf16 v[20:23], v[28:31], v[136:143], v14
    v_and_b32_dpp v26, v33, v12 row_newbcast:13 row_mask:0xf bank_mask:0xf
    v_and_b32_dpp v27, v33, v13 row_newbcast:13 row_mask:0xf bank_mask:0xf
    v_add_u32_dpp v11, v34, v7 row_newbcast:5 row_mask:0xf bank_mask:0xf
    buffer_load_dwordx4 v[84:87], v11, s[32:35], 0 offen offset:0
    buffer_load_dwordx4 v[92:95], v11, s[32:35], 0 offen offset:256
    s_cbranch_scc1 L_ev5
L_fp6:
    s_bitcmp1_b32 s52, 6
    s_waitcnt vmcnt(16)
    v_smfmac_f32_16x16x64_bf16 v[16:19], v[24:27], v[144:151], v14
    v_and_b32_dpp v28, v33, v12 row_newbcast:14 row_mask:0xf bank_mask:0xf
    v_and_b32_dpp v29, v33, v13 row_newbcast:14 row_mask:0xf bank_mask:0xf
    v_smfmac_f32_16x16x64_bf16 v[20:23], v[24:27], v[152:159], v14
    v_and_b32_dpp v30, v33, v12 row_newbcast:15 row_mask:0xf bank_mask:0xf
    v_and_b32_dpp v31, v33, v13 row_newbcast:15 row_mask:0xf bank_mask:0xf
    v_add_u32_dpp v11, v34, v7 row_newbcast:6 row_mask:0xf bank_mask:0xf
    buffer_load_dwordx4 v[96:99], v11, s[32:35], 0 offen offset:0
    buffer_load_dwordx4 v[104:107], v11, s[32:35], 0 offen offset:256
    s_cbranch_scc1 L_ev6
L_fp7:
    s_bitcmp1_b32 s52, 7
    s_waitcnt vmcnt(14)
    v_smfmac_f32_16x16x64_bf16 v[16:19], v[28:31], v[160:167], v14
    v_and_b32_dpp v24, v35, v12 row_newbcast:0 row_mask:0xf bank_mask:0xf
    v_and_b32_dpp v25, v35, v13 row_newbcast:0 row_mask:0xf bank_mask:0xf
    v_smfmac_f32_16x16x64_bf16 v[20:23], v[28:31], v[168:175], v14
    v_and_b32_dpp v26, v35, v12 row_newbcast:1 row_mask:0xf bank_mask:0xf
    v_and_b32_dpp v27, v35, v13 row_newbcast:1 row_mask:0xf bank_mask:0xf
    v_add_u32_dpp v11, v34, v7 row_newbcast:7 row_mask:0xf bank_mask:0xf
    buffer_load_dwordx4 v[100:103], v11, s[32:35], 0 offen offset:0
    buffer_load_dwordx4 v[108:111], v11, s[32:35], 0 offen offset:256
    s_cbranch_scc1 L_ev7
L_fp8:
    v_mov_b64 v[32:33], v[34:35]
    v_mov_b64 v[34:35], v[36:37]
    v_mov_b64 v[36:37], v[38:39]
    s_lshr_b32 s52, s52, 8
    s_lshr_b32 s53, s53, 8
    s_lshr_b32 s56, s56, 8
    s_mov_b32 s62, L_st1-L_anc
    s_mov_b32 s63, L_st1-L_st0
L_st0:
    s_bitcmp1_b32 s52, 0
    s_waitcnt vmcnt(12)
    v_smfmac_f32_16x16x64_bf16 v[16:19], v[24:27], v[48:55], v14
    v_and_b32_dpp v28, v33, v12 row_newbcast:2 row_mask:0xf bank_mask:0xf
    v_and_b32_dpp v29, v33, v13 row_newbcast:2 row_mask:0xf bank_mask:0xf
    v_smfmac_f32_16x16x64_bf16 v[20:23], v[24:27], v[56:63], v14
    v_and_b32_dpp v30, v33, v12 row_newbcast:3 row_mask:0xf bank_mask:0xf
    v_and_b32_dpp v31, v33, v13 row_newbcast:3 row_mask:0xf bank_mask:0xf
    v_add_u32_dpp v11, v32, v7 row_newbcast:8 row_mask:0xf bank_mask:0xf
    buffer_load_dwordx4 v[112:115], v11, s[32:35], 0 offen offset:0
    buffer_load_dwordx4 v[120:123], v11, s[32:35], 0 offen offset:256
    v_add_u32_dpp v11, v32, v7 row_newbcast:9 row_mask:0xf bank_mask:0xf
    buffer_load_dwordx4 v[116:119], v11, s[32:35], 0 offen offset:0
    buffer_load_dwordx4 v[124:127], v11, s[32:35], 0 offen offset:256
    s_cbranch_scc1 L_ev0
L_st1:
    s_bitcmp1_b32 s52, 1
    s_waitcnt vmcnt(12)
    v_smfmac_f32_16x16x64_bf16 v[16:19], v[28:31], v[64:71], v14
    v_and_b32_dpp v24, v33, v12 row_newbcast:4 row_mask:0xf bank_mask:0xf
    v_and_b32_dpp v25, v33, v13 row_newbcast:4 row_mask:0xf bank_mask:0xf
    v_smfmac_f32_16x16x64_bf16 v[20:23], v[28:31], v[72:79], v14
    v_and_b32_dpp v26, v33, v12 row_newbcast:5 row_mask:0xf bank_mask:0xf
    v_and_b32_dpp v27, v33, v13 row_newbcast:5 row_mask:0xf bank_mask:0xf
    v_add_u32_dpp v11, v32, v7 row_newbcast:10 row_mask:0xf bank_mask:0xf
    buffer_load_dwordx4 v[128:131], v11, s[32:35], 0 offen offset:0
    buffer_load_dwordx4 v[136:139], v11, s[32:35], 0 offen offset:256
    v_add_u32_dpp v11, v32, v7 row_newbcast:11 row_mask:0xf bank_mask:0xf
    buffer_load_dwordx4 v[132:135], v11, s[32:35], 0 offen offset:0
    buffer_load_dwordx4 v[140:143], v11, s[32:35], 0 offen offset:256
    s_cbranch_scc1 L_ev1
L_st2:
    s_bitcmp1_b32 s52, 2
    s_waitcnt vmcnt(12)
    v_smfmac_f32_16x16x64_bf16 v[16:19], v[24:27], v[80:87], v14
    v_and_b32_dpp v28, v33, v12 row_newbcast:6 row_mask:0xf bank_mask:0xf
    v_and_b32_dpp v29, v33, v13 row_newbcast:6 row_mask:0xf bank_mask:0xf
    v_smfmac_f32_16x16x64_bf16 v[20:23], v[24:27], v[88:95], v14
    v_and_b32_dpp v30, v33, v12 row_newbcast:7 row_mask:0xf bank_mask:0xf
    v_and_b32_dpp v31, v33, v13 row_newbcast:7 row_mask:0xf bank_mask:0xf
    v_add_u32_dpp v11, v32, v7 row_newbcast:12 row_mask:0xf bank_mask:0xf
    buffer_load_dwordx4 v[144:147], v11, s[32:35], 0 offen offset:0
    buffer_load_dwordx4 v[152:155], v11, s[32:35], 0 offen offset:256
    v_add_u32_dpp v11, v32, v7 row_newbcast:13 row_mask:0xf bank_mask:0xf
    buffer_load_dwordx4 v[148:151], v11, s[32:35], 0 offen offset:0
    buffer_load_dwordx4 v[156:159], v11, s[32:35], 0 offen offset:256
    s_cbranch_scc1 L_ev2
L_st3:
    s_bitcmp1_b32 s52, 3
    s_waitcnt vmcnt(12)
    v_smfmac_f32_16x16x64_bf16 v[16:19], v[28:31], v[96:103], v14
    v_and_b32_dpp v24, v33, v12 row_newbcast:8 row_mask:0xf bank_mask:0xf
    v_and_b32_dpp v25, v33, v13 row_newbcast:8 row_mask:0xf bank_mask:0xf
    v_smfmac_f32_16x16x64_bf16 v[20:23], v[28:31], v[104:111], v14
    v_and_b32_dpp v26, v33, v12 row_newbcast:9 row_mask:0xf bank_mask:0xf
    v_and_b32_dpp v27, v33, v13 row_newbcast:9 row_mask:0xf bank_mask:0xf
    v_add_u32_dpp v11, v32, v7 row_newbcast:14 row_mask:0xf bank_mask:0xf
    buffer_load_dwordx4 v[160:163], v11, s[32:35], 0 offen offset:0
    buffer_load_dwordx4 v[168:171], v11, s[32:35], 0 offen offset:256
    v_add_u32_dpp v11, v32, v7 row_newbcast:15 row_mask:0xf bank_mask:0xf
    buffer_load_dwordx4 v[164:167], v11, s[32:35], 0 offen offset:0
    buffer_load_dwordx4 v[172:175], v11, s[32:35], 0 offen offset:256
    s_cbranch_scc1 L_ev3
L_st4:
    s_bitcmp1_b32 s52, 4
    s_waitcnt vmcnt(12)
    v_smfmac_f32_16x16x64_bf16 v[16:19], v[24:27], v[112:119], v14
    v_and_b32_dpp v28, v33, v12 row_newbcast:10 row_mask:0xf bank_mask:0xf
    v_and_b32_dpp v29, v33, v13 row_newbcast:10 row_mask:0xf bank_mask:0xf
    v_smfmac_f32_16x16x64_bf16 v[20:23], v[24:27], v[120:127], v14
    v_and_b32_dpp v30, v33, v12 row_newbcast:11 row_mask:0xf bank_mask:0xf
    v_and_b32_dpp v31, v33, v13 row_newbcast:11 row_mask:0xf bank_mask:0xf
    v_add_u32_dpp v11, v34, v7 row_newbcast:0 row_mask:0xf bank_mask:0xf
    buffer_load_dwordx4 v[48:51], v11, s[32:35], 0 offen offset:0
    buffer_load_dwordx4 v[56:59], v11, s[32:35], 0 offen offset:256
    v_add_u32_dpp v11, v34, v7 row_newbcast:1 row_mask:0xf bank_mask:0xf
    buffer_load_dwordx4 v[52:55], v11, s[32:35], 0 offen offset:0
    buffer_load_dwordx4 v[60:63], v11, s[32:35], 0 offen offset:256
    s_cbranch_scc1 L_ev4
L_st5:
    s_bitcmp1_b32 s52, 5
    s_waitcnt vmcnt(12)
    v_smfmac_f32_16x16x64_bf16 v[16:19], v[28:31], v[128:135], v14
    v_and_b32_dpp v24, v33, v12 row_newbcast:12 row_mask:0xf bank_mask:0xf
    v_and_b32_dpp v25, v33, v13 row_newbcast:12 row_mask:0xf bank_mask:0xf
    v_smfmac_f32_16x16x64_bf16 v[20:23], v[28:31], v[136:143], v14
    v_and_b32_dpp v26, v33, v12 row_newbcast:13 row_mask:0xf bank_mask:0xf
    v_and_b32_dpp v27, v33, v13 row_newbcast:13 row_mask:0xf bank_mask:0xf
    v_add_u32_dpp v11, v34, v7 row_newbcast:2 row_mask:0xf bank_mask:0xf
    buffer_load_dwordx4 v[64:67], v11, s[32:35], 0 offen offset:0
    buffer_load_dwordx4 v[72:75], v11, s[32:35], 0 offen offset:256
    v_add_u32_dpp v11, v34, v7 row_newbcast:3 row_mask:0xf bank_mask:0xf
    buffer_load_dwordx4 v[68:71], v11, s[32:35], 0 offen offset:0
    buffer_load_dwordx4 v[76:79], v11, s[32:35], 0 offen offset:256
    s_cbranch_scc1 L_ev5
L_st6:
    s_bitcmp1_b32 s52, 6
    s_waitcnt vmcnt(12)
    v_smfmac_f32_16x16x64_bf16 v[16:19], v[24:27], v[144:151], v14
    v_and_b32_dpp v28, v33, v12 row_newbcast:14 row_mask:0xf bank_mask:0xf
    v_and_b32_dpp v29, v33, v13 row_newbcast:14 row_mask:0xf bank_mask:0xf
    v_smfmac_f32_16x16x64_bf16 v[20:23], v[24:27], v[152:159], v14
    v_and_b32_dpp v30, v33, v12 row_newbcast:15 row_mask:0xf bank_mask:0xf
    v_and_b32_dpp v31, v33, v13 row_newbcast:15 row_mask:0xf bank_mask:0xf
    v_add_u32_dpp v11, v34, v7 row_newbcast:4 row_mask:0xf bank_mask:0xf
    buffer_load_dwordx4 v[80:83], v11, s[32:35], 0 offen offset:0
    buffer_load_dwordx4 v[88:91], v11, s[32:35], 0 offen offset:256
    v_add_u32_dpp v11, v34, v7 row_newbcast:5 row_mask:0xf bank_mask:0xf
    buffer_load_dwordx4 v[84:87], v11, s[32:35], 0 offen offset:0
    buffer_load_dwordx4 v[92:95], v11, s[32:35], 0 offen offset:256
    s_cbranch_scc1 L_ev6
L_st7:
    s_bitcmp1_b32 s52, 7
    s_waitcnt vmcnt(12)
    v_smfmac_f32_16x16x64_bf16 v[16:19], v[28:31], v[160:167], v14
    v_and_b32_dpp v24, v35, v12 row_newbcast:0 row_mask:0xf bank_mask:0xf
    v_and_b32_dpp v25, v35, v13 row_newbcast:0 row_mask:0xf bank_mask:0xf
    v_smfmac_f32_16x16x64_bf16 v[20:23], v[28:31], v[168:175], v14
    v_and_b32_dpp v26, v35, v12 row_newbcast:1 row_mask:0xf bank_mask:0xf
    v_and_b32_dpp v27, v35, v13 row_newbcast:1 row_mask:0xf bank_mask:0xf
    v_add_u32_dpp v11, v34, v7 row_newbcast:6 row_mask:0xf bank_mask:0xf
    buffer_load_dwordx4 v[96:99], v11, s[32:35], 0 offen offset:0
    buffer_load_dwordx4 v[104:107], v11, s[32:35], 0 offen offset:256
    v_add_u32_dpp v11, v34, v7 row_newbcast:7 row_mask:0xf bank_mask:0xf
    buffer_load_dwordx4 v[100:103], v11, s[32:35], 0 offen offset:0
    buffer_load_dwordx4 v[108:111], v11, s[32:35], 0 offen offset:256
    s_cbranch_scc1 L_ev7
L_st8:
    v_mov_b64 v[32:33], v[34:35]
    v_mov_b64 v[34:35], v[36:37]
    v_mov_b64 v[36:37], v[38:39]
    s_lshr_b32 s52, s52, 8
    s_lshr_b32 s53, s53, 8
    s_lshr_b32 s56, s56, 8
    s_branch L_st0
L_pad8:
    s_setpc_b64 s[68:69]
L_dr0:
    s_bitcmp1_b32 s52, 0
    ds_write_b32 v10, v6 offset:48
    s_waitcnt vmcnt(12)
    v_smfmac_f32_16x16x64_bf16 v[16:19], v[24:27], v[48:55], v14
    v_and_b32_dpp v28, v33, v12 row_newbcast:2 row_mask:0xf bank_mask:0xf
    v_and_b32_dpp v29, v33, v13 row_newbcast:2 row_mask:0xf bank_mask:0xf
    v_smfmac_f32_16x16x64_bf16 v[20:23], v[24:27], v[56:63], v14
    v_and_b32_dpp v30, v33, v12 row_newbcast:3 row_mask:0xf bank_mask:0xf
    v_and_b32_dpp v31, v33, v13 row_newbcast:3 row_mask:0xf bank_mask:0xf
    buffer_load_ubyte v15, off, s[32:35], 0
    buffer_load_ubyte v15, off, s[32:35], 0
    buffer_load_ubyte v15, off, s[32:35], 0
    buffer_load_ubyte v15, off, s[32:35], 0
    s_cbranch_scc1 L_ev0
L_dr1:
    s_bitcmp1_b32 s52, 1
    ds_write_b32 v10, v6 offset:48
    s_waitcnt vmcnt(12)
    v_smfmac_f32_16x16x64_bf16 v[16:19], v[28:31], v[64:71], v14
    v_and_b32_dpp v24, v33, v12 row_newbcast:4 row_mask:0xf bank_mask:0xf
    v_and_b32_dpp v25, v33, v13 row_newbcast:4 row_mask:0xf bank_mask:0xf
    v_smfmac_f32_16x16x64_bf16 v[20:23], v[28:31], v[72:79], v14
    v_and_b32_dpp v26, v33, v12 row_newbcast:5 row_mask:0xf bank_mask:0xf
    v_and_b32_dpp v27, v33, v13 row_newbcast:5 row_mask:0xf bank_mask:0xf
    buffer_load_ubyte v15, off, s[32:35], 0
    buffer_load_ubyte v15, off, s[32:35], 0
    buffer_load_ubyte v15, off, s[32:35], 0
    buffer_load_ubyte v15, off, s[32:35], 0
    s_cbranch_scc1 L_ev1
L_dr2:
    s_bitcmp1_b32 s52, 2
    ds_write_b32 v10, v6 offset:48
    s_waitcnt vmcnt(12)
    v_smfmac_f32_16x16x64_bf16 v[16:19], v[24:27], v[80:87], v14
    v_and_b32_dpp v28, v33, v12 row_newbcast:6 row_mask:0xf bank_mask:0xf
    v_and_b32_dpp v29, v33, v13 row_newbcast:6 row_mask:0xf bank_mask:0xf
    v_smfmac_f32_16x16x64_bf16 v[20:23], v[24:27], v[88:95], v14
    v_and_b32_dpp v30, v33, v12 row_newbcast:7 row_mask:0xf bank_mask:0xf
    v_and_b32_dpp v31, v33, v13 row_newbcast:7 row_mask:0xf bank_mask:0xf
    buffer_load_ubyte v15, off, s[32:35], 0
    buffer_load_ubyte v15, off, s[32:35], 0
    buffer_load_ubyte v15, off, s[32:35], 0
    buffer_load_ubyte v15, off, s[32:35], 0
    s_cbranch_scc1 L_ev2
L_dr3:
    s_bitcmp1_b32 s52, 3
    ds_write_b32 v10, v6 offset:48
    s_waitcnt vmcnt(12)
    v_smfmac_f32_16x16x64_bf16 v[16:19], v[28:31], v[96:103], v14
    v_and_b32_dpp v24, v33, v12 row_newbcast:8 row_mask:0xf bank_mask:0xf
    v_and_b32_dpp v25, v33, v13 row_newbcast:8 row_mask:0xf bank_mask:0xf
    v_smfmac_f32_16x16x64_bf16 v[20:23], v[28:31], v[104:111], v14
    v_and_b32_dpp v26, v33, v12 row_newbcast:9 row_mask:0xf bank_mask:0xf
    v_and_b32_dpp v27, v33, v13 row_newbcast:9 row_mask:0xf bank_mask:0xf
    buffer_load_ubyte v15, off, s[32:35], 0
    buffer_load_ubyte v15, off, s[32:35], 0
    buffer_load_ubyte v15, off, s[32:35], 0
    buffer_load_ubyte v15, off, s[32:35], 0
    s_cbranch_scc1 L_ev3
L_dr4:
    s_bitcmp1_b32 s52, 4
    ds_write_b32 v10, v6 offset:48
    s_waitcnt vmcnt(12)
    v_smfmac_f32_16x16x64_bf16 v[16:19], v[24:27], v[112:119], v14
    v_and_b32_dpp v28, v33, v12 row_newbcast:10 row_mask:0xf bank_mask:0xf
    v_and_b32_dpp v29, v33, v13 row_newbcast:10 row_mask:0xf bank_mask:0xf
    v_smfmac_f32_16x16x64_bf16 v[20:23], v[24:27], v[120:127], v14
    v_and_b32_dpp v30, v33, v12 row_newbcast:11 row_mask:0xf bank_mask:0xf
    v_and_b32_dpp v31, v33, v13 row_newbcast:11 row_mask:0xf bank_mask:0xf
    buffer_load_ubyte v15, off, s[32:35], 0
    buffer_load_ubyte v15, off, s[32:35], 0
    buffer_load_ubyte v15, off, s[32:35], 0
    buffer_load_ubyte v15, off, s[32:35], 0
    s_cbranch_scc1 L_ev4
L_dr5:
    s_bitcmp1_b32 s52, 5
    ds_write_b32 v10, v6 offset:48
    s_waitcnt vmcnt(12)
    v_smfmac_f32_16x16x64_bf16 v[16:19], v[28:31], v[128:135], v14
    v_and_b32_dpp v24, v33, v12 row_newbcast:12 row_mask:0xf bank_mask:0xf
    v_and_b32_dpp v25, v33, v13 row_newbcast:12 row_mask:0xf bank_mask:0xf
    v_smfmac_f32_16x16x64_bf16 v[20:23], v[28:31], v[136:143], v14
    v_and_b32_dpp v26, v33, v12 row_newbcast:13 row_mask:0xf bank_mask:0xf
    v_and_b32_dpp v27, v33, v13 row_newbcast:13 row_mask:0xf bank_mask:0xf
    buffer_load_ubyte v15, off, s[32:35], 0
    buffer_load_ubyte v15, off, s[32:35], 0
    buffer_load_ubyte v15, off, s[32:35], 0
    buffer_load_ubyte v15, off, s[32:35], 0
    s_cbranch_scc1 L_ev5
L_dr6:
    s_bitcmp1_b32 s52, 6
    ds_write_b32 v10, v6 offset:48
    s_waitcnt vmcnt(12)
    v_smfmac_f32_16x16x64_bf16 v[16:19], v[24:27], v[144:151], v14
    v_and_b32_dpp v28, v33, v12 row_newbcast:14 row_mask:0xf bank_mask:0xf
    v_and_b32_dpp v29, v33, v13 row_newbcast:14 row_mask:0xf bank_mask:0xf
    v_smfmac_f32_16x16x64_bf16 v[20:23], v[24:27], v[152:159], v14
    v_and_b32_dpp v30, v33, v12 row_newbcast:15 row_mask:0xf bank_mask:0xf
    v_and_b32_dpp v31, v33, v13 row_newbcast:15 row_mask:0xf bank_mask:0xf
    buffer_load_ubyte v15, off, s[32:35], 0
    buffer_load_ubyte v15, off, s[32:35], 0
    buffer_load_ubyte v15, off, s[32:35], 0
    buffer_load_ubyte v15, off, s[32:35], 0
    s_cbranch_scc1 L_ev6
L_dr7:
    s_bitcmp1_b32 s52, 7
    ds_write_b32 v10, v6 offset:48
    s_waitcnt vmcnt(12)
    v_smfmac_f32_16x16x64_bf16 v[16:19], v[28:31], v[160:167], v14
    v_and_b32_dpp v24, v35, v12 row_newbcast:0 row_mask:0xf bank_mask:0xf
    v_and_b32_dpp v25, v35, v13 row_newbcast:0 row_mask:0xf bank_mask:0xf
    v_smfmac_f32_16x16x64_bf16 v[20:23], v[28:31], v[168:175], v14
    v_and_b32_dpp v26, v35, v12 row_newbcast:1 row_mask:0xf bank_mask:0xf
    v_and_b32_dpp v27, v35, v13 row_newbcast:1 row_mask:0xf bank_mask:0xf
    buffer_load_ubyte v15, off, s[32:35], 0
    buffer_load_ubyte v15, off, s[32:35], 0
    buffer_load_ubyte v15, off, s[32:35], 0
    buffer_load_ubyte v15, off, s[32:35], 0
    s_cbranch_scc1 L_ev7
L_dr8:
    v_mov_b64 v[32:33], v[34:35]
    v_mov_b64 v[34:35], v[36:37]
    v_mov_b64 v[36:37], v[38:39]
    s_lshr_b32 s52, s52, 8
    s_lshr_b32 s53, s53, 8
    s_lshr_b32 s56, s56, 8
    s_branch L_dr0
L_pad0:
    s_setpc_b64 s[68:69]
L_ev0:
    s_and_b32 s65, s57, 15
    v_cmp_ge_u32 s[66:67], s65, v4
    v_cmp_gt_u32 s[68:69], s65, v4
    s_bitcmp1_b32 s56, 0
    s_cselect_b64 s[62:63], s[70:71], s[62:63]
    v_cndmask_b32 v40, 0, v28, s[66:67]
    v_cndmask_b32 v41, 0, v29, s[66:67]
    v_cndmask_b32 v42, 0, v30, s[68:69]
    v_cndmask_b32 v43, 0, v31, s[68:69]
    s_mul_i32 s64, s63, 0
    s_bitcmp1_b32 s53, 0
    s_cbranch_scc0 L_evret
    s_waitcnt vmcnt(12)
    v_smfmac_f32_16x16x64_bf16 v[16:19], v[40:43], v[64:71], v14
    v_xor_b32 v28, v28, v40
    v_xor_b32 v29, v29, v41
    v_smfmac_f32_16x16x64_bf16 v[20:23], v[40:43], v[72:79], v14
    v_xor_b32 v30, v30, v42
    v_xor_b32 v31, v31, v43
    s_branch L_flush
L_pad1:
    s_setpc_b64 s[68:69]
L_ev1:
    s_and_b32 s65, s57, 15
    v_cmp_ge_u32 s[66:67], s65, v4
    v_cmp_gt_u32 s[68:69], s65, v4
    s_bitcmp1_b32 s56, 1
    s_cselect_b64 s[62:63], s[70:71], s[62:63]
    v_cndmask_b32 v40, 0, v24, s[66:67]
    v_cndmask_b32 v41, 0, v25, s[66:67]
    v_cndmask_b32 v42, 0, v26, s[68:69]
    v_cndmask_b32 v43, 0, v27, s[68:69]
    s_mul_i32 s64, s63, 1
    s_bitcmp1_b32 s53, 1
    s_cbranch_scc0 L_evret
    s_waitcnt vmcnt(12)
    v_smfmac_f32_16x16x64_bf16 v[16:19], v[40:43], v[80:87], v14
    v_xor_b32 v24, v24, v40
    v_xor_b32 v25, v25, v41
    v_smfmac_f32_16x16x64_bf16 v[20:23], v[40:43], v[88:95], v14
    v_xor_b32 v26, v26, v42
    v_xor_b32 v27, v27, v43
    s_branch L_flush
L_pad2:
    s_setpc_b64 s[68:69]
L_ev2:
    s_and_b32 s65, s57, 15
    v_cmp_ge_u32 s[66:67], s65, v4
    v_cmp_gt_u32 s[68:69], s65, v4
    s_bitcmp1_b32 s56, 2
    s_cselect_b64 s[62:63], s[70:71], s[62:63]
    v_cndmask_b32 v40, 0, v28, s[66:67]
    v_cndmask_b32 v41, 0, v29, s[66:67]
    v_cndmask_b32 v42, 0, v30, s[68:69]
    v_cndmask_b32 v43, 0, v31, s[68:69]
    s_mul_i32 s64, s63, 2
    s_bitcmp1_b32 s53, 2
    s_cbranch_scc0 L_evret
    s_waitcnt vmcnt(12)
    v_smfmac_f32_16x16x64_bf16 v[16:19], v[40:43], v[96:103], v14
    v_xor_b32 v28, v28, v40
    v_xor_b32 v29, v29, v41
    v_smfmac_f32_16x16x64_bf16 v[20:23], v[40:43], v[104:111], v14
    v_xor_b32 v30, v30, v42
    v_xor_b32 v31, v31, v43
    s_branch L_flush
L_pad3:
    s_setpc_b64 s[68:69]
L_ev3:
    s_and_b32 s65, s57, 15
    v_cmp_ge_u32 s[66:67], s65, v4
    v_cmp_gt_u32 s[68:69], s65, v4
    s_bitcmp1_b32 s56, 3
    s_cselect_b64 s[62:63], s[70:71], s[62:63]
    v_cndmask_b32 v40, 0, v24, s[66:67]
    v_cndmask_b32 v41, 0, v25, s[66:67]
    v_cndmask_b32 v42, 0, v26, s[68:69]
    v_cndmask_b32 v43, 0, v27, s[68:69]
    s_mul_i32 s64, s63, 3
    s_bitcmp1_b32 s53, 3
    s_cbranch_scc0 L_evret
    s_waitcnt vmcnt(12)
    v_smfmac_f32_16x16x64_bf16 v[16:19], v[40:43], v[112:119], v14
    v_xor_b32 v24, v24, v40
    v_xor_b32 v25, v25, v41
    v_smfmac_f32_16x16x64_bf16 v[20:23], v[40:43], v[120:127], v14
    v_xor_b32 v26, v26, v42
    v_xor_b32 v27, v27, v43
    s_branch L_flush
L_pad4:
    s_setpc_b64 s[68:69]
L_ev4:
    s_and_b32 s65, s57, 15
    v_cmp_ge_u32 s[66:67], s65, v4
    v_cmp_gt_u32 s[68:69], s65, v4
    s_bitcmp1_b32 s56, 4
    s_cselect_b64 s[62:63], s[70:71], s[62:63]
    v_cndmask_b32 v40, 0, v28, s[66:67]
    v_cndmask_b32 v41, 0, v29, s[66:67]
    v_cndmask_b32 v42, 0, v30, s[68:69]
    v_cndmask_b32 v43, 0, v31, s[68:69]
    s_mul_i32 s64, s63, 4
    s_bitcmp1_b32 s53, 4
    s_cbranch_scc0 L_evret
    s_waitcnt vmcnt(12)
    v_smfmac_f32_16x16x64_bf16 v[16:19], v[40:43], v[128:135], v14
    v_xor_b32 v28, v28, v40
    v_xor_b32 v29, v29, v41
    v_smfmac_f32_16x16x64_bf16 v[20:23], v[40:43], v[136:143], v14
    v_xor_b32 v30, v30, v42
    v_xor_b32 v31, v31, v43
    s_branch L_flush
L_pad5:
    s_setpc_b64 s[68:69]
L_ev5:
    s_and_b32 s65, s57, 15
    v_cmp_ge_u32 s[66:67], s65, v4
    v_cmp_gt_u32 s[68:69], s65, v4
    s_bitcmp1_b32 s56, 5
    s_cselect_b64 s[62:63], s[70:71], s[62:63]
    v_cndmask_b32 v40, 0, v24, s[66:67]
    v_cndmask_b32 v41, 0, v25, s[66:67]
    v_cndmask_b32 v42, 0, v26, s[68:69]
    v_cndmask_b32 v43, 0, v27, s[68:69]
    s_mul_i32 s64, s63, 5
    s_bitcmp1_b32 s53, 5
    s_cbranch_scc0 L_evret
    s_waitcnt vmcnt(12)
    v_smfmac_f32_16x16x64_bf16 v[16:19], v[40:43], v[144:151], v14
    v_xor_b32 v24, v24, v40
    v_xor_b32 v25, v25, v41
    v_smfmac_f32_16x16x64_bf16 v[20:23], v[40:43], v[152:159], v14
    v_xor_b32 v26, v26, v42
    v_xor_b32 v27, v27, v43
    s_branch L_flush
L_pad6:
    s_setpc_b64 s[68:69]
L_ev6:
    s_and_b32 s65, s57, 15
    v_cmp_ge_u32 s[66:67], s65, v4
    v_cmp_gt_u32 s[68:69], s65, v4
    s_bitcmp1_b32 s56, 6
    s_cselect_b64 s[62:63], s[70:71], s[62:63]
    v_cndmask_b32 v40, 0, v28, s[66:67]
    v_cndmask_b32 v41, 0, v29, s[66:67]
    v_cndmask_b32 v42, 0, v30, s[68:69]
    v_cndmask_b32 v43, 0, v31, s[68:69]
    s_mul_i32 s64, s63, 6
    s_bitcmp1_b32 s53, 6
    s_cbranch_scc0 L_evret
    s_waitcnt vmcnt(12)
    v_smfmac_f32_16x16x64_bf16 v[16:19], v[40:43], v[160:167], v14
    v_xor_b32 v28, v28, v40
    v_xor_b32 v29, v29, v41
    v_smfmac_f32_16x16x64_bf16 v[20:23], v[40:43], v[168:175], v14
    v_xor_b32 v30, v30, v42
    v_xor_b32 v31, v31, v43
    s_branch L_flush
L_pad7:
    s_setpc_b64 s[68:69]
L_ev7:
    s_and_b32 s65, s57, 15
    v_cmp_ge_u32 s[66:67], s65, v4
    v_cmp_gt_u32 s[68:69], s65, v4
    s_bitcmp1_b32 s56, 7
    s_cselect_b64 s[62:63], s[70:71], s[62:63]
    v_cndmask_b32 v40, 0, v24, s[66:67]
    v_cndmask_b32 v41, 0, v25, s[66:67]
    v_cndmask_b32 v42, 0, v26, s[68:69]
    v_cndmask_b32 v43, 0, v27, s[68:69]
    s_mul_i32 s64, s63, 7
    s_bitcmp1_b32 s53, 7
    s_cbranch_scc0 L_evret
    s_waitcnt vmcnt(12)
    v_smfmac_f32_16x16x64_bf16 v[16:19], v[40:43], v[48:55], v14
    v_xor_b32 v24, v24, v40
    v_xor_b32 v25, v25, v41
    v_smfmac_f32_16x16x64_bf16 v[20:23], v[40:43], v[56:63], v14
    v_xor_b32 v26, v26, v42
    v_xor_b32 v27, v27, v43
    s_nop 0
L_flush:
    s_lshr_b32 s57, s57, 4
    s_cmp_eq_u32 s26, 4
    v_add_u32 v1, 1, v1
    v_mul_f32 v40, v177, v16
    v_mul_f32 v41, v177, v17
    v_mul_f32 v42, v177, v18
    v_mul_f32 v43, v177, v19
    v_cvt_pk_bf16_f32 v40, v40, v41
    v_cvt_pk_bf16_f32 v41, v42, v43
    ds_write_b64 v176, v[40:41] offset:41984
    v_mul_f32 v44, v177, v20
    v_mul_f32 v45, v177, v21
    v_mul_f32 v46, v177, v22
    v_mul_f32 v47, v177, v23
    v_cvt_pk_bf16_f32 v44, v44, v45
    v_cvt_pk_bf16_f32 v45, v46, v47
    ds_write_b64 v176, v[44:45] offset:42240
    ds_write_b32 v10, v1 offset:32
    s_cbranch_scc1 L_sdone
    v_mov_b64 v[16:17], 0
    v_mov_b64 v[18:19], 0
    v_mov_b64 v[20:21], 0
    v_mov_b64 v[22:23], 0
    s_add_u32 s26, s26, 1
    v_mov_b64 v[176:177], v[178:179]
    v_mov_b64 v[178:179], v[180:181]
    v_mov_b64 v[180:181], v[182:183]
    v_mov_b64 v[182:183], v[184:185]
L_evret:
    s_add_u32 s64, s64, s62
    s_add_u32 s54, s72, s64
    s_addc_u32 s55, s73, 0
    s_setpc_b64 s[54:55]
L_pad9:
    s_setpc_b64 s[68:69]
L_slow:
    s_mov_b32 s62, L_slow_pair-L_anc
    v_mbcnt_lo_u32_b32 v200, -1, 0
    v_mbcnt_hi_u32_b32 v200, -1, v200
L_slow_pair:
    v_lshlrev_b32 v201, 2, v200
    s_mul_i32 s70, s1, 40
    s_lshl1_add_u32 s70, s24, s70
    s_mov_b32 s71, 0
    s_mov_b32 s24, s20
    s_mov_b32 s20, s21
    s_mov_b32 s21, s22
    s_mov_b32 s22, s23
L_slow_chunk:
    global_load_dword v202, v201, s[8:9]
    global_load_dword v203, v201, s[6:7]
    v_add_u32 v201, 0x100, v201
    s_waitcnt vmcnt(0)
    v_subrev_u32 v202, s70, v202
    v_cmp_gt_u32 vcc, 2, v202
    v_lshlrev_b32 v204, 1, v203
    ds_read_u16 v204, v204 offset:62464
    s_mov_b64 s[76:77], vcc
    v_lshlrev_b32 v202, 4, v202
    v_lshlrev_b32 v203, 9, v203
    s_waitcnt lgkmcnt(0)
    v_lshlrev_b32 v204, v202, v204
L_slow_edge:
    s_cmp_eq_u64 s[76:77], 0
    s_cbranch_scc1 L_slow_next
    s_ff1_i32_b64 s74, s[76:77]
    s_bitset0_b64 s[76:77], s74
    v_readlane_b32 s64, v203, s74
    v_readlane_b32 s65, v204, s74
    v_mov_b32 v205, 0
    v_mov_b32 v11, 2147483648
    s_mov_b64 exec, 0xffff
    v_mov_b32 v205, s65
    v_add_u32 v11, s64, v7
    s_mov_b64 exec, -1
    buffer_load_dwordx4 v[208:211], v11, s[32:35], 0 offen
    buffer_load_dwordx4 v[212:215], v11, s[32:35], 0 offen offset:256
    v_and_b32 v24, v205, v12
    v_and_b32 v25, v205, v13
    s_nop 0
    s_waitcnt vmcnt(0)
    v_smfmac_f32_16x16x32_bf16 v[16:19], v[24:25], v[208:211], v14
    v_smfmac_f32_16x16x32_bf16 v[20:23], v[24:25], v[212:215], v14
    s_branch L_slow_edge
L_slow_next:
    s_add_u32 s71, s71, 1
    s_cmp_lt_u32 s71, 2500
    s_cbranch_scc1 L_slow_chunk
    s_mov_b32 s64, 0
    s_nop 3
    s_branch L_flush
L_sdone:
    ds_write_b32 v10, v6 offset:48
    s_waitcnt lgkmcnt(0)
    s_barrier
    s_endpgm
L_retry_16:
    s_sub_u32 s100, s100, 1
    s_cbranch_scc1 L_end
    s_sleep 1
    s_branch L_spin_15
L_retry_17:
    s_sub_u32 s100, s100, 1
    s_cbranch_scc1 L_end
    s_sleep 4
    s_branch L_ipoll_14
L_retry_23:
    s_sub_u32 s100, s100, 1
    s_cbranch_scc1 L_end
    s_sleep 2
    s_branch L_secload_22
L_secload_22:
    buffer_load_dwordx4 v[56:59], v8, s[40:43], s12 offen sc1
    s_waitcnt vmcnt(0)
    s_branch L_sec_20
L_retry_27:
    s_sub_u32 s100, s100, 1
    s_cbranch_scc1 L_end
    s_sleep 2
    s_branch L_secload_26
L_secload_26:
    buffer_load_dwordx4 v[60:63], v8, s[40:43], s13 offen sc1
    s_waitcnt vmcnt(0)
    s_branch L_sec_24
L_retry_29:
    s_sub_u32 s100, s100, 1
    s_cbranch_scc1 L_end
    s_sleep 1
    s_branch L_spin_28
L_mwork_4:
    v_xor_b32 v44, v4, v3
    v_lshlrev_b32 v44, 4, v44
    v_lshl_add_u32 v44, v3, 9, v44
    v_xor_b32 v45, 64, v44
    v_xor_b32 v46, 0x80, v44
    v_xor_b32 v47, 0xc0, v44
    s_cmp_lg_u32 s31, 0
    s_waitcnt vmcnt(0)
    s_barrier
    s_cbranch_scc1 L_worked_5_w
    ds_read_b128 v[48:51], v44 offset:62464
    ds_read_b128 v[52:55], v44 offset:21504
    ds_read_b128 v[56:59], v44 offset:29696
    ds_read_b128 v[60:63], v45 offset:62464
    ds_read_b128 v[64:67], v45 offset:21504
    ds_read_b128 v[68:71], v45 offset:29696
    ds_read_b128 v[72:75], v46 offset:62464
    ds_read_b128 v[76:79], v46 offset:21504
    ds_read_b128 v[80:83], v46 offset:29696
    ds_read_b128 v[84:87], v47 offset:62464
    ds_read_b128 v[88:91], v47 offset:21504
    ds_read_b128 v[92:95], v47 offset:29696
    s_waitcnt lgkmcnt(9)
    v_mfma_f32_16x16x32_bf16 v[16:19], v[52:55], v[48:51], 0
    v_mfma_f32_16x16x32_bf16 v[20:23], v[56:59], v[48:51], 0
    ds_read_b128 v[96:99], v44 offset:62720
    ds_read_b128 v[100:103], v44 offset:21760
    ds_read_b128 v[104:107], v44 offset:29952
    s_waitcnt lgkmcnt(9)
    v_mfma_f32_16x16x32_bf16 v[16:19], v[64:67], v[60:63], v[16:19]
    v_mfma_f32_16x16x32_bf16 v[20:23], v[68:71], v[60:63], v[20:23]
    ds_read_b128 v[108:111], v45 offset:62720
    ds_read_b128 v[112:115], v45 offset:21760
    ds_read_b128 v[116:119], v45 offset:29952
    s_waitcnt lgkmcnt(9)
    v_mfma_f32_16x16x32_bf16 v[16:19], v[76:79], v[72:75], v[16:19]
    v_mfma_f32_16x16x32_bf16 v[20:23], v[80:83], v[72:75], v[20:23]
    ds_read_b128 v[120:123], v46 offset:62720
    ds_read_b128 v[124:127], v46 offset:21760
    ds_read_b128 v[128:131], v46 offset:29952
    s_waitcnt lgkmcnt(9)
    v_mfma_f32_16x16x32_bf16 v[16:19], v[88:91], v[84:87], v[16:19]
    v_mfma_f32_16x16x32_bf16 v[20:23], v[92:95], v[84:87], v[20:23]
    ds_read_b128 v[132:135], v47 offset:62720
    ds_read_b128 v[136:139], v47 offset:21760
    ds_read_b128 v[140:143], v47 offset:29952
    s_waitcnt lgkmcnt(9)
    v_mfma_f32_16x16x32_bf16 v[16:19], v[100:103], v[96:99], v[16:19]
    v_mfma_f32_16x16x32_bf16 v[20:23], v[104:107], v[96:99], v[20:23]
    s_waitcnt lgkmcnt(6)
    v_mfma_f32_16x16x32_bf16 v[16:19], v[112:115], v[108:111], v[16:19]
    v_mfma_f32_16x16x32_bf16 v[20:23], v[116:119], v[108:111], v[20:23]
    s_waitcnt lgkmcnt(3)
    v_mfma_f32_16x16x32_bf16 v[16:19], v[124:127], v[120:123], v[16:19]
    v_mfma_f32_16x16x32_bf16 v[20:23], v[128:131], v[120:123], v[20:23]
    s_waitcnt lgkmcnt(0)
    v_mfma_f32_16x16x32_bf16 v[16:19], v[136:139], v[132:135], v[16:19]
    v_mfma_f32_16x16x32_bf16 v[20:23], v[140:143], v[132:135], v[20:23]
    s_lshl_b32 s64, s27, 10
    s_add_u32 s64, s64, 65536
    v_lshl_add_u32 v40, v2, 4, s64
    s_lshl_b32 s64, s27, 2
    s_add_u32 s64, s64, 4096
    v_lshl_add_u32 v41, v2, 9, s64
    v_mov_b32 v42, s30
    s_nop 1
    v_cvt_pk_bf16_f32 v44, v16, v17
    v_cvt_pk_bf16_f32 v45, v18, v19
    v_cvt_pk_bf16_f32 v46, v20, v21
    v_cvt_pk_bf16_f32 v47, v22, v23
    global_store_dwordx4 v40, v[44:47], s[28:29] sc1
    s_barrier
    s_mov_b32 s26, 2
    s_waitcnt vmcnt(0)
    s_mov_b64 exec, 0xff
    global_store_dword v41, v42, s[28:29] sc1
    s_mov_b64 exec, -1
    s_branch L_worked_5
L_worked_5_w:
    s_barrier
    s_branch L_worked_5
L_gemm:
    v_lshrrev_b32 v0, 5, v2
    s_lshl_b32 s64, s31, 1
    v_add_u32 v0, s64, v0
    v_and_b32 v1, 31, v2
    v_xor_b32 v1, v1, v0
    v_lshlrev_b32 v1, 4, v1
    v_lshl_add_u32 v30, v0, 9, v1
    v_xor_b32 v31, 0x80, v30
    v_lshrrev_b32 v13, 3, v2
    v_lshrrev_b32 v15, 2, v2
    v_and_b32 v15, 4, v15
    v_and_b32 v14, 7, v2
    v_xor_b32 v15, v15, v14
    v_lshlrev_b32 v15, 4, v15
    v_lshl_add_u32 v13, v13, 9, v15
    s_lshr_b32 s67, s2, 3
    s_and_b32 s67, s67, 7
    s_lshl_b32 s64, s31, 7
    s_lshl_b32 s65, s67, 14
    s_or_b32 s64, s64, s65
    v_add_u32 v13, s64, v13
    s_mul_i32 s63, s1, 20480
    s_lshl_b32 s66, s31, 10
    s_lshl_b32 s70, s31, 14
    s_add_u32 s70, s70, 82944
    s_mov_b32 s71, 3072
    s_mov_b32 s72, 6144
    s_mov_b32 s73, 9216
    s_waitcnt lgkmcnt(0)
    s_mov_b32 s32, s4
    s_and_b32 s33, s5, 0xffff
    s_mov_b32 s34, 5120000
    s_mov_b32 s35, 0x20000
    s_mov_b32 s36, s22
    s_and_b32 s37, s23, 0xffff
    s_mov_b32 s38, 131072
    s_mov_b32 s39, 0x20000
    s_bitcmp1_b32 s2, 3
    s_cbranch_scc0 L_touched_30
    s_lshr_b32 s64, s2, 4
    s_lshl_b32 s64, s64, 3
    s_and_b32 s68, s2, 7
    s_or_b32 s64, s64, s68
    s_lshl_b32 s64, s64, 10
    v_lshl_add_u32 v16, v2, 4, s64
    s_cmp_eq_u32 s31, 1
    s_cselect_b64 s[68:69], s[22:23], s[16:17]
    s_cmp_eq_u32 s31, 2
    s_cselect_b64 s[68:69], s[18:19], s[68:69]
    s_cmp_eq_u32 s31, 3
    s_cselect_b64 s[68:69], s[20:21], s[68:69]
    global_load_dwordx4 v[20:23], v16, s[68:69]
L_touched_30:
    s_cmp_ge_u32 s2, 250
    s_cbranch_scc1 L_end
    s_mul_i32 s64, s1, 20480
    s_mov_b32 s76, 0
    s_cmp_eq_u32 s31, 0
    s_cselect_b64 s[68:69], s[24:25], s[16:17]
    s_cselect_b32 s64, s64, 0
    s_cmp_eq_u32 s31, 2
    s_cselect_b64 s[68:69], s[28:29], s[68:69]
    s_cselect_b32 s64, 0x800, s64
    s_cselect_b32 s76, 0x2f8000, s76
    s_cmp_eq_u32 s31, 3
    s_cselect_b64 s[68:69], s[4:5], s[68:69]
    s_cselect_b32 s76, 0x200000, s76
    s_cselect_b32 s77, 2, 1
    v_min_u32 v17, s77, v2
    v_mul_lo_u32 v17, v17, s76
    v_add_u32 v17, s64, v17
    global_load_dword v24, v17, s[68:69]
    s_barrier
    s_setprio 2
    s_add_u32 m0, s66, 1024
    s_nop 0
    buffer_load_dwordx4 v30, s[32:35], s63 offen lds
    s_add_u32 m0, s66, 5120
    s_add_u32 s63, s63, 4096
    buffer_load_dwordx4 v31, s[32:35], s63 offen lds
    s_add_u32 m0, s70, 0
    s_nop 0
    buffer_load_dwordx4 v13, s[36:39], 0 offen offset:0 lds
    buffer_load_dwordx4 v13, s[36:39], s71 offen offset:1024 lds
    buffer_load_dwordx4 v13, s[36:39], s72 offen offset:2048 lds
    buffer_load_dwordx4 v13, s[36:39], s73 offen offset:3072 lds
    v_xor_b32 v13, 16384, v13
    s_mov_b32 s40, s16
    s_and_b32 s41, s17, 0xffff
    s_mov_b32 s42, 131072
    s_mov_b32 s43, 0x20000
    s_mov_b32 s44, s28
    s_and_b32 s45, s29, 0xffff
    s_mov_b32 s46, 1048576
    s_mov_b32 s47, 0x20000
    s_mov_b32 s48, s24
    s_and_b32 s49, s25, 0xffff
    s_mov_b32 s50, 5120000
    s_mov_b32 s51, 0x20000
    v_xor_b32 v15, v4, v3
    v_lshlrev_b32 v15, 4, v15
    v_lshl_add_u32 v7, v3, 9, v15
    s_lshl_b32 s64, s67, 6
    v_xor_b32 v7, s64, v7
    v_xor_b32 v8, 64, v7
    v_xor_b32 v9, 0x80, v7
    v_xor_b32 v10, 0xc0, v7
    v_lshrrev_b32 v15, 2, v3
    v_lshl_add_u32 v15, v4, 3, v15
    v_lshlrev_b32 v15, 7, v15
    v_lshrrev_b32 v14, 1, v3
    v_and_b32 v14, 4, v14
    v_and_b32 v0, 3, v3
    v_xor_b32 v14, v14, v0
    v_lshl_add_u32 v15, v14, 4, v15
    v_add_u32 v11, s70, v15
    v_xor_b32 v12, 64, v11
    v_and_b32 v0, 31, v2
    v_lshlrev_b32 v0, 2, v0
    s_and_b32 s64, s2, 7
    s_lshl_b32 s64, s64, 9
    s_lshl_b32 s65, s31, 7
    s_add_u32 s64, s64, s65
    s_add_u32 s74, s64, 4096
    v_lshlrev_b32 v14, 4, v2
    s_lshl_b32 s75, s31, 15
    s_lshl_b32 s64, s67, 12
    s_or_b32 s75, s75, s64
    s_add_u32 s75, s75, 65536
    s_cmp_eq_u32 s31, 0
    s_cbranch_scc0 L_nw_32
    s_call_b64 s[68:69], L_pad0
    s_call_b64 s[68:69], L_pad1
    s_call_b64 s[68:69], L_pad8
    s_branch L_warmed_31
L_nw_32:
    s_cmp_eq_u32 s31, 1
    s_cbranch_scc0 L_nw_33
    s_call_b64 s[68:69], L_pad2
    s_call_b64 s[68:69], L_pad3
    s_call_b64 s[68:69], L_pad9
    s_branch L_warmed_31
L_nw_33:
    s_cmp_eq_u32 s31, 2
    s_cbranch_scc0 L_nw_34
    s_call_b64 s[68:69], L_pad4
    s_call_b64 s[68:69], L_pad5
    s_branch L_warmed_31
L_nw_34:
    s_call_b64 s[68:69], L_pad6
    s_call_b64 s[68:69], L_pad7
L_warmed_31:
    s_add_u32 m0, s66, 9216
    s_add_u32 s63, s63, 4096
    buffer_load_dwordx4 v30, s[32:35], s63 offen lds
    s_add_u32 m0, s66, 13312
    s_add_u32 s63, s63, 4096
    buffer_load_dwordx4 v31, s[32:35], s63 offen lds
    s_add_u32 m0, s66, 17408
    s_add_u32 s63, s63, 4096
    buffer_load_dwordx4 v30, s[32:35], s63 offen lds
    s_barrier
    s_add_u32 m0, s70, 4096
    s_waitcnt vmcnt(9)
    buffer_load_dwordx4 v13, s[36:39], 0 offen offset:0 lds
    s_waitcnt vmcnt(9)
    buffer_load_dwordx4 v13, s[36:39], s71 offen offset:1024 lds
    s_waitcnt vmcnt(9)
    buffer_load_dwordx4 v13, s[36:39], s72 offen offset:2048 lds
    s_waitcnt vmcnt(9)
    buffer_load_dwordx4 v13, s[36:39], s73 offen offset:3072 lds
    v_xor_b32 v13, 49152, v13
    s_bitcmp1_b32 s2, 3
    s_cbranch_scc1 L_nobar_36
    s_barrier
L_nobar_36:
    s_add_u32 m0, s70, 8192
    s_waitcnt vmcnt(4)
    buffer_load_dwordx4 v13, s[36:39], 0 offen offset:0 lds
    s_waitcnt vmcnt(4)
    buffer_load_dwordx4 v13, s[36:39], s71 offen offset:1024 lds
    s_waitcnt vmcnt(4)
    buffer_load_dwordx4 v13, s[36:39], s72 offen offset:2048 lds
    s_waitcnt vmcnt(4)
    buffer_load_dwordx4 v13, s[36:39], s73 offen offset:3072 lds
    v_xor_b32 v13, 16384, v13
    s_add_u32 m0, s70, 12288
    s_waitcnt vmcnt(4)
    buffer_load_dwordx4 v13, s[36:39], 0 offen offset:0 lds
    s_waitcnt vmcnt(4)
    buffer_load_dwordx4 v13, s[36:39], s71 offen offset:1024 lds
    s_waitcnt vmcnt(4)
    buffer_load_dwordx4 v13, s[36:39], s72 offen offset:2048 lds
    s_waitcnt vmcnt(4)
    buffer_load_dwordx4 v13, s[36:39], s73 offen offset:3072 lds
    v_xor_b32 v13, 114688, v13
    s_waitcnt vmcnt(12)
    ds_read_b64_tr_b16 v[128:129], v11 offset:0
    ds_read_b64_tr_b16 v[130:131], v11 offset:512
    ds_read_b64_tr_b16 v[132:133], v11 offset:8
    ds_read_b64_tr_b16 v[134:135], v11 offset:520
    ds_read_b64_tr_b16 v[136:137], v12 offset:0
    ds_read_b64_tr_b16 v[138:139], v12 offset:512
    ds_read_b64_tr_b16 v[140:141], v12 offset:8
    ds_read_b64_tr_b16 v[142:143], v12 offset:520
    s_waitcnt lgkmcnt(0)
    s_add_u32 m0, s70, 0
    s_waitcnt vmcnt(4)
    buffer_load_dwordx4 v13, s[36:39], 0 offen offset:0 lds
    s_waitcnt vmcnt(4)
    buffer_load_dwordx4 v13, s[36:39], s71 offen offset:1024 lds
    s_waitcnt vmcnt(4)
    buffer_load_dwordx4 v13, s[36:39], s72 offen offset:2048 lds
    s_waitcnt vmcnt(4)
    buffer_load_dwordx4 v13, s[36:39], s73 offen offset:3072 lds
    v_xor_b32 v13, 16384, v13
    s_waitcnt vmcnt(12)
    s_waitcnt lgkmcnt(0)
    s_mov_b64 exec, 1
    ds_add_u32 v5, v6 offset:4
    s_mov_b64 exec, -1
    ds_read_b64_tr_b16 v[144:145], v11 offset:4096
    ds_read_b64_tr_b16 v[146:147], v11 offset:4608
    ds_read_b64_tr_b16 v[148:149], v11 offset:4104
    ds_read_b64_tr_b16 v[150:151], v11 offset:4616
    ds_read_b64_tr_b16 v[152:153], v12 offset:4096
    ds_read_b64_tr_b16 v[154:155], v12 offset:4608
    ds_read_b64_tr_b16 v[156:157], v12 offset:4104
    ds_read_b64_tr_b16 v[158:159], v12 offset:4616
    s_waitcnt lgkmcnt(0)
    s_add_u32 m0, s70, 4096
    s_waitcnt vmcnt(4)
    buffer_load_dwordx4 v13, s[36:39], 0 offen offset:0 lds
    s_waitcnt vmcnt(4)
    buffer_load_dwordx4 v13, s[36:39], s71 offen offset:1024 lds
    s_waitcnt vmcnt(4)
    buffer_load_dwordx4 v13, s[36:39], s72 offen offset:2048 lds
    s_waitcnt vmcnt(4)
    buffer_load_dwordx4 v13, s[36:39], s73 offen offset:3072 lds
    v_xor_b32 v13, 49152, v13
    s_waitcnt vmcnt(12)
    ds_read_b64_tr_b16 v[160:161], v11 offset:8192
    ds_read_b64_tr_b16 v[162:163], v11 offset:8704
    ds_read_b64_tr_b16 v[164:165], v11 offset:8200
    ds_read_b64_tr_b16 v[166:167], v11 offset:8712
    ds_read_b64_tr_b16 v[168:169], v12 offset:8192
    ds_read_b64_tr_b16 v[170:171], v12 offset:8704
    ds_read_b64_tr_b16 v[172:173], v12 offset:8200
    ds_read_b64_tr_b16 v[174:175], v12 offset:8712
    s_waitcnt lgkmcnt(0)
    s_add_u32 m0, s70, 8192
    s_waitcnt vmcnt(4)
    buffer_load_dwordx4 v13, s[36:39], 0 offen offset:0 lds
    s_waitcnt vmcnt(4)
    buffer_load_dwordx4 v13, s[36:39], s71 offen offset:1024 lds
    s_waitcnt vmcnt(4)
    buffer_load_dwordx4 v13, s[36:39], s72 offen offset:2048 lds
    s_waitcnt vmcnt(4)
    buffer_load_dwordx4 v13, s[36:39], s73 offen offset:3072 lds
    v_xor_b32 v13, 16384, v13
    buffer_load_dword v1, v0, s[44:47], s74 offen sc1
    s_waitcnt vmcnt(13)
    ds_read_b64_tr_b16 v[176:177], v11 offset:12288
    ds_read_b64_tr_b16 v[178:179], v11 offset:12800
    ds_read_b64_tr_b16 v[180:181], v11 offset:12296
    ds_read_b64_tr_b16 v[182:183], v11 offset:12808
    ds_read_b64_tr_b16 v[184:185], v12 offset:12288
    ds_read_b64_tr_b16 v[186:187], v12 offset:12800
    ds_read_b64_tr_b16 v[188:189], v12 offset:12296
    ds_read_b64_tr_b16 v[190:191], v12 offset:12808
    s_waitcnt lgkmcnt(0)
    s_add_u32 m0, s70, 12288
    s_nop 0
    buffer_load_dwordx4 v13, s[36:39], 0 offen offset:0 lds
    buffer_load_dwordx4 v13, s[36:39], s71 offen offset:1024 lds
    buffer_load_dwordx4 v13, s[36:39], s72 offen offset:2048 lds
    buffer_load_dwordx4 v13, s[36:39], s73 offen offset:3072 lds
    v_xor_b32 v13, 114688, v13
    s_waitcnt vmcnt(13)
    ds_read_b64_tr_b16 v[192:193], v11 offset:0
    ds_read_b64_tr_b16 v[194:195], v11 offset:512
    ds_read_b64_tr_b16 v[196:197], v11 offset:8
    ds_read_b64_tr_b16 v[198:199], v11 offset:520
    ds_read_b64_tr_b16 v[200:201], v12 offset:0
    ds_read_b64_tr_b16 v[202:203], v12 offset:512
    ds_read_b64_tr_b16 v[204:205], v12 offset:8
    ds_read_b64_tr_b16 v[206:207], v12 offset:520
    s_waitcnt vmcnt(9)
    ds_read_b64_tr_b16 v[208:209], v11 offset:4096
    ds_read_b64_tr_b16 v[210:211], v11 offset:4608
    ds_read_b64_tr_b16 v[212:213], v11 offset:4104
    ds_read_b64_tr_b16 v[214:215], v11 offset:4616
    ds_read_b64_tr_b16 v[216:217], v12 offset:4096
    ds_read_b64_tr_b16 v[218:219], v12 offset:4608
    ds_read_b64_tr_b16 v[220:221], v12 offset:4104
    ds_read_b64_tr_b16 v[222:223], v12 offset:4616
    s_waitcnt vmcnt(5)
    ds_read_b64_tr_b16 v[224:225], v11 offset:8192
    ds_read_b64_tr_b16 v[226:227], v11 offset:8704
    ds_read_b64_tr_b16 v[228:229], v11 offset:8200
    ds_read_b64_tr_b16 v[230:231], v11 offset:8712
    ds_read_b64_tr_b16 v[232:233], v12 offset:8192
    ds_read_b64_tr_b16 v[234:235], v12 offset:8704
    ds_read_b64_tr_b16 v[236:237], v12 offset:8200
    ds_read_b64_tr_b16 v[238:239], v12 offset:8712
    s_waitcnt vmcnt(4)
L_spin_38:
    ds_read_b128 v[16:19], v5
    s_waitcnt lgkmcnt(0)
    v_readfirstlane_b32 s101, v18
    v_readfirstlane_b32 s30, v19
    s_cmp_ge_u32 s101, 1
    s_cbranch_scc0 L_retry_39
L_mchk_37:
    v_cmp_ne_u32 vcc, s30, v1
    s_cbranch_vccnz L_mre_40
    buffer_load_dwordx4 v[40:43], v14, s[44:47], s75 offen offset:0 sc1
    buffer_load_dwordx4 v[44:47], v14, s[44:47], s75 offen offset:1024 sc1
    buffer_load_dwordx4 v[48:51], v14, s[44:47], s75 offen offset:2048 sc1
    buffer_load_dwordx4 v[52:55], v14, s[44:47], s75 offen offset:3072 sc1
    s_xor_b32 s75, s75, 4096
    buffer_load_dwordx4 v[56:59], v14, s[44:47], s75 offen offset:0 sc1
    buffer_load_dwordx4 v[60:63], v14, s[44:47], s75 offen offset:1024 sc1
    buffer_load_dwordx4 v[64:67], v14, s[44:47], s75 offen offset:2048 sc1
    buffer_load_dwordx4 v[68:71], v14, s[44:47], s75 offen offset:3072 sc1
    s_xor_b32 s75, s75, 12288
    buffer_load_dwordx4 v[72:75], v14, s[44:47], s75 offen offset:0 sc1
    buffer_load_dwordx4 v[76:79], v14, s[44:47], s75 offen offset:1024 sc1
    s_waitcnt vmcnt(10)
    ds_read_b64_tr_b16 v[240:241], v11 offset:12288
    ds_read_b64_tr_b16 v[242:243], v11 offset:12800
    ds_read_b64_tr_b16 v[244:245], v11 offset:12296
    ds_read_b64_tr_b16 v[246:247], v11 offset:12808
    ds_read_b64_tr_b16 v[248:249], v12 offset:12288
    ds_read_b64_tr_b16 v[250:251], v12 offset:12800
    ds_read_b64_tr_b16 v[252:253], v12 offset:12296
    ds_read_b64_tr_b16 v[254:255], v12 offset:12808
L_spin_41:
    ds_read_b32 v15, v5 offset:4
    s_waitcnt lgkmcnt(0)
    v_readfirstlane_b32 s101, v15
    s_cmp_ge_u32 s101, 4
    s_cbranch_scc0 L_retry_42
    ds_read_b128 v[16:19], v7 offset:1024
    ds_read_b128 v[20:23], v7 offset:9216
    ds_read_b128 v[24:27], v7 offset:17408
    v_xor_b32 v7, 0x100, v7
    ds_read_b128 v[28:31], v8 offset:1024
    ds_read_b128 v[32:35], v8 offset:9216
    ds_read_b128 v[36:39], v8 offset:17408
    v_xor_b32 v8, 0x100, v8
    s_waitcnt lgkmcnt(3)
    s_waitcnt vmcnt(9)
    v_mfma_f32_16x16x32_bf16 v[80:83], v[40:43], v[16:19], 0
    v_mfma_f32_16x16x32_bf16 v[96:99], v[40:43], v[20:23], 0
    v_mfma_f32_16x16x32_bf16 v[112:115], v[40:43], v[24:27], 0
    buffer_load_dwordx4 v[40:43], v14, s[44:47], s75 offen offset:2048 sc1
    s_waitcnt vmcnt(9)
    v_mfma_f32_16x16x32_bf16 v[84:87], v[44:47], v[16:19], 0
    v_mfma_f32_16x16x32_bf16 v[100:103], v[44:47], v[20:23], 0
    v_mfma_f32_16x16x32_bf16 v[116:119], v[44:47], v[24:27], 0
    buffer_load_dwordx4 v[44:47], v14, s[44:47], s75 offen offset:3072 sc1
    s_xor_b32 s75, s75, 4096
    s_waitcnt vmcnt(9)
    v_mfma_f32_16x16x32_bf16 v[88:91], v[48:51], v[16:19], 0
    v_mfma_f32_16x16x32_bf16 v[104:107], v[48:51], v[20:23], 0
    v_mfma_f32_16x16x32_bf16 v[120:123], v[48:51], v[24:27], 0
    buffer_load_dwordx4 v[48:51], v14, s[44:47], s75 offen offset:0 sc1
    s_waitcnt vmcnt(9)
    v_mfma_f32_16x16x32_bf16 v[92:95], v[52:55], v[16:19], 0
    v_mfma_f32_16x16x32_bf16 v[108:111], v[52:55], v[20:23], 0
    v_mfma_f32_16x16x32_bf16 v[124:127], v[52:55], v[24:27], 0
    buffer_load_dwordx4 v[52:55], v14, s[44:47], s75 offen offset:1024 sc1
    ds_read_b128 v[16:19], v9 offset:1024
    ds_read_b128 v[20:23], v9 offset:9216
    ds_read_b128 v[24:27], v9 offset:17408
    v_xor_b32 v9, 0x100, v9
    s_waitcnt lgkmcnt(3)
    s_waitcnt vmcnt(9)
    v_mfma_f32_16x16x32_bf16 v[80:83], v[56:59], v[28:31], v[80:83]
    v_mfma_f32_16x16x32_bf16 v[96:99], v[56:59], v[32:35], v[96:99]
    v_mfma_f32_16x16x32_bf16 v[112:115], v[56:59], v[36:39], v[112:115]
    buffer_load_dwordx4 v[56:59], v14, s[44:47], s75 offen offset:2048 sc1
    s_waitcnt vmcnt(9)
    v_mfma_f32_16x16x32_bf16 v[84:87], v[60:63], v[28:31], v[84:87]
    v_mfma_f32_16x16x32_bf16 v[100:103], v[60:63], v[32:35], v[100:103]
    v_mfma_f32_16x16x32_bf16 v[116:119], v[60:63], v[36:39], v[116:119]
    buffer_load_dwordx4 v[60:63], v14, s[44:47], s75 offen offset:3072 sc1
    s_xor_b32 s75, s75, 28672
    s_waitcnt vmcnt(9)
    v_mfma_f32_16x16x32_bf16 v[88:91], v[64:67], v[28:31], v[88:91]
    v_mfma_f32_16x16x32_bf16 v[104:107], v[64:67], v[32:35], v[104:107]
    v_mfma_f32_16x16x32_bf16 v[120:123], v[64:67], v[36:39], v[120:123]
    buffer_load_dwordx4 v[64:67], v14, s[44:47], s75 offen offset:0 sc1
    s_waitcnt vmcnt(9)
    v_mfma_f32_16x16x32_bf16 v[92:95], v[68:71], v[28:31], v[92:95]
    v_mfma_f32_16x16x32_bf16 v[108:111], v[68:71], v[32:35], v[108:111]
    v_mfma_f32_16x16x32_bf16 v[124:127], v[68:71], v[36:39], v[124:127]
    buffer_load_dwordx4 v[68:71], v14, s[44:47], s75 offen offset:1024 sc1
    ds_read_b128 v[28:31], v10 offset:1024
    ds_read_b128 v[32:35], v10 offset:9216
    ds_read_b128 v[36:39], v10 offset:17408
    v_xor_b32 v10, 0x100, v10
    s_waitcnt lgkmcnt(3)
    s_waitcnt vmcnt(9)
    v_mfma_f32_16x16x32_bf16 v[80:83], v[72:75], v[16:19], v[80:83]
    v_mfma_f32_16x16x32_bf16 v[96:99], v[72:75], v[20:23], v[96:99]
    v_mfma_f32_16x16x32_bf16 v[112:115], v[72:75], v[24:27], v[112:115]
    buffer_load_dwordx4 v[72:75], v14, s[44:47], s75 offen offset:2048 sc1
    s_waitcnt vmcnt(9)
    v_mfma_f32_16x16x32_bf16 v[84:87], v[76:79], v[16:19], v[84:87]
    v_mfma_f32_16x16x32_bf16 v[100:103], v[76:79], v[20:23], v[100:103]
    v_mfma_f32_16x16x32_bf16 v[116:119], v[76:79], v[24:27], v[116:119]
    buffer_load_dwordx4 v[76:79], v14, s[44:47], s75 offen offset:3072 sc1
    s_xor_b32 s75, s75, 4096
    s_waitcnt vmcnt(9)
    v_mfma_f32_16x16x32_bf16 v[88:91], v[40:43], v[16:19], v[88:91]
    v_mfma_f32_16x16x32_bf16 v[104:107], v[40:43], v[20:23], v[104:107]
    v_mfma_f32_16x16x32_bf16 v[120:123], v[40:43], v[24:27], v[120:123]
    buffer_load_dwordx4 v[40:43], v14, s[44:47], s75 offen offset:0 sc1
    s_waitcnt vmcnt(9)
    v_mfma_f32_16x16x32_bf16 v[92:95], v[44:47], v[16:19], v[92:95]
    v_mfma_f32_16x16x32_bf16 v[108:111], v[44:47], v[20:23], v[108:111]
    v_mfma_f32_16x16x32_bf16 v[124:127], v[44:47], v[24:27], v[124:127]
    buffer_load_dwordx4 v[44:47], v14, s[44:47], s75 offen offset:1024 sc1
    ds_read_b128 v[16:19], v7 offset:1024
    ds_read_b128 v[20:23], v7 offset:9216
    ds_read_b128 v[24:27], v7 offset:17408
    v_xor_b32 v7, 0x100, v7
    s_waitcnt lgkmcnt(3)
    s_waitcnt vmcnt(9)
    v_mfma_f32_16x16x32_bf16 v[80:83], v[48:51], v[28:31], v[80:83]
    v_mfma_f32_16x16x32_bf16 v[96:99], v[48:51], v[32:35], v[96:99]
    v_mfma_f32_16x16x32_bf16 v[112:115], v[48:51], v[36:39], v[112:115]
    buffer_load_dwordx4 v[48:51], v14, s[44:47], s75 offen offset:2048 sc1
    s_waitcnt vmcnt(9)
    v_mfma_f32_16x16x32_bf16 v[84:87], v[52:55], v[28:31], v[84:87]
    v_mfma_f32_16x16x32_bf16 v[100:103], v[52:55], v[32:35], v[100:103]
    v_mfma_f32_16x16x32_bf16 v[116:119], v[52:55], v[36:39], v[116:119]
    buffer_load_dwordx4 v[52:55], v14, s[44:47], s75 offen offset:3072 sc1
    s_xor_b32 s75, s75, 12288
    s_waitcnt vmcnt(9)
    v_mfma_f32_16x16x32_bf16 v[88:91], v[56:59], v[28:31], v[88:91]
    v_mfma_f32_16x16x32_bf16 v[104:107], v[56:59], v[32:35], v[104:107]
    v_mfma_f32_16x16x32_bf16 v[120:123], v[56:59], v[36:39], v[120:123]
    buffer_load_dwordx4 v[56:59], v14, s[44:47], s75 offen offset:0 sc1
    s_waitcnt vmcnt(9)
    v_mfma_f32_16x16x32_bf16 v[92:95], v[60:63], v[28:31], v[92:95]
    v_mfma_f32_16x16x32_bf16 v[108:111], v[60:63], v[32:35], v[108:111]
    v_mfma_f32_16x16x32_bf16 v[124:127], v[60:63], v[36:39], v[124:127]
    buffer_load_dwordx4 v[60:63], v14, s[44:47], s75 offen offset:1024 sc1
    ds_read_b128 v[28:31], v8 offset:1024
    ds_read_b128 v[32:35], v8 offset:9216
    ds_read_b128 v[36:39], v8 offset:17408
    v_xor_b32 v8, 0x100, v8
    s_waitcnt lgkmcnt(3)
    s_waitcnt vmcnt(9)
    v_mfma_f32_16x16x32_bf16 v[80:83], v[64:67], v[16:19], v[80:83]
    v_mfma_f32_16x16x32_bf16 v[96:99], v[64:67], v[20:23], v[96:99]
    v_mfma_f32_16x16x32_bf16 v[112:115], v[64:67], v[24:27], v[112:115]
    buffer_load_dwordx4 v[64:67], v14, s[44:47], s75 offen offset:2048 sc1
    s_waitcnt vmcnt(9)
    v_mfma_f32_16x16x32_bf16 v[84:87], v[68:71], v[16:19], v[84:87]
    v_mfma_f32_16x16x32_bf16 v[100:103], v[68:71], v[20:23], v[100:103]
    v_mfma_f32_16x16x32_bf16 v[116:119], v[68:71], v[24:27], v[116:119]
    buffer_load_dwordx4 v[68:71], v14, s[44:47], s75 offen offset:3072 sc1
    s_xor_b32 s75, s75, 4096
    s_waitcnt vmcnt(9)
    v_mfma_f32_16x16x32_bf16 v[88:91], v[72:75], v[16:19], v[88:91]
    v_mfma_f32_16x16x32_bf16 v[104:107], v[72:75], v[20:23], v[104:107]
    v_mfma_f32_16x16x32_bf16 v[120:123], v[72:75], v[24:27], v[120:123]
    buffer_load_dwordx4 v[72:75], v14, s[44:47], s75 offen offset:0 sc1
    s_waitcnt vmcnt(9)
    v_mfma_f32_16x16x32_bf16 v[92:95], v[76:79], v[16:19], v[92:95]
    v_mfma_f32_16x16x32_bf16 v[108:111], v[76:79], v[20:23], v[108:111]
    v_mfma_f32_16x16x32_bf16 v[124:127], v[76:79], v[24:27], v[124:127]
    buffer_load_dwordx4 v[76:79], v14, s[44:47], s75 offen offset:1024 sc1
    ds_read_b128 v[16:19], v9 offset:1024
    ds_read_b128 v[20:23], v9 offset:9216
    ds_read_b128 v[24:27], v9 offset:17408
    v_xor_b32 v9, 0x100, v9
    s_waitcnt lgkmcnt(3)
    s_waitcnt vmcnt(9)
    v_mfma_f32_16x16x32_bf16 v[80:83], v[40:43], v[28:31], v[80:83]
    v_mfma_f32_16x16x32_bf16 v[96:99], v[40:43], v[32:35], v[96:99]
    v_mfma_f32_16x16x32_bf16 v[112:115], v[40:43], v[36:39], v[112:115]
    buffer_load_dwordx4 v[40:43], v14, s[44:47], s75 offen offset:2048 sc1
    s_waitcnt vmcnt(9)
    v_mfma_f32_16x16x32_bf16 v[84:87], v[44:47], v[28:31], v[84:87]
    v_mfma_f32_16x16x32_bf16 v[100:103], v[44:47], v[32:35], v[100:103]
    v_mfma_f32_16x16x32_bf16 v[116:119], v[44:47], v[36:39], v[116:119]
    buffer_load_dwordx4 v[44:47], v14, s[44:47], s75 offen offset:3072 sc1
    s_xor_b32 s75, s75, 28672
    s_waitcnt vmcnt(9)
    v_mfma_f32_16x16x32_bf16 v[88:91], v[48:51], v[28:31], v[88:91]
    v_mfma_f32_16x16x32_bf16 v[104:107], v[48:51], v[32:35], v[104:107]
    v_mfma_f32_16x16x32_bf16 v[120:123], v[48:51], v[36:39], v[120:123]
    s_add_u32 m0, s70, 0
    s_nop 0
    buffer_load_dwordx4 v13, s[40:43], 0 offen offset:0 lds
    s_waitcnt vmcnt(9)
    v_mfma_f32_16x16x32_bf16 v[92:95], v[52:55], v[28:31], v[92:95]
    v_mfma_f32_16x16x32_bf16 v[108:111], v[52:55], v[32:35], v[108:111]
    v_mfma_f32_16x16x32_bf16 v[124:127], v[52:55], v[36:39], v[124:127]
    buffer_load_dwordx4 v13, s[40:43], s71 offen offset:1024 lds
    ds_read_b128 v[28:31], v10 offset:1024
    ds_read_b128 v[32:35], v10 offset:9216
    ds_read_b128 v[36:39], v10 offset:17408
    v_xor_b32 v10, 0x100, v10
    s_waitcnt lgkmcnt(3)
    s_waitcnt vmcnt(9)
    v_mfma_f32_16x16x32_bf16 v[80:83], v[56:59], v[16:19], v[80:83]
    v_mfma_f32_16x16x32_bf16 v[96:99], v[56:59], v[20:23], v[96:99]
    v_mfma_f32_16x16x32_bf16 v[112:115], v[56:59], v[24:27], v[112:115]
    buffer_load_dwordx4 v13, s[40:43], s72 offen offset:2048 lds
    s_waitcnt vmcnt(9)
    v_mfma_f32_16x16x32_bf16 v[84:87], v[60:63], v[16:19], v[84:87]
    v_mfma_f32_16x16x32_bf16 v[100:103], v[60:63], v[20:23], v[100:103]
    v_mfma_f32_16x16x32_bf16 v[116:119], v[60:63], v[24:27], v[116:119]
    buffer_load_dwordx4 v13, s[40:43], s73 offen offset:3072 lds
    v_xor_b32 v13, 16384, v13
    s_waitcnt vmcnt(9)
    v_mfma_f32_16x16x32_bf16 v[88:91], v[64:67], v[16:19], v[88:91]
    v_mfma_f32_16x16x32_bf16 v[104:107], v[64:67], v[20:23], v[104:107]
    v_mfma_f32_16x16x32_bf16 v[120:123], v[64:67], v[24:27], v[120:123]
    s_add_u32 m0, s70, 4096
    s_nop 0
    buffer_load_dwordx4 v13, s[40:43], 0 offen offset:0 lds
    s_waitcnt vmcnt(9)
    v_mfma_f32_16x16x32_bf16 v[92:95], v[68:71], v[16:19], v[92:95]
    v_mfma_f32_16x16x32_bf16 v[108:111], v[68:71], v[20:23], v[108:111]
    v_mfma_f32_16x16x32_bf16 v[124:127], v[68:71], v[24:27], v[124:127]
    buffer_load_dwordx4 v13, s[40:43], s71 offen offset:1024 lds
    s_waitcnt lgkmcnt(0)
    s_waitcnt vmcnt(9)
    v_mfma_f32_16x16x32_bf16 v[80:83], v[72:75], v[28:31], v[80:83]
    v_mfma_f32_16x16x32_bf16 v[96:99], v[72:75], v[32:35], v[96:99]
    v_mfma_f32_16x16x32_bf16 v[112:115], v[72:75], v[36:39], v[112:115]
    buffer_load_dwordx4 v13, s[40:43], s72 offen offset:2048 lds
    s_waitcnt vmcnt(9)
    v_mfma_f32_16x16x32_bf16 v[84:87], v[76:79], v[28:31], v[84:87]
    v_mfma_f32_16x16x32_bf16 v[100:103], v[76:79], v[32:35], v[100:103]
    v_mfma_f32_16x16x32_bf16 v[116:119], v[76:79], v[36:39], v[116:119]
    buffer_load_dwordx4 v13, s[40:43], s73 offen offset:3072 lds
    v_xor_b32 v13, 49152, v13
    s_waitcnt vmcnt(9)
    v_mfma_f32_16x16x32_bf16 v[88:91], v[40:43], v[28:31], v[88:91]
    v_mfma_f32_16x16x32_bf16 v[104:107], v[40:43], v[32:35], v[104:107]
    v_mfma_f32_16x16x32_bf16 v[120:123], v[40:43], v[36:39], v[120:123]
    s_add_u32 m0, s70, 8192
    s_nop 0
    buffer_load_dwordx4 v13, s[40:43], 0 offen offset:0 lds
    s_waitcnt vmcnt(9)
    v_mfma_f32_16x16x32_bf16 v[92:95], v[44:47], v[28:31], v[92:95]
    v_mfma_f32_16x16x32_bf16 v[108:111], v[44:47], v[32:35], v[108:111]
    v_mfma_f32_16x16x32_bf16 v[124:127], v[44:47], v[36:39], v[124:127]
    buffer_load_dwordx4 v13, s[40:43], s71 offen offset:1024 lds
    s_lshl_b32 s64, s31, 3
    v_add_u32 v0, s64, v4
    v_xor_b32 v0, v0, v3
    v_lshlrev_b32 v0, 4, v0
    v_lshl_add_u32 v0, v3, 9, v0
    v_xor_b32 v1, 64, v0
    s_mov_b32 s76, 0x00ff00ff
    s_mov_b32 s77, 0x00ff00ff
    v_cvt_pk_bf16_f32 v16, v80, v81
    v_cvt_pk_bf16_f32 v17, v82, v83
    v_cvt_pk_bf16_f32 v18, v84, v85
    v_cvt_pk_bf16_f32 v19, v86, v87
    ds_write_b128 v0, v[16:19] offset:21504
    v_cvt_pk_bf16_f32 v20, v88, v89
    v_cvt_pk_bf16_f32 v21, v90, v91
    v_cvt_pk_bf16_f32 v22, v92, v93
    v_cvt_pk_bf16_f32 v23, v94, v95
    ds_write_b128 v1, v[20:23] offset:21504
    v_cvt_pk_bf16_f32 v24, v96, v97
    v_cvt_pk_bf16_f32 v25, v98, v99
    v_cvt_pk_bf16_f32 v26, v100, v101
    v_cvt_pk_bf16_f32 v27, v102, v103
    ds_write_b128 v0, v[24:27] offset:29696
    v_cvt_pk_bf16_f32 v28, v104, v105
    v_cvt_pk_bf16_f32 v29, v106, v107
    v_cvt_pk_bf16_f32 v30, v108, v109
    v_cvt_pk_bf16_f32 v31, v110, v111
    ds_write_b128 v1, v[28:31] offset:29696
    s_mov_b64 exec, s[76:77]
    v_cvt_pk_bf16_f32 v32, v112, v113
    v_cvt_pk_bf16_f32 v33, v114, v115
    v_cvt_pk_bf16_f32 v34, v116, v117
    v_cvt_pk_bf16_f32 v35, v118, v119
    ds_write_b128 v0, v[32:35] offset:37888
    v_cvt_pk_bf16_f32 v36, v120, v121
    v_cvt_pk_bf16_f32 v37, v122, v123
    v_cvt_pk_bf16_f32 v38, v124, v125
    v_cvt_pk_bf16_f32 v39, v126, v127
    ds_write_b128 v1, v[36:39] offset:37888
    s_mov_b64 exec, -1
    s_waitcnt lgkmcnt(0)
    s_barrier
    buffer_load_dwordx4 v13, s[40:43], s72 offen offset:2048 lds
    buffer_load_dwordx4 v13, s[40:43], s73 offen offset:3072 lds
    v_xor_b32 v13, 16384, v13
    s_add_u32 m0, s70, 12288
    s_nop 0
    buffer_load_dwordx4 v13, s[40:43], 0 offen offset:0 lds
    buffer_load_dwordx4 v13, s[40:43], s71 offen offset:1024 lds
    buffer_load_dwordx4 v13, s[40:43], s72 offen offset:2048 lds
    buffer_load_dwordx4 v13, s[40:43], s73 offen offset:3072 lds
    v_xor_b32 v13, 114688, v13
    v_lshlrev_b32 v0, 4, v4
    v_and_b32 v1, 7, v3
    v_lshl_add_u32 v0, v1, 9, v0
    v_and_b32 v1, 8, v3
    v_lshl_add_u32 v0, v1, 3, v0
    s_mul_i32 s74, s1, 20480
    s_lshl_b32 s64, s31, 7
    s_add_u32 s74, s74, s64
    s_waitcnt vmcnt(8)
    ds_read_b64_tr_b16 v[48:49], v11 offset:0
    ds_read_b64_tr_b16 v[50:51], v11 offset:512
    ds_read_b64_tr_b16 v[52:53], v11 offset:8
    ds_read_b64_tr_b16 v[54:55], v11 offset:520
    ds_read_b64_tr_b16 v[56:57], v12 offset:0
    ds_read_b64_tr_b16 v[58:59], v12 offset:512
    ds_read_b64_tr_b16 v[60:61], v12 offset:8
    ds_read_b64_tr_b16 v[62:63], v12 offset:520
    ds_read_b64_tr_b16 v[64:65], v11 offset:4096
    ds_read_b64_tr_b16 v[66:67], v11 offset:4608
    ds_read_b64_tr_b16 v[68:69], v11 offset:4104
    ds_read_b64_tr_b16 v[70:71], v11 offset:4616
    ds_read_b64_tr_b16 v[72:73], v12 offset:4096
    ds_read_b64_tr_b16 v[74:75], v12 offset:4608
    ds_read_b64_tr_b16 v[76:77], v12 offset:4104
    ds_read_b64_tr_b16 v[78:79], v12 offset:4616
    s_waitcnt lgkmcnt(8)
    s_add_u32 m0, s70, 0
    s_nop 0
    buffer_load_dwordx4 v13, s[40:43], 0 offen offset:0 lds
    buffer_load_dwordx4 v13, s[40:43], s71 offen offset:1024 lds
    buffer_load_dwordx4 v13, s[40:43], s72 offen offset:2048 lds
    buffer_load_dwordx4 v13, s[40:43], s73 offen offset:3072 lds
    v_xor_b32 v13, 16384, v13
    s_waitcnt lgkmcnt(0)
    s_add_u32 m0, s70, 4096
    s_nop 0
    buffer_load_dwordx4 v13, s[40:43], 0 offen offset:0 lds
    buffer_load_dwordx4 v13, s[40:43], s71 offen offset:1024 lds
    buffer_load_dwordx4 v13, s[40:43], s72 offen offset:2048 lds
    buffer_load_dwordx4 v13, s[40:43], s73 offen offset:3072 lds
    v_xor_b32 v13, 49152, v13
    s_lshl_b32 s64, s31, 12
    s_add_u32 s78, s64, 21504
    s_add_u32 s79, s64, 148480
    s_cmp_eq_u32 s31, 3
    s_cselect_b32 s79, 37888, s79
    s_sub_u32 s76, s78, s70
    s_sub_u32 s77, s79, s78
    v_xor_b32 v40, 0x100, v7
    v_xor_b32 v41, 0x100, v8
    v_xor_b32 v42, 0x100, v9
    v_xor_b32 v43, 0x100, v10
    s_barrier
    s_mov_b32 m0, s78
    s_nop 0
    buffer_load_dwordx4 v13, s[40:43], 0 offen offset:0 lds
    buffer_load_dwordx4 v13, s[40:43], s71 offen offset:1024 lds
    buffer_load_dwordx4 v13, s[40:43], s72 offen offset:2048 lds
    buffer_load_dwordx4 v13, s[40:43], s73 offen offset:3072 lds
    v_xor_b32 v13, 16384, v13
    s_mov_b32 m0, s79
    s_nop 0
    buffer_load_dwordx4 v13, s[40:43], 0 offen offset:0 lds
    buffer_load_dwordx4 v13, s[40:43], s71 offen offset:1024 lds
    buffer_load_dwordx4 v13, s[40:43], s72 offen offset:2048 lds
    buffer_load_dwordx4 v13, s[40:43], s73 offen offset:3072 lds
    v_xor_b32 v13, 114688, v13
    s_setprio 0
L_prog_43:
    ds_read_b128 v[16:19], v5 offset:32
    s_waitcnt lgkmcnt(0)
    v_min3_u32 v16, v16, v17, v18
    v_min_u32 v16, v16, v19
    v_cmp_gt_u32 vcc, 1, v16
    s_cbranch_vccnz L_retry_44
    ds_read_b128 v[16:19], v7 offset:1024
    ds_read_b128 v[20:23], v7 offset:9216
    ds_read_b128 v[24:27], v7 offset:17408
    s_waitcnt vmcnt(8)
    s_waitcnt lgkmcnt(0)
    v_mfma_f32_16x16x32_bf16 v[80:83], v[128:131], v[16:19], 0
    ds_read_b128 v[28:31], v8 offset:1024
    v_mfma_f32_16x16x32_bf16 v[96:99], v[128:131], v[20:23], 0
    ds_read_b128 v[32:35], v8 offset:9216
    v_mfma_f32_16x16x32_bf16 v[112:115], v[128:131], v[24:27], 0
    ds_read_b128 v[36:39], v8 offset:17408
    v_mfma_f32_16x16x32_bf16 v[84:87], v[132:135], v[16:19], 0
    v_mfma_f32_16x16x32_bf16 v[100:103], v[132:135], v[20:23], 0
    v_mfma_f32_16x16x32_bf16 v[116:119], v[132:135], v[24:27], 0
    v_mfma_f32_16x16x32_bf16 v[88:91], v[136:139], v[16:19], 0
    v_mfma_f32_16x16x32_bf16 v[104:107], v[136:139], v[20:23], 0
    v_mfma_f32_16x16x32_bf16 v[120:123], v[136:139], v[24:27], 0
    v_mfma_f32_16x16x32_bf16 v[92:95], v[140:143], v[16:19], 0
    v_mfma_f32_16x16x32_bf16 v[108:111], v[140:143], v[20:23], 0
    v_mfma_f32_16x16x32_bf16 v[124:127], v[140:143], v[24:27], 0
    s_waitcnt lgkmcnt(0)
    v_mfma_f32_16x16x32_bf16 v[80:83], v[144:147], v[28:31], v[80:83]
    ds_read_b128 v[16:19], v9 offset:1024
    v_mfma_f32_16x16x32_bf16 v[96:99], v[144:147], v[32:35], v[96:99]
    ds_read_b128 v[20:23], v9 offset:9216
    v_mfma_f32_16x16x32_bf16 v[112:115], v[144:147], v[36:39], v[112:115]
    ds_read_b128 v[24:27], v9 offset:17408
    v_mfma_f32_16x16x32_bf16 v[84:87], v[148:151], v[28:31], v[84:87]
    ds_read_b64_tr_b16 v[128:129], v11 offset:8192
    v_mfma_f32_16x16x32_bf16 v[100:103], v[148:151], v[32:35], v[100:103]
    ds_read_b64_tr_b16 v[130:131], v11 offset:8704
    v_mfma_f32_16x16x32_bf16 v[116:119], v[148:151], v[36:39], v[116:119]
    ds_read_b64_tr_b16 v[132:133], v11 offset:8200
    v_mfma_f32_16x16x32_bf16 v[88:91], v[152:155], v[28:31], v[88:91]
    ds_read_b64_tr_b16 v[134:135], v11 offset:8712
    v_mfma_f32_16x16x32_bf16 v[104:107], v[152:155], v[32:35], v[104:107]
    ds_read_b64_tr_b16 v[136:137], v12 offset:8192
    v_mfma_f32_16x16x32_bf16 v[120:123], v[152:155], v[36:39], v[120:123]
    ds_read_b64_tr_b16 v[138:139], v12 offset:8704
    v_mfma_f32_16x16x32_bf16 v[92:95], v[156:159], v[28:31], v[92:95]
    ds_read_b64_tr_b16 v[140:141], v12 offset:8200
    v_mfma_f32_16x16x32_bf16 v[108:111], v[156:159], v[32:35], v[108:111]
    ds_read_b64_tr_b16 v[142:143], v12 offset:8712
    v_mfma_f32_16x16x32_bf16 v[124:127], v[156:159], v[36:39], v[124:127]
    s_waitcnt lgkmcnt(8)
    v_mfma_f32_16x16x32_bf16 v[80:83], v[160:163], v[16:19], v[80:83]
    ds_read_b128 v[28:31], v10 offset:1024
    v_mfma_f32_16x16x32_bf16 v[96:99], v[160:163], v[20:23], v[96:99]
    ds_read_b128 v[32:35], v10 offset:9216
    v_mfma_f32_16x16x32_bf16 v[112:115], v[160:163], v[24:27], v[112:115]
    ds_read_b128 v[36:39], v10 offset:17408
    v_mfma_f32_16x16x32_bf16 v[84:87], v[164:167], v[16:19], v[84:87]
    ds_read_b64_tr_b16 v[144:145], v11 offset:12288
    v_mfma_f32_16x16x32_bf16 v[100:103], v[164:167], v[20:23], v[100:103]
    ds_read_b64_tr_b16 v[146:147], v11 offset:12800
    v_mfma_f32_16x16x32_bf16 v[116:119], v[164:167], v[24:27], v[116:119]
    ds_read_b64_tr_b16 v[148:149], v11 offset:12296
    v_mfma_f32_16x16x32_bf16 v[88:91], v[168:171], v[16:19], v[88:91]
    ds_read_b64_tr_b16 v[150:151], v11 offset:12808
    v_mfma_f32_16x16x32_bf16 v[104:107], v[168:171], v[20:23], v[104:107]
    ds_read_b64_tr_b16 v[152:153], v12 offset:12288
    v_mfma_f32_16x16x32_bf16 v[120:123], v[168:171], v[24:27], v[120:123]
    ds_read_b64_tr_b16 v[154:155], v12 offset:12800
    v_mfma_f32_16x16x32_bf16 v[92:95], v[172:175], v[16:19], v[92:95]
    ds_read_b64_tr_b16 v[156:157], v12 offset:12296
    v_mfma_f32_16x16x32_bf16 v[108:111], v[172:175], v[20:23], v[108:111]
    ds_read_b64_tr_b16 v[158:159], v12 offset:12808
    v_mfma_f32_16x16x32_bf16 v[124:127], v[172:175], v[24:27], v[124:127]
    s_waitcnt lgkmcnt(8)
    v_mfma_f32_16x16x32_bf16 v[80:83], v[176:179], v[28:31], v[80:83]
    ds_read_b128 v[16:19], v40 offset:1024
    v_mfma_f32_16x16x32_bf16 v[96:99], v[176:179], v[32:35], v[96:99]
    ds_read_b128 v[20:23], v40 offset:9216
    v_mfma_f32_16x16x32_bf16 v[112:115], v[176:179], v[36:39], v[112:115]
    ds_read_b128 v[24:27], v40 offset:17408
    v_mfma_f32_16x16x32_bf16 v[84:87], v[180:183], v[28:31], v[84:87]
    ds_read_b64_tr_b16 v[160:161], v11 offset:0
    v_mfma_f32_16x16x32_bf16 v[100:103], v[180:183], v[32:35], v[100:103]
    ds_read_b64_tr_b16 v[162:163], v11 offset:512
    v_mfma_f32_16x16x32_bf16 v[116:119], v[180:183], v[36:39], v[116:119]
    ds_read_b64_tr_b16 v[164:165], v11 offset:8
    v_mfma_f32_16x16x32_bf16 v[88:91], v[184:187], v[28:31], v[88:91]
    ds_read_b64_tr_b16 v[166:167], v11 offset:520
    v_mfma_f32_16x16x32_bf16 v[104:107], v[184:187], v[32:35], v[104:107]
    ds_read_b64_tr_b16 v[168:169], v12 offset:0
    v_mfma_f32_16x16x32_bf16 v[120:123], v[184:187], v[36:39], v[120:123]
    ds_read_b64_tr_b16 v[170:171], v12 offset:512
    v_mfma_f32_16x16x32_bf16 v[92:95], v[188:191], v[28:31], v[92:95]
    ds_read_b64_tr_b16 v[172:173], v12 offset:8
    v_mfma_f32_16x16x32_bf16 v[108:111], v[188:191], v[32:35], v[108:111]
    ds_read_b64_tr_b16 v[174:175], v12 offset:520
    v_mfma_f32_16x16x32_bf16 v[124:127], v[188:191], v[36:39], v[124:127]
    s_waitcnt lgkmcnt(8)
    v_mfma_f32_16x16x32_bf16 v[80:83], v[192:195], v[16:19], v[80:83]
    ds_read_b128 v[28:31], v41 offset:1024
    v_mfma_f32_16x16x32_bf16 v[96:99], v[192:195], v[20:23], v[96:99]
    ds_read_b128 v[32:35], v41 offset:9216
    v_mfma_f32_16x16x32_bf16 v[112:115], v[192:195], v[24:27], v[112:115]
    ds_read_b128 v[36:39], v41 offset:17408
    v_mfma_f32_16x16x32_bf16 v[84:87], v[196:199], v[16:19], v[84:87]
    ds_read_b64_tr_b16 v[176:177], v11 offset:4096
    v_mfma_f32_16x16x32_bf16 v[100:103], v[196:199], v[20:23], v[100:103]
    ds_read_b64_tr_b16 v[178:179], v11 offset:4608
    v_mfma_f32_16x16x32_bf16 v[116:119], v[196:199], v[24:27], v[116:119]
    ds_read_b64_tr_b16 v[180:181], v11 offset:4104
    v_mfma_f32_16x16x32_bf16 v[88:91], v[200:203], v[16:19], v[88:91]
    ds_read_b64_tr_b16 v[182:183], v11 offset:4616
    v_mfma_f32_16x16x32_bf16 v[104:107], v[200:203], v[20:23], v[104:107]
    ds_read_b64_tr_b16 v[184:185], v12 offset:4096
    v_mfma_f32_16x16x32_bf16 v[120:123], v[200:203], v[24:27], v[120:123]
    ds_read_b64_tr_b16 v[186:187], v12 offset:4608
    v_mfma_f32_16x16x32_bf16 v[92:95], v[204:207], v[16:19], v[92:95]
    ds_read_b64_tr_b16 v[188:189], v12 offset:4104
    v_mfma_f32_16x16x32_bf16 v[108:111], v[204:207], v[20:23], v[108:111]
    ds_read_b64_tr_b16 v[190:191], v12 offset:4616
    v_mfma_f32_16x16x32_bf16 v[124:127], v[204:207], v[24:27], v[124:127]
    s_waitcnt lgkmcnt(8)
    v_mfma_f32_16x16x32_bf16 v[80:83], v[208:211], v[28:31], v[80:83]
    ds_read_b128 v[16:19], v42 offset:1024
    v_mfma_f32_16x16x32_bf16 v[96:99], v[208:211], v[32:35], v[96:99]
    ds_read_b128 v[20:23], v42 offset:9216
    v_mfma_f32_16x16x32_bf16 v[112:115], v[208:211], v[36:39], v[112:115]
    ds_read_b128 v[24:27], v42 offset:17408
    v_mfma_f32_16x16x32_bf16 v[84:87], v[212:215], v[28:31], v[84:87]
    v_mfma_f32_16x16x32_bf16 v[100:103], v[212:215], v[32:35], v[100:103]
    v_mfma_f32_16x16x32_bf16 v[116:119], v[212:215], v[36:39], v[116:119]
    v_mfma_f32_16x16x32_bf16 v[88:91], v[216:219], v[28:31], v[88:91]
    v_mfma_f32_16x16x32_bf16 v[104:107], v[216:219], v[32:35], v[104:107]
    v_mfma_f32_16x16x32_bf16 v[120:123], v[216:219], v[36:39], v[120:123]
    v_mfma_f32_16x16x32_bf16 v[92:95], v[220:223], v[28:31], v[92:95]
    v_mfma_f32_16x16x32_bf16 v[108:111], v[220:223], v[32:35], v[108:111]
    v_mfma_f32_16x16x32_bf16 v[124:127], v[220:223], v[36:39], v[124:127]
    s_waitcnt lgkmcnt(0)
    v_mfma_f32_16x16x32_bf16 v[80:83], v[224:227], v[16:19], v[80:83]
    v_add_u32 v11, s76, v11
    v_add_u32 v12, s76, v12
    v_mfma_f32_16x16x32_bf16 v[96:99], v[224:227], v[20:23], v[96:99]
    ds_read_b128 v[28:31], v43 offset:1024
    v_mfma_f32_16x16x32_bf16 v[112:115], v[224:227], v[24:27], v[112:115]
    ds_read_b128 v[32:35], v43 offset:9216
    v_mfma_f32_16x16x32_bf16 v[84:87], v[228:231], v[16:19], v[84:87]
    ds_read_b128 v[36:39], v43 offset:17408
    v_mfma_f32_16x16x32_bf16 v[100:103], v[228:231], v[20:23], v[100:103]
    s_waitcnt vmcnt(4)
    ds_read_b64_tr_b16 v[192:193], v11 offset:0
    v_mfma_f32_16x16x32_bf16 v[116:119], v[228:231], v[24:27], v[116:119]
    ds_read_b64_tr_b16 v[194:195], v11 offset:512
    v_mfma_f32_16x16x32_bf16 v[88:91], v[232:235], v[16:19], v[88:91]
    ds_read_b64_tr_b16 v[196:197], v11 offset:8
    v_mfma_f32_16x16x32_bf16 v[104:107], v[232:235], v[20:23], v[104:107]
    ds_read_b64_tr_b16 v[198:199], v11 offset:520
    v_mfma_f32_16x16x32_bf16 v[120:123], v[232:235], v[24:27], v[120:123]
    ds_read_b64_tr_b16 v[200:201], v12 offset:0
    v_mfma_f32_16x16x32_bf16 v[92:95], v[236:239], v[16:19], v[92:95]
    ds_read_b64_tr_b16 v[202:203], v12 offset:512
    v_mfma_f32_16x16x32_bf16 v[108:111], v[236:239], v[20:23], v[108:111]
    ds_read_b64_tr_b16 v[204:205], v12 offset:8
    v_mfma_f32_16x16x32_bf16 v[124:127], v[236:239], v[24:27], v[124:127]
    ds_read_b64_tr_b16 v[206:207], v12 offset:520
    s_waitcnt lgkmcnt(8)
    v_mfma_f32_16x16x32_bf16 v[80:83], v[240:243], v[28:31], v[80:83]
    v_add_u32 v11, s77, v11
    v_add_u32 v12, s77, v12
    v_mfma_f32_16x16x32_bf16 v[96:99], v[240:243], v[32:35], v[96:99]
    s_waitcnt vmcnt(0)
    ds_read_b64_tr_b16 v[208:209], v11 offset:0
    v_mfma_f32_16x16x32_bf16 v[112:115], v[240:243], v[36:39], v[112:115]
    ds_read_b64_tr_b16 v[210:211], v11 offset:512
    v_mfma_f32_16x16x32_bf16 v[84:87], v[244:247], v[28:31], v[84:87]
    ds_read_b64_tr_b16 v[212:213], v11 offset:8
    v_mfma_f32_16x16x32_bf16 v[100:103], v[244:247], v[32:35], v[100:103]
    ds_read_b64_tr_b16 v[214:215], v11 offset:520
    v_mfma_f32_16x16x32_bf16 v[116:119], v[244:247], v[36:39], v[116:119]
    ds_read_b64_tr_b16 v[216:217], v12 offset:0
    v_mfma_f32_16x16x32_bf16 v[88:91], v[248:251], v[28:31], v[88:91]
    ds_read_b64_tr_b16 v[218:219], v12 offset:512
    v_mfma_f32_16x16x32_bf16 v[104:107], v[248:251], v[32:35], v[104:107]
    ds_read_b64_tr_b16 v[220:221], v12 offset:8
    v_mfma_f32_16x16x32_bf16 v[120:123], v[248:251], v[36:39], v[120:123]
    ds_read_b64_tr_b16 v[222:223], v12 offset:520
    v_mfma_f32_16x16x32_bf16 v[92:95], v[252:255], v[28:31], v[92:95]
    v_mfma_f32_16x16x32_bf16 v[108:111], v[252:255], v[32:35], v[108:111]
    v_mfma_f32_16x16x32_bf16 v[124:127], v[252:255], v[36:39], v[124:127]
    s_add_u32 s75, s74, 4096
    s_add_u32 s76, s74, 8192
    s_add_u32 s77, s74, 12288
    s_add_u32 s78, s74, 16384
L_prog_45:
    ds_read_b128 v[16:19], v5 offset:32
    s_waitcnt lgkmcnt(0)
    v_min3_u32 v16, v16, v17, v18
    v_min_u32 v16, v16, v19
    v_cmp_gt_u32 vcc, 1, v16
    s_cbranch_vccnz L_retry_46
    ds_read_b128 v[16:19], v7 offset:58368
    ds_read_b128 v[20:23], v8 offset:58368
    ds_read_b128 v[24:27], v9 offset:58368
    ds_read_b128 v[28:31], v10 offset:58368
    ds_read_b128 v[32:35], v40 offset:58368
    ds_read_b128 v[36:39], v41 offset:58368
    ds_read_b128 v[44:47], v42 offset:58368
    ds_read_b128 v[252:255], v43 offset:58368
    s_waitcnt lgkmcnt(7)
    v_mfma_f32_16x16x32_bf16 v[120:123], v[56:59], v[16:19], v[120:123]
    v_mfma_f32_16x16x32_bf16 v[124:127], v[60:63], v[16:19], v[124:127]
    v_mfma_f32_16x16x32_bf16 v[112:115], v[48:51], v[16:19], v[112:115]
    v_mfma_f32_16x16x32_bf16 v[116:119], v[52:55], v[16:19], v[116:119]
    s_waitcnt lgkmcnt(6)
    v_mfma_f32_16x16x32_bf16 v[120:123], v[72:75], v[20:23], v[120:123]
    v_mfma_f32_16x16x32_bf16 v[124:127], v[76:79], v[20:23], v[124:127]
    v_mfma_f32_16x16x32_bf16 v[112:115], v[64:67], v[20:23], v[112:115]
    v_mfma_f32_16x16x32_bf16 v[116:119], v[68:71], v[20:23], v[116:119]
    s_waitcnt lgkmcnt(5)
    v_mfma_f32_16x16x32_bf16 v[120:123], v[136:139], v[24:27], v[120:123]
    v_mfma_f32_16x16x32_bf16 v[124:127], v[140:143], v[24:27], v[124:127]
    v_mfma_f32_16x16x32_bf16 v[112:115], v[128:131], v[24:27], v[112:115]
    v_mfma_f32_16x16x32_bf16 v[116:119], v[132:135], v[24:27], v[116:119]
    s_waitcnt lgkmcnt(4)
    v_mfma_f32_16x16x32_bf16 v[120:123], v[152:155], v[28:31], v[120:123]
    v_mfma_f32_16x16x32_bf16 v[124:127], v[156:159], v[28:31], v[124:127]
    v_mfma_f32_16x16x32_bf16 v[112:115], v[144:147], v[28:31], v[112:115]
    v_mfma_f32_16x16x32_bf16 v[116:119], v[148:151], v[28:31], v[116:119]
    s_waitcnt lgkmcnt(3)
    v_mfma_f32_16x16x32_bf16 v[120:123], v[168:171], v[32:35], v[120:123]
    v_mfma_f32_16x16x32_bf16 v[124:127], v[172:175], v[32:35], v[124:127]
    v_mfma_f32_16x16x32_bf16 v[112:115], v[160:163], v[32:35], v[112:115]
    v_mfma_f32_16x16x32_bf16 v[116:119], v[164:167], v[32:35], v[116:119]
    s_waitcnt lgkmcnt(2)
    v_mfma_f32_16x16x32_bf16 v[120:123], v[184:187], v[36:39], v[120:123]
    v_mfma_f32_16x16x32_bf16 v[124:127], v[188:191], v[36:39], v[124:127]
    v_mfma_f32_16x16x32_bf16 v[112:115], v[176:179], v[36:39], v[112:115]
    v_mfma_f32_16x16x32_bf16 v[116:119], v[180:183], v[36:39], v[116:119]
    s_waitcnt lgkmcnt(1)
    v_mfma_f32_16x16x32_bf16 v[120:123], v[200:203], v[44:47], v[120:123]
    v_mfma_f32_16x16x32_bf16 v[124:127], v[204:207], v[44:47], v[124:127]
    v_mfma_f32_16x16x32_bf16 v[112:115], v[192:195], v[44:47], v[112:115]
    v_mfma_f32_16x16x32_bf16 v[116:119], v[196:199], v[44:47], v[116:119]
    s_waitcnt lgkmcnt(0)
    v_mfma_f32_16x16x32_bf16 v[120:123], v[216:219], v[252:255], v[120:123]
    v_mfma_f32_16x16x32_bf16 v[124:127], v[220:223], v[252:255], v[124:127]
    v_mfma_f32_16x16x32_bf16 v[112:115], v[208:211], v[252:255], v[112:115]
    v_mfma_f32_16x16x32_bf16 v[116:119], v[212:215], v[252:255], v[116:119]
L_prog_47:
    ds_read_b128 v[16:19], v5 offset:32
    s_waitcnt lgkmcnt(0)
    v_min3_u32 v16, v16, v17, v18
    v_min_u32 v16, v16, v19
    v_cmp_gt_u32 vcc, 3, v16
    s_cbranch_vccnz L_retry_48
    ds_read_b128 v[16:19], v7 offset:41984
    ds_read_b128 v[20:23], v8 offset:41984
    ds_read_b128 v[24:27], v9 offset:41984
    ds_read_b128 v[28:31], v10 offset:41984
    ds_read_b128 v[32:35], v40 offset:41984
    ds_read_b128 v[36:39], v41 offset:41984
    ds_read_b128 v[44:47], v42 offset:41984
    ds_read_b128 v[252:255], v43 offset:41984
    s_waitcnt lgkmcnt(7)
    v_mfma_f32_16x16x32_bf16 v[88:91], v[56:59], v[16:19], v[88:91]
    v_cvt_pk_bf16_f32 v248, v120, v121
    v_mfma_f32_16x16x32_bf16 v[92:95], v[60:63], v[16:19], v[92:95]
    v_cvt_pk_bf16_f32 v249, v122, v123
    v_mfma_f32_16x16x32_bf16 v[80:83], v[48:51], v[16:19], v[80:83]
    v_cvt_pk_bf16_f32 v250, v124, v125
    v_mfma_f32_16x16x32_bf16 v[84:87], v[52:55], v[16:19], v[84:87]
    v_cvt_pk_bf16_f32 v251, v126, v127
    s_waitcnt lgkmcnt(6)
    v_mfma_f32_16x16x32_bf16 v[88:91], v[72:75], v[20:23], v[88:91]
    v_cvt_pk_bf16_f32 v244, v112, v113
    v_mfma_f32_16x16x32_bf16 v[92:95], v[76:79], v[20:23], v[92:95]
    v_cvt_pk_bf16_f32 v245, v114, v115
    v_mfma_f32_16x16x32_bf16 v[80:83], v[64:67], v[20:23], v[80:83]
    v_cvt_pk_bf16_f32 v246, v116, v117
    v_mfma_f32_16x16x32_bf16 v[84:87], v[68:71], v[20:23], v[84:87]
    v_cvt_pk_bf16_f32 v247, v118, v119
    s_waitcnt lgkmcnt(5)
    v_mfma_f32_16x16x32_bf16 v[88:91], v[136:139], v[24:27], v[88:91]
    v_mov_b32_dpp v244, v248 row_ror:8 row_mask:0xf bank_mask:0xc
    v_mfma_f32_16x16x32_bf16 v[92:95], v[140:143], v[24:27], v[92:95]
    v_mov_b32_dpp v245, v249 row_ror:8 row_mask:0xf bank_mask:0xc
    v_mfma_f32_16x16x32_bf16 v[80:83], v[128:131], v[24:27], v[80:83]
    v_mov_b32_dpp v246, v250 row_ror:8 row_mask:0xf bank_mask:0xc
    v_mfma_f32_16x16x32_bf16 v[84:87], v[132:135], v[24:27], v[84:87]
    v_mov_b32_dpp v247, v251 row_ror:8 row_mask:0xf bank_mask:0xc
    s_waitcnt lgkmcnt(4)
    v_mfma_f32_16x16x32_bf16 v[88:91], v[152:155], v[28:31], v[88:91]
    v_mfma_f32_16x16x32_bf16 v[92:95], v[156:159], v[28:31], v[92:95]
    v_mfma_f32_16x16x32_bf16 v[80:83], v[144:147], v[28:31], v[80:83]
    v_mfma_f32_16x16x32_bf16 v[84:87], v[148:151], v[28:31], v[84:87]
    s_waitcnt lgkmcnt(3)
    v_mfma_f32_16x16x32_bf16 v[88:91], v[168:171], v[32:35], v[88:91]
    v_mfma_f32_16x16x32_bf16 v[92:95], v[172:175], v[32:35], v[92:95]
    v_mfma_f32_16x16x32_bf16 v[80:83], v[160:163], v[32:35], v[80:83]
    v_mfma_f32_16x16x32_bf16 v[84:87], v[164:167], v[32:35], v[84:87]
    s_waitcnt lgkmcnt(2)
    v_mfma_f32_16x16x32_bf16 v[88:91], v[184:187], v[36:39], v[88:91]
    v_mfma_f32_16x16x32_bf16 v[92:95], v[188:191], v[36:39], v[92:95]
    v_mfma_f32_16x16x32_bf16 v[80:83], v[176:179], v[36:39], v[80:83]
    v_mfma_f32_16x16x32_bf16 v[84:87], v[180:183], v[36:39], v[84:87]
    s_waitcnt lgkmcnt(1)
    v_mfma_f32_16x16x32_bf16 v[88:91], v[200:203], v[44:47], v[88:91]
    v_mfma_f32_16x16x32_bf16 v[92:95], v[204:207], v[44:47], v[92:95]
    v_mfma_f32_16x16x32_bf16 v[80:83], v[192:195], v[44:47], v[80:83]
    v_mfma_f32_16x16x32_bf16 v[84:87], v[196:199], v[44:47], v[84:87]
    s_waitcnt lgkmcnt(0)
    v_mfma_f32_16x16x32_bf16 v[88:91], v[216:219], v[252:255], v[88:91]
    v_mfma_f32_16x16x32_bf16 v[92:95], v[220:223], v[252:255], v[92:95]
    v_mfma_f32_16x16x32_bf16 v[80:83], v[208:211], v[252:255], v[80:83]
    v_mfma_f32_16x16x32_bf16 v[84:87], v[212:215], v[252:255], v[84:87]
    s_nop 4
    v_cvt_pk_bf16_f32 v228, v88, v89
    v_cvt_pk_bf16_f32 v229, v90, v91
    v_cvt_pk_bf16_f32 v230, v92, v93
    v_cvt_pk_bf16_f32 v231, v94, v95
    v_cvt_pk_bf16_f32 v224, v80, v81
    v_cvt_pk_bf16_f32 v225, v82, v83
    v_cvt_pk_bf16_f32 v226, v84, v85
    v_cvt_pk_bf16_f32 v227, v86, v87
    v_cvt_pk_bf16_f32 v240, v80, v81
    v_cvt_pk_bf16_f32 v241, v82, v83
    v_cvt_pk_bf16_f32 v242, v84, v85
    v_cvt_pk_bf16_f32 v243, v86, v87
    v_mov_b32_dpp v224, v228 row_ror:8 row_mask:0xf bank_mask:0xc
    v_mov_b32_dpp v225, v229 row_ror:8 row_mask:0xf bank_mask:0xc
    v_mov_b32_dpp v226, v230 row_ror:8 row_mask:0xf bank_mask:0xc
    v_mov_b32_dpp v227, v231 row_ror:8 row_mask:0xf bank_mask:0xc
    v_mov_b32_dpp v228, v240 row_ror:8 row_mask:0xf bank_mask:0x3
    v_mov_b32_dpp v229, v241 row_ror:8 row_mask:0xf bank_mask:0x3
    v_mov_b32_dpp v230, v242 row_ror:8 row_mask:0xf bank_mask:0x3
    v_mov_b32_dpp v231, v243 row_ror:8 row_mask:0xf bank_mask:0x3
L_prog_49:
    ds_read_b128 v[16:19], v5 offset:48
    s_waitcnt lgkmcnt(0)
    v_min3_u32 v16, v16, v17, v18
    v_min_u32 v16, v16, v19
    v_cmp_gt_u32 vcc, 1, v16
    s_cbranch_vccnz L_retry_50
    s_setprio 2
    buffer_store_dwordx4 v[244:247], v0, s[48:51], s78 offen sc1
    buffer_store_dwordx4 v[224:227], v0, s[48:51], s74 offen sc1
    buffer_store_dwordx4 v[228:231], v0, s[48:51], s75 offen sc1
    s_setprio 0
    v_lshlrev_b32 v1, 4, v4
    v_lshl_add_u32 v1, v3, 9, v1
    s_barrier
    s_setprio 2
    ds_read_b128 v[16:19], v7 offset:50176
    ds_read_b128 v[20:23], v8 offset:50176
    ds_read_b128 v[24:27], v9 offset:50176
    ds_read_b128 v[28:31], v10 offset:50176
    ds_read_b128 v[32:35], v40 offset:50176
    ds_read_b128 v[36:39], v41 offset:50176
    ds_read_b128 v[44:47], v42 offset:50176
    ds_read_b128 v[252:255], v43 offset:50176
    s_waitcnt lgkmcnt(7)
    v_mfma_f32_16x16x32_bf16 v[104:107], v[56:59], v[16:19], v[104:107]
    v_mfma_f32_16x16x32_bf16 v[108:111], v[60:63], v[16:19], v[108:111]
    s_waitcnt lgkmcnt(6)
    v_mfma_f32_16x16x32_bf16 v[104:107], v[72:75], v[20:23], v[104:107]
    v_mfma_f32_16x16x32_bf16 v[108:111], v[76:79], v[20:23], v[108:111]
    s_waitcnt lgkmcnt(5)
    v_mfma_f32_16x16x32_bf16 v[104:107], v[136:139], v[24:27], v[104:107]
    v_mfma_f32_16x16x32_bf16 v[108:111], v[140:143], v[24:27], v[108:111]
    s_waitcnt lgkmcnt(4)
    v_mfma_f32_16x16x32_bf16 v[104:107], v[152:155], v[28:31], v[104:107]
    v_mfma_f32_16x16x32_bf16 v[108:111], v[156:159], v[28:31], v[108:111]
    s_waitcnt lgkmcnt(3)
    v_mfma_f32_16x16x32_bf16 v[104:107], v[168:171], v[32:35], v[104:107]
    v_mfma_f32_16x16x32_bf16 v[108:111], v[172:175], v[32:35], v[108:111]
    s_waitcnt lgkmcnt(2)
    v_mfma_f32_16x16x32_bf16 v[104:107], v[184:187], v[36:39], v[104:107]
    v_mfma_f32_16x16x32_bf16 v[108:111], v[188:191], v[36:39], v[108:111]
    s_waitcnt lgkmcnt(1)
    v_mfma_f32_16x16x32_bf16 v[104:107], v[200:203], v[44:47], v[104:107]
    v_mfma_f32_16x16x32_bf16 v[108:111], v[204:207], v[44:47], v[108:111]
    s_waitcnt lgkmcnt(0)
    v_mfma_f32_16x16x32_bf16 v[104:107], v[216:219], v[252:255], v[104:107]
    v_mfma_f32_16x16x32_bf16 v[108:111], v[220:223], v[252:255], v[108:111]
    v_mfma_f32_16x16x32_bf16 v[96:99], v[48:51], v[16:19], v[96:99]
    v_mfma_f32_16x16x32_bf16 v[100:103], v[52:55], v[16:19], v[100:103]
    v_mfma_f32_16x16x32_bf16 v[96:99], v[64:67], v[20:23], v[96:99]
    v_mfma_f32_16x16x32_bf16 v[100:103], v[68:71], v[20:23], v[100:103]
    v_mfma_f32_16x16x32_bf16 v[96:99], v[128:131], v[24:27], v[96:99]
    v_mfma_f32_16x16x32_bf16 v[100:103], v[132:135], v[24:27], v[100:103]
    v_mfma_f32_16x16x32_bf16 v[96:99], v[144:147], v[28:31], v[96:99]
    v_mfma_f32_16x16x32_bf16 v[100:103], v[148:151], v[28:31], v[100:103]
    v_cvt_pk_bf16_f32 v236, v104, v105
    v_mfma_f32_16x16x32_bf16 v[96:99], v[160:163], v[32:35], v[96:99]
    v_cvt_pk_bf16_f32 v237, v106, v107
    v_mfma_f32_16x16x32_bf16 v[100:103], v[164:167], v[32:35], v[100:103]
    v_cvt_pk_bf16_f32 v238, v108, v109
    v_mfma_f32_16x16x32_bf16 v[96:99], v[176:179], v[36:39], v[96:99]
    v_cvt_pk_bf16_f32 v239, v110, v111
    v_mfma_f32_16x16x32_bf16 v[100:103], v[180:183], v[36:39], v[100:103]
    buffer_store_dwordx4 v[236:239], v1, s[48:51], s76 offen offset:64 sc1
    v_mfma_f32_16x16x32_bf16 v[96:99], v[192:195], v[44:47], v[96:99]
    v_mfma_f32_16x16x32_bf16 v[100:103], v[196:199], v[44:47], v[100:103]
    v_mfma_f32_16x16x32_bf16 v[96:99], v[208:211], v[252:255], v[96:99]
    v_mfma_f32_16x16x32_bf16 v[100:103], v[212:215], v[252:255], v[100:103]
    s_nop 6
    v_cvt_pk_bf16_f32 v232, v96, v97
    v_cvt_pk_bf16_f32 v233, v98, v99
    v_cvt_pk_bf16_f32 v234, v100, v101
    v_cvt_pk_bf16_f32 v235, v102, v103
    buffer_store_dwordx4 v[232:235], v1, s[48:51], s76 offen offset:0 sc1
    s_or_b32 s64, s2, s3
    s_cbranch_scc1 L_noepoch_51
    v_mov_b32 v1, s30
    s_mov_b64 exec, 1
    buffer_store_dword v1, v5, s[44:47], 0 offen sc1
L_noepoch_51:
    s_endpgm
L_retry_39:
    s_sub_u32 s100, s100, 1
    s_cbranch_scc1 L_end
    s_sleep 1
    s_branch L_spin_38
L_mre_40:
    s_sub_u32 s100, s100, 1
    s_cbranch_scc1 L_end
    s_sleep 2
    buffer_load_dword v1, v0, s[44:47], s74 offen sc1
    s_waitcnt vmcnt(0)
    s_branch L_mchk_37
L_retry_42:
    s_sub_u32 s100, s100, 1
    s_cbranch_scc1 L_end
    s_sleep 1
    s_branch L_spin_41
L_retry_44:
    s_sub_u32 s100, s100, 1
    s_cbranch_scc1 L_end
    s_sleep 1
    s_branch L_prog_43
L_retry_46:
    s_sub_u32 s100, s100, 1
    s_cbranch_scc1 L_end
    s_sleep 1
    s_branch L_prog_45
L_retry_48:
    s_sub_u32 s100, s100, 1
    s_cbranch_scc1 L_end
    s_sleep 1
    s_branch L_prog_47
L_retry_50:
    s_sub_u32 s100, s100, 1
    s_cbranch_scc1 L_end
    s_sleep 1
    s_branch L_prog_49
L_end:
    s_endpgm
.section .rodata,"a"
.p2align 6
.amdhsa_kernel standalone__hybrid_graph_tf_exphormer__graph_kernel
  .amdhsa_next_free_vgpr 256
  .amdhsa_next_free_sgpr 102
  .amdhsa_accum_offset 256
  .amdhsa_group_segment_fixed_size 0
  .amdhsa_kernarg_size 104
  .amdhsa_user_sgpr_count 2
  .amdhsa_user_sgpr_kernarg_segment_ptr 1
  .amdhsa_system_sgpr_workgroup_id_x 1
  .amdhsa_float_denorm_mode_32 3
.end_amdhsa_kernel
```

```asm
; @launch grid=(253,1,1) block=(512,1,1) lds=161792
.amdgcn_target "amdgcn-amd-amdhsa--gfx950"
.text
.globl standalone__hybrid_graph_tf_exphormer__graph_kernel
.p2align 8
.type standalone__hybrid_graph_tf_exphormer__graph_kernel,@function
standalone__hybrid_graph_tf_exphormer__graph_kernel:
L_begin:
    s_cmp_ge_u32 s2, 253
    s_cbranch_scc1 L_end
    s_load_dwordx16 s[4:19], s[0:1], 0
    s_load_dwordx8 s[20:27], s[0:1], 64
    s_load_dwordx2 s[28:29], s[0:1], 96
    s_and_b32 s64, s2, 0xf8
    s_cmp_lg_u32 s64, 8
    s_cbranch_scc1 L_nopf
    s_getpc_b64 s[32:33]
L_pc:
    v_lshlrev_b32 v1, 6, v0
    v_min_u32 v1, L_end-L_pc, v1
    global_load_dword v255, v1, s[32:33]
L_nopf:
    v_lshrrev_b32 v1, 6, v0
    v_lshlrev_b32 v8, 4, v0
    v_mov_b32 v12, 1966080
    v_readfirstlane_b32 s3, v1
    v_mov_b32 v13, 1966080
    v_mov_b32 v14, 1966080
    v_mov_b32 v15, 1966080
    ds_write_b128 v8, v[12:15] offset:41984
    ds_write_b128 v8, v[12:15] offset:50176
    v_subrev_u32 v9, 32, v0
    v_cmp_gt_u32 vcc, 20, v9
    v_mul_u32_u24 v9, 264, v9
    v_add_u32 v9, 148480, v9
    v_lshlrev_b32 v10, 2, v0
    v_cndmask_b32 v9, 0, v9, vcc
    v_min_u32 v11, 1020, v10
    ds_write_b32 v11, v9
    v_mov_b32 v16, 1310740000
    v_mov_b32 v17, 1310740000
    v_mov_b32 v18, 1310740000
    v_mov_b32 v19, 1310740000
    v_add_u32 v9, 148480, v8
    ds_write_b128 v9, v[16:19]
    v_and_b32 v2, 63, v0
    v_and_b32 v3, 15, v0
    v_bfe_u32 v4, v0, 4, 2
    v_mov_b32 v5, 0
    v_mov_b32 v6, 1
    s_mov_b32 s100, 67108864
    s_and_b32 s64, s2, 7
    s_lshl_b32 s64, s64, 1
    s_bfe_u32 s65, s2, 0x10003
    s_or_b32 s64, s64, s65
    s_and_b32 s65, s2, 0xf0
    s_or_b32 s64, s64, s65
    s_cmp_lt_u32 s2, 240
    s_cselect_b32 s1, s64, s2
    s_and_b32 s31, s3, 3
    s_cmp_lt_u32 s3, 4
    s_cbranch_scc1 L_gemm
    s_setprio 3
    v_and_b32 v8, 0xfff, v8
    v_and_b32 v9, 0x3ff, v10
    s_lshr_b32 s66, s2, 4
    s_lshl_b32 s66, s66, 3
    s_and_b32 s67, s2, 7
    s_or_b32 s68, s66, s67
    s_mul_i32 s64, s68, 5120
    v_add_u32 v40, s64, v8
    s_add_u32 s64, s64, 4096
    v_add_u32 v41, s64, v9
    v_lshrrev_b32 v42, 2, v3
    v_and_b32 v43, 3, v3
    v_lshl_add_u32 v42, v42, 4, v43
    s_lshl_b32 s64, s31, 1
    v_mov_b32 v43, s64
    v_lshlrev_b32 v44, 1, v43
    v_cmp_gt_u32 vcc, 8, v3
    s_mul_i32 s65, s1, 640
    v_lshlrev_b32 v7, 4, v3
    v_cndmask_b32 v43, v43, v44, vcc
    v_add_lshl_u32 v42, v42, v43, 4
    v_lshl_add_u32 v42, v4, 2, v42
    v_add_u32 v42, s65, v42
    v_min_u32 v42, 159996, v42
    s_bitcmp1_b32 s2, 3
    s_cbranch_scc0 L_mrole_1
    s_waitcnt lgkmcnt(0)
    global_load_dword v0, v42, s[10:11] nt
    global_load_dwordx4 v[48:51], v40, s[8:9] nt
    global_load_dword v52, v41, s[8:9] nt
    global_load_dwordx4 v[56:59], v40, s[6:7] nt
    global_load_dword v60, v41, s[6:7] nt
L_roled_2:
    s_mov_b32 s27, s68
    s_mov_b32 s26, 0
    s_cmp_lg_u32 s31, 0
    s_cbranch_scc1 L_roled_2_b
    s_load_dword s30, s[28:29], 0
L_roled_2_b:
    s_barrier
    s_branch L_pastm
L_mrole_1:
    v_lshrrev_b32 v43, 5, v2
    s_lshl_b32 s66, s31, 2
    v_add_u32 v44, s66, v43
    v_and_b32 v46, 31, v2
    v_xor_b32 v46, v46, v44
    v_lshlrev_b32 v46, 4, v46
    v_lshl_add_u32 v46, v43, 9, v46
    s_bfe_u32 s64, s68, 0x30002
    s_lshl_b32 s64, s64, 14
    s_lshr_b32 s65, s68, 5
    s_lshl_b32 s65, s65, 15
    s_bfe_u32 s66, s68, 0x10001
    s_lshl_b32 s66, s66, 14
    s_add_u32 s65, s65, s66
    s_and_b32 s66, s68, 1
    s_lshl_b32 s66, s66, 11
    s_add_u32 s65, s65, s66
    s_lshl_b32 s66, s31, 12
    v_add_u32 v46, s66, v46
    v_add_u32 v44, s64, v46
    v_add_u32 v46, s65, v46
    v_xor_b32 v45, 0x420, v44
    v_xor_b32 v47, 0x420, v46
    s_lshl_b32 s66, s31, 11
    s_waitcnt lgkmcnt(0)
    global_load_dword v0, v42, s[10:11] nt
    s_add_u32 m0, s66, 62464
    s_nop 0
    global_load_lds_dwordx4 v46, s[20:21] offset:0
    s_add_u32 m0, s66, 63488
    s_nop 0
    global_load_lds_dwordx4 v47, s[20:21] offset:0
    s_add_u32 m0, s66, 21504
    s_nop 0
    global_load_lds_dwordx4 v44, s[18:19] offset:0
    s_add_u32 m0, s66, 22528
    s_nop 0
    global_load_lds_dwordx4 v45, s[18:19] offset:0
    s_add_u32 m0, s66, 27648
    s_nop 0
    global_load_lds_dwordx4 v44, s[18:19] offset:2048
    s_add_u32 m0, s66, 28672
    s_nop 0
    global_load_lds_dwordx4 v45, s[18:19] offset:2048
    s_branch L_roled_2
L_pastm:
    s_mov_b32 s32, s4
    s_and_b32 s33, s5, 0xffff
    s_mov_b32 s34, 5120000
    s_mov_b32 s35, 0x20000
    s_mov_b32 s36, s14
    s_and_b32 s37, s15, 0xffff
    s_mov_b32 s38, 20000
    s_mov_b32 s39, 0x20000
    s_add_u32 s40, s28, 1048576
    s_addc_u32 s41, s29, 0
    s_and_b32 s41, s41, 0xffff
    s_mov_b32 s42, 2048000
    s_mov_b32 s43, 0x20000
    v_and_b32 v40, 8, v3
    v_lshlrev_b32 v40, 1, v40
    v_mov_b32 v41, 0xffff
    v_lshlrev_b32 v40, v40, v41
    s_mov_b32 s64, 0x0f0f0f0f
    s_mov_b32 s65, 0x0f0f0f0f
    v_cndmask_b32 v12, 0, v40, s[64:65]
    v_xor_b32 v13, v40, v12
    v_and_b32 v14, 3, v3
    v_mul_u32_u24 v14, 0x5555, v14
    s_cmp_lg_u32 s31, 0
    s_cbranch_scc1 L_tagged_3
    s_waitcnt lgkmcnt(0)
    s_mul_i32 s30, s30, 0x9E3779B1
    s_add_u32 s30, s30, 0x7F4A7C15
    v_mov_b32 v40, 1
    v_mov_b32 v41, s30
    ds_write_b64 v5, v[40:41] offset:8
L_tagged_3:
    s_bitcmp1_b32 s2, 3
    s_cbranch_scc0 L_mwork_4
    v_mov_b32 v43, 4
    v_mov_b32 v44, 2031616
    s_mov_b32 s64, 0x3f0001
    v_lshrrev_b32 v40, 6, v8
    v_and_b32 v41, 0x30, v8
    v_lshl_add_u32 v40, v40, 14, v41
    s_lshl_b32 s68, s27, 6
    s_add_u32 s69, s68, 0x100000
    s_add_u32 s70, s68, 8192
    s_add_u32 s71, s69, 8192
    s_mov_b32 s65, 0x203c
    s_waitcnt vmcnt(2)
    v_mul_u32_u24 v64, 52429, v48
    v_lshrrev_b32 v72, 22, v64
    v_lshlrev_b32 v80, 2, v72
    ds_add_rtn_u32 v80, v80, v43 offset:512
    v_mul_u32_u24 v65, 52429, v49
    v_lshrrev_b32 v73, 22, v65
    v_lshlrev_b32 v81, 2, v73
    ds_add_rtn_u32 v81, v81, v43 offset:512
    v_mul_u32_u24 v66, 52429, v50
    v_lshrrev_b32 v74, 22, v66
    v_lshlrev_b32 v82, 2, v74
    ds_add_rtn_u32 v82, v82, v43 offset:512
    v_mul_u32_u24 v67, 52429, v51
    v_lshrrev_b32 v75, 22, v67
    v_lshlrev_b32 v83, 2, v75
    ds_add_rtn_u32 v83, v83, v43 offset:512
    v_mul_u32_u24 v68, 52429, v52
    v_lshrrev_b32 v76, 22, v68
    v_lshlrev_b32 v84, 2, v76
    ds_add_rtn_u32 v84, v84, v43 offset:512
    v_lshrrev_b32 v64, 21, v64
    v_mad_u32_u24 v64, v64, 24, v48
    v_mul_u32_u24 v64, 0x8001, v64
    v_bfe_u32 v88, v72, 1, 2
    v_lshl_or_b32 v72, v72, 2, v88
    v_lshlrev_b32 v72, 4, v72
    v_lshrrev_b32 v65, 21, v65
    v_mad_u32_u24 v65, v65, 24, v49
    v_mul_u32_u24 v65, 0x8001, v65
    v_bfe_u32 v89, v73, 1, 2
    v_lshl_or_b32 v73, v73, 2, v89
    v_lshlrev_b32 v73, 4, v73
    v_lshrrev_b32 v66, 21, v66
    v_mad_u32_u24 v66, v66, 24, v50
    v_mul_u32_u24 v66, 0x8001, v66
    v_bfe_u32 v90, v74, 1, 2
    v_lshl_or_b32 v74, v74, 2, v90
    v_lshlrev_b32 v74, 4, v74
    v_lshrrev_b32 v67, 21, v67
    v_mad_u32_u24 v67, v67, 24, v51
    v_mul_u32_u24 v67, 0x8001, v67
    v_bfe_u32 v91, v75, 1, 2
    v_lshl_or_b32 v75, v75, 2, v91
    v_lshlrev_b32 v75, 4, v75
    v_lshrrev_b32 v68, 21, v68
    v_mad_u32_u24 v68, v68, 24, v52
    v_mul_u32_u24 v68, 0x8001, v68
    v_bfe_u32 v92, v76, 1, 2
    v_lshl_or_b32 v76, v76, 2, v92
    v_lshlrev_b32 v76, 4, v76
    s_waitcnt vmcnt(0)
    v_lshlrev_b32 v56, 1, v56
    v_and_or_b32 v64, v64, s64, v56
    v_lshlrev_b32 v57, 1, v57
    v_and_or_b32 v65, v65, s64, v57
    v_lshlrev_b32 v58, 1, v58
    v_and_or_b32 v66, v66, s64, v58
    v_lshlrev_b32 v59, 1, v59
    v_and_or_b32 v67, v67, s64, v59
    v_lshlrev_b32 v60, 1, v60
    v_and_or_b32 v68, v68, s64, v60
    s_waitcnt lgkmcnt(0)
    v_cmp_gt_u32 vcc, 124, v80
    v_min_u32 v80, 124, v80
    v_lshl_or_b32 v80, v80, 7, v80
    v_cndmask_b32 v64, v44, v64, vcc
    v_bitop3_b32 v80, v80, s65, v72 bitop3:0x6a
    ds_write_b32 v80, v64 offset:41984
    v_cmp_gt_u32 vcc, 124, v81
    v_min_u32 v81, 124, v81
    v_lshl_or_b32 v81, v81, 7, v81
    v_cndmask_b32 v65, v44, v65, vcc
    v_bitop3_b32 v81, v81, s65, v73 bitop3:0x6a
    ds_write_b32 v81, v65 offset:41984
    v_cmp_gt_u32 vcc, 124, v82
    v_min_u32 v82, 124, v82
    v_lshl_or_b32 v82, v82, 7, v82
    v_cndmask_b32 v66, v44, v66, vcc
    v_bitop3_b32 v82, v82, s65, v74 bitop3:0x6a
    ds_write_b32 v82, v66 offset:41984
    v_cmp_gt_u32 vcc, 124, v83
    v_min_u32 v83, 124, v83
    v_lshl_or_b32 v83, v83, 7, v83
    v_cndmask_b32 v67, v44, v67, vcc
    v_bitop3_b32 v83, v83, s65, v75 bitop3:0x6a
    ds_write_b32 v83, v67 offset:41984
    v_cmp_gt_u32 vcc, 124, v84
    v_min_u32 v84, 124, v84
    v_lshl_or_b32 v84, v84, 7, v84
    v_cndmask_b32 v68, v44, v68, vcc
    v_bitop3_b32 v84, v84, s65, v76 bitop3:0x6a
    ds_write_b32 v84, v68 offset:41984
    s_waitcnt lgkmcnt(0)
    s_barrier
    ds_read_b32 v44, v5 offset:12
    ds_read_b128 v[48:51], v8 offset:41984
    ds_read_b128 v[52:55], v8 offset:46080
    ds_read_b128 v[56:59], v8 offset:50176
    ds_read_b128 v[60:63], v8 offset:54272
    s_waitcnt lgkmcnt(4)
    v_readfirstlane_b32 s30, v44
    s_nop 0
    s_and_b32 s44, s30, 0xffc00000
    s_lshl_b32 s45, s30, 10
    s_and_b32 s45, s45, 0xffc00000
    s_lshl_b32 s46, s30, 20
    s_and_b32 s46, s46, 0xffc00000
    s_lshl_b32 s47, s30, 22
    s_waitcnt lgkmcnt(3)
    v_cmp_eq_u32 vcc, 1966080, v51
    v_or_b32 v48, s44, v48
    v_or_b32 v49, s45, v49
    v_or_b32 v50, s46, v50
    v_or_b32 v51, s47, v51
    buffer_store_dwordx4 v[48:51], v40, s[40:43], s68 offen sc1
    s_wqm_b64 s[72:73], vcc
    s_waitcnt lgkmcnt(2)
    v_cmp_eq_u32 vcc, 1966080, v55
    v_or_b32 v52, s44, v52
    v_or_b32 v53, s45, v53
    v_or_b32 v54, s46, v54
    v_or_b32 v55, s47, v55
    buffer_store_dwordx4 v[52:55], v40, s[40:43], s69 offen sc1
    s_wqm_b64 s[74:75], vcc
    s_waitcnt lgkmcnt(1)
    s_not_b64 exec, s[72:73]
    s_cbranch_scc0 L_nosec_8
    v_or_b32 v56, s44, v56
    v_or_b32 v57, s45, v57
    v_or_b32 v58, s46, v58
    v_or_b32 v59, s47, v59
    buffer_store_dwordx4 v[56:59], v40, s[40:43], s70 offen sc1
L_nosec_8:
    s_waitcnt lgkmcnt(0)
    s_not_b64 exec, s[74:75]
    s_cbranch_scc0 L_nosec_9
    v_or_b32 v60, s44, v60
    v_or_b32 v61, s45, v61
    v_or_b32 v62, s46, v62
    v_or_b32 v63, s47, v63
    buffer_store_dwordx4 v[60:63], v40, s[40:43], s71 offen sc1
L_nosec_9:
    s_mov_b64 exec, -1
    s_cmp_ge_u32 s2, 250
    s_cbranch_scc1 L_end
L_worked_5:
    v_lshlrev_b32 v0, 9, v0
    s_setprio 1
    s_lshl_b32 s64, s31, 10
    s_lshr_b32 s10, s1, 1
    s_lshl_b32 s10, s10, 14
    s_add_u32 s11, s10, 4096
    s_add_u32 s12, s10, 8192
    s_add_u32 s13, s10, 12288
    v_cmp_gt_u32 vcc, 0xf40, v8
    s_mov_b64 s[14:15], vcc
    v_add_u32_dpp v9, v0, v7 row_newbcast:0 row_mask:0xf bank_mask:0xf
    buffer_load_dwordx4 v[176:179], v9, s[32:35], 0 offen offset:0
    buffer_load_dwordx4 v[180:183], v9, s[32:35], 0 offen offset:256
    v_add_u32_dpp v9, v0, v7 row_newbcast:1 row_mask:0xf bank_mask:0xf
    buffer_load_dwordx4 v[184:187], v9, s[32:35], 0 offen offset:0
    buffer_load_dwordx4 v[188:191], v9, s[32:35], 0 offen offset:256
    s_add_u32 m0, s64, 62464
    s_mov_b32 s65, 0
    buffer_load_dwordx4 v8, s[36:39], s65 offen lds
    v_add_u32_dpp v9, v0, v7 row_newbcast:2 row_mask:0xf bank_mask:0xf
    s_cmp_eq_u32 s26, 2
    s_cbranch_scc1 L_loose_10
    s_waitcnt vmcnt(2)
L_loose_10:
    s_waitcnt vmcnt(6)
    buffer_load_dwordx4 v[192:195], v9, s[32:35], 0 offen offset:0
    buffer_load_dwordx4 v[196:199], v9, s[32:35], 0 offen offset:256
    s_add_u32 m0, s64, 66560
    s_mov_b32 s65, 4096
    buffer_load_dwordx4 v8, s[36:39], s65 offen lds
    v_add_u32_dpp v9, v0, v7 row_newbcast:3 row_mask:0xf bank_mask:0xf
    s_cmp_eq_u32 s26, 2
    s_cbranch_scc1 L_loose_11
    s_waitcnt vmcnt(2)
L_loose_11:
    s_waitcnt vmcnt(6)
    buffer_load_dwordx4 v[200:203], v9, s[32:35], 0 offen offset:0
    buffer_load_dwordx4 v[204:207], v9, s[32:35], 0 offen offset:256
    s_add_u32 m0, s64, 70656
    s_mov_b32 s65, 8192
    buffer_load_dwordx4 v8, s[36:39], s65 offen lds
    v_add_u32_dpp v9, v0, v7 row_newbcast:4 row_mask:0xf bank_mask:0xf
    s_cmp_eq_u32 s26, 2
    s_cbranch_scc1 L_loose_12
    s_waitcnt vmcnt(2)
L_loose_12:
    s_waitcnt vmcnt(6)
    buffer_load_dwordx4 v[208:211], v9, s[32:35], 0 offen offset:0
    buffer_load_dwordx4 v[212:215], v9, s[32:35], 0 offen offset:256
    s_add_u32 m0, s64, 74752
    s_mov_b32 s65, 12288
    buffer_load_dwordx4 v8, s[36:39], s65 offen lds
    v_add_u32_dpp v9, v0, v7 row_newbcast:5 row_mask:0xf bank_mask:0xf
    s_cmp_eq_u32 s26, 2
    s_cbranch_scc1 L_loose_13
    s_waitcnt vmcnt(2)
L_loose_13:
    s_waitcnt vmcnt(6)
    buffer_load_dwordx4 v[216:219], v9, s[32:35], 0 offen offset:0
    buffer_load_dwordx4 v[220:223], v9, s[32:35], 0 offen offset:256
    s_add_u32 m0, s64, 78848
    s_mov_b32 s65, 16384
    buffer_load_dwordx4 v8, s[36:39], s65 offen lds
L_ipoll_14:
    buffer_load_dwordx4 v[48:51], v8, s[40:43], s10 offen sc1
    s_mov_b64 exec, s[14:15]
    buffer_load_dwordx4 v[52:55], v8, s[40:43], s11 offen sc1
    s_mov_b64 exec, -1
L_spin_15:
    ds_read_b128 v[44:47], v5
    s_waitcnt lgkmcnt(0)
    v_readfirstlane_b32 s101, v46
    v_readfirstlane_b32 s30, v47
    s_cmp_ge_u32 s101, 1
    s_cbranch_scc0 L_retry_16
    s_and_b32 s44, s30, 0xffc00000
    s_lshl_b32 s45, s30, 10
    s_and_b32 s45, s45, 0xffc00000
    s_lshl_b32 s46, s30, 20
    s_and_b32 s46, s46, 0xffc00000
    s_lshl_b32 s47, s30, 22
    s_and_b32 s64, s1, 1
    s_lshl_b32 s64, s64, 21
    s_xor_b32 s17, s64, 1966080
    s_or_b32 s44, s44, s64
    v_mov_b32 v68, s17
    s_or_b32 s45, s45, s64
    v_mov_b32 v69, s17
    s_or_b32 s46, s46, s64
    v_mov_b32 v70, s17
    s_or_b32 s47, s47, s64
    v_mov_b32 v71, s17
    s_mov_b32 s16, 1310720
    v_mov_b32 v42, 2
    s_waitcnt vmcnt(1)
    v_xor_b32 v64, s44, v48
    v_xor_b32 v65, s45, v49
    v_xor_b32 v66, s46, v50
    v_xor_b32 v67, s47, v51
    v_or3_b32 v40, v64, v65, v66
    v_or_b32 v40, v40, v67
    v_cmp_eq_u32 s[72:73], s17, v67
    v_cmp_gt_u32 s[48:49], s16, v64
    v_lshlrev_b32_sdwa v80, 2, v64 dst_sel:DWORD dst_unused:UNUSED_PAD src0_sel:DWORD src1_sel:WORD_1
    v_cmp_gt_u32 s[50:51], s16, v65
    v_lshlrev_b32_sdwa v81, 2, v65 dst_sel:DWORD dst_unused:UNUSED_PAD src0_sel:DWORD src1_sel:WORD_1
    v_cmp_gt_u32 s[52:53], s16, v66
    v_lshlrev_b32_sdwa v82, 2, v66 dst_sel:DWORD dst_unused:UNUSED_PAD src0_sel:DWORD src1_sel:WORD_1
    v_cmp_gt_u32 s[54:55], s16, v67
    v_lshlrev_b32_sdwa v83, 2, v67 dst_sel:DWORD dst_unused:UNUSED_PAD src0_sel:DWORD src1_sel:WORD_1
    s_waitcnt vmcnt(0)
    s_mov_b64 exec, s[14:15]
    v_xor_b32 v68, s44, v52
    v_xor_b32 v69, s45, v53
    v_xor_b32 v70, s46, v54
    v_xor_b32 v71, s47, v55
    s_mov_b64 exec, -1
    v_or3_b32 v40, v40, v68, v69
    v_or3_b32 v40, v40, v70, v71
    v_cmp_eq_u32 s[74:75], s17, v71
    v_cmp_le_u32 vcc, 0x400000, v40
    s_cbranch_vccnz L_retry_17
    s_wqm_b64 s[72:73], s[72:73]
    s_not_b64 exec, s[72:73]
    s_cbranch_scc0 L_nosec_18
    buffer_load_dwordx4 v[56:59], v8, s[40:43], s12 offen sc1
L_nosec_18:
    s_wqm_b64 s[74:75], s[74:75]
    s_not_b64 exec, s[74:75]
    s_cbranch_scc0 L_nosec_19
    buffer_load_dwordx4 v[60:63], v8, s[40:43], s13 offen sc1
L_nosec_19:
    s_mov_b64 exec, -1
    v_cmp_gt_u32 s[56:57], s16, v68
    v_lshlrev_b32_sdwa v84, 2, v68 dst_sel:DWORD dst_unused:UNUSED_PAD src0_sel:DWORD src1_sel:WORD_1
    v_cmp_gt_u32 s[58:59], s16, v69
    v_lshlrev_b32_sdwa v85, 2, v69 dst_sel:DWORD dst_unused:UNUSED_PAD src0_sel:DWORD src1_sel:WORD_1
    v_cmp_gt_u32 s[60:61], s16, v70
    v_lshlrev_b32_sdwa v86, 2, v70 dst_sel:DWORD dst_unused:UNUSED_PAD src0_sel:DWORD src1_sel:WORD_1
    v_cmp_gt_u32 s[62:63], s16, v71
    v_lshlrev_b32_sdwa v87, 2, v71 dst_sel:DWORD dst_unused:UNUSED_PAD src0_sel:DWORD src1_sel:WORD_1
    s_mov_b64 exec, s[48:49]
    ds_add_rtn_u32 v80, v80, v42 offset:128
    s_mov_b64 exec, s[50:51]
    ds_add_rtn_u32 v81, v81, v42 offset:128
    s_mov_b64 exec, s[52:53]
    ds_add_rtn_u32 v82, v82, v42 offset:128
    s_mov_b64 exec, s[54:55]
    ds_add_rtn_u32 v83, v83, v42 offset:128
    s_mov_b64 exec, s[56:57]
    ds_add_rtn_u32 v84, v84, v42 offset:128
    s_mov_b64 exec, s[58:59]
    ds_add_rtn_u32 v85, v85, v42 offset:128
    s_mov_b64 exec, s[60:61]
    ds_add_rtn_u32 v86, v86, v42 offset:128
    s_mov_b64 exec, s[62:63]
    ds_add_rtn_u32 v87, v87, v42 offset:128
    s_mov_b64 exec, -1
    v_add_u32_dpp v9, v0, v7 row_newbcast:6 row_mask:0xf bank_mask:0xf
    buffer_load_dwordx4 v[224:227], v9, s[32:35], 0 offen offset:0
    buffer_load_dwordx4 v[228:231], v9, s[32:35], 0 offen offset:256
    v_add_u32_dpp v9, v0, v7 row_newbcast:7 row_mask:0xf bank_mask:0xf
    buffer_load_dwordx4 v[232:235], v9, s[32:35], 0 offen offset:0
    buffer_load_dwordx4 v[236:239], v9, s[32:35], 0 offen offset:256
    s_waitcnt lgkmcnt(4)
    s_mov_b64 exec, s[48:49]
    ds_write_b16 v80, v64
    s_mov_b64 exec, s[50:51]
    ds_write_b16 v81, v65
    s_mov_b64 exec, s[52:53]
    ds_write_b16 v82, v66
    s_mov_b64 exec, s[54:55]
    ds_write_b16 v83, v67
    s_waitcnt lgkmcnt(4)
    s_mov_b64 exec, s[56:57]
    ds_write_b16 v84, v68
    s_mov_b64 exec, s[58:59]
    ds_write_b16 v85, v69
    s_mov_b64 exec, s[60:61]
    ds_write_b16 v86, v70
    s_mov_b64 exec, s[62:63]
    ds_write_b16 v87, v71
    s_not_b64 exec, s[72:73]
    s_cbranch_scc0 L_secdone_21
    s_waitcnt vmcnt(4)
L_sec_20:
    v_xor_b32 v72, s44, v56
    v_xor_b32 v73, s45, v57
    v_xor_b32 v74, s46, v58
    v_xor_b32 v75, s47, v59
    v_or3_b32 v40, v72, v73, v74
    v_or_b32 v40, v40, v75
    v_cmp_le_u32 vcc, 0x400000, v40
    s_cbranch_vccnz L_retry_23
    v_and_b32 v40, 2031616, v75
    v_cmp_eq_u32 vcc, 2031616, v40
    v_cmp_gt_u32 s[64:65], s16, v72
    v_lshlrev_b32_sdwa v88, 2, v72 dst_sel:DWORD dst_unused:UNUSED_PAD src0_sel:DWORD src1_sel:WORD_1
    v_cmp_gt_u32 s[66:67], s16, v73
    v_lshlrev_b32_sdwa v89, 2, v73 dst_sel:DWORD dst_unused:UNUSED_PAD src0_sel:DWORD src1_sel:WORD_1
    v_cmp_gt_u32 s[68:69], s16, v74
    v_lshlrev_b32_sdwa v90, 2, v74 dst_sel:DWORD dst_unused:UNUSED_PAD src0_sel:DWORD src1_sel:WORD_1
    v_cmp_gt_u32 s[70:71], s16, v75
    v_lshlrev_b32_sdwa v91, 2, v75 dst_sel:DWORD dst_unused:UNUSED_PAD src0_sel:DWORD src1_sel:WORD_1
    s_mov_b64 exec, s[64:65]
    ds_add_rtn_u32 v88, v88, v42 offset:128
    s_mov_b64 exec, s[66:67]
    ds_add_rtn_u32 v89, v89, v42 offset:128
    s_mov_b64 exec, s[68:69]
    ds_add_rtn_u32 v90, v90, v42 offset:128
    s_mov_b64 exec, s[70:71]
    ds_add_rtn_u32 v91, v91, v42 offset:128
    s_mov_b64 exec, vcc
    ds_write_b32 v5, v6 offset:20
    s_waitcnt lgkmcnt(0)
    s_mov_b64 exec, s[64:65]
    ds_write_b16 v88, v72
    s_mov_b64 exec, s[66:67]
    ds_write_b16 v89, v73
    s_mov_b64 exec, s[68:69]
    ds_write_b16 v90, v74
    s_mov_b64 exec, s[70:71]
    ds_write_b16 v91, v75
L_secdone_21:
    s_not_b64 exec, s[74:75]
    s_cbranch_scc0 L_secdone_25
    s_waitcnt vmcnt(4)
L_sec_24:
    v_xor_b32 v76, s44, v60
    v_xor_b32 v77, s45, v61
    v_xor_b32 v78, s46, v62
    v_xor_b32 v79, s47, v63
    v_or3_b32 v40, v76, v77, v78
    v_or_b32 v40, v40, v79
    v_cmp_le_u32 vcc, 0x400000, v40
    s_cbranch_vccnz L_retry_27
    v_and_b32 v40, 2031616, v79
    v_cmp_eq_u32 vcc, 2031616, v40
    v_cmp_gt_u32 s[64:65], s16, v76
    v_lshlrev_b32_sdwa v92, 2, v76 dst_sel:DWORD dst_unused:UNUSED_PAD src0_sel:DWORD src1_sel:WORD_1
    v_cmp_gt_u32 s[66:67], s16, v77
    v_lshlrev_b32_sdwa v93, 2, v77 dst_sel:DWORD dst_unused:UNUSED_PAD src0_sel:DWORD src1_sel:WORD_1
    v_cmp_gt_u32 s[68:69], s16, v78
    v_lshlrev_b32_sdwa v94, 2, v78 dst_sel:DWORD dst_unused:UNUSED_PAD src0_sel:DWORD src1_sel:WORD_1
    v_cmp_gt_u32 s[70:71], s16, v79
    v_lshlrev_b32_sdwa v95, 2, v79 dst_sel:DWORD dst_unused:UNUSED_PAD src0_sel:DWORD src1_sel:WORD_1
    s_mov_b64 exec, s[64:65]
    ds_add_rtn_u32 v92, v92, v42 offset:128
    s_mov_b64 exec, s[66:67]
    ds_add_rtn_u32 v93, v93, v42 offset:128
    s_mov_b64 exec, s[68:69]
    ds_add_rtn_u32 v94, v94, v42 offset:128
    s_mov_b64 exec, s[70:71]
    ds_add_rtn_u32 v95, v95, v42 offset:128
    s_mov_b64 exec, vcc
    ds_write_b32 v5, v6 offset:20
    s_waitcnt lgkmcnt(0)
    s_mov_b64 exec, s[64:65]
    ds_write_b16 v92, v76
    s_mov_b64 exec, s[66:67]
    ds_write_b16 v93, v77
    s_mov_b64 exec, s[68:69]
    ds_write_b16 v94, v78
    s_mov_b64 exec, s[70:71]
    ds_write_b16 v95, v79
L_secdone_25:
    s_waitcnt lgkmcnt(0)
    s_mov_b64 exec, 1
    ds_add_u32 v5, v6 offset:16
    s_mov_b64 exec, -1
    v_add_u32_dpp v9, v0, v7 row_newbcast:8 row_mask:0xf bank_mask:0xf
    buffer_load_dwordx4 v[240:243], v9, s[32:35], 0 offen offset:0
    buffer_load_dwordx4 v[244:247], v9, s[32:35], 0 offen offset:256
    v_add_u32_dpp v9, v0, v7 row_newbcast:9 row_mask:0xf bank_mask:0xf
    buffer_load_dwordx4 v[248:251], v9, s[32:35], 0 offen offset:0
    buffer_load_dwordx4 v[252:255], v9, s[32:35], 0 offen offset:256
    s_lshl_b32 s20, s31, 1
    s_add_u32 s21, s20, 1
    s_add_u32 s22, s20, 8
    s_add_u32 s23, s20, 9
    s_add_u32 s24, s31, 16
    v_add_u32 v47, -1, v3
    v_bfe_u32 v40, v47, 1, 1
    v_and_b32 v41, 1, v47
    v_lshl_add_u32 v40, v40, 3, v41
    v_add_u32 v40, s20, v40
    v_mov_b32 v41, s24
    v_cmp_ne_u32 vcc, 0, v3
    v_min_u32 v47, 19, v2
    v_mul_u32_u24 v46, 264, v47
    v_cndmask_b32 v40, v41, v40, vcc
    v_mul_u32_u24 v41, 264, v40
    v_add_u32 v41, 148480, v41
    v_lshlrev_b32 v40, 2, v40
    v_add_u32 v46, 148728, v46
    v_lshlrev_b32 v47, 2, v47
    v_lshlrev_b32 v43, 3, v3
    v_lshl_add_u32 v43, v4, 1, v43
L_spin_28:
    ds_read_b32 v44, v5 offset:16
    s_waitcnt lgkmcnt(0)
    v_readfirstlane_b32 s101, v44
    s_cmp_ge_u32 s101, 4
    s_cbranch_scc0 L_retry_29
    ds_read_b32 v44, v40 offset:128
    ds_read_b32 v47, v47 offset:128
    ds_read_b32 v45, v5 offset:20
    s_waitcnt lgkmcnt(2)
    v_sub_u32 v44, v44, v41
    v_max_u32 v44, 18, v44
    s_waitcnt lgkmcnt(0)
    v_cmp_gt_u32 vcc, v47, v46
    v_add_u32_dpp v48, v44, v44 row_shr:1 row_mask:0xf bank_mask:0xf bound_ctrl:1
    v_readfirstlane_b32 s25, v45
    s_or_b32 s64, vcc_lo, vcc_hi
    v_add_u32_dpp v48, v48, v48 row_shr:2 row_mask:0xf bank_mask:0xf bound_ctrl:1
    s_or_b32 s25, s25, s64
    s_mov_b32 s53, 0
    v_add_u32_dpp v48, v48, v48 row_shr:4 row_mask:0xf bank_mask:0xf bound_ctrl:1
    v_sub_u32 v44, v48, v44
    v_sub_u32 v44, v41, v44
    v_readlane_b32 s10, v48, 0
    v_readlane_b32 s11, v48, 1
    v_readlane_b32 s12, v48, 2
    v_readlane_b32 s13, v48, 3
    v_readlane_b32 s14, v48, 4
    v_add_u32_dpp v160, v44, v43 row_newbcast:0 row_mask:0xf bank_mask:0xf
    v_add_u32_dpp v161, v44, v43 row_newbcast:1 row_mask:0xf bank_mask:0xf
    v_add_u32_dpp v162, v44, v43 row_newbcast:2 row_mask:0xf bank_mask:0xf
    v_add_u32_dpp v163, v44, v43 row_newbcast:3 row_mask:0xf bank_mask:0xf
    v_add_u32_dpp v164, v44, v43 row_newbcast:4 row_mask:0xf bank_mask:0xf
    s_add_u32 s50, s14, 14
    s_lshr_b32 s50, s50, 4
    s_cmp_gt_u32 s50, 32
    s_cselect_b32 s25, 1, s25
    s_max_u32 s50, s50, 12
    v_add_u32 v40, 0, v43
    v_cmp_le_u32 s[64:65], s10, v40
    v_cmp_le_u32 s[66:67], s11, v40
    v_cmp_le_u32 s[68:69], s12, v40
    v_cmp_le_u32 s[70:71], s13, v40
    v_cndmask_b32 v40, v160, v161, s[64:65]
    v_cndmask_b32 v40, v40, v162, s[66:67]
    v_cndmask_b32 v40, v40, v163, s[68:69]
    v_cndmask_b32 v40, v40, v164, s[70:71]
    ds_read_u16 v40, v40 offset:0
    v_add_u32 v41, 128, v43
    v_cmp_le_u32 s[64:65], s10, v41
    v_cmp_le_u32 s[66:67], s11, v41
    v_cmp_le_u32 s[68:69], s12, v41
    v_cmp_le_u32 s[70:71], s13, v41
    v_cndmask_b32 v41, v160, v161, s[64:65]
    v_cndmask_b32 v41, v41, v162, s[66:67]
    v_cndmask_b32 v41, v41, v163, s[68:69]
    v_cndmask_b32 v41, v41, v164, s[70:71]
    ds_read_u16 v41, v41 offset:128
    v_add_u32 v42, 256, v43
    v_cmp_le_u32 s[64:65], s10, v42
    v_cmp_le_u32 s[66:67], s11, v42
    v_cmp_le_u32 s[68:69], s12, v42
    v_cmp_le_u32 s[70:71], s13, v42
    v_cndmask_b32 v42, v160, v161, s[64:65]
    v_cndmask_b32 v42, v42, v162, s[66:67]
    v_cndmask_b32 v42, v42, v163, s[68:69]
    v_cndmask_b32 v42, v42, v164, s[70:71]
    ds_read_u16 v42, v42 offset:256
    v_add_u32 v43, 384, v43
    v_cmp_le_u32 s[64:65], s10, v43
    v_cmp_le_u32 s[66:67], s11, v43
    v_cmp_le_u32 s[68:69], s12, v43
    v_cmp_le_u32 s[70:71], s13, v43
    v_cndmask_b32 v43, v160, v161, s[64:65]
    v_cndmask_b32 v43, v43, v162, s[66:67]
    v_cndmask_b32 v43, v43, v163, s[68:69]
    v_cndmask_b32 v43, v43, v164, s[70:71]
    ds_read_u16 v43, v43 offset:384
    s_waitcnt lgkmcnt(3)
    v_and_b32 v32, 0x7ffe, v40
    ds_read_u16 v33, v32 offset:62464
    v_lshlrev_b32 v32, 8, v32
    v_lshlrev_b32 v40, 4, v40
    s_waitcnt lgkmcnt(3)
    v_and_b32 v34, 0x7ffe, v41
    ds_read_u16 v35, v34 offset:62464
    v_lshlrev_b32 v34, 8, v34
    v_lshlrev_b32 v41, 4, v41
    s_waitcnt lgkmcnt(3)
    v_and_b32 v36, 0x7ffe, v42
    ds_read_u16 v37, v36 offset:62464
    v_lshlrev_b32 v36, 8, v36
    v_lshlrev_b32 v42, 4, v42
    s_waitcnt lgkmcnt(3)
    v_and_b32 v38, 0x7ffe, v43
    ds_read_u16 v39, v38 offset:62464
    v_lshlrev_b32 v38, 8, v38
    v_lshlrev_b32 v43, 4, v43
    v_add_u32_dpp v11, v32, v7 row_newbcast:0 row_mask:0xf bank_mask:0xf
    buffer_load_dwordx4 v[48:51], v11, s[32:35], 0 offen offset:0
    buffer_load_dwordx4 v[56:59], v11, s[32:35], 0 offen offset:256
    v_add_u32_dpp v11, v32, v7 row_newbcast:1 row_mask:0xf bank_mask:0xf
    buffer_load_dwordx4 v[52:55], v11, s[32:35], 0 offen offset:0
    buffer_load_dwordx4 v[60:63], v11, s[32:35], 0 offen offset:256
    v_add_u32_dpp v11, v32, v7 row_newbcast:2 row_mask:0xf bank_mask:0xf
    buffer_load_dwordx4 v[64:67], v11, s[32:35], 0 offen offset:0
    buffer_load_dwordx4 v[72:75], v11, s[32:35], 0 offen offset:256
    v_add_u32_dpp v11, v32, v7 row_newbcast:3 row_mask:0xf bank_mask:0xf
    buffer_load_dwordx4 v[68:71], v11, s[32:35], 0 offen offset:0
    buffer_load_dwordx4 v[76:79], v11, s[32:35], 0 offen offset:256
    v_add_u32_dpp v11, v32, v7 row_newbcast:4 row_mask:0xf bank_mask:0xf
    buffer_load_dwordx4 v[80:83], v11, s[32:35], 0 offen offset:0
    buffer_load_dwordx4 v[88:91], v11, s[32:35], 0 offen offset:256
    v_add_u32_dpp v11, v32, v7 row_newbcast:5 row_mask:0xf bank_mask:0xf
    buffer_load_dwordx4 v[84:87], v11, s[32:35], 0 offen offset:0
    buffer_load_dwordx4 v[92:95], v11, s[32:35], 0 offen offset:256
    s_mov_b32 s57, 0
    s_sub_u32 s64, s14, 18
    s_lshr_b32 s65, s64, 4
    s_bitset1_b32 s53, s65
    s_and_b32 s64, s64, 14
    s_lshl4_add_u32 s57, s57, s64
    s_and_b32 s65, s24, 7
    s_lshl_b32 s65, s65, 5
    s_lshl_b32 s19, s24, 10
    s_or_b32 s19, s19, s65
    s_sub_u32 s64, s13, 18
    s_lshr_b32 s65, s64, 4
    s_bitset1_b32 s53, s65
    s_and_b32 s64, s64, 14
    s_lshl4_add_u32 s57, s57, s64
    s_and_b32 s65, s23, 7
    s_lshl_b32 s65, s65, 5
    s_lshl_b32 s18, s23, 10
    s_or_b32 s18, s18, s65
    s_sub_u32 s64, s12, 18
    s_lshr_b32 s65, s64, 4
    s_bitset1_b32 s53, s65
    s_and_b32 s64, s64, 14
    s_lshl4_add_u32 s57, s57, s64
    s_and_b32 s65, s22, 7
    s_lshl_b32 s65, s65, 5
    s_lshl_b32 s17, s22, 10
    s_or_b32 s17, s17, s65
    s_sub_u32 s64, s11, 18
    s_lshr_b32 s65, s64, 4
    s_bitset1_b32 s53, s65
    s_and_b32 s64, s64, 14
    s_lshl4_add_u32 s57, s57, s64
    s_and_b32 s65, s21, 7
    s_lshl_b32 s65, s65, 5
    s_lshl_b32 s16, s21, 10
    s_or_b32 s16, s16, s65
    s_sub_u32 s64, s10, 18
    s_lshr_b32 s65, s64, 4
    s_bitset1_b32 s53, s65
    s_and_b32 s64, s64, 14
    s_lshl4_add_u32 s57, s57, s64
    s_and_b32 s65, s20, 7
    s_lshl_b32 s65, s65, 5
    s_lshl_b32 s15, s20, 10
    s_or_b32 s15, s15, s65
    s_sub_u32 s64, s50, 5
    s_lshl_b32 s56, 1, s64
    s_or_b32 s52, s56, s53
    v_and_b32 v46, 1, v3
    v_lshl_add_u32 v46, v4, 1, v46
    v_and_b32 v46, 3, v46
    v_and_b32 v47, 14, v3
    v_lshl_add_u32 v46, v46, 4, v47
    v_lshrrev_b32 v47, 1, v4
    v_add_lshl_u32 v46, v46, v47, 2
    v_lshrrev_b32 v44, 1, v4
    v_mul_u32_u24 v44, 528, v44
    v_xor_b32 v44, v44, v7
    v_and_b32 v45, 1, v4
    v_lshl_or_b32 v2, v45, 3, v44
    v_xor_b32 v144, s15, v7
    v_xor_b32 v146, s16, v7
    v_xor_b32 v148, s19, v7
    v_xor_b32 v145, 528, v144
    v_xor_b32 v147, 528, v146
    v_xor_b32 v149, 528, v148
    s_mul_i32 s64, s1, 80
    s_add_u32 s64, s64, 62464
    v_and_b32 v45, 2, v4
    v_add_u32 v0, s64, v45
    s_getpc_b64 s[72:73]
L_anc:
    v_lshlrev_b32 v4, 2, v4
    s_mov_b32 s62, L_fp1-L_anc
    s_mov_b32 s63, L_fp1-L_fp0
    s_mov_b32 s70, L_dr1-L_anc
    s_mov_b32 s71, L_dr1-L_dr0
    s_mov_b32 s26, 0
    v_mov_b32 v1, 0
    s_lshl_b32 s64, s31, 2
    v_mov_b32 v10, s64
    v_and_b32 v9, 8, v3
    v_lshlrev_b32 v9, 1, v9
    s_mov_b32 s66, 0x22222222
    s_mov_b32 s67, 0x22222222
    s_mov_b32 s68, 0x44444444
    s_mov_b32 s69, 0x44444444
    v_mov_b64 v[150:151], 0
    v_mov_b64 v[152:153], 0
    v_mov_b64 v[154:155], 0
    v_mov_b64 v[156:157], 0
    v_mov_b64 v[158:159], 0
    v_mov_b64 v[16:17], 0
    v_mov_b64 v[18:19], 0
    v_mov_b64 v[20:21], 0
    v_mov_b64 v[22:23], 0
    s_waitcnt lgkmcnt(0)
    v_lshlrev_b32 v33, v40, v33
    ds_bpermute_b32 v33, v46, v33
    v_lshlrev_b32 v35, v41, v35
    ds_bpermute_b32 v35, v46, v35
    v_lshlrev_b32 v37, v42, v37
    ds_bpermute_b32 v37, v46, v37
    v_lshlrev_b32 v39, v43, v39
    ds_bpermute_b32 v39, v46, v39
    s_waitcnt vmcnt(12) lgkmcnt(0)
    s_barrier
    ds_read_b128 v[160:163], v144 offset:21504
    ds_read_b128 v[164:167], v144 offset:21760
    ds_read_b128 v[168:171], v145 offset:21504
    ds_read_b128 v[172:175], v145 offset:21760
    s_waitcnt lgkmcnt(2)
    v_dot2c_f32_bf16 v150, v176, v160
    v_dot2c_f32_bf16 v150, v177, v161
    v_dot2c_f32_bf16 v150, v178, v162
    v_dot2c_f32_bf16 v150, v179, v163
    v_dot2c_f32_bf16 v150, v180, v164
    v_dot2c_f32_bf16 v150, v181, v165
    v_dot2c_f32_bf16 v150, v182, v166
    v_dot2c_f32_bf16 v150, v183, v167
    ds_read_b128 v[160:163], v146 offset:21504
    ds_read_b128 v[164:167], v146 offset:21760
    s_waitcnt lgkmcnt(2)
    v_dot2c_f32_bf16 v151, v184, v168
    v_dot2c_f32_bf16 v151, v185, v169
    v_dot2c_f32_bf16 v151, v186, v170
    v_dot2c_f32_bf16 v151, v187, v171
    v_dot2c_f32_bf16 v151, v188, v172
    v_dot2c_f32_bf16 v151, v189, v173
    v_dot2c_f32_bf16 v151, v190, v174
    v_dot2c_f32_bf16 v151, v191, v175
    ds_read_b128 v[168:171], v147 offset:21504
    ds_read_b128 v[172:175], v147 offset:21760
    s_waitcnt lgkmcnt(2)
    v_dot2c_f32_bf16 v152, v192, v160
    v_dot2c_f32_bf16 v152, v193, v161
    v_dot2c_f32_bf16 v152, v194, v162
    v_dot2c_f32_bf16 v152, v195, v163
    v_dot2c_f32_bf16 v152, v196, v164
    v_dot2c_f32_bf16 v152, v197, v165
    v_dot2c_f32_bf16 v152, v198, v166
    v_dot2c_f32_bf16 v152, v199, v167
    v_add_f32_dpp v150, v150, v150 row_ror:8 row_mask:0xf bank_mask:0x3
    v_add_f32_dpp v150, v151, v151 row_ror:8 row_mask:0xf bank_mask:0xc
    ds_read_b128 v[160:163], v144 offset:29696
    ds_read_b128 v[164:167], v144 offset:29952
    s_waitcnt lgkmcnt(2)
    v_dot2c_f32_bf16 v153, v200, v168
    v_dot2c_f32_bf16 v153, v201, v169
    v_dot2c_f32_bf16 v153, v202, v170
    v_dot2c_f32_bf16 v153, v203, v171
    v_dot2c_f32_bf16 v153, v204, v172
    v_dot2c_f32_bf16 v153, v205, v173
    v_dot2c_f32_bf16 v153, v206, v174
    v_dot2c_f32_bf16 v153, v207, v175
    ds_read_b128 v[168:171], v145 offset:29696
    ds_read_b128 v[172:175], v145 offset:29952
    s_waitcnt lgkmcnt(2)
    v_dot2c_f32_bf16 v154, v208, v160
    v_dot2c_f32_bf16 v154, v209, v161
    v_dot2c_f32_bf16 v154, v210, v162
    v_dot2c_f32_bf16 v154, v211, v163
    v_dot2c_f32_bf16 v154, v212, v164
    v_dot2c_f32_bf16 v154, v213, v165
    v_dot2c_f32_bf16 v154, v214, v166
    v_dot2c_f32_bf16 v154, v215, v167
    v_add_f32_dpp v152, v152, v152 row_ror:8 row_mask:0xf bank_mask:0x3
    v_add_f32_dpp v152, v153, v153 row_ror:8 row_mask:0xf bank_mask:0xc
    v_add_u32_dpp v11, v32, v7 row_newbcast:6 row_mask:0xf bank_mask:0xf
    buffer_load_dwordx4 v[96:99], v11, s[32:35], 0 offen offset:0
    buffer_load_dwordx4 v[104:107], v11, s[32:35], 0 offen offset:256
    ds_read_b128 v[160:163], v146 offset:29696
    ds_read_b128 v[164:167], v146 offset:29952
    s_waitcnt lgkmcnt(2)
    v_dot2c_f32_bf16 v155, v216, v168
    v_dot2c_f32_bf16 v155, v217, v169
    v_dot2c_f32_bf16 v155, v218, v170
    v_dot2c_f32_bf16 v155, v219, v171
    v_dot2c_f32_bf16 v155, v220, v172
    v_dot2c_f32_bf16 v155, v221, v173
    v_dot2c_f32_bf16 v155, v222, v174
    v_dot2c_f32_bf16 v155, v223, v175
    v_add_f32_dpp v150, v150, v150 row_half_mirror row_mask:0xf bank_mask:0x5
    v_add_f32_dpp v150, v152, v152 row_half_mirror row_mask:0xf bank_mask:0xa
    v_add_u32_dpp v11, v32, v7 row_newbcast:7 row_mask:0xf bank_mask:0xf
    buffer_load_dwordx4 v[100:103], v11, s[32:35], 0 offen offset:0
    buffer_load_dwordx4 v[108:111], v11, s[32:35], 0 offen offset:256
    ds_read_b128 v[168:171], v147 offset:29696
    ds_read_b128 v[172:175], v147 offset:29952
    s_waitcnt lgkmcnt(2)
    v_dot2c_f32_bf16 v156, v224, v160
    v_dot2c_f32_bf16 v156, v225, v161
    v_dot2c_f32_bf16 v156, v226, v162
    v_dot2c_f32_bf16 v156, v227, v163
    v_dot2c_f32_bf16 v156, v228, v164
    v_dot2c_f32_bf16 v156, v229, v165
    v_dot2c_f32_bf16 v156, v230, v166
    v_dot2c_f32_bf16 v156, v231, v167
    v_add_f32_dpp v154, v154, v154 row_ror:8 row_mask:0xf bank_mask:0x3
    v_add_f32_dpp v154, v155, v155 row_ror:8 row_mask:0xf bank_mask:0xc
    v_add_u32_dpp v11, v32, v7 row_newbcast:8 row_mask:0xf bank_mask:0xf
    buffer_load_dwordx4 v[112:115], v11, s[32:35], 0 offen offset:0
    buffer_load_dwordx4 v[120:123], v11, s[32:35], 0 offen offset:256
    ds_read_b128 v[160:163], v148 offset:21504
    ds_read_b128 v[164:167], v148 offset:21760
    s_waitcnt lgkmcnt(2)
    v_dot2c_f32_bf16 v157, v232, v168
    v_dot2c_f32_bf16 v157, v233, v169
    v_dot2c_f32_bf16 v157, v234, v170
    v_dot2c_f32_bf16 v157, v235, v171
    v_dot2c_f32_bf16 v157, v236, v172
    v_dot2c_f32_bf16 v157, v237, v173
    v_dot2c_f32_bf16 v157, v238, v174
    v_dot2c_f32_bf16 v157, v239, v175
    v_add_u32_dpp v11, v32, v7 row_newbcast:9 row_mask:0xf bank_mask:0xf
    buffer_load_dwordx4 v[116:119], v11, s[32:35], 0 offen offset:0
    buffer_load_dwordx4 v[124:127], v11, s[32:35], 0 offen offset:256
    ds_read_b128 v[168:171], v149 offset:21504
    ds_read_b128 v[172:175], v149 offset:21760
    s_waitcnt lgkmcnt(2)
    v_dot2c_f32_bf16 v158, v240, v160
    v_dot2c_f32_bf16 v158, v241, v161
    v_dot2c_f32_bf16 v158, v242, v162
    v_dot2c_f32_bf16 v158, v243, v163
    v_dot2c_f32_bf16 v158, v244, v164
    v_dot2c_f32_bf16 v158, v245, v165
    v_dot2c_f32_bf16 v158, v246, v166
    v_dot2c_f32_bf16 v158, v247, v167
    v_add_f32_dpp v156, v156, v156 row_ror:8 row_mask:0xf bank_mask:0x3
    v_add_f32_dpp v156, v157, v157 row_ror:8 row_mask:0xf bank_mask:0xc
    v_add_u32_dpp v11, v32, v7 row_newbcast:10 row_mask:0xf bank_mask:0xf
    buffer_load_dwordx4 v[128:131], v11, s[32:35], 0 offen offset:0
    buffer_load_dwordx4 v[136:139], v11, s[32:35], 0 offen offset:256
    s_waitcnt lgkmcnt(0)
    v_dot2c_f32_bf16 v159, v248, v168
    v_dot2c_f32_bf16 v159, v249, v169
    v_dot2c_f32_bf16 v159, v250, v170
    v_dot2c_f32_bf16 v159, v251, v171
    v_dot2c_f32_bf16 v159, v252, v172
    v_dot2c_f32_bf16 v159, v253, v173
    v_dot2c_f32_bf16 v159, v254, v174
    v_dot2c_f32_bf16 v159, v255, v175
    v_add_f32_dpp v154, v154, v154 row_half_mirror row_mask:0xf bank_mask:0x5
    v_add_f32_dpp v154, v156, v156 row_half_mirror row_mask:0xf bank_mask:0xa
    v_add_u32_dpp v11, v32, v7 row_newbcast:11 row_mask:0xf bank_mask:0xf
    buffer_load_dwordx4 v[132:135], v11, s[32:35], 0 offen offset:0
    buffer_load_dwordx4 v[140:143], v11, s[32:35], 0 offen offset:256
    v_add_f32_dpp v150, v150, v150 quad_perm:[1,0,3,2] row_mask:0xf bank_mask:0xf
    s_nop 0
    v_add_f32_dpp v158, v158, v158 row_ror:8 row_mask:0xf bank_mask:0x3
    v_add_f32_dpp v158, v159, v159 row_ror:8 row_mask:0xf bank_mask:0xc
    v_add_f32_dpp v154, v154, v154 quad_perm:[1,0,3,2] row_mask:0xf bank_mask:0xf
    v_add_f32_dpp v150, v150, v150 quad_perm:[2,3,0,1] row_mask:0xf bank_mask:0xf
    v_add_f32_dpp v158, v158, v158 row_half_mirror row_mask:0xf bank_mask:0x5
    v_add_f32_dpp v154, v154, v154 quad_perm:[2,3,0,1] row_mask:0xf bank_mask:0xf
    s_nop 0
    v_add_f32_dpp v158, v158, v158 quad_perm:[1,0,3,2] row_mask:0xf bank_mask:0xf
    v_cndmask_b32 v150, v150, v154, s[66:67]
    s_nop 0
    v_add_f32_dpp v158, v158, v158 quad_perm:[2,3,0,1] row_mask:0xf bank_mask:0xf
    v_cndmask_b32 v150, v150, v158, s[68:69]
    v_mul_f32 v150, 0x3db8aa3b, v150
    v_exp_f32 v150, v150
    s_nop 0
    v_mov_b32 v44, v150
    v_mov_b32 v45, v150
    s_nop 1
    v_permlane32_swap_b32 v44, v45
    v_add_f32 v44, v44, v45
    v_mov_b32 v45, v44
    s_nop 1
    v_permlane16_swap_b32 v44, v45
    v_add_f32 v44, v44, v45
    v_add_f32 v44, 0x3089705f, v44
    v_rcp_f32 v44, v44
    s_nop 0
    v_mul_f32 v150, v150, v44
    v_cvt_pk_bf16_f32 v150, v150, 0
    v_lshlrev_b32 v8, v9, v150
    s_nop 1
    v_and_b32_dpp v24, v8, v12 row_newbcast:0 row_mask:0xf bank_mask:0xf
    v_and_b32_dpp v25, v8, v13 row_newbcast:0 row_mask:0xf bank_mask:0xf
    v_mov_b64 v[40:41], 0
    v_mov_b64 v[42:43], 0
    v_mov_b64 v[44:45], 0
    v_mov_b64 v[46:47], 0
    v_smfmac_f32_16x16x32_bf16 v[40:43], v[24:25], v[176:179], v14
    v_and_b32_dpp v28, v8, v12 row_newbcast:8 row_mask:0xf bank_mask:0xf
    v_and_b32_dpp v29, v8, v13 row_newbcast:8 row_mask:0xf bank_mask:0xf
    v_smfmac_f32_16x16x32_bf16 v[44:47], v[24:25], v[180:183], v14
    v_add_u32_dpp v11, v32, v7 row_newbcast:12 row_mask:0xf bank_mask:0xf
    buffer_load_dwordx4 v[144:147], v11, s[32:35], 0 offen offset:0
    buffer_load_dwordx4 v[152:155], v11, s[32:35], 0 offen offset:256
    v_smfmac_f32_16x16x32_bf16 v[40:43], v[28:29], v[184:187], v14
    v_and_b32_dpp v24, v8, v12 row_newbcast:4 row_mask:0xf bank_mask:0xf
    v_and_b32_dpp v25, v8, v13 row_newbcast:4 row_mask:0xf bank_mask:0xf
    v_smfmac_f32_16x16x32_bf16 v[44:47], v[28:29], v[188:191], v14
    s_nop 0
    v_smfmac_f32_16x16x32_bf16 v[16:19], v[24:25], v[192:195], v14
    v_and_b32_dpp v28, v8, v12 row_newbcast:12 row_mask:0xf bank_mask:0xf
    v_and_b32_dpp v29, v8, v13 row_newbcast:12 row_mask:0xf bank_mask:0xf
    v_smfmac_f32_16x16x32_bf16 v[20:23], v[24:25], v[196:199], v14
    v_add_u32_dpp v11, v32, v7 row_newbcast:13 row_mask:0xf bank_mask:0xf
    buffer_load_dwordx4 v[148:151], v11, s[32:35], 0 offen offset:0
    buffer_load_dwordx4 v[156:159], v11, s[32:35], 0 offen offset:256
    v_smfmac_f32_16x16x32_bf16 v[16:19], v[28:29], v[200:203], v14
    v_and_b32_dpp v24, v8, v12 row_newbcast:1 row_mask:0xf bank_mask:0xf
    v_and_b32_dpp v25, v8, v13 row_newbcast:1 row_mask:0xf bank_mask:0xf
    v_smfmac_f32_16x16x32_bf16 v[20:23], v[28:29], v[204:207], v14
    v_xor_b32 v178, s15, v2
    s_lshl_b32 s64, s20, 2
    v_add_u32 v9, s64, v0
    v_mov_b32 v179, 0
    v_cvt_pk_bf16_f32 v30, v40, v41
    v_cvt_pk_bf16_f32 v31, v42, v43
    ds_write_b64 v178, v[30:31] offset:1024
    v_cvt_pk_bf16_f32 v30, v44, v45
    v_cvt_pk_bf16_f32 v31, v46, v47
    ds_write_b64 v178, v[30:31] offset:1280
    ds_read_u16_d16_hi v179, v9
    v_mov_b64 v[40:41], 0
    v_mov_b64 v[42:43], 0
    v_mov_b64 v[44:45], 0
    v_mov_b64 v[46:47], 0
    s_nop 0
    v_smfmac_f32_16x16x32_bf16 v[40:43], v[24:25], v[208:211], v14
    v_and_b32_dpp v28, v8, v12 row_newbcast:9 row_mask:0xf bank_mask:0xf
    v_and_b32_dpp v29, v8, v13 row_newbcast:9 row_mask:0xf bank_mask:0xf
    v_smfmac_f32_16x16x32_bf16 v[44:47], v[24:25], v[212:215], v14
    v_add_u32_dpp v11, v32, v7 row_newbcast:14 row_mask:0xf bank_mask:0xf
    buffer_load_dwordx4 v[160:163], v11, s[32:35], 0 offen offset:0
    buffer_load_dwordx4 v[168:171], v11, s[32:35], 0 offen offset:256
    v_smfmac_f32_16x16x32_bf16 v[40:43], v[28:29], v[216:219], v14
    v_and_b32_dpp v24, v8, v12 row_newbcast:5 row_mask:0xf bank_mask:0xf
    v_and_b32_dpp v25, v8, v13 row_newbcast:5 row_mask:0xf bank_mask:0xf
    v_smfmac_f32_16x16x32_bf16 v[44:47], v[28:29], v[220:223], v14
    v_xor_b32 v180, s16, v2
    s_lshl_b32 s64, s21, 2
    v_add_u32 v9, s64, v0
    v_mov_b32 v181, 0
    v_cvt_pk_bf16_f32 v30, v16, v17
    v_cvt_pk_bf16_f32 v31, v18, v19
    ds_write_b64 v180, v[30:31] offset:1024
    v_cvt_pk_bf16_f32 v30, v20, v21
    v_cvt_pk_bf16_f32 v31, v22, v23
    ds_write_b64 v180, v[30:31] offset:1280
    ds_read_u16_d16_hi v181, v9
    v_mov_b64 v[16:17], 0
    v_mov_b64 v[18:19], 0
    v_mov_b64 v[20:21], 0
    v_mov_b64 v[22:23], 0
    s_nop 0
    v_smfmac_f32_16x16x32_bf16 v[16:19], v[24:25], v[224:227], v14
    v_and_b32_dpp v28, v8, v12 row_newbcast:13 row_mask:0xf bank_mask:0xf
    v_and_b32_dpp v29, v8, v13 row_newbcast:13 row_mask:0xf bank_mask:0xf
    v_smfmac_f32_16x16x32_bf16 v[20:23], v[24:25], v[228:231], v14
    v_add_u32_dpp v11, v32, v7 row_newbcast:15 row_mask:0xf bank_mask:0xf
    buffer_load_dwordx4 v[164:167], v11, s[32:35], 0 offen offset:0
    buffer_load_dwordx4 v[172:175], v11, s[32:35], 0 offen offset:256
    v_smfmac_f32_16x16x32_bf16 v[16:19], v[28:29], v[232:235], v14
    v_and_b32_dpp v24, v8, v12 row_newbcast:2 row_mask:0xf bank_mask:0xf
    v_and_b32_dpp v25, v8, v13 row_newbcast:2 row_mask:0xf bank_mask:0xf
    v_smfmac_f32_16x16x32_bf16 v[20:23], v[28:29], v[236:239], v14
    v_xor_b32 v182, s17, v2
    s_lshl_b32 s64, s22, 2
    v_add_u32 v9, s64, v0
    v_mov_b32 v183, 0
    v_cvt_pk_bf16_f32 v30, v40, v41
    v_cvt_pk_bf16_f32 v31, v42, v43
    ds_write_b64 v182, v[30:31] offset:1024
    v_cvt_pk_bf16_f32 v30, v44, v45
    v_cvt_pk_bf16_f32 v31, v46, v47
    ds_write_b64 v182, v[30:31] offset:1280
    ds_read_u16_d16_hi v183, v9
    v_mov_b64 v[40:41], 0
    v_mov_b64 v[42:43], 0
    v_mov_b64 v[44:45], 0
    v_mov_b64 v[46:47], 0
    s_nop 0
    v_smfmac_f32_16x16x32_bf16 v[40:43], v[24:25], v[240:243], v14
    v_and_b32_dpp v28, v8, v12 row_newbcast:10 row_mask:0xf bank_mask:0xf
    v_and_b32_dpp v29, v8, v13 row_newbcast:10 row_mask:0xf bank_mask:0xf
    v_smfmac_f32_16x16x32_bf16 v[44:47], v[24:25], v[244:247], v14
    s_nop 0
    v_smfmac_f32_16x16x32_bf16 v[40:43], v[28:29], v[248:251], v14
    v_and_b32_dpp v24, v33, v12 row_newbcast:0 row_mask:0xf bank_mask:0xf
    v_and_b32_dpp v25, v33, v13 row_newbcast:0 row_mask:0xf bank_mask:0xf
    v_and_b32_dpp v26, v33, v12 row_newbcast:1 row_mask:0xf bank_mask:0xf
    v_and_b32_dpp v27, v33, v13 row_newbcast:1 row_mask:0xf bank_mask:0xf
    v_smfmac_f32_16x16x32_bf16 v[44:47], v[28:29], v[252:255], v14
    v_xor_b32 v184, s18, v2
    s_lshl_b32 s64, s23, 2
    v_add_u32 v9, s64, v0
    v_mov_b32 v185, 0
    v_cvt_pk_bf16_f32 v30, v16, v17
    v_cvt_pk_bf16_f32 v31, v18, v19
    ds_write_b64 v184, v[30:31] offset:1024
    v_cvt_pk_bf16_f32 v30, v20, v21
    v_cvt_pk_bf16_f32 v31, v22, v23
    ds_write_b64 v184, v[30:31] offset:1280
    ds_read_u16_d16_hi v185, v9
    v_mov_b64 v[16:17], 0
    v_mov_b64 v[18:19], 0
    v_mov_b64 v[20:21], 0
    v_mov_b64 v[22:23], 0
    s_nop 0
    v_xor_b32 v176, s19, v2
    s_lshl_b32 s64, s24, 2
    v_add_u32 v9, s64, v0
    v_mov_b32 v177, 0
    v_cvt_pk_bf16_f32 v30, v40, v41
    v_cvt_pk_bf16_f32 v31, v42, v43
    ds_write_b64 v176, v[30:31] offset:1024
    v_cvt_pk_bf16_f32 v30, v44, v45
    v_cvt_pk_bf16_f32 v31, v46, v47
    ds_write_b64 v176, v[30:31] offset:1280
    ds_read_u16_d16_hi v177, v9
    s_waitcnt lgkmcnt(0)
    s_barrier
    s_cmp_lg_u32 s25, 0
    s_cbranch_scc1 L_slow
L_fp0:
    s_bitcmp1_b32 s52, 0
    s_waitcnt vmcnt(28)
    v_smfmac_f32_16x16x64_bf16 v[16:19], v[24:27], v[48:55], v14
    v_and_b32_dpp v28, v33, v12 row_newbcast:2 row_mask:0xf bank_mask:0xf
    v_and_b32_dpp v29, v33, v13 row_newbcast:2 row_mask:0xf bank_mask:0xf
    v_smfmac_f32_16x16x64_bf16 v[20:23], v[24:27], v[56:63], v14
    v_and_b32_dpp v30, v33, v12 row_newbcast:3 row_mask:0xf bank_mask:0xf
    v_and_b32_dpp v31, v33, v13 row_newbcast:3 row_mask:0xf bank_mask:0xf
    v_add_u32_dpp v11, v34, v7 row_newbcast:0 row_mask:0xf bank_mask:0xf
    buffer_load_dwordx4 v[48:51], v11, s[32:35], 0 offen offset:0
    buffer_load_dwordx4 v[56:59], v11, s[32:35], 0 offen offset:256
    s_cbranch_scc1 L_ev0
L_fp1:
    s_bitcmp1_b32 s52, 1
    s_waitcnt vmcnt(26)
    v_smfmac_f32_16x16x64_bf16 v[16:19], v[28:31], v[64:71], v14
    v_and_b32_dpp v24, v33, v12 row_newbcast:4 row_mask:0xf bank_mask:0xf
    v_and_b32_dpp v25, v33, v13 row_newbcast:4 row_mask:0xf bank_mask:0xf
    v_smfmac_f32_16x16x64_bf16 v[20:23], v[28:31], v[72:79], v14
    v_and_b32_dpp v26, v33, v12 row_newbcast:5 row_mask:0xf bank_mask:0xf
    v_and_b32_dpp v27, v33, v13 row_newbcast:5 row_mask:0xf bank_mask:0xf
    v_add_u32_dpp v11, v34, v7 row_newbcast:1 row_mask:0xf bank_mask:0xf
    buffer_load_dwordx4 v[52:55], v11, s[32:35], 0 offen offset:0
    buffer_load_dwordx4 v[60:63], v11, s[32:35], 0 offen offset:256
    s_cbranch_scc1 L_ev1
L_fp2:
    s_bitcmp1_b32 s52, 2
    s_waitcnt vmcnt(24)
    v_smfmac_f32_16x16x64_bf16 v[16:19], v[24:27], v[80:87], v14
    v_and_b32_dpp v28, v33, v12 row_newbcast:6 row_mask:0xf bank_mask:0xf
    v_and_b32_dpp v29, v33, v13 row_newbcast:6 row_mask:0xf bank_mask:0xf
    v_smfmac_f32_16x16x64_bf16 v[20:23], v[24:27], v[88:95], v14
    v_and_b32_dpp v30, v33, v12 row_newbcast:7 row_mask:0xf bank_mask:0xf
    v_and_b32_dpp v31, v33, v13 row_newbcast:7 row_mask:0xf bank_mask:0xf
    v_add_u32_dpp v11, v34, v7 row_newbcast:2 row_mask:0xf bank_mask:0xf
    buffer_load_dwordx4 v[64:67], v11, s[32:35], 0 offen offset:0
    buffer_load_dwordx4 v[72:75], v11, s[32:35], 0 offen offset:256
    s_cbranch_scc1 L_ev2
L_fp3:
    s_bitcmp1_b32 s52, 3
    s_waitcnt vmcnt(22)
    v_smfmac_f32_16x16x64_bf16 v[16:19], v[28:31], v[96:103], v14
    v_and_b32_dpp v24, v33, v12 row_newbcast:8 row_mask:0xf bank_mask:0xf
    v_and_b32_dpp v25, v33, v13 row_newbcast:8 row_mask:0xf bank_mask:0xf
    v_smfmac_f32_16x16x64_bf16 v[20:23], v[28:31], v[104:111], v14
    v_and_b32_dpp v26, v33, v12 row_newbcast:9 row_mask:0xf bank_mask:0xf
    v_and_b32_dpp v27, v33, v13 row_newbcast:9 row_mask:0xf bank_mask:0xf
    v_add_u32_dpp v11, v34, v7 row_newbcast:3 row_mask:0xf bank_mask:0xf
    buffer_load_dwordx4 v[68:71], v11, s[32:35], 0 offen offset:0
    buffer_load_dwordx4 v[76:79], v11, s[32:35], 0 offen offset:256
    s_cbranch_scc1 L_ev3
L_fp4:
    s_bitcmp1_b32 s52, 4
    s_waitcnt vmcnt(20)
    v_smfmac_f32_16x16x64_bf16 v[16:19], v[24:27], v[112:119], v14
    v_and_b32_dpp v28, v33, v12 row_newbcast:10 row_mask:0xf bank_mask:0xf
    v_and_b32_dpp v29, v33, v13 row_newbcast:10 row_mask:0xf bank_mask:0xf
    v_smfmac_f32_16x16x64_bf16 v[20:23], v[24:27], v[120:127], v14
    v_and_b32_dpp v30, v33, v12 row_newbcast:11 row_mask:0xf bank_mask:0xf
    v_and_b32_dpp v31, v33, v13 row_newbcast:11 row_mask:0xf bank_mask:0xf
    v_add_u32_dpp v11, v34, v7 row_newbcast:4 row_mask:0xf bank_mask:0xf
    buffer_load_dwordx4 v[80:83], v11, s[32:35], 0 offen offset:0
    buffer_load_dwordx4 v[88:91], v11, s[32:35], 0 offen offset:256
    s_cbranch_scc1 L_ev4
L_fp5:
    s_bitcmp1_b32 s52, 5
    s_waitcnt vmcnt(18)
    v_smfmac_f32_16x16x64_bf16 v[16:19], v[28:31], v[128:135], v14
    v_and_b32_dpp v24, v33, v12 row_newbcast:12 row_mask:0xf bank_mask:0xf
    v_and_b32_dpp v25, v33, v13 row_newbcast:12 row_mask:0xf bank_mask:0xf
    v_smfmac_f32_16x16x64_bf16 v[20:23], v[28:31], v[136:143], v14
    v_and_b32_dpp v26, v33, v12 row_newbcast:13 row_mask:0xf bank_mask:0xf
    v_and_b32_dpp v27, v33, v13 row_newbcast:13 row_mask:0xf bank_mask:0xf
    v_add_u32_dpp v11, v34, v7 row_newbcast:5 row_mask:0xf bank_mask:0xf
    buffer_load_dwordx4 v[84:87], v11, s[32:35], 0 offen offset:0
    buffer_load_dwordx4 v[92:95], v11, s[32:35], 0 offen offset:256
    s_cbranch_scc1 L_ev5
L_fp6:
    s_bitcmp1_b32 s52, 6
    s_waitcnt vmcnt(16)
    v_smfmac_f32_16x16x64_bf16 v[16:19], v[24:27], v[144:151], v14
    v_and_b32_dpp v28, v33, v12 row_newbcast:14 row_mask:0xf bank_mask:0xf
    v_and_b32_dpp v29, v33, v13 row_newbcast:14 row_mask:0xf bank_mask:0xf
    v_smfmac_f32_16x16x64_bf16 v[20:23], v[24:27], v[152:159], v14
    v_and_b32_dpp v30, v33, v12 row_newbcast:15 row_mask:0xf bank_mask:0xf
    v_and_b32_dpp v31, v33, v13 row_newbcast:15 row_mask:0xf bank_mask:0xf
    v_add_u32_dpp v11, v34, v7 row_newbcast:6 row_mask:0xf bank_mask:0xf
    buffer_load_dwordx4 v[96:99], v11, s[32:35], 0 offen offset:0
    buffer_load_dwordx4 v[104:107], v11, s[32:35], 0 offen offset:256
    s_cbranch_scc1 L_ev6
L_fp7:
    s_bitcmp1_b32 s52, 7
    s_waitcnt vmcnt(14)
    v_smfmac_f32_16x16x64_bf16 v[16:19], v[28:31], v[160:167], v14
    v_and_b32_dpp v24, v35, v12 row_newbcast:0 row_mask:0xf bank_mask:0xf
    v_and_b32_dpp v25, v35, v13 row_newbcast:0 row_mask:0xf bank_mask:0xf
    v_smfmac_f32_16x16x64_bf16 v[20:23], v[28:31], v[168:175], v14
    v_and_b32_dpp v26, v35, v12 row_newbcast:1 row_mask:0xf bank_mask:0xf
    v_and_b32_dpp v27, v35, v13 row_newbcast:1 row_mask:0xf bank_mask:0xf
    v_add_u32_dpp v11, v34, v7 row_newbcast:7 row_mask:0xf bank_mask:0xf
    buffer_load_dwordx4 v[100:103], v11, s[32:35], 0 offen offset:0
    buffer_load_dwordx4 v[108:111], v11, s[32:35], 0 offen offset:256
    s_cbranch_scc1 L_ev7
L_fp8:
    v_mov_b64 v[32:33], v[34:35]
    v_mov_b64 v[34:35], v[36:37]
    v_mov_b64 v[36:37], v[38:39]
    s_lshr_b32 s52, s52, 8
    s_lshr_b32 s53, s53, 8
    s_lshr_b32 s56, s56, 8
    s_mov_b32 s62, L_st1-L_anc
    s_mov_b32 s63, L_st1-L_st0
L_st0:
    s_bitcmp1_b32 s52, 0
    s_waitcnt vmcnt(12)
    v_smfmac_f32_16x16x64_bf16 v[16:19], v[24:27], v[48:55], v14
    v_and_b32_dpp v28, v33, v12 row_newbcast:2 row_mask:0xf bank_mask:0xf
    v_and_b32_dpp v29, v33, v13 row_newbcast:2 row_mask:0xf bank_mask:0xf
    v_smfmac_f32_16x16x64_bf16 v[20:23], v[24:27], v[56:63], v14
    v_and_b32_dpp v30, v33, v12 row_newbcast:3 row_mask:0xf bank_mask:0xf
    v_and_b32_dpp v31, v33, v13 row_newbcast:3 row_mask:0xf bank_mask:0xf
    v_add_u32_dpp v11, v32, v7 row_newbcast:8 row_mask:0xf bank_mask:0xf
    buffer_load_dwordx4 v[112:115], v11, s[32:35], 0 offen offset:0
    buffer_load_dwordx4 v[120:123], v11, s[32:35], 0 offen offset:256
    v_add_u32_dpp v11, v32, v7 row_newbcast:9 row_mask:0xf bank_mask:0xf
    buffer_load_dwordx4 v[116:119], v11, s[32:35], 0 offen offset:0
    buffer_load_dwordx4 v[124:127], v11, s[32:35], 0 offen offset:256
    s_cbranch_scc1 L_ev0
L_st1:
    s_bitcmp1_b32 s52, 1
    s_waitcnt vmcnt(12)
    v_smfmac_f32_16x16x64_bf16 v[16:19], v[28:31], v[64:71], v14
    v_and_b32_dpp v24, v33, v12 row_newbcast:4 row_mask:0xf bank_mask:0xf
    v_and_b32_dpp v25, v33, v13 row_newbcast:4 row_mask:0xf bank_mask:0xf
    v_smfmac_f32_16x16x64_bf16 v[20:23], v[28:31], v[72:79], v14
    v_and_b32_dpp v26, v33, v12 row_newbcast:5 row_mask:0xf bank_mask:0xf
    v_and_b32_dpp v27, v33, v13 row_newbcast:5 row_mask:0xf bank_mask:0xf
    v_add_u32_dpp v11, v32, v7 row_newbcast:10 row_mask:0xf bank_mask:0xf
    buffer_load_dwordx4 v[128:131], v11, s[32:35], 0 offen offset:0
    buffer_load_dwordx4 v[136:139], v11, s[32:35], 0 offen offset:256
    v_add_u32_dpp v11, v32, v7 row_newbcast:11 row_mask:0xf bank_mask:0xf
    buffer_load_dwordx4 v[132:135], v11, s[32:35], 0 offen offset:0
    buffer_load_dwordx4 v[140:143], v11, s[32:35], 0 offen offset:256
    s_cbranch_scc1 L_ev1
L_st2:
    s_bitcmp1_b32 s52, 2
    s_waitcnt vmcnt(12)
    v_smfmac_f32_16x16x64_bf16 v[16:19], v[24:27], v[80:87], v14
    v_and_b32_dpp v28, v33, v12 row_newbcast:6 row_mask:0xf bank_mask:0xf
    v_and_b32_dpp v29, v33, v13 row_newbcast:6 row_mask:0xf bank_mask:0xf
    v_smfmac_f32_16x16x64_bf16 v[20:23], v[24:27], v[88:95], v14
    v_and_b32_dpp v30, v33, v12 row_newbcast:7 row_mask:0xf bank_mask:0xf
    v_and_b32_dpp v31, v33, v13 row_newbcast:7 row_mask:0xf bank_mask:0xf
    v_add_u32_dpp v11, v32, v7 row_newbcast:12 row_mask:0xf bank_mask:0xf
    buffer_load_dwordx4 v[144:147], v11, s[32:35], 0 offen offset:0
    buffer_load_dwordx4 v[152:155], v11, s[32:35], 0 offen offset:256
    v_add_u32_dpp v11, v32, v7 row_newbcast:13 row_mask:0xf bank_mask:0xf
    buffer_load_dwordx4 v[148:151], v11, s[32:35], 0 offen offset:0
    buffer_load_dwordx4 v[156:159], v11, s[32:35], 0 offen offset:256
    s_cbranch_scc1 L_ev2
L_st3:
    s_bitcmp1_b32 s52, 3
    s_waitcnt vmcnt(12)
    v_smfmac_f32_16x16x64_bf16 v[16:19], v[28:31], v[96:103], v14
    v_and_b32_dpp v24, v33, v12 row_newbcast:8 row_mask:0xf bank_mask:0xf
    v_and_b32_dpp v25, v33, v13 row_newbcast:8 row_mask:0xf bank_mask:0xf
    v_smfmac_f32_16x16x64_bf16 v[20:23], v[28:31], v[104:111], v14
    v_and_b32_dpp v26, v33, v12 row_newbcast:9 row_mask:0xf bank_mask:0xf
    v_and_b32_dpp v27, v33, v13 row_newbcast:9 row_mask:0xf bank_mask:0xf
    v_add_u32_dpp v11, v32, v7 row_newbcast:14 row_mask:0xf bank_mask:0xf
    buffer_load_dwordx4 v[160:163], v11, s[32:35], 0 offen offset:0
    buffer_load_dwordx4 v[168:171], v11, s[32:35], 0 offen offset:256
    v_add_u32_dpp v11, v32, v7 row_newbcast:15 row_mask:0xf bank_mask:0xf
    buffer_load_dwordx4 v[164:167], v11, s[32:35], 0 offen offset:0
    buffer_load_dwordx4 v[172:175], v11, s[32:35], 0 offen offset:256
    s_cbranch_scc1 L_ev3
L_st4:
    s_bitcmp1_b32 s52, 4
    s_waitcnt vmcnt(12)
    v_smfmac_f32_16x16x64_bf16 v[16:19], v[24:27], v[112:119], v14
    v_and_b32_dpp v28, v33, v12 row_newbcast:10 row_mask:0xf bank_mask:0xf
    v_and_b32_dpp v29, v33, v13 row_newbcast:10 row_mask:0xf bank_mask:0xf
    v_smfmac_f32_16x16x64_bf16 v[20:23], v[24:27], v[120:127], v14
    v_and_b32_dpp v30, v33, v12 row_newbcast:11 row_mask:0xf bank_mask:0xf
    v_and_b32_dpp v31, v33, v13 row_newbcast:11 row_mask:0xf bank_mask:0xf
    v_add_u32_dpp v11, v34, v7 row_newbcast:0 row_mask:0xf bank_mask:0xf
    buffer_load_dwordx4 v[48:51], v11, s[32:35], 0 offen offset:0
    buffer_load_dwordx4 v[56:59], v11, s[32:35], 0 offen offset:256
    v_add_u32_dpp v11, v34, v7 row_newbcast:1 row_mask:0xf bank_mask:0xf
    buffer_load_dwordx4 v[52:55], v11, s[32:35], 0 offen offset:0
    buffer_load_dwordx4 v[60:63], v11, s[32:35], 0 offen offset:256
    s_cbranch_scc1 L_ev4
L_st5:
    s_bitcmp1_b32 s52, 5
    s_waitcnt vmcnt(12)
    v_smfmac_f32_16x16x64_bf16 v[16:19], v[28:31], v[128:135], v14
    v_and_b32_dpp v24, v33, v12 row_newbcast:12 row_mask:0xf bank_mask:0xf
    v_and_b32_dpp v25, v33, v13 row_newbcast:12 row_mask:0xf bank_mask:0xf
    v_smfmac_f32_16x16x64_bf16 v[20:23], v[28:31], v[136:143], v14
    v_and_b32_dpp v26, v33, v12 row_newbcast:13 row_mask:0xf bank_mask:0xf
    v_and_b32_dpp v27, v33, v13 row_newbcast:13 row_mask:0xf bank_mask:0xf
    v_add_u32_dpp v11, v34, v7 row_newbcast:2 row_mask:0xf bank_mask:0xf
    buffer_load_dwordx4 v[64:67], v11, s[32:35], 0 offen offset:0
    buffer_load_dwordx4 v[72:75], v11, s[32:35], 0 offen offset:256
    v_add_u32_dpp v11, v34, v7 row_newbcast:3 row_mask:0xf bank_mask:0xf
    buffer_load_dwordx4 v[68:71], v11, s[32:35], 0 offen offset:0
    buffer_load_dwordx4 v[76:79], v11, s[32:35], 0 offen offset:256
    s_cbranch_scc1 L_ev5
L_st6:
    s_bitcmp1_b32 s52, 6
    s_waitcnt vmcnt(12)
    v_smfmac_f32_16x16x64_bf16 v[16:19], v[24:27], v[144:151], v14
    v_and_b32_dpp v28, v33, v12 row_newbcast:14 row_mask:0xf bank_mask:0xf
    v_and_b32_dpp v29, v33, v13 row_newbcast:14 row_mask:0xf bank_mask:0xf
    v_smfmac_f32_16x16x64_bf16 v[20:23], v[24:27], v[152:159], v14
    v_and_b32_dpp v30, v33, v12 row_newbcast:15 row_mask:0xf bank_mask:0xf
    v_and_b32_dpp v31, v33, v13 row_newbcast:15 row_mask:0xf bank_mask:0xf
    v_add_u32_dpp v11, v34, v7 row_newbcast:4 row_mask:0xf bank_mask:0xf
    buffer_load_dwordx4 v[80:83], v11, s[32:35], 0 offen offset:0
    buffer_load_dwordx4 v[88:91], v11, s[32:35], 0 offen offset:256
    v_add_u32_dpp v11, v34, v7 row_newbcast:5 row_mask:0xf bank_mask:0xf
    buffer_load_dwordx4 v[84:87], v11, s[32:35], 0 offen offset:0
    buffer_load_dwordx4 v[92:95], v11, s[32:35], 0 offen offset:256
    s_cbranch_scc1 L_ev6
L_st7:
    s_bitcmp1_b32 s52, 7
    s_waitcnt vmcnt(12)
    v_smfmac_f32_16x16x64_bf16 v[16:19], v[28:31], v[160:167], v14
    v_and_b32_dpp v24, v35, v12 row_newbcast:0 row_mask:0xf bank_mask:0xf
    v_and_b32_dpp v25, v35, v13 row_newbcast:0 row_mask:0xf bank_mask:0xf
    v_smfmac_f32_16x16x64_bf16 v[20:23], v[28:31], v[168:175], v14
    v_and_b32_dpp v26, v35, v12 row_newbcast:1 row_mask:0xf bank_mask:0xf
    v_and_b32_dpp v27, v35, v13 row_newbcast:1 row_mask:0xf bank_mask:0xf
    v_add_u32_dpp v11, v34, v7 row_newbcast:6 row_mask:0xf bank_mask:0xf
    buffer_load_dwordx4 v[96:99], v11, s[32:35], 0 offen offset:0
    buffer_load_dwordx4 v[104:107], v11, s[32:35], 0 offen offset:256
    v_add_u32_dpp v11, v34, v7 row_newbcast:7 row_mask:0xf bank_mask:0xf
    buffer_load_dwordx4 v[100:103], v11, s[32:35], 0 offen offset:0
    buffer_load_dwordx4 v[108:111], v11, s[32:35], 0 offen offset:256
    s_cbranch_scc1 L_ev7
L_st8:
    v_mov_b64 v[32:33], v[34:35]
    v_mov_b64 v[34:35], v[36:37]
    v_mov_b64 v[36:37], v[38:39]
    s_lshr_b32 s52, s52, 8
    s_lshr_b32 s53, s53, 8
    s_lshr_b32 s56, s56, 8
    s_branch L_st0
L_pad8:
    s_setpc_b64 s[68:69]
L_dr0:
    s_bitcmp1_b32 s52, 0
    ds_write_b32 v10, v6 offset:48
    s_waitcnt vmcnt(12)
    v_smfmac_f32_16x16x64_bf16 v[16:19], v[24:27], v[48:55], v14
    v_and_b32_dpp v28, v33, v12 row_newbcast:2 row_mask:0xf bank_mask:0xf
    v_and_b32_dpp v29, v33, v13 row_newbcast:2 row_mask:0xf bank_mask:0xf
    v_smfmac_f32_16x16x64_bf16 v[20:23], v[24:27], v[56:63], v14
    v_and_b32_dpp v30, v33, v12 row_newbcast:3 row_mask:0xf bank_mask:0xf
    v_and_b32_dpp v31, v33, v13 row_newbcast:3 row_mask:0xf bank_mask:0xf
    buffer_load_ubyte v15, off, s[32:35], 0
    buffer_load_ubyte v15, off, s[32:35], 0
    buffer_load_ubyte v15, off, s[32:35], 0
    buffer_load_ubyte v15, off, s[32:35], 0
    s_cbranch_scc1 L_ev0
L_dr1:
    s_bitcmp1_b32 s52, 1
    ds_write_b32 v10, v6 offset:48
    s_waitcnt vmcnt(12)
    v_smfmac_f32_16x16x64_bf16 v[16:19], v[28:31], v[64:71], v14
    v_and_b32_dpp v24, v33, v12 row_newbcast:4 row_mask:0xf bank_mask:0xf
    v_and_b32_dpp v25, v33, v13 row_newbcast:4 row_mask:0xf bank_mask:0xf
    v_smfmac_f32_16x16x64_bf16 v[20:23], v[28:31], v[72:79], v14
    v_and_b32_dpp v26, v33, v12 row_newbcast:5 row_mask:0xf bank_mask:0xf
    v_and_b32_dpp v27, v33, v13 row_newbcast:5 row_mask:0xf bank_mask:0xf
    buffer_load_ubyte v15, off, s[32:35], 0
    buffer_load_ubyte v15, off, s[32:35], 0
    buffer_load_ubyte v15, off, s[32:35], 0
    buffer_load_ubyte v15, off, s[32:35], 0
    s_cbranch_scc1 L_ev1
L_dr2:
    s_bitcmp1_b32 s52, 2
    ds_write_b32 v10, v6 offset:48
    s_waitcnt vmcnt(12)
    v_smfmac_f32_16x16x64_bf16 v[16:19], v[24:27], v[80:87], v14
    v_and_b32_dpp v28, v33, v12 row_newbcast:6 row_mask:0xf bank_mask:0xf
    v_and_b32_dpp v29, v33, v13 row_newbcast:6 row_mask:0xf bank_mask:0xf
    v_smfmac_f32_16x16x64_bf16 v[20:23], v[24:27], v[88:95], v14
    v_and_b32_dpp v30, v33, v12 row_newbcast:7 row_mask:0xf bank_mask:0xf
    v_and_b32_dpp v31, v33, v13 row_newbcast:7 row_mask:0xf bank_mask:0xf
    buffer_load_ubyte v15, off, s[32:35], 0
    buffer_load_ubyte v15, off, s[32:35], 0
    buffer_load_ubyte v15, off, s[32:35], 0
    buffer_load_ubyte v15, off, s[32:35], 0
    s_cbranch_scc1 L_ev2
L_dr3:
    s_bitcmp1_b32 s52, 3
    ds_write_b32 v10, v6 offset:48
    s_waitcnt vmcnt(12)
    v_smfmac_f32_16x16x64_bf16 v[16:19], v[28:31], v[96:103], v14
    v_and_b32_dpp v24, v33, v12 row_newbcast:8 row_mask:0xf bank_mask:0xf
    v_and_b32_dpp v25, v33, v13 row_newbcast:8 row_mask:0xf bank_mask:0xf
    v_smfmac_f32_16x16x64_bf16 v[20:23], v[28:31], v[104:111], v14
    v_and_b32_dpp v26, v33, v12 row_newbcast:9 row_mask:0xf bank_mask:0xf
    v_and_b32_dpp v27, v33, v13 row_newbcast:9 row_mask:0xf bank_mask:0xf
    buffer_load_ubyte v15, off, s[32:35], 0
    buffer_load_ubyte v15, off, s[32:35], 0
    buffer_load_ubyte v15, off, s[32:35], 0
    buffer_load_ubyte v15, off, s[32:35], 0
    s_cbranch_scc1 L_ev3
L_dr4:
    s_bitcmp1_b32 s52, 4
    ds_write_b32 v10, v6 offset:48
    s_waitcnt vmcnt(12)
    v_smfmac_f32_16x16x64_bf16 v[16:19], v[24:27], v[112:119], v14
    v_and_b32_dpp v28, v33, v12 row_newbcast:10 row_mask:0xf bank_mask:0xf
    v_and_b32_dpp v29, v33, v13 row_newbcast:10 row_mask:0xf bank_mask:0xf
    v_smfmac_f32_16x16x64_bf16 v[20:23], v[24:27], v[120:127], v14
    v_and_b32_dpp v30, v33, v12 row_newbcast:11 row_mask:0xf bank_mask:0xf
    v_and_b32_dpp v31, v33, v13 row_newbcast:11 row_mask:0xf bank_mask:0xf
    buffer_load_ubyte v15, off, s[32:35], 0
    buffer_load_ubyte v15, off, s[32:35], 0
    buffer_load_ubyte v15, off, s[32:35], 0
    buffer_load_ubyte v15, off, s[32:35], 0
    s_cbranch_scc1 L_ev4
L_dr5:
    s_bitcmp1_b32 s52, 5
    ds_write_b32 v10, v6 offset:48
    s_waitcnt vmcnt(12)
    v_smfmac_f32_16x16x64_bf16 v[16:19], v[28:31], v[128:135], v14
    v_and_b32_dpp v24, v33, v12 row_newbcast:12 row_mask:0xf bank_mask:0xf
    v_and_b32_dpp v25, v33, v13 row_newbcast:12 row_mask:0xf bank_mask:0xf
    v_smfmac_f32_16x16x64_bf16 v[20:23], v[28:31], v[136:143], v14
    v_and_b32_dpp v26, v33, v12 row_newbcast:13 row_mask:0xf bank_mask:0xf
    v_and_b32_dpp v27, v33, v13 row_newbcast:13 row_mask:0xf bank_mask:0xf
    buffer_load_ubyte v15, off, s[32:35], 0
    buffer_load_ubyte v15, off, s[32:35], 0
    buffer_load_ubyte v15, off, s[32:35], 0
    buffer_load_ubyte v15, off, s[32:35], 0
    s_cbranch_scc1 L_ev5
L_dr6:
    s_bitcmp1_b32 s52, 6
    ds_write_b32 v10, v6 offset:48
    s_waitcnt vmcnt(12)
    v_smfmac_f32_16x16x64_bf16 v[16:19], v[24:27], v[144:151], v14
    v_and_b32_dpp v28, v33, v12 row_newbcast:14 row_mask:0xf bank_mask:0xf
    v_and_b32_dpp v29, v33, v13 row_newbcast:14 row_mask:0xf bank_mask:0xf
    v_smfmac_f32_16x16x64_bf16 v[20:23], v[24:27], v[152:159], v14
    v_and_b32_dpp v30, v33, v12 row_newbcast:15 row_mask:0xf bank_mask:0xf
    v_and_b32_dpp v31, v33, v13 row_newbcast:15 row_mask:0xf bank_mask:0xf
    buffer_load_ubyte v15, off, s[32:35], 0
    buffer_load_ubyte v15, off, s[32:35], 0
    buffer_load_ubyte v15, off, s[32:35], 0
    buffer_load_ubyte v15, off, s[32:35], 0
    s_cbranch_scc1 L_ev6
L_dr7:
    s_bitcmp1_b32 s52, 7
    ds_write_b32 v10, v6 offset:48
    s_waitcnt vmcnt(12)
    v_smfmac_f32_16x16x64_bf16 v[16:19], v[28:31], v[160:167], v14
    v_and_b32_dpp v24, v35, v12 row_newbcast:0 row_mask:0xf bank_mask:0xf
    v_and_b32_dpp v25, v35, v13 row_newbcast:0 row_mask:0xf bank_mask:0xf
    v_smfmac_f32_16x16x64_bf16 v[20:23], v[28:31], v[168:175], v14
    v_and_b32_dpp v26, v35, v12 row_newbcast:1 row_mask:0xf bank_mask:0xf
    v_and_b32_dpp v27, v35, v13 row_newbcast:1 row_mask:0xf bank_mask:0xf
    buffer_load_ubyte v15, off, s[32:35], 0
    buffer_load_ubyte v15, off, s[32:35], 0
    buffer_load_ubyte v15, off, s[32:35], 0
    buffer_load_ubyte v15, off, s[32:35], 0
    s_cbranch_scc1 L_ev7
L_dr8:
    v_mov_b64 v[32:33], v[34:35]
    v_mov_b64 v[34:35], v[36:37]
    v_mov_b64 v[36:37], v[38:39]
    s_lshr_b32 s52, s52, 8
    s_lshr_b32 s53, s53, 8
    s_lshr_b32 s56, s56, 8
    s_branch L_dr0
L_pad0:
    s_setpc_b64 s[68:69]
L_ev0:
    s_and_b32 s65, s57, 15
    v_cmp_ge_u32 s[66:67], s65, v4
    v_cmp_gt_u32 s[68:69], s65, v4
    s_bitcmp1_b32 s56, 0
    s_cselect_b64 s[62:63], s[70:71], s[62:63]
    v_cndmask_b32 v40, 0, v28, s[66:67]
    v_cndmask_b32 v41, 0, v29, s[66:67]
    v_cndmask_b32 v42, 0, v30, s[68:69]
    v_cndmask_b32 v43, 0, v31, s[68:69]
    s_mul_i32 s64, s63, 0
    s_bitcmp1_b32 s53, 0
    s_cbranch_scc0 L_evret
    s_waitcnt vmcnt(12)
    v_smfmac_f32_16x16x64_bf16 v[16:19], v[40:43], v[64:71], v14
    v_xor_b32 v28, v28, v40
    v_xor_b32 v29, v29, v41
    v_smfmac_f32_16x16x64_bf16 v[20:23], v[40:43], v[72:79], v14
    v_xor_b32 v30, v30, v42
    v_xor_b32 v31, v31, v43
    s_branch L_flush
L_pad1:
    s_setpc_b64 s[68:69]
L_ev1:
    s_and_b32 s65, s57, 15
    v_cmp_ge_u32 s[66:67], s65, v4
    v_cmp_gt_u32 s[68:69], s65, v4
    s_bitcmp1_b32 s56, 1
    s_cselect_b64 s[62:63], s[70:71], s[62:63]
    v_cndmask_b32 v40, 0, v24, s[66:67]
    v_cndmask_b32 v41, 0, v25, s[66:67]
    v_cndmask_b32 v42, 0, v26, s[68:69]
    v_cndmask_b32 v43, 0, v27, s[68:69]
    s_mul_i32 s64, s63, 1
    s_bitcmp1_b32 s53, 1
    s_cbranch_scc0 L_evret
    s_waitcnt vmcnt(12)
    v_smfmac_f32_16x16x64_bf16 v[16:19], v[40:43], v[80:87], v14
    v_xor_b32 v24, v24, v40
    v_xor_b32 v25, v25, v41
    v_smfmac_f32_16x16x64_bf16 v[20:23], v[40:43], v[88:95], v14
    v_xor_b32 v26, v26, v42
    v_xor_b32 v27, v27, v43
    s_branch L_flush
L_pad2:
    s_setpc_b64 s[68:69]
L_ev2:
    s_and_b32 s65, s57, 15
    v_cmp_ge_u32 s[66:67], s65, v4
    v_cmp_gt_u32 s[68:69], s65, v4
    s_bitcmp1_b32 s56, 2
    s_cselect_b64 s[62:63], s[70:71], s[62:63]
    v_cndmask_b32 v40, 0, v28, s[66:67]
    v_cndmask_b32 v41, 0, v29, s[66:67]
    v_cndmask_b32 v42, 0, v30, s[68:69]
    v_cndmask_b32 v43, 0, v31, s[68:69]
    s_mul_i32 s64, s63, 2
    s_bitcmp1_b32 s53, 2
    s_cbranch_scc0 L_evret
    s_waitcnt vmcnt(12)
    v_smfmac_f32_16x16x64_bf16 v[16:19], v[40:43], v[96:103], v14
    v_xor_b32 v28, v28, v40
    v_xor_b32 v29, v29, v41
    v_smfmac_f32_16x16x64_bf16 v[20:23], v[40:43], v[104:111], v14
    v_xor_b32 v30, v30, v42
    v_xor_b32 v31, v31, v43
    s_branch L_flush
L_pad3:
    s_setpc_b64 s[68:69]
L_ev3:
    s_and_b32 s65, s57, 15
    v_cmp_ge_u32 s[66:67], s65, v4
    v_cmp_gt_u32 s[68:69], s65, v4
    s_bitcmp1_b32 s56, 3
    s_cselect_b64 s[62:63], s[70:71], s[62:63]
    v_cndmask_b32 v40, 0, v24, s[66:67]
    v_cndmask_b32 v41, 0, v25, s[66:67]
    v_cndmask_b32 v42, 0, v26, s[68:69]
    v_cndmask_b32 v43, 0, v27, s[68:69]
    s_mul_i32 s64, s63, 3
    s_bitcmp1_b32 s53, 3
    s_cbranch_scc0 L_evret
    s_waitcnt vmcnt(12)
    v_smfmac_f32_16x16x64_bf16 v[16:19], v[40:43], v[112:119], v14
    v_xor_b32 v24, v24, v40
    v_xor_b32 v25, v25, v41
    v_smfmac_f32_16x16x64_bf16 v[20:23], v[40:43], v[120:127], v14
    v_xor_b32 v26, v26, v42
    v_xor_b32 v27, v27, v43
    s_branch L_flush
L_pad4:
    s_setpc_b64 s[68:69]
L_ev4:
    s_and_b32 s65, s57, 15
    v_cmp_ge_u32 s[66:67], s65, v4
    v_cmp_gt_u32 s[68:69], s65, v4
    s_bitcmp1_b32 s56, 4
    s_cselect_b64 s[62:63], s[70:71], s[62:63]
    v_cndmask_b32 v40, 0, v28, s[66:67]
    v_cndmask_b32 v41, 0, v29, s[66:67]
    v_cndmask_b32 v42, 0, v30, s[68:69]
    v_cndmask_b32 v43, 0, v31, s[68:69]
    s_mul_i32 s64, s63, 4
    s_bitcmp1_b32 s53, 4
    s_cbranch_scc0 L_evret
    s_waitcnt vmcnt(12)
    v_smfmac_f32_16x16x64_bf16 v[16:19], v[40:43], v[128:135], v14
    v_xor_b32 v28, v28, v40
    v_xor_b32 v29, v29, v41
    v_smfmac_f32_16x16x64_bf16 v[20:23], v[40:43], v[136:143], v14
    v_xor_b32 v30, v30, v42
    v_xor_b32 v31, v31, v43
    s_branch L_flush
L_pad5:
    s_setpc_b64 s[68:69]
L_ev5:
    s_and_b32 s65, s57, 15
    v_cmp_ge_u32 s[66:67], s65, v4
    v_cmp_gt_u32 s[68:69], s65, v4
    s_bitcmp1_b32 s56, 5
    s_cselect_b64 s[62:63], s[70:71], s[62:63]
    v_cndmask_b32 v40, 0, v24, s[66:67]
    v_cndmask_b32 v41, 0, v25, s[66:67]
    v_cndmask_b32 v42, 0, v26, s[68:69]
    v_cndmask_b32 v43, 0, v27, s[68:69]
    s_mul_i32 s64, s63, 5
    s_bitcmp1_b32 s53, 5
    s_cbranch_scc0 L_evret
    s_waitcnt vmcnt(12)
    v_smfmac_f32_16x16x64_bf16 v[16:19], v[40:43], v[144:151], v14
    v_xor_b32 v24, v24, v40
    v_xor_b32 v25, v25, v41
    v_smfmac_f32_16x16x64_bf16 v[20:23], v[40:43], v[152:159], v14
    v_xor_b32 v26, v26, v42
    v_xor_b32 v27, v27, v43
    s_branch L_flush
L_pad6:
    s_setpc_b64 s[68:69]
L_ev6:
    s_and_b32 s65, s57, 15
    v_cmp_ge_u32 s[66:67], s65, v4
    v_cmp_gt_u32 s[68:69], s65, v4
    s_bitcmp1_b32 s56, 6
    s_cselect_b64 s[62:63], s[70:71], s[62:63]
    v_cndmask_b32 v40, 0, v28, s[66:67]
    v_cndmask_b32 v41, 0, v29, s[66:67]
    v_cndmask_b32 v42, 0, v30, s[68:69]
    v_cndmask_b32 v43, 0, v31, s[68:69]
    s_mul_i32 s64, s63, 6
    s_bitcmp1_b32 s53, 6
    s_cbranch_scc0 L_evret
    s_waitcnt vmcnt(12)
    v_smfmac_f32_16x16x64_bf16 v[16:19], v[40:43], v[160:167], v14
    v_xor_b32 v28, v28, v40
    v_xor_b32 v29, v29, v41
    v_smfmac_f32_16x16x64_bf16 v[20:23], v[40:43], v[168:175], v14
    v_xor_b32 v30, v30, v42
    v_xor_b32 v31, v31, v43
    s_branch L_flush
L_pad7:
    s_setpc_b64 s[68:69]
L_ev7:
    s_and_b32 s65, s57, 15
    v_cmp_ge_u32 s[66:67], s65, v4
    v_cmp_gt_u32 s[68:69], s65, v4
    s_bitcmp1_b32 s56, 7
    s_cselect_b64 s[62:63], s[70:71], s[62:63]
    v_cndmask_b32 v40, 0, v24, s[66:67]
    v_cndmask_b32 v41, 0, v25, s[66:67]
    v_cndmask_b32 v42, 0, v26, s[68:69]
    v_cndmask_b32 v43, 0, v27, s[68:69]
    s_mul_i32 s64, s63, 7
    s_bitcmp1_b32 s53, 7
    s_cbranch_scc0 L_evret
    s_waitcnt vmcnt(12)
    v_smfmac_f32_16x16x64_bf16 v[16:19], v[40:43], v[48:55], v14
    v_xor_b32 v24, v24, v40
    v_xor_b32 v25, v25, v41
    v_smfmac_f32_16x16x64_bf16 v[20:23], v[40:43], v[56:63], v14
    v_xor_b32 v26, v26, v42
    v_xor_b32 v27, v27, v43
    s_nop 0
L_flush:
    s_lshr_b32 s57, s57, 4
    s_cmp_eq_u32 s26, 4
    v_add_u32 v1, 1, v1
    v_mul_f32 v40, v177, v16
    v_mul_f32 v41, v177, v17
    v_mul_f32 v42, v177, v18
    v_mul_f32 v43, v177, v19
    v_cvt_pk_bf16_f32 v40, v40, v41
    v_cvt_pk_bf16_f32 v41, v42, v43
    ds_write_b64 v176, v[40:41] offset:41984
    v_mul_f32 v44, v177, v20
    v_mul_f32 v45, v177, v21
    v_mul_f32 v46, v177, v22
    v_mul_f32 v47, v177, v23
    v_cvt_pk_bf16_f32 v44, v44, v45
    v_cvt_pk_bf16_f32 v45, v46, v47
    ds_write_b64 v176, v[44:45] offset:42240
    ds_write_b32 v10, v1 offset:32
    s_cbranch_scc1 L_sdone
    v_mov_b64 v[16:17], 0
    v_mov_b64 v[18:19], 0
    v_mov_b64 v[20:21], 0
    v_mov_b64 v[22:23], 0
    s_add_u32 s26, s26, 1
    v_mov_b64 v[176:177], v[178:179]
    v_mov_b64 v[178:179], v[180:181]
    v_mov_b64 v[180:181], v[182:183]
    v_mov_b64 v[182:183], v[184:185]
L_evret:
    s_add_u32 s64, s64, s62
    s_add_u32 s54, s72, s64
    s_addc_u32 s55, s73, 0
    s_setpc_b64 s[54:55]
L_pad9:
    s_setpc_b64 s[68:69]
L_slow:
    s_mov_b32 s62, L_slow_pair-L_anc
    v_mbcnt_lo_u32_b32 v200, -1, 0
    v_mbcnt_hi_u32_b32 v200, -1, v200
L_slow_pair:
    v_lshlrev_b32 v201, 2, v200
    s_mul_i32 s70, s1, 40
    s_lshl1_add_u32 s70, s24, s70
    s_mov_b32 s71, 0
    s_mov_b32 s24, s20
    s_mov_b32 s20, s21
    s_mov_b32 s21, s22
    s_mov_b32 s22, s23
L_slow_chunk:
    global_load_dword v202, v201, s[8:9]
    global_load_dword v203, v201, s[6:7]
    v_add_u32 v201, 0x100, v201
    s_waitcnt vmcnt(0)
    v_subrev_u32 v202, s70, v202
    v_cmp_gt_u32 vcc, 2, v202
    v_lshlrev_b32 v204, 1, v203
    ds_read_u16 v204, v204 offset:62464
    s_mov_b64 s[76:77], vcc
    v_lshlrev_b32 v202, 4, v202
    v_lshlrev_b32 v203, 9, v203
    s_waitcnt lgkmcnt(0)
    v_lshlrev_b32 v204, v202, v204
L_slow_edge:
    s_cmp_eq_u64 s[76:77], 0
    s_cbranch_scc1 L_slow_next
    s_ff1_i32_b64 s74, s[76:77]
    s_bitset0_b64 s[76:77], s74
    v_readlane_b32 s64, v203, s74
    v_readlane_b32 s65, v204, s74
    v_mov_b32 v205, 0
    v_mov_b32 v11, 2147483648
    s_mov_b64 exec, 0xffff
    v_mov_b32 v205, s65
    v_add_u32 v11, s64, v7
    s_mov_b64 exec, -1
    buffer_load_dwordx4 v[208:211], v11, s[32:35], 0 offen
    buffer_load_dwordx4 v[212:215], v11, s[32:35], 0 offen offset:256
    v_and_b32 v24, v205, v12
    v_and_b32 v25, v205, v13
    s_nop 0
    s_waitcnt vmcnt(0)
    v_smfmac_f32_16x16x32_bf16 v[16:19], v[24:25], v[208:211], v14
    v_smfmac_f32_16x16x32_bf16 v[20:23], v[24:25], v[212:215], v14
    s_branch L_slow_edge
L_slow_next:
    s_add_u32 s71, s71, 1
    s_cmp_lt_u32 s71, 2500
    s_cbranch_scc1 L_slow_chunk
    s_mov_b32 s64, 0
    s_nop 3
    s_branch L_flush
L_sdone:
    ds_write_b32 v10, v6 offset:48
    s_waitcnt lgkmcnt(0)
    s_barrier
    s_endpgm
L_retry_16:
    s_sub_u32 s100, s100, 1
    s_cbranch_scc1 L_end
    s_sleep 1
    s_branch L_spin_15
L_retry_17:
    s_sub_u32 s100, s100, 1
    s_cbranch_scc1 L_end
    s_sleep 4
    s_branch L_ipoll_14
L_retry_23:
    s_sub_u32 s100, s100, 1
    s_cbranch_scc1 L_end
    s_sleep 2
    s_branch L_secload_22
L_secload_22:
    buffer_load_dwordx4 v[56:59], v8, s[40:43], s12 offen sc1
    s_waitcnt vmcnt(0)
    s_branch L_sec_20
L_retry_27:
    s_sub_u32 s100, s100, 1
    s_cbranch_scc1 L_end
    s_sleep 2
    s_branch L_secload_26
L_secload_26:
    buffer_load_dwordx4 v[60:63], v8, s[40:43], s13 offen sc1
    s_waitcnt vmcnt(0)
    s_branch L_sec_24
L_retry_29:
    s_sub_u32 s100, s100, 1
    s_cbranch_scc1 L_end
    s_sleep 1
    s_branch L_spin_28
L_mwork_4:
    v_xor_b32 v44, v4, v3
    v_lshlrev_b32 v44, 4, v44
    v_lshl_add_u32 v44, v3, 9, v44
    v_xor_b32 v45, 64, v44
    v_xor_b32 v46, 0x80, v44
    v_xor_b32 v47, 0xc0, v44
    s_cmp_lg_u32 s31, 0
    s_waitcnt vmcnt(0)
    s_barrier
    s_cbranch_scc1 L_worked_5_w
    ds_read_b128 v[48:51], v44 offset:62464
    ds_read_b128 v[52:55], v44 offset:21504
    ds_read_b128 v[56:59], v44 offset:29696
    ds_read_b128 v[60:63], v45 offset:62464
    ds_read_b128 v[64:67], v45 offset:21504
    ds_read_b128 v[68:71], v45 offset:29696
    ds_read_b128 v[72:75], v46 offset:62464
    ds_read_b128 v[76:79], v46 offset:21504
    ds_read_b128 v[80:83], v46 offset:29696
    ds_read_b128 v[84:87], v47 offset:62464
    ds_read_b128 v[88:91], v47 offset:21504
    ds_read_b128 v[92:95], v47 offset:29696
    s_waitcnt lgkmcnt(9)
    v_mfma_f32_16x16x32_bf16 v[16:19], v[52:55], v[48:51], 0
    v_mfma_f32_16x16x32_bf16 v[20:23], v[56:59], v[48:51], 0
    ds_read_b128 v[96:99], v44 offset:62720
    ds_read_b128 v[100:103], v44 offset:21760
    ds_read_b128 v[104:107], v44 offset:29952
    s_waitcnt lgkmcnt(9)
    v_mfma_f32_16x16x32_bf16 v[16:19], v[64:67], v[60:63], v[16:19]
    v_mfma_f32_16x16x32_bf16 v[20:23], v[68:71], v[60:63], v[20:23]
    ds_read_b128 v[108:111], v45 offset:62720
    ds_read_b128 v[112:115], v45 offset:21760
    ds_read_b128 v[116:119], v45 offset:29952
    s_waitcnt lgkmcnt(9)
    v_mfma_f32_16x16x32_bf16 v[16:19], v[76:79], v[72:75], v[16:19]
    v_mfma_f32_16x16x32_bf16 v[20:23], v[80:83], v[72:75], v[20:23]
    ds_read_b128 v[120:123], v46 offset:62720
    ds_read_b128 v[124:127], v46 offset:21760
    ds_read_b128 v[128:131], v46 offset:29952
    s_waitcnt lgkmcnt(9)
    v_mfma_f32_16x16x32_bf16 v[16:19], v[88:91], v[84:87], v[16:19]
    v_mfma_f32_16x16x32_bf16 v[20:23], v[92:95], v[84:87], v[20:23]
    ds_read_b128 v[132:135], v47 offset:62720
    ds_read_b128 v[136:139], v47 offset:21760
    ds_read_b128 v[140:143], v47 offset:29952
    s_waitcnt lgkmcnt(9)
    v_mfma_f32_16x16x32_bf16 v[16:19], v[100:103], v[96:99], v[16:19]
    v_mfma_f32_16x16x32_bf16 v[20:23], v[104:107], v[96:99], v[20:23]
    s_waitcnt lgkmcnt(6)
    v_mfma_f32_16x16x32_bf16 v[16:19], v[112:115], v[108:111], v[16:19]
    v_mfma_f32_16x16x32_bf16 v[20:23], v[116:119], v[108:111], v[20:23]
    s_waitcnt lgkmcnt(3)
    v_mfma_f32_16x16x32_bf16 v[16:19], v[124:127], v[120:123], v[16:19]
    v_mfma_f32_16x16x32_bf16 v[20:23], v[128:131], v[120:123], v[20:23]
    s_waitcnt lgkmcnt(0)
    v_mfma_f32_16x16x32_bf16 v[16:19], v[136:139], v[132:135], v[16:19]
    v_mfma_f32_16x16x32_bf16 v[20:23], v[140:143], v[132:135], v[20:23]
    s_lshl_b32 s64, s27, 10
    s_add_u32 s64, s64, 65536
    v_lshl_add_u32 v40, v2, 4, s64
    s_lshl_b32 s64, s27, 2
    s_add_u32 s64, s64, 4096
    v_lshl_add_u32 v41, v2, 9, s64
    v_mov_b32 v42, s30
    s_nop 1
    v_cvt_pk_bf16_f32 v44, v16, v17
    v_cvt_pk_bf16_f32 v45, v18, v19
    v_cvt_pk_bf16_f32 v46, v20, v21
    v_cvt_pk_bf16_f32 v47, v22, v23
    global_store_dwordx4 v40, v[44:47], s[28:29] sc1
    s_barrier
    s_mov_b32 s26, 2
    s_waitcnt vmcnt(0)
    s_mov_b64 exec, 0xff
    global_store_dword v41, v42, s[28:29] sc1
    s_mov_b64 exec, -1
    s_branch L_worked_5
L_worked_5_w:
    s_barrier
    s_branch L_worked_5
L_gemm:
    v_lshrrev_b32 v0, 5, v2
    s_lshl_b32 s64, s31, 1
    v_add_u32 v0, s64, v0
    v_and_b32 v1, 31, v2
    v_xor_b32 v1, v1, v0
    v_lshlrev_b32 v1, 4, v1
    v_lshl_add_u32 v30, v0, 9, v1
    v_xor_b32 v31, 0x80, v30
    v_lshrrev_b32 v13, 3, v2
    v_lshrrev_b32 v15, 2, v2
    v_and_b32 v15, 4, v15
    v_and_b32 v14, 7, v2
    v_xor_b32 v15, v15, v14
    v_lshlrev_b32 v15, 4, v15
    v_lshl_add_u32 v13, v13, 9, v15
    s_lshr_b32 s67, s2, 3
    s_and_b32 s67, s67, 7
    s_lshl_b32 s64, s31, 7
    s_lshl_b32 s65, s67, 14
    s_or_b32 s64, s64, s65
    v_add_u32 v13, s64, v13
    s_mul_i32 s63, s1, 20480
    s_lshl_b32 s66, s31, 10
    s_lshl_b32 s70, s31, 14
    s_add_u32 s70, s70, 82944
    s_mov_b32 s71, 3072
    s_mov_b32 s72, 6144
    s_mov_b32 s73, 9216
    s_waitcnt lgkmcnt(0)
    s_mov_b32 s32, s4
    s_and_b32 s33, s5, 0xffff
    s_mov_b32 s34, 5120000
    s_mov_b32 s35, 0x20000
    s_mov_b32 s36, s22
    s_and_b32 s37, s23, 0xffff
    s_mov_b32 s38, 131072
    s_mov_b32 s39, 0x20000
    s_bitcmp1_b32 s2, 3
    s_cbranch_scc0 L_touched_30
    s_lshr_b32 s64, s2, 4
    s_lshl_b32 s64, s64, 3
    s_and_b32 s68, s2, 7
    s_or_b32 s64, s64, s68
    s_lshl_b32 s64, s64, 10
    v_lshl_add_u32 v16, v2, 4, s64
    s_cmp_eq_u32 s31, 1
    s_cselect_b64 s[68:69], s[22:23], s[16:17]
    s_cmp_eq_u32 s31, 2
    s_cselect_b64 s[68:69], s[18:19], s[68:69]
    s_cmp_eq_u32 s31, 3
    s_cselect_b64 s[68:69], s[20:21], s[68:69]
    global_load_dwordx4 v[20:23], v16, s[68:69]
L_touched_30:
    s_cmp_ge_u32 s2, 250
    s_cbranch_scc1 L_end
    s_mul_i32 s64, s1, 20480
    s_mov_b32 s76, 0
    s_cmp_eq_u32 s31, 0
    s_cselect_b64 s[68:69], s[24:25], s[16:17]
    s_cselect_b32 s64, s64, 0
    s_cmp_eq_u32 s31, 2
    s_cselect_b64 s[68:69], s[28:29], s[68:69]
    s_cselect_b32 s64, 0x800, s64
    s_cselect_b32 s76, 0x2f8000, s76
    s_cmp_eq_u32 s31, 3
    s_cselect_b64 s[68:69], s[4:5], s[68:69]
    s_cselect_b32 s76, 0x200000, s76
    s_cselect_b32 s77, 2, 1
    v_min_u32 v17, s77, v2
    v_mul_lo_u32 v17, v17, s76
    v_add_u32 v17, s64, v17
    global_load_dword v24, v17, s[68:69]
    s_barrier
    s_setprio 2
    s_add_u32 m0, s66, 1024
    s_nop 0
    buffer_load_dwordx4 v30, s[32:35], s63 offen lds
    s_add_u32 m0, s66, 5120
    s_add_u32 s63, s63, 4096
    buffer_load_dwordx4 v31, s[32:35], s63 offen lds
    s_add_u32 m0, s70, 0
    s_nop 0
    buffer_load_dwordx4 v13, s[36:39], 0 offen offset:0 lds
    buffer_load_dwordx4 v13, s[36:39], s71 offen offset:1024 lds
    buffer_load_dwordx4 v13, s[36:39], s72 offen offset:2048 lds
    buffer_load_dwordx4 v13, s[36:39], s73 offen offset:3072 lds
    v_xor_b32 v13, 16384, v13
    s_mov_b32 s40, s16
    s_and_b32 s41, s17, 0xffff
    s_mov_b32 s42, 131072
    s_mov_b32 s43, 0x20000
    s_mov_b32 s44, s28
    s_and_b32 s45, s29, 0xffff
    s_mov_b32 s46, 1048576
    s_mov_b32 s47, 0x20000
    s_mov_b32 s48, s24
    s_and_b32 s49, s25, 0xffff
    s_mov_b32 s50, 5120000
    s_mov_b32 s51, 0x20000
    v_xor_b32 v15, v4, v3
    v_lshlrev_b32 v15, 4, v15
    v_lshl_add_u32 v7, v3, 9, v15
    s_lshl_b32 s64, s67, 6
    v_xor_b32 v7, s64, v7
    v_xor_b32 v8, 64, v7
    v_xor_b32 v9, 0x80, v7
    v_xor_b32 v10, 0xc0, v7
    v_lshrrev_b32 v15, 2, v3
    v_lshl_add_u32 v15, v4, 3, v15
    v_lshlrev_b32 v15, 7, v15
    v_lshrrev_b32 v14, 1, v3
    v_and_b32 v14, 4, v14
    v_and_b32 v0, 3, v3
    v_xor_b32 v14, v14, v0
    v_lshl_add_u32 v15, v14, 4, v15
    v_add_u32 v11, s70, v15
    v_xor_b32 v12, 64, v11
    v_and_b32 v0, 31, v2
    v_lshlrev_b32 v0, 2, v0
    s_and_b32 s64, s2, 7
    s_lshl_b32 s64, s64, 9
    s_lshl_b32 s65, s31, 7
    s_add_u32 s64, s64, s65
    s_add_u32 s74, s64, 4096
    v_lshlrev_b32 v14, 4, v2
    s_lshl_b32 s75, s31, 15
    s_lshl_b32 s64, s67, 12
    s_or_b32 s75, s75, s64
    s_add_u32 s75, s75, 65536
    s_cmp_eq_u32 s31, 0
    s_cbranch_scc0 L_nw_32
    s_call_b64 s[68:69], L_pad0
    s_call_b64 s[68:69], L_pad1
    s_call_b64 s[68:69], L_pad8
    s_branch L_warmed_31
L_nw_32:
    s_cmp_eq_u32 s31, 1
    s_cbranch_scc0 L_nw_33
    s_call_b64 s[68:69], L_pad2
    s_call_b64 s[68:69], L_pad3
    s_call_b64 s[68:69], L_pad9
    s_branch L_warmed_31
L_nw_33:
    s_cmp_eq_u32 s31, 2
    s_cbranch_scc0 L_nw_34
    s_call_b64 s[68:69], L_pad4
    s_call_b64 s[68:69], L_pad5
    s_branch L_warmed_31
L_nw_34:
    s_call_b64 s[68:69], L_pad6
    s_call_b64 s[68:69], L_pad7
L_warmed_31:
    s_add_u32 m0, s66, 9216
    s_add_u32 s63, s63, 4096
    buffer_load_dwordx4 v30, s[32:35], s63 offen lds
    s_add_u32 m0, s66, 13312
    s_add_u32 s63, s63, 4096
    buffer_load_dwordx4 v31, s[32:35], s63 offen lds
    s_add_u32 m0, s66, 17408
    s_add_u32 s63, s63, 4096
    buffer_load_dwordx4 v30, s[32:35], s63 offen lds
    s_barrier
    s_add_u32 m0, s70, 4096
    s_waitcnt vmcnt(9)
    buffer_load_dwordx4 v13, s[36:39], 0 offen offset:0 lds
    s_waitcnt vmcnt(9)
    buffer_load_dwordx4 v13, s[36:39], s71 offen offset:1024 lds
    s_waitcnt vmcnt(9)
    buffer_load_dwordx4 v13, s[36:39], s72 offen offset:2048 lds
    s_waitcnt vmcnt(9)
    buffer_load_dwordx4 v13, s[36:39], s73 offen offset:3072 lds
    v_xor_b32 v13, 49152, v13
    s_bitcmp1_b32 s2, 3
    s_cbranch_scc1 L_nobar_36
    s_barrier
L_nobar_36:
    s_add_u32 m0, s70, 8192
    s_waitcnt vmcnt(4)
    buffer_load_dwordx4 v13, s[36:39], 0 offen offset:0 lds
    s_waitcnt vmcnt(4)
    buffer_load_dwordx4 v13, s[36:39], s71 offen offset:1024 lds
    s_waitcnt vmcnt(4)
    buffer_load_dwordx4 v13, s[36:39], s72 offen offset:2048 lds
    s_waitcnt vmcnt(4)
    buffer_load_dwordx4 v13, s[36:39], s73 offen offset:3072 lds
    v_xor_b32 v13, 16384, v13
    s_add_u32 m0, s70, 12288
    s_waitcnt vmcnt(4)
    buffer_load_dwordx4 v13, s[36:39], 0 offen offset:0 lds
    s_waitcnt vmcnt(4)
    buffer_load_dwordx4 v13, s[36:39], s71 offen offset:1024 lds
    s_waitcnt vmcnt(4)
    buffer_load_dwordx4 v13, s[36:39], s72 offen offset:2048 lds
    s_waitcnt vmcnt(4)
    buffer_load_dwordx4 v13, s[36:39], s73 offen offset:3072 lds
    v_xor_b32 v13, 114688, v13
    s_waitcnt vmcnt(12)
    ds_read_b64_tr_b16 v[128:129], v11 offset:0
    ds_read_b64_tr_b16 v[130:131], v11 offset:512
    ds_read_b64_tr_b16 v[132:133], v11 offset:8
    ds_read_b64_tr_b16 v[134:135], v11 offset:520
    ds_read_b64_tr_b16 v[136:137], v12 offset:0
    ds_read_b64_tr_b16 v[138:139], v12 offset:512
    ds_read_b64_tr_b16 v[140:141], v12 offset:8
    ds_read_b64_tr_b16 v[142:143], v12 offset:520
    s_waitcnt lgkmcnt(0)
    s_add_u32 m0, s70, 0
    s_waitcnt vmcnt(4)
    buffer_load_dwordx4 v13, s[36:39], 0 offen offset:0 lds
    s_waitcnt vmcnt(4)
    buffer_load_dwordx4 v13, s[36:39], s71 offen offset:1024 lds
    s_waitcnt vmcnt(4)
    buffer_load_dwordx4 v13, s[36:39], s72 offen offset:2048 lds
    s_waitcnt vmcnt(4)
    buffer_load_dwordx4 v13, s[36:39], s73 offen offset:3072 lds
    v_xor_b32 v13, 16384, v13
    s_waitcnt vmcnt(12)
    s_waitcnt lgkmcnt(0)
    s_mov_b64 exec, 1
    ds_add_u32 v5, v6 offset:4
    s_mov_b64 exec, -1
    ds_read_b64_tr_b16 v[144:145], v11 offset:4096
    ds_read_b64_tr_b16 v[146:147], v11 offset:4608
    ds_read_b64_tr_b16 v[148:149], v11 offset:4104
    ds_read_b64_tr_b16 v[150:151], v11 offset:4616
    ds_read_b64_tr_b16 v[152:153], v12 offset:4096
    ds_read_b64_tr_b16 v[154:155], v12 offset:4608
    ds_read_b64_tr_b16 v[156:157], v12 offset:4104
    ds_read_b64_tr_b16 v[158:159], v12 offset:4616
    s_waitcnt lgkmcnt(0)
    s_add_u32 m0, s70, 4096
    s_waitcnt vmcnt(4)
    buffer_load_dwordx4 v13, s[36:39], 0 offen offset:0 lds
    s_waitcnt vmcnt(4)
    buffer_load_dwordx4 v13, s[36:39], s71 offen offset:1024 lds
    s_waitcnt vmcnt(4)
    buffer_load_dwordx4 v13, s[36:39], s72 offen offset:2048 lds
    s_waitcnt vmcnt(4)
    buffer_load_dwordx4 v13, s[36:39], s73 offen offset:3072 lds
    v_xor_b32 v13, 49152, v13
    s_waitcnt vmcnt(12)
    ds_read_b64_tr_b16 v[160:161], v11 offset:8192
    ds_read_b64_tr_b16 v[162:163], v11 offset:8704
    ds_read_b64_tr_b16 v[164:165], v11 offset:8200
    ds_read_b64_tr_b16 v[166:167], v11 offset:8712
    ds_read_b64_tr_b16 v[168:169], v12 offset:8192
    ds_read_b64_tr_b16 v[170:171], v12 offset:8704
    ds_read_b64_tr_b16 v[172:173], v12 offset:8200
    ds_read_b64_tr_b16 v[174:175], v12 offset:8712
    s_waitcnt lgkmcnt(0)
    s_add_u32 m0, s70, 8192
    s_waitcnt vmcnt(4)
    buffer_load_dwordx4 v13, s[36:39], 0 offen offset:0 lds
    s_waitcnt vmcnt(4)
    buffer_load_dwordx4 v13, s[36:39], s71 offen offset:1024 lds
    s_waitcnt vmcnt(4)
    buffer_load_dwordx4 v13, s[36:39], s72 offen offset:2048 lds
    s_waitcnt vmcnt(4)
    buffer_load_dwordx4 v13, s[36:39], s73 offen offset:3072 lds
    v_xor_b32 v13, 16384, v13
    buffer_load_dword v1, v0, s[44:47], s74 offen sc1
    s_waitcnt vmcnt(13)
    ds_read_b64_tr_b16 v[176:177], v11 offset:12288
    ds_read_b64_tr_b16 v[178:179], v11 offset:12800
    ds_read_b64_tr_b16 v[180:181], v11 offset:12296
    ds_read_b64_tr_b16 v[182:183], v11 offset:12808
    ds_read_b64_tr_b16 v[184:185], v12 offset:12288
    ds_read_b64_tr_b16 v[186:187], v12 offset:12800
    ds_read_b64_tr_b16 v[188:189], v12 offset:12296
    ds_read_b64_tr_b16 v[190:191], v12 offset:12808
    s_waitcnt lgkmcnt(0)
    s_add_u32 m0, s70, 12288
    s_nop 0
    buffer_load_dwordx4 v13, s[36:39], 0 offen offset:0 lds
    buffer_load_dwordx4 v13, s[36:39], s71 offen offset:1024 lds
    buffer_load_dwordx4 v13, s[36:39], s72 offen offset:2048 lds
    buffer_load_dwordx4 v13, s[36:39], s73 offen offset:3072 lds
    v_xor_b32 v13, 114688, v13
    s_waitcnt vmcnt(13)
    ds_read_b64_tr_b16 v[192:193], v11 offset:0
    ds_read_b64_tr_b16 v[194:195], v11 offset:512
    ds_read_b64_tr_b16 v[196:197], v11 offset:8
    ds_read_b64_tr_b16 v[198:199], v11 offset:520
    ds_read_b64_tr_b16 v[200:201], v12 offset:0
    ds_read_b64_tr_b16 v[202:203], v12 offset:512
    ds_read_b64_tr_b16 v[204:205], v12 offset:8
    ds_read_b64_tr_b16 v[206:207], v12 offset:520
    s_waitcnt vmcnt(9)
    ds_read_b64_tr_b16 v[208:209], v11 offset:4096
    ds_read_b64_tr_b16 v[210:211], v11 offset:4608
    ds_read_b64_tr_b16 v[212:213], v11 offset:4104
    ds_read_b64_tr_b16 v[214:215], v11 offset:4616
    ds_read_b64_tr_b16 v[216:217], v12 offset:4096
    ds_read_b64_tr_b16 v[218:219], v12 offset:4608
    ds_read_b64_tr_b16 v[220:221], v12 offset:4104
    ds_read_b64_tr_b16 v[222:223], v12 offset:4616
    s_waitcnt vmcnt(5)
    ds_read_b64_tr_b16 v[224:225], v11 offset:8192
    ds_read_b64_tr_b16 v[226:227], v11 offset:8704
    ds_read_b64_tr_b16 v[228:229], v11 offset:8200
    ds_read_b64_tr_b16 v[230:231], v11 offset:8712
    ds_read_b64_tr_b16 v[232:233], v12 offset:8192
    ds_read_b64_tr_b16 v[234:235], v12 offset:8704
    ds_read_b64_tr_b16 v[236:237], v12 offset:8200
    ds_read_b64_tr_b16 v[238:239], v12 offset:8712
    s_waitcnt vmcnt(4)
L_spin_38:
    ds_read_b128 v[16:19], v5
    s_waitcnt lgkmcnt(0)
    v_readfirstlane_b32 s101, v18
    v_readfirstlane_b32 s30, v19
    s_cmp_ge_u32 s101, 1
    s_cbranch_scc0 L_retry_39
L_mchk_37:
    v_cmp_ne_u32 vcc, s30, v1
    s_cbranch_vccnz L_mre_40
    buffer_load_dwordx4 v[40:43], v14, s[44:47], s75 offen offset:0 sc1
    buffer_load_dwordx4 v[44:47], v14, s[44:47], s75 offen offset:1024 sc1
    buffer_load_dwordx4 v[48:51], v14, s[44:47], s75 offen offset:2048 sc1
    buffer_load_dwordx4 v[52:55], v14, s[44:47], s75 offen offset:3072 sc1
    s_xor_b32 s75, s75, 4096
    buffer_load_dwordx4 v[56:59], v14, s[44:47], s75 offen offset:0 sc1
    buffer_load_dwordx4 v[60:63], v14, s[44:47], s75 offen offset:1024 sc1
    buffer_load_dwordx4 v[64:67], v14, s[44:47], s75 offen offset:2048 sc1
    buffer_load_dwordx4 v[68:71], v14, s[44:47], s75 offen offset:3072 sc1
    s_xor_b32 s75, s75, 12288
    buffer_load_dwordx4 v[72:75], v14, s[44:47], s75 offen offset:0 sc1
    buffer_load_dwordx4 v[76:79], v14, s[44:47], s75 offen offset:1024 sc1
    s_waitcnt vmcnt(10)
    ds_read_b64_tr_b16 v[240:241], v11 offset:12288
    ds_read_b64_tr_b16 v[242:243], v11 offset:12800
    ds_read_b64_tr_b16 v[244:245], v11 offset:12296
    ds_read_b64_tr_b16 v[246:247], v11 offset:12808
    ds_read_b64_tr_b16 v[248:249], v12 offset:12288
    ds_read_b64_tr_b16 v[250:251], v12 offset:12800
    ds_read_b64_tr_b16 v[252:253], v12 offset:12296
    ds_read_b64_tr_b16 v[254:255], v12 offset:12808
L_spin_41:
    ds_read_b32 v15, v5 offset:4
    s_waitcnt lgkmcnt(0)
    v_readfirstlane_b32 s101, v15
    s_cmp_ge_u32 s101, 4
    s_cbranch_scc0 L_retry_42
    ds_read_b128 v[16:19], v7 offset:1024
    ds_read_b128 v[20:23], v7 offset:9216
    ds_read_b128 v[24:27], v7 offset:17408
    v_xor_b32 v7, 0x100, v7
    ds_read_b128 v[28:31], v8 offset:1024
    ds_read_b128 v[32:35], v8 offset:9216
    ds_read_b128 v[36:39], v8 offset:17408
    v_xor_b32 v8, 0x100, v8
    s_waitcnt lgkmcnt(3)
    s_waitcnt vmcnt(9)
    v_mfma_f32_16x16x32_bf16 v[80:83], v[40:43], v[16:19], 0
    v_mfma_f32_16x16x32_bf16 v[96:99], v[40:43], v[20:23], 0
    v_mfma_f32_16x16x32_bf16 v[112:115], v[40:43], v[24:27], 0
    buffer_load_dwordx4 v[40:43], v14, s[44:47], s75 offen offset:2048 sc1
    s_waitcnt vmcnt(9)
    v_mfma_f32_16x16x32_bf16 v[84:87], v[44:47], v[16:19], 0
    v_mfma_f32_16x16x32_bf16 v[100:103], v[44:47], v[20:23], 0
    v_mfma_f32_16x16x32_bf16 v[116:119], v[44:47], v[24:27], 0
    buffer_load_dwordx4 v[44:47], v14, s[44:47], s75 offen offset:3072 sc1
    s_xor_b32 s75, s75, 4096
    s_waitcnt vmcnt(9)
    v_mfma_f32_16x16x32_bf16 v[88:91], v[48:51], v[16:19], 0
    v_mfma_f32_16x16x32_bf16 v[104:107], v[48:51], v[20:23], 0
    v_mfma_f32_16x16x32_bf16 v[120:123], v[48:51], v[24:27], 0
    buffer_load_dwordx4 v[48:51], v14, s[44:47], s75 offen offset:0 sc1
    s_waitcnt vmcnt(9)
    v_mfma_f32_16x16x32_bf16 v[92:95], v[52:55], v[16:19], 0
    v_mfma_f32_16x16x32_bf16 v[108:111], v[52:55], v[20:23], 0
    v_mfma_f32_16x16x32_bf16 v[124:127], v[52:55], v[24:27], 0
    buffer_load_dwordx4 v[52:55], v14, s[44:47], s75 offen offset:1024 sc1
    ds_read_b128 v[16:19], v9 offset:1024
    ds_read_b128 v[20:23], v9 offset:9216
    ds_read_b128 v[24:27], v9 offset:17408
    v_xor_b32 v9, 0x100, v9
    s_waitcnt lgkmcnt(3)
    s_waitcnt vmcnt(9)
    v_mfma_f32_16x16x32_bf16 v[80:83], v[56:59], v[28:31], v[80:83]
    v_mfma_f32_16x16x32_bf16 v[96:99], v[56:59], v[32:35], v[96:99]
    v_mfma_f32_16x16x32_bf16 v[112:115], v[56:59], v[36:39], v[112:115]
    buffer_load_dwordx4 v[56:59], v14, s[44:47], s75 offen offset:2048 sc1
    s_waitcnt vmcnt(9)
    v_mfma_f32_16x16x32_bf16 v[84:87], v[60:63], v[28:31], v[84:87]
    v_mfma_f32_16x16x32_bf16 v[100:103], v[60:63], v[32:35], v[100:103]
    v_mfma_f32_16x16x32_bf16 v[116:119], v[60:63], v[36:39], v[116:119]
    buffer_load_dwordx4 v[60:63], v14, s[44:47], s75 offen offset:3072 sc1
    s_xor_b32 s75, s75, 28672
    s_waitcnt vmcnt(9)
    v_mfma_f32_16x16x32_bf16 v[88:91], v[64:67], v[28:31], v[88:91]
    v_mfma_f32_16x16x32_bf16 v[104:107], v[64:67], v[32:35], v[104:107]
    v_mfma_f32_16x16x32_bf16 v[120:123], v[64:67], v[36:39], v[120:123]
    buffer_load_dwordx4 v[64:67], v14, s[44:47], s75 offen offset:0 sc1
    s_waitcnt vmcnt(9)
    v_mfma_f32_16x16x32_bf16 v[92:95], v[68:71], v[28:31], v[92:95]
    v_mfma_f32_16x16x32_bf16 v[108:111], v[68:71], v[32:35], v[108:111]
    v_mfma_f32_16x16x32_bf16 v[124:127], v[68:71], v[36:39], v[124:127]
    buffer_load_dwordx4 v[68:71], v14, s[44:47], s75 offen offset:1024 sc1
    ds_read_b128 v[28:31], v10 offset:1024
    ds_read_b128 v[32:35], v10 offset:9216
    ds_read_b128 v[36:39], v10 offset:17408
    v_xor_b32 v10, 0x100, v10
    s_waitcnt lgkmcnt(3)
    s_waitcnt vmcnt(9)
    v_mfma_f32_16x16x32_bf16 v[80:83], v[72:75], v[16:19], v[80:83]
    v_mfma_f32_16x16x32_bf16 v[96:99], v[72:75], v[20:23], v[96:99]
    v_mfma_f32_16x16x32_bf16 v[112:115], v[72:75], v[24:27], v[112:115]
    buffer_load_dwordx4 v[72:75], v14, s[44:47], s75 offen offset:2048 sc1
    s_waitcnt vmcnt(9)
    v_mfma_f32_16x16x32_bf16 v[84:87], v[76:79], v[16:19], v[84:87]
    v_mfma_f32_16x16x32_bf16 v[100:103], v[76:79], v[20:23], v[100:103]
    v_mfma_f32_16x16x32_bf16 v[116:119], v[76:79], v[24:27], v[116:119]
    buffer_load_dwordx4 v[76:79], v14, s[44:47], s75 offen offset:3072 sc1
    s_xor_b32 s75, s75, 4096
    s_waitcnt vmcnt(9)
    v_mfma_f32_16x16x32_bf16 v[88:91], v[40:43], v[16:19], v[88:91]
    v_mfma_f32_16x16x32_bf16 v[104:107], v[40:43], v[20:23], v[104:107]
    v_mfma_f32_16x16x32_bf16 v[120:123], v[40:43], v[24:27], v[120:123]
    buffer_load_dwordx4 v[40:43], v14, s[44:47], s75 offen offset:0 sc1
    s_waitcnt vmcnt(9)
    v_mfma_f32_16x16x32_bf16 v[92:95], v[44:47], v[16:19], v[92:95]
    v_mfma_f32_16x16x32_bf16 v[108:111], v[44:47], v[20:23], v[108:111]
    v_mfma_f32_16x16x32_bf16 v[124:127], v[44:47], v[24:27], v[124:127]
    buffer_load_dwordx4 v[44:47], v14, s[44:47], s75 offen offset:1024 sc1
    ds_read_b128 v[16:19], v7 offset:1024
    ds_read_b128 v[20:23], v7 offset:9216
    ds_read_b128 v[24:27], v7 offset:17408
    v_xor_b32 v7, 0x100, v7
    s_waitcnt lgkmcnt(3)
    s_waitcnt vmcnt(9)
    v_mfma_f32_16x16x32_bf16 v[80:83], v[48:51], v[28:31], v[80:83]
    v_mfma_f32_16x16x32_bf16 v[96:99], v[48:51], v[32:35], v[96:99]
    v_mfma_f32_16x16x32_bf16 v[112:115], v[48:51], v[36:39], v[112:115]
    buffer_load_dwordx4 v[48:51], v14, s[44:47], s75 offen offset:2048 sc1
    s_waitcnt vmcnt(9)
    v_mfma_f32_16x16x32_bf16 v[84:87], v[52:55], v[28:31], v[84:87]
    v_mfma_f32_16x16x32_bf16 v[100:103], v[52:55], v[32:35], v[100:103]
    v_mfma_f32_16x16x32_bf16 v[116:119], v[52:55], v[36:39], v[116:119]
    buffer_load_dwordx4 v[52:55], v14, s[44:47], s75 offen offset:3072 sc1
    s_xor_b32 s75, s75, 12288
    s_waitcnt vmcnt(9)
    v_mfma_f32_16x16x32_bf16 v[88:91], v[56:59], v[28:31], v[88:91]
    v_mfma_f32_16x16x32_bf16 v[104:107], v[56:59], v[32:35], v[104:107]
    v_mfma_f32_16x16x32_bf16 v[120:123], v[56:59], v[36:39], v[120:123]
    buffer_load_dwordx4 v[56:59], v14, s[44:47], s75 offen offset:0 sc1
    s_waitcnt vmcnt(9)
    v_mfma_f32_16x16x32_bf16 v[92:95], v[60:63], v[28:31], v[92:95]
    v_mfma_f32_16x16x32_bf16 v[108:111], v[60:63], v[32:35], v[108:111]
    v_mfma_f32_16x16x32_bf16 v[124:127], v[60:63], v[36:39], v[124:127]
    buffer_load_dwordx4 v[60:63], v14, s[44:47], s75 offen offset:1024 sc1
    ds_read_b128 v[28:31], v8 offset:1024
    ds_read_b128 v[32:35], v8 offset:9216
    ds_read_b128 v[36:39], v8 offset:17408
    v_xor_b32 v8, 0x100, v8
    s_waitcnt lgkmcnt(3)
    s_waitcnt vmcnt(9)
    v_mfma_f32_16x16x32_bf16 v[80:83], v[64:67], v[16:19], v[80:83]
    v_mfma_f32_16x16x32_bf16 v[96:99], v[64:67], v[20:23], v[96:99]
    v_mfma_f32_16x16x32_bf16 v[112:115], v[64:67], v[24:27], v[112:115]
    buffer_load_dwordx4 v[64:67], v14, s[44:47], s75 offen offset:2048 sc1
    s_waitcnt vmcnt(9)
    v_mfma_f32_16x16x32_bf16 v[84:87], v[68:71], v[16:19], v[84:87]
    v_mfma_f32_16x16x32_bf16 v[100:103], v[68:71], v[20:23], v[100:103]
    v_mfma_f32_16x16x32_bf16 v[116:119], v[68:71], v[24:27], v[116:119]
    buffer_load_dwordx4 v[68:71], v14, s[44:47], s75 offen offset:3072 sc1
    s_xor_b32 s75, s75, 4096
    s_waitcnt vmcnt(9)
    v_mfma_f32_16x16x32_bf16 v[88:91], v[72:75], v[16:19], v[88:91]
    v_mfma_f32_16x16x32_bf16 v[104:107], v[72:75], v[20:23], v[104:107]
    v_mfma_f32_16x16x32_bf16 v[120:123], v[72:75], v[24:27], v[120:123]
    buffer_load_dwordx4 v[72:75], v14, s[44:47], s75 offen offset:0 sc1
    s_waitcnt vmcnt(9)
    v_mfma_f32_16x16x32_bf16 v[92:95], v[76:79], v[16:19], v[92:95]
    v_mfma_f32_16x16x32_bf16 v[108:111], v[76:79], v[20:23], v[108:111]
    v_mfma_f32_16x16x32_bf16 v[124:127], v[76:79], v[24:27], v[124:127]
    buffer_load_dwordx4 v[76:79], v14, s[44:47], s75 offen offset:1024 sc1
    ds_read_b128 v[16:19], v9 offset:1024
    ds_read_b128 v[20:23], v9 offset:9216
    ds_read_b128 v[24:27], v9 offset:17408
    v_xor_b32 v9, 0x100, v9
    s_waitcnt lgkmcnt(3)
    s_waitcnt vmcnt(9)
    v_mfma_f32_16x16x32_bf16 v[80:83], v[40:43], v[28:31], v[80:83]
    v_mfma_f32_16x16x32_bf16 v[96:99], v[40:43], v[32:35], v[96:99]
    v_mfma_f32_16x16x32_bf16 v[112:115], v[40:43], v[36:39], v[112:115]
    buffer_load_dwordx4 v[40:43], v14, s[44:47], s75 offen offset:2048 sc1
    s_waitcnt vmcnt(9)
    v_mfma_f32_16x16x32_bf16 v[84:87], v[44:47], v[28:31], v[84:87]
    v_mfma_f32_16x16x32_bf16 v[100:103], v[44:47], v[32:35], v[100:103]
    v_mfma_f32_16x16x32_bf16 v[116:119], v[44:47], v[36:39], v[116:119]
    buffer_load_dwordx4 v[44:47], v14, s[44:47], s75 offen offset:3072 sc1
    s_xor_b32 s75, s75, 28672
    s_waitcnt vmcnt(9)
    v_mfma_f32_16x16x32_bf16 v[88:91], v[48:51], v[28:31], v[88:91]
    v_mfma_f32_16x16x32_bf16 v[104:107], v[48:51], v[32:35], v[104:107]
    v_mfma_f32_16x16x32_bf16 v[120:123], v[48:51], v[36:39], v[120:123]
    s_add_u32 m0, s70, 0
    s_nop 0
    buffer_load_dwordx4 v13, s[40:43], 0 offen offset:0 lds
    s_waitcnt vmcnt(9)
    v_mfma_f32_16x16x32_bf16 v[92:95], v[52:55], v[28:31], v[92:95]
    v_mfma_f32_16x16x32_bf16 v[108:111], v[52:55], v[32:35], v[108:111]
    v_mfma_f32_16x16x32_bf16 v[124:127], v[52:55], v[36:39], v[124:127]
    buffer_load_dwordx4 v13, s[40:43], s71 offen offset:1024 lds
    ds_read_b128 v[28:31], v10 offset:1024
    ds_read_b128 v[32:35], v10 offset:9216
    ds_read_b128 v[36:39], v10 offset:17408
    v_xor_b32 v10, 0x100, v10
    s_waitcnt lgkmcnt(3)
    s_waitcnt vmcnt(9)
    v_mfma_f32_16x16x32_bf16 v[80:83], v[56:59], v[16:19], v[80:83]
    v_mfma_f32_16x16x32_bf16 v[96:99], v[56:59], v[20:23], v[96:99]
    v_mfma_f32_16x16x32_bf16 v[112:115], v[56:59], v[24:27], v[112:115]
    buffer_load_dwordx4 v13, s[40:43], s72 offen offset:2048 lds
    s_waitcnt vmcnt(9)
    v_mfma_f32_16x16x32_bf16 v[84:87], v[60:63], v[16:19], v[84:87]
    v_mfma_f32_16x16x32_bf16 v[100:103], v[60:63], v[20:23], v[100:103]
    v_mfma_f32_16x16x32_bf16 v[116:119], v[60:63], v[24:27], v[116:119]
    buffer_load_dwordx4 v13, s[40:43], s73 offen offset:3072 lds
    v_xor_b32 v13, 16384, v13
    s_waitcnt vmcnt(9)
    v_mfma_f32_16x16x32_bf16 v[88:91], v[64:67], v[16:19], v[88:91]
    v_mfma_f32_16x16x32_bf16 v[104:107], v[64:67], v[20:23], v[104:107]
    v_mfma_f32_16x16x32_bf16 v[120:123], v[64:67], v[24:27], v[120:123]
    s_add_u32 m0, s70, 4096
    s_nop 0
    buffer_load_dwordx4 v13, s[40:43], 0 offen offset:0 lds
    s_waitcnt vmcnt(9)
    v_mfma_f32_16x16x32_bf16 v[92:95], v[68:71], v[16:19], v[92:95]
    v_mfma_f32_16x16x32_bf16 v[108:111], v[68:71], v[20:23], v[108:111]
    v_mfma_f32_16x16x32_bf16 v[124:127], v[68:71], v[24:27], v[124:127]
    buffer_load_dwordx4 v13, s[40:43], s71 offen offset:1024 lds
    s_waitcnt lgkmcnt(0)
    s_waitcnt vmcnt(9)
    v_mfma_f32_16x16x32_bf16 v[80:83], v[72:75], v[28:31], v[80:83]
    v_mfma_f32_16x16x32_bf16 v[96:99], v[72:75], v[32:35], v[96:99]
    v_mfma_f32_16x16x32_bf16 v[112:115], v[72:75], v[36:39], v[112:115]
    buffer_load_dwordx4 v13, s[40:43], s72 offen offset:2048 lds
    s_waitcnt vmcnt(9)
    v_mfma_f32_16x16x32_bf16 v[84:87], v[76:79], v[28:31], v[84:87]
    v_mfma_f32_16x16x32_bf16 v[100:103], v[76:79], v[32:35], v[100:103]
    v_mfma_f32_16x16x32_bf16 v[116:119], v[76:79], v[36:39], v[116:119]
    buffer_load_dwordx4 v13, s[40:43], s73 offen offset:3072 lds
    v_xor_b32 v13, 49152, v13
    s_waitcnt vmcnt(9)
    v_mfma_f32_16x16x32_bf16 v[88:91], v[40:43], v[28:31], v[88:91]
    v_mfma_f32_16x16x32_bf16 v[104:107], v[40:43], v[32:35], v[104:107]
    v_mfma_f32_16x16x32_bf16 v[120:123], v[40:43], v[36:39], v[120:123]
    s_add_u32 m0, s70, 8192
    s_nop 0
    buffer_load_dwordx4 v13, s[40:43], 0 offen offset:0 lds
    s_waitcnt vmcnt(9)
    v_mfma_f32_16x16x32_bf16 v[92:95], v[44:47], v[28:31], v[92:95]
    v_mfma_f32_16x16x32_bf16 v[108:111], v[44:47], v[32:35], v[108:111]
    v_mfma_f32_16x16x32_bf16 v[124:127], v[44:47], v[36:39], v[124:127]
    buffer_load_dwordx4 v13, s[40:43], s71 offen offset:1024 lds
    s_lshl_b32 s64, s31, 3
    v_add_u32 v0, s64, v4
    v_xor_b32 v0, v0, v3
    v_lshlrev_b32 v0, 4, v0
    v_lshl_add_u32 v0, v3, 9, v0
    v_xor_b32 v1, 64, v0
    s_mov_b32 s76, 0x00ff00ff
    s_mov_b32 s77, 0x00ff00ff
    v_cvt_pk_bf16_f32 v16, v80, v81
    v_cvt_pk_bf16_f32 v17, v82, v83
    v_cvt_pk_bf16_f32 v18, v84, v85
    v_cvt_pk_bf16_f32 v19, v86, v87
    ds_write_b128 v0, v[16:19] offset:21504
    v_cvt_pk_bf16_f32 v20, v88, v89
    v_cvt_pk_bf16_f32 v21, v90, v91
    v_cvt_pk_bf16_f32 v22, v92, v93
    v_cvt_pk_bf16_f32 v23, v94, v95
    ds_write_b128 v1, v[20:23] offset:21504
    v_cvt_pk_bf16_f32 v24, v96, v97
    v_cvt_pk_bf16_f32 v25, v98, v99
    v_cvt_pk_bf16_f32 v26, v100, v101
    v_cvt_pk_bf16_f32 v27, v102, v103
    ds_write_b128 v0, v[24:27] offset:29696
    v_cvt_pk_bf16_f32 v28, v104, v105
    v_cvt_pk_bf16_f32 v29, v106, v107
    v_cvt_pk_bf16_f32 v30, v108, v109
    v_cvt_pk_bf16_f32 v31, v110, v111
    ds_write_b128 v1, v[28:31] offset:29696
    s_mov_b64 exec, s[76:77]
    v_cvt_pk_bf16_f32 v32, v112, v113
    v_cvt_pk_bf16_f32 v33, v114, v115
    v_cvt_pk_bf16_f32 v34, v116, v117
    v_cvt_pk_bf16_f32 v35, v118, v119
    ds_write_b128 v0, v[32:35] offset:37888
    v_cvt_pk_bf16_f32 v36, v120, v121
    v_cvt_pk_bf16_f32 v37, v122, v123
    v_cvt_pk_bf16_f32 v38, v124, v125
    v_cvt_pk_bf16_f32 v39, v126, v127
    ds_write_b128 v1, v[36:39] offset:37888
    s_mov_b64 exec, -1
    s_waitcnt lgkmcnt(0)
    s_barrier
    buffer_load_dwordx4 v13, s[40:43], s72 offen offset:2048 lds
    buffer_load_dwordx4 v13, s[40:43], s73 offen offset:3072 lds
    v_xor_b32 v13, 16384, v13
    s_add_u32 m0, s70, 12288
    s_nop 0
    buffer_load_dwordx4 v13, s[40:43], 0 offen offset:0 lds
    buffer_load_dwordx4 v13, s[40:43], s71 offen offset:1024 lds
    buffer_load_dwordx4 v13, s[40:43], s72 offen offset:2048 lds
    buffer_load_dwordx4 v13, s[40:43], s73 offen offset:3072 lds
    v_xor_b32 v13, 114688, v13
    v_lshlrev_b32 v0, 4, v4
    v_and_b32 v1, 7, v3
    v_lshl_add_u32 v0, v1, 9, v0
    v_and_b32 v1, 8, v3
    v_lshl_add_u32 v0, v1, 3, v0
    s_mul_i32 s74, s1, 20480
    s_lshl_b32 s64, s31, 7
    s_add_u32 s74, s74, s64
    s_waitcnt vmcnt(8)
    ds_read_b64_tr_b16 v[48:49], v11 offset:0
    ds_read_b64_tr_b16 v[50:51], v11 offset:512
    ds_read_b64_tr_b16 v[52:53], v11 offset:8
    ds_read_b64_tr_b16 v[54:55], v11 offset:520
    ds_read_b64_tr_b16 v[56:57], v12 offset:0
    ds_read_b64_tr_b16 v[58:59], v12 offset:512
    ds_read_b64_tr_b16 v[60:61], v12 offset:8
    ds_read_b64_tr_b16 v[62:63], v12 offset:520
    ds_read_b64_tr_b16 v[64:65], v11 offset:4096
    ds_read_b64_tr_b16 v[66:67], v11 offset:4608
    ds_read_b64_tr_b16 v[68:69], v11 offset:4104
    ds_read_b64_tr_b16 v[70:71], v11 offset:4616
    ds_read_b64_tr_b16 v[72:73], v12 offset:4096
    ds_read_b64_tr_b16 v[74:75], v12 offset:4608
    ds_read_b64_tr_b16 v[76:77], v12 offset:4104
    ds_read_b64_tr_b16 v[78:79], v12 offset:4616
    s_waitcnt lgkmcnt(8)
    s_add_u32 m0, s70, 0
    s_nop 0
    buffer_load_dwordx4 v13, s[40:43], 0 offen offset:0 lds
    buffer_load_dwordx4 v13, s[40:43], s71 offen offset:1024 lds
    buffer_load_dwordx4 v13, s[40:43], s72 offen offset:2048 lds
    buffer_load_dwordx4 v13, s[40:43], s73 offen offset:3072 lds
    v_xor_b32 v13, 16384, v13
    s_waitcnt lgkmcnt(0)
    s_add_u32 m0, s70, 4096
    s_nop 0
    buffer_load_dwordx4 v13, s[40:43], 0 offen offset:0 lds
    buffer_load_dwordx4 v13, s[40:43], s71 offen offset:1024 lds
    buffer_load_dwordx4 v13, s[40:43], s72 offen offset:2048 lds
    buffer_load_dwordx4 v13, s[40:43], s73 offen offset:3072 lds
    v_xor_b32 v13, 49152, v13
    s_lshl_b32 s64, s31, 12
    s_add_u32 s78, s64, 21504
    s_add_u32 s79, s64, 148480
    s_cmp_eq_u32 s31, 3
    s_cselect_b32 s79, 37888, s79
    s_sub_u32 s76, s78, s70
    s_sub_u32 s77, s79, s78
    v_xor_b32 v40, 0x100, v7
    v_xor_b32 v41, 0x100, v8
    v_xor_b32 v42, 0x100, v9
    v_xor_b32 v43, 0x100, v10
    s_barrier
    s_mov_b32 m0, s78
    s_nop 0
    buffer_load_dwordx4 v13, s[40:43], 0 offen offset:0 lds
    buffer_load_dwordx4 v13, s[40:43], s71 offen offset:1024 lds
    buffer_load_dwordx4 v13, s[40:43], s72 offen offset:2048 lds
    buffer_load_dwordx4 v13, s[40:43], s73 offen offset:3072 lds
    v_xor_b32 v13, 16384, v13
    s_mov_b32 m0, s79
    s_nop 0
    buffer_load_dwordx4 v13, s[40:43], 0 offen offset:0 lds
    buffer_load_dwordx4 v13, s[40:43], s71 offen offset:1024 lds
    buffer_load_dwordx4 v13, s[40:43], s72 offen offset:2048 lds
    buffer_load_dwordx4 v13, s[40:43], s73 offen offset:3072 lds
    v_xor_b32 v13, 114688, v13
    s_setprio 0
L_prog_43:
    ds_read_b128 v[16:19], v5 offset:32
    s_waitcnt lgkmcnt(0)
    v_min3_u32 v16, v16, v17, v18
    v_min_u32 v16, v16, v19
    v_cmp_gt_u32 vcc, 1, v16
    s_cbranch_vccnz L_retry_44
    ds_read_b128 v[16:19], v7 offset:1024
    ds_read_b128 v[20:23], v7 offset:9216
    ds_read_b128 v[24:27], v7 offset:17408
    s_waitcnt vmcnt(8)
    s_waitcnt lgkmcnt(0)
    v_mfma_f32_16x16x32_bf16 v[80:83], v[128:131], v[16:19], 0
    ds_read_b128 v[28:31], v8 offset:1024
    v_mfma_f32_16x16x32_bf16 v[96:99], v[128:131], v[20:23], 0
    ds_read_b128 v[32:35], v8 offset:9216
    v_mfma_f32_16x16x32_bf16 v[112:115], v[128:131], v[24:27], 0
    ds_read_b128 v[36:39], v8 offset:17408
    v_mfma_f32_16x16x32_bf16 v[84:87], v[132:135], v[16:19], 0
    v_mfma_f32_16x16x32_bf16 v[100:103], v[132:135], v[20:23], 0
    v_mfma_f32_16x16x32_bf16 v[116:119], v[132:135], v[24:27], 0
    v_mfma_f32_16x16x32_bf16 v[88:91], v[136:139], v[16:19], 0
    v_mfma_f32_16x16x32_bf16 v[104:107], v[136:139], v[20:23], 0
    v_mfma_f32_16x16x32_bf16 v[120:123], v[136:139], v[24:27], 0
    v_mfma_f32_16x16x32_bf16 v[92:95], v[140:143], v[16:19], 0
    v_mfma_f32_16x16x32_bf16 v[108:111], v[140:143], v[20:23], 0
    v_mfma_f32_16x16x32_bf16 v[124:127], v[140:143], v[24:27], 0
    s_waitcnt lgkmcnt(0)
    v_mfma_f32_16x16x32_bf16 v[80:83], v[144:147], v[28:31], v[80:83]
    ds_read_b128 v[16:19], v9 offset:1024
    v_mfma_f32_16x16x32_bf16 v[96:99], v[144:147], v[32:35], v[96:99]
    ds_read_b128 v[20:23], v9 offset:9216
    v_mfma_f32_16x16x32_bf16 v[112:115], v[144:147], v[36:39], v[112:115]
    ds_read_b128 v[24:27], v9 offset:17408
    v_mfma_f32_16x16x32_bf16 v[84:87], v[148:151], v[28:31], v[84:87]
    ds_read_b64_tr_b16 v[128:129], v11 offset:8192
    v_mfma_f32_16x16x32_bf16 v[100:103], v[148:151], v[32:35], v[100:103]
    ds_read_b64_tr_b16 v[130:131], v11 offset:8704
    v_mfma_f32_16x16x32_bf16 v[116:119], v[148:151], v[36:39], v[116:119]
    ds_read_b64_tr_b16 v[132:133], v11 offset:8200
    v_mfma_f32_16x16x32_bf16 v[88:91], v[152:155], v[28:31], v[88:91]
    ds_read_b64_tr_b16 v[134:135], v11 offset:8712
    v_mfma_f32_16x16x32_bf16 v[104:107], v[152:155], v[32:35], v[104:107]
    ds_read_b64_tr_b16 v[136:137], v12 offset:8192
    v_mfma_f32_16x16x32_bf16 v[120:123], v[152:155], v[36:39], v[120:123]
    ds_read_b64_tr_b16 v[138:139], v12 offset:8704
    v_mfma_f32_16x16x32_bf16 v[92:95], v[156:159], v[28:31], v[92:95]
    ds_read_b64_tr_b16 v[140:141], v12 offset:8200
    v_mfma_f32_16x16x32_bf16 v[108:111], v[156:159], v[32:35], v[108:111]
    ds_read_b64_tr_b16 v[142:143], v12 offset:8712
    v_mfma_f32_16x16x32_bf16 v[124:127], v[156:159], v[36:39], v[124:127]
    s_waitcnt lgkmcnt(8)
    v_mfma_f32_16x16x32_bf16 v[80:83], v[160:163], v[16:19], v[80:83]
    ds_read_b128 v[28:31], v10 offset:1024
    v_mfma_f32_16x16x32_bf16 v[96:99], v[160:163], v[20:23], v[96:99]
    ds_read_b128 v[32:35], v10 offset:9216
    v_mfma_f32_16x16x32_bf16 v[112:115], v[160:163], v[24:27], v[112:115]
    ds_read_b128 v[36:39], v10 offset:17408
    v_mfma_f32_16x16x32_bf16 v[84:87], v[164:167], v[16:19], v[84:87]
    ds_read_b64_tr_b16 v[144:145], v11 offset:12288
    v_mfma_f32_16x16x32_bf16 v[100:103], v[164:167], v[20:23], v[100:103]
    ds_read_b64_tr_b16 v[146:147], v11 offset:12800
    v_mfma_f32_16x16x32_bf16 v[116:119], v[164:167], v[24:27], v[116:119]
    ds_read_b64_tr_b16 v[148:149], v11 offset:12296
    v_mfma_f32_16x16x32_bf16 v[88:91], v[168:171], v[16:19], v[88:91]
    ds_read_b64_tr_b16 v[150:151], v11 offset:12808
    v_mfma_f32_16x16x32_bf16 v[104:107], v[168:171], v[20:23], v[104:107]
    ds_read_b64_tr_b16 v[152:153], v12 offset:12288
    v_mfma_f32_16x16x32_bf16 v[120:123], v[168:171], v[24:27], v[120:123]
    ds_read_b64_tr_b16 v[154:155], v12 offset:12800
    v_mfma_f32_16x16x32_bf16 v[92:95], v[172:175], v[16:19], v[92:95]
    ds_read_b64_tr_b16 v[156:157], v12 offset:12296
    v_mfma_f32_16x16x32_bf16 v[108:111], v[172:175], v[20:23], v[108:111]
    ds_read_b64_tr_b16 v[158:159], v12 offset:12808
    v_mfma_f32_16x16x32_bf16 v[124:127], v[172:175], v[24:27], v[124:127]
    s_waitcnt lgkmcnt(8)
    v_mfma_f32_16x16x32_bf16 v[80:83], v[176:179], v[28:31], v[80:83]
    ds_read_b128 v[16:19], v40 offset:1024
    v_mfma_f32_16x16x32_bf16 v[96:99], v[176:179], v[32:35], v[96:99]
    ds_read_b128 v[20:23], v40 offset:9216
    v_mfma_f32_16x16x32_bf16 v[112:115], v[176:179], v[36:39], v[112:115]
    ds_read_b128 v[24:27], v40 offset:17408
    v_mfma_f32_16x16x32_bf16 v[84:87], v[180:183], v[28:31], v[84:87]
    ds_read_b64_tr_b16 v[160:161], v11 offset:0
    v_mfma_f32_16x16x32_bf16 v[100:103], v[180:183], v[32:35], v[100:103]
    ds_read_b64_tr_b16 v[162:163], v11 offset:512
    v_mfma_f32_16x16x32_bf16 v[116:119], v[180:183], v[36:39], v[116:119]
    ds_read_b64_tr_b16 v[164:165], v11 offset:8
    v_mfma_f32_16x16x32_bf16 v[88:91], v[184:187], v[28:31], v[88:91]
    ds_read_b64_tr_b16 v[166:167], v11 offset:520
    v_mfma_f32_16x16x32_bf16 v[104:107], v[184:187], v[32:35], v[104:107]
    ds_read_b64_tr_b16 v[168:169], v12 offset:0
    v_mfma_f32_16x16x32_bf16 v[120:123], v[184:187], v[36:39], v[120:123]
    ds_read_b64_tr_b16 v[170:171], v12 offset:512
    v_mfma_f32_16x16x32_bf16 v[92:95], v[188:191], v[28:31], v[92:95]
    ds_read_b64_tr_b16 v[172:173], v12 offset:8
    v_mfma_f32_16x16x32_bf16 v[108:111], v[188:191], v[32:35], v[108:111]
    ds_read_b64_tr_b16 v[174:175], v12 offset:520
    v_mfma_f32_16x16x32_bf16 v[124:127], v[188:191], v[36:39], v[124:127]
    s_waitcnt lgkmcnt(8)
    v_mfma_f32_16x16x32_bf16 v[80:83], v[192:195], v[16:19], v[80:83]
    ds_read_b128 v[28:31], v41 offset:1024
    v_mfma_f32_16x16x32_bf16 v[96:99], v[192:195], v[20:23], v[96:99]
    ds_read_b128 v[32:35], v41 offset:9216
    v_mfma_f32_16x16x32_bf16 v[112:115], v[192:195], v[24:27], v[112:115]
    ds_read_b128 v[36:39], v41 offset:17408
    v_mfma_f32_16x16x32_bf16 v[84:87], v[196:199], v[16:19], v[84:87]
    ds_read_b64_tr_b16 v[176:177], v11 offset:4096
    v_mfma_f32_16x16x32_bf16 v[100:103], v[196:199], v[20:23], v[100:103]
    ds_read_b64_tr_b16 v[178:179], v11 offset:4608
    v_mfma_f32_16x16x32_bf16 v[116:119], v[196:199], v[24:27], v[116:119]
    ds_read_b64_tr_b16 v[180:181], v11 offset:4104
    v_mfma_f32_16x16x32_bf16 v[88:91], v[200:203], v[16:19], v[88:91]
    ds_read_b64_tr_b16 v[182:183], v11 offset:4616
    v_mfma_f32_16x16x32_bf16 v[104:107], v[200:203], v[20:23], v[104:107]
    ds_read_b64_tr_b16 v[184:185], v12 offset:4096
    v_mfma_f32_16x16x32_bf16 v[120:123], v[200:203], v[24:27], v[120:123]
    ds_read_b64_tr_b16 v[186:187], v12 offset:4608
    v_mfma_f32_16x16x32_bf16 v[92:95], v[204:207], v[16:19], v[92:95]
    ds_read_b64_tr_b16 v[188:189], v12 offset:4104
    v_mfma_f32_16x16x32_bf16 v[108:111], v[204:207], v[20:23], v[108:111]
    ds_read_b64_tr_b16 v[190:191], v12 offset:4616
    v_mfma_f32_16x16x32_bf16 v[124:127], v[204:207], v[24:27], v[124:127]
    s_waitcnt lgkmcnt(8)
    v_mfma_f32_16x16x32_bf16 v[80:83], v[208:211], v[28:31], v[80:83]
    ds_read_b128 v[16:19], v42 offset:1024
    v_mfma_f32_16x16x32_bf16 v[96:99], v[208:211], v[32:35], v[96:99]
    ds_read_b128 v[20:23], v42 offset:9216
    v_mfma_f32_16x16x32_bf16 v[112:115], v[208:211], v[36:39], v[112:115]
    ds_read_b128 v[24:27], v42 offset:17408
    v_mfma_f32_16x16x32_bf16 v[84:87], v[212:215], v[28:31], v[84:87]
    v_mfma_f32_16x16x32_bf16 v[100:103], v[212:215], v[32:35], v[100:103]
    v_mfma_f32_16x16x32_bf16 v[116:119], v[212:215], v[36:39], v[116:119]
    v_mfma_f32_16x16x32_bf16 v[88:91], v[216:219], v[28:31], v[88:91]
    v_mfma_f32_16x16x32_bf16 v[104:107], v[216:219], v[32:35], v[104:107]
    v_mfma_f32_16x16x32_bf16 v[120:123], v[216:219], v[36:39], v[120:123]
    v_mfma_f32_16x16x32_bf16 v[92:95], v[220:223], v[28:31], v[92:95]
    v_mfma_f32_16x16x32_bf16 v[108:111], v[220:223], v[32:35], v[108:111]
    v_mfma_f32_16x16x32_bf16 v[124:127], v[220:223], v[36:39], v[124:127]
    s_waitcnt lgkmcnt(0)
    v_mfma_f32_16x16x32_bf16 v[80:83], v[224:227], v[16:19], v[80:83]
    v_add_u32 v11, s76, v11
    v_add_u32 v12, s76, v12
    v_mfma_f32_16x16x32_bf16 v[96:99], v[224:227], v[20:23], v[96:99]
    ds_read_b128 v[28:31], v43 offset:1024
    v_mfma_f32_16x16x32_bf16 v[112:115], v[224:227], v[24:27], v[112:115]
    ds_read_b128 v[32:35], v43 offset:9216
    v_mfma_f32_16x16x32_bf16 v[84:87], v[228:231], v[16:19], v[84:87]
    ds_read_b128 v[36:39], v43 offset:17408
    v_mfma_f32_16x16x32_bf16 v[100:103], v[228:231], v[20:23], v[100:103]
    s_waitcnt vmcnt(4)
    ds_read_b64_tr_b16 v[192:193], v11 offset:0
    v_mfma_f32_16x16x32_bf16 v[116:119], v[228:231], v[24:27], v[116:119]
    ds_read_b64_tr_b16 v[194:195], v11 offset:512
    v_mfma_f32_16x16x32_bf16 v[88:91], v[232:235], v[16:19], v[88:91]
    ds_read_b64_tr_b16 v[196:197], v11 offset:8
    v_mfma_f32_16x16x32_bf16 v[104:107], v[232:235], v[20:23], v[104:107]
    ds_read_b64_tr_b16 v[198:199], v11 offset:520
    v_mfma_f32_16x16x32_bf16 v[120:123], v[232:235], v[24:27], v[120:123]
    ds_read_b64_tr_b16 v[200:201], v12 offset:0
    v_mfma_f32_16x16x32_bf16 v[92:95], v[236:239], v[16:19], v[92:95]
    ds_read_b64_tr_b16 v[202:203], v12 offset:512
    v_mfma_f32_16x16x32_bf16 v[108:111], v[236:239], v[20:23], v[108:111]
    ds_read_b64_tr_b16 v[204:205], v12 offset:8
    v_mfma_f32_16x16x32_bf16 v[124:127], v[236:239], v[24:27], v[124:127]
    ds_read_b64_tr_b16 v[206:207], v12 offset:520
    s_waitcnt lgkmcnt(8)
    v_mfma_f32_16x16x32_bf16 v[80:83], v[240:243], v[28:31], v[80:83]
    v_add_u32 v11, s77, v11
    v_add_u32 v12, s77, v12
    v_mfma_f32_16x16x32_bf16 v[96:99], v[240:243], v[32:35], v[96:99]
    s_waitcnt vmcnt(0)
    ds_read_b64_tr_b16 v[208:209], v11 offset:0
    v_mfma_f32_16x16x32_bf16 v[112:115], v[240:243], v[36:39], v[112:115]
    ds_read_b64_tr_b16 v[210:211], v11 offset:512
    v_mfma_f32_16x16x32_bf16 v[84:87], v[244:247], v[28:31], v[84:87]
    ds_read_b64_tr_b16 v[212:213], v11 offset:8
    v_mfma_f32_16x16x32_bf16 v[100:103], v[244:247], v[32:35], v[100:103]
    ds_read_b64_tr_b16 v[214:215], v11 offset:520
    v_mfma_f32_16x16x32_bf16 v[116:119], v[244:247], v[36:39], v[116:119]
    ds_read_b64_tr_b16 v[216:217], v12 offset:0
    v_mfma_f32_16x16x32_bf16 v[88:91], v[248:251], v[28:31], v[88:91]
    ds_read_b64_tr_b16 v[218:219], v12 offset:512
    v_mfma_f32_16x16x32_bf16 v[104:107], v[248:251], v[32:35], v[104:107]
    ds_read_b64_tr_b16 v[220:221], v12 offset:8
    v_mfma_f32_16x16x32_bf16 v[120:123], v[248:251], v[36:39], v[120:123]
    ds_read_b64_tr_b16 v[222:223], v12 offset:520
    v_mfma_f32_16x16x32_bf16 v[92:95], v[252:255], v[28:31], v[92:95]
    v_mfma_f32_16x16x32_bf16 v[108:111], v[252:255], v[32:35], v[108:111]
    v_mfma_f32_16x16x32_bf16 v[124:127], v[252:255], v[36:39], v[124:127]
    s_add_u32 s75, s74, 4096
    s_add_u32 s76, s74, 8192
    s_add_u32 s77, s74, 12288
    s_add_u32 s78, s74, 16384
L_prog_45:
    ds_read_b128 v[16:19], v5 offset:32
    s_waitcnt lgkmcnt(0)
    v_min3_u32 v16, v16, v17, v18
    v_min_u32 v16, v16, v19
    v_cmp_gt_u32 vcc, 1, v16
    s_cbranch_vccnz L_retry_46
    ds_read_b128 v[16:19], v7 offset:58368
    ds_read_b128 v[20:23], v8 offset:58368
    ds_read_b128 v[24:27], v9 offset:58368
    ds_read_b128 v[28:31], v10 offset:58368
    ds_read_b128 v[32:35], v40 offset:58368
    ds_read_b128 v[36:39], v41 offset:58368
    ds_read_b128 v[44:47], v42 offset:58368
    ds_read_b128 v[252:255], v43 offset:58368
    s_waitcnt lgkmcnt(7)
    v_mfma_f32_16x16x32_bf16 v[120:123], v[56:59], v[16:19], v[120:123]
    v_mfma_f32_16x16x32_bf16 v[124:127], v[60:63], v[16:19], v[124:127]
    v_mfma_f32_16x16x32_bf16 v[112:115], v[48:51], v[16:19], v[112:115]
    v_mfma_f32_16x16x32_bf16 v[116:119], v[52:55], v[16:19], v[116:119]
    s_waitcnt lgkmcnt(6)
    v_mfma_f32_16x16x32_bf16 v[120:123], v[72:75], v[20:23], v[120:123]
    v_mfma_f32_16x16x32_bf16 v[124:127], v[76:79], v[20:23], v[124:127]
    v_mfma_f32_16x16x32_bf16 v[112:115], v[64:67], v[20:23], v[112:115]
    v_mfma_f32_16x16x32_bf16 v[116:119], v[68:71], v[20:23], v[116:119]
    s_waitcnt lgkmcnt(5)
    v_mfma_f32_16x16x32_bf16 v[120:123], v[136:139], v[24:27], v[120:123]
    v_mfma_f32_16x16x32_bf16 v[124:127], v[140:143], v[24:27], v[124:127]
    v_mfma_f32_16x16x32_bf16 v[112:115], v[128:131], v[24:27], v[112:115]
    v_mfma_f32_16x16x32_bf16 v[116:119], v[132:135], v[24:27], v[116:119]
    s_waitcnt lgkmcnt(4)
    v_mfma_f32_16x16x32_bf16 v[120:123], v[152:155], v[28:31], v[120:123]
    v_mfma_f32_16x16x32_bf16 v[124:127], v[156:159], v[28:31], v[124:127]
    v_mfma_f32_16x16x32_bf16 v[112:115], v[144:147], v[28:31], v[112:115]
    v_mfma_f32_16x16x32_bf16 v[116:119], v[148:151], v[28:31], v[116:119]
    s_waitcnt lgkmcnt(3)
    v_mfma_f32_16x16x32_bf16 v[120:123], v[168:171], v[32:35], v[120:123]
    v_mfma_f32_16x16x32_bf16 v[124:127], v[172:175], v[32:35], v[124:127]
    v_mfma_f32_16x16x32_bf16 v[112:115], v[160:163], v[32:35], v[112:115]
    v_mfma_f32_16x16x32_bf16 v[116:119], v[164:167], v[32:35], v[116:119]
    s_waitcnt lgkmcnt(2)
    v_mfma_f32_16x16x32_bf16 v[120:123], v[184:187], v[36:39], v[120:123]
    v_mfma_f32_16x16x32_bf16 v[124:127], v[188:191], v[36:39], v[124:127]
    v_mfma_f32_16x16x32_bf16 v[112:115], v[176:179], v[36:39], v[112:115]
    v_mfma_f32_16x16x32_bf16 v[116:119], v[180:183], v[36:39], v[116:119]
    s_waitcnt lgkmcnt(1)
    v_mfma_f32_16x16x32_bf16 v[120:123], v[200:203], v[44:47], v[120:123]
    v_mfma_f32_16x16x32_bf16 v[124:127], v[204:207], v[44:47], v[124:127]
    v_mfma_f32_16x16x32_bf16 v[112:115], v[192:195], v[44:47], v[112:115]
    v_mfma_f32_16x16x32_bf16 v[116:119], v[196:199], v[44:47], v[116:119]
    s_waitcnt lgkmcnt(0)
    v_mfma_f32_16x16x32_bf16 v[120:123], v[216:219], v[252:255], v[120:123]
    v_mfma_f32_16x16x32_bf16 v[124:127], v[220:223], v[252:255], v[124:127]
    v_mfma_f32_16x16x32_bf16 v[112:115], v[208:211], v[252:255], v[112:115]
    v_mfma_f32_16x16x32_bf16 v[116:119], v[212:215], v[252:255], v[116:119]
L_prog_47:
    ds_read_b128 v[16:19], v5 offset:32
    s_waitcnt lgkmcnt(0)
    v_min3_u32 v16, v16, v17, v18
    v_min_u32 v16, v16, v19
    v_cmp_gt_u32 vcc, 3, v16
    s_cbranch_vccnz L_retry_48
    ds_read_b128 v[16:19], v7 offset:41984
    ds_read_b128 v[20:23], v8 offset:41984
    ds_read_b128 v[24:27], v9 offset:41984
    ds_read_b128 v[28:31], v10 offset:41984
    ds_read_b128 v[32:35], v40 offset:41984
    ds_read_b128 v[36:39], v41 offset:41984
    ds_read_b128 v[44:47], v42 offset:41984
    ds_read_b128 v[252:255], v43 offset:41984
    s_waitcnt lgkmcnt(7)
    v_mfma_f32_16x16x32_bf16 v[88:91], v[56:59], v[16:19], v[88:91]
    v_cvt_pk_bf16_f32 v248, v120, v121
    v_mfma_f32_16x16x32_bf16 v[92:95], v[60:63], v[16:19], v[92:95]
    v_cvt_pk_bf16_f32 v249, v122, v123
    v_mfma_f32_16x16x32_bf16 v[80:83], v[48:51], v[16:19], v[80:83]
    v_cvt_pk_bf16_f32 v250, v124, v125
    v_mfma_f32_16x16x32_bf16 v[84:87], v[52:55], v[16:19], v[84:87]
    v_cvt_pk_bf16_f32 v251, v126, v127
    s_waitcnt lgkmcnt(6)
    v_mfma_f32_16x16x32_bf16 v[88:91], v[72:75], v[20:23], v[88:91]
    v_cvt_pk_bf16_f32 v244, v112, v113
    v_mfma_f32_16x16x32_bf16 v[92:95], v[76:79], v[20:23], v[92:95]
    v_cvt_pk_bf16_f32 v245, v114, v115
    v_mfma_f32_16x16x32_bf16 v[80:83], v[64:67], v[20:23], v[80:83]
    v_cvt_pk_bf16_f32 v246, v116, v117
    v_mfma_f32_16x16x32_bf16 v[84:87], v[68:71], v[20:23], v[84:87]
    v_cvt_pk_bf16_f32 v247, v118, v119
    s_waitcnt lgkmcnt(5)
    v_mfma_f32_16x16x32_bf16 v[88:91], v[136:139], v[24:27], v[88:91]
    v_mov_b32_dpp v244, v248 row_ror:8 row_mask:0xf bank_mask:0xc
    v_mfma_f32_16x16x32_bf16 v[92:95], v[140:143], v[24:27], v[92:95]
    v_mov_b32_dpp v245, v249 row_ror:8 row_mask:0xf bank_mask:0xc
    v_mfma_f32_16x16x32_bf16 v[80:83], v[128:131], v[24:27], v[80:83]
    v_mov_b32_dpp v246, v250 row_ror:8 row_mask:0xf bank_mask:0xc
    v_mfma_f32_16x16x32_bf16 v[84:87], v[132:135], v[24:27], v[84:87]
    v_mov_b32_dpp v247, v251 row_ror:8 row_mask:0xf bank_mask:0xc
    s_waitcnt lgkmcnt(4)
    v_mfma_f32_16x16x32_bf16 v[88:91], v[152:155], v[28:31], v[88:91]
    v_mfma_f32_16x16x32_bf16 v[92:95], v[156:159], v[28:31], v[92:95]
    v_mfma_f32_16x16x32_bf16 v[80:83], v[144:147], v[28:31], v[80:83]
    v_mfma_f32_16x16x32_bf16 v[84:87], v[148:151], v[28:31], v[84:87]
    s_waitcnt lgkmcnt(3)
    v_mfma_f32_16x16x32_bf16 v[88:91], v[168:171], v[32:35], v[88:91]
    v_mfma_f32_16x16x32_bf16 v[92:95], v[172:175], v[32:35], v[92:95]
    v_mfma_f32_16x16x32_bf16 v[80:83], v[160:163], v[32:35], v[80:83]
    v_mfma_f32_16x16x32_bf16 v[84:87], v[164:167], v[32:35], v[84:87]
    s_waitcnt lgkmcnt(2)
    v_mfma_f32_16x16x32_bf16 v[88:91], v[184:187], v[36:39], v[88:91]
    v_mfma_f32_16x16x32_bf16 v[92:95], v[188:191], v[36:39], v[92:95]
    v_mfma_f32_16x16x32_bf16 v[80:83], v[176:179], v[36:39], v[80:83]
    v_mfma_f32_16x16x32_bf16 v[84:87], v[180:183], v[36:39], v[84:87]
    s_waitcnt lgkmcnt(1)
    v_mfma_f32_16x16x32_bf16 v[88:91], v[200:203], v[44:47], v[88:91]
    v_mfma_f32_16x16x32_bf16 v[92:95], v[204:207], v[44:47], v[92:95]
    v_mfma_f32_16x16x32_bf16 v[80:83], v[192:195], v[44:47], v[80:83]
    v_mfma_f32_16x16x32_bf16 v[84:87], v[196:199], v[44:47], v[84:87]
    s_waitcnt lgkmcnt(0)
    v_mfma_f32_16x16x32_bf16 v[88:91], v[216:219], v[252:255], v[88:91]
    v_mfma_f32_16x16x32_bf16 v[92:95], v[220:223], v[252:255], v[92:95]
    v_mfma_f32_16x16x32_bf16 v[80:83], v[208:211], v[252:255], v[80:83]
    v_mfma_f32_16x16x32_bf16 v[84:87], v[212:215], v[252:255], v[84:87]
    s_nop 4
    v_cvt_pk_bf16_f32 v228, v88, v89
    v_cvt_pk_bf16_f32 v229, v90, v91
    v_cvt_pk_bf16_f32 v230, v92, v93
    v_cvt_pk_bf16_f32 v231, v94, v95
    v_cvt_pk_bf16_f32 v224, v80, v81
    v_cvt_pk_bf16_f32 v225, v82, v83
    v_cvt_pk_bf16_f32 v226, v84, v85
    v_cvt_pk_bf16_f32 v227, v86, v87
    v_cvt_pk_bf16_f32 v240, v80, v81
    v_cvt_pk_bf16_f32 v241, v82, v83
    v_cvt_pk_bf16_f32 v242, v84, v85
    v_cvt_pk_bf16_f32 v243, v86, v87
    v_mov_b32_dpp v224, v228 row_ror:8 row_mask:0xf bank_mask:0xc
    v_mov_b32_dpp v225, v229 row_ror:8 row_mask:0xf bank_mask:0xc
    v_mov_b32_dpp v226, v230 row_ror:8 row_mask:0xf bank_mask:0xc
    v_mov_b32_dpp v227, v231 row_ror:8 row_mask:0xf bank_mask:0xc
    v_mov_b32_dpp v228, v240 row_ror:8 row_mask:0xf bank_mask:0x3
    v_mov_b32_dpp v229, v241 row_ror:8 row_mask:0xf bank_mask:0x3
    v_mov_b32_dpp v230, v242 row_ror:8 row_mask:0xf bank_mask:0x3
    v_mov_b32_dpp v231, v243 row_ror:8 row_mask:0xf bank_mask:0x3
L_prog_49:
    ds_read_b128 v[16:19], v5 offset:48
    s_waitcnt lgkmcnt(0)
    v_min3_u32 v16, v16, v17, v18
    v_min_u32 v16, v16, v19
    v_cmp_gt_u32 vcc, 1, v16
    s_cbranch_vccnz L_retry_50
    s_setprio 2
    buffer_store_dwordx4 v[244:247], v0, s[48:51], s78 offen sc1
    buffer_store_dwordx4 v[224:227], v0, s[48:51], s74 offen sc1
    buffer_store_dwordx4 v[228:231], v0, s[48:51], s75 offen sc1
    s_setprio 0
    v_lshlrev_b32 v1, 4, v4
    v_lshl_add_u32 v1, v3, 9, v1
    s_barrier
    s_setprio 2
    ds_read_b128 v[16:19], v7 offset:50176
    ds_read_b128 v[20:23], v8 offset:50176
    ds_read_b128 v[24:27], v9 offset:50176
    ds_read_b128 v[28:31], v10 offset:50176
    ds_read_b128 v[32:35], v40 offset:50176
    ds_read_b128 v[36:39], v41 offset:50176
    ds_read_b128 v[44:47], v42 offset:50176
    ds_read_b128 v[252:255], v43 offset:50176
    s_waitcnt lgkmcnt(7)
    v_mfma_f32_16x16x32_bf16 v[104:107], v[56:59], v[16:19], v[104:107]
    v_mfma_f32_16x16x32_bf16 v[108:111], v[60:63], v[16:19], v[108:111]
    s_waitcnt lgkmcnt(6)
    v_mfma_f32_16x16x32_bf16 v[104:107], v[72:75], v[20:23], v[104:107]
    v_mfma_f32_16x16x32_bf16 v[108:111], v[76:79], v[20:23], v[108:111]
    s_waitcnt lgkmcnt(5)
    v_mfma_f32_16x16x32_bf16 v[104:107], v[136:139], v[24:27], v[104:107]
    v_mfma_f32_16x16x32_bf16 v[108:111], v[140:143], v[24:27], v[108:111]
    s_waitcnt lgkmcnt(4)
    v_mfma_f32_16x16x32_bf16 v[104:107], v[152:155], v[28:31], v[104:107]
    v_mfma_f32_16x16x32_bf16 v[108:111], v[156:159], v[28:31], v[108:111]
    s_waitcnt lgkmcnt(3)
    v_mfma_f32_16x16x32_bf16 v[104:107], v[168:171], v[32:35], v[104:107]
    v_mfma_f32_16x16x32_bf16 v[108:111], v[172:175], v[32:35], v[108:111]
    s_waitcnt lgkmcnt(2)
    v_mfma_f32_16x16x32_bf16 v[104:107], v[184:187], v[36:39], v[104:107]
    v_mfma_f32_16x16x32_bf16 v[108:111], v[188:191], v[36:39], v[108:111]
    s_waitcnt lgkmcnt(1)
    v_mfma_f32_16x16x32_bf16 v[104:107], v[200:203], v[44:47], v[104:107]
    v_mfma_f32_16x16x32_bf16 v[108:111], v[204:207], v[44:47], v[108:111]
    s_waitcnt lgkmcnt(0)
    v_mfma_f32_16x16x32_bf16 v[104:107], v[216:219], v[252:255], v[104:107]
    v_mfma_f32_16x16x32_bf16 v[108:111], v[220:223], v[252:255], v[108:111]
    v_mfma_f32_16x16x32_bf16 v[96:99], v[48:51], v[16:19], v[96:99]
    v_mfma_f32_16x16x32_bf16 v[100:103], v[52:55], v[16:19], v[100:103]
    v_mfma_f32_16x16x32_bf16 v[96:99], v[64:67], v[20:23], v[96:99]
    v_mfma_f32_16x16x32_bf16 v[100:103], v[68:71], v[20:23], v[100:103]
    v_mfma_f32_16x16x32_bf16 v[96:99], v[128:131], v[24:27], v[96:99]
    v_mfma_f32_16x16x32_bf16 v[100:103], v[132:135], v[24:27], v[100:103]
    v_mfma_f32_16x16x32_bf16 v[96:99], v[144:147], v[28:31], v[96:99]
    v_mfma_f32_16x16x32_bf16 v[100:103], v[148:151], v[28:31], v[100:103]
    v_cvt_pk_bf16_f32 v236, v104, v105
    v_mfma_f32_16x16x32_bf16 v[96:99], v[160:163], v[32:35], v[96:99]
    v_cvt_pk_bf16_f32 v237, v106, v107
    v_mfma_f32_16x16x32_bf16 v[100:103], v[164:167], v[32:35], v[100:103]
    v_cvt_pk_bf16_f32 v238, v108, v109
    v_mfma_f32_16x16x32_bf16 v[96:99], v[176:179], v[36:39], v[96:99]
    v_cvt_pk_bf16_f32 v239, v110, v111
    v_mfma_f32_16x16x32_bf16 v[100:103], v[180:183], v[36:39], v[100:103]
    buffer_store_dwordx4 v[236:239], v1, s[48:51], s76 offen offset:64 sc1
    v_mfma_f32_16x16x32_bf16 v[96:99], v[192:195], v[44:47], v[96:99]
    v_mfma_f32_16x16x32_bf16 v[100:103], v[196:199], v[44:47], v[100:103]
    v_mfma_f32_16x16x32_bf16 v[96:99], v[208:211], v[252:255], v[96:99]
    v_mfma_f32_16x16x32_bf16 v[100:103], v[212:215], v[252:255], v[100:103]
    s_nop 6
    v_cvt_pk_bf16_f32 v232, v96, v97
    v_cvt_pk_bf16_f32 v233, v98, v99
    v_cvt_pk_bf16_f32 v234, v100, v101
    v_cvt_pk_bf16_f32 v235, v102, v103
    buffer_store_dwordx4 v[232:235], v1, s[48:51], s76 offen offset:0 sc1
    s_or_b32 s64, s2, s3
    s_cbranch_scc1 L_noepoch_51
    v_mov_b32 v1, s30
    s_mov_b64 exec, 1
    buffer_store_dword v1, v5, s[44:47], 0 offen sc1
L_noepoch_51:
    s_endpgm
L_retry_39:
    s_sub_u32 s100, s100, 1
    s_cbranch_scc1 L_end
    s_sleep 1
    s_branch L_spin_38
L_mre_40:
    s_sub_u32 s100, s100, 1
    s_cbranch_scc1 L_end
    s_sleep 2
    buffer_load_dword v1, v0, s[44:47], s74 offen sc1
    s_waitcnt vmcnt(0)
    s_branch L_mchk_37
L_retry_42:
    s_sub_u32 s100, s100, 1
    s_cbranch_scc1 L_end
    s_sleep 1
    s_branch L_spin_41
L_retry_44:
    s_sub_u32 s100, s100, 1
    s_cbranch_scc1 L_end
    s_sleep 1
    s_branch L_prog_43
L_retry_46:
    s_sub_u32 s100, s100, 1
    s_cbranch_scc1 L_end
    s_sleep 1
    s_branch L_prog_45
L_retry_48:
    s_sub_u32 s100, s100, 1
    s_cbranch_scc1 L_end
    s_sleep 1
    s_branch L_prog_47
L_retry_50:
    s_sub_u32 s100, s100, 1
    s_cbranch_scc1 L_end
    s_sleep 1
    s_branch L_prog_49
L_end:
    s_endpgm
.section .rodata,"a"
.p2align 6
.amdhsa_kernel standalone__hybrid_graph_tf_exphormer__graph_kernel
  .amdhsa_next_free_vgpr 256
  .amdhsa_next_free_sgpr 102
  .amdhsa_accum_offset 256
  .amdhsa_group_segment_fixed_size 0
  .amdhsa_kernarg_size 104
  .amdhsa_user_sgpr_count 2
  .amdhsa_user_sgpr_kernarg_segment_ptr 1
  .amdhsa_system_sgpr_workgroup_id_x 1
  .amdhsa_float_denorm_mode_32 3
.end_amdhsa_kernel
```

```asm
; @launch grid=(253,1,1) block=(512,1,1) lds=161792
.amdgcn_target "amdgcn-amd-amdhsa--gfx950"
.text
.globl standalone__hybrid_graph_tf_exphormer__graph_kernel
.p2align 8
.type standalone__hybrid_graph_tf_exphormer__graph_kernel,@function
standalone__hybrid_graph_tf_exphormer__graph_kernel:
L_begin:
    s_cmp_ge_u32 s2, 253
    s_cbranch_scc1 L_end
    s_load_dwordx16 s[4:19], s[0:1], 0
    s_load_dwordx8 s[20:27], s[0:1], 64
    s_load_dwordx2 s[28:29], s[0:1], 96
    s_and_b32 s64, s2, 0xf8
    s_cmp_lg_u32 s64, 8
    s_cbranch_scc1 L_nopf
    s_getpc_b64 s[32:33]
L_pc:
    v_lshlrev_b32 v1, 6, v0
    v_min_u32 v1, L_end-L_pc, v1
    global_load_dword v255, v1, s[32:33]
L_nopf:
    v_lshrrev_b32 v1, 6, v0
    v_lshlrev_b32 v8, 4, v0
    v_mov_b32 v12, 1966080
    v_readfirstlane_b32 s3, v1
    v_mov_b32 v13, 1966080
    v_mov_b32 v14, 1966080
    v_mov_b32 v15, 1966080
    ds_write_b128 v8, v[12:15] offset:41984
    ds_write_b128 v8, v[12:15] offset:50176
    v_subrev_u32 v9, 32, v0
    v_cmp_gt_u32 vcc, 20, v9
    v_mul_u32_u24 v9, 264, v9
    v_add_u32 v9, 148480, v9
    v_lshlrev_b32 v10, 2, v0
    v_cndmask_b32 v9, 0, v9, vcc
    v_min_u32 v11, 1020, v10
    ds_write_b32 v11, v9
    v_mov_b32 v16, 1310740000
    v_mov_b32 v17, 1310740000
    v_mov_b32 v18, 1310740000
    v_mov_b32 v19, 1310740000
    v_add_u32 v9, 148480, v8
    ds_write_b128 v9, v[16:19]
    v_and_b32 v2, 63, v0
    v_and_b32 v3, 15, v0
    v_bfe_u32 v4, v0, 4, 2
    v_mov_b32 v5, 0
    v_mov_b32 v6, 1
    s_mov_b32 s100, 67108864
    s_and_b32 s64, s2, 7
    s_lshl_b32 s64, s64, 1
    s_bfe_u32 s65, s2, 0x10003
    s_or_b32 s64, s64, s65
    s_and_b32 s65, s2, 0xf0
    s_or_b32 s64, s64, s65
    s_cmp_lt_u32 s2, 240
    s_cselect_b32 s1, s64, s2
    s_and_b32 s31, s3, 3
    s_cmp_lt_u32 s3, 4
    s_cbranch_scc1 L_gemm
    s_setprio 3
    v_and_b32 v8, 0xfff, v8
    v_and_b32 v9, 0x3ff, v10
    s_lshr_b32 s66, s2, 4
    s_lshl_b32 s66, s66, 3
    s_and_b32 s67, s2, 7
    s_or_b32 s68, s66, s67
    s_mul_i32 s64, s68, 5120
    v_add_u32 v40, s64, v8
    s_add_u32 s64, s64, 4096
    v_add_u32 v41, s64, v9
    v_lshrrev_b32 v42, 2, v3
    v_and_b32 v43, 3, v3
    v_lshl_add_u32 v42, v42, 4, v43
    s_lshl_b32 s64, s31, 1
    v_mov_b32 v43, s64
    v_lshlrev_b32 v44, 1, v43
    v_cmp_gt_u32 vcc, 8, v3
    s_mul_i32 s65, s1, 640
    v_lshlrev_b32 v7, 4, v3
    v_cndmask_b32 v43, v43, v44, vcc
    v_add_lshl_u32 v42, v42, v43, 4
    v_lshl_add_u32 v42, v4, 2, v42
    v_add_u32 v42, s65, v42
    v_min_u32 v42, 159996, v42
    s_bitcmp1_b32 s2, 3
    s_cbranch_scc0 L_mrole_1
    s_waitcnt lgkmcnt(0)
    global_load_dword v0, v42, s[10:11] nt
    global_load_dwordx4 v[48:51], v40, s[8:9] nt
    global_load_dword v52, v41, s[8:9] nt
    global_load_dwordx4 v[56:59], v40, s[6:7] nt
    global_load_dword v60, v41, s[6:7] nt
L_roled_2:
    s_mov_b32 s27, s68
    s_mov_b32 s26, 0
    s_cmp_lg_u32 s31, 0
    s_cbranch_scc1 L_roled_2_b
    s_load_dword s30, s[28:29], 0
L_roled_2_b:
    s_barrier
    s_branch L_pastm
L_mrole_1:
    v_lshrrev_b32 v43, 5, v2
    s_lshl_b32 s66, s31, 2
    v_add_u32 v44, s66, v43
    v_and_b32 v46, 31, v2
    v_xor_b32 v46, v46, v44
    v_lshlrev_b32 v46, 4, v46
    v_lshl_add_u32 v46, v43, 9, v46
    s_bfe_u32 s64, s68, 0x30002
    s_lshl_b32 s64, s64, 14
    s_lshr_b32 s65, s68, 5
    s_lshl_b32 s65, s65, 15
    s_bfe_u32 s66, s68, 0x10001
    s_lshl_b32 s66, s66, 14
    s_add_u32 s65, s65, s66
    s_and_b32 s66, s68, 1
    s_lshl_b32 s66, s66, 11
    s_add_u32 s65, s65, s66
    s_lshl_b32 s66, s31, 12
    v_add_u32 v46, s66, v46
    v_add_u32 v44, s64, v46
    v_add_u32 v46, s65, v46
    v_xor_b32 v45, 0x420, v44
    v_xor_b32 v47, 0x420, v46
    s_lshl_b32 s66, s31, 11
    s_waitcnt lgkmcnt(0)
    global_load_dword v0, v42, s[10:11] nt
    s_add_u32 m0, s66, 62464
    s_nop 0
    global_load_lds_dwordx4 v46, s[20:21] offset:0
    s_add_u32 m0, s66, 63488
    s_nop 0
    global_load_lds_dwordx4 v47, s[20:21] offset:0
    s_add_u32 m0, s66, 21504
    s_nop 0
    global_load_lds_dwordx4 v44, s[18:19] offset:0
    s_add_u32 m0, s66, 22528
    s_nop 0
    global_load_lds_dwordx4 v45, s[18:19] offset:0
    s_add_u32 m0, s66, 27648
    s_nop 0
    global_load_lds_dwordx4 v44, s[18:19] offset:2048
    s_add_u32 m0, s66, 28672
    s_nop 0
    global_load_lds_dwordx4 v45, s[18:19] offset:2048
    s_branch L_roled_2
L_pastm:
    s_mov_b32 s32, s4
    s_and_b32 s33, s5, 0xffff
    s_mov_b32 s34, 5120000
    s_mov_b32 s35, 0x20000
    s_mov_b32 s36, s14
    s_and_b32 s37, s15, 0xffff
    s_mov_b32 s38, 20000
    s_mov_b32 s39, 0x20000
    s_add_u32 s40, s28, 1048576
    s_addc_u32 s41, s29, 0
    s_and_b32 s41, s41, 0xffff
    s_mov_b32 s42, 2048000
    s_mov_b32 s43, 0x20000
    v_and_b32 v40, 8, v3
    v_lshlrev_b32 v40, 1, v40
    v_mov_b32 v41, 0xffff
    v_lshlrev_b32 v40, v40, v41
    s_mov_b32 s64, 0x0f0f0f0f
    s_mov_b32 s65, 0x0f0f0f0f
    v_cndmask_b32 v12, 0, v40, s[64:65]
    v_xor_b32 v13, v40, v12
    v_and_b32 v14, 3, v3
    v_mul_u32_u24 v14, 0x5555, v14
    s_cmp_lg_u32 s31, 0
    s_cbranch_scc1 L_tagged_3
    s_waitcnt lgkmcnt(0)
    s_mul_i32 s30, s30, 0x9E3779B1
    s_add_u32 s30, s30, 0x7F4A7C15
    v_mov_b32 v40, 1
    v_mov_b32 v41, s30
    ds_write_b64 v5, v[40:41] offset:8
L_tagged_3:
    s_bitcmp1_b32 s2, 3
    s_cbranch_scc0 L_mwork_4
    v_mov_b32 v43, 4
    v_mov_b32 v44, 2031616
    s_mov_b32 s64, 0x3f0001
    v_lshrrev_b32 v40, 6, v8
    v_and_b32 v41, 0x30, v8
    v_lshl_add_u32 v40, v40, 14, v41
    s_lshl_b32 s68, s27, 6
    s_add_u32 s69, s68, 0x100000
    s_add_u32 s70, s68, 8192
    s_add_u32 s71, s69, 8192
    s_mov_b32 s65, 0x203c
    s_waitcnt vmcnt(2)
    v_mul_u32_u24 v64, 52429, v48
    v_lshrrev_b32 v72, 22, v64
    v_lshlrev_b32 v80, 2, v72
    ds_add_rtn_u32 v80, v80, v43 offset:512
    v_mul_u32_u24 v65, 52429, v49
    v_lshrrev_b32 v73, 22, v65
    v_lshlrev_b32 v81, 2, v73
    ds_add_rtn_u32 v81, v81, v43 offset:512
    v_mul_u32_u24 v66, 52429, v50
    v_lshrrev_b32 v74, 22, v66
    v_lshlrev_b32 v82, 2, v74
    ds_add_rtn_u32 v82, v82, v43 offset:512
    v_mul_u32_u24 v67, 52429, v51
    v_lshrrev_b32 v75, 22, v67
    v_lshlrev_b32 v83, 2, v75
    ds_add_rtn_u32 v83, v83, v43 offset:512
    v_mul_u32_u24 v68, 52429, v52
    v_lshrrev_b32 v76, 22, v68
    v_lshlrev_b32 v84, 2, v76
    ds_add_rtn_u32 v84, v84, v43 offset:512
    v_lshrrev_b32 v64, 21, v64
    v_mad_u32_u24 v64, v64, 24, v48
    v_mul_u32_u24 v64, 0x8001, v64
    v_bfe_u32 v88, v72, 1, 2
    v_lshl_or_b32 v72, v72, 2, v88
    v_lshlrev_b32 v72, 4, v72
    v_lshrrev_b32 v65, 21, v65
    v_mad_u32_u24 v65, v65, 24, v49
    v_mul_u32_u24 v65, 0x8001, v65
    v_bfe_u32 v89, v73, 1, 2
    v_lshl_or_b32 v73, v73, 2, v89
    v_lshlrev_b32 v73, 4, v73
    v_lshrrev_b32 v66, 21, v66
    v_mad_u32_u24 v66, v66, 24, v50
    v_mul_u32_u24 v66, 0x8001, v66
    v_bfe_u32 v90, v74, 1, 2
    v_lshl_or_b32 v74, v74, 2, v90
    v_lshlrev_b32 v74, 4, v74
    v_lshrrev_b32 v67, 21, v67
    v_mad_u32_u24 v67, v67, 24, v51
    v_mul_u32_u24 v67, 0x8001, v67
    v_bfe_u32 v91, v75, 1, 2
    v_lshl_or_b32 v75, v75, 2, v91
    v_lshlrev_b32 v75, 4, v75
    v_lshrrev_b32 v68, 21, v68
    v_mad_u32_u24 v68, v68, 24, v52
    v_mul_u32_u24 v68, 0x8001, v68
    v_bfe_u32 v92, v76, 1, 2
    v_lshl_or_b32 v76, v76, 2, v92
    v_lshlrev_b32 v76, 4, v76
    s_waitcnt vmcnt(0)
    v_lshlrev_b32 v56, 1, v56
    v_and_or_b32 v64, v64, s64, v56
    v_lshlrev_b32 v57, 1, v57
    v_and_or_b32 v65, v65, s64, v57
    v_lshlrev_b32 v58, 1, v58
    v_and_or_b32 v66, v66, s64, v58
    v_lshlrev_b32 v59, 1, v59
    v_and_or_b32 v67, v67, s64, v59
    v_lshlrev_b32 v60, 1, v60
    v_and_or_b32 v68, v68, s64, v60
    s_waitcnt lgkmcnt(0)
    v_cmp_gt_u32 vcc, 124, v80
    v_min_u32 v80, 124, v80
    v_lshl_or_b32 v80, v80, 7, v80
    v_cndmask_b32 v64, v44, v64, vcc
    v_bitop3_b32 v80, v80, s65, v72 bitop3:0x6a
    ds_write_b32 v80, v64 offset:41984
    v_cmp_gt_u32 vcc, 124, v81
    v_min_u32 v81, 124, v81
    v_lshl_or_b32 v81, v81, 7, v81
    v_cndmask_b32 v65, v44, v65, vcc
    v_bitop3_b32 v81, v81, s65, v73 bitop3:0x6a
    ds_write_b32 v81, v65 offset:41984
    v_cmp_gt_u32 vcc, 124, v82
    v_min_u32 v82, 124, v82
    v_lshl_or_b32 v82, v82, 7, v82
    v_cndmask_b32 v66, v44, v66, vcc
    v_bitop3_b32 v82, v82, s65, v74 bitop3:0x6a
    ds_write_b32 v82, v66 offset:41984
    v_cmp_gt_u32 vcc, 124, v83
    v_min_u32 v83, 124, v83
    v_lshl_or_b32 v83, v83, 7, v83
    v_cndmask_b32 v67, v44, v67, vcc
    v_bitop3_b32 v83, v83, s65, v75 bitop3:0x6a
    ds_write_b32 v83, v67 offset:41984
    v_cmp_gt_u32 vcc, 124, v84
    v_min_u32 v84, 124, v84
    v_lshl_or_b32 v84, v84, 7, v84
    v_cndmask_b32 v68, v44, v68, vcc
    v_bitop3_b32 v84, v84, s65, v76 bitop3:0x6a
    ds_write_b32 v84, v68 offset:41984
    s_waitcnt lgkmcnt(0)
    s_barrier
    ds_read_b32 v44, v5 offset:12
    ds_read_b128 v[48:51], v8 offset:41984
    ds_read_b128 v[52:55], v8 offset:46080
    ds_read_b128 v[56:59], v8 offset:50176
    ds_read_b128 v[60:63], v8 offset:54272
    s_waitcnt lgkmcnt(4)
    v_readfirstlane_b32 s30, v44
    s_nop 0
    s_and_b32 s44, s30, 0xffc00000
    s_lshl_b32 s45, s30, 10
    s_and_b32 s45, s45, 0xffc00000
    s_lshl_b32 s46, s30, 20
    s_and_b32 s46, s46, 0xffc00000
    s_lshl_b32 s47, s30, 22
    s_waitcnt lgkmcnt(3)
    v_cmp_eq_u32 vcc, 1966080, v51
    v_or_b32 v48, s44, v48
    v_or_b32 v49, s45, v49
    v_or_b32 v50, s46, v50
    v_or_b32 v51, s47, v51
    buffer_store_dwordx4 v[48:51], v40, s[40:43], s68 offen sc1
    s_wqm_b64 s[72:73], vcc
    s_waitcnt lgkmcnt(2)
    v_cmp_eq_u32 vcc, 1966080, v55
    v_or_b32 v52, s44, v52
    v_or_b32 v53, s45, v53
    v_or_b32 v54, s46, v54
    v_or_b32 v55, s47, v55
    buffer_store_dwordx4 v[52:55], v40, s[40:43], s69 offen sc1
    s_wqm_b64 s[74:75], vcc
    s_waitcnt lgkmcnt(1)
    s_not_b64 exec, s[72:73]
    s_cbranch_scc0 L_nosec_8
    v_or_b32 v56, s44, v56
    v_or_b32 v57, s45, v57
    v_or_b32 v58, s46, v58
    v_or_b32 v59, s47, v59
    buffer_store_dwordx4 v[56:59], v40, s[40:43], s70 offen sc1
L_nosec_8:
    s_waitcnt lgkmcnt(0)
    s_not_b64 exec, s[74:75]
    s_cbranch_scc0 L_nosec_9
    v_or_b32 v60, s44, v60
    v_or_b32 v61, s45, v61
    v_or_b32 v62, s46, v62
    v_or_b32 v63, s47, v63
    buffer_store_dwordx4 v[60:63], v40, s[40:43], s71 offen sc1
L_nosec_9:
    s_mov_b64 exec, -1
    s_cmp_ge_u32 s2, 250
    s_cbranch_scc1 L_end
L_worked_5:
    v_lshlrev_b32 v0, 9, v0
    s_setprio 1
    s_lshl_b32 s64, s31, 10
    s_lshr_b32 s10, s1, 1
    s_lshl_b32 s10, s10, 14
    s_add_u32 s11, s10, 4096
    s_add_u32 s12, s10, 8192
    s_add_u32 s13, s10, 12288
    v_cmp_gt_u32 vcc, 0xf40, v8
    s_mov_b64 s[14:15], vcc
    v_add_u32_dpp v9, v0, v7 row_newbcast:0 row_mask:0xf bank_mask:0xf
    buffer_load_dwordx4 v[176:179], v9, s[32:35], 0 offen offset:0
    buffer_load_dwordx4 v[180:183], v9, s[32:35], 0 offen offset:256
    v_add_u32_dpp v9, v0, v7 row_newbcast:1 row_mask:0xf bank_mask:0xf
    buffer_load_dwordx4 v[184:187], v9, s[32:35], 0 offen offset:0
    buffer_load_dwordx4 v[188:191], v9, s[32:35], 0 offen offset:256
    s_add_u32 m0, s64, 62464
    s_mov_b32 s65, 0
    buffer_load_dwordx4 v8, s[36:39], s65 offen lds
    v_add_u32_dpp v9, v0, v7 row_newbcast:2 row_mask:0xf bank_mask:0xf
    s_cmp_eq_u32 s26, 2
    s_cbranch_scc1 L_loose_10
    s_waitcnt vmcnt(2)
L_loose_10:
    s_waitcnt vmcnt(6)
    buffer_load_dwordx4 v[192:195], v9, s[32:35], 0 offen offset:0
    buffer_load_dwordx4 v[196:199], v9, s[32:35], 0 offen offset:256
    s_add_u32 m0, s64, 66560
    s_mov_b32 s65, 4096
    buffer_load_dwordx4 v8, s[36:39], s65 offen lds
    v_add_u32_dpp v9, v0, v7 row_newbcast:3 row_mask:0xf bank_mask:0xf
    s_cmp_eq_u32 s26, 2
    s_cbranch_scc1 L_loose_11
    s_waitcnt vmcnt(2)
L_loose_11:
    s_waitcnt vmcnt(6)
    buffer_load_dwordx4 v[200:203], v9, s[32:35], 0 offen offset:0
    buffer_load_dwordx4 v[204:207], v9, s[32:35], 0 offen offset:256
    s_add_u32 m0, s64, 70656
    s_mov_b32 s65, 8192
    buffer_load_dwordx4 v8, s[36:39], s65 offen lds
    v_add_u32_dpp v9, v0, v7 row_newbcast:4 row_mask:0xf bank_mask:0xf
    s_cmp_eq_u32 s26, 2
    s_cbranch_scc1 L_loose_12
    s_waitcnt vmcnt(2)
L_loose_12:
    s_waitcnt vmcnt(6)
    buffer_load_dwordx4 v[208:211], v9, s[32:35], 0 offen offset:0
    buffer_load_dwordx4 v[212:215], v9, s[32:35], 0 offen offset:256
    s_add_u32 m0, s64, 74752
    s_mov_b32 s65, 12288
    buffer_load_dwordx4 v8, s[36:39], s65 offen lds
    v_add_u32_dpp v9, v0, v7 row_newbcast:5 row_mask:0xf bank_mask:0xf
    s_cmp_eq_u32 s26, 2
    s_cbranch_scc1 L_loose_13
    s_waitcnt vmcnt(2)
L_loose_13:
    s_waitcnt vmcnt(6)
    buffer_load_dwordx4 v[216:219], v9, s[32:35], 0 offen offset:0
    buffer_load_dwordx4 v[220:223], v9, s[32:35], 0 offen offset:256
    s_add_u32 m0, s64, 78848
    s_mov_b32 s65, 16384
    buffer_load_dwordx4 v8, s[36:39], s65 offen lds
L_ipoll_14:
    buffer_load_dwordx4 v[48:51], v8, s[40:43], s10 offen sc1
    s_mov_b64 exec, s[14:15]
    buffer_load_dwordx4 v[52:55], v8, s[40:43], s11 offen sc1
    s_mov_b64 exec, -1
L_spin_15:
    ds_read_b128 v[44:47], v5
    s_waitcnt lgkmcnt(0)
    v_readfirstlane_b32 s101, v46
    v_readfirstlane_b32 s30, v47
    s_cmp_ge_u32 s101, 1
    s_cbranch_scc0 L_retry_16
    s_and_b32 s44, s30, 0xffc00000
    s_lshl_b32 s45, s30, 10
    s_and_b32 s45, s45, 0xffc00000
    s_lshl_b32 s46, s30, 20
    s_and_b32 s46, s46, 0xffc00000
    s_lshl_b32 s47, s30, 22
    s_and_b32 s64, s1, 1
    s_lshl_b32 s64, s64, 21
    s_xor_b32 s17, s64, 1966080
    s_or_b32 s44, s44, s64
    v_mov_b32 v68, s17
    s_or_b32 s45, s45, s64
    v_mov_b32 v69, s17
    s_or_b32 s46, s46, s64
    v_mov_b32 v70, s17
    s_or_b32 s47, s47, s64
    v_mov_b32 v71, s17
    s_mov_b32 s16, 1310720
    v_mov_b32 v42, 2
    s_waitcnt vmcnt(1)
    v_xor_b32 v64, s44, v48
    v_xor_b32 v65, s45, v49
    v_xor_b32 v66, s46, v50
    v_xor_b32 v67, s47, v51
    v_or3_b32 v40, v64, v65, v66
    v_or_b32 v40, v40, v67
    v_cmp_eq_u32 s[72:73], s17, v67
    v_cmp_gt_u32 s[48:49], s16, v64
    v_lshlrev_b32_sdwa v80, 2, v64 dst_sel:DWORD dst_unused:UNUSED_PAD src0_sel:DWORD src1_sel:WORD_1
    v_cmp_gt_u32 s[50:51], s16, v65
    v_lshlrev_b32_sdwa v81, 2, v65 dst_sel:DWORD dst_unused:UNUSED_PAD src0_sel:DWORD src1_sel:WORD_1
    v_cmp_gt_u32 s[52:53], s16, v66
    v_lshlrev_b32_sdwa v82, 2, v66 dst_sel:DWORD dst_unused:UNUSED_PAD src0_sel:DWORD src1_sel:WORD_1
    v_cmp_gt_u32 s[54:55], s16, v67
    v_lshlrev_b32_sdwa v83, 2, v67 dst_sel:DWORD dst_unused:UNUSED_PAD src0_sel:DWORD src1_sel:WORD_1
    s_waitcnt vmcnt(0)
    s_mov_b64 exec, s[14:15]
    v_xor_b32 v68, s44, v52
    v_xor_b32 v69, s45, v53
    v_xor_b32 v70, s46, v54
    v_xor_b32 v71, s47, v55
    s_mov_b64 exec, -1
    v_or3_b32 v40, v40, v68, v69
    v_or3_b32 v40, v40, v70, v71
    v_cmp_eq_u32 s[74:75], s17, v71
    v_cmp_le_u32 vcc, 0x400000, v40
    s_cbranch_vccnz L_retry_17
    s_wqm_b64 s[72:73], s[72:73]
    s_not_b64 exec, s[72:73]
    s_cbranch_scc0 L_nosec_18
    buffer_load_dwordx4 v[56:59], v8, s[40:43], s12 offen sc1
L_nosec_18:
    s_wqm_b64 s[74:75], s[74:75]
    s_not_b64 exec, s[74:75]
    s_cbranch_scc0 L_nosec_19
    buffer_load_dwordx4 v[60:63], v8, s[40:43], s13 offen sc1
L_nosec_19:
    s_mov_b64 exec, -1
    v_cmp_gt_u32 s[56:57], s16, v68
    v_lshlrev_b32_sdwa v84, 2, v68 dst_sel:DWORD dst_unused:UNUSED_PAD src0_sel:DWORD src1_sel:WORD_1
    v_cmp_gt_u32 s[58:59], s16, v69
    v_lshlrev_b32_sdwa v85, 2, v69 dst_sel:DWORD dst_unused:UNUSED_PAD src0_sel:DWORD src1_sel:WORD_1
    v_cmp_gt_u32 s[60:61], s16, v70
    v_lshlrev_b32_sdwa v86, 2, v70 dst_sel:DWORD dst_unused:UNUSED_PAD src0_sel:DWORD src1_sel:WORD_1
    v_cmp_gt_u32 s[62:63], s16, v71
    v_lshlrev_b32_sdwa v87, 2, v71 dst_sel:DWORD dst_unused:UNUSED_PAD src0_sel:DWORD src1_sel:WORD_1
    s_mov_b64 exec, s[48:49]
    ds_add_rtn_u32 v80, v80, v42 offset:128
    s_mov_b64 exec, s[50:51]
    ds_add_rtn_u32 v81, v81, v42 offset:128
    s_mov_b64 exec, s[52:53]
    ds_add_rtn_u32 v82, v82, v42 offset:128
    s_mov_b64 exec, s[54:55]
    ds_add_rtn_u32 v83, v83, v42 offset:128
    s_mov_b64 exec, s[56:57]
    ds_add_rtn_u32 v84, v84, v42 offset:128
    s_mov_b64 exec, s[58:59]
    ds_add_rtn_u32 v85, v85, v42 offset:128
    s_mov_b64 exec, s[60:61]
    ds_add_rtn_u32 v86, v86, v42 offset:128
    s_mov_b64 exec, s[62:63]
    ds_add_rtn_u32 v87, v87, v42 offset:128
    s_mov_b64 exec, -1
    v_add_u32_dpp v9, v0, v7 row_newbcast:6 row_mask:0xf bank_mask:0xf
    buffer_load_dwordx4 v[224:227], v9, s[32:35], 0 offen offset:0
    buffer_load_dwordx4 v[228:231], v9, s[32:35], 0 offen offset:256
    v_add_u32_dpp v9, v0, v7 row_newbcast:7 row_mask:0xf bank_mask:0xf
    buffer_load_dwordx4 v[232:235], v9, s[32:35], 0 offen offset:0
    buffer_load_dwordx4 v[236:239], v9, s[32:35], 0 offen offset:256
    s_waitcnt lgkmcnt(4)
    s_mov_b64 exec, s[48:49]
    ds_write_b16 v80, v64
    s_mov_b64 exec, s[50:51]
    ds_write_b16 v81, v65
    s_mov_b64 exec, s[52:53]
    ds_write_b16 v82, v66
    s_mov_b64 exec, s[54:55]
    ds_write_b16 v83, v67
    s_waitcnt lgkmcnt(4)
    s_mov_b64 exec, s[56:57]
    ds_write_b16 v84, v68
    s_mov_b64 exec, s[58:59]
    ds_write_b16 v85, v69
    s_mov_b64 exec, s[60:61]
    ds_write_b16 v86, v70
    s_mov_b64 exec, s[62:63]
    ds_write_b16 v87, v71
    s_not_b64 exec, s[72:73]
    s_cbranch_scc0 L_secdone_21
    s_waitcnt vmcnt(4)
L_sec_20:
    v_xor_b32 v72, s44, v56
    v_xor_b32 v73, s45, v57
    v_xor_b32 v74, s46, v58
    v_xor_b32 v75, s47, v59
    v_or3_b32 v40, v72, v73, v74
    v_or_b32 v40, v40, v75
    v_cmp_le_u32 vcc, 0x400000, v40
    s_cbranch_vccnz L_retry_23
    v_and_b32 v40, 2031616, v75
    v_cmp_eq_u32 vcc, 2031616, v40
    v_cmp_gt_u32 s[64:65], s16, v72
    v_lshlrev_b32_sdwa v88, 2, v72 dst_sel:DWORD dst_unused:UNUSED_PAD src0_sel:DWORD src1_sel:WORD_1
    v_cmp_gt_u32 s[66:67], s16, v73
    v_lshlrev_b32_sdwa v89, 2, v73 dst_sel:DWORD dst_unused:UNUSED_PAD src0_sel:DWORD src1_sel:WORD_1
    v_cmp_gt_u32 s[68:69], s16, v74
    v_lshlrev_b32_sdwa v90, 2, v74 dst_sel:DWORD dst_unused:UNUSED_PAD src0_sel:DWORD src1_sel:WORD_1
    v_cmp_gt_u32 s[70:71], s16, v75
    v_lshlrev_b32_sdwa v91, 2, v75 dst_sel:DWORD dst_unused:UNUSED_PAD src0_sel:DWORD src1_sel:WORD_1
    s_mov_b64 exec, s[64:65]
    ds_add_rtn_u32 v88, v88, v42 offset:128
    s_mov_b64 exec, s[66:67]
    ds_add_rtn_u32 v89, v89, v42 offset:128
    s_mov_b64 exec, s[68:69]
    ds_add_rtn_u32 v90, v90, v42 offset:128
    s_mov_b64 exec, s[70:71]
    ds_add_rtn_u32 v91, v91, v42 offset:128
    s_mov_b64 exec, vcc
    ds_write_b32 v5, v6 offset:20
    s_waitcnt lgkmcnt(0)
    s_mov_b64 exec, s[64:65]
    ds_write_b16 v88, v72
    s_mov_b64 exec, s[66:67]
    ds_write_b16 v89, v73
    s_mov_b64 exec, s[68:69]
    ds_write_b16 v90, v74
    s_mov_b64 exec, s[70:71]
    ds_write_b16 v91, v75
L_secdone_21:
    s_not_b64 exec, s[74:75]
    s_cbranch_scc0 L_secdone_25
    s_waitcnt vmcnt(4)
L_sec_24:
    v_xor_b32 v76, s44, v60
    v_xor_b32 v77, s45, v61
    v_xor_b32 v78, s46, v62
    v_xor_b32 v79, s47, v63
    v_or3_b32 v40, v76, v77, v78
    v_or_b32 v40, v40, v79
    v_cmp_le_u32 vcc, 0x400000, v40
    s_cbranch_vccnz L_retry_27
    v_and_b32 v40, 2031616, v79
    v_cmp_eq_u32 vcc, 2031616, v40
    v_cmp_gt_u32 s[64:65], s16, v76
    v_lshlrev_b32_sdwa v92, 2, v76 dst_sel:DWORD dst_unused:UNUSED_PAD src0_sel:DWORD src1_sel:WORD_1
    v_cmp_gt_u32 s[66:67], s16, v77
    v_lshlrev_b32_sdwa v93, 2, v77 dst_sel:DWORD dst_unused:UNUSED_PAD src0_sel:DWORD src1_sel:WORD_1
    v_cmp_gt_u32 s[68:69], s16, v78
    v_lshlrev_b32_sdwa v94, 2, v78 dst_sel:DWORD dst_unused:UNUSED_PAD src0_sel:DWORD src1_sel:WORD_1
    v_cmp_gt_u32 s[70:71], s16, v79
    v_lshlrev_b32_sdwa v95, 2, v79 dst_sel:DWORD dst_unused:UNUSED_PAD src0_sel:DWORD src1_sel:WORD_1
    s_mov_b64 exec, s[64:65]
    ds_add_rtn_u32 v92, v92, v42 offset:128
    s_mov_b64 exec, s[66:67]
    ds_add_rtn_u32 v93, v93, v42 offset:128
    s_mov_b64 exec, s[68:69]
    ds_add_rtn_u32 v94, v94, v42 offset:128
    s_mov_b64 exec, s[70:71]
    ds_add_rtn_u32 v95, v95, v42 offset:128
    s_mov_b64 exec, vcc
    ds_write_b32 v5, v6 offset:20
    s_waitcnt lgkmcnt(0)
    s_mov_b64 exec, s[64:65]
    ds_write_b16 v92, v76
    s_mov_b64 exec, s[66:67]
    ds_write_b16 v93, v77
    s_mov_b64 exec, s[68:69]
    ds_write_b16 v94, v78
    s_mov_b64 exec, s[70:71]
    ds_write_b16 v95, v79
L_secdone_25:
    s_waitcnt lgkmcnt(0)
    s_mov_b64 exec, 1
    ds_add_u32 v5, v6 offset:16
    s_mov_b64 exec, -1
    v_add_u32_dpp v9, v0, v7 row_newbcast:8 row_mask:0xf bank_mask:0xf
    buffer_load_dwordx4 v[240:243], v9, s[32:35], 0 offen offset:0
    buffer_load_dwordx4 v[244:247], v9, s[32:35], 0 offen offset:256
    v_add_u32_dpp v9, v0, v7 row_newbcast:9 row_mask:0xf bank_mask:0xf
    buffer_load_dwordx4 v[248:251], v9, s[32:35], 0 offen offset:0
    buffer_load_dwordx4 v[252:255], v9, s[32:35], 0 offen offset:256
    s_lshl_b32 s20, s31, 1
    s_add_u32 s21, s20, 1
    s_add_u32 s22, s20, 8
    s_add_u32 s23, s20, 9
    s_add_u32 s24, s31, 16
    v_add_u32 v47, -1, v3
    v_bfe_u32 v40, v47, 1, 1
    v_and_b32 v41, 1, v47
    v_lshl_add_u32 v40, v40, 3, v41
    v_add_u32 v40, s20, v40
    v_mov_b32 v41, s24
    v_cmp_ne_u32 vcc, 0, v3
    v_min_u32 v47, 19, v2
    v_mul_u32_u24 v46, 264, v47
    v_cndmask_b32 v40, v41, v40, vcc
    v_mul_u32_u24 v41, 264, v40
    v_add_u32 v41, 148480, v41
    v_lshlrev_b32 v40, 2, v40
    v_add_u32 v46, 148728, v46
    v_lshlrev_b32 v47, 2, v47
    v_lshlrev_b32 v43, 3, v3
    v_lshl_add_u32 v43, v4, 1, v43
L_spin_28:
    ds_read_b32 v44, v5 offset:16
    s_waitcnt lgkmcnt(0)
    v_readfirstlane_b32 s101, v44
    s_cmp_ge_u32 s101, 4
    s_cbranch_scc0 L_retry_29
    ds_read_b32 v44, v40 offset:128
    ds_read_b32 v47, v47 offset:128
    ds_read_b32 v45, v5 offset:20
    s_waitcnt lgkmcnt(2)
    v_sub_u32 v44, v44, v41
    v_max_u32 v44, 18, v44
    s_waitcnt lgkmcnt(0)
    v_cmp_gt_u32 vcc, v47, v46
    v_add_u32_dpp v48, v44, v44 row_shr:1 row_mask:0xf bank_mask:0xf bound_ctrl:1
    v_readfirstlane_b32 s25, v45
    s_or_b32 s64, vcc_lo, vcc_hi
    v_add_u32_dpp v48, v48, v48 row_shr:2 row_mask:0xf bank_mask:0xf bound_ctrl:1
    s_or_b32 s25, s25, s64
    s_mov_b32 s53, 0
    v_add_u32_dpp v48, v48, v48 row_shr:4 row_mask:0xf bank_mask:0xf bound_ctrl:1
    v_sub_u32 v44, v48, v44
    v_sub_u32 v44, v41, v44
    v_readlane_b32 s10, v48, 0
    v_readlane_b32 s11, v48, 1
    v_readlane_b32 s12, v48, 2
    v_readlane_b32 s13, v48, 3
    v_readlane_b32 s14, v48, 4
    v_add_u32_dpp v160, v44, v43 row_newbcast:0 row_mask:0xf bank_mask:0xf
    v_add_u32_dpp v161, v44, v43 row_newbcast:1 row_mask:0xf bank_mask:0xf
    v_add_u32_dpp v162, v44, v43 row_newbcast:2 row_mask:0xf bank_mask:0xf
    v_add_u32_dpp v163, v44, v43 row_newbcast:3 row_mask:0xf bank_mask:0xf
    v_add_u32_dpp v164, v44, v43 row_newbcast:4 row_mask:0xf bank_mask:0xf
    s_add_u32 s50, s14, 14
    s_lshr_b32 s50, s50, 4
    s_cmp_gt_u32 s50, 32
    s_cselect_b32 s25, 1, s25
    s_max_u32 s50, s50, 12
    v_add_u32 v40, 0, v43
    v_cmp_le_u32 s[64:65], s10, v40
    v_cmp_le_u32 s[66:67], s11, v40
    v_cmp_le_u32 s[68:69], s12, v40
    v_cmp_le_u32 s[70:71], s13, v40
    v_cndmask_b32 v40, v160, v161, s[64:65]
    v_cndmask_b32 v40, v40, v162, s[66:67]
    v_cndmask_b32 v40, v40, v163, s[68:69]
    v_cndmask_b32 v40, v40, v164, s[70:71]
    ds_read_u16 v40, v40 offset:0
    v_add_u32 v41, 128, v43
    v_cmp_le_u32 s[64:65], s10, v41
    v_cmp_le_u32 s[66:67], s11, v41
    v_cmp_le_u32 s[68:69], s12, v41
    v_cmp_le_u32 s[70:71], s13, v41
    v_cndmask_b32 v41, v160, v161, s[64:65]
    v_cndmask_b32 v41, v41, v162, s[66:67]
    v_cndmask_b32 v41, v41, v163, s[68:69]
    v_cndmask_b32 v41, v41, v164, s[70:71]
    ds_read_u16 v41, v41 offset:128
    v_add_u32 v42, 256, v43
    v_cmp_le_u32 s[64:65], s10, v42
    v_cmp_le_u32 s[66:67], s11, v42
    v_cmp_le_u32 s[68:69], s12, v42
    v_cmp_le_u32 s[70:71], s13, v42
    v_cndmask_b32 v42, v160, v161, s[64:65]
    v_cndmask_b32 v42, v42, v162, s[66:67]
    v_cndmask_b32 v42, v42, v163, s[68:69]
    v_cndmask_b32 v42, v42, v164, s[70:71]
    ds_read_u16 v42, v42 offset:256
    v_add_u32 v43, 384, v43
    v_cmp_le_u32 s[64:65], s10, v43
    v_cmp_le_u32 s[66:67], s11, v43
    v_cmp_le_u32 s[68:69], s12, v43
    v_cmp_le_u32 s[70:71], s13, v43
    v_cndmask_b32 v43, v160, v161, s[64:65]
    v_cndmask_b32 v43, v43, v162, s[66:67]
    v_cndmask_b32 v43, v43, v163, s[68:69]
    v_cndmask_b32 v43, v43, v164, s[70:71]
    ds_read_u16 v43, v43 offset:384
    s_waitcnt lgkmcnt(3)
    v_and_b32 v32, 0x7ffe, v40
    ds_read_u16 v33, v32 offset:62464
    v_lshlrev_b32 v32, 8, v32
    v_lshlrev_b32 v40, 4, v40
    s_waitcnt lgkmcnt(3)
    v_and_b32 v34, 0x7ffe, v41
    ds_read_u16 v35, v34 offset:62464
    v_lshlrev_b32 v34, 8, v34
    v_lshlrev_b32 v41, 4, v41
    s_waitcnt lgkmcnt(3)
    v_and_b32 v36, 0x7ffe, v42
    ds_read_u16 v37, v36 offset:62464
    v_lshlrev_b32 v36, 8, v36
    v_lshlrev_b32 v42, 4, v42
    s_waitcnt lgkmcnt(3)
    v_and_b32 v38, 0x7ffe, v43
    ds_read_u16 v39, v38 offset:62464
    v_lshlrev_b32 v38, 8, v38
    v_lshlrev_b32 v43, 4, v43
    v_add_u32_dpp v11, v32, v7 row_newbcast:0 row_mask:0xf bank_mask:0xf
    buffer_load_dwordx4 v[48:51], v11, s[32:35], 0 offen offset:0
    buffer_load_dwordx4 v[56:59], v11, s[32:35], 0 offen offset:256
    v_add_u32_dpp v11, v32, v7 row_newbcast:1 row_mask:0xf bank_mask:0xf
    buffer_load_dwordx4 v[52:55], v11, s[32:35], 0 offen offset:0
    buffer_load_dwordx4 v[60:63], v11, s[32:35], 0 offen offset:256
    v_add_u32_dpp v11, v32, v7 row_newbcast:2 row_mask:0xf bank_mask:0xf
    buffer_load_dwordx4 v[64:67], v11, s[32:35], 0 offen offset:0
    buffer_load_dwordx4 v[72:75], v11, s[32:35], 0 offen offset:256
    v_add_u32_dpp v11, v32, v7 row_newbcast:3 row_mask:0xf bank_mask:0xf
    buffer_load_dwordx4 v[68:71], v11, s[32:35], 0 offen offset:0
    buffer_load_dwordx4 v[76:79], v11, s[32:35], 0 offen offset:256
    v_add_u32_dpp v11, v32, v7 row_newbcast:4 row_mask:0xf bank_mask:0xf
    buffer_load_dwordx4 v[80:83], v11, s[32:35], 0 offen offset:0
    buffer_load_dwordx4 v[88:91], v11, s[32:35], 0 offen offset:256
    v_add_u32_dpp v11, v32, v7 row_newbcast:5 row_mask:0xf bank_mask:0xf
    buffer_load_dwordx4 v[84:87], v11, s[32:35], 0 offen offset:0
    buffer_load_dwordx4 v[92:95], v11, s[32:35], 0 offen offset:256
    s_mov_b32 s57, 0
    s_sub_u32 s64, s14, 18
    s_lshr_b32 s65, s64, 4
    s_bitset1_b32 s53, s65
    s_and_b32 s64, s64, 14
    s_lshl4_add_u32 s57, s57, s64
    s_and_b32 s65, s24, 7
    s_lshl_b32 s65, s65, 5
    s_lshl_b32 s19, s24, 10
    s_or_b32 s19, s19, s65
    s_sub_u32 s64, s13, 18
    s_lshr_b32 s65, s64, 4
    s_bitset1_b32 s53, s65
    s_and_b32 s64, s64, 14
    s_lshl4_add_u32 s57, s57, s64
    s_and_b32 s65, s23, 7
    s_lshl_b32 s65, s65, 5
    s_lshl_b32 s18, s23, 10
    s_or_b32 s18, s18, s65
    s_sub_u32 s64, s12, 18
    s_lshr_b32 s65, s64, 4
    s_bitset1_b32 s53, s65
    s_and_b32 s64, s64, 14
    s_lshl4_add_u32 s57, s57, s64
    s_and_b32 s65, s22, 7
    s_lshl_b32 s65, s65, 5
    s_lshl_b32 s17, s22, 10
    s_or_b32 s17, s17, s65
    s_sub_u32 s64, s11, 18
    s_lshr_b32 s65, s64, 4
    s_bitset1_b32 s53, s65
    s_and_b32 s64, s64, 14
    s_lshl4_add_u32 s57, s57, s64
    s_and_b32 s65, s21, 7
    s_lshl_b32 s65, s65, 5
    s_lshl_b32 s16, s21, 10
    s_or_b32 s16, s16, s65
    s_sub_u32 s64, s10, 18
    s_lshr_b32 s65, s64, 4
    s_bitset1_b32 s53, s65
    s_and_b32 s64, s64, 14
    s_lshl4_add_u32 s57, s57, s64
    s_and_b32 s65, s20, 7
    s_lshl_b32 s65, s65, 5
    s_lshl_b32 s15, s20, 10
    s_or_b32 s15, s15, s65
    s_sub_u32 s64, s50, 5
    s_lshl_b32 s56, 1, s64
    s_or_b32 s52, s56, s53
    v_and_b32 v46, 1, v3
    v_lshl_add_u32 v46, v4, 1, v46
    v_and_b32 v46, 3, v46
    v_and_b32 v47, 14, v3
    v_lshl_add_u32 v46, v46, 4, v47
    v_lshrrev_b32 v47, 1, v4
    v_add_lshl_u32 v46, v46, v47, 2
    v_lshrrev_b32 v44, 1, v4
    v_mul_u32_u24 v44, 528, v44
    v_xor_b32 v44, v44, v7
    v_and_b32 v45, 1, v4
    v_lshl_or_b32 v2, v45, 3, v44
    v_xor_b32 v144, s15, v7
    v_xor_b32 v146, s16, v7
    v_xor_b32 v148, s19, v7
    v_xor_b32 v145, 528, v144
    v_xor_b32 v147, 528, v146
    v_xor_b32 v149, 528, v148
    s_mul_i32 s64, s1, 80
    s_add_u32 s64, s64, 62464
    v_and_b32 v45, 2, v4
    v_add_u32 v0, s64, v45
    s_getpc_b64 s[72:73]
L_anc:
    v_lshlrev_b32 v4, 2, v4
    s_mov_b32 s62, L_fp1-L_anc
    s_mov_b32 s63, L_fp1-L_fp0
    s_mov_b32 s70, L_dr1-L_anc
    s_mov_b32 s71, L_dr1-L_dr0
    s_mov_b32 s26, 0
    s_mov_b32 s49, 0
    v_mov_b32 v1, 0
    s_lshl_b32 s64, s31, 2
    v_mov_b32 v10, s64
    v_and_b32 v9, 8, v3
    v_lshlrev_b32 v9, 1, v9
    s_mov_b32 s66, 0x22222222
    s_mov_b32 s67, 0x22222222
    s_mov_b32 s68, 0x44444444
    s_mov_b32 s69, 0x44444444
    v_mov_b64 v[150:151], 0
    v_mov_b64 v[152:153], 0
    v_mov_b64 v[154:155], 0
    v_mov_b64 v[156:157], 0
    v_mov_b64 v[158:159], 0
    v_mov_b64 v[16:17], 0
    v_mov_b64 v[18:19], 0
    v_mov_b64 v[20:21], 0
    v_mov_b64 v[22:23], 0
    s_waitcnt lgkmcnt(0)
    v_lshlrev_b32 v33, v40, v33
    ds_bpermute_b32 v33, v46, v33
    v_lshlrev_b32 v35, v41, v35
    ds_bpermute_b32 v35, v46, v35
    v_lshlrev_b32 v37, v42, v37
    ds_bpermute_b32 v37, v46, v37
    v_lshlrev_b32 v39, v43, v39
    ds_bpermute_b32 v39, v46, v39
    s_waitcnt vmcnt(12) lgkmcnt(0)
    s_barrier
    ds_read_b128 v[160:163], v144 offset:21504
    ds_read_b128 v[164:167], v144 offset:21760
    ds_read_b128 v[168:171], v145 offset:21504
    ds_read_b128 v[172:175], v145 offset:21760
    s_waitcnt lgkmcnt(2)
    v_dot2c_f32_bf16 v150, v176, v160
    v_dot2c_f32_bf16 v150, v177, v161
    v_dot2c_f32_bf16 v150, v178, v162
    v_dot2c_f32_bf16 v150, v179, v163
    v_dot2c_f32_bf16 v150, v180, v164
    v_dot2c_f32_bf16 v150, v181, v165
    v_dot2c_f32_bf16 v150, v182, v166
    v_dot2c_f32_bf16 v150, v183, v167
    ds_read_b128 v[160:163], v146 offset:21504
    ds_read_b128 v[164:167], v146 offset:21760
    s_waitcnt lgkmcnt(2)
    v_dot2c_f32_bf16 v151, v184, v168
    v_dot2c_f32_bf16 v151, v185, v169
    v_dot2c_f32_bf16 v151, v186, v170
    v_dot2c_f32_bf16 v151, v187, v171
    v_dot2c_f32_bf16 v151, v188, v172
    v_dot2c_f32_bf16 v151, v189, v173
    v_dot2c_f32_bf16 v151, v190, v174
    v_dot2c_f32_bf16 v151, v191, v175
    ds_read_b128 v[168:171], v147 offset:21504
    ds_read_b128 v[172:175], v147 offset:21760
    s_waitcnt lgkmcnt(2)
    v_dot2c_f32_bf16 v152, v192, v160
    v_dot2c_f32_bf16 v152, v193, v161
    v_dot2c_f32_bf16 v152, v194, v162
    v_dot2c_f32_bf16 v152, v195, v163
    v_dot2c_f32_bf16 v152, v196, v164
    v_dot2c_f32_bf16 v152, v197, v165
    v_dot2c_f32_bf16 v152, v198, v166
    v_dot2c_f32_bf16 v152, v199, v167
    v_add_f32_dpp v150, v150, v150 row_ror:8 row_mask:0xf bank_mask:0x3
    v_add_f32_dpp v150, v151, v151 row_ror:8 row_mask:0xf bank_mask:0xc
    ds_read_b128 v[160:163], v144 offset:29696
    ds_read_b128 v[164:167], v144 offset:29952
    s_waitcnt lgkmcnt(2)
    v_dot2c_f32_bf16 v153, v200, v168
    v_dot2c_f32_bf16 v153, v201, v169
    v_dot2c_f32_bf16 v153, v202, v170
    v_dot2c_f32_bf16 v153, v203, v171
    v_dot2c_f32_bf16 v153, v204, v172
    v_dot2c_f32_bf16 v153, v205, v173
    v_dot2c_f32_bf16 v153, v206, v174
    v_dot2c_f32_bf16 v153, v207, v175
    ds_read_b128 v[168:171], v145 offset:29696
    ds_read_b128 v[172:175], v145 offset:29952
    s_waitcnt lgkmcnt(2)
    v_dot2c_f32_bf16 v154, v208, v160
    v_dot2c_f32_bf16 v154, v209, v161
    v_dot2c_f32_bf16 v154, v210, v162
    v_dot2c_f32_bf16 v154, v211, v163
    v_dot2c_f32_bf16 v154, v212, v164
    v_dot2c_f32_bf16 v154, v213, v165
    v_dot2c_f32_bf16 v154, v214, v166
    v_dot2c_f32_bf16 v154, v215, v167
    v_add_f32_dpp v152, v152, v152 row_ror:8 row_mask:0xf bank_mask:0x3
    v_add_f32_dpp v152, v153, v153 row_ror:8 row_mask:0xf bank_mask:0xc
    v_add_u32_dpp v11, v32, v7 row_newbcast:6 row_mask:0xf bank_mask:0xf
    buffer_load_dwordx4 v[96:99], v11, s[32:35], 0 offen offset:0
    buffer_load_dwordx4 v[104:107], v11, s[32:35], 0 offen offset:256
    ds_read_b128 v[160:163], v146 offset:29696
    ds_read_b128 v[164:167], v146 offset:29952
    s_waitcnt lgkmcnt(2)
    v_dot2c_f32_bf16 v155, v216, v168
    v_dot2c_f32_bf16 v155, v217, v169
    v_dot2c_f32_bf16 v155, v218, v170
    v_dot2c_f32_bf16 v155, v219, v171
    v_dot2c_f32_bf16 v155, v220, v172
    v_dot2c_f32_bf16 v155, v221, v173
    v_dot2c_f32_bf16 v155, v222, v174
    v_dot2c_f32_bf16 v155, v223, v175
    v_add_f32_dpp v150, v150, v150 row_half_mirror row_mask:0xf bank_mask:0x5
    v_add_f32_dpp v150, v152, v152 row_half_mirror row_mask:0xf bank_mask:0xa
    v_add_u32_dpp v11, v32, v7 row_newbcast:7 row_mask:0xf bank_mask:0xf
    buffer_load_dwordx4 v[100:103], v11, s[32:35], 0 offen offset:0
    buffer_load_dwordx4 v[108:111], v11, s[32:35], 0 offen offset:256
    ds_read_b128 v[168:171], v147 offset:29696
    ds_read_b128 v[172:175], v147 offset:29952
    s_waitcnt lgkmcnt(2)
    v_dot2c_f32_bf16 v156, v224, v160
    v_dot2c_f32_bf16 v156, v225, v161
    v_dot2c_f32_bf16 v156, v226, v162
    v_dot2c_f32_bf16 v156, v227, v163
    v_dot2c_f32_bf16 v156, v228, v164
    v_dot2c_f32_bf16 v156, v229, v165
    v_dot2c_f32_bf16 v156, v230, v166
    v_dot2c_f32_bf16 v156, v231, v167
    v_add_f32_dpp v154, v154, v154 row_ror:8 row_mask:0xf bank_mask:0x3
    v_add_f32_dpp v154, v155, v155 row_ror:8 row_mask:0xf bank_mask:0xc
    v_add_u32_dpp v11, v32, v7 row_newbcast:8 row_mask:0xf bank_mask:0xf
    buffer_load_dwordx4 v[112:115], v11, s[32:35], 0 offen offset:0
    buffer_load_dwordx4 v[120:123], v11, s[32:35], 0 offen offset:256
    ds_read_b128 v[160:163], v148 offset:21504
    ds_read_b128 v[164:167], v148 offset:21760
    s_waitcnt lgkmcnt(2)
    v_dot2c_f32_bf16 v157, v232, v168
    v_dot2c_f32_bf16 v157, v233, v169
    v_dot2c_f32_bf16 v157, v234, v170
    v_dot2c_f32_bf16 v157, v235, v171
    v_dot2c_f32_bf16 v157, v236, v172
    v_dot2c_f32_bf16 v157, v237, v173
    v_dot2c_f32_bf16 v157, v238, v174
    v_dot2c_f32_bf16 v157, v239, v175
    v_add_u32_dpp v11, v32, v7 row_newbcast:9 row_mask:0xf bank_mask:0xf
    buffer_load_dwordx4 v[116:119], v11, s[32:35], 0 offen offset:0
    buffer_load_dwordx4 v[124:127], v11, s[32:35], 0 offen offset:256
    ds_read_b128 v[168:171], v149 offset:21504
    ds_read_b128 v[172:175], v149 offset:21760
    s_waitcnt lgkmcnt(2)
    v_dot2c_f32_bf16 v158, v240, v160
    v_dot2c_f32_bf16 v158, v241, v161
    v_dot2c_f32_bf16 v158, v242, v162
    v_dot2c_f32_bf16 v158, v243, v163
    v_dot2c_f32_bf16 v158, v244, v164
    v_dot2c_f32_bf16 v158, v245, v165
    v_dot2c_f32_bf16 v158, v246, v166
    v_dot2c_f32_bf16 v158, v247, v167
    v_add_f32_dpp v156, v156, v156 row_ror:8 row_mask:0xf bank_mask:0x3
    v_add_f32_dpp v156, v157, v157 row_ror:8 row_mask:0xf bank_mask:0xc
    v_add_u32_dpp v11, v32, v7 row_newbcast:10 row_mask:0xf bank_mask:0xf
    buffer_load_dwordx4 v[128:131], v11, s[32:35], 0 offen offset:0
    buffer_load_dwordx4 v[136:139], v11, s[32:35], 0 offen offset:256
    s_waitcnt lgkmcnt(0)
    v_dot2c_f32_bf16 v159, v248, v168
    v_dot2c_f32_bf16 v159, v249, v169
    v_dot2c_f32_bf16 v159, v250, v170
    v_dot2c_f32_bf16 v159, v251, v171
    v_dot2c_f32_bf16 v159, v252, v172
    v_dot2c_f32_bf16 v159, v253, v173
    v_dot2c_f32_bf16 v159, v254, v174
    v_dot2c_f32_bf16 v159, v255, v175
    v_add_f32_dpp v154, v154, v154 row_half_mirror row_mask:0xf bank_mask:0x5
    v_add_f32_dpp v154, v156, v156 row_half_mirror row_mask:0xf bank_mask:0xa
    v_add_u32_dpp v11, v32, v7 row_newbcast:11 row_mask:0xf bank_mask:0xf
    buffer_load_dwordx4 v[132:135], v11, s[32:35], 0 offen offset:0
    buffer_load_dwordx4 v[140:143], v11, s[32:35], 0 offen offset:256
    v_add_f32_dpp v150, v150, v150 quad_perm:[1,0,3,2] row_mask:0xf bank_mask:0xf
    s_nop 0
    v_add_f32_dpp v158, v158, v158 row_ror:8 row_mask:0xf bank_mask:0x3
    v_add_f32_dpp v158, v159, v159 row_ror:8 row_mask:0xf bank_mask:0xc
    v_add_f32_dpp v154, v154, v154 quad_perm:[1,0,3,2] row_mask:0xf bank_mask:0xf
    v_add_f32_dpp v150, v150, v150 quad_perm:[2,3,0,1] row_mask:0xf bank_mask:0xf
    v_add_f32_dpp v158, v158, v158 row_half_mirror row_mask:0xf bank_mask:0x5
    v_add_f32_dpp v154, v154, v154 quad_perm:[2,3,0,1] row_mask:0xf bank_mask:0xf
    s_nop 0
    v_add_f32_dpp v158, v158, v158 quad_perm:[1,0,3,2] row_mask:0xf bank_mask:0xf
    v_cndmask_b32 v150, v150, v154, s[66:67]
    s_nop 0
    v_add_f32_dpp v158, v158, v158 quad_perm:[2,3,0,1] row_mask:0xf bank_mask:0xf
    v_cndmask_b32 v150, v150, v158, s[68:69]
    v_mul_f32 v150, 0x3db8aa3b, v150
    v_exp_f32 v150, v150
    s_nop 0
    v_mov_b32 v44, v150
    v_mov_b32 v45, v150
    s_nop 1
    v_permlane32_swap_b32 v44, v45
    v_add_f32 v44, v44, v45
    v_mov_b32 v45, v44
    s_nop 1
    v_permlane16_swap_b32 v44, v45
    v_add_f32 v44, v44, v45
    v_add_f32 v44, 0x3089705f, v44
    v_rcp_f32 v44, v44
    s_nop 0
    v_mul_f32 v150, v150, v44
    v_cvt_pk_bf16_f32 v150, v150, 0
    v_lshlrev_b32 v8, v9, v150
    s_nop 1
    v_and_b32_dpp v24, v8, v12 row_newbcast:0 row_mask:0xf bank_mask:0xf
    v_and_b32_dpp v25, v8, v13 row_newbcast:0 row_mask:0xf bank_mask:0xf
    v_mov_b64 v[40:41], 0
    v_mov_b64 v[42:43], 0
    v_mov_b64 v[44:45], 0
    v_mov_b64 v[46:47], 0
    v_smfmac_f32_16x16x32_bf16 v[40:43], v[24:25], v[176:179], v14
    v_and_b32_dpp v28, v8, v12 row_newbcast:8 row_mask:0xf bank_mask:0xf
    v_and_b32_dpp v29, v8, v13 row_newbcast:8 row_mask:0xf bank_mask:0xf
    v_smfmac_f32_16x16x32_bf16 v[44:47], v[24:25], v[180:183], v14
    v_add_u32_dpp v11, v32, v7 row_newbcast:12 row_mask:0xf bank_mask:0xf
    buffer_load_dwordx4 v[144:147], v11, s[32:35], 0 offen offset:0
    buffer_load_dwordx4 v[152:155], v11, s[32:35], 0 offen offset:256
    v_smfmac_f32_16x16x32_bf16 v[40:43], v[28:29], v[184:187], v14
    v_and_b32_dpp v24, v8, v12 row_newbcast:4 row_mask:0xf bank_mask:0xf
    v_and_b32_dpp v25, v8, v13 row_newbcast:4 row_mask:0xf bank_mask:0xf
    v_smfmac_f32_16x16x32_bf16 v[44:47], v[28:29], v[188:191], v14
    s_nop 0
    v_smfmac_f32_16x16x32_bf16 v[16:19], v[24:25], v[192:195], v14
    v_and_b32_dpp v28, v8, v12 row_newbcast:12 row_mask:0xf bank_mask:0xf
    v_and_b32_dpp v29, v8, v13 row_newbcast:12 row_mask:0xf bank_mask:0xf
    v_smfmac_f32_16x16x32_bf16 v[20:23], v[24:25], v[196:199], v14
    v_add_u32_dpp v11, v32, v7 row_newbcast:13 row_mask:0xf bank_mask:0xf
    buffer_load_dwordx4 v[148:151], v11, s[32:35], 0 offen offset:0
    buffer_load_dwordx4 v[156:159], v11, s[32:35], 0 offen offset:256
    v_smfmac_f32_16x16x32_bf16 v[16:19], v[28:29], v[200:203], v14
    v_and_b32_dpp v24, v8, v12 row_newbcast:1 row_mask:0xf bank_mask:0xf
    v_and_b32_dpp v25, v8, v13 row_newbcast:1 row_mask:0xf bank_mask:0xf
    v_smfmac_f32_16x16x32_bf16 v[20:23], v[28:29], v[204:207], v14
    v_xor_b32 v178, s15, v2
    s_lshl_b32 s64, s20, 2
    v_add_u32 v9, s64, v0
    v_mov_b32 v179, 0
    v_cvt_pk_bf16_f32 v30, v40, v41
    v_cvt_pk_bf16_f32 v31, v42, v43
    ds_write_b64 v178, v[30:31] offset:1024
    v_cvt_pk_bf16_f32 v30, v44, v45
    v_cvt_pk_bf16_f32 v31, v46, v47
    ds_write_b64 v178, v[30:31] offset:1280
    ds_read_u16_d16_hi v179, v9
    v_mov_b64 v[40:41], 0
    v_mov_b64 v[42:43], 0
    v_mov_b64 v[44:45], 0
    v_mov_b64 v[46:47], 0
    s_nop 0
    v_smfmac_f32_16x16x32_bf16 v[40:43], v[24:25], v[208:211], v14
    v_and_b32_dpp v28, v8, v12 row_newbcast:9 row_mask:0xf bank_mask:0xf
    v_and_b32_dpp v29, v8, v13 row_newbcast:9 row_mask:0xf bank_mask:0xf
    v_smfmac_f32_16x16x32_bf16 v[44:47], v[24:25], v[212:215], v14
    v_add_u32_dpp v11, v32, v7 row_newbcast:14 row_mask:0xf bank_mask:0xf
    buffer_load_dwordx4 v[160:163], v11, s[32:35], 0 offen offset:0
    buffer_load_dwordx4 v[168:171], v11, s[32:35], 0 offen offset:256
    v_smfmac_f32_16x16x32_bf16 v[40:43], v[28:29], v[216:219], v14
    v_and_b32_dpp v24, v8, v12 row_newbcast:5 row_mask:0xf bank_mask:0xf
    v_and_b32_dpp v25, v8, v13 row_newbcast:5 row_mask:0xf bank_mask:0xf
    v_smfmac_f32_16x16x32_bf16 v[44:47], v[28:29], v[220:223], v14
    v_xor_b32 v180, s16, v2
    s_lshl_b32 s64, s21, 2
    v_add_u32 v9, s64, v0
    v_mov_b32 v181, 0
    v_cvt_pk_bf16_f32 v30, v16, v17
    v_cvt_pk_bf16_f32 v31, v18, v19
    ds_write_b64 v180, v[30:31] offset:1024
    v_cvt_pk_bf16_f32 v30, v20, v21
    v_cvt_pk_bf16_f32 v31, v22, v23
    ds_write_b64 v180, v[30:31] offset:1280
    ds_read_u16_d16_hi v181, v9
    v_mov_b64 v[16:17], 0
    v_mov_b64 v[18:19], 0
    v_mov_b64 v[20:21], 0
    v_mov_b64 v[22:23], 0
    s_nop 0
    v_smfmac_f32_16x16x32_bf16 v[16:19], v[24:25], v[224:227], v14
    v_and_b32_dpp v28, v8, v12 row_newbcast:13 row_mask:0xf bank_mask:0xf
    v_and_b32_dpp v29, v8, v13 row_newbcast:13 row_mask:0xf bank_mask:0xf
    v_smfmac_f32_16x16x32_bf16 v[20:23], v[24:25], v[228:231], v14
    v_add_u32_dpp v11, v32, v7 row_newbcast:15 row_mask:0xf bank_mask:0xf
    buffer_load_dwordx4 v[164:167], v11, s[32:35], 0 offen offset:0
    buffer_load_dwordx4 v[172:175], v11, s[32:35], 0 offen offset:256
    v_smfmac_f32_16x16x32_bf16 v[16:19], v[28:29], v[232:235], v14
    v_and_b32_dpp v24, v8, v12 row_newbcast:2 row_mask:0xf bank_mask:0xf
    v_and_b32_dpp v25, v8, v13 row_newbcast:2 row_mask:0xf bank_mask:0xf
    v_smfmac_f32_16x16x32_bf16 v[20:23], v[28:29], v[236:239], v14
    v_xor_b32 v182, s17, v2
    s_lshl_b32 s64, s22, 2
    v_add_u32 v9, s64, v0
    v_mov_b32 v183, 0
    v_cvt_pk_bf16_f32 v30, v40, v41
    v_cvt_pk_bf16_f32 v31, v42, v43
    ds_write_b64 v182, v[30:31] offset:1024
    v_cvt_pk_bf16_f32 v30, v44, v45
    v_cvt_pk_bf16_f32 v31, v46, v47
    ds_write_b64 v182, v[30:31] offset:1280
    ds_read_u16_d16_hi v183, v9
    v_mov_b64 v[40:41], 0
    v_mov_b64 v[42:43], 0
    v_mov_b64 v[44:45], 0
    v_mov_b64 v[46:47], 0
    s_nop 0
    v_smfmac_f32_16x16x32_bf16 v[40:43], v[24:25], v[240:243], v14
    v_and_b32_dpp v28, v8, v12 row_newbcast:10 row_mask:0xf bank_mask:0xf
    v_and_b32_dpp v29, v8, v13 row_newbcast:10 row_mask:0xf bank_mask:0xf
    v_smfmac_f32_16x16x32_bf16 v[44:47], v[24:25], v[244:247], v14
    s_nop 0
    v_smfmac_f32_16x16x32_bf16 v[40:43], v[28:29], v[248:251], v14
    v_and_b32_dpp v24, v33, v12 row_newbcast:0 row_mask:0xf bank_mask:0xf
    v_and_b32_dpp v25, v33, v13 row_newbcast:0 row_mask:0xf bank_mask:0xf
    v_and_b32_dpp v26, v33, v12 row_newbcast:1 row_mask:0xf bank_mask:0xf
    v_and_b32_dpp v27, v33, v13 row_newbcast:1 row_mask:0xf bank_mask:0xf
    v_smfmac_f32_16x16x32_bf16 v[44:47], v[28:29], v[252:255], v14
    v_xor_b32 v184, s18, v2
    s_lshl_b32 s64, s23, 2
    v_add_u32 v9, s64, v0
    v_mov_b32 v185, 0
    v_cvt_pk_bf16_f32 v30, v16, v17
    v_cvt_pk_bf16_f32 v31, v18, v19
    ds_write_b64 v184, v[30:31] offset:1024
    v_cvt_pk_bf16_f32 v30, v20, v21
    v_cvt_pk_bf16_f32 v31, v22, v23
    ds_write_b64 v184, v[30:31] offset:1280
    ds_read_u16_d16_hi v185, v9
    v_mov_b64 v[16:17], 0
    v_mov_b64 v[18:19], 0
    v_mov_b64 v[20:21], 0
    v_mov_b64 v[22:23], 0
    s_nop 0
    v_xor_b32 v176, s19, v2
    s_lshl_b32 s64, s24, 2
    v_add_u32 v9, s64, v0
    v_mov_b32 v177, 0
    v_cvt_pk_bf16_f32 v30, v40, v41
    v_cvt_pk_bf16_f32 v31, v42, v43
    ds_write_b64 v176, v[30:31] offset:1024
    v_cvt_pk_bf16_f32 v30, v44, v45
    v_cvt_pk_bf16_f32 v31, v46, v47
    ds_write_b64 v176, v[30:31] offset:1280
    ds_read_u16_d16_hi v177, v9
    s_waitcnt lgkmcnt(0)
    s_barrier
    s_cmp_lg_u32 s25, 0
    s_cbranch_scc1 L_slow
L_fp0:
    s_bitcmp1_b32 s52, 0
    s_waitcnt vmcnt(28)
    v_smfmac_f32_16x16x64_bf16 v[16:19], v[24:27], v[48:55], v14
    v_and_b32_dpp v28, v33, v12 row_newbcast:2 row_mask:0xf bank_mask:0xf
    v_and_b32_dpp v29, v33, v13 row_newbcast:2 row_mask:0xf bank_mask:0xf
    v_smfmac_f32_16x16x64_bf16 v[20:23], v[24:27], v[56:63], v14
    v_and_b32_dpp v30, v33, v12 row_newbcast:3 row_mask:0xf bank_mask:0xf
    v_and_b32_dpp v31, v33, v13 row_newbcast:3 row_mask:0xf bank_mask:0xf
    v_add_u32_dpp v11, v34, v7 row_newbcast:0 row_mask:0xf bank_mask:0xf
    buffer_load_dwordx4 v[48:51], v11, s[32:35], 0 offen offset:0
    buffer_load_dwordx4 v[56:59], v11, s[32:35], 0 offen offset:256
    s_cbranch_scc1 L_ev0
L_fp1:
    s_bitcmp1_b32 s52, 1
    s_waitcnt vmcnt(26)
    v_smfmac_f32_16x16x64_bf16 v[16:19], v[28:31], v[64:71], v14
    v_and_b32_dpp v24, v33, v12 row_newbcast:4 row_mask:0xf bank_mask:0xf
    v_and_b32_dpp v25, v33, v13 row_newbcast:4 row_mask:0xf bank_mask:0xf
    v_smfmac_f32_16x16x64_bf16 v[20:23], v[28:31], v[72:79], v14
    v_and_b32_dpp v26, v33, v12 row_newbcast:5 row_mask:0xf bank_mask:0xf
    v_and_b32_dpp v27, v33, v13 row_newbcast:5 row_mask:0xf bank_mask:0xf
    v_add_u32_dpp v11, v34, v7 row_newbcast:1 row_mask:0xf bank_mask:0xf
    buffer_load_dwordx4 v[52:55], v11, s[32:35], 0 offen offset:0
    buffer_load_dwordx4 v[60:63], v11, s[32:35], 0 offen offset:256
    s_cbranch_scc1 L_ev1
L_fp2:
    s_bitcmp1_b32 s52, 2
    s_waitcnt vmcnt(24)
    v_smfmac_f32_16x16x64_bf16 v[16:19], v[24:27], v[80:87], v14
    v_and_b32_dpp v28, v33, v12 row_newbcast:6 row_mask:0xf bank_mask:0xf
    v_and_b32_dpp v29, v33, v13 row_newbcast:6 row_mask:0xf bank_mask:0xf
    v_smfmac_f32_16x16x64_bf16 v[20:23], v[24:27], v[88:95], v14
    v_and_b32_dpp v30, v33, v12 row_newbcast:7 row_mask:0xf bank_mask:0xf
    v_and_b32_dpp v31, v33, v13 row_newbcast:7 row_mask:0xf bank_mask:0xf
    v_add_u32_dpp v11, v34, v7 row_newbcast:2 row_mask:0xf bank_mask:0xf
    buffer_load_dwordx4 v[64:67], v11, s[32:35], 0 offen offset:0
    buffer_load_dwordx4 v[72:75], v11, s[32:35], 0 offen offset:256
    s_cbranch_scc1 L_ev2
L_fp3:
    s_bitcmp1_b32 s52, 3
    s_waitcnt vmcnt(22)
    v_smfmac_f32_16x16x64_bf16 v[16:19], v[28:31], v[96:103], v14
    v_and_b32_dpp v24, v33, v12 row_newbcast:8 row_mask:0xf bank_mask:0xf
    v_and_b32_dpp v25, v33, v13 row_newbcast:8 row_mask:0xf bank_mask:0xf
    v_smfmac_f32_16x16x64_bf16 v[20:23], v[28:31], v[104:111], v14
    v_and_b32_dpp v26, v33, v12 row_newbcast:9 row_mask:0xf bank_mask:0xf
    v_and_b32_dpp v27, v33, v13 row_newbcast:9 row_mask:0xf bank_mask:0xf
    v_add_u32_dpp v11, v34, v7 row_newbcast:3 row_mask:0xf bank_mask:0xf
    buffer_load_dwordx4 v[68:71], v11, s[32:35], 0 offen offset:0
    buffer_load_dwordx4 v[76:79], v11, s[32:35], 0 offen offset:256
    s_cbranch_scc1 L_ev3
L_fp4:
    s_bitcmp1_b32 s52, 4
    s_waitcnt vmcnt(20)
    v_smfmac_f32_16x16x64_bf16 v[16:19], v[24:27], v[112:119], v14
    v_and_b32_dpp v28, v33, v12 row_newbcast:10 row_mask:0xf bank_mask:0xf
    v_and_b32_dpp v29, v33, v13 row_newbcast:10 row_mask:0xf bank_mask:0xf
    v_smfmac_f32_16x16x64_bf16 v[20:23], v[24:27], v[120:127], v14
    v_and_b32_dpp v30, v33, v12 row_newbcast:11 row_mask:0xf bank_mask:0xf
    v_and_b32_dpp v31, v33, v13 row_newbcast:11 row_mask:0xf bank_mask:0xf
    v_add_u32_dpp v11, v34, v7 row_newbcast:4 row_mask:0xf bank_mask:0xf
    buffer_load_dwordx4 v[80:83], v11, s[32:35], 0 offen offset:0
    buffer_load_dwordx4 v[88:91], v11, s[32:35], 0 offen offset:256
    s_cbranch_scc1 L_ev4
L_fp5:
    s_bitcmp1_b32 s52, 5
    s_waitcnt vmcnt(18)
    v_smfmac_f32_16x16x64_bf16 v[16:19], v[28:31], v[128:135], v14
    v_and_b32_dpp v24, v33, v12 row_newbcast:12 row_mask:0xf bank_mask:0xf
    v_and_b32_dpp v25, v33, v13 row_newbcast:12 row_mask:0xf bank_mask:0xf
    v_smfmac_f32_16x16x64_bf16 v[20:23], v[28:31], v[136:143], v14
    v_and_b32_dpp v26, v33, v12 row_newbcast:13 row_mask:0xf bank_mask:0xf
    v_and_b32_dpp v27, v33, v13 row_newbcast:13 row_mask:0xf bank_mask:0xf
    v_add_u32_dpp v11, v34, v7 row_newbcast:5 row_mask:0xf bank_mask:0xf
    buffer_load_dwordx4 v[84:87], v11, s[32:35], 0 offen offset:0
    buffer_load_dwordx4 v[92:95], v11, s[32:35], 0 offen offset:256
    s_cbranch_scc1 L_ev5
L_fp6:
    s_bitcmp1_b32 s52, 6
    s_waitcnt vmcnt(16)
    v_smfmac_f32_16x16x64_bf16 v[16:19], v[24:27], v[144:151], v14
    v_and_b32_dpp v28, v33, v12 row_newbcast:14 row_mask:0xf bank_mask:0xf
    v_and_b32_dpp v29, v33, v13 row_newbcast:14 row_mask:0xf bank_mask:0xf
    v_smfmac_f32_16x16x64_bf16 v[20:23], v[24:27], v[152:159], v14
    v_and_b32_dpp v30, v33, v12 row_newbcast:15 row_mask:0xf bank_mask:0xf
    v_and_b32_dpp v31, v33, v13 row_newbcast:15 row_mask:0xf bank_mask:0xf
    v_add_u32_dpp v11, v34, v7 row_newbcast:6 row_mask:0xf bank_mask:0xf
    buffer_load_dwordx4 v[96:99], v11, s[32:35], 0 offen offset:0
    buffer_load_dwordx4 v[104:107], v11, s[32:35], 0 offen offset:256
    s_cbranch_scc1 L_ev6
L_fp7:
    s_bitcmp1_b32 s52, 7
    s_waitcnt vmcnt(14)
    v_smfmac_f32_16x16x64_bf16 v[16:19], v[28:31], v[160:167], v14
    v_and_b32_dpp v24, v35, v12 row_newbcast:0 row_mask:0xf bank_mask:0xf
    v_and_b32_dpp v25, v35, v13 row_newbcast:0 row_mask:0xf bank_mask:0xf
    v_smfmac_f32_16x16x64_bf16 v[20:23], v[28:31], v[168:175], v14
    v_and_b32_dpp v26, v35, v12 row_newbcast:1 row_mask:0xf bank_mask:0xf
    v_and_b32_dpp v27, v35, v13 row_newbcast:1 row_mask:0xf bank_mask:0xf
    v_add_u32_dpp v11, v34, v7 row_newbcast:7 row_mask:0xf bank_mask:0xf
    buffer_load_dwordx4 v[100:103], v11, s[32:35], 0 offen offset:0
    buffer_load_dwordx4 v[108:111], v11, s[32:35], 0 offen offset:256
    s_cbranch_scc1 L_ev7
L_fp8:
    v_mov_b64 v[32:33], v[34:35]
    v_mov_b64 v[34:35], v[36:37]
    v_mov_b64 v[36:37], v[38:39]
    s_lshr_b32 s52, s52, 8
    s_lshr_b32 s53, s53, 8
    s_lshr_b32 s56, s56, 8
    s_mov_b32 s62, L_st1-L_anc
    s_mov_b32 s63, L_st1-L_st0
L_st0:
    s_bitcmp1_b32 s52, 0
    s_waitcnt vmcnt(12)
    v_smfmac_f32_16x16x64_bf16 v[16:19], v[24:27], v[48:55], v14
    v_and_b32_dpp v28, v33, v12 row_newbcast:2 row_mask:0xf bank_mask:0xf
    v_and_b32_dpp v29, v33, v13 row_newbcast:2 row_mask:0xf bank_mask:0xf
    v_smfmac_f32_16x16x64_bf16 v[20:23], v[24:27], v[56:63], v14
    v_and_b32_dpp v30, v33, v12 row_newbcast:3 row_mask:0xf bank_mask:0xf
    v_and_b32_dpp v31, v33, v13 row_newbcast:3 row_mask:0xf bank_mask:0xf
    v_add_u32_dpp v11, v32, v7 row_newbcast:8 row_mask:0xf bank_mask:0xf
    buffer_load_dwordx4 v[112:115], v11, s[32:35], 0 offen offset:0
    buffer_load_dwordx4 v[120:123], v11, s[32:35], 0 offen offset:256
    v_add_u32_dpp v11, v32, v7 row_newbcast:9 row_mask:0xf bank_mask:0xf
    buffer_load_dwordx4 v[116:119], v11, s[32:35], 0 offen offset:0
    buffer_load_dwordx4 v[124:127], v11, s[32:35], 0 offen offset:256
    s_cbranch_scc1 L_ev0
L_st1:
    s_bitcmp1_b32 s52, 1
    s_waitcnt vmcnt(12)
    v_smfmac_f32_16x16x64_bf16 v[16:19], v[28:31], v[64:71], v14
    v_and_b32_dpp v24, v33, v12 row_newbcast:4 row_mask:0xf bank_mask:0xf
    v_and_b32_dpp v25, v33, v13 row_newbcast:4 row_mask:0xf bank_mask:0xf
    v_smfmac_f32_16x16x64_bf16 v[20:23], v[28:31], v[72:79], v14
    v_and_b32_dpp v26, v33, v12 row_newbcast:5 row_mask:0xf bank_mask:0xf
    v_and_b32_dpp v27, v33, v13 row_newbcast:5 row_mask:0xf bank_mask:0xf
    v_add_u32_dpp v11, v32, v7 row_newbcast:10 row_mask:0xf bank_mask:0xf
    buffer_load_dwordx4 v[128:131], v11, s[32:35], 0 offen offset:0
    buffer_load_dwordx4 v[136:139], v11, s[32:35], 0 offen offset:256
    v_add_u32_dpp v11, v32, v7 row_newbcast:11 row_mask:0xf bank_mask:0xf
    buffer_load_dwordx4 v[132:135], v11, s[32:35], 0 offen offset:0
    buffer_load_dwordx4 v[140:143], v11, s[32:35], 0 offen offset:256
    s_cbranch_scc1 L_ev1
L_st2:
    s_bitcmp1_b32 s52, 2
    s_waitcnt vmcnt(12)
    v_smfmac_f32_16x16x64_bf16 v[16:19], v[24:27], v[80:87], v14
    v_and_b32_dpp v28, v33, v12 row_newbcast:6 row_mask:0xf bank_mask:0xf
    v_and_b32_dpp v29, v33, v13 row_newbcast:6 row_mask:0xf bank_mask:0xf
    v_smfmac_f32_16x16x64_bf16 v[20:23], v[24:27], v[88:95], v14
    v_and_b32_dpp v30, v33, v12 row_newbcast:7 row_mask:0xf bank_mask:0xf
    v_and_b32_dpp v31, v33, v13 row_newbcast:7 row_mask:0xf bank_mask:0xf
    v_add_u32_dpp v11, v32, v7 row_newbcast:12 row_mask:0xf bank_mask:0xf
    buffer_load_dwordx4 v[144:147], v11, s[32:35], 0 offen offset:0
    buffer_load_dwordx4 v[152:155], v11, s[32:35], 0 offen offset:256
    v_add_u32_dpp v11, v32, v7 row_newbcast:13 row_mask:0xf bank_mask:0xf
    buffer_load_dwordx4 v[148:151], v11, s[32:35], 0 offen offset:0
    buffer_load_dwordx4 v[156:159], v11, s[32:35], 0 offen offset:256
    s_cbranch_scc1 L_ev2
L_st3:
    s_bitcmp1_b32 s52, 3
    s_waitcnt vmcnt(12)
    v_smfmac_f32_16x16x64_bf16 v[16:19], v[28:31], v[96:103], v14
    v_and_b32_dpp v24, v33, v12 row_newbcast:8 row_mask:0xf bank_mask:0xf
    v_and_b32_dpp v25, v33, v13 row_newbcast:8 row_mask:0xf bank_mask:0xf
    v_smfmac_f32_16x16x64_bf16 v[20:23], v[28:31], v[104:111], v14
    v_and_b32_dpp v26, v33, v12 row_newbcast:9 row_mask:0xf bank_mask:0xf
    v_and_b32_dpp v27, v33, v13 row_newbcast:9 row_mask:0xf bank_mask:0xf
    v_add_u32_dpp v11, v32, v7 row_newbcast:14 row_mask:0xf bank_mask:0xf
    buffer_load_dwordx4 v[160:163], v11, s[32:35], 0 offen offset:0
    buffer_load_dwordx4 v[168:171], v11, s[32:35], 0 offen offset:256
    v_add_u32_dpp v11, v32, v7 row_newbcast:15 row_mask:0xf bank_mask:0xf
    buffer_load_dwordx4 v[164:167], v11, s[32:35], 0 offen offset:0
    buffer_load_dwordx4 v[172:175], v11, s[32:35], 0 offen offset:256
    s_cbranch_scc1 L_ev3
L_st4:
    s_bitcmp1_b32 s52, 4
    s_waitcnt vmcnt(12)
    v_smfmac_f32_16x16x64_bf16 v[16:19], v[24:27], v[112:119], v14
    v_and_b32_dpp v28, v33, v12 row_newbcast:10 row_mask:0xf bank_mask:0xf
    v_and_b32_dpp v29, v33, v13 row_newbcast:10 row_mask:0xf bank_mask:0xf
    v_smfmac_f32_16x16x64_bf16 v[20:23], v[24:27], v[120:127], v14
    v_and_b32_dpp v30, v33, v12 row_newbcast:11 row_mask:0xf bank_mask:0xf
    v_and_b32_dpp v31, v33, v13 row_newbcast:11 row_mask:0xf bank_mask:0xf
    v_add_u32_dpp v11, v34, v7 row_newbcast:0 row_mask:0xf bank_mask:0xf
    buffer_load_dwordx4 v[48:51], v11, s[32:35], 0 offen offset:0
    buffer_load_dwordx4 v[56:59], v11, s[32:35], 0 offen offset:256
    v_add_u32_dpp v11, v34, v7 row_newbcast:1 row_mask:0xf bank_mask:0xf
    buffer_load_dwordx4 v[52:55], v11, s[32:35], 0 offen offset:0
    buffer_load_dwordx4 v[60:63], v11, s[32:35], 0 offen offset:256
    s_cbranch_scc1 L_ev4
L_st5:
    s_bitcmp1_b32 s52, 5
    s_waitcnt vmcnt(12)
    v_smfmac_f32_16x16x64_bf16 v[16:19], v[28:31], v[128:135], v14
    v_and_b32_dpp v24, v33, v12 row_newbcast:12 row_mask:0xf bank_mask:0xf
    v_and_b32_dpp v25, v33, v13 row_newbcast:12 row_mask:0xf bank_mask:0xf
    v_smfmac_f32_16x16x64_bf16 v[20:23], v[28:31], v[136:143], v14
    v_and_b32_dpp v26, v33, v12 row_newbcast:13 row_mask:0xf bank_mask:0xf
    v_and_b32_dpp v27, v33, v13 row_newbcast:13 row_mask:0xf bank_mask:0xf
    v_add_u32_dpp v11, v34, v7 row_newbcast:2 row_mask:0xf bank_mask:0xf
    buffer_load_dwordx4 v[64:67], v11, s[32:35], 0 offen offset:0
    buffer_load_dwordx4 v[72:75], v11, s[32:35], 0 offen offset:256
    v_add_u32_dpp v11, v34, v7 row_newbcast:3 row_mask:0xf bank_mask:0xf
    buffer_load_dwordx4 v[68:71], v11, s[32:35], 0 offen offset:0
    buffer_load_dwordx4 v[76:79], v11, s[32:35], 0 offen offset:256
    s_cbranch_scc1 L_ev5
L_st6:
    s_bitcmp1_b32 s52, 6
    s_waitcnt vmcnt(12)
    v_smfmac_f32_16x16x64_bf16 v[16:19], v[24:27], v[144:151], v14
    v_and_b32_dpp v28, v33, v12 row_newbcast:14 row_mask:0xf bank_mask:0xf
    v_and_b32_dpp v29, v33, v13 row_newbcast:14 row_mask:0xf bank_mask:0xf
    v_smfmac_f32_16x16x64_bf16 v[20:23], v[24:27], v[152:159], v14
    v_and_b32_dpp v30, v33, v12 row_newbcast:15 row_mask:0xf bank_mask:0xf
    v_and_b32_dpp v31, v33, v13 row_newbcast:15 row_mask:0xf bank_mask:0xf
    v_add_u32_dpp v11, v34, v7 row_newbcast:4 row_mask:0xf bank_mask:0xf
    buffer_load_dwordx4 v[80:83], v11, s[32:35], 0 offen offset:0
    buffer_load_dwordx4 v[88:91], v11, s[32:35], 0 offen offset:256
    v_add_u32_dpp v11, v34, v7 row_newbcast:5 row_mask:0xf bank_mask:0xf
    buffer_load_dwordx4 v[84:87], v11, s[32:35], 0 offen offset:0
    buffer_load_dwordx4 v[92:95], v11, s[32:35], 0 offen offset:256
    s_cbranch_scc1 L_ev6
L_st7:
    s_bitcmp1_b32 s52, 7
    s_waitcnt vmcnt(12)
    v_smfmac_f32_16x16x64_bf16 v[16:19], v[28:31], v[160:167], v14
    v_and_b32_dpp v24, v35, v12 row_newbcast:0 row_mask:0xf bank_mask:0xf
    v_and_b32_dpp v25, v35, v13 row_newbcast:0 row_mask:0xf bank_mask:0xf
    v_smfmac_f32_16x16x64_bf16 v[20:23], v[28:31], v[168:175], v14
    v_and_b32_dpp v26, v35, v12 row_newbcast:1 row_mask:0xf bank_mask:0xf
    v_and_b32_dpp v27, v35, v13 row_newbcast:1 row_mask:0xf bank_mask:0xf
    v_add_u32_dpp v11, v34, v7 row_newbcast:6 row_mask:0xf bank_mask:0xf
    buffer_load_dwordx4 v[96:99], v11, s[32:35], 0 offen offset:0
    buffer_load_dwordx4 v[104:107], v11, s[32:35], 0 offen offset:256
    v_add_u32_dpp v11, v34, v7 row_newbcast:7 row_mask:0xf bank_mask:0xf
    buffer_load_dwordx4 v[100:103], v11, s[32:35], 0 offen offset:0
    buffer_load_dwordx4 v[108:111], v11, s[32:35], 0 offen offset:256
    s_cbranch_scc1 L_ev7
L_st8:
    v_mov_b64 v[32:33], v[34:35]
    v_mov_b64 v[34:35], v[36:37]
    v_mov_b64 v[36:37], v[38:39]
    s_lshr_b32 s52, s52, 8
    s_lshr_b32 s53, s53, 8
    s_lshr_b32 s56, s56, 8
    s_branch L_st0
L_pad8:
    s_setpc_b64 s[68:69]
L_dr0:
    s_add_u32 s49, s49, 1
    ds_write_b32 v10, v6 offset:48
    s_waitcnt vmcnt(12)
    v_smfmac_f32_16x16x64_bf16 v[16:19], v[24:27], v[48:55], v14
    v_and_b32_dpp v28, v33, v12 row_newbcast:2 row_mask:0xf bank_mask:0xf
    v_and_b32_dpp v29, v33, v13 row_newbcast:2 row_mask:0xf bank_mask:0xf
    v_smfmac_f32_16x16x64_bf16 v[20:23], v[24:27], v[56:63], v14
    v_and_b32_dpp v30, v33, v12 row_newbcast:3 row_mask:0xf bank_mask:0xf
    v_and_b32_dpp v31, v33, v13 row_newbcast:3 row_mask:0xf bank_mask:0xf
    s_cmp_eq_u32 s49, 1
    s_cbranch_scc1 L_dw0_1
    s_cmp_eq_u32 s49, 2
    s_cbranch_scc1 L_dw0_2
L_dw0_3:
    s_waitcnt vmcnt(0)
L_dw0_2:
    s_waitcnt vmcnt(4)
L_dw0_1:
    s_waitcnt vmcnt(8)
    s_bitcmp1_b32 s52, 0
    s_cbranch_scc1 L_ev0
L_dr1:
    s_add_u32 s49, s49, 1
    ds_write_b32 v10, v6 offset:48
    s_waitcnt vmcnt(12)
    v_smfmac_f32_16x16x64_bf16 v[16:19], v[28:31], v[64:71], v14
    v_and_b32_dpp v24, v33, v12 row_newbcast:4 row_mask:0xf bank_mask:0xf
    v_and_b32_dpp v25, v33, v13 row_newbcast:4 row_mask:0xf bank_mask:0xf
    v_smfmac_f32_16x16x64_bf16 v[20:23], v[28:31], v[72:79], v14
    v_and_b32_dpp v26, v33, v12 row_newbcast:5 row_mask:0xf bank_mask:0xf
    v_and_b32_dpp v27, v33, v13 row_newbcast:5 row_mask:0xf bank_mask:0xf
    s_cmp_eq_u32 s49, 1
    s_cbranch_scc1 L_dw1_1
    s_cmp_eq_u32 s49, 2
    s_cbranch_scc1 L_dw1_2
L_dw1_3:
    s_waitcnt vmcnt(0)
L_dw1_2:
    s_waitcnt vmcnt(4)
L_dw1_1:
    s_waitcnt vmcnt(8)
    s_bitcmp1_b32 s52, 1
    s_cbranch_scc1 L_ev1
L_dr2:
    s_add_u32 s49, s49, 1
    ds_write_b32 v10, v6 offset:48
    s_waitcnt vmcnt(12)
    v_smfmac_f32_16x16x64_bf16 v[16:19], v[24:27], v[80:87], v14
    v_and_b32_dpp v28, v33, v12 row_newbcast:6 row_mask:0xf bank_mask:0xf
    v_and_b32_dpp v29, v33, v13 row_newbcast:6 row_mask:0xf bank_mask:0xf
    v_smfmac_f32_16x16x64_bf16 v[20:23], v[24:27], v[88:95], v14
    v_and_b32_dpp v30, v33, v12 row_newbcast:7 row_mask:0xf bank_mask:0xf
    v_and_b32_dpp v31, v33, v13 row_newbcast:7 row_mask:0xf bank_mask:0xf
    s_cmp_eq_u32 s49, 1
    s_cbranch_scc1 L_dw2_1
    s_cmp_eq_u32 s49, 2
    s_cbranch_scc1 L_dw2_2
L_dw2_3:
    s_waitcnt vmcnt(0)
L_dw2_2:
    s_waitcnt vmcnt(4)
L_dw2_1:
    s_waitcnt vmcnt(8)
    s_bitcmp1_b32 s52, 2
    s_cbranch_scc1 L_ev2
L_dr3:
    s_add_u32 s49, s49, 1
    ds_write_b32 v10, v6 offset:48
    s_waitcnt vmcnt(12)
    v_smfmac_f32_16x16x64_bf16 v[16:19], v[28:31], v[96:103], v14
    v_and_b32_dpp v24, v33, v12 row_newbcast:8 row_mask:0xf bank_mask:0xf
    v_and_b32_dpp v25, v33, v13 row_newbcast:8 row_mask:0xf bank_mask:0xf
    v_smfmac_f32_16x16x64_bf16 v[20:23], v[28:31], v[104:111], v14
    v_and_b32_dpp v26, v33, v12 row_newbcast:9 row_mask:0xf bank_mask:0xf
    v_and_b32_dpp v27, v33, v13 row_newbcast:9 row_mask:0xf bank_mask:0xf
    s_cmp_eq_u32 s49, 1
    s_cbranch_scc1 L_dw3_1
    s_cmp_eq_u32 s49, 2
    s_cbranch_scc1 L_dw3_2
L_dw3_3:
    s_waitcnt vmcnt(0)
L_dw3_2:
    s_waitcnt vmcnt(4)
L_dw3_1:
    s_waitcnt vmcnt(8)
    s_bitcmp1_b32 s52, 3
    s_cbranch_scc1 L_ev3
L_dr4:
    s_add_u32 s49, s49, 1
    ds_write_b32 v10, v6 offset:48
    s_waitcnt vmcnt(12)
    v_smfmac_f32_16x16x64_bf16 v[16:19], v[24:27], v[112:119], v14
    v_and_b32_dpp v28, v33, v12 row_newbcast:10 row_mask:0xf bank_mask:0xf
    v_and_b32_dpp v29, v33, v13 row_newbcast:10 row_mask:0xf bank_mask:0xf
    v_smfmac_f32_16x16x64_bf16 v[20:23], v[24:27], v[120:127], v14
    v_and_b32_dpp v30, v33, v12 row_newbcast:11 row_mask:0xf bank_mask:0xf
    v_and_b32_dpp v31, v33, v13 row_newbcast:11 row_mask:0xf bank_mask:0xf
    s_cmp_eq_u32 s49, 1
    s_cbranch_scc1 L_dw4_1
    s_cmp_eq_u32 s49, 2
    s_cbranch_scc1 L_dw4_2
L_dw4_3:
    s_waitcnt vmcnt(0)
L_dw4_2:
    s_waitcnt vmcnt(4)
L_dw4_1:
    s_waitcnt vmcnt(8)
    s_bitcmp1_b32 s52, 4
    s_cbranch_scc1 L_ev4
L_dr5:
    s_add_u32 s49, s49, 1
    ds_write_b32 v10, v6 offset:48
    s_waitcnt vmcnt(12)
    v_smfmac_f32_16x16x64_bf16 v[16:19], v[28:31], v[128:135], v14
    v_and_b32_dpp v24, v33, v12 row_newbcast:12 row_mask:0xf bank_mask:0xf
    v_and_b32_dpp v25, v33, v13 row_newbcast:12 row_mask:0xf bank_mask:0xf
    v_smfmac_f32_16x16x64_bf16 v[20:23], v[28:31], v[136:143], v14
    v_and_b32_dpp v26, v33, v12 row_newbcast:13 row_mask:0xf bank_mask:0xf
    v_and_b32_dpp v27, v33, v13 row_newbcast:13 row_mask:0xf bank_mask:0xf
    s_cmp_eq_u32 s49, 1
    s_cbranch_scc1 L_dw5_1
    s_cmp_eq_u32 s49, 2
    s_cbranch_scc1 L_dw5_2
L_dw5_3:
    s_waitcnt vmcnt(0)
L_dw5_2:
    s_waitcnt vmcnt(4)
L_dw5_1:
    s_waitcnt vmcnt(8)
    s_bitcmp1_b32 s52, 5
    s_cbranch_scc1 L_ev5
L_dr6:
    s_add_u32 s49, s49, 1
    ds_write_b32 v10, v6 offset:48
    s_waitcnt vmcnt(12)
    v_smfmac_f32_16x16x64_bf16 v[16:19], v[24:27], v[144:151], v14
    v_and_b32_dpp v28, v33, v12 row_newbcast:14 row_mask:0xf bank_mask:0xf
    v_and_b32_dpp v29, v33, v13 row_newbcast:14 row_mask:0xf bank_mask:0xf
    v_smfmac_f32_16x16x64_bf16 v[20:23], v[24:27], v[152:159], v14
    v_and_b32_dpp v30, v33, v12 row_newbcast:15 row_mask:0xf bank_mask:0xf
    v_and_b32_dpp v31, v33, v13 row_newbcast:15 row_mask:0xf bank_mask:0xf
    s_cmp_eq_u32 s49, 1
    s_cbranch_scc1 L_dw6_1
    s_cmp_eq_u32 s49, 2
    s_cbranch_scc1 L_dw6_2
L_dw6_3:
    s_waitcnt vmcnt(0)
L_dw6_2:
    s_waitcnt vmcnt(4)
L_dw6_1:
    s_waitcnt vmcnt(8)
    s_bitcmp1_b32 s52, 6
    s_cbranch_scc1 L_ev6
L_dr7:
    s_add_u32 s49, s49, 1
    ds_write_b32 v10, v6 offset:48
    s_waitcnt vmcnt(12)
    v_smfmac_f32_16x16x64_bf16 v[16:19], v[28:31], v[160:167], v14
    v_and_b32_dpp v24, v35, v12 row_newbcast:0 row_mask:0xf bank_mask:0xf
    v_and_b32_dpp v25, v35, v13 row_newbcast:0 row_mask:0xf bank_mask:0xf
    v_smfmac_f32_16x16x64_bf16 v[20:23], v[28:31], v[168:175], v14
    v_and_b32_dpp v26, v35, v12 row_newbcast:1 row_mask:0xf bank_mask:0xf
    v_and_b32_dpp v27, v35, v13 row_newbcast:1 row_mask:0xf bank_mask:0xf
    s_cmp_eq_u32 s49, 1
    s_cbranch_scc1 L_dw7_1
    s_cmp_eq_u32 s49, 2
    s_cbranch_scc1 L_dw7_2
L_dw7_3:
    s_waitcnt vmcnt(0)
L_dw7_2:
    s_waitcnt vmcnt(4)
L_dw7_1:
    s_waitcnt vmcnt(8)
    s_bitcmp1_b32 s52, 7
    s_cbranch_scc1 L_ev7
L_dr8:
    v_mov_b64 v[32:33], v[34:35]
    v_mov_b64 v[34:35], v[36:37]
    v_mov_b64 v[36:37], v[38:39]
    s_lshr_b32 s52, s52, 8
    s_lshr_b32 s53, s53, 8
    s_lshr_b32 s56, s56, 8
    s_branch L_dr0
L_pad0:
    s_setpc_b64 s[68:69]
L_ev0:
    s_and_b32 s65, s57, 15
    v_cmp_ge_u32 s[66:67], s65, v4
    v_cmp_gt_u32 s[68:69], s65, v4
    s_bitcmp1_b32 s56, 0
    s_cselect_b64 s[62:63], s[70:71], s[62:63]
    v_cndmask_b32 v40, 0, v28, s[66:67]
    v_cndmask_b32 v41, 0, v29, s[66:67]
    v_cndmask_b32 v42, 0, v30, s[68:69]
    v_cndmask_b32 v43, 0, v31, s[68:69]
    s_mul_i32 s64, s63, 0
    s_bitcmp1_b32 s53, 0
    s_cbranch_scc0 L_evret
    s_waitcnt vmcnt(12)
    v_smfmac_f32_16x16x64_bf16 v[16:19], v[40:43], v[64:71], v14
    v_xor_b32 v28, v28, v40
    v_xor_b32 v29, v29, v41
    v_smfmac_f32_16x16x64_bf16 v[20:23], v[40:43], v[72:79], v14
    v_xor_b32 v30, v30, v42
    v_xor_b32 v31, v31, v43
    s_branch L_flush
L_pad1:
    s_setpc_b64 s[68:69]
L_ev1:
    s_and_b32 s65, s57, 15
    v_cmp_ge_u32 s[66:67], s65, v4
    v_cmp_gt_u32 s[68:69], s65, v4
    s_bitcmp1_b32 s56, 1
    s_cselect_b64 s[62:63], s[70:71], s[62:63]
    v_cndmask_b32 v40, 0, v24, s[66:67]
    v_cndmask_b32 v41, 0, v25, s[66:67]
    v_cndmask_b32 v42, 0, v26, s[68:69]
    v_cndmask_b32 v43, 0, v27, s[68:69]
    s_mul_i32 s64, s63, 1
    s_bitcmp1_b32 s53, 1
    s_cbranch_scc0 L_evret
    s_waitcnt vmcnt(12)
    v_smfmac_f32_16x16x64_bf16 v[16:19], v[40:43], v[80:87], v14
    v_xor_b32 v24, v24, v40
    v_xor_b32 v25, v25, v41
    v_smfmac_f32_16x16x64_bf16 v[20:23], v[40:43], v[88:95], v14
    v_xor_b32 v26, v26, v42
    v_xor_b32 v27, v27, v43
    s_branch L_flush
L_pad2:
    s_setpc_b64 s[68:69]
L_ev2:
    s_and_b32 s65, s57, 15
    v_cmp_ge_u32 s[66:67], s65, v4
    v_cmp_gt_u32 s[68:69], s65, v4
    s_bitcmp1_b32 s56, 2
    s_cselect_b64 s[62:63], s[70:71], s[62:63]
    v_cndmask_b32 v40, 0, v28, s[66:67]
    v_cndmask_b32 v41, 0, v29, s[66:67]
    v_cndmask_b32 v42, 0, v30, s[68:69]
    v_cndmask_b32 v43, 0, v31, s[68:69]
    s_mul_i32 s64, s63, 2
    s_bitcmp1_b32 s53, 2
    s_cbranch_scc0 L_evret
    s_waitcnt vmcnt(12)
    v_smfmac_f32_16x16x64_bf16 v[16:19], v[40:43], v[96:103], v14
    v_xor_b32 v28, v28, v40
    v_xor_b32 v29, v29, v41
    v_smfmac_f32_16x16x64_bf16 v[20:23], v[40:43], v[104:111], v14
    v_xor_b32 v30, v30, v42
    v_xor_b32 v31, v31, v43
    s_branch L_flush
L_pad3:
    s_setpc_b64 s[68:69]
L_ev3:
    s_and_b32 s65, s57, 15
    v_cmp_ge_u32 s[66:67], s65, v4
    v_cmp_gt_u32 s[68:69], s65, v4
    s_bitcmp1_b32 s56, 3
    s_cselect_b64 s[62:63], s[70:71], s[62:63]
    v_cndmask_b32 v40, 0, v24, s[66:67]
    v_cndmask_b32 v41, 0, v25, s[66:67]
    v_cndmask_b32 v42, 0, v26, s[68:69]
    v_cndmask_b32 v43, 0, v27, s[68:69]
    s_mul_i32 s64, s63, 3
    s_bitcmp1_b32 s53, 3
    s_cbranch_scc0 L_evret
    s_waitcnt vmcnt(12)
    v_smfmac_f32_16x16x64_bf16 v[16:19], v[40:43], v[112:119], v14
    v_xor_b32 v24, v24, v40
    v_xor_b32 v25, v25, v41
    v_smfmac_f32_16x16x64_bf16 v[20:23], v[40:43], v[120:127], v14
    v_xor_b32 v26, v26, v42
    v_xor_b32 v27, v27, v43
    s_branch L_flush
L_pad4:
    s_setpc_b64 s[68:69]
L_ev4:
    s_and_b32 s65, s57, 15
    v_cmp_ge_u32 s[66:67], s65, v4
    v_cmp_gt_u32 s[68:69], s65, v4
    s_bitcmp1_b32 s56, 4
    s_cselect_b64 s[62:63], s[70:71], s[62:63]
    v_cndmask_b32 v40, 0, v28, s[66:67]
    v_cndmask_b32 v41, 0, v29, s[66:67]
    v_cndmask_b32 v42, 0, v30, s[68:69]
    v_cndmask_b32 v43, 0, v31, s[68:69]
    s_mul_i32 s64, s63, 4
    s_bitcmp1_b32 s53, 4
    s_cbranch_scc0 L_evret
    s_waitcnt vmcnt(12)
    v_smfmac_f32_16x16x64_bf16 v[16:19], v[40:43], v[128:135], v14
    v_xor_b32 v28, v28, v40
    v_xor_b32 v29, v29, v41
    v_smfmac_f32_16x16x64_bf16 v[20:23], v[40:43], v[136:143], v14
    v_xor_b32 v30, v30, v42
    v_xor_b32 v31, v31, v43
    s_branch L_flush
L_pad5:
    s_setpc_b64 s[68:69]
L_ev5:
    s_and_b32 s65, s57, 15
    v_cmp_ge_u32 s[66:67], s65, v4
    v_cmp_gt_u32 s[68:69], s65, v4
    s_bitcmp1_b32 s56, 5
    s_cselect_b64 s[62:63], s[70:71], s[62:63]
    v_cndmask_b32 v40, 0, v24, s[66:67]
    v_cndmask_b32 v41, 0, v25, s[66:67]
    v_cndmask_b32 v42, 0, v26, s[68:69]
    v_cndmask_b32 v43, 0, v27, s[68:69]
    s_mul_i32 s64, s63, 5
    s_bitcmp1_b32 s53, 5
    s_cbranch_scc0 L_evret
    s_waitcnt vmcnt(12)
    v_smfmac_f32_16x16x64_bf16 v[16:19], v[40:43], v[144:151], v14
    v_xor_b32 v24, v24, v40
    v_xor_b32 v25, v25, v41
    v_smfmac_f32_16x16x64_bf16 v[20:23], v[40:43], v[152:159], v14
    v_xor_b32 v26, v26, v42
    v_xor_b32 v27, v27, v43
    s_branch L_flush
L_pad6:
    s_setpc_b64 s[68:69]
L_ev6:
    s_and_b32 s65, s57, 15
    v_cmp_ge_u32 s[66:67], s65, v4
    v_cmp_gt_u32 s[68:69], s65, v4
    s_bitcmp1_b32 s56, 6
    s_cselect_b64 s[62:63], s[70:71], s[62:63]
    v_cndmask_b32 v40, 0, v28, s[66:67]
    v_cndmask_b32 v41, 0, v29, s[66:67]
    v_cndmask_b32 v42, 0, v30, s[68:69]
    v_cndmask_b32 v43, 0, v31, s[68:69]
    s_mul_i32 s64, s63, 6
    s_bitcmp1_b32 s53, 6
    s_cbranch_scc0 L_evret
    s_waitcnt vmcnt(12)
    v_smfmac_f32_16x16x64_bf16 v[16:19], v[40:43], v[160:167], v14
    v_xor_b32 v28, v28, v40
    v_xor_b32 v29, v29, v41
    v_smfmac_f32_16x16x64_bf16 v[20:23], v[40:43], v[168:175], v14
    v_xor_b32 v30, v30, v42
    v_xor_b32 v31, v31, v43
    s_branch L_flush
L_pad7:
    s_setpc_b64 s[68:69]
L_ev7:
    s_and_b32 s65, s57, 15
    v_cmp_ge_u32 s[66:67], s65, v4
    v_cmp_gt_u32 s[68:69], s65, v4
    s_bitcmp1_b32 s56, 7
    s_cselect_b64 s[62:63], s[70:71], s[62:63]
    v_cndmask_b32 v40, 0, v24, s[66:67]
    v_cndmask_b32 v41, 0, v25, s[66:67]
    v_cndmask_b32 v42, 0, v26, s[68:69]
    v_cndmask_b32 v43, 0, v27, s[68:69]
    s_mul_i32 s64, s63, 7
    s_bitcmp1_b32 s53, 7
    s_cbranch_scc0 L_evret
    s_waitcnt vmcnt(12)
    v_smfmac_f32_16x16x64_bf16 v[16:19], v[40:43], v[48:55], v14
    v_xor_b32 v24, v24, v40
    v_xor_b32 v25, v25, v41
    v_smfmac_f32_16x16x64_bf16 v[20:23], v[40:43], v[56:63], v14
    v_xor_b32 v26, v26, v42
    v_xor_b32 v27, v27, v43
    s_nop 0
L_flush:
    s_lshr_b32 s57, s57, 4
    s_cmp_eq_u32 s26, 4
    v_add_u32 v1, 1, v1
    v_mul_f32 v40, v177, v16
    v_mul_f32 v41, v177, v17
    v_mul_f32 v42, v177, v18
    v_mul_f32 v43, v177, v19
    v_cvt_pk_bf16_f32 v40, v40, v41
    v_cvt_pk_bf16_f32 v41, v42, v43
    ds_write_b64 v176, v[40:41] offset:41984
    v_mul_f32 v44, v177, v20
    v_mul_f32 v45, v177, v21
    v_mul_f32 v46, v177, v22
    v_mul_f32 v47, v177, v23
    v_cvt_pk_bf16_f32 v44, v44, v45
    v_cvt_pk_bf16_f32 v45, v46, v47
    ds_write_b64 v176, v[44:45] offset:42240
    ds_write_b32 v10, v1 offset:32
    s_cbranch_scc1 L_sdone
    v_mov_b64 v[16:17], 0
    v_mov_b64 v[18:19], 0
    v_mov_b64 v[20:21], 0
    v_mov_b64 v[22:23], 0
    s_add_u32 s26, s26, 1
    v_mov_b64 v[176:177], v[178:179]
    v_mov_b64 v[178:179], v[180:181]
    v_mov_b64 v[180:181], v[182:183]
    v_mov_b64 v[182:183], v[184:185]
L_evret:
    s_add_u32 s64, s64, s62
    s_add_u32 s54, s72, s64
    s_addc_u32 s55, s73, 0
    s_setpc_b64 s[54:55]
L_pad9:
    s_setpc_b64 s[68:69]
L_slow:
    s_mov_b32 s62, L_slow_pair-L_anc
    v_mbcnt_lo_u32_b32 v200, -1, 0
    v_mbcnt_hi_u32_b32 v200, -1, v200
L_slow_pair:
    v_lshlrev_b32 v201, 2, v200
    s_mul_i32 s70, s1, 40
    s_lshl1_add_u32 s70, s24, s70
    s_mov_b32 s71, 0
    s_mov_b32 s24, s20
    s_mov_b32 s20, s21
    s_mov_b32 s21, s22
    s_mov_b32 s22, s23
L_slow_chunk:
    global_load_dword v202, v201, s[8:9]
    global_load_dword v203, v201, s[6:7]
    v_add_u32 v201, 0x100, v201
    s_waitcnt vmcnt(0)
    v_subrev_u32 v202, s70, v202
    v_cmp_gt_u32 vcc, 2, v202
    v_lshlrev_b32 v204, 1, v203
    ds_read_u16 v204, v204 offset:62464
    s_mov_b64 s[76:77], vcc
    v_lshlrev_b32 v202, 4, v202
    v_lshlrev_b32 v203, 9, v203
    s_waitcnt lgkmcnt(0)
    v_lshlrev_b32 v204, v202, v204
L_slow_edge:
    s_cmp_eq_u64 s[76:77], 0
    s_cbranch_scc1 L_slow_next
    s_ff1_i32_b64 s74, s[76:77]
    s_bitset0_b64 s[76:77], s74
    v_readlane_b32 s64, v203, s74
    v_readlane_b32 s65, v204, s74
    v_mov_b32 v205, 0
    v_mov_b32 v11, 2147483648
    s_mov_b64 exec, 0xffff
    v_mov_b32 v205, s65
    v_add_u32 v11, s64, v7
    s_mov_b64 exec, -1
    buffer_load_dwordx4 v[208:211], v11, s[32:35], 0 offen
    buffer_load_dwordx4 v[212:215], v11, s[32:35], 0 offen offset:256
    v_and_b32 v24, v205, v12
    v_and_b32 v25, v205, v13
    s_nop 0
    s_waitcnt vmcnt(0)
    v_smfmac_f32_16x16x32_bf16 v[16:19], v[24:25], v[208:211], v14
    v_smfmac_f32_16x16x32_bf16 v[20:23], v[24:25], v[212:215], v14
    s_branch L_slow_edge
L_slow_next:
    s_add_u32 s71, s71, 1
    s_cmp_lt_u32 s71, 2500
    s_cbranch_scc1 L_slow_chunk
    s_mov_b32 s64, 0
    s_nop 3
    s_branch L_flush
L_sdone:
    ds_write_b32 v10, v6 offset:48
    s_waitcnt lgkmcnt(0)
    s_barrier
    s_endpgm
L_retry_16:
    s_sub_u32 s100, s100, 1
    s_cbranch_scc1 L_end
    s_sleep 1
    s_branch L_spin_15
L_retry_17:
    s_sub_u32 s100, s100, 1
    s_cbranch_scc1 L_end
    s_sleep 4
    s_branch L_ipoll_14
L_retry_23:
    s_sub_u32 s100, s100, 1
    s_cbranch_scc1 L_end
    s_sleep 2
    s_branch L_secload_22
L_secload_22:
    buffer_load_dwordx4 v[56:59], v8, s[40:43], s12 offen sc1
    s_waitcnt vmcnt(0)
    s_branch L_sec_20
L_retry_27:
    s_sub_u32 s100, s100, 1
    s_cbranch_scc1 L_end
    s_sleep 2
    s_branch L_secload_26
L_secload_26:
    buffer_load_dwordx4 v[60:63], v8, s[40:43], s13 offen sc1
    s_waitcnt vmcnt(0)
    s_branch L_sec_24
L_retry_29:
    s_sub_u32 s100, s100, 1
    s_cbranch_scc1 L_end
    s_sleep 1
    s_branch L_spin_28
L_mwork_4:
    v_xor_b32 v44, v4, v3
    v_lshlrev_b32 v44, 4, v44
    v_lshl_add_u32 v44, v3, 9, v44
    v_xor_b32 v45, 64, v44
    v_xor_b32 v46, 0x80, v44
    v_xor_b32 v47, 0xc0, v44
    s_cmp_lg_u32 s31, 0
    s_waitcnt vmcnt(0)
    s_barrier
    s_cbranch_scc1 L_worked_5_w
    ds_read_b128 v[48:51], v44 offset:62464
    ds_read_b128 v[52:55], v44 offset:21504
    ds_read_b128 v[56:59], v44 offset:29696
    ds_read_b128 v[60:63], v45 offset:62464
    ds_read_b128 v[64:67], v45 offset:21504
    ds_read_b128 v[68:71], v45 offset:29696
    ds_read_b128 v[72:75], v46 offset:62464
    ds_read_b128 v[76:79], v46 offset:21504
    ds_read_b128 v[80:83], v46 offset:29696
    ds_read_b128 v[84:87], v47 offset:62464
    ds_read_b128 v[88:91], v47 offset:21504
    ds_read_b128 v[92:95], v47 offset:29696
    s_waitcnt lgkmcnt(9)
    v_mfma_f32_16x16x32_bf16 v[16:19], v[52:55], v[48:51], 0
    v_mfma_f32_16x16x32_bf16 v[20:23], v[56:59], v[48:51], 0
    ds_read_b128 v[96:99], v44 offset:62720
    ds_read_b128 v[100:103], v44 offset:21760
    ds_read_b128 v[104:107], v44 offset:29952
    s_waitcnt lgkmcnt(9)
    v_mfma_f32_16x16x32_bf16 v[16:19], v[64:67], v[60:63], v[16:19]
    v_mfma_f32_16x16x32_bf16 v[20:23], v[68:71], v[60:63], v[20:23]
    ds_read_b128 v[108:111], v45 offset:62720
    ds_read_b128 v[112:115], v45 offset:21760
    ds_read_b128 v[116:119], v45 offset:29952
    s_waitcnt lgkmcnt(9)
    v_mfma_f32_16x16x32_bf16 v[16:19], v[76:79], v[72:75], v[16:19]
    v_mfma_f32_16x16x32_bf16 v[20:23], v[80:83], v[72:75], v[20:23]
    ds_read_b128 v[120:123], v46 offset:62720
    ds_read_b128 v[124:127], v46 offset:21760
    ds_read_b128 v[128:131], v46 offset:29952
    s_waitcnt lgkmcnt(9)
    v_mfma_f32_16x16x32_bf16 v[16:19], v[88:91], v[84:87], v[16:19]
    v_mfma_f32_16x16x32_bf16 v[20:23], v[92:95], v[84:87], v[20:23]
    ds_read_b128 v[132:135], v47 offset:62720
    ds_read_b128 v[136:139], v47 offset:21760
    ds_read_b128 v[140:143], v47 offset:29952
    s_waitcnt lgkmcnt(9)
    v_mfma_f32_16x16x32_bf16 v[16:19], v[100:103], v[96:99], v[16:19]
    v_mfma_f32_16x16x32_bf16 v[20:23], v[104:107], v[96:99], v[20:23]
    s_waitcnt lgkmcnt(6)
    v_mfma_f32_16x16x32_bf16 v[16:19], v[112:115], v[108:111], v[16:19]
    v_mfma_f32_16x16x32_bf16 v[20:23], v[116:119], v[108:111], v[20:23]
    s_waitcnt lgkmcnt(3)
    v_mfma_f32_16x16x32_bf16 v[16:19], v[124:127], v[120:123], v[16:19]
    v_mfma_f32_16x16x32_bf16 v[20:23], v[128:131], v[120:123], v[20:23]
    s_waitcnt lgkmcnt(0)
    v_mfma_f32_16x16x32_bf16 v[16:19], v[136:139], v[132:135], v[16:19]
    v_mfma_f32_16x16x32_bf16 v[20:23], v[140:143], v[132:135], v[20:23]
    s_lshl_b32 s64, s27, 10
    s_add_u32 s64, s64, 65536
    v_lshl_add_u32 v40, v2, 4, s64
    s_lshl_b32 s64, s27, 2
    s_add_u32 s64, s64, 4096
    v_lshl_add_u32 v41, v2, 9, s64
    v_mov_b32 v42, s30
    s_nop 1
    v_cvt_pk_bf16_f32 v44, v16, v17
    v_cvt_pk_bf16_f32 v45, v18, v19
    v_cvt_pk_bf16_f32 v46, v20, v21
    v_cvt_pk_bf16_f32 v47, v22, v23
    global_store_dwordx4 v40, v[44:47], s[28:29] sc1
    s_barrier
    s_mov_b32 s26, 2
    s_waitcnt vmcnt(0)
    s_mov_b64 exec, 0xff
    global_store_dword v41, v42, s[28:29] sc1
    s_mov_b64 exec, -1
    s_branch L_worked_5
L_worked_5_w:
    s_barrier
    s_branch L_worked_5
L_gemm:
    v_lshrrev_b32 v0, 5, v2
    s_lshl_b32 s64, s31, 1
    v_add_u32 v0, s64, v0
    v_and_b32 v1, 31, v2
    v_xor_b32 v1, v1, v0
    v_lshlrev_b32 v1, 4, v1
    v_lshl_add_u32 v30, v0, 9, v1
    v_xor_b32 v31, 0x80, v30
    v_lshrrev_b32 v13, 3, v2
    v_lshrrev_b32 v15, 2, v2
    v_and_b32 v15, 4, v15
    v_and_b32 v14, 7, v2
    v_xor_b32 v15, v15, v14
    v_lshlrev_b32 v15, 4, v15
    v_lshl_add_u32 v13, v13, 9, v15
    s_lshr_b32 s67, s2, 3
    s_and_b32 s67, s67, 7
    s_lshl_b32 s64, s31, 7
    s_lshl_b32 s65, s67, 14
    s_or_b32 s64, s64, s65
    v_add_u32 v13, s64, v13
    s_mul_i32 s63, s1, 20480
    s_lshl_b32 s66, s31, 10
    s_lshl_b32 s70, s31, 14
    s_add_u32 s70, s70, 82944
    s_mov_b32 s71, 3072
    s_mov_b32 s72, 6144
    s_mov_b32 s73, 9216
    s_waitcnt lgkmcnt(0)
    s_mov_b32 s32, s4
    s_and_b32 s33, s5, 0xffff
    s_mov_b32 s34, 5120000
    s_mov_b32 s35, 0x20000
    s_mov_b32 s36, s22
    s_and_b32 s37, s23, 0xffff
    s_mov_b32 s38, 131072
    s_mov_b32 s39, 0x20000
    s_and_b32 s64, s2, 8
    s_or_b32 s64, s64, s31
    s_cbranch_scc1 L_touched_30
    s_lshr_b32 s64, s2, 4
    s_lshl_b32 s64, s64, 3
    s_and_b32 s68, s2, 7
    s_or_b32 s64, s64, s68
    s_lshl_b32 s64, s64, 10
    v_lshl_add_u32 v16, v2, 4, s64
    global_load_dwordx4 v[20:23], v16, s[16:17]
L_touched_30:
    s_cmp_ge_u32 s2, 250
    s_cbranch_scc1 L_end
    s_mul_i32 s64, s1, 20480
    s_mov_b32 s76, 0
    s_cmp_eq_u32 s31, 0
    s_cselect_b64 s[68:69], s[24:25], s[16:17]
    s_cselect_b32 s64, s64, 0
    s_cmp_eq_u32 s31, 2
    s_cselect_b64 s[68:69], s[28:29], s[68:69]
    s_cselect_b32 s64, 0x800, s64
    s_cselect_b32 s76, 0x2f8000, s76
    s_cmp_eq_u32 s31, 3
    s_cselect_b64 s[68:69], s[4:5], s[68:69]
    s_cselect_b32 s76, 0x200000, s76
    s_cselect_b32 s77, 2, 1
    v_min_u32 v17, s77, v2
    v_mul_lo_u32 v17, v17, s76
    v_add_u32 v17, s64, v17
    global_load_dword v24, v17, s[68:69]
    s_barrier
    s_setprio 2
    s_add_u32 m0, s66, 1024
    s_nop 0
    buffer_load_dwordx4 v30, s[32:35], s63 offen lds
    s_add_u32 m0, s66, 5120
    s_add_u32 s63, s63, 4096
    buffer_load_dwordx4 v31, s[32:35], s63 offen lds
    s_add_u32 m0, s70, 0
    s_nop 0
    buffer_load_dwordx4 v13, s[36:39], 0 offen offset:0 lds
    buffer_load_dwordx4 v13, s[36:39], s71 offen offset:1024 lds
    buffer_load_dwordx4 v13, s[36:39], s72 offen offset:2048 lds
    buffer_load_dwordx4 v13, s[36:39], s73 offen offset:3072 lds
    v_xor_b32 v13, 16384, v13
    s_mov_b32 s40, s16
    s_and_b32 s41, s17, 0xffff
    s_mov_b32 s42, 131072
    s_mov_b32 s43, 0x20000
    s_mov_b32 s44, s28
    s_and_b32 s45, s29, 0xffff
    s_mov_b32 s46, 1048576
    s_mov_b32 s47, 0x20000
    s_mov_b32 s48, s24
    s_and_b32 s49, s25, 0xffff
    s_mov_b32 s50, 5120000
    s_mov_b32 s51, 0x20000
    v_xor_b32 v15, v4, v3
    v_lshlrev_b32 v15, 4, v15
    v_lshl_add_u32 v7, v3, 9, v15
    s_lshl_b32 s64, s67, 6
    v_xor_b32 v7, s64, v7
    v_xor_b32 v8, 64, v7
    v_xor_b32 v9, 0x80, v7
    v_xor_b32 v10, 0xc0, v7
    v_lshrrev_b32 v15, 2, v3
    v_lshl_add_u32 v15, v4, 3, v15
    v_lshlrev_b32 v15, 7, v15
    v_lshrrev_b32 v14, 1, v3
    v_and_b32 v14, 4, v14
    v_and_b32 v0, 3, v3
    v_xor_b32 v14, v14, v0
    v_lshl_add_u32 v15, v14, 4, v15
    v_add_u32 v11, s70, v15
    v_xor_b32 v12, 64, v11
    v_and_b32 v0, 31, v2
    v_lshlrev_b32 v0, 2, v0
    s_and_b32 s64, s2, 7
    s_lshl_b32 s64, s64, 9
    s_lshl_b32 s65, s31, 7
    s_add_u32 s64, s64, s65
    s_add_u32 s74, s64, 4096
    v_lshlrev_b32 v14, 4, v2
    s_lshl_b32 s75, s31, 15
    s_lshl_b32 s64, s67, 12
    s_or_b32 s75, s75, s64
    s_add_u32 s75, s75, 65536
    s_cmp_eq_u32 s31, 0
    s_cbranch_scc0 L_nw_32
    s_call_b64 s[68:69], L_pad0
    s_call_b64 s[68:69], L_pad1
    s_call_b64 s[68:69], L_pad8
    s_branch L_warmed_31
L_nw_32:
    s_cmp_eq_u32 s31, 1
    s_cbranch_scc0 L_nw_33
    s_call_b64 s[68:69], L_pad2
    s_call_b64 s[68:69], L_pad3
    s_call_b64 s[68:69], L_pad9
    s_branch L_warmed_31
L_nw_33:
    s_cmp_eq_u32 s31, 2
    s_cbranch_scc0 L_nw_34
    s_call_b64 s[68:69], L_pad4
    s_call_b64 s[68:69], L_pad5
    s_branch L_warmed_31
L_nw_34:
    s_call_b64 s[68:69], L_pad6
    s_call_b64 s[68:69], L_pad7
L_warmed_31:
    s_add_u32 m0, s66, 9216
    s_add_u32 s63, s63, 4096
    buffer_load_dwordx4 v30, s[32:35], s63 offen lds
    s_add_u32 m0, s66, 13312
    s_add_u32 s63, s63, 4096
    buffer_load_dwordx4 v31, s[32:35], s63 offen lds
    s_add_u32 m0, s66, 17408
    s_add_u32 s63, s63, 4096
    buffer_load_dwordx4 v30, s[32:35], s63 offen lds
    s_barrier
    s_add_u32 m0, s70, 4096
    s_waitcnt vmcnt(9)
    buffer_load_dwordx4 v13, s[36:39], 0 offen offset:0 lds
    s_waitcnt vmcnt(9)
    buffer_load_dwordx4 v13, s[36:39], s71 offen offset:1024 lds
    s_waitcnt vmcnt(9)
    buffer_load_dwordx4 v13, s[36:39], s72 offen offset:2048 lds
    s_waitcnt vmcnt(9)
    buffer_load_dwordx4 v13, s[36:39], s73 offen offset:3072 lds
    v_xor_b32 v13, 49152, v13
    s_bitcmp1_b32 s2, 3
    s_cbranch_scc1 L_nobar_36
    s_barrier
L_nobar_36:
    s_add_u32 m0, s70, 8192
    s_waitcnt vmcnt(4)
    buffer_load_dwordx4 v13, s[36:39], 0 offen offset:0 lds
    s_waitcnt vmcnt(4)
    buffer_load_dwordx4 v13, s[36:39], s71 offen offset:1024 lds
    s_waitcnt vmcnt(4)
    buffer_load_dwordx4 v13, s[36:39], s72 offen offset:2048 lds
    s_waitcnt vmcnt(4)
    buffer_load_dwordx4 v13, s[36:39], s73 offen offset:3072 lds
    v_xor_b32 v13, 16384, v13
    s_add_u32 m0, s70, 12288
    s_waitcnt vmcnt(4)
    buffer_load_dwordx4 v13, s[36:39], 0 offen offset:0 lds
    s_waitcnt vmcnt(4)
    buffer_load_dwordx4 v13, s[36:39], s71 offen offset:1024 lds
    s_waitcnt vmcnt(4)
    buffer_load_dwordx4 v13, s[36:39], s72 offen offset:2048 lds
    s_waitcnt vmcnt(4)
    buffer_load_dwordx4 v13, s[36:39], s73 offen offset:3072 lds
    v_xor_b32 v13, 114688, v13
    s_waitcnt vmcnt(12)
    ds_read_b64_tr_b16 v[128:129], v11 offset:0
    ds_read_b64_tr_b16 v[130:131], v11 offset:512
    ds_read_b64_tr_b16 v[132:133], v11 offset:8
    ds_read_b64_tr_b16 v[134:135], v11 offset:520
    ds_read_b64_tr_b16 v[136:137], v12 offset:0
    ds_read_b64_tr_b16 v[138:139], v12 offset:512
    ds_read_b64_tr_b16 v[140:141], v12 offset:8
    ds_read_b64_tr_b16 v[142:143], v12 offset:520
    s_waitcnt lgkmcnt(0)
    s_add_u32 m0, s70, 0
    s_waitcnt vmcnt(4)
    buffer_load_dwordx4 v13, s[36:39], 0 offen offset:0 lds
    s_waitcnt vmcnt(4)
    buffer_load_dwordx4 v13, s[36:39], s71 offen offset:1024 lds
    s_waitcnt vmcnt(4)
    buffer_load_dwordx4 v13, s[36:39], s72 offen offset:2048 lds
    s_waitcnt vmcnt(4)
    buffer_load_dwordx4 v13, s[36:39], s73 offen offset:3072 lds
    v_xor_b32 v13, 16384, v13
    s_waitcnt vmcnt(12)
    s_waitcnt lgkmcnt(0)
    s_mov_b64 exec, 1
    ds_add_u32 v5, v6 offset:4
    s_mov_b64 exec, -1
    ds_read_b64_tr_b16 v[144:145], v11 offset:4096
    ds_read_b64_tr_b16 v[146:147], v11 offset:4608
    ds_read_b64_tr_b16 v[148:149], v11 offset:4104
    ds_read_b64_tr_b16 v[150:151], v11 offset:4616
    ds_read_b64_tr_b16 v[152:153], v12 offset:4096
    ds_read_b64_tr_b16 v[154:155], v12 offset:4608
    ds_read_b64_tr_b16 v[156:157], v12 offset:4104
    ds_read_b64_tr_b16 v[158:159], v12 offset:4616
    s_waitcnt lgkmcnt(0)
    s_add_u32 m0, s70, 4096
    s_waitcnt vmcnt(4)
    buffer_load_dwordx4 v13, s[36:39], 0 offen offset:0 lds
    s_waitcnt vmcnt(4)
    buffer_load_dwordx4 v13, s[36:39], s71 offen offset:1024 lds
    s_waitcnt vmcnt(4)
    buffer_load_dwordx4 v13, s[36:39], s72 offen offset:2048 lds
    s_waitcnt vmcnt(4)
    buffer_load_dwordx4 v13, s[36:39], s73 offen offset:3072 lds
    v_xor_b32 v13, 49152, v13
    s_waitcnt vmcnt(12)
    ds_read_b64_tr_b16 v[160:161], v11 offset:8192
    ds_read_b64_tr_b16 v[162:163], v11 offset:8704
    ds_read_b64_tr_b16 v[164:165], v11 offset:8200
    ds_read_b64_tr_b16 v[166:167], v11 offset:8712
    ds_read_b64_tr_b16 v[168:169], v12 offset:8192
    ds_read_b64_tr_b16 v[170:171], v12 offset:8704
    ds_read_b64_tr_b16 v[172:173], v12 offset:8200
    ds_read_b64_tr_b16 v[174:175], v12 offset:8712
    s_waitcnt lgkmcnt(0)
    s_add_u32 m0, s70, 8192
    s_waitcnt vmcnt(4)
    buffer_load_dwordx4 v13, s[36:39], 0 offen offset:0 lds
    s_waitcnt vmcnt(4)
    buffer_load_dwordx4 v13, s[36:39], s71 offen offset:1024 lds
    s_waitcnt vmcnt(4)
    buffer_load_dwordx4 v13, s[36:39], s72 offen offset:2048 lds
    s_waitcnt vmcnt(4)
    buffer_load_dwordx4 v13, s[36:39], s73 offen offset:3072 lds
    v_xor_b32 v13, 16384, v13
    buffer_load_dword v1, v0, s[44:47], s74 offen sc1
    s_waitcnt vmcnt(13)
    ds_read_b64_tr_b16 v[176:177], v11 offset:12288
    ds_read_b64_tr_b16 v[178:179], v11 offset:12800
    ds_read_b64_tr_b16 v[180:181], v11 offset:12296
    ds_read_b64_tr_b16 v[182:183], v11 offset:12808
    ds_read_b64_tr_b16 v[184:185], v12 offset:12288
    ds_read_b64_tr_b16 v[186:187], v12 offset:12800
    ds_read_b64_tr_b16 v[188:189], v12 offset:12296
    ds_read_b64_tr_b16 v[190:191], v12 offset:12808
    s_waitcnt lgkmcnt(0)
    s_add_u32 m0, s70, 12288
    s_nop 0
    buffer_load_dwordx4 v13, s[36:39], 0 offen offset:0 lds
    buffer_load_dwordx4 v13, s[36:39], s71 offen offset:1024 lds
    buffer_load_dwordx4 v13, s[36:39], s72 offen offset:2048 lds
    buffer_load_dwordx4 v13, s[36:39], s73 offen offset:3072 lds
    v_xor_b32 v13, 114688, v13
    s_waitcnt vmcnt(13)
    ds_read_b64_tr_b16 v[192:193], v11 offset:0
    ds_read_b64_tr_b16 v[194:195], v11 offset:512
    ds_read_b64_tr_b16 v[196:197], v11 offset:8
    ds_read_b64_tr_b16 v[198:199], v11 offset:520
    ds_read_b64_tr_b16 v[200:201], v12 offset:0
    ds_read_b64_tr_b16 v[202:203], v12 offset:512
    ds_read_b64_tr_b16 v[204:205], v12 offset:8
    ds_read_b64_tr_b16 v[206:207], v12 offset:520
    s_waitcnt vmcnt(9)
    ds_read_b64_tr_b16 v[208:209], v11 offset:4096
    ds_read_b64_tr_b16 v[210:211], v11 offset:4608
    ds_read_b64_tr_b16 v[212:213], v11 offset:4104
    ds_read_b64_tr_b16 v[214:215], v11 offset:4616
    ds_read_b64_tr_b16 v[216:217], v12 offset:4096
    ds_read_b64_tr_b16 v[218:219], v12 offset:4608
    ds_read_b64_tr_b16 v[220:221], v12 offset:4104
    ds_read_b64_tr_b16 v[222:223], v12 offset:4616
    s_waitcnt vmcnt(5)
    ds_read_b64_tr_b16 v[224:225], v11 offset:8192
    ds_read_b64_tr_b16 v[226:227], v11 offset:8704
    ds_read_b64_tr_b16 v[228:229], v11 offset:8200
    ds_read_b64_tr_b16 v[230:231], v11 offset:8712
    ds_read_b64_tr_b16 v[232:233], v12 offset:8192
    ds_read_b64_tr_b16 v[234:235], v12 offset:8704
    ds_read_b64_tr_b16 v[236:237], v12 offset:8200
    ds_read_b64_tr_b16 v[238:239], v12 offset:8712
    s_waitcnt vmcnt(4)
L_spin_38:
    ds_read_b128 v[16:19], v5
    s_waitcnt lgkmcnt(0)
    v_readfirstlane_b32 s101, v18
    v_readfirstlane_b32 s30, v19
    s_cmp_ge_u32 s101, 1
    s_cbranch_scc0 L_retry_39
L_mchk_37:
    v_cmp_ne_u32 vcc, s30, v1
    s_cbranch_vccnz L_mre_40
    buffer_load_dwordx4 v[40:43], v14, s[44:47], s75 offen offset:0 sc1
    buffer_load_dwordx4 v[44:47], v14, s[44:47], s75 offen offset:1024 sc1
    buffer_load_dwordx4 v[48:51], v14, s[44:47], s75 offen offset:2048 sc1
    buffer_load_dwordx4 v[52:55], v14, s[44:47], s75 offen offset:3072 sc1
    s_xor_b32 s75, s75, 4096
    buffer_load_dwordx4 v[56:59], v14, s[44:47], s75 offen offset:0 sc1
    buffer_load_dwordx4 v[60:63], v14, s[44:47], s75 offen offset:1024 sc1
    buffer_load_dwordx4 v[64:67], v14, s[44:47], s75 offen offset:2048 sc1
    buffer_load_dwordx4 v[68:71], v14, s[44:47], s75 offen offset:3072 sc1
    s_xor_b32 s75, s75, 12288
    buffer_load_dwordx4 v[72:75], v14, s[44:47], s75 offen offset:0 sc1
    buffer_load_dwordx4 v[76:79], v14, s[44:47], s75 offen offset:1024 sc1
    s_waitcnt vmcnt(10)
    ds_read_b64_tr_b16 v[240:241], v11 offset:12288
    ds_read_b64_tr_b16 v[242:243], v11 offset:12800
    ds_read_b64_tr_b16 v[244:245], v11 offset:12296
    ds_read_b64_tr_b16 v[246:247], v11 offset:12808
    ds_read_b64_tr_b16 v[248:249], v12 offset:12288
    ds_read_b64_tr_b16 v[250:251], v12 offset:12800
    ds_read_b64_tr_b16 v[252:253], v12 offset:12296
    ds_read_b64_tr_b16 v[254:255], v12 offset:12808
L_spin_41:
    ds_read_b32 v15, v5 offset:4
    s_waitcnt lgkmcnt(0)
    v_readfirstlane_b32 s101, v15
    s_cmp_ge_u32 s101, 4
    s_cbranch_scc0 L_retry_42
    ds_read_b128 v[16:19], v7 offset:1024
    ds_read_b128 v[20:23], v7 offset:9216
    ds_read_b128 v[24:27], v7 offset:17408
    v_xor_b32 v7, 0x100, v7
    ds_read_b128 v[28:31], v8 offset:1024
    ds_read_b128 v[32:35], v8 offset:9216
    ds_read_b128 v[36:39], v8 offset:17408
    v_xor_b32 v8, 0x100, v8
    s_waitcnt lgkmcnt(3)
    s_waitcnt vmcnt(9)
    v_mfma_f32_16x16x32_bf16 v[80:83], v[40:43], v[16:19], 0
    v_mfma_f32_16x16x32_bf16 v[96:99], v[40:43], v[20:23], 0
    v_mfma_f32_16x16x32_bf16 v[112:115], v[40:43], v[24:27], 0
    buffer_load_dwordx4 v[40:43], v14, s[44:47], s75 offen offset:2048 sc1
    s_waitcnt vmcnt(9)
    v_mfma_f32_16x16x32_bf16 v[84:87], v[44:47], v[16:19], 0
    v_mfma_f32_16x16x32_bf16 v[100:103], v[44:47], v[20:23], 0
    v_mfma_f32_16x16x32_bf16 v[116:119], v[44:47], v[24:27], 0
    buffer_load_dwordx4 v[44:47], v14, s[44:47], s75 offen offset:3072 sc1
    s_xor_b32 s75, s75, 4096
    s_waitcnt vmcnt(9)
    v_mfma_f32_16x16x32_bf16 v[88:91], v[48:51], v[16:19], 0
    v_mfma_f32_16x16x32_bf16 v[104:107], v[48:51], v[20:23], 0
    v_mfma_f32_16x16x32_bf16 v[120:123], v[48:51], v[24:27], 0
    buffer_load_dwordx4 v[48:51], v14, s[44:47], s75 offen offset:0 sc1
    s_waitcnt vmcnt(9)
    v_mfma_f32_16x16x32_bf16 v[92:95], v[52:55], v[16:19], 0
    v_mfma_f32_16x16x32_bf16 v[108:111], v[52:55], v[20:23], 0
    v_mfma_f32_16x16x32_bf16 v[124:127], v[52:55], v[24:27], 0
    buffer_load_dwordx4 v[52:55], v14, s[44:47], s75 offen offset:1024 sc1
    ds_read_b128 v[16:19], v9 offset:1024
    ds_read_b128 v[20:23], v9 offset:9216
    ds_read_b128 v[24:27], v9 offset:17408
    v_xor_b32 v9, 0x100, v9
    s_waitcnt lgkmcnt(3)
    s_waitcnt vmcnt(9)
    v_mfma_f32_16x16x32_bf16 v[80:83], v[56:59], v[28:31], v[80:83]
    v_mfma_f32_16x16x32_bf16 v[96:99], v[56:59], v[32:35], v[96:99]
    v_mfma_f32_16x16x32_bf16 v[112:115], v[56:59], v[36:39], v[112:115]
    buffer_load_dwordx4 v[56:59], v14, s[44:47], s75 offen offset:2048 sc1
    s_waitcnt vmcnt(9)
    v_mfma_f32_16x16x32_bf16 v[84:87], v[60:63], v[28:31], v[84:87]
    v_mfma_f32_16x16x32_bf16 v[100:103], v[60:63], v[32:35], v[100:103]
    v_mfma_f32_16x16x32_bf16 v[116:119], v[60:63], v[36:39], v[116:119]
    buffer_load_dwordx4 v[60:63], v14, s[44:47], s75 offen offset:3072 sc1
    s_xor_b32 s75, s75, 28672
    s_waitcnt vmcnt(9)
    v_mfma_f32_16x16x32_bf16 v[88:91], v[64:67], v[28:31], v[88:91]
    v_mfma_f32_16x16x32_bf16 v[104:107], v[64:67], v[32:35], v[104:107]
    v_mfma_f32_16x16x32_bf16 v[120:123], v[64:67], v[36:39], v[120:123]
    buffer_load_dwordx4 v[64:67], v14, s[44:47], s75 offen offset:0 sc1
    s_waitcnt vmcnt(9)
    v_mfma_f32_16x16x32_bf16 v[92:95], v[68:71], v[28:31], v[92:95]
    v_mfma_f32_16x16x32_bf16 v[108:111], v[68:71], v[32:35], v[108:111]
    v_mfma_f32_16x16x32_bf16 v[124:127], v[68:71], v[36:39], v[124:127]
    buffer_load_dwordx4 v[68:71], v14, s[44:47], s75 offen offset:1024 sc1
    ds_read_b128 v[28:31], v10 offset:1024
    ds_read_b128 v[32:35], v10 offset:9216
    ds_read_b128 v[36:39], v10 offset:17408
    v_xor_b32 v10, 0x100, v10
    s_waitcnt lgkmcnt(3)
    s_waitcnt vmcnt(9)
    v_mfma_f32_16x16x32_bf16 v[80:83], v[72:75], v[16:19], v[80:83]
    v_mfma_f32_16x16x32_bf16 v[96:99], v[72:75], v[20:23], v[96:99]
    v_mfma_f32_16x16x32_bf16 v[112:115], v[72:75], v[24:27], v[112:115]
    buffer_load_dwordx4 v[72:75], v14, s[44:47], s75 offen offset:2048 sc1
    s_waitcnt vmcnt(9)
    v_mfma_f32_16x16x32_bf16 v[84:87], v[76:79], v[16:19], v[84:87]
    v_mfma_f32_16x16x32_bf16 v[100:103], v[76:79], v[20:23], v[100:103]
    v_mfma_f32_16x16x32_bf16 v[116:119], v[76:79], v[24:27], v[116:119]
    buffer_load_dwordx4 v[76:79], v14, s[44:47], s75 offen offset:3072 sc1
    s_xor_b32 s75, s75, 4096
    s_waitcnt vmcnt(9)
    v_mfma_f32_16x16x32_bf16 v[88:91], v[40:43], v[16:19], v[88:91]
    v_mfma_f32_16x16x32_bf16 v[104:107], v[40:43], v[20:23], v[104:107]
    v_mfma_f32_16x16x32_bf16 v[120:123], v[40:43], v[24:27], v[120:123]
    buffer_load_dwordx4 v[40:43], v14, s[44:47], s75 offen offset:0 sc1
    s_waitcnt vmcnt(9)
    v_mfma_f32_16x16x32_bf16 v[92:95], v[44:47], v[16:19], v[92:95]
    v_mfma_f32_16x16x32_bf16 v[108:111], v[44:47], v[20:23], v[108:111]
    v_mfma_f32_16x16x32_bf16 v[124:127], v[44:47], v[24:27], v[124:127]
    buffer_load_dwordx4 v[44:47], v14, s[44:47], s75 offen offset:1024 sc1
    ds_read_b128 v[16:19], v7 offset:1024
    ds_read_b128 v[20:23], v7 offset:9216
    ds_read_b128 v[24:27], v7 offset:17408
    v_xor_b32 v7, 0x100, v7
    s_waitcnt lgkmcnt(3)
    s_waitcnt vmcnt(9)
    v_mfma_f32_16x16x32_bf16 v[80:83], v[48:51], v[28:31], v[80:83]
    v_mfma_f32_16x16x32_bf16 v[96:99], v[48:51], v[32:35], v[96:99]
    v_mfma_f32_16x16x32_bf16 v[112:115], v[48:51], v[36:39], v[112:115]
    buffer_load_dwordx4 v[48:51], v14, s[44:47], s75 offen offset:2048 sc1
    s_waitcnt vmcnt(9)
    v_mfma_f32_16x16x32_bf16 v[84:87], v[52:55], v[28:31], v[84:87]
    v_mfma_f32_16x16x32_bf16 v[100:103], v[52:55], v[32:35], v[100:103]
    v_mfma_f32_16x16x32_bf16 v[116:119], v[52:55], v[36:39], v[116:119]
    buffer_load_dwordx4 v[52:55], v14, s[44:47], s75 offen offset:3072 sc1
    s_xor_b32 s75, s75, 12288
    s_waitcnt vmcnt(9)
    v_mfma_f32_16x16x32_bf16 v[88:91], v[56:59], v[28:31], v[88:91]
    v_mfma_f32_16x16x32_bf16 v[104:107], v[56:59], v[32:35], v[104:107]
    v_mfma_f32_16x16x32_bf16 v[120:123], v[56:59], v[36:39], v[120:123]
    buffer_load_dwordx4 v[56:59], v14, s[44:47], s75 offen offset:0 sc1
    s_waitcnt vmcnt(9)
    v_mfma_f32_16x16x32_bf16 v[92:95], v[60:63], v[28:31], v[92:95]
    v_mfma_f32_16x16x32_bf16 v[108:111], v[60:63], v[32:35], v[108:111]
    v_mfma_f32_16x16x32_bf16 v[124:127], v[60:63], v[36:39], v[124:127]
    buffer_load_dwordx4 v[60:63], v14, s[44:47], s75 offen offset:1024 sc1
    ds_read_b128 v[28:31], v8 offset:1024
    ds_read_b128 v[32:35], v8 offset:9216
    ds_read_b128 v[36:39], v8 offset:17408
    v_xor_b32 v8, 0x100, v8
    s_waitcnt lgkmcnt(3)
    s_waitcnt vmcnt(9)
    v_mfma_f32_16x16x32_bf16 v[80:83], v[64:67], v[16:19], v[80:83]
    v_mfma_f32_16x16x32_bf16 v[96:99], v[64:67], v[20:23], v[96:99]
    v_mfma_f32_16x16x32_bf16 v[112:115], v[64:67], v[24:27], v[112:115]
    buffer_load_dwordx4 v[64:67], v14, s[44:47], s75 offen offset:2048 sc1
    s_waitcnt vmcnt(9)
    v_mfma_f32_16x16x32_bf16 v[84:87], v[68:71], v[16:19], v[84:87]
    v_mfma_f32_16x16x32_bf16 v[100:103], v[68:71], v[20:23], v[100:103]
    v_mfma_f32_16x16x32_bf16 v[116:119], v[68:71], v[24:27], v[116:119]
    buffer_load_dwordx4 v[68:71], v14, s[44:47], s75 offen offset:3072 sc1
    s_xor_b32 s75, s75, 4096
    s_waitcnt vmcnt(9)
    v_mfma_f32_16x16x32_bf16 v[88:91], v[72:75], v[16:19], v[88:91]
    v_mfma_f32_16x16x32_bf16 v[104:107], v[72:75], v[20:23], v[104:107]
    v_mfma_f32_16x16x32_bf16 v[120:123], v[72:75], v[24:27], v[120:123]
    buffer_load_dwordx4 v[72:75], v14, s[44:47], s75 offen offset:0 sc1
    s_waitcnt vmcnt(9)
    v_mfma_f32_16x16x32_bf16 v[92:95], v[76:79], v[16:19], v[92:95]
    v_mfma_f32_16x16x32_bf16 v[108:111], v[76:79], v[20:23], v[108:111]
    v_mfma_f32_16x16x32_bf16 v[124:127], v[76:79], v[24:27], v[124:127]
    buffer_load_dwordx4 v[76:79], v14, s[44:47], s75 offen offset:1024 sc1
    ds_read_b128 v[16:19], v9 offset:1024
    ds_read_b128 v[20:23], v9 offset:9216
    ds_read_b128 v[24:27], v9 offset:17408
    v_xor_b32 v9, 0x100, v9
    s_waitcnt lgkmcnt(3)
    s_waitcnt vmcnt(9)
    v_mfma_f32_16x16x32_bf16 v[80:83], v[40:43], v[28:31], v[80:83]
    v_mfma_f32_16x16x32_bf16 v[96:99], v[40:43], v[32:35], v[96:99]
    v_mfma_f32_16x16x32_bf16 v[112:115], v[40:43], v[36:39], v[112:115]
    buffer_load_dwordx4 v[40:43], v14, s[44:47], s75 offen offset:2048 sc1
    s_waitcnt vmcnt(9)
    v_mfma_f32_16x16x32_bf16 v[84:87], v[44:47], v[28:31], v[84:87]
    v_mfma_f32_16x16x32_bf16 v[100:103], v[44:47], v[32:35], v[100:103]
    v_mfma_f32_16x16x32_bf16 v[116:119], v[44:47], v[36:39], v[116:119]
    buffer_load_dwordx4 v[44:47], v14, s[44:47], s75 offen offset:3072 sc1
    s_xor_b32 s75, s75, 28672
    s_waitcnt vmcnt(9)
    v_mfma_f32_16x16x32_bf16 v[88:91], v[48:51], v[28:31], v[88:91]
    v_mfma_f32_16x16x32_bf16 v[104:107], v[48:51], v[32:35], v[104:107]
    v_mfma_f32_16x16x32_bf16 v[120:123], v[48:51], v[36:39], v[120:123]
    s_add_u32 m0, s70, 0
    s_nop 0
    buffer_load_dwordx4 v13, s[40:43], 0 offen offset:0 lds
    s_waitcnt vmcnt(9)
    v_mfma_f32_16x16x32_bf16 v[92:95], v[52:55], v[28:31], v[92:95]
    v_mfma_f32_16x16x32_bf16 v[108:111], v[52:55], v[32:35], v[108:111]
    v_mfma_f32_16x16x32_bf16 v[124:127], v[52:55], v[36:39], v[124:127]
    buffer_load_dwordx4 v13, s[40:43], s71 offen offset:1024 lds
    ds_read_b128 v[28:31], v10 offset:1024
    ds_read_b128 v[32:35], v10 offset:9216
    ds_read_b128 v[36:39], v10 offset:17408
    v_xor_b32 v10, 0x100, v10
    s_waitcnt lgkmcnt(3)
    s_waitcnt vmcnt(9)
    v_mfma_f32_16x16x32_bf16 v[80:83], v[56:59], v[16:19], v[80:83]
    v_mfma_f32_16x16x32_bf16 v[96:99], v[56:59], v[20:23], v[96:99]
    v_mfma_f32_16x16x32_bf16 v[112:115], v[56:59], v[24:27], v[112:115]
    buffer_load_dwordx4 v13, s[40:43], s72 offen offset:2048 lds
    s_waitcnt vmcnt(9)
    v_mfma_f32_16x16x32_bf16 v[84:87], v[60:63], v[16:19], v[84:87]
    v_mfma_f32_16x16x32_bf16 v[100:103], v[60:63], v[20:23], v[100:103]
    v_mfma_f32_16x16x32_bf16 v[116:119], v[60:63], v[24:27], v[116:119]
    buffer_load_dwordx4 v13, s[40:43], s73 offen offset:3072 lds
    v_xor_b32 v13, 16384, v13
    s_waitcnt vmcnt(9)
    v_mfma_f32_16x16x32_bf16 v[88:91], v[64:67], v[16:19], v[88:91]
    v_mfma_f32_16x16x32_bf16 v[104:107], v[64:67], v[20:23], v[104:107]
    v_mfma_f32_16x16x32_bf16 v[120:123], v[64:67], v[24:27], v[120:123]
    s_add_u32 m0, s70, 4096
    s_nop 0
    buffer_load_dwordx4 v13, s[40:43], 0 offen offset:0 lds
    s_waitcnt vmcnt(9)
    v_mfma_f32_16x16x32_bf16 v[92:95], v[68:71], v[16:19], v[92:95]
    v_mfma_f32_16x16x32_bf16 v[108:111], v[68:71], v[20:23], v[108:111]
    v_mfma_f32_16x16x32_bf16 v[124:127], v[68:71], v[24:27], v[124:127]
    buffer_load_dwordx4 v13, s[40:43], s71 offen offset:1024 lds
    s_waitcnt lgkmcnt(0)
    s_waitcnt vmcnt(9)
    v_mfma_f32_16x16x32_bf16 v[80:83], v[72:75], v[28:31], v[80:83]
    v_mfma_f32_16x16x32_bf16 v[96:99], v[72:75], v[32:35], v[96:99]
    v_mfma_f32_16x16x32_bf16 v[112:115], v[72:75], v[36:39], v[112:115]
    buffer_load_dwordx4 v13, s[40:43], s72 offen offset:2048 lds
    s_waitcnt vmcnt(9)
    v_mfma_f32_16x16x32_bf16 v[84:87], v[76:79], v[28:31], v[84:87]
    v_mfma_f32_16x16x32_bf16 v[100:103], v[76:79], v[32:35], v[100:103]
    v_mfma_f32_16x16x32_bf16 v[116:119], v[76:79], v[36:39], v[116:119]
    buffer_load_dwordx4 v13, s[40:43], s73 offen offset:3072 lds
    v_xor_b32 v13, 49152, v13
    s_waitcnt vmcnt(9)
    v_mfma_f32_16x16x32_bf16 v[88:91], v[40:43], v[28:31], v[88:91]
    v_mfma_f32_16x16x32_bf16 v[104:107], v[40:43], v[32:35], v[104:107]
    v_mfma_f32_16x16x32_bf16 v[120:123], v[40:43], v[36:39], v[120:123]
    s_add_u32 m0, s70, 8192
    s_nop 0
    buffer_load_dwordx4 v13, s[40:43], 0 offen offset:0 lds
    s_waitcnt vmcnt(9)
    v_mfma_f32_16x16x32_bf16 v[92:95], v[44:47], v[28:31], v[92:95]
    v_mfma_f32_16x16x32_bf16 v[108:111], v[44:47], v[32:35], v[108:111]
    v_mfma_f32_16x16x32_bf16 v[124:127], v[44:47], v[36:39], v[124:127]
    buffer_load_dwordx4 v13, s[40:43], s71 offen offset:1024 lds
    s_lshl_b32 s64, s31, 3
    v_add_u32 v0, s64, v4
    v_xor_b32 v0, v0, v3
    v_lshlrev_b32 v0, 4, v0
    v_lshl_add_u32 v0, v3, 9, v0
    v_xor_b32 v1, 64, v0
    s_mov_b32 s76, 0x00ff00ff
    s_mov_b32 s77, 0x00ff00ff
    v_cvt_pk_bf16_f32 v16, v80, v81
    v_cvt_pk_bf16_f32 v17, v82, v83
    v_cvt_pk_bf16_f32 v18, v84, v85
    v_cvt_pk_bf16_f32 v19, v86, v87
    ds_write_b128 v0, v[16:19] offset:21504
    v_cvt_pk_bf16_f32 v20, v88, v89
    v_cvt_pk_bf16_f32 v21, v90, v91
    v_cvt_pk_bf16_f32 v22, v92, v93
    v_cvt_pk_bf16_f32 v23, v94, v95
    ds_write_b128 v1, v[20:23] offset:21504
    v_cvt_pk_bf16_f32 v24, v96, v97
    v_cvt_pk_bf16_f32 v25, v98, v99
    v_cvt_pk_bf16_f32 v26, v100, v101
    v_cvt_pk_bf16_f32 v27, v102, v103
    ds_write_b128 v0, v[24:27] offset:29696
    v_cvt_pk_bf16_f32 v28, v104, v105
    v_cvt_pk_bf16_f32 v29, v106, v107
    v_cvt_pk_bf16_f32 v30, v108, v109
    v_cvt_pk_bf16_f32 v31, v110, v111
    ds_write_b128 v1, v[28:31] offset:29696
    s_mov_b64 exec, s[76:77]
    v_cvt_pk_bf16_f32 v32, v112, v113
    v_cvt_pk_bf16_f32 v33, v114, v115
    v_cvt_pk_bf16_f32 v34, v116, v117
    v_cvt_pk_bf16_f32 v35, v118, v119
    ds_write_b128 v0, v[32:35] offset:37888
    v_cvt_pk_bf16_f32 v36, v120, v121
    v_cvt_pk_bf16_f32 v37, v122, v123
    v_cvt_pk_bf16_f32 v38, v124, v125
    v_cvt_pk_bf16_f32 v39, v126, v127
    ds_write_b128 v1, v[36:39] offset:37888
    s_mov_b64 exec, -1
    s_waitcnt lgkmcnt(0)
    s_barrier
    buffer_load_dwordx4 v13, s[40:43], s72 offen offset:2048 lds
    buffer_load_dwordx4 v13, s[40:43], s73 offen offset:3072 lds
    v_xor_b32 v13, 16384, v13
    s_add_u32 m0, s70, 12288
    s_nop 0
    buffer_load_dwordx4 v13, s[40:43], 0 offen offset:0 lds
    buffer_load_dwordx4 v13, s[40:43], s71 offen offset:1024 lds
    buffer_load_dwordx4 v13, s[40:43], s72 offen offset:2048 lds
    buffer_load_dwordx4 v13, s[40:43], s73 offen offset:3072 lds
    v_xor_b32 v13, 114688, v13
    v_lshlrev_b32 v0, 4, v4
    v_and_b32 v1, 7, v3
    v_lshl_add_u32 v0, v1, 9, v0
    v_and_b32 v1, 8, v3
    v_lshl_add_u32 v0, v1, 3, v0
    s_mul_i32 s74, s1, 20480
    s_lshl_b32 s64, s31, 7
    s_add_u32 s74, s74, s64
    s_waitcnt vmcnt(8)
    ds_read_b64_tr_b16 v[48:49], v11 offset:0
    ds_read_b64_tr_b16 v[50:51], v11 offset:512
    ds_read_b64_tr_b16 v[52:53], v11 offset:8
    ds_read_b64_tr_b16 v[54:55], v11 offset:520
    ds_read_b64_tr_b16 v[56:57], v12 offset:0
    ds_read_b64_tr_b16 v[58:59], v12 offset:512
    ds_read_b64_tr_b16 v[60:61], v12 offset:8
    ds_read_b64_tr_b16 v[62:63], v12 offset:520
    ds_read_b64_tr_b16 v[64:65], v11 offset:4096
    ds_read_b64_tr_b16 v[66:67], v11 offset:4608
    ds_read_b64_tr_b16 v[68:69], v11 offset:4104
    ds_read_b64_tr_b16 v[70:71], v11 offset:4616
    ds_read_b64_tr_b16 v[72:73], v12 offset:4096
    ds_read_b64_tr_b16 v[74:75], v12 offset:4608
    ds_read_b64_tr_b16 v[76:77], v12 offset:4104
    ds_read_b64_tr_b16 v[78:79], v12 offset:4616
    s_waitcnt lgkmcnt(8)
    s_add_u32 m0, s70, 0
    s_nop 0
    buffer_load_dwordx4 v13, s[40:43], 0 offen offset:0 lds
    buffer_load_dwordx4 v13, s[40:43], s71 offen offset:1024 lds
    buffer_load_dwordx4 v13, s[40:43], s72 offen offset:2048 lds
    buffer_load_dwordx4 v13, s[40:43], s73 offen offset:3072 lds
    v_xor_b32 v13, 16384, v13
    s_waitcnt lgkmcnt(0)
    s_add_u32 m0, s70, 4096
    s_nop 0
    buffer_load_dwordx4 v13, s[40:43], 0 offen offset:0 lds
    buffer_load_dwordx4 v13, s[40:43], s71 offen offset:1024 lds
    buffer_load_dwordx4 v13, s[40:43], s72 offen offset:2048 lds
    buffer_load_dwordx4 v13, s[40:43], s73 offen offset:3072 lds
    v_xor_b32 v13, 49152, v13
    s_lshl_b32 s64, s31, 12
    s_add_u32 s78, s64, 21504
    s_add_u32 s79, s64, 148480
    s_cmp_eq_u32 s31, 3
    s_cselect_b32 s79, 37888, s79
    s_sub_u32 s76, s78, s70
    s_sub_u32 s77, s79, s78
    v_xor_b32 v40, 0x100, v7
    v_xor_b32 v41, 0x100, v8
    v_xor_b32 v42, 0x100, v9
    v_xor_b32 v43, 0x100, v10
    s_barrier
    s_mov_b32 m0, s78
    s_nop 0
    buffer_load_dwordx4 v13, s[40:43], 0 offen offset:0 lds
    buffer_load_dwordx4 v13, s[40:43], s71 offen offset:1024 lds
    buffer_load_dwordx4 v13, s[40:43], s72 offen offset:2048 lds
    buffer_load_dwordx4 v13, s[40:43], s73 offen offset:3072 lds
    v_xor_b32 v13, 16384, v13
    s_mov_b32 m0, s79
    s_nop 0
    buffer_load_dwordx4 v13, s[40:43], 0 offen offset:0 lds
    buffer_load_dwordx4 v13, s[40:43], s71 offen offset:1024 lds
    buffer_load_dwordx4 v13, s[40:43], s72 offen offset:2048 lds
    buffer_load_dwordx4 v13, s[40:43], s73 offen offset:3072 lds
    v_xor_b32 v13, 114688, v13
    s_setprio 0
L_prog_43:
    ds_read_b128 v[16:19], v5 offset:32
    s_waitcnt lgkmcnt(0)
    v_min3_u32 v16, v16, v17, v18
    v_min_u32 v16, v16, v19
    v_cmp_gt_u32 vcc, 1, v16
    s_cbranch_vccnz L_retry_44
    ds_read_b128 v[16:19], v7 offset:1024
    ds_read_b128 v[20:23], v7 offset:9216
    ds_read_b128 v[24:27], v7 offset:17408
    s_waitcnt vmcnt(8)
    s_waitcnt lgkmcnt(0)
    v_mfma_f32_16x16x32_bf16 v[80:83], v[128:131], v[16:19], 0
    ds_read_b128 v[28:31], v8 offset:1024
    v_mfma_f32_16x16x32_bf16 v[96:99], v[128:131], v[20:23], 0
    ds_read_b128 v[32:35], v8 offset:9216
    v_mfma_f32_16x16x32_bf16 v[112:115], v[128:131], v[24:27], 0
    ds_read_b128 v[36:39], v8 offset:17408
    v_mfma_f32_16x16x32_bf16 v[84:87], v[132:135], v[16:19], 0
    v_mfma_f32_16x16x32_bf16 v[100:103], v[132:135], v[20:23], 0
    v_mfma_f32_16x16x32_bf16 v[116:119], v[132:135], v[24:27], 0
    v_mfma_f32_16x16x32_bf16 v[88:91], v[136:139], v[16:19], 0
    v_mfma_f32_16x16x32_bf16 v[104:107], v[136:139], v[20:23], 0
    v_mfma_f32_16x16x32_bf16 v[120:123], v[136:139], v[24:27], 0
    v_mfma_f32_16x16x32_bf16 v[92:95], v[140:143], v[16:19], 0
    v_mfma_f32_16x16x32_bf16 v[108:111], v[140:143], v[20:23], 0
    v_mfma_f32_16x16x32_bf16 v[124:127], v[140:143], v[24:27], 0
    s_waitcnt lgkmcnt(0)
    v_mfma_f32_16x16x32_bf16 v[80:83], v[144:147], v[28:31], v[80:83]
    ds_read_b128 v[16:19], v9 offset:1024
    v_mfma_f32_16x16x32_bf16 v[96:99], v[144:147], v[32:35], v[96:99]
    ds_read_b128 v[20:23], v9 offset:9216
    v_mfma_f32_16x16x32_bf16 v[112:115], v[144:147], v[36:39], v[112:115]
    ds_read_b128 v[24:27], v9 offset:17408
    v_mfma_f32_16x16x32_bf16 v[84:87], v[148:151], v[28:31], v[84:87]
    ds_read_b64_tr_b16 v[128:129], v11 offset:8192
    v_mfma_f32_16x16x32_bf16 v[100:103], v[148:151], v[32:35], v[100:103]
    ds_read_b64_tr_b16 v[130:131], v11 offset:8704
    v_mfma_f32_16x16x32_bf16 v[116:119], v[148:151], v[36:39], v[116:119]
    ds_read_b64_tr_b16 v[132:133], v11 offset:8200
    v_mfma_f32_16x16x32_bf16 v[88:91], v[152:155], v[28:31], v[88:91]
    ds_read_b64_tr_b16 v[134:135], v11 offset:8712
    v_mfma_f32_16x16x32_bf16 v[104:107], v[152:155], v[32:35], v[104:107]
    ds_read_b64_tr_b16 v[136:137], v12 offset:8192
    v_mfma_f32_16x16x32_bf16 v[120:123], v[152:155], v[36:39], v[120:123]
    ds_read_b64_tr_b16 v[138:139], v12 offset:8704
    v_mfma_f32_16x16x32_bf16 v[92:95], v[156:159], v[28:31], v[92:95]
    ds_read_b64_tr_b16 v[140:141], v12 offset:8200
    v_mfma_f32_16x16x32_bf16 v[108:111], v[156:159], v[32:35], v[108:111]
    ds_read_b64_tr_b16 v[142:143], v12 offset:8712
    v_mfma_f32_16x16x32_bf16 v[124:127], v[156:159], v[36:39], v[124:127]
    s_waitcnt lgkmcnt(8)
    v_mfma_f32_16x16x32_bf16 v[80:83], v[160:163], v[16:19], v[80:83]
    ds_read_b128 v[28:31], v10 offset:1024
    v_mfma_f32_16x16x32_bf16 v[96:99], v[160:163], v[20:23], v[96:99]
    ds_read_b128 v[32:35], v10 offset:9216
    v_mfma_f32_16x16x32_bf16 v[112:115], v[160:163], v[24:27], v[112:115]
    ds_read_b128 v[36:39], v10 offset:17408
    v_mfma_f32_16x16x32_bf16 v[84:87], v[164:167], v[16:19], v[84:87]
    ds_read_b64_tr_b16 v[144:145], v11 offset:12288
    v_mfma_f32_16x16x32_bf16 v[100:103], v[164:167], v[20:23], v[100:103]
    ds_read_b64_tr_b16 v[146:147], v11 offset:12800
    v_mfma_f32_16x16x32_bf16 v[116:119], v[164:167], v[24:27], v[116:119]
    ds_read_b64_tr_b16 v[148:149], v11 offset:12296
    v_mfma_f32_16x16x32_bf16 v[88:91], v[168:171], v[16:19], v[88:91]
    ds_read_b64_tr_b16 v[150:151], v11 offset:12808
    v_mfma_f32_16x16x32_bf16 v[104:107], v[168:171], v[20:23], v[104:107]
    ds_read_b64_tr_b16 v[152:153], v12 offset:12288
    v_mfma_f32_16x16x32_bf16 v[120:123], v[168:171], v[24:27], v[120:123]
    ds_read_b64_tr_b16 v[154:155], v12 offset:12800
    v_mfma_f32_16x16x32_bf16 v[92:95], v[172:175], v[16:19], v[92:95]
    ds_read_b64_tr_b16 v[156:157], v12 offset:12296
    v_mfma_f32_16x16x32_bf16 v[108:111], v[172:175], v[20:23], v[108:111]
    ds_read_b64_tr_b16 v[158:159], v12 offset:12808
    v_mfma_f32_16x16x32_bf16 v[124:127], v[172:175], v[24:27], v[124:127]
    s_waitcnt lgkmcnt(8)
    v_mfma_f32_16x16x32_bf16 v[80:83], v[176:179], v[28:31], v[80:83]
    ds_read_b128 v[16:19], v40 offset:1024
    v_mfma_f32_16x16x32_bf16 v[96:99], v[176:179], v[32:35], v[96:99]
    ds_read_b128 v[20:23], v40 offset:9216
    v_mfma_f32_16x16x32_bf16 v[112:115], v[176:179], v[36:39], v[112:115]
    ds_read_b128 v[24:27], v40 offset:17408
    v_mfma_f32_16x16x32_bf16 v[84:87], v[180:183], v[28:31], v[84:87]
    ds_read_b64_tr_b16 v[160:161], v11 offset:0
    v_mfma_f32_16x16x32_bf16 v[100:103], v[180:183], v[32:35], v[100:103]
    ds_read_b64_tr_b16 v[162:163], v11 offset:512
    v_mfma_f32_16x16x32_bf16 v[116:119], v[180:183], v[36:39], v[116:119]
    ds_read_b64_tr_b16 v[164:165], v11 offset:8
    v_mfma_f32_16x16x32_bf16 v[88:91], v[184:187], v[28:31], v[88:91]
    ds_read_b64_tr_b16 v[166:167], v11 offset:520
    v_mfma_f32_16x16x32_bf16 v[104:107], v[184:187], v[32:35], v[104:107]
    ds_read_b64_tr_b16 v[168:169], v12 offset:0
    v_mfma_f32_16x16x32_bf16 v[120:123], v[184:187], v[36:39], v[120:123]
    ds_read_b64_tr_b16 v[170:171], v12 offset:512
    v_mfma_f32_16x16x32_bf16 v[92:95], v[188:191], v[28:31], v[92:95]
    ds_read_b64_tr_b16 v[172:173], v12 offset:8
    v_mfma_f32_16x16x32_bf16 v[108:111], v[188:191], v[32:35], v[108:111]
    ds_read_b64_tr_b16 v[174:175], v12 offset:520
    v_mfma_f32_16x16x32_bf16 v[124:127], v[188:191], v[36:39], v[124:127]
    s_waitcnt lgkmcnt(8)
    v_mfma_f32_16x16x32_bf16 v[80:83], v[192:195], v[16:19], v[80:83]
    ds_read_b128 v[28:31], v41 offset:1024
    v_mfma_f32_16x16x32_bf16 v[96:99], v[192:195], v[20:23], v[96:99]
    ds_read_b128 v[32:35], v41 offset:9216
    v_mfma_f32_16x16x32_bf16 v[112:115], v[192:195], v[24:27], v[112:115]
    ds_read_b128 v[36:39], v41 offset:17408
    v_mfma_f32_16x16x32_bf16 v[84:87], v[196:199], v[16:19], v[84:87]
    ds_read_b64_tr_b16 v[176:177], v11 offset:4096
    v_mfma_f32_16x16x32_bf16 v[100:103], v[196:199], v[20:23], v[100:103]
    ds_read_b64_tr_b16 v[178:179], v11 offset:4608
    v_mfma_f32_16x16x32_bf16 v[116:119], v[196:199], v[24:27], v[116:119]
    ds_read_b64_tr_b16 v[180:181], v11 offset:4104
    v_mfma_f32_16x16x32_bf16 v[88:91], v[200:203], v[16:19], v[88:91]
    ds_read_b64_tr_b16 v[182:183], v11 offset:4616
    v_mfma_f32_16x16x32_bf16 v[104:107], v[200:203], v[20:23], v[104:107]
    ds_read_b64_tr_b16 v[184:185], v12 offset:4096
    v_mfma_f32_16x16x32_bf16 v[120:123], v[200:203], v[24:27], v[120:123]
    ds_read_b64_tr_b16 v[186:187], v12 offset:4608
    v_mfma_f32_16x16x32_bf16 v[92:95], v[204:207], v[16:19], v[92:95]
    ds_read_b64_tr_b16 v[188:189], v12 offset:4104
    v_mfma_f32_16x16x32_bf16 v[108:111], v[204:207], v[20:23], v[108:111]
    ds_read_b64_tr_b16 v[190:191], v12 offset:4616
    v_mfma_f32_16x16x32_bf16 v[124:127], v[204:207], v[24:27], v[124:127]
    s_waitcnt lgkmcnt(8)
    v_mfma_f32_16x16x32_bf16 v[80:83], v[208:211], v[28:31], v[80:83]
    ds_read_b128 v[16:19], v42 offset:1024
    v_mfma_f32_16x16x32_bf16 v[96:99], v[208:211], v[32:35], v[96:99]
    ds_read_b128 v[20:23], v42 offset:9216
    v_mfma_f32_16x16x32_bf16 v[112:115], v[208:211], v[36:39], v[112:115]
    ds_read_b128 v[24:27], v42 offset:17408
    v_mfma_f32_16x16x32_bf16 v[84:87], v[212:215], v[28:31], v[84:87]
    v_mfma_f32_16x16x32_bf16 v[100:103], v[212:215], v[32:35], v[100:103]
    v_mfma_f32_16x16x32_bf16 v[116:119], v[212:215], v[36:39], v[116:119]
    v_mfma_f32_16x16x32_bf16 v[88:91], v[216:219], v[28:31], v[88:91]
    v_mfma_f32_16x16x32_bf16 v[104:107], v[216:219], v[32:35], v[104:107]
    v_mfma_f32_16x16x32_bf16 v[120:123], v[216:219], v[36:39], v[120:123]
    v_mfma_f32_16x16x32_bf16 v[92:95], v[220:223], v[28:31], v[92:95]
    v_mfma_f32_16x16x32_bf16 v[108:111], v[220:223], v[32:35], v[108:111]
    v_mfma_f32_16x16x32_bf16 v[124:127], v[220:223], v[36:39], v[124:127]
    s_waitcnt lgkmcnt(0)
    v_mfma_f32_16x16x32_bf16 v[80:83], v[224:227], v[16:19], v[80:83]
    v_add_u32 v11, s76, v11
    v_add_u32 v12, s76, v12
    v_mfma_f32_16x16x32_bf16 v[96:99], v[224:227], v[20:23], v[96:99]
    ds_read_b128 v[28:31], v43 offset:1024
    v_mfma_f32_16x16x32_bf16 v[112:115], v[224:227], v[24:27], v[112:115]
    ds_read_b128 v[32:35], v43 offset:9216
    v_mfma_f32_16x16x32_bf16 v[84:87], v[228:231], v[16:19], v[84:87]
    ds_read_b128 v[36:39], v43 offset:17408
    v_mfma_f32_16x16x32_bf16 v[100:103], v[228:231], v[20:23], v[100:103]
    s_waitcnt vmcnt(4)
    ds_read_b64_tr_b16 v[192:193], v11 offset:0
    v_mfma_f32_16x16x32_bf16 v[116:119], v[228:231], v[24:27], v[116:119]
    ds_read_b64_tr_b16 v[194:195], v11 offset:512
    v_mfma_f32_16x16x32_bf16 v[88:91], v[232:235], v[16:19], v[88:91]
    ds_read_b64_tr_b16 v[196:197], v11 offset:8
    v_mfma_f32_16x16x32_bf16 v[104:107], v[232:235], v[20:23], v[104:107]
    ds_read_b64_tr_b16 v[198:199], v11 offset:520
    v_mfma_f32_16x16x32_bf16 v[120:123], v[232:235], v[24:27], v[120:123]
    ds_read_b64_tr_b16 v[200:201], v12 offset:0
    v_mfma_f32_16x16x32_bf16 v[92:95], v[236:239], v[16:19], v[92:95]
    ds_read_b64_tr_b16 v[202:203], v12 offset:512
    v_mfma_f32_16x16x32_bf16 v[108:111], v[236:239], v[20:23], v[108:111]
    ds_read_b64_tr_b16 v[204:205], v12 offset:8
    v_mfma_f32_16x16x32_bf16 v[124:127], v[236:239], v[24:27], v[124:127]
    ds_read_b64_tr_b16 v[206:207], v12 offset:520
    s_waitcnt lgkmcnt(8)
    v_mfma_f32_16x16x32_bf16 v[80:83], v[240:243], v[28:31], v[80:83]
    v_add_u32 v11, s77, v11
    v_add_u32 v12, s77, v12
    v_mfma_f32_16x16x32_bf16 v[96:99], v[240:243], v[32:35], v[96:99]
    s_waitcnt vmcnt(0)
    ds_read_b64_tr_b16 v[208:209], v11 offset:0
    v_mfma_f32_16x16x32_bf16 v[112:115], v[240:243], v[36:39], v[112:115]
    ds_read_b64_tr_b16 v[210:211], v11 offset:512
    v_mfma_f32_16x16x32_bf16 v[84:87], v[244:247], v[28:31], v[84:87]
    ds_read_b64_tr_b16 v[212:213], v11 offset:8
    v_mfma_f32_16x16x32_bf16 v[100:103], v[244:247], v[32:35], v[100:103]
    ds_read_b64_tr_b16 v[214:215], v11 offset:520
    v_mfma_f32_16x16x32_bf16 v[116:119], v[244:247], v[36:39], v[116:119]
    ds_read_b64_tr_b16 v[216:217], v12 offset:0
    v_mfma_f32_16x16x32_bf16 v[88:91], v[248:251], v[28:31], v[88:91]
    ds_read_b64_tr_b16 v[218:219], v12 offset:512
    v_mfma_f32_16x16x32_bf16 v[104:107], v[248:251], v[32:35], v[104:107]
    ds_read_b64_tr_b16 v[220:221], v12 offset:8
    v_mfma_f32_16x16x32_bf16 v[120:123], v[248:251], v[36:39], v[120:123]
    ds_read_b64_tr_b16 v[222:223], v12 offset:520
    v_mfma_f32_16x16x32_bf16 v[92:95], v[252:255], v[28:31], v[92:95]
    v_mfma_f32_16x16x32_bf16 v[108:111], v[252:255], v[32:35], v[108:111]
    v_mfma_f32_16x16x32_bf16 v[124:127], v[252:255], v[36:39], v[124:127]
    s_add_u32 s75, s74, 4096
    s_add_u32 s76, s74, 8192
    s_add_u32 s77, s74, 12288
    s_add_u32 s78, s74, 16384
L_prog_45:
    ds_read_b128 v[16:19], v5 offset:32
    s_waitcnt lgkmcnt(0)
    v_min3_u32 v16, v16, v17, v18
    v_min_u32 v16, v16, v19
    v_cmp_gt_u32 vcc, 1, v16
    s_cbranch_vccnz L_retry_46
    ds_read_b128 v[16:19], v7 offset:58368
    ds_read_b128 v[20:23], v8 offset:58368
    ds_read_b128 v[24:27], v9 offset:58368
    ds_read_b128 v[28:31], v10 offset:58368
    ds_read_b128 v[32:35], v40 offset:58368
    ds_read_b128 v[36:39], v41 offset:58368
    ds_read_b128 v[44:47], v42 offset:58368
    ds_read_b128 v[252:255], v43 offset:58368
    s_waitcnt lgkmcnt(7)
    v_mfma_f32_16x16x32_bf16 v[120:123], v[56:59], v[16:19], v[120:123]
    v_mfma_f32_16x16x32_bf16 v[124:127], v[60:63], v[16:19], v[124:127]
    v_mfma_f32_16x16x32_bf16 v[112:115], v[48:51], v[16:19], v[112:115]
    v_mfma_f32_16x16x32_bf16 v[116:119], v[52:55], v[16:19], v[116:119]
    s_waitcnt lgkmcnt(6)
    v_mfma_f32_16x16x32_bf16 v[120:123], v[72:75], v[20:23], v[120:123]
    v_mfma_f32_16x16x32_bf16 v[124:127], v[76:79], v[20:23], v[124:127]
    v_mfma_f32_16x16x32_bf16 v[112:115], v[64:67], v[20:23], v[112:115]
    v_mfma_f32_16x16x32_bf16 v[116:119], v[68:71], v[20:23], v[116:119]
    s_waitcnt lgkmcnt(5)
    v_mfma_f32_16x16x32_bf16 v[120:123], v[136:139], v[24:27], v[120:123]
    v_mfma_f32_16x16x32_bf16 v[124:127], v[140:143], v[24:27], v[124:127]
    v_mfma_f32_16x16x32_bf16 v[112:115], v[128:131], v[24:27], v[112:115]
    v_mfma_f32_16x16x32_bf16 v[116:119], v[132:135], v[24:27], v[116:119]
    s_waitcnt lgkmcnt(4)
    v_mfma_f32_16x16x32_bf16 v[120:123], v[152:155], v[28:31], v[120:123]
    v_mfma_f32_16x16x32_bf16 v[124:127], v[156:159], v[28:31], v[124:127]
    v_mfma_f32_16x16x32_bf16 v[112:115], v[144:147], v[28:31], v[112:115]
    v_mfma_f32_16x16x32_bf16 v[116:119], v[148:151], v[28:31], v[116:119]
    s_waitcnt lgkmcnt(3)
    v_mfma_f32_16x16x32_bf16 v[120:123], v[168:171], v[32:35], v[120:123]
    v_mfma_f32_16x16x32_bf16 v[124:127], v[172:175], v[32:35], v[124:127]
    v_mfma_f32_16x16x32_bf16 v[112:115], v[160:163], v[32:35], v[112:115]
    v_mfma_f32_16x16x32_bf16 v[116:119], v[164:167], v[32:35], v[116:119]
    s_waitcnt lgkmcnt(2)
    v_mfma_f32_16x16x32_bf16 v[120:123], v[184:187], v[36:39], v[120:123]
    v_mfma_f32_16x16x32_bf16 v[124:127], v[188:191], v[36:39], v[124:127]
    v_mfma_f32_16x16x32_bf16 v[112:115], v[176:179], v[36:39], v[112:115]
    v_mfma_f32_16x16x32_bf16 v[116:119], v[180:183], v[36:39], v[116:119]
    s_waitcnt lgkmcnt(1)
    v_mfma_f32_16x16x32_bf16 v[120:123], v[200:203], v[44:47], v[120:123]
    v_mfma_f32_16x16x32_bf16 v[124:127], v[204:207], v[44:47], v[124:127]
    v_mfma_f32_16x16x32_bf16 v[112:115], v[192:195], v[44:47], v[112:115]
    v_mfma_f32_16x16x32_bf16 v[116:119], v[196:199], v[44:47], v[116:119]
    s_waitcnt lgkmcnt(0)
    v_mfma_f32_16x16x32_bf16 v[120:123], v[216:219], v[252:255], v[120:123]
    v_mfma_f32_16x16x32_bf16 v[124:127], v[220:223], v[252:255], v[124:127]
    v_mfma_f32_16x16x32_bf16 v[112:115], v[208:211], v[252:255], v[112:115]
    v_mfma_f32_16x16x32_bf16 v[116:119], v[212:215], v[252:255], v[116:119]
L_prog_47:
    ds_read_b128 v[16:19], v5 offset:32
    s_waitcnt lgkmcnt(0)
    v_min3_u32 v16, v16, v17, v18
    v_min_u32 v16, v16, v19
    v_cmp_gt_u32 vcc, 3, v16
    s_cbranch_vccnz L_retry_48
    ds_read_b128 v[16:19], v7 offset:41984
    ds_read_b128 v[20:23], v8 offset:41984
    ds_read_b128 v[24:27], v9 offset:41984
    ds_read_b128 v[28:31], v10 offset:41984
    ds_read_b128 v[32:35], v40 offset:41984
    ds_read_b128 v[36:39], v41 offset:41984
    ds_read_b128 v[44:47], v42 offset:41984
    ds_read_b128 v[252:255], v43 offset:41984
    s_waitcnt lgkmcnt(7)
    v_mfma_f32_16x16x32_bf16 v[88:91], v[56:59], v[16:19], v[88:91]
    v_cvt_pk_bf16_f32 v248, v120, v121
    v_mfma_f32_16x16x32_bf16 v[92:95], v[60:63], v[16:19], v[92:95]
    v_cvt_pk_bf16_f32 v249, v122, v123
    v_mfma_f32_16x16x32_bf16 v[80:83], v[48:51], v[16:19], v[80:83]
    v_cvt_pk_bf16_f32 v250, v124, v125
    v_mfma_f32_16x16x32_bf16 v[84:87], v[52:55], v[16:19], v[84:87]
    v_cvt_pk_bf16_f32 v251, v126, v127
    s_waitcnt lgkmcnt(6)
    v_mfma_f32_16x16x32_bf16 v[88:91], v[72:75], v[20:23], v[88:91]
    v_cvt_pk_bf16_f32 v244, v112, v113
    v_mfma_f32_16x16x32_bf16 v[92:95], v[76:79], v[20:23], v[92:95]
    v_cvt_pk_bf16_f32 v245, v114, v115
    v_mfma_f32_16x16x32_bf16 v[80:83], v[64:67], v[20:23], v[80:83]
    v_cvt_pk_bf16_f32 v246, v116, v117
    v_mfma_f32_16x16x32_bf16 v[84:87], v[68:71], v[20:23], v[84:87]
    v_cvt_pk_bf16_f32 v247, v118, v119
    s_waitcnt lgkmcnt(5)
    v_mfma_f32_16x16x32_bf16 v[88:91], v[136:139], v[24:27], v[88:91]
    v_mov_b32_dpp v244, v248 row_ror:8 row_mask:0xf bank_mask:0xc
    v_mfma_f32_16x16x32_bf16 v[92:95], v[140:143], v[24:27], v[92:95]
    v_mov_b32_dpp v245, v249 row_ror:8 row_mask:0xf bank_mask:0xc
    v_mfma_f32_16x16x32_bf16 v[80:83], v[128:131], v[24:27], v[80:83]
    v_mov_b32_dpp v246, v250 row_ror:8 row_mask:0xf bank_mask:0xc
    v_mfma_f32_16x16x32_bf16 v[84:87], v[132:135], v[24:27], v[84:87]
    v_mov_b32_dpp v247, v251 row_ror:8 row_mask:0xf bank_mask:0xc
    s_waitcnt lgkmcnt(4)
    v_mfma_f32_16x16x32_bf16 v[88:91], v[152:155], v[28:31], v[88:91]
    v_mfma_f32_16x16x32_bf16 v[92:95], v[156:159], v[28:31], v[92:95]
    v_mfma_f32_16x16x32_bf16 v[80:83], v[144:147], v[28:31], v[80:83]
    v_mfma_f32_16x16x32_bf16 v[84:87], v[148:151], v[28:31], v[84:87]
    s_waitcnt lgkmcnt(3)
    v_mfma_f32_16x16x32_bf16 v[88:91], v[168:171], v[32:35], v[88:91]
    v_mfma_f32_16x16x32_bf16 v[92:95], v[172:175], v[32:35], v[92:95]
    v_mfma_f32_16x16x32_bf16 v[80:83], v[160:163], v[32:35], v[80:83]
    v_mfma_f32_16x16x32_bf16 v[84:87], v[164:167], v[32:35], v[84:87]
    s_waitcnt lgkmcnt(2)
    v_mfma_f32_16x16x32_bf16 v[88:91], v[184:187], v[36:39], v[88:91]
    v_mfma_f32_16x16x32_bf16 v[92:95], v[188:191], v[36:39], v[92:95]
    v_mfma_f32_16x16x32_bf16 v[80:83], v[176:179], v[36:39], v[80:83]
    v_mfma_f32_16x16x32_bf16 v[84:87], v[180:183], v[36:39], v[84:87]
    s_waitcnt lgkmcnt(1)
    v_mfma_f32_16x16x32_bf16 v[88:91], v[200:203], v[44:47], v[88:91]
    v_mfma_f32_16x16x32_bf16 v[92:95], v[204:207], v[44:47], v[92:95]
    v_mfma_f32_16x16x32_bf16 v[80:83], v[192:195], v[44:47], v[80:83]
    v_mfma_f32_16x16x32_bf16 v[84:87], v[196:199], v[44:47], v[84:87]
    s_waitcnt lgkmcnt(0)
    v_mfma_f32_16x16x32_bf16 v[88:91], v[216:219], v[252:255], v[88:91]
    v_mfma_f32_16x16x32_bf16 v[92:95], v[220:223], v[252:255], v[92:95]
    v_mfma_f32_16x16x32_bf16 v[80:83], v[208:211], v[252:255], v[80:83]
    v_mfma_f32_16x16x32_bf16 v[84:87], v[212:215], v[252:255], v[84:87]
    s_nop 4
    v_cvt_pk_bf16_f32 v228, v88, v89
    v_cvt_pk_bf16_f32 v229, v90, v91
    v_cvt_pk_bf16_f32 v230, v92, v93
    v_cvt_pk_bf16_f32 v231, v94, v95
    v_cvt_pk_bf16_f32 v224, v80, v81
    v_cvt_pk_bf16_f32 v225, v82, v83
    v_cvt_pk_bf16_f32 v226, v84, v85
    v_cvt_pk_bf16_f32 v227, v86, v87
    v_cvt_pk_bf16_f32 v240, v80, v81
    v_cvt_pk_bf16_f32 v241, v82, v83
    v_cvt_pk_bf16_f32 v242, v84, v85
    v_cvt_pk_bf16_f32 v243, v86, v87
    v_mov_b32_dpp v224, v228 row_ror:8 row_mask:0xf bank_mask:0xc
    v_mov_b32_dpp v225, v229 row_ror:8 row_mask:0xf bank_mask:0xc
    v_mov_b32_dpp v226, v230 row_ror:8 row_mask:0xf bank_mask:0xc
    v_mov_b32_dpp v227, v231 row_ror:8 row_mask:0xf bank_mask:0xc
    v_mov_b32_dpp v228, v240 row_ror:8 row_mask:0xf bank_mask:0x3
    v_mov_b32_dpp v229, v241 row_ror:8 row_mask:0xf bank_mask:0x3
    v_mov_b32_dpp v230, v242 row_ror:8 row_mask:0xf bank_mask:0x3
    v_mov_b32_dpp v231, v243 row_ror:8 row_mask:0xf bank_mask:0x3
L_prog_49:
    ds_read_b128 v[16:19], v5 offset:48
    s_waitcnt lgkmcnt(0)
    v_min3_u32 v16, v16, v17, v18
    v_min_u32 v16, v16, v19
    v_cmp_gt_u32 vcc, 1, v16
    s_cbranch_vccnz L_retry_50
    s_setprio 2
    buffer_store_dwordx4 v[244:247], v0, s[48:51], s78 offen sc1
    buffer_store_dwordx4 v[224:227], v0, s[48:51], s74 offen sc1
    buffer_store_dwordx4 v[228:231], v0, s[48:51], s75 offen sc1
    s_setprio 0
    v_lshlrev_b32 v1, 4, v4
    v_lshl_add_u32 v1, v3, 9, v1
    s_barrier
    s_setprio 2
    ds_read_b128 v[16:19], v7 offset:50176
    ds_read_b128 v[20:23], v8 offset:50176
    ds_read_b128 v[24:27], v9 offset:50176
    ds_read_b128 v[28:31], v10 offset:50176
    ds_read_b128 v[32:35], v40 offset:50176
    ds_read_b128 v[36:39], v41 offset:50176
    ds_read_b128 v[44:47], v42 offset:50176
    ds_read_b128 v[252:255], v43 offset:50176
    s_waitcnt lgkmcnt(7)
    v_mfma_f32_16x16x32_bf16 v[104:107], v[56:59], v[16:19], v[104:107]
    v_mfma_f32_16x16x32_bf16 v[108:111], v[60:63], v[16:19], v[108:111]
    s_waitcnt lgkmcnt(6)
    v_mfma_f32_16x16x32_bf16 v[104:107], v[72:75], v[20:23], v[104:107]
    v_mfma_f32_16x16x32_bf16 v[108:111], v[76:79], v[20:23], v[108:111]
    s_waitcnt lgkmcnt(5)
    v_mfma_f32_16x16x32_bf16 v[104:107], v[136:139], v[24:27], v[104:107]
    v_mfma_f32_16x16x32_bf16 v[108:111], v[140:143], v[24:27], v[108:111]
    s_waitcnt lgkmcnt(4)
    v_mfma_f32_16x16x32_bf16 v[104:107], v[152:155], v[28:31], v[104:107]
    v_mfma_f32_16x16x32_bf16 v[108:111], v[156:159], v[28:31], v[108:111]
    s_waitcnt lgkmcnt(3)
    v_mfma_f32_16x16x32_bf16 v[104:107], v[168:171], v[32:35], v[104:107]
    v_mfma_f32_16x16x32_bf16 v[108:111], v[172:175], v[32:35], v[108:111]
    s_waitcnt lgkmcnt(2)
    v_mfma_f32_16x16x32_bf16 v[104:107], v[184:187], v[36:39], v[104:107]
    v_mfma_f32_16x16x32_bf16 v[108:111], v[188:191], v[36:39], v[108:111]
    s_waitcnt lgkmcnt(1)
    v_mfma_f32_16x16x32_bf16 v[104:107], v[200:203], v[44:47], v[104:107]
    v_mfma_f32_16x16x32_bf16 v[108:111], v[204:207], v[44:47], v[108:111]
    s_waitcnt lgkmcnt(0)
    v_mfma_f32_16x16x32_bf16 v[104:107], v[216:219], v[252:255], v[104:107]
    v_mfma_f32_16x16x32_bf16 v[108:111], v[220:223], v[252:255], v[108:111]
    v_mfma_f32_16x16x32_bf16 v[96:99], v[48:51], v[16:19], v[96:99]
    v_mfma_f32_16x16x32_bf16 v[100:103], v[52:55], v[16:19], v[100:103]
    v_mfma_f32_16x16x32_bf16 v[96:99], v[64:67], v[20:23], v[96:99]
    v_mfma_f32_16x16x32_bf16 v[100:103], v[68:71], v[20:23], v[100:103]
    v_mfma_f32_16x16x32_bf16 v[96:99], v[128:131], v[24:27], v[96:99]
    v_mfma_f32_16x16x32_bf16 v[100:103], v[132:135], v[24:27], v[100:103]
    v_mfma_f32_16x16x32_bf16 v[96:99], v[144:147], v[28:31], v[96:99]
    v_mfma_f32_16x16x32_bf16 v[100:103], v[148:151], v[28:31], v[100:103]
    v_cvt_pk_bf16_f32 v236, v104, v105
    v_mfma_f32_16x16x32_bf16 v[96:99], v[160:163], v[32:35], v[96:99]
    v_cvt_pk_bf16_f32 v237, v106, v107
    v_mfma_f32_16x16x32_bf16 v[100:103], v[164:167], v[32:35], v[100:103]
    v_cvt_pk_bf16_f32 v238, v108, v109
    v_mfma_f32_16x16x32_bf16 v[96:99], v[176:179], v[36:39], v[96:99]
    v_cvt_pk_bf16_f32 v239, v110, v111
    v_mfma_f32_16x16x32_bf16 v[100:103], v[180:183], v[36:39], v[100:103]
    buffer_store_dwordx4 v[236:239], v1, s[48:51], s76 offen offset:64 sc1
    v_mfma_f32_16x16x32_bf16 v[96:99], v[192:195], v[44:47], v[96:99]
    v_mfma_f32_16x16x32_bf16 v[100:103], v[196:199], v[44:47], v[100:103]
    v_mfma_f32_16x16x32_bf16 v[96:99], v[208:211], v[252:255], v[96:99]
    v_mfma_f32_16x16x32_bf16 v[100:103], v[212:215], v[252:255], v[100:103]
    s_nop 6
    v_cvt_pk_bf16_f32 v232, v96, v97
    v_cvt_pk_bf16_f32 v233, v98, v99
    v_cvt_pk_bf16_f32 v234, v100, v101
    v_cvt_pk_bf16_f32 v235, v102, v103
    buffer_store_dwordx4 v[232:235], v1, s[48:51], s76 offen offset:0 sc1
    s_or_b32 s64, s2, s3
    s_cbranch_scc1 L_noepoch_51
    v_mov_b32 v1, s30
    s_mov_b64 exec, 1
    buffer_store_dword v1, v5, s[44:47], 0 offen sc1
L_noepoch_51:
    s_endpgm
L_retry_39:
    s_sub_u32 s100, s100, 1
    s_cbranch_scc1 L_end
    s_sleep 1
    s_branch L_spin_38
L_mre_40:
    s_sub_u32 s100, s100, 1
    s_cbranch_scc1 L_end
    s_sleep 2
    buffer_load_dword v1, v0, s[44:47], s74 offen sc1
    s_waitcnt vmcnt(0)
    s_branch L_mchk_37
L_retry_42:
    s_sub_u32 s100, s100, 1
    s_cbranch_scc1 L_end
    s_sleep 1
    s_branch L_spin_41
L_retry_44:
    s_sub_u32 s100, s100, 1
    s_cbranch_scc1 L_end
    s_sleep 1
    s_branch L_prog_43
L_retry_46:
    s_sub_u32 s100, s100, 1
    s_cbranch_scc1 L_end
    s_sleep 1
    s_branch L_prog_45
L_retry_48:
    s_sub_u32 s100, s100, 1
    s_cbranch_scc1 L_end
    s_sleep 1
    s_branch L_prog_47
L_retry_50:
    s_sub_u32 s100, s100, 1
    s_cbranch_scc1 L_end
    s_sleep 1
    s_branch L_prog_49
L_end:
    s_endpgm
.section .rodata,"a"
.p2align 6
.amdhsa_kernel standalone__hybrid_graph_tf_exphormer__graph_kernel
  .amdhsa_next_free_vgpr 256
  .amdhsa_next_free_sgpr 102
  .amdhsa_accum_offset 256
  .amdhsa_group_segment_fixed_size 0
  .amdhsa_kernarg_size 104
  .amdhsa_user_sgpr_count 2
  .amdhsa_user_sgpr_kernarg_segment_ptr 1
  .amdhsa_system_sgpr_workgroup_id_x 1
  .amdhsa_float_denorm_mode_32 3
.end_amdhsa_kernel
```

```asm
; @launch grid=(253,1,1) block=(512,1,1) lds=161792
.amdgcn_target "amdgcn-amd-amdhsa--gfx950"
.text
.globl standalone__hybrid_graph_tf_exphormer__graph_kernel
.p2align 8
.type standalone__hybrid_graph_tf_exphormer__graph_kernel,@function
standalone__hybrid_graph_tf_exphormer__graph_kernel:
L_begin:
    s_cmp_ge_u32 s2, 253
    s_cbranch_scc1 L_end
    s_load_dwordx16 s[4:19], s[0:1], 0
    s_load_dwordx8 s[20:27], s[0:1], 64
    s_load_dwordx2 s[28:29], s[0:1], 96
    s_and_b32 s64, s2, 0xf8
    s_cmp_lg_u32 s64, 8
    s_cbranch_scc1 L_nopf
    s_getpc_b64 s[32:33]
L_pc:
    v_lshlrev_b32 v1, 6, v0
    v_min_u32 v1, L_end-L_pc, v1
    global_load_dword v255, v1, s[32:33]
L_nopf:
    v_lshrrev_b32 v1, 6, v0
    v_and_b32 v2, 63, v0
    v_readfirstlane_b32 s3, v1
    s_and_b32 s67, s2, 7
    s_and_b32 s31, s3, 3
    s_cmp_lt_u32 s3, 4
    s_cbranch_scc1 L_gemm
    s_setprio 3
    s_bitcmp1_b32 s2, 3
    s_cbranch_scc0 L_mload_1
    s_lshr_b32 s66, s2, 4
    s_lshl3_add_u32 s68, s66, s67
    s_mul_i32 s64, s68, 5120
    s_sub_u32 s65, s64, 4096
    v_lshl_add_u32 v40, v0, 4, s65
    s_add_u32 s64, s64, 3072
    v_lshl_add_u32 v41, v0, 2, s64
    s_waitcnt lgkmcnt(0)
    global_load_dwordx4 v[48:51], v40, s[8:9] nt
    global_load_dword v52, v41, s[8:9] nt
    global_load_dwordx4 v[56:59], v40, s[6:7] nt
    global_load_dword v60, v41, s[6:7] nt
    s_mov_b32 s27, s68
    s_branch L_roled_2
L_mload_1:
    v_lshrrev_b32 v43, 5, v2
    v_lshl_add_u32 v44, s31, 2, v43
    v_and_b32 v46, 31, v2
    v_xor_b32 v46, v46, v44
    v_lshl_add_u32 v43, s31, 3, v43
    v_lshlrev_b32 v43, 9, v43
    v_lshl_add_u32 v46, v46, 4, v43
    v_lshl_add_u32 v44, s67, 14, v46
    s_and_b32 s65, s2, 0xe0
    s_and_b32 s66, s2, 16
    s_lshl2_add_u32 s65, s65, s66
    v_lshl_add_u32 v46, s65, 7, v46
    s_lshl_b32 s66, s31, 11
    s_add_u32 m0, s66, 62464
    s_waitcnt lgkmcnt(0)
    global_load_lds_dwordx4 v46, s[20:21]
    s_add_u32 m0, s66, 21504
    v_xor_b32 v46, 0x420, v46
    global_load_lds_dwordx4 v44, s[18:19]
    s_add_u32 m0, s66, 27648
    v_xor_b32 v45, 0x420, v44
    global_load_lds_dwordx4 v44, s[18:19] offset:2048
    s_add_u32 m0, s66, 63488
    s_lshr_b32 s64, s2, 6
    global_load_lds_dwordx4 v46, s[20:21]
    s_add_u32 m0, s66, 22528
    s_lshl3_add_u32 s64, s64, s67
    global_load_lds_dwordx4 v45, s[18:19]
    s_add_u32 m0, s66, 28672
    s_bfe_u32 s65, s2, 0x20004
    global_load_lds_dwordx4 v45, s[18:19] offset:2048
    s_lshl2_add_u32 s27, s64, s65
L_roled_2:
    s_cmp_lg_u32 s31, 0
    s_cbranch_scc1 L_roled_2_b
    s_load_dword s30, s[28:29], 0
L_roled_2_b:
    v_and_b32 v3, 15, v2
    v_lshrrev_b32 v4, 4, v2
    v_mov_b32 v5, 0
    v_mov_b32 v6, 1
    s_mov_b32 s100, 67108864
    s_bfe_u32 s65, s2, 0x10003
    s_lshl1_add_u32 s64, s67, s65
    s_and_b32 s65, s2, 0xf0
    s_or_b32 s64, s64, s65
    s_cmp_lt_u32 s2, 240
    s_cselect_b32 s1, s64, s2
    v_lshrrev_b32 v42, 2, v3
    v_and_b32 v43, 3, v3
    v_lshl_add_u32 v42, v42, 4, v43
    s_lshl_b32 s64, s31, 1
    v_mov_b32 v43, s64
    v_lshlrev_b32 v44, 1, v43
    v_cmp_gt_u32 vcc, 8, v3
    s_mul_i32 s65, s1, 640
    v_lshlrev_b32 v7, 4, v3
    v_cndmask_b32 v43, v43, v44, vcc
    v_add_lshl_u32 v42, v42, v43, 4
    v_lshl_add_u32 v42, v4, 2, v42
    v_add_u32 v42, s65, v42
    v_min_u32 v42, 159996, v42
    v_lshlrev_b32 v8, 4, v0
    v_and_b32 v8, 0xfff, v8
    global_load_dword v0, v42, s[10:11] nt
    s_mov_b32 s26, 0
    s_barrier
    s_mov_b32 s32, s4
    s_and_b32 s33, s5, 0xffff
    s_mov_b32 s34, 5120000
    s_mov_b32 s35, 0x20000
    s_mov_b32 s36, s14
    s_and_b32 s37, s15, 0xffff
    s_mov_b32 s38, 20000
    s_mov_b32 s39, 0x20000
    s_add_u32 s40, s28, 1048576
    s_addc_u32 s41, s29, 0
    s_and_b32 s41, s41, 0xffff
    s_mov_b32 s42, 2048000
    s_mov_b32 s43, 0x20000
    v_and_b32 v40, 8, v3
    v_lshlrev_b32 v40, 1, v40
    v_mov_b32 v41, 0xffff
    v_lshlrev_b32 v40, v40, v41
    s_mov_b32 s64, 0x0f0f0f0f
    s_mov_b32 s65, 0x0f0f0f0f
    v_cndmask_b32 v12, 0, v40, s[64:65]
    v_xor_b32 v13, v40, v12
    v_and_b32 v14, 3, v3
    v_mul_u32_u24 v14, 0x5555, v14
    s_cmp_lg_u32 s31, 0
    s_cbranch_scc1 L_tagged_3
    s_waitcnt lgkmcnt(0)
    s_mul_i32 s30, s30, 0x9E3779B1
    s_add_u32 s30, s30, 0x7F4A7C15
    v_mov_b32 v40, 1
    v_mov_b32 v41, s30
    ds_write_b64 v5, v[40:41] offset:8
L_tagged_3:
    s_bitcmp1_b32 s2, 3
    s_cbranch_scc0 L_mwork_4
    v_mov_b32 v43, 4
    v_mov_b32 v44, 2031616
    s_mov_b32 s64, 0x3f0001
    v_lshrrev_b32 v40, 6, v8
    v_and_b32 v41, 0x30, v8
    v_lshl_add_u32 v40, v40, 14, v41
    s_lshl_b32 s68, s27, 6
    s_add_u32 s69, s68, 0x100000
    s_add_u32 s70, s68, 8192
    s_add_u32 s71, s69, 8192
    s_mov_b32 s65, 0x203c
    s_waitcnt vmcnt(3)
    v_mul_u32_u24 v64, 52429, v48
    v_lshrrev_b32 v72, 22, v64
    v_lshlrev_b32 v80, 2, v72
    ds_add_rtn_u32 v80, v80, v43 offset:512
    v_mul_u32_u24 v65, 52429, v49
    v_lshrrev_b32 v73, 22, v65
    v_lshlrev_b32 v81, 2, v73
    ds_add_rtn_u32 v81, v81, v43 offset:512
    v_mul_u32_u24 v66, 52429, v50
    v_lshrrev_b32 v74, 22, v66
    v_lshlrev_b32 v82, 2, v74
    ds_add_rtn_u32 v82, v82, v43 offset:512
    v_mul_u32_u24 v67, 52429, v51
    v_lshrrev_b32 v75, 22, v67
    v_lshlrev_b32 v83, 2, v75
    ds_add_rtn_u32 v83, v83, v43 offset:512
    v_mul_u32_u24 v68, 52429, v52
    v_lshrrev_b32 v76, 22, v68
    v_lshlrev_b32 v84, 2, v76
    ds_add_rtn_u32 v84, v84, v43 offset:512
    v_lshrrev_b32 v64, 21, v64
    v_mad_u32_u24 v64, v64, 24, v48
    v_mul_u32_u24 v64, 0x8001, v64
    v_bfe_u32 v88, v72, 1, 2
    v_lshl_or_b32 v72, v72, 2, v88
    v_lshlrev_b32 v72, 4, v72
    v_lshrrev_b32 v65, 21, v65
    v_mad_u32_u24 v65, v65, 24, v49
    v_mul_u32_u24 v65, 0x8001, v65
    v_bfe_u32 v89, v73, 1, 2
    v_lshl_or_b32 v73, v73, 2, v89
    v_lshlrev_b32 v73, 4, v73
    v_lshrrev_b32 v66, 21, v66
    v_mad_u32_u24 v66, v66, 24, v50
    v_mul_u32_u24 v66, 0x8001, v66
    v_bfe_u32 v90, v74, 1, 2
    v_lshl_or_b32 v74, v74, 2, v90
    v_lshlrev_b32 v74, 4, v74
    v_lshrrev_b32 v67, 21, v67
    v_mad_u32_u24 v67, v67, 24, v51
    v_mul_u32_u24 v67, 0x8001, v67
    v_bfe_u32 v91, v75, 1, 2
    v_lshl_or_b32 v75, v75, 2, v91
    v_lshlrev_b32 v75, 4, v75
    v_lshrrev_b32 v68, 21, v68
    v_mad_u32_u24 v68, v68, 24, v52
    v_mul_u32_u24 v68, 0x8001, v68
    v_bfe_u32 v92, v76, 1, 2
    v_lshl_or_b32 v76, v76, 2, v92
    v_lshlrev_b32 v76, 4, v76
    s_waitcnt vmcnt(1)
    v_lshlrev_b32 v56, 1, v56
    v_and_or_b32 v64, v64, s64, v56
    v_lshlrev_b32 v57, 1, v57
    v_and_or_b32 v65, v65, s64, v57
    v_lshlrev_b32 v58, 1, v58
    v_and_or_b32 v66, v66, s64, v58
    v_lshlrev_b32 v59, 1, v59
    v_and_or_b32 v67, v67, s64, v59
    v_lshlrev_b32 v60, 1, v60
    v_and_or_b32 v68, v68, s64, v60
    s_waitcnt lgkmcnt(0)
    v_cmp_gt_u32 vcc, 124, v80
    v_min_u32 v80, 124, v80
    v_lshl_or_b32 v80, v80, 7, v80
    v_cndmask_b32 v64, v44, v64, vcc
    v_bitop3_b32 v80, v80, s65, v72 bitop3:0x6a
    ds_write_b32 v80, v64 offset:41984
    v_cmp_gt_u32 vcc, 124, v81
    v_min_u32 v81, 124, v81
    v_lshl_or_b32 v81, v81, 7, v81
    v_cndmask_b32 v65, v44, v65, vcc
    v_bitop3_b32 v81, v81, s65, v73 bitop3:0x6a
    ds_write_b32 v81, v65 offset:41984
    v_cmp_gt_u32 vcc, 124, v82
    v_min_u32 v82, 124, v82
    v_lshl_or_b32 v82, v82, 7, v82
    v_cndmask_b32 v66, v44, v66, vcc
    v_bitop3_b32 v82, v82, s65, v74 bitop3:0x6a
    ds_write_b32 v82, v66 offset:41984
    v_cmp_gt_u32 vcc, 124, v83
    v_min_u32 v83, 124, v83
    v_lshl_or_b32 v83, v83, 7, v83
    v_cndmask_b32 v67, v44, v67, vcc
    v_bitop3_b32 v83, v83, s65, v75 bitop3:0x6a
    ds_write_b32 v83, v67 offset:41984
    v_cmp_gt_u32 vcc, 124, v84
    v_min_u32 v84, 124, v84
    v_lshl_or_b32 v84, v84, 7, v84
    v_cndmask_b32 v68, v44, v68, vcc
    v_bitop3_b32 v84, v84, s65, v76 bitop3:0x6a
    ds_write_b32 v84, v68 offset:41984
    s_waitcnt lgkmcnt(0)
    s_barrier
    ds_read_b32 v44, v5 offset:12
    ds_read_b128 v[48:51], v8 offset:41984
    ds_read_b128 v[52:55], v8 offset:46080
    ds_read_b128 v[56:59], v8 offset:50176
    ds_read_b128 v[60:63], v8 offset:54272
    s_waitcnt lgkmcnt(4)
    v_readfirstlane_b32 s30, v44
    s_waitcnt vmcnt(0)
    s_and_b32 s44, s30, 0xffc00000
    s_lshl_b32 s45, s30, 10
    s_and_b32 s45, s45, 0xffc00000
    s_lshl_b32 s46, s30, 20
    s_and_b32 s46, s46, 0xffc00000
    s_lshl_b32 s47, s30, 22
    s_waitcnt lgkmcnt(3)
    v_cmp_eq_u32 vcc, 1966080, v51
    v_or_b32 v48, s44, v48
    v_or_b32 v49, s45, v49
    v_or_b32 v50, s46, v50
    v_or_b32 v51, s47, v51
    buffer_store_dwordx4 v[48:51], v40, s[40:43], s68 offen sc1
    s_wqm_b64 s[72:73], vcc
    s_waitcnt lgkmcnt(2)
    v_cmp_eq_u32 vcc, 1966080, v55
    v_or_b32 v52, s44, v52
    v_or_b32 v53, s45, v53
    v_or_b32 v54, s46, v54
    v_or_b32 v55, s47, v55
    buffer_store_dwordx4 v[52:55], v40, s[40:43], s69 offen sc1
    s_wqm_b64 s[74:75], vcc
    s_waitcnt lgkmcnt(1)
    s_not_b64 exec, s[72:73]
    s_cbranch_scc0 L_nosec_8
    v_or_b32 v56, s44, v56
    v_or_b32 v57, s45, v57
    v_or_b32 v58, s46, v58
    v_or_b32 v59, s47, v59
    buffer_store_dwordx4 v[56:59], v40, s[40:43], s70 offen sc1
L_nosec_8:
    s_waitcnt lgkmcnt(0)
    s_not_b64 exec, s[74:75]
    s_cbranch_scc0 L_nosec_9
    v_or_b32 v60, s44, v60
    v_or_b32 v61, s45, v61
    v_or_b32 v62, s46, v62
    v_or_b32 v63, s47, v63
    buffer_store_dwordx4 v[60:63], v40, s[40:43], s71 offen sc1
L_nosec_9:
    s_mov_b64 exec, -1
    s_cmp_ge_u32 s2, 250
    s_cbranch_scc1 L_end
L_worked_5:
    v_lshlrev_b32 v0, 9, v0
    s_setprio 1
    s_lshl_b32 s64, s31, 10
    s_lshr_b32 s10, s1, 1
    s_lshl_b32 s10, s10, 14
    s_add_u32 s11, s10, 4096
    s_add_u32 s12, s10, 8192
    s_add_u32 s13, s10, 12288
    v_cmp_gt_u32 vcc, 0xf40, v8
    s_mov_b64 s[14:15], vcc
    v_add_u32_dpp v9, v0, v7 row_newbcast:0 row_mask:0xf bank_mask:0xf
    buffer_load_dwordx4 v[176:179], v9, s[32:35], 0 offen offset:0
    buffer_load_dwordx4 v[180:183], v9, s[32:35], 0 offen offset:256
    v_add_u32_dpp v9, v0, v7 row_newbcast:1 row_mask:0xf bank_mask:0xf
    buffer_load_dwordx4 v[184:187], v9, s[32:35], 0 offen offset:0
    buffer_load_dwordx4 v[188:191], v9, s[32:35], 0 offen offset:256
    s_add_u32 m0, s64, 62464
    s_mov_b32 s65, 0
    buffer_load_dwordx4 v8, s[36:39], s65 offen lds
    v_add_u32_dpp v9, v0, v7 row_newbcast:2 row_mask:0xf bank_mask:0xf
    s_cmp_eq_u32 s26, 2
    s_cbranch_scc1 L_loose_10
    s_waitcnt vmcnt(2)
L_loose_10:
    s_waitcnt vmcnt(6)
    buffer_load_dwordx4 v[192:195], v9, s[32:35], 0 offen offset:0
    buffer_load_dwordx4 v[196:199], v9, s[32:35], 0 offen offset:256
    s_add_u32 m0, s64, 66560
    s_mov_b32 s65, 4096
    buffer_load_dwordx4 v8, s[36:39], s65 offen lds
    v_add_u32_dpp v9, v0, v7 row_newbcast:3 row_mask:0xf bank_mask:0xf
    s_cmp_eq_u32 s26, 2
    s_cbranch_scc1 L_loose_11
    s_waitcnt vmcnt(2)
L_loose_11:
    s_waitcnt vmcnt(6)
    buffer_load_dwordx4 v[200:203], v9, s[32:35], 0 offen offset:0
    buffer_load_dwordx4 v[204:207], v9, s[32:35], 0 offen offset:256
    s_add_u32 m0, s64, 70656
    s_mov_b32 s65, 8192
    buffer_load_dwordx4 v8, s[36:39], s65 offen lds
    v_add_u32_dpp v9, v0, v7 row_newbcast:4 row_mask:0xf bank_mask:0xf
    s_cmp_eq_u32 s26, 2
    s_cbranch_scc1 L_loose_12
    s_waitcnt vmcnt(2)
L_loose_12:
    s_waitcnt vmcnt(6)
    buffer_load_dwordx4 v[208:211], v9, s[32:35], 0 offen offset:0
    buffer_load_dwordx4 v[212:215], v9, s[32:35], 0 offen offset:256
    s_add_u32 m0, s64, 74752
    s_mov_b32 s65, 12288
    buffer_load_dwordx4 v8, s[36:39], s65 offen lds
    v_add_u32_dpp v9, v0, v7 row_newbcast:5 row_mask:0xf bank_mask:0xf
    s_cmp_eq_u32 s26, 2
    s_cbranch_scc1 L_loose_13
    s_waitcnt vmcnt(2)
L_loose_13:
    s_waitcnt vmcnt(6)
    buffer_load_dwordx4 v[216:219], v9, s[32:35], 0 offen offset:0
    buffer_load_dwordx4 v[220:223], v9, s[32:35], 0 offen offset:256
    s_add_u32 m0, s64, 78848
    s_mov_b32 s65, 16384
    buffer_load_dwordx4 v8, s[36:39], s65 offen lds
L_ipoll_14:
    buffer_load_dwordx4 v[48:51], v8, s[40:43], s10 offen sc1
    s_mov_b64 exec, s[14:15]
    buffer_load_dwordx4 v[52:55], v8, s[40:43], s11 offen sc1
    s_mov_b64 exec, -1
L_spin_15:
    ds_read_b128 v[44:47], v5
    s_waitcnt lgkmcnt(0)
    v_readfirstlane_b32 s101, v46
    v_readfirstlane_b32 s30, v47
    s_cmp_ge_u32 s101, 1
    s_cbranch_scc0 L_retry_16
    s_and_b32 s44, s30, 0xffc00000
    s_lshl_b32 s45, s30, 10
    s_and_b32 s45, s45, 0xffc00000
    s_lshl_b32 s46, s30, 20
    s_and_b32 s46, s46, 0xffc00000
    s_lshl_b32 s47, s30, 22
    s_and_b32 s64, s1, 1
    s_lshl_b32 s64, s64, 21
    s_xor_b32 s17, s64, 1966080
    s_or_b32 s44, s44, s64
    v_mov_b32 v68, s17
    s_or_b32 s45, s45, s64
    v_mov_b32 v69, s17
    s_or_b32 s46, s46, s64
    v_mov_b32 v70, s17
    s_or_b32 s47, s47, s64
    v_mov_b32 v71, s17
    s_mov_b32 s16, 1310720
    v_mov_b32 v42, 2
    s_waitcnt vmcnt(1)
    v_xor_b32 v64, s44, v48
    v_xor_b32 v65, s45, v49
    v_xor_b32 v66, s46, v50
    v_xor_b32 v67, s47, v51
    v_or3_b32 v40, v64, v65, v66
    v_or_b32 v40, v40, v67
    v_cmp_eq_u32 s[72:73], s17, v67
    v_cmp_gt_u32 s[48:49], s16, v64
    v_lshlrev_b32_sdwa v80, 2, v64 dst_sel:DWORD dst_unused:UNUSED_PAD src0_sel:DWORD src1_sel:WORD_1
    v_cmp_gt_u32 s[50:51], s16, v65
    v_lshlrev_b32_sdwa v81, 2, v65 dst_sel:DWORD dst_unused:UNUSED_PAD src0_sel:DWORD src1_sel:WORD_1
    v_cmp_gt_u32 s[52:53], s16, v66
    v_lshlrev_b32_sdwa v82, 2, v66 dst_sel:DWORD dst_unused:UNUSED_PAD src0_sel:DWORD src1_sel:WORD_1
    v_cmp_gt_u32 s[54:55], s16, v67
    v_lshlrev_b32_sdwa v83, 2, v67 dst_sel:DWORD dst_unused:UNUSED_PAD src0_sel:DWORD src1_sel:WORD_1
    s_waitcnt vmcnt(0)
    s_mov_b64 exec, s[14:15]
    v_xor_b32 v68, s44, v52
    v_xor_b32 v69, s45, v53
    v_xor_b32 v70, s46, v54
    v_xor_b32 v71, s47, v55
    s_mov_b64 exec, -1
    v_or3_b32 v40, v40, v68, v69
    v_or3_b32 v40, v40, v70, v71
    v_cmp_eq_u32 s[74:75], s17, v71
    v_cmp_le_u32 vcc, 0x400000, v40
    s_cbranch_vccnz L_retry_17
    s_wqm_b64 s[72:73], s[72:73]
    s_not_b64 exec, s[72:73]
    s_cbranch_scc0 L_nosec_18
    buffer_load_dwordx4 v[56:59], v8, s[40:43], s12 offen sc1
L_nosec_18:
    s_wqm_b64 s[74:75], s[74:75]
    s_not_b64 exec, s[74:75]
    s_cbranch_scc0 L_nosec_19
    buffer_load_dwordx4 v[60:63], v8, s[40:43], s13 offen sc1
L_nosec_19:
    s_mov_b64 exec, -1
    v_cmp_gt_u32 s[56:57], s16, v68
    v_lshlrev_b32_sdwa v84, 2, v68 dst_sel:DWORD dst_unused:UNUSED_PAD src0_sel:DWORD src1_sel:WORD_1
    v_cmp_gt_u32 s[58:59], s16, v69
    v_lshlrev_b32_sdwa v85, 2, v69 dst_sel:DWORD dst_unused:UNUSED_PAD src0_sel:DWORD src1_sel:WORD_1
    v_cmp_gt_u32 s[60:61], s16, v70
    v_lshlrev_b32_sdwa v86, 2, v70 dst_sel:DWORD dst_unused:UNUSED_PAD src0_sel:DWORD src1_sel:WORD_1
    v_cmp_gt_u32 s[62:63], s16, v71
    v_lshlrev_b32_sdwa v87, 2, v71 dst_sel:DWORD dst_unused:UNUSED_PAD src0_sel:DWORD src1_sel:WORD_1
    s_mov_b64 exec, s[48:49]
    ds_add_rtn_u32 v80, v80, v42 offset:128
    s_mov_b64 exec, s[50:51]
    ds_add_rtn_u32 v81, v81, v42 offset:128
    s_mov_b64 exec, s[52:53]
    ds_add_rtn_u32 v82, v82, v42 offset:128
    s_mov_b64 exec, s[54:55]
    ds_add_rtn_u32 v83, v83, v42 offset:128
    s_mov_b64 exec, s[56:57]
    ds_add_rtn_u32 v84, v84, v42 offset:128
    s_mov_b64 exec, s[58:59]
    ds_add_rtn_u32 v85, v85, v42 offset:128
    s_mov_b64 exec, s[60:61]
    ds_add_rtn_u32 v86, v86, v42 offset:128
    s_mov_b64 exec, s[62:63]
    ds_add_rtn_u32 v87, v87, v42 offset:128
    s_mov_b64 exec, -1
    v_add_u32_dpp v9, v0, v7 row_newbcast:6 row_mask:0xf bank_mask:0xf
    buffer_load_dwordx4 v[224:227], v9, s[32:35], 0 offen offset:0
    buffer_load_dwordx4 v[228:231], v9, s[32:35], 0 offen offset:256
    v_add_u32_dpp v9, v0, v7 row_newbcast:7 row_mask:0xf bank_mask:0xf
    buffer_load_dwordx4 v[232:235], v9, s[32:35], 0 offen offset:0
    buffer_load_dwordx4 v[236:239], v9, s[32:35], 0 offen offset:256
    s_waitcnt lgkmcnt(4)
    s_mov_b64 exec, s[48:49]
    ds_write_b16 v80, v64
    s_mov_b64 exec, s[50:51]
    ds_write_b16 v81, v65
    s_mov_b64 exec, s[52:53]
    ds_write_b16 v82, v66
    s_mov_b64 exec, s[54:55]
    ds_write_b16 v83, v67
    s_waitcnt lgkmcnt(4)
    s_mov_b64 exec, s[56:57]
    ds_write_b16 v84, v68
    s_mov_b64 exec, s[58:59]
    ds_write_b16 v85, v69
    s_mov_b64 exec, s[60:61]
    ds_write_b16 v86, v70
    s_mov_b64 exec, s[62:63]
    ds_write_b16 v87, v71
    s_not_b64 exec, s[72:73]
    s_cbranch_scc0 L_secdone_21
    s_waitcnt vmcnt(4)
L_sec_20:
    v_xor_b32 v72, s44, v56
    v_xor_b32 v73, s45, v57
    v_xor_b32 v74, s46, v58
    v_xor_b32 v75, s47, v59
    v_or3_b32 v40, v72, v73, v74
    v_or_b32 v40, v40, v75
    v_cmp_le_u32 vcc, 0x400000, v40
    s_cbranch_vccnz L_retry_23
    v_and_b32 v40, 2031616, v75
    v_cmp_eq_u32 vcc, 2031616, v40
    v_cmp_gt_u32 s[64:65], s16, v72
    v_lshlrev_b32_sdwa v88, 2, v72 dst_sel:DWORD dst_unused:UNUSED_PAD src0_sel:DWORD src1_sel:WORD_1
    v_cmp_gt_u32 s[66:67], s16, v73
    v_lshlrev_b32_sdwa v89, 2, v73 dst_sel:DWORD dst_unused:UNUSED_PAD src0_sel:DWORD src1_sel:WORD_1
    v_cmp_gt_u32 s[68:69], s16, v74
    v_lshlrev_b32_sdwa v90, 2, v74 dst_sel:DWORD dst_unused:UNUSED_PAD src0_sel:DWORD src1_sel:WORD_1
    v_cmp_gt_u32 s[70:71], s16, v75
    v_lshlrev_b32_sdwa v91, 2, v75 dst_sel:DWORD dst_unused:UNUSED_PAD src0_sel:DWORD src1_sel:WORD_1
    s_mov_b64 exec, s[64:65]
    ds_add_rtn_u32 v88, v88, v42 offset:128
    s_mov_b64 exec, s[66:67]
    ds_add_rtn_u32 v89, v89, v42 offset:128
    s_mov_b64 exec, s[68:69]
    ds_add_rtn_u32 v90, v90, v42 offset:128
    s_mov_b64 exec, s[70:71]
    ds_add_rtn_u32 v91, v91, v42 offset:128
    s_mov_b64 exec, vcc
    ds_write_b32 v5, v6 offset:20
    s_waitcnt lgkmcnt(0)
    s_mov_b64 exec, s[64:65]
    ds_write_b16 v88, v72
    s_mov_b64 exec, s[66:67]
    ds_write_b16 v89, v73
    s_mov_b64 exec, s[68:69]
    ds_write_b16 v90, v74
    s_mov_b64 exec, s[70:71]
    ds_write_b16 v91, v75
L_secdone_21:
    s_not_b64 exec, s[74:75]
    s_cbranch_scc0 L_secdone_25
    s_waitcnt vmcnt(4)
L_sec_24:
    v_xor_b32 v76, s44, v60
    v_xor_b32 v77, s45, v61
    v_xor_b32 v78, s46, v62
    v_xor_b32 v79, s47, v63
    v_or3_b32 v40, v76, v77, v78
    v_or_b32 v40, v40, v79
    v_cmp_le_u32 vcc, 0x400000, v40
    s_cbranch_vccnz L_retry_27
    v_and_b32 v40, 2031616, v79
    v_cmp_eq_u32 vcc, 2031616, v40
    v_cmp_gt_u32 s[64:65], s16, v76
    v_lshlrev_b32_sdwa v92, 2, v76 dst_sel:DWORD dst_unused:UNUSED_PAD src0_sel:DWORD src1_sel:WORD_1
    v_cmp_gt_u32 s[66:67], s16, v77
    v_lshlrev_b32_sdwa v93, 2, v77 dst_sel:DWORD dst_unused:UNUSED_PAD src0_sel:DWORD src1_sel:WORD_1
    v_cmp_gt_u32 s[68:69], s16, v78
    v_lshlrev_b32_sdwa v94, 2, v78 dst_sel:DWORD dst_unused:UNUSED_PAD src0_sel:DWORD src1_sel:WORD_1
    v_cmp_gt_u32 s[70:71], s16, v79
    v_lshlrev_b32_sdwa v95, 2, v79 dst_sel:DWORD dst_unused:UNUSED_PAD src0_sel:DWORD src1_sel:WORD_1
    s_mov_b64 exec, s[64:65]
    ds_add_rtn_u32 v92, v92, v42 offset:128
    s_mov_b64 exec, s[66:67]
    ds_add_rtn_u32 v93, v93, v42 offset:128
    s_mov_b64 exec, s[68:69]
    ds_add_rtn_u32 v94, v94, v42 offset:128
    s_mov_b64 exec, s[70:71]
    ds_add_rtn_u32 v95, v95, v42 offset:128
    s_mov_b64 exec, vcc
    ds_write_b32 v5, v6 offset:20
    s_waitcnt lgkmcnt(0)
    s_mov_b64 exec, s[64:65]
    ds_write_b16 v92, v76
    s_mov_b64 exec, s[66:67]
    ds_write_b16 v93, v77
    s_mov_b64 exec, s[68:69]
    ds_write_b16 v94, v78
    s_mov_b64 exec, s[70:71]
    ds_write_b16 v95, v79
L_secdone_25:
    s_waitcnt lgkmcnt(0)
    s_mov_b64 exec, 1
    ds_add_u32 v5, v6 offset:16
    s_mov_b64 exec, -1
    v_add_u32_dpp v9, v0, v7 row_newbcast:8 row_mask:0xf bank_mask:0xf
    buffer_load_dwordx4 v[240:243], v9, s[32:35], 0 offen offset:0
    buffer_load_dwordx4 v[244:247], v9, s[32:35], 0 offen offset:256
    v_add_u32_dpp v9, v0, v7 row_newbcast:9 row_mask:0xf bank_mask:0xf
    buffer_load_dwordx4 v[248:251], v9, s[32:35], 0 offen offset:0
    buffer_load_dwordx4 v[252:255], v9, s[32:35], 0 offen offset:256
    s_lshl_b32 s20, s31, 1
    s_add_u32 s21, s20, 1
    s_add_u32 s22, s20, 8
    s_add_u32 s23, s20, 9
    s_add_u32 s24, s31, 16
    v_add_u32 v47, -1, v3
    v_bfe_u32 v40, v47, 1, 1
    v_and_b32 v41, 1, v47
    v_lshl_add_u32 v40, v40, 3, v41
    v_add_u32 v40, s20, v40
    v_mov_b32 v41, s24
    v_cmp_ne_u32 vcc, 0, v3
    v_min_u32 v47, 19, v2
    v_mul_u32_u24 v46, 264, v47
    v_cndmask_b32 v40, v41, v40, vcc
    v_mul_u32_u24 v41, 264, v40
    v_add_u32 v41, 148480, v41
    v_lshlrev_b32 v40, 2, v40
    v_add_u32 v46, 148728, v46
    v_lshlrev_b32 v47, 2, v47
    v_lshlrev_b32 v43, 3, v3
    v_lshl_add_u32 v43, v4, 1, v43
L_spin_28:
    ds_read_b32 v44, v5 offset:16
    s_waitcnt lgkmcnt(0)
    v_readfirstlane_b32 s101, v44
    s_cmp_ge_u32 s101, 4
    s_cbranch_scc0 L_retry_29
    ds_read_b32 v44, v40 offset:128
    ds_read_b32 v47, v47 offset:128
    ds_read_b32 v45, v5 offset:20
    s_waitcnt lgkmcnt(2)
    v_sub_u32 v44, v44, v41
    v_max_u32 v44, 18, v44
    s_waitcnt lgkmcnt(0)
    v_cmp_gt_u32 vcc, v47, v46
    v_add_u32_dpp v48, v44, v44 row_shr:1 row_mask:0xf bank_mask:0xf bound_ctrl:1
    v_readfirstlane_b32 s25, v45
    s_or_b32 s64, vcc_lo, vcc_hi
    v_add_u32_dpp v48, v48, v48 row_shr:2 row_mask:0xf bank_mask:0xf bound_ctrl:1
    s_or_b32 s25, s25, s64
    s_mov_b32 s53, 0
    v_add_u32_dpp v48, v48, v48 row_shr:4 row_mask:0xf bank_mask:0xf bound_ctrl:1
    v_sub_u32 v44, v48, v44
    v_sub_u32 v44, v41, v44
    v_readlane_b32 s10, v48, 0
    v_readlane_b32 s11, v48, 1
    v_readlane_b32 s12, v48, 2
    v_readlane_b32 s13, v48, 3
    v_readlane_b32 s14, v48, 4
    v_add_u32_dpp v160, v44, v43 row_newbcast:0 row_mask:0xf bank_mask:0xf
    v_add_u32_dpp v161, v44, v43 row_newbcast:1 row_mask:0xf bank_mask:0xf
    v_add_u32_dpp v162, v44, v43 row_newbcast:2 row_mask:0xf bank_mask:0xf
    v_add_u32_dpp v163, v44, v43 row_newbcast:3 row_mask:0xf bank_mask:0xf
    v_add_u32_dpp v164, v44, v43 row_newbcast:4 row_mask:0xf bank_mask:0xf
    s_add_u32 s50, s14, 14
    s_lshr_b32 s50, s50, 4
    s_cmp_gt_u32 s50, 32
    s_cselect_b32 s25, 1, s25
    s_max_u32 s50, s50, 12
    v_add_u32 v40, 0, v43
    v_cmp_le_u32 s[64:65], s10, v40
    v_cmp_le_u32 s[66:67], s11, v40
    v_cmp_le_u32 s[68:69], s12, v40
    v_cmp_le_u32 s[70:71], s13, v40
    v_cndmask_b32 v40, v160, v161, s[64:65]
    v_cndmask_b32 v40, v40, v162, s[66:67]
    v_cndmask_b32 v40, v40, v163, s[68:69]
    v_cndmask_b32 v40, v40, v164, s[70:71]
    ds_read_u16 v40, v40 offset:0
    v_add_u32 v41, 128, v43
    v_cmp_le_u32 s[64:65], s10, v41
    v_cmp_le_u32 s[66:67], s11, v41
    v_cmp_le_u32 s[68:69], s12, v41
    v_cmp_le_u32 s[70:71], s13, v41
    v_cndmask_b32 v41, v160, v161, s[64:65]
    v_cndmask_b32 v41, v41, v162, s[66:67]
    v_cndmask_b32 v41, v41, v163, s[68:69]
    v_cndmask_b32 v41, v41, v164, s[70:71]
    ds_read_u16 v41, v41 offset:128
    v_add_u32 v42, 256, v43
    v_cmp_le_u32 s[64:65], s10, v42
    v_cmp_le_u32 s[66:67], s11, v42
    v_cmp_le_u32 s[68:69], s12, v42
    v_cmp_le_u32 s[70:71], s13, v42
    v_cndmask_b32 v42, v160, v161, s[64:65]
    v_cndmask_b32 v42, v42, v162, s[66:67]
    v_cndmask_b32 v42, v42, v163, s[68:69]
    v_cndmask_b32 v42, v42, v164, s[70:71]
    ds_read_u16 v42, v42 offset:256
    v_add_u32 v43, 384, v43
    v_cmp_le_u32 s[64:65], s10, v43
    v_cmp_le_u32 s[66:67], s11, v43
    v_cmp_le_u32 s[68:69], s12, v43
    v_cmp_le_u32 s[70:71], s13, v43
    v_cndmask_b32 v43, v160, v161, s[64:65]
    v_cndmask_b32 v43, v43, v162, s[66:67]
    v_cndmask_b32 v43, v43, v163, s[68:69]
    v_cndmask_b32 v43, v43, v164, s[70:71]
    ds_read_u16 v43, v43 offset:384
    s_waitcnt lgkmcnt(3)
    v_and_b32 v32, 0x7ffe, v40
    ds_read_u16 v33, v32 offset:62464
    v_lshlrev_b32 v32, 8, v32
    v_lshlrev_b32 v40, 4, v40
    s_waitcnt lgkmcnt(3)
    v_and_b32 v34, 0x7ffe, v41
    ds_read_u16 v35, v34 offset:62464
    v_lshlrev_b32 v34, 8, v34
    v_lshlrev_b32 v41, 4, v41
    s_waitcnt lgkmcnt(3)
    v_and_b32 v36, 0x7ffe, v42
    ds_read_u16 v37, v36 offset:62464
    v_lshlrev_b32 v36, 8, v36
    v_lshlrev_b32 v42, 4, v42
    s_waitcnt lgkmcnt(3)
    v_and_b32 v38, 0x7ffe, v43
    ds_read_u16 v39, v38 offset:62464
    v_lshlrev_b32 v38, 8, v38
    v_lshlrev_b32 v43, 4, v43
    v_add_u32_dpp v11, v32, v7 row_newbcast:0 row_mask:0xf bank_mask:0xf
    buffer_load_dwordx4 v[48:51], v11, s[32:35], 0 offen offset:0
    buffer_load_dwordx4 v[56:59], v11, s[32:35], 0 offen offset:256
    v_add_u32_dpp v11, v32, v7 row_newbcast:1 row_mask:0xf bank_mask:0xf
    buffer_load_dwordx4 v[52:55], v11, s[32:35], 0 offen offset:0
    buffer_load_dwordx4 v[60:63], v11, s[32:35], 0 offen offset:256
    v_add_u32_dpp v11, v32, v7 row_newbcast:2 row_mask:0xf bank_mask:0xf
    buffer_load_dwordx4 v[64:67], v11, s[32:35], 0 offen offset:0
    buffer_load_dwordx4 v[72:75], v11, s[32:35], 0 offen offset:256
    v_add_u32_dpp v11, v32, v7 row_newbcast:3 row_mask:0xf bank_mask:0xf
    buffer_load_dwordx4 v[68:71], v11, s[32:35], 0 offen offset:0
    buffer_load_dwordx4 v[76:79], v11, s[32:35], 0 offen offset:256
    v_add_u32_dpp v11, v32, v7 row_newbcast:4 row_mask:0xf bank_mask:0xf
    buffer_load_dwordx4 v[80:83], v11, s[32:35], 0 offen offset:0
    buffer_load_dwordx4 v[88:91], v11, s[32:35], 0 offen offset:256
    v_add_u32_dpp v11, v32, v7 row_newbcast:5 row_mask:0xf bank_mask:0xf
    buffer_load_dwordx4 v[84:87], v11, s[32:35], 0 offen offset:0
    buffer_load_dwordx4 v[92:95], v11, s[32:35], 0 offen offset:256
    s_mov_b32 s57, 0
    s_sub_u32 s64, s14, 18
    s_lshr_b32 s65, s64, 4
    s_bitset1_b32 s53, s65
    s_and_b32 s64, s64, 14
    s_lshl4_add_u32 s57, s57, s64
    s_and_b32 s65, s24, 7
    s_lshl_b32 s65, s65, 5
    s_lshl_b32 s19, s24, 10
    s_or_b32 s19, s19, s65
    s_sub_u32 s64, s13, 18
    s_lshr_b32 s65, s64, 4
    s_bitset1_b32 s53, s65
    s_and_b32 s64, s64, 14
    s_lshl4_add_u32 s57, s57, s64
    s_and_b32 s65, s23, 7
    s_lshl_b32 s65, s65, 5
    s_lshl_b32 s18, s23, 10
    s_or_b32 s18, s18, s65
    s_sub_u32 s64, s12, 18
    s_lshr_b32 s65, s64, 4
    s_bitset1_b32 s53, s65
    s_and_b32 s64, s64, 14
    s_lshl4_add_u32 s57, s57, s64
    s_and_b32 s65, s22, 7
    s_lshl_b32 s65, s65, 5
    s_lshl_b32 s17, s22, 10
    s_or_b32 s17, s17, s65
    s_sub_u32 s64, s11, 18
    s_lshr_b32 s65, s64, 4
    s_bitset1_b32 s53, s65
    s_and_b32 s64, s64, 14
    s_lshl4_add_u32 s57, s57, s64
    s_and_b32 s65, s21, 7
    s_lshl_b32 s65, s65, 5
    s_lshl_b32 s16, s21, 10
    s_or_b32 s16, s16, s65
    s_sub_u32 s64, s10, 18
    s_lshr_b32 s65, s64, 4
    s_bitset1_b32 s53, s65
    s_and_b32 s64, s64, 14
    s_lshl4_add_u32 s57, s57, s64
    s_and_b32 s65, s20, 7
    s_lshl_b32 s65, s65, 5
    s_lshl_b32 s15, s20, 10
    s_or_b32 s15, s15, s65
    s_sub_u32 s64, s50, 5
    s_lshl_b32 s56, 1, s64
    s_or_b32 s52, s56, s53
    v_and_b32 v46, 1, v3
    v_lshl_add_u32 v46, v4, 1, v46
    v_and_b32 v46, 3, v46
    v_and_b32 v47, 14, v3
    v_lshl_add_u32 v46, v46, 4, v47
    v_lshrrev_b32 v47, 1, v4
    v_add_lshl_u32 v46, v46, v47, 2
    v_lshrrev_b32 v44, 1, v4
    v_mul_u32_u24 v44, 528, v44
    v_xor_b32 v44, v44, v7
    v_and_b32 v45, 1, v4
    v_lshl_or_b32 v2, v45, 3, v44
    v_xor_b32 v144, s15, v7
    v_xor_b32 v146, s16, v7
    v_xor_b32 v148, s19, v7
    v_xor_b32 v145, 528, v144
    v_xor_b32 v147, 528, v146
    v_xor_b32 v149, 528, v148
    s_mul_i32 s64, s1, 80
    s_add_u32 s64, s64, 62464
    v_and_b32 v45, 2, v4
    v_add_u32 v0, s64, v45
    s_getpc_b64 s[72:73]
L_anc:
    v_lshlrev_b32 v4, 2, v4
    s_mov_b32 s62, L_fp1-L_anc
    s_mov_b32 s63, L_fp1-L_fp0
    s_mov_b32 s70, L_dr1-L_anc
    s_mov_b32 s71, L_dr1-L_dr0
    s_mov_b32 s26, 0
    s_mov_b32 s49, 0
    v_mov_b32 v1, 0
    s_lshl_b32 s64, s31, 2
    v_mov_b32 v10, s64
    v_and_b32 v9, 8, v3
    v_lshlrev_b32 v9, 1, v9
    s_mov_b32 s66, 0x22222222
    s_mov_b32 s67, 0x22222222
    s_mov_b32 s68, 0x44444444
    s_mov_b32 s69, 0x44444444
    v_mov_b64 v[150:151], 0
    v_mov_b64 v[152:153], 0
    v_mov_b64 v[154:155], 0
    v_mov_b64 v[156:157], 0
    v_mov_b64 v[158:159], 0
    v_mov_b64 v[16:17], 0
    v_mov_b64 v[18:19], 0
    v_mov_b64 v[20:21], 0
    v_mov_b64 v[22:23], 0
    s_waitcnt lgkmcnt(0)
    v_lshlrev_b32 v33, v40, v33
    ds_bpermute_b32 v33, v46, v33
    v_lshlrev_b32 v35, v41, v35
    ds_bpermute_b32 v35, v46, v35
    v_lshlrev_b32 v37, v42, v37
    ds_bpermute_b32 v37, v46, v37
    v_lshlrev_b32 v39, v43, v39
    ds_bpermute_b32 v39, v46, v39
    s_waitcnt vmcnt(12) lgkmcnt(0)
    s_barrier
    ds_read_b128 v[160:163], v144 offset:21504
    ds_read_b128 v[164:167], v144 offset:21760
    ds_read_b128 v[168:171], v145 offset:21504
    ds_read_b128 v[172:175], v145 offset:21760
    s_waitcnt lgkmcnt(2)
    v_dot2c_f32_bf16 v150, v176, v160
    v_dot2c_f32_bf16 v150, v177, v161
    v_dot2c_f32_bf16 v150, v178, v162
    v_dot2c_f32_bf16 v150, v179, v163
    v_dot2c_f32_bf16 v150, v180, v164
    v_dot2c_f32_bf16 v150, v181, v165
    v_dot2c_f32_bf16 v150, v182, v166
    v_dot2c_f32_bf16 v150, v183, v167
    ds_read_b128 v[160:163], v146 offset:21504
    ds_read_b128 v[164:167], v146 offset:21760
    s_waitcnt lgkmcnt(2)
    v_dot2c_f32_bf16 v151, v184, v168
    v_dot2c_f32_bf16 v151, v185, v169
    v_dot2c_f32_bf16 v151, v186, v170
    v_dot2c_f32_bf16 v151, v187, v171
    v_dot2c_f32_bf16 v151, v188, v172
    v_dot2c_f32_bf16 v151, v189, v173
    v_dot2c_f32_bf16 v151, v190, v174
    v_dot2c_f32_bf16 v151, v191, v175
    ds_read_b128 v[168:171], v147 offset:21504
    ds_read_b128 v[172:175], v147 offset:21760
    s_waitcnt lgkmcnt(2)
    v_dot2c_f32_bf16 v152, v192, v160
    v_dot2c_f32_bf16 v152, v193, v161
    v_dot2c_f32_bf16 v152, v194, v162
    v_dot2c_f32_bf16 v152, v195, v163
    v_dot2c_f32_bf16 v152, v196, v164
    v_dot2c_f32_bf16 v152, v197, v165
    v_dot2c_f32_bf16 v152, v198, v166
    v_dot2c_f32_bf16 v152, v199, v167
    v_add_f32_dpp v150, v150, v150 row_ror:8 row_mask:0xf bank_mask:0x3
    v_add_f32_dpp v150, v151, v151 row_ror:8 row_mask:0xf bank_mask:0xc
    ds_read_b128 v[160:163], v144 offset:29696
    ds_read_b128 v[164:167], v144 offset:29952
    s_waitcnt lgkmcnt(2)
    v_dot2c_f32_bf16 v153, v200, v168
    v_dot2c_f32_bf16 v153, v201, v169
    v_dot2c_f32_bf16 v153, v202, v170
    v_dot2c_f32_bf16 v153, v203, v171
    v_dot2c_f32_bf16 v153, v204, v172
    v_dot2c_f32_bf16 v153, v205, v173
    v_dot2c_f32_bf16 v153, v206, v174
    v_dot2c_f32_bf16 v153, v207, v175
    ds_read_b128 v[168:171], v145 offset:29696
    ds_read_b128 v[172:175], v145 offset:29952
    s_waitcnt lgkmcnt(2)
    v_dot2c_f32_bf16 v154, v208, v160
    v_dot2c_f32_bf16 v154, v209, v161
    v_dot2c_f32_bf16 v154, v210, v162
    v_dot2c_f32_bf16 v154, v211, v163
    v_dot2c_f32_bf16 v154, v212, v164
    v_dot2c_f32_bf16 v154, v213, v165
    v_dot2c_f32_bf16 v154, v214, v166
    v_dot2c_f32_bf16 v154, v215, v167
    v_add_f32_dpp v152, v152, v152 row_ror:8 row_mask:0xf bank_mask:0x3
    v_add_f32_dpp v152, v153, v153 row_ror:8 row_mask:0xf bank_mask:0xc
    v_add_u32_dpp v11, v32, v7 row_newbcast:6 row_mask:0xf bank_mask:0xf
    buffer_load_dwordx4 v[96:99], v11, s[32:35], 0 offen offset:0
    buffer_load_dwordx4 v[104:107], v11, s[32:35], 0 offen offset:256
    ds_read_b128 v[160:163], v146 offset:29696
    ds_read_b128 v[164:167], v146 offset:29952
    s_waitcnt lgkmcnt(2)
    v_dot2c_f32_bf16 v155, v216, v168
    v_dot2c_f32_bf16 v155, v217, v169
    v_dot2c_f32_bf16 v155, v218, v170
    v_dot2c_f32_bf16 v155, v219, v171
    v_dot2c_f32_bf16 v155, v220, v172
    v_dot2c_f32_bf16 v155, v221, v173
    v_dot2c_f32_bf16 v155, v222, v174
    v_dot2c_f32_bf16 v155, v223, v175
    v_add_f32_dpp v150, v150, v150 row_half_mirror row_mask:0xf bank_mask:0x5
    v_add_f32_dpp v150, v152, v152 row_half_mirror row_mask:0xf bank_mask:0xa
    v_add_u32_dpp v11, v32, v7 row_newbcast:7 row_mask:0xf bank_mask:0xf
    buffer_load_dwordx4 v[100:103], v11, s[32:35], 0 offen offset:0
    buffer_load_dwordx4 v[108:111], v11, s[32:35], 0 offen offset:256
    ds_read_b128 v[168:171], v147 offset:29696
    ds_read_b128 v[172:175], v147 offset:29952
    s_waitcnt lgkmcnt(2)
    v_dot2c_f32_bf16 v156, v224, v160
    v_dot2c_f32_bf16 v156, v225, v161
    v_dot2c_f32_bf16 v156, v226, v162
    v_dot2c_f32_bf16 v156, v227, v163
    v_dot2c_f32_bf16 v156, v228, v164
    v_dot2c_f32_bf16 v156, v229, v165
    v_dot2c_f32_bf16 v156, v230, v166
    v_dot2c_f32_bf16 v156, v231, v167
    v_add_f32_dpp v154, v154, v154 row_ror:8 row_mask:0xf bank_mask:0x3
    v_add_f32_dpp v154, v155, v155 row_ror:8 row_mask:0xf bank_mask:0xc
    v_add_u32_dpp v11, v32, v7 row_newbcast:8 row_mask:0xf bank_mask:0xf
    buffer_load_dwordx4 v[112:115], v11, s[32:35], 0 offen offset:0
    buffer_load_dwordx4 v[120:123], v11, s[32:35], 0 offen offset:256
    ds_read_b128 v[160:163], v148 offset:21504
    ds_read_b128 v[164:167], v148 offset:21760
    s_waitcnt lgkmcnt(2)
    v_dot2c_f32_bf16 v157, v232, v168
    v_dot2c_f32_bf16 v157, v233, v169
    v_dot2c_f32_bf16 v157, v234, v170
    v_dot2c_f32_bf16 v157, v235, v171
    v_dot2c_f32_bf16 v157, v236, v172
    v_dot2c_f32_bf16 v157, v237, v173
    v_dot2c_f32_bf16 v157, v238, v174
    v_dot2c_f32_bf16 v157, v239, v175
    v_add_u32_dpp v11, v32, v7 row_newbcast:9 row_mask:0xf bank_mask:0xf
    buffer_load_dwordx4 v[116:119], v11, s[32:35], 0 offen offset:0
    buffer_load_dwordx4 v[124:127], v11, s[32:35], 0 offen offset:256
    ds_read_b128 v[168:171], v149 offset:21504
    ds_read_b128 v[172:175], v149 offset:21760
    s_waitcnt lgkmcnt(2)
    v_dot2c_f32_bf16 v158, v240, v160
    v_dot2c_f32_bf16 v158, v241, v161
    v_dot2c_f32_bf16 v158, v242, v162
    v_dot2c_f32_bf16 v158, v243, v163
    v_dot2c_f32_bf16 v158, v244, v164
    v_dot2c_f32_bf16 v158, v245, v165
    v_dot2c_f32_bf16 v158, v246, v166
    v_dot2c_f32_bf16 v158, v247, v167
    v_add_f32_dpp v156, v156, v156 row_ror:8 row_mask:0xf bank_mask:0x3
    v_add_f32_dpp v156, v157, v157 row_ror:8 row_mask:0xf bank_mask:0xc
    v_add_u32_dpp v11, v32, v7 row_newbcast:10 row_mask:0xf bank_mask:0xf
    buffer_load_dwordx4 v[128:131], v11, s[32:35], 0 offen offset:0
    buffer_load_dwordx4 v[136:139], v11, s[32:35], 0 offen offset:256
    s_waitcnt lgkmcnt(0)
    v_dot2c_f32_bf16 v159, v248, v168
    v_dot2c_f32_bf16 v159, v249, v169
    v_dot2c_f32_bf16 v159, v250, v170
    v_dot2c_f32_bf16 v159, v251, v171
    v_dot2c_f32_bf16 v159, v252, v172
    v_dot2c_f32_bf16 v159, v253, v173
    v_dot2c_f32_bf16 v159, v254, v174
    v_dot2c_f32_bf16 v159, v255, v175
    v_add_f32_dpp v154, v154, v154 row_half_mirror row_mask:0xf bank_mask:0x5
    v_add_f32_dpp v154, v156, v156 row_half_mirror row_mask:0xf bank_mask:0xa
    v_add_u32_dpp v11, v32, v7 row_newbcast:11 row_mask:0xf bank_mask:0xf
    buffer_load_dwordx4 v[132:135], v11, s[32:35], 0 offen offset:0
    buffer_load_dwordx4 v[140:143], v11, s[32:35], 0 offen offset:256
    v_add_f32_dpp v150, v150, v150 quad_perm:[1,0,3,2] row_mask:0xf bank_mask:0xf
    s_nop 0
    v_add_f32_dpp v158, v158, v158 row_ror:8 row_mask:0xf bank_mask:0x3
    v_add_f32_dpp v158, v159, v159 row_ror:8 row_mask:0xf bank_mask:0xc
    v_add_f32_dpp v154, v154, v154 quad_perm:[1,0,3,2] row_mask:0xf bank_mask:0xf
    v_add_f32_dpp v150, v150, v150 quad_perm:[2,3,0,1] row_mask:0xf bank_mask:0xf
    v_add_f32_dpp v158, v158, v158 row_half_mirror row_mask:0xf bank_mask:0x5
    v_add_f32_dpp v154, v154, v154 quad_perm:[2,3,0,1] row_mask:0xf bank_mask:0xf
    s_nop 0
    v_add_f32_dpp v158, v158, v158 quad_perm:[1,0,3,2] row_mask:0xf bank_mask:0xf
    v_cndmask_b32 v150, v150, v154, s[66:67]
    s_nop 0
    v_add_f32_dpp v158, v158, v158 quad_perm:[2,3,0,1] row_mask:0xf bank_mask:0xf
    v_cndmask_b32 v150, v150, v158, s[68:69]
    v_mul_f32 v150, 0x3db8aa3b, v150
    v_exp_f32 v150, v150
    s_nop 0
    v_mov_b32 v44, v150
    v_mov_b32 v45, v150
    s_nop 1
    v_permlane32_swap_b32 v44, v45
    v_add_f32 v44, v44, v45
    v_mov_b32 v45, v44
    s_nop 1
    v_permlane16_swap_b32 v44, v45
    v_add_f32 v44, v44, v45
    v_add_f32 v44, 0x3089705f, v44
    v_rcp_f32 v44, v44
    s_nop 0
    v_mul_f32 v150, v150, v44
    v_cvt_pk_bf16_f32 v150, v150, 0
    v_lshlrev_b32 v8, v9, v150
    s_nop 1
    v_and_b32_dpp v24, v8, v12 row_newbcast:0 row_mask:0xf bank_mask:0xf
    v_and_b32_dpp v25, v8, v13 row_newbcast:0 row_mask:0xf bank_mask:0xf
    v_mov_b64 v[40:41], 0
    v_mov_b64 v[42:43], 0
    v_mov_b64 v[44:45], 0
    v_mov_b64 v[46:47], 0
    v_smfmac_f32_16x16x32_bf16 v[40:43], v[24:25], v[176:179], v14
    v_and_b32_dpp v28, v8, v12 row_newbcast:8 row_mask:0xf bank_mask:0xf
    v_and_b32_dpp v29, v8, v13 row_newbcast:8 row_mask:0xf bank_mask:0xf
    v_smfmac_f32_16x16x32_bf16 v[44:47], v[24:25], v[180:183], v14
    v_add_u32_dpp v11, v32, v7 row_newbcast:12 row_mask:0xf bank_mask:0xf
    buffer_load_dwordx4 v[144:147], v11, s[32:35], 0 offen offset:0
    buffer_load_dwordx4 v[152:155], v11, s[32:35], 0 offen offset:256
    v_smfmac_f32_16x16x32_bf16 v[40:43], v[28:29], v[184:187], v14
    v_and_b32_dpp v24, v8, v12 row_newbcast:4 row_mask:0xf bank_mask:0xf
    v_and_b32_dpp v25, v8, v13 row_newbcast:4 row_mask:0xf bank_mask:0xf
    v_smfmac_f32_16x16x32_bf16 v[44:47], v[28:29], v[188:191], v14
    s_nop 0
    v_smfmac_f32_16x16x32_bf16 v[16:19], v[24:25], v[192:195], v14
    v_and_b32_dpp v28, v8, v12 row_newbcast:12 row_mask:0xf bank_mask:0xf
    v_and_b32_dpp v29, v8, v13 row_newbcast:12 row_mask:0xf bank_mask:0xf
    v_smfmac_f32_16x16x32_bf16 v[20:23], v[24:25], v[196:199], v14
    v_add_u32_dpp v11, v32, v7 row_newbcast:13 row_mask:0xf bank_mask:0xf
    buffer_load_dwordx4 v[148:151], v11, s[32:35], 0 offen offset:0
    buffer_load_dwordx4 v[156:159], v11, s[32:35], 0 offen offset:256
    v_smfmac_f32_16x16x32_bf16 v[16:19], v[28:29], v[200:203], v14
    v_and_b32_dpp v24, v8, v12 row_newbcast:1 row_mask:0xf bank_mask:0xf
    v_and_b32_dpp v25, v8, v13 row_newbcast:1 row_mask:0xf bank_mask:0xf
    v_smfmac_f32_16x16x32_bf16 v[20:23], v[28:29], v[204:207], v14
    v_xor_b32 v178, s15, v2
    s_lshl_b32 s64, s20, 2
    v_add_u32 v9, s64, v0
    v_mov_b32 v179, 0
    v_cvt_pk_bf16_f32 v30, v40, v41
    v_cvt_pk_bf16_f32 v31, v42, v43
    ds_write_b64 v178, v[30:31] offset:1024
    v_cvt_pk_bf16_f32 v30, v44, v45
    v_cvt_pk_bf16_f32 v31, v46, v47
    ds_write_b64 v178, v[30:31] offset:1280
    ds_read_u16_d16_hi v179, v9
    v_mov_b64 v[40:41], 0
    v_mov_b64 v[42:43], 0
    v_mov_b64 v[44:45], 0
    v_mov_b64 v[46:47], 0
    s_nop 0
    v_smfmac_f32_16x16x32_bf16 v[40:43], v[24:25], v[208:211], v14
    v_and_b32_dpp v28, v8, v12 row_newbcast:9 row_mask:0xf bank_mask:0xf
    v_and_b32_dpp v29, v8, v13 row_newbcast:9 row_mask:0xf bank_mask:0xf
    v_smfmac_f32_16x16x32_bf16 v[44:47], v[24:25], v[212:215], v14
    v_add_u32_dpp v11, v32, v7 row_newbcast:14 row_mask:0xf bank_mask:0xf
    buffer_load_dwordx4 v[160:163], v11, s[32:35], 0 offen offset:0
    buffer_load_dwordx4 v[168:171], v11, s[32:35], 0 offen offset:256
    v_smfmac_f32_16x16x32_bf16 v[40:43], v[28:29], v[216:219], v14
    v_and_b32_dpp v24, v8, v12 row_newbcast:5 row_mask:0xf bank_mask:0xf
    v_and_b32_dpp v25, v8, v13 row_newbcast:5 row_mask:0xf bank_mask:0xf
    v_smfmac_f32_16x16x32_bf16 v[44:47], v[28:29], v[220:223], v14
    v_xor_b32 v180, s16, v2
    s_lshl_b32 s64, s21, 2
    v_add_u32 v9, s64, v0
    v_mov_b32 v181, 0
    v_cvt_pk_bf16_f32 v30, v16, v17
    v_cvt_pk_bf16_f32 v31, v18, v19
    ds_write_b64 v180, v[30:31] offset:1024
    v_cvt_pk_bf16_f32 v30, v20, v21
    v_cvt_pk_bf16_f32 v31, v22, v23
    ds_write_b64 v180, v[30:31] offset:1280
    ds_read_u16_d16_hi v181, v9
    v_mov_b64 v[16:17], 0
    v_mov_b64 v[18:19], 0
    v_mov_b64 v[20:21], 0
    v_mov_b64 v[22:23], 0
    s_nop 0
    v_smfmac_f32_16x16x32_bf16 v[16:19], v[24:25], v[224:227], v14
    v_and_b32_dpp v28, v8, v12 row_newbcast:13 row_mask:0xf bank_mask:0xf
    v_and_b32_dpp v29, v8, v13 row_newbcast:13 row_mask:0xf bank_mask:0xf
    v_smfmac_f32_16x16x32_bf16 v[20:23], v[24:25], v[228:231], v14
    v_add_u32_dpp v11, v32, v7 row_newbcast:15 row_mask:0xf bank_mask:0xf
    buffer_load_dwordx4 v[164:167], v11, s[32:35], 0 offen offset:0
    buffer_load_dwordx4 v[172:175], v11, s[32:35], 0 offen offset:256
    v_smfmac_f32_16x16x32_bf16 v[16:19], v[28:29], v[232:235], v14
    v_and_b32_dpp v24, v8, v12 row_newbcast:2 row_mask:0xf bank_mask:0xf
    v_and_b32_dpp v25, v8, v13 row_newbcast:2 row_mask:0xf bank_mask:0xf
    v_smfmac_f32_16x16x32_bf16 v[20:23], v[28:29], v[236:239], v14
    v_xor_b32 v182, s17, v2
    s_lshl_b32 s64, s22, 2
    v_add_u32 v9, s64, v0
    v_mov_b32 v183, 0
    v_cvt_pk_bf16_f32 v30, v40, v41
    v_cvt_pk_bf16_f32 v31, v42, v43
    ds_write_b64 v182, v[30:31] offset:1024
    v_cvt_pk_bf16_f32 v30, v44, v45
    v_cvt_pk_bf16_f32 v31, v46, v47
    ds_write_b64 v182, v[30:31] offset:1280
    ds_read_u16_d16_hi v183, v9
    v_mov_b64 v[40:41], 0
    v_mov_b64 v[42:43], 0
    v_mov_b64 v[44:45], 0
    v_mov_b64 v[46:47], 0
    s_nop 0
    v_smfmac_f32_16x16x32_bf16 v[40:43], v[24:25], v[240:243], v14
    v_and_b32_dpp v28, v8, v12 row_newbcast:10 row_mask:0xf bank_mask:0xf
    v_and_b32_dpp v29, v8, v13 row_newbcast:10 row_mask:0xf bank_mask:0xf
    v_smfmac_f32_16x16x32_bf16 v[44:47], v[24:25], v[244:247], v14
    s_nop 0
    v_smfmac_f32_16x16x32_bf16 v[40:43], v[28:29], v[248:251], v14
    v_and_b32_dpp v24, v33, v12 row_newbcast:0 row_mask:0xf bank_mask:0xf
    v_and_b32_dpp v25, v33, v13 row_newbcast:0 row_mask:0xf bank_mask:0xf
    v_and_b32_dpp v26, v33, v12 row_newbcast:1 row_mask:0xf bank_mask:0xf
    v_and_b32_dpp v27, v33, v13 row_newbcast:1 row_mask:0xf bank_mask:0xf
    v_smfmac_f32_16x16x32_bf16 v[44:47], v[28:29], v[252:255], v14
    v_xor_b32 v184, s18, v2
    s_lshl_b32 s64, s23, 2
    v_add_u32 v9, s64, v0
    v_mov_b32 v185, 0
    v_cvt_pk_bf16_f32 v30, v16, v17
    v_cvt_pk_bf16_f32 v31, v18, v19
    ds_write_b64 v184, v[30:31] offset:1024
    v_cvt_pk_bf16_f32 v30, v20, v21
    v_cvt_pk_bf16_f32 v31, v22, v23
    ds_write_b64 v184, v[30:31] offset:1280
    ds_read_u16_d16_hi v185, v9
    v_mov_b64 v[16:17], 0
    v_mov_b64 v[18:19], 0
    v_mov_b64 v[20:21], 0
    v_mov_b64 v[22:23], 0
    s_nop 0
    v_xor_b32 v176, s19, v2
    s_lshl_b32 s64, s24, 2
    v_add_u32 v9, s64, v0
    v_mov_b32 v177, 0
    v_cvt_pk_bf16_f32 v30, v40, v41
    v_cvt_pk_bf16_f32 v31, v42, v43
    ds_write_b64 v176, v[30:31] offset:1024
    v_cvt_pk_bf16_f32 v30, v44, v45
    v_cvt_pk_bf16_f32 v31, v46, v47
    ds_write_b64 v176, v[30:31] offset:1280
    ds_read_u16_d16_hi v177, v9
    s_waitcnt lgkmcnt(0)
    s_barrier
    s_cmp_lg_u32 s25, 0
    s_cbranch_scc1 L_slow
L_fp0:
    s_bitcmp1_b32 s52, 0
    s_waitcnt vmcnt(28)
    v_smfmac_f32_16x16x64_bf16 v[16:19], v[24:27], v[48:55], v14
    v_and_b32_dpp v28, v33, v12 row_newbcast:2 row_mask:0xf bank_mask:0xf
    v_and_b32_dpp v29, v33, v13 row_newbcast:2 row_mask:0xf bank_mask:0xf
    v_smfmac_f32_16x16x64_bf16 v[20:23], v[24:27], v[56:63], v14
    v_and_b32_dpp v30, v33, v12 row_newbcast:3 row_mask:0xf bank_mask:0xf
    v_and_b32_dpp v31, v33, v13 row_newbcast:3 row_mask:0xf bank_mask:0xf
    v_add_u32_dpp v11, v34, v7 row_newbcast:0 row_mask:0xf bank_mask:0xf
    buffer_load_dwordx4 v[48:51], v11, s[32:35], 0 offen offset:0
    buffer_load_dwordx4 v[56:59], v11, s[32:35], 0 offen offset:256
    s_cbranch_scc1 L_ev0
L_fp1:
    s_bitcmp1_b32 s52, 1
    s_waitcnt vmcnt(26)
    v_smfmac_f32_16x16x64_bf16 v[16:19], v[28:31], v[64:71], v14
    v_and_b32_dpp v24, v33, v12 row_newbcast:4 row_mask:0xf bank_mask:0xf
    v_and_b32_dpp v25, v33, v13 row_newbcast:4 row_mask:0xf bank_mask:0xf
    v_smfmac_f32_16x16x64_bf16 v[20:23], v[28:31], v[72:79], v14
    v_and_b32_dpp v26, v33, v12 row_newbcast:5 row_mask:0xf bank_mask:0xf
    v_and_b32_dpp v27, v33, v13 row_newbcast:5 row_mask:0xf bank_mask:0xf
    v_add_u32_dpp v11, v34, v7 row_newbcast:1 row_mask:0xf bank_mask:0xf
    buffer_load_dwordx4 v[52:55], v11, s[32:35], 0 offen offset:0
    buffer_load_dwordx4 v[60:63], v11, s[32:35], 0 offen offset:256
    s_cbranch_scc1 L_ev1
L_fp2:
    s_bitcmp1_b32 s52, 2
    s_waitcnt vmcnt(24)
    v_smfmac_f32_16x16x64_bf16 v[16:19], v[24:27], v[80:87], v14
    v_and_b32_dpp v28, v33, v12 row_newbcast:6 row_mask:0xf bank_mask:0xf
    v_and_b32_dpp v29, v33, v13 row_newbcast:6 row_mask:0xf bank_mask:0xf
    v_smfmac_f32_16x16x64_bf16 v[20:23], v[24:27], v[88:95], v14
    v_and_b32_dpp v30, v33, v12 row_newbcast:7 row_mask:0xf bank_mask:0xf
    v_and_b32_dpp v31, v33, v13 row_newbcast:7 row_mask:0xf bank_mask:0xf
    v_add_u32_dpp v11, v34, v7 row_newbcast:2 row_mask:0xf bank_mask:0xf
    buffer_load_dwordx4 v[64:67], v11, s[32:35], 0 offen offset:0
    buffer_load_dwordx4 v[72:75], v11, s[32:35], 0 offen offset:256
    s_cbranch_scc1 L_ev2
L_fp3:
    s_bitcmp1_b32 s52, 3
    s_waitcnt vmcnt(22)
    v_smfmac_f32_16x16x64_bf16 v[16:19], v[28:31], v[96:103], v14
    v_and_b32_dpp v24, v33, v12 row_newbcast:8 row_mask:0xf bank_mask:0xf
    v_and_b32_dpp v25, v33, v13 row_newbcast:8 row_mask:0xf bank_mask:0xf
    v_smfmac_f32_16x16x64_bf16 v[20:23], v[28:31], v[104:111], v14
    v_and_b32_dpp v26, v33, v12 row_newbcast:9 row_mask:0xf bank_mask:0xf
    v_and_b32_dpp v27, v33, v13 row_newbcast:9 row_mask:0xf bank_mask:0xf
    v_add_u32_dpp v11, v34, v7 row_newbcast:3 row_mask:0xf bank_mask:0xf
    buffer_load_dwordx4 v[68:71], v11, s[32:35], 0 offen offset:0
    buffer_load_dwordx4 v[76:79], v11, s[32:35], 0 offen offset:256
    s_cbranch_scc1 L_ev3
L_fp4:
    s_bitcmp1_b32 s52, 4
    s_waitcnt vmcnt(20)
    v_smfmac_f32_16x16x64_bf16 v[16:19], v[24:27], v[112:119], v14
    v_and_b32_dpp v28, v33, v12 row_newbcast:10 row_mask:0xf bank_mask:0xf
    v_and_b32_dpp v29, v33, v13 row_newbcast:10 row_mask:0xf bank_mask:0xf
    v_smfmac_f32_16x16x64_bf16 v[20:23], v[24:27], v[120:127], v14
    v_and_b32_dpp v30, v33, v12 row_newbcast:11 row_mask:0xf bank_mask:0xf
    v_and_b32_dpp v31, v33, v13 row_newbcast:11 row_mask:0xf bank_mask:0xf
    v_add_u32_dpp v11, v34, v7 row_newbcast:4 row_mask:0xf bank_mask:0xf
    buffer_load_dwordx4 v[80:83], v11, s[32:35], 0 offen offset:0
    buffer_load_dwordx4 v[88:91], v11, s[32:35], 0 offen offset:256
    s_cbranch_scc1 L_ev4
L_fp5:
    s_bitcmp1_b32 s52, 5
    s_waitcnt vmcnt(18)
    v_smfmac_f32_16x16x64_bf16 v[16:19], v[28:31], v[128:135], v14
    v_and_b32_dpp v24, v33, v12 row_newbcast:12 row_mask:0xf bank_mask:0xf
    v_and_b32_dpp v25, v33, v13 row_newbcast:12 row_mask:0xf bank_mask:0xf
    v_smfmac_f32_16x16x64_bf16 v[20:23], v[28:31], v[136:143], v14
    v_and_b32_dpp v26, v33, v12 row_newbcast:13 row_mask:0xf bank_mask:0xf
    v_and_b32_dpp v27, v33, v13 row_newbcast:13 row_mask:0xf bank_mask:0xf
    v_add_u32_dpp v11, v34, v7 row_newbcast:5 row_mask:0xf bank_mask:0xf
    buffer_load_dwordx4 v[84:87], v11, s[32:35], 0 offen offset:0
    buffer_load_dwordx4 v[92:95], v11, s[32:35], 0 offen offset:256
    s_cbranch_scc1 L_ev5
L_fp6:
    s_bitcmp1_b32 s52, 6
    s_waitcnt vmcnt(16)
    v_smfmac_f32_16x16x64_bf16 v[16:19], v[24:27], v[144:151], v14
    v_and_b32_dpp v28, v33, v12 row_newbcast:14 row_mask:0xf bank_mask:0xf
    v_and_b32_dpp v29, v33, v13 row_newbcast:14 row_mask:0xf bank_mask:0xf
    v_smfmac_f32_16x16x64_bf16 v[20:23], v[24:27], v[152:159], v14
    v_and_b32_dpp v30, v33, v12 row_newbcast:15 row_mask:0xf bank_mask:0xf
    v_and_b32_dpp v31, v33, v13 row_newbcast:15 row_mask:0xf bank_mask:0xf
    v_add_u32_dpp v11, v34, v7 row_newbcast:6 row_mask:0xf bank_mask:0xf
    buffer_load_dwordx4 v[96:99], v11, s[32:35], 0 offen offset:0
    buffer_load_dwordx4 v[104:107], v11, s[32:35], 0 offen offset:256
    s_cbranch_scc1 L_ev6
L_fp7:
    s_bitcmp1_b32 s52, 7
    s_waitcnt vmcnt(14)
    v_smfmac_f32_16x16x64_bf16 v[16:19], v[28:31], v[160:167], v14
    v_and_b32_dpp v24, v35, v12 row_newbcast:0 row_mask:0xf bank_mask:0xf
    v_and_b32_dpp v25, v35, v13 row_newbcast:0 row_mask:0xf bank_mask:0xf
    v_smfmac_f32_16x16x64_bf16 v[20:23], v[28:31], v[168:175], v14
    v_and_b32_dpp v26, v35, v12 row_newbcast:1 row_mask:0xf bank_mask:0xf
    v_and_b32_dpp v27, v35, v13 row_newbcast:1 row_mask:0xf bank_mask:0xf
    v_add_u32_dpp v11, v34, v7 row_newbcast:7 row_mask:0xf bank_mask:0xf
    buffer_load_dwordx4 v[100:103], v11, s[32:35], 0 offen offset:0
    buffer_load_dwordx4 v[108:111], v11, s[32:35], 0 offen offset:256
    s_cbranch_scc1 L_ev7
L_fp8:
    v_mov_b64 v[32:33], v[34:35]
    v_mov_b64 v[34:35], v[36:37]
    v_mov_b64 v[36:37], v[38:39]
    s_lshr_b32 s52, s52, 8
    s_lshr_b32 s53, s53, 8
    s_lshr_b32 s56, s56, 8
    s_mov_b32 s62, L_st1-L_anc
    s_mov_b32 s63, L_st1-L_st0
L_st0:
    s_bitcmp1_b32 s52, 0
    s_waitcnt vmcnt(12)
    v_smfmac_f32_16x16x64_bf16 v[16:19], v[24:27], v[48:55], v14
    v_and_b32_dpp v28, v33, v12 row_newbcast:2 row_mask:0xf bank_mask:0xf
    v_and_b32_dpp v29, v33, v13 row_newbcast:2 row_mask:0xf bank_mask:0xf
    v_smfmac_f32_16x16x64_bf16 v[20:23], v[24:27], v[56:63], v14
    v_and_b32_dpp v30, v33, v12 row_newbcast:3 row_mask:0xf bank_mask:0xf
    v_and_b32_dpp v31, v33, v13 row_newbcast:3 row_mask:0xf bank_mask:0xf
    v_add_u32_dpp v11, v32, v7 row_newbcast:8 row_mask:0xf bank_mask:0xf
    buffer_load_dwordx4 v[112:115], v11, s[32:35], 0 offen offset:0
    buffer_load_dwordx4 v[120:123], v11, s[32:35], 0 offen offset:256
    v_add_u32_dpp v11, v32, v7 row_newbcast:9 row_mask:0xf bank_mask:0xf
    buffer_load_dwordx4 v[116:119], v11, s[32:35], 0 offen offset:0
    buffer_load_dwordx4 v[124:127], v11, s[32:35], 0 offen offset:256
    s_cbranch_scc1 L_ev0
L_st1:
    s_bitcmp1_b32 s52, 1
    s_waitcnt vmcnt(12)
    v_smfmac_f32_16x16x64_bf16 v[16:19], v[28:31], v[64:71], v14
    v_and_b32_dpp v24, v33, v12 row_newbcast:4 row_mask:0xf bank_mask:0xf
    v_and_b32_dpp v25, v33, v13 row_newbcast:4 row_mask:0xf bank_mask:0xf
    v_smfmac_f32_16x16x64_bf16 v[20:23], v[28:31], v[72:79], v14
    v_and_b32_dpp v26, v33, v12 row_newbcast:5 row_mask:0xf bank_mask:0xf
    v_and_b32_dpp v27, v33, v13 row_newbcast:5 row_mask:0xf bank_mask:0xf
    v_add_u32_dpp v11, v32, v7 row_newbcast:10 row_mask:0xf bank_mask:0xf
    buffer_load_dwordx4 v[128:131], v11, s[32:35], 0 offen offset:0
    buffer_load_dwordx4 v[136:139], v11, s[32:35], 0 offen offset:256
    v_add_u32_dpp v11, v32, v7 row_newbcast:11 row_mask:0xf bank_mask:0xf
    buffer_load_dwordx4 v[132:135], v11, s[32:35], 0 offen offset:0
    buffer_load_dwordx4 v[140:143], v11, s[32:35], 0 offen offset:256
    s_cbranch_scc1 L_ev1
L_st2:
    s_bitcmp1_b32 s52, 2
    s_waitcnt vmcnt(12)
    v_smfmac_f32_16x16x64_bf16 v[16:19], v[24:27], v[80:87], v14
    v_and_b32_dpp v28, v33, v12 row_newbcast:6 row_mask:0xf bank_mask:0xf
    v_and_b32_dpp v29, v33, v13 row_newbcast:6 row_mask:0xf bank_mask:0xf
    v_smfmac_f32_16x16x64_bf16 v[20:23], v[24:27], v[88:95], v14
    v_and_b32_dpp v30, v33, v12 row_newbcast:7 row_mask:0xf bank_mask:0xf
    v_and_b32_dpp v31, v33, v13 row_newbcast:7 row_mask:0xf bank_mask:0xf
    v_add_u32_dpp v11, v32, v7 row_newbcast:12 row_mask:0xf bank_mask:0xf
    buffer_load_dwordx4 v[144:147], v11, s[32:35], 0 offen offset:0
    buffer_load_dwordx4 v[152:155], v11, s[32:35], 0 offen offset:256
    v_add_u32_dpp v11, v32, v7 row_newbcast:13 row_mask:0xf bank_mask:0xf
    buffer_load_dwordx4 v[148:151], v11, s[32:35], 0 offen offset:0
    buffer_load_dwordx4 v[156:159], v11, s[32:35], 0 offen offset:256
    s_cbranch_scc1 L_ev2
L_st3:
    s_bitcmp1_b32 s52, 3
    s_waitcnt vmcnt(12)
    v_smfmac_f32_16x16x64_bf16 v[16:19], v[28:31], v[96:103], v14
    v_and_b32_dpp v24, v33, v12 row_newbcast:8 row_mask:0xf bank_mask:0xf
    v_and_b32_dpp v25, v33, v13 row_newbcast:8 row_mask:0xf bank_mask:0xf
    v_smfmac_f32_16x16x64_bf16 v[20:23], v[28:31], v[104:111], v14
    v_and_b32_dpp v26, v33, v12 row_newbcast:9 row_mask:0xf bank_mask:0xf
    v_and_b32_dpp v27, v33, v13 row_newbcast:9 row_mask:0xf bank_mask:0xf
    v_add_u32_dpp v11, v32, v7 row_newbcast:14 row_mask:0xf bank_mask:0xf
    buffer_load_dwordx4 v[160:163], v11, s[32:35], 0 offen offset:0
    buffer_load_dwordx4 v[168:171], v11, s[32:35], 0 offen offset:256
    v_add_u32_dpp v11, v32, v7 row_newbcast:15 row_mask:0xf bank_mask:0xf
    buffer_load_dwordx4 v[164:167], v11, s[32:35], 0 offen offset:0
    buffer_load_dwordx4 v[172:175], v11, s[32:35], 0 offen offset:256
    s_cbranch_scc1 L_ev3
L_st4:
    s_bitcmp1_b32 s52, 4
    s_waitcnt vmcnt(12)
    v_smfmac_f32_16x16x64_bf16 v[16:19], v[24:27], v[112:119], v14
    v_and_b32_dpp v28, v33, v12 row_newbcast:10 row_mask:0xf bank_mask:0xf
    v_and_b32_dpp v29, v33, v13 row_newbcast:10 row_mask:0xf bank_mask:0xf
    v_smfmac_f32_16x16x64_bf16 v[20:23], v[24:27], v[120:127], v14
    v_and_b32_dpp v30, v33, v12 row_newbcast:11 row_mask:0xf bank_mask:0xf
    v_and_b32_dpp v31, v33, v13 row_newbcast:11 row_mask:0xf bank_mask:0xf
    v_add_u32_dpp v11, v34, v7 row_newbcast:0 row_mask:0xf bank_mask:0xf
    buffer_load_dwordx4 v[48:51], v11, s[32:35], 0 offen offset:0
    buffer_load_dwordx4 v[56:59], v11, s[32:35], 0 offen offset:256
    v_add_u32_dpp v11, v34, v7 row_newbcast:1 row_mask:0xf bank_mask:0xf
    buffer_load_dwordx4 v[52:55], v11, s[32:35], 0 offen offset:0
    buffer_load_dwordx4 v[60:63], v11, s[32:35], 0 offen offset:256
    s_cbranch_scc1 L_ev4
L_st5:
    s_bitcmp1_b32 s52, 5
    s_waitcnt vmcnt(12)
    v_smfmac_f32_16x16x64_bf16 v[16:19], v[28:31], v[128:135], v14
    v_and_b32_dpp v24, v33, v12 row_newbcast:12 row_mask:0xf bank_mask:0xf
    v_and_b32_dpp v25, v33, v13 row_newbcast:12 row_mask:0xf bank_mask:0xf
    v_smfmac_f32_16x16x64_bf16 v[20:23], v[28:31], v[136:143], v14
    v_and_b32_dpp v26, v33, v12 row_newbcast:13 row_mask:0xf bank_mask:0xf
    v_and_b32_dpp v27, v33, v13 row_newbcast:13 row_mask:0xf bank_mask:0xf
    v_add_u32_dpp v11, v34, v7 row_newbcast:2 row_mask:0xf bank_mask:0xf
    buffer_load_dwordx4 v[64:67], v11, s[32:35], 0 offen offset:0
    buffer_load_dwordx4 v[72:75], v11, s[32:35], 0 offen offset:256
    v_add_u32_dpp v11, v34, v7 row_newbcast:3 row_mask:0xf bank_mask:0xf
    buffer_load_dwordx4 v[68:71], v11, s[32:35], 0 offen offset:0
    buffer_load_dwordx4 v[76:79], v11, s[32:35], 0 offen offset:256
    s_cbranch_scc1 L_ev5
L_st6:
    s_bitcmp1_b32 s52, 6
    s_waitcnt vmcnt(12)
    v_smfmac_f32_16x16x64_bf16 v[16:19], v[24:27], v[144:151], v14
    v_and_b32_dpp v28, v33, v12 row_newbcast:14 row_mask:0xf bank_mask:0xf
    v_and_b32_dpp v29, v33, v13 row_newbcast:14 row_mask:0xf bank_mask:0xf
    v_smfmac_f32_16x16x64_bf16 v[20:23], v[24:27], v[152:159], v14
    v_and_b32_dpp v30, v33, v12 row_newbcast:15 row_mask:0xf bank_mask:0xf
    v_and_b32_dpp v31, v33, v13 row_newbcast:15 row_mask:0xf bank_mask:0xf
    v_add_u32_dpp v11, v34, v7 row_newbcast:4 row_mask:0xf bank_mask:0xf
    buffer_load_dwordx4 v[80:83], v11, s[32:35], 0 offen offset:0
    buffer_load_dwordx4 v[88:91], v11, s[32:35], 0 offen offset:256
    v_add_u32_dpp v11, v34, v7 row_newbcast:5 row_mask:0xf bank_mask:0xf
    buffer_load_dwordx4 v[84:87], v11, s[32:35], 0 offen offset:0
    buffer_load_dwordx4 v[92:95], v11, s[32:35], 0 offen offset:256
    s_cbranch_scc1 L_ev6
L_st7:
    s_bitcmp1_b32 s52, 7
    s_waitcnt vmcnt(12)
    v_smfmac_f32_16x16x64_bf16 v[16:19], v[28:31], v[160:167], v14
    v_and_b32_dpp v24, v35, v12 row_newbcast:0 row_mask:0xf bank_mask:0xf
    v_and_b32_dpp v25, v35, v13 row_newbcast:0 row_mask:0xf bank_mask:0xf
    v_smfmac_f32_16x16x64_bf16 v[20:23], v[28:31], v[168:175], v14
    v_and_b32_dpp v26, v35, v12 row_newbcast:1 row_mask:0xf bank_mask:0xf
    v_and_b32_dpp v27, v35, v13 row_newbcast:1 row_mask:0xf bank_mask:0xf
    v_add_u32_dpp v11, v34, v7 row_newbcast:6 row_mask:0xf bank_mask:0xf
    buffer_load_dwordx4 v[96:99], v11, s[32:35], 0 offen offset:0
    buffer_load_dwordx4 v[104:107], v11, s[32:35], 0 offen offset:256
    v_add_u32_dpp v11, v34, v7 row_newbcast:7 row_mask:0xf bank_mask:0xf
    buffer_load_dwordx4 v[100:103], v11, s[32:35], 0 offen offset:0
    buffer_load_dwordx4 v[108:111], v11, s[32:35], 0 offen offset:256
    s_cbranch_scc1 L_ev7
L_st8:
    v_mov_b64 v[32:33], v[34:35]
    v_mov_b64 v[34:35], v[36:37]
    v_mov_b64 v[36:37], v[38:39]
    s_lshr_b32 s52, s52, 8
    s_lshr_b32 s53, s53, 8
    s_lshr_b32 s56, s56, 8
    s_branch L_st0
L_pad8:
    s_setpc_b64 s[68:69]
L_dr0:
    s_add_u32 s49, s49, 1
    ds_write_b32 v10, v6 offset:48
    s_waitcnt vmcnt(12)
    v_smfmac_f32_16x16x64_bf16 v[16:19], v[24:27], v[48:55], v14
    v_and_b32_dpp v28, v33, v12 row_newbcast:2 row_mask:0xf bank_mask:0xf
    v_and_b32_dpp v29, v33, v13 row_newbcast:2 row_mask:0xf bank_mask:0xf
    v_smfmac_f32_16x16x64_bf16 v[20:23], v[24:27], v[56:63], v14
    v_and_b32_dpp v30, v33, v12 row_newbcast:3 row_mask:0xf bank_mask:0xf
    v_and_b32_dpp v31, v33, v13 row_newbcast:3 row_mask:0xf bank_mask:0xf
    s_cmp_eq_u32 s49, 1
    s_cbranch_scc1 L_dw0_1
    s_cmp_eq_u32 s49, 2
    s_cbranch_scc1 L_dw0_2
L_dw0_3:
    s_waitcnt vmcnt(0)
L_dw0_2:
    s_waitcnt vmcnt(4)
L_dw0_1:
    s_waitcnt vmcnt(8)
    s_bitcmp1_b32 s52, 0
    s_cbranch_scc1 L_ev0
L_dr1:
    s_add_u32 s49, s49, 1
    ds_write_b32 v10, v6 offset:48
    s_waitcnt vmcnt(12)
    v_smfmac_f32_16x16x64_bf16 v[16:19], v[28:31], v[64:71], v14
    v_and_b32_dpp v24, v33, v12 row_newbcast:4 row_mask:0xf bank_mask:0xf
    v_and_b32_dpp v25, v33, v13 row_newbcast:4 row_mask:0xf bank_mask:0xf
    v_smfmac_f32_16x16x64_bf16 v[20:23], v[28:31], v[72:79], v14
    v_and_b32_dpp v26, v33, v12 row_newbcast:5 row_mask:0xf bank_mask:0xf
    v_and_b32_dpp v27, v33, v13 row_newbcast:5 row_mask:0xf bank_mask:0xf
    s_cmp_eq_u32 s49, 1
    s_cbranch_scc1 L_dw1_1
    s_cmp_eq_u32 s49, 2
    s_cbranch_scc1 L_dw1_2
L_dw1_3:
    s_waitcnt vmcnt(0)
L_dw1_2:
    s_waitcnt vmcnt(4)
L_dw1_1:
    s_waitcnt vmcnt(8)
    s_bitcmp1_b32 s52, 1
    s_cbranch_scc1 L_ev1
L_dr2:
    s_add_u32 s49, s49, 1
    ds_write_b32 v10, v6 offset:48
    s_waitcnt vmcnt(12)
    v_smfmac_f32_16x16x64_bf16 v[16:19], v[24:27], v[80:87], v14
    v_and_b32_dpp v28, v33, v12 row_newbcast:6 row_mask:0xf bank_mask:0xf
    v_and_b32_dpp v29, v33, v13 row_newbcast:6 row_mask:0xf bank_mask:0xf
    v_smfmac_f32_16x16x64_bf16 v[20:23], v[24:27], v[88:95], v14
    v_and_b32_dpp v30, v33, v12 row_newbcast:7 row_mask:0xf bank_mask:0xf
    v_and_b32_dpp v31, v33, v13 row_newbcast:7 row_mask:0xf bank_mask:0xf
    s_cmp_eq_u32 s49, 1
    s_cbranch_scc1 L_dw2_1
    s_cmp_eq_u32 s49, 2
    s_cbranch_scc1 L_dw2_2
L_dw2_3:
    s_waitcnt vmcnt(0)
L_dw2_2:
    s_waitcnt vmcnt(4)
L_dw2_1:
    s_waitcnt vmcnt(8)
    s_bitcmp1_b32 s52, 2
    s_cbranch_scc1 L_ev2
L_dr3:
    s_add_u32 s49, s49, 1
    ds_write_b32 v10, v6 offset:48
    s_waitcnt vmcnt(12)
    v_smfmac_f32_16x16x64_bf16 v[16:19], v[28:31], v[96:103], v14
    v_and_b32_dpp v24, v33, v12 row_newbcast:8 row_mask:0xf bank_mask:0xf
    v_and_b32_dpp v25, v33, v13 row_newbcast:8 row_mask:0xf bank_mask:0xf
    v_smfmac_f32_16x16x64_bf16 v[20:23], v[28:31], v[104:111], v14
    v_and_b32_dpp v26, v33, v12 row_newbcast:9 row_mask:0xf bank_mask:0xf
    v_and_b32_dpp v27, v33, v13 row_newbcast:9 row_mask:0xf bank_mask:0xf
    s_cmp_eq_u32 s49, 1
    s_cbranch_scc1 L_dw3_1
    s_cmp_eq_u32 s49, 2
    s_cbranch_scc1 L_dw3_2
L_dw3_3:
    s_waitcnt vmcnt(0)
L_dw3_2:
    s_waitcnt vmcnt(4)
L_dw3_1:
    s_waitcnt vmcnt(8)
    s_bitcmp1_b32 s52, 3
    s_cbranch_scc1 L_ev3
L_dr4:
    s_add_u32 s49, s49, 1
    ds_write_b32 v10, v6 offset:48
    s_waitcnt vmcnt(12)
    v_smfmac_f32_16x16x64_bf16 v[16:19], v[24:27], v[112:119], v14
    v_and_b32_dpp v28, v33, v12 row_newbcast:10 row_mask:0xf bank_mask:0xf
    v_and_b32_dpp v29, v33, v13 row_newbcast:10 row_mask:0xf bank_mask:0xf
    v_smfmac_f32_16x16x64_bf16 v[20:23], v[24:27], v[120:127], v14
    v_and_b32_dpp v30, v33, v12 row_newbcast:11 row_mask:0xf bank_mask:0xf
    v_and_b32_dpp v31, v33, v13 row_newbcast:11 row_mask:0xf bank_mask:0xf
    s_cmp_eq_u32 s49, 1
    s_cbranch_scc1 L_dw4_1
    s_cmp_eq_u32 s49, 2
    s_cbranch_scc1 L_dw4_2
L_dw4_3:
    s_waitcnt vmcnt(0)
L_dw4_2:
    s_waitcnt vmcnt(4)
L_dw4_1:
    s_waitcnt vmcnt(8)
    s_bitcmp1_b32 s52, 4
    s_cbranch_scc1 L_ev4
L_dr5:
    s_add_u32 s49, s49, 1
    ds_write_b32 v10, v6 offset:48
    s_waitcnt vmcnt(12)
    v_smfmac_f32_16x16x64_bf16 v[16:19], v[28:31], v[128:135], v14
    v_and_b32_dpp v24, v33, v12 row_newbcast:12 row_mask:0xf bank_mask:0xf
    v_and_b32_dpp v25, v33, v13 row_newbcast:12 row_mask:0xf bank_mask:0xf
    v_smfmac_f32_16x16x64_bf16 v[20:23], v[28:31], v[136:143], v14
    v_and_b32_dpp v26, v33, v12 row_newbcast:13 row_mask:0xf bank_mask:0xf
    v_and_b32_dpp v27, v33, v13 row_newbcast:13 row_mask:0xf bank_mask:0xf
    s_cmp_eq_u32 s49, 1
    s_cbranch_scc1 L_dw5_1
    s_cmp_eq_u32 s49, 2
    s_cbranch_scc1 L_dw5_2
L_dw5_3:
    s_waitcnt vmcnt(0)
L_dw5_2:
    s_waitcnt vmcnt(4)
L_dw5_1:
    s_waitcnt vmcnt(8)
    s_bitcmp1_b32 s52, 5
    s_cbranch_scc1 L_ev5
L_dr6:
    s_add_u32 s49, s49, 1
    ds_write_b32 v10, v6 offset:48
    s_waitcnt vmcnt(12)
    v_smfmac_f32_16x16x64_bf16 v[16:19], v[24:27], v[144:151], v14
    v_and_b32_dpp v28, v33, v12 row_newbcast:14 row_mask:0xf bank_mask:0xf
    v_and_b32_dpp v29, v33, v13 row_newbcast:14 row_mask:0xf bank_mask:0xf
    v_smfmac_f32_16x16x64_bf16 v[20:23], v[24:27], v[152:159], v14
    v_and_b32_dpp v30, v33, v12 row_newbcast:15 row_mask:0xf bank_mask:0xf
    v_and_b32_dpp v31, v33, v13 row_newbcast:15 row_mask:0xf bank_mask:0xf
    s_cmp_eq_u32 s49, 1
    s_cbranch_scc1 L_dw6_1
    s_cmp_eq_u32 s49, 2
    s_cbranch_scc1 L_dw6_2
L_dw6_3:
    s_waitcnt vmcnt(0)
L_dw6_2:
    s_waitcnt vmcnt(4)
L_dw6_1:
    s_waitcnt vmcnt(8)
    s_bitcmp1_b32 s52, 6
    s_cbranch_scc1 L_ev6
L_dr7:
    s_add_u32 s49, s49, 1
    ds_write_b32 v10, v6 offset:48
    s_waitcnt vmcnt(12)
    v_smfmac_f32_16x16x64_bf16 v[16:19], v[28:31], v[160:167], v14
    v_and_b32_dpp v24, v35, v12 row_newbcast:0 row_mask:0xf bank_mask:0xf
    v_and_b32_dpp v25, v35, v13 row_newbcast:0 row_mask:0xf bank_mask:0xf
    v_smfmac_f32_16x16x64_bf16 v[20:23], v[28:31], v[168:175], v14
    v_and_b32_dpp v26, v35, v12 row_newbcast:1 row_mask:0xf bank_mask:0xf
    v_and_b32_dpp v27, v35, v13 row_newbcast:1 row_mask:0xf bank_mask:0xf
    s_cmp_eq_u32 s49, 1
    s_cbranch_scc1 L_dw7_1
    s_cmp_eq_u32 s49, 2
    s_cbranch_scc1 L_dw7_2
L_dw7_3:
    s_waitcnt vmcnt(0)
L_dw7_2:
    s_waitcnt vmcnt(4)
L_dw7_1:
    s_waitcnt vmcnt(8)
    s_bitcmp1_b32 s52, 7
    s_cbranch_scc1 L_ev7
L_dr8:
    v_mov_b64 v[32:33], v[34:35]
    v_mov_b64 v[34:35], v[36:37]
    v_mov_b64 v[36:37], v[38:39]
    s_lshr_b32 s52, s52, 8
    s_lshr_b32 s53, s53, 8
    s_lshr_b32 s56, s56, 8
    s_branch L_dr0
L_pad0:
    s_setpc_b64 s[68:69]
L_ev0:
    s_and_b32 s65, s57, 15
    v_cmp_ge_u32 s[66:67], s65, v4
    v_cmp_gt_u32 s[68:69], s65, v4
    s_bitcmp1_b32 s56, 0
    s_cselect_b64 s[62:63], s[70:71], s[62:63]
    v_cndmask_b32 v40, 0, v28, s[66:67]
    v_cndmask_b32 v41, 0, v29, s[66:67]
    v_cndmask_b32 v42, 0, v30, s[68:69]
    v_cndmask_b32 v43, 0, v31, s[68:69]
    s_mul_i32 s64, s63, 0
    s_bitcmp1_b32 s53, 0
    s_cbranch_scc0 L_evret
    s_waitcnt vmcnt(12)
    v_smfmac_f32_16x16x64_bf16 v[16:19], v[40:43], v[64:71], v14
    v_xor_b32 v28, v28, v40
    v_xor_b32 v29, v29, v41
    v_smfmac_f32_16x16x64_bf16 v[20:23], v[40:43], v[72:79], v14
    v_xor_b32 v30, v30, v42
    v_xor_b32 v31, v31, v43
    s_branch L_flush
L_pad1:
    s_setpc_b64 s[68:69]
L_ev1:
    s_and_b32 s65, s57, 15
    v_cmp_ge_u32 s[66:67], s65, v4
    v_cmp_gt_u32 s[68:69], s65, v4
    s_bitcmp1_b32 s56, 1
    s_cselect_b64 s[62:63], s[70:71], s[62:63]
    v_cndmask_b32 v40, 0, v24, s[66:67]
    v_cndmask_b32 v41, 0, v25, s[66:67]
    v_cndmask_b32 v42, 0, v26, s[68:69]
    v_cndmask_b32 v43, 0, v27, s[68:69]
    s_mul_i32 s64, s63, 1
    s_bitcmp1_b32 s53, 1
    s_cbranch_scc0 L_evret
    s_waitcnt vmcnt(12)
    v_smfmac_f32_16x16x64_bf16 v[16:19], v[40:43], v[80:87], v14
    v_xor_b32 v24, v24, v40
    v_xor_b32 v25, v25, v41
    v_smfmac_f32_16x16x64_bf16 v[20:23], v[40:43], v[88:95], v14
    v_xor_b32 v26, v26, v42
    v_xor_b32 v27, v27, v43
    s_branch L_flush
L_pad2:
    s_setpc_b64 s[68:69]
L_ev2:
    s_and_b32 s65, s57, 15
    v_cmp_ge_u32 s[66:67], s65, v4
    v_cmp_gt_u32 s[68:69], s65, v4
    s_bitcmp1_b32 s56, 2
    s_cselect_b64 s[62:63], s[70:71], s[62:63]
    v_cndmask_b32 v40, 0, v28, s[66:67]
    v_cndmask_b32 v41, 0, v29, s[66:67]
    v_cndmask_b32 v42, 0, v30, s[68:69]
    v_cndmask_b32 v43, 0, v31, s[68:69]
    s_mul_i32 s64, s63, 2
    s_bitcmp1_b32 s53, 2
    s_cbranch_scc0 L_evret
    s_waitcnt vmcnt(12)
    v_smfmac_f32_16x16x64_bf16 v[16:19], v[40:43], v[96:103], v14
    v_xor_b32 v28, v28, v40
    v_xor_b32 v29, v29, v41
    v_smfmac_f32_16x16x64_bf16 v[20:23], v[40:43], v[104:111], v14
    v_xor_b32 v30, v30, v42
    v_xor_b32 v31, v31, v43
    s_branch L_flush
L_pad3:
    s_setpc_b64 s[68:69]
L_ev3:
    s_and_b32 s65, s57, 15
    v_cmp_ge_u32 s[66:67], s65, v4
    v_cmp_gt_u32 s[68:69], s65, v4
    s_bitcmp1_b32 s56, 3
    s_cselect_b64 s[62:63], s[70:71], s[62:63]
    v_cndmask_b32 v40, 0, v24, s[66:67]
    v_cndmask_b32 v41, 0, v25, s[66:67]
    v_cndmask_b32 v42, 0, v26, s[68:69]
    v_cndmask_b32 v43, 0, v27, s[68:69]
    s_mul_i32 s64, s63, 3
    s_bitcmp1_b32 s53, 3
    s_cbranch_scc0 L_evret
    s_waitcnt vmcnt(12)
    v_smfmac_f32_16x16x64_bf16 v[16:19], v[40:43], v[112:119], v14
    v_xor_b32 v24, v24, v40
    v_xor_b32 v25, v25, v41
    v_smfmac_f32_16x16x64_bf16 v[20:23], v[40:43], v[120:127], v14
    v_xor_b32 v26, v26, v42
    v_xor_b32 v27, v27, v43
    s_branch L_flush
L_pad4:
    s_setpc_b64 s[68:69]
L_ev4:
    s_and_b32 s65, s57, 15
    v_cmp_ge_u32 s[66:67], s65, v4
    v_cmp_gt_u32 s[68:69], s65, v4
    s_bitcmp1_b32 s56, 4
    s_cselect_b64 s[62:63], s[70:71], s[62:63]
    v_cndmask_b32 v40, 0, v28, s[66:67]
    v_cndmask_b32 v41, 0, v29, s[66:67]
    v_cndmask_b32 v42, 0, v30, s[68:69]
    v_cndmask_b32 v43, 0, v31, s[68:69]
    s_mul_i32 s64, s63, 4
    s_bitcmp1_b32 s53, 4
    s_cbranch_scc0 L_evret
    s_waitcnt vmcnt(12)
    v_smfmac_f32_16x16x64_bf16 v[16:19], v[40:43], v[128:135], v14
    v_xor_b32 v28, v28, v40
    v_xor_b32 v29, v29, v41
    v_smfmac_f32_16x16x64_bf16 v[20:23], v[40:43], v[136:143], v14
    v_xor_b32 v30, v30, v42
    v_xor_b32 v31, v31, v43
    s_branch L_flush
L_pad5:
    s_setpc_b64 s[68:69]
L_ev5:
    s_and_b32 s65, s57, 15
    v_cmp_ge_u32 s[66:67], s65, v4
    v_cmp_gt_u32 s[68:69], s65, v4
    s_bitcmp1_b32 s56, 5
    s_cselect_b64 s[62:63], s[70:71], s[62:63]
    v_cndmask_b32 v40, 0, v24, s[66:67]
    v_cndmask_b32 v41, 0, v25, s[66:67]
    v_cndmask_b32 v42, 0, v26, s[68:69]
    v_cndmask_b32 v43, 0, v27, s[68:69]
    s_mul_i32 s64, s63, 5
    s_bitcmp1_b32 s53, 5
    s_cbranch_scc0 L_evret
    s_waitcnt vmcnt(12)
    v_smfmac_f32_16x16x64_bf16 v[16:19], v[40:43], v[144:151], v14
    v_xor_b32 v24, v24, v40
    v_xor_b32 v25, v25, v41
    v_smfmac_f32_16x16x64_bf16 v[20:23], v[40:43], v[152:159], v14
    v_xor_b32 v26, v26, v42
    v_xor_b32 v27, v27, v43
    s_branch L_flush
L_pad6:
    s_setpc_b64 s[68:69]
L_ev6:
    s_and_b32 s65, s57, 15
    v_cmp_ge_u32 s[66:67], s65, v4
    v_cmp_gt_u32 s[68:69], s65, v4
    s_bitcmp1_b32 s56, 6
    s_cselect_b64 s[62:63], s[70:71], s[62:63]
    v_cndmask_b32 v40, 0, v28, s[66:67]
    v_cndmask_b32 v41, 0, v29, s[66:67]
    v_cndmask_b32 v42, 0, v30, s[68:69]
    v_cndmask_b32 v43, 0, v31, s[68:69]
    s_mul_i32 s64, s63, 6
    s_bitcmp1_b32 s53, 6
    s_cbranch_scc0 L_evret
    s_waitcnt vmcnt(12)
    v_smfmac_f32_16x16x64_bf16 v[16:19], v[40:43], v[160:167], v14
    v_xor_b32 v28, v28, v40
    v_xor_b32 v29, v29, v41
    v_smfmac_f32_16x16x64_bf16 v[20:23], v[40:43], v[168:175], v14
    v_xor_b32 v30, v30, v42
    v_xor_b32 v31, v31, v43
    s_branch L_flush
L_pad7:
    s_setpc_b64 s[68:69]
L_ev7:
    s_and_b32 s65, s57, 15
    v_cmp_ge_u32 s[66:67], s65, v4
    v_cmp_gt_u32 s[68:69], s65, v4
    s_bitcmp1_b32 s56, 7
    s_cselect_b64 s[62:63], s[70:71], s[62:63]
    v_cndmask_b32 v40, 0, v24, s[66:67]
    v_cndmask_b32 v41, 0, v25, s[66:67]
    v_cndmask_b32 v42, 0, v26, s[68:69]
    v_cndmask_b32 v43, 0, v27, s[68:69]
    s_mul_i32 s64, s63, 7
    s_bitcmp1_b32 s53, 7
    s_cbranch_scc0 L_evret
    s_waitcnt vmcnt(12)
    v_smfmac_f32_16x16x64_bf16 v[16:19], v[40:43], v[48:55], v14
    v_xor_b32 v24, v24, v40
    v_xor_b32 v25, v25, v41
    v_smfmac_f32_16x16x64_bf16 v[20:23], v[40:43], v[56:63], v14
    v_xor_b32 v26, v26, v42
    v_xor_b32 v27, v27, v43
    s_nop 0
L_flush:
    s_lshr_b32 s57, s57, 4
    s_cmp_eq_u32 s26, 4
    v_add_u32 v1, 1, v1
    v_mul_f32 v40, v177, v16
    v_mul_f32 v41, v177, v17
    v_mul_f32 v42, v177, v18
    v_mul_f32 v43, v177, v19
    v_cvt_pk_bf16_f32 v40, v40, v41
    v_cvt_pk_bf16_f32 v41, v42, v43
    ds_write_b64 v176, v[40:41] offset:41984
    v_mul_f32 v44, v177, v20
    v_mul_f32 v45, v177, v21
    v_mul_f32 v46, v177, v22
    v_mul_f32 v47, v177, v23
    v_cvt_pk_bf16_f32 v44, v44, v45
    v_cvt_pk_bf16_f32 v45, v46, v47
    ds_write_b64 v176, v[44:45] offset:42240
    ds_write_b32 v10, v1 offset:32
    s_cbranch_scc1 L_sdone
    v_mov_b64 v[16:17], 0
    v_mov_b64 v[18:19], 0
    v_mov_b64 v[20:21], 0
    v_mov_b64 v[22:23], 0
    s_add_u32 s26, s26, 1
    v_mov_b64 v[176:177], v[178:179]
    v_mov_b64 v[178:179], v[180:181]
    v_mov_b64 v[180:181], v[182:183]
    v_mov_b64 v[182:183], v[184:185]
L_evret:
    s_add_u32 s64, s64, s62
    s_add_u32 s54, s72, s64
    s_addc_u32 s55, s73, 0
    s_setpc_b64 s[54:55]
L_pad9:
    s_setpc_b64 s[68:69]
L_slow:
    s_mov_b32 s62, L_slow_pair-L_anc
    v_mbcnt_lo_u32_b32 v200, -1, 0
    v_mbcnt_hi_u32_b32 v200, -1, v200
L_slow_pair:
    v_lshlrev_b32 v201, 2, v200
    s_mul_i32 s70, s1, 40
    s_lshl1_add_u32 s70, s24, s70
    s_mov_b32 s71, 0
    s_mov_b32 s24, s20
    s_mov_b32 s20, s21
    s_mov_b32 s21, s22
    s_mov_b32 s22, s23
L_slow_chunk:
    global_load_dword v202, v201, s[8:9]
    global_load_dword v203, v201, s[6:7]
    v_add_u32 v201, 0x100, v201
    s_waitcnt vmcnt(0)
    v_subrev_u32 v202, s70, v202
    v_cmp_gt_u32 vcc, 2, v202
    v_lshlrev_b32 v204, 1, v203
    ds_read_u16 v204, v204 offset:62464
    s_mov_b64 s[76:77], vcc
    v_lshlrev_b32 v202, 4, v202
    v_lshlrev_b32 v203, 9, v203
    s_waitcnt lgkmcnt(0)
    v_lshlrev_b32 v204, v202, v204
L_slow_edge:
    s_cmp_eq_u64 s[76:77], 0
    s_cbranch_scc1 L_slow_next
    s_ff1_i32_b64 s74, s[76:77]
    s_bitset0_b64 s[76:77], s74
    v_readlane_b32 s64, v203, s74
    v_readlane_b32 s65, v204, s74
    v_mov_b32 v205, 0
    v_mov_b32 v11, 2147483648
    s_mov_b64 exec, 0xffff
    v_mov_b32 v205, s65
    v_add_u32 v11, s64, v7
    s_mov_b64 exec, -1
    buffer_load_dwordx4 v[208:211], v11, s[32:35], 0 offen
    buffer_load_dwordx4 v[212:215], v11, s[32:35], 0 offen offset:256
    v_and_b32 v24, v205, v12
    v_and_b32 v25, v205, v13
    s_nop 0
    s_waitcnt vmcnt(0)
    v_smfmac_f32_16x16x32_bf16 v[16:19], v[24:25], v[208:211], v14
    v_smfmac_f32_16x16x32_bf16 v[20:23], v[24:25], v[212:215], v14
    s_branch L_slow_edge
L_slow_next:
    s_add_u32 s71, s71, 1
    s_cmp_lt_u32 s71, 2500
    s_cbranch_scc1 L_slow_chunk
    s_mov_b32 s64, 0
    s_nop 3
    s_branch L_flush
L_sdone:
    ds_write_b32 v10, v6 offset:48
    s_waitcnt lgkmcnt(0)
    s_barrier
    s_endpgm
L_retry_16:
    s_sub_u32 s100, s100, 1
    s_cbranch_scc1 L_end
    s_sleep 1
    s_branch L_spin_15
L_retry_17:
    s_sub_u32 s100, s100, 1
    s_cbranch_scc1 L_end
    s_sleep 4
    s_branch L_ipoll_14
L_retry_23:
    s_sub_u32 s100, s100, 1
    s_cbranch_scc1 L_end
    s_sleep 2
    s_branch L_secload_22
L_secload_22:
    buffer_load_dwordx4 v[56:59], v8, s[40:43], s12 offen sc1
    s_waitcnt vmcnt(0)
    s_branch L_sec_20
L_retry_27:
    s_sub_u32 s100, s100, 1
    s_cbranch_scc1 L_end
    s_sleep 2
    s_branch L_secload_26
L_secload_26:
    buffer_load_dwordx4 v[60:63], v8, s[40:43], s13 offen sc1
    s_waitcnt vmcnt(0)
    s_branch L_sec_24
L_retry_29:
    s_sub_u32 s100, s100, 1
    s_cbranch_scc1 L_end
    s_sleep 1
    s_branch L_spin_28
L_mwork_4:
    v_xor_b32 v44, v4, v3
    v_lshlrev_b32 v44, 4, v44
    v_lshl_add_u32 v44, v3, 9, v44
    v_xor_b32 v45, 64, v44
    v_xor_b32 v46, 0x80, v44
    v_xor_b32 v47, 0xc0, v44
    s_cmp_lg_u32 s31, 0
    s_waitcnt vmcnt(1)
    s_barrier
    s_cbranch_scc1 L_worked_5_w
    ds_read_b128 v[48:51], v44 offset:62464
    ds_read_b128 v[52:55], v44 offset:21504
    ds_read_b128 v[56:59], v44 offset:29696
    ds_read_b128 v[60:63], v45 offset:62464
    ds_read_b128 v[64:67], v45 offset:21504
    ds_read_b128 v[68:71], v45 offset:29696
    ds_read_b128 v[72:75], v46 offset:62464
    ds_read_b128 v[76:79], v46 offset:21504
    ds_read_b128 v[80:83], v46 offset:29696
    ds_read_b128 v[84:87], v47 offset:62464
    ds_read_b128 v[88:91], v47 offset:21504
    ds_read_b128 v[92:95], v47 offset:29696
    s_waitcnt lgkmcnt(9)
    v_mfma_f32_16x16x32_bf16 v[16:19], v[52:55], v[48:51], 0
    v_mfma_f32_16x16x32_bf16 v[20:23], v[56:59], v[48:51], 0
    ds_read_b128 v[96:99], v44 offset:62720
    ds_read_b128 v[100:103], v44 offset:21760
    ds_read_b128 v[104:107], v44 offset:29952
    s_waitcnt lgkmcnt(9)
    v_mfma_f32_16x16x32_bf16 v[16:19], v[64:67], v[60:63], v[16:19]
    v_mfma_f32_16x16x32_bf16 v[20:23], v[68:71], v[60:63], v[20:23]
    ds_read_b128 v[108:111], v45 offset:62720
    ds_read_b128 v[112:115], v45 offset:21760
    ds_read_b128 v[116:119], v45 offset:29952
    s_waitcnt lgkmcnt(9)
    v_mfma_f32_16x16x32_bf16 v[16:19], v[76:79], v[72:75], v[16:19]
    v_mfma_f32_16x16x32_bf16 v[20:23], v[80:83], v[72:75], v[20:23]
    ds_read_b128 v[120:123], v46 offset:62720
    ds_read_b128 v[124:127], v46 offset:21760
    ds_read_b128 v[128:131], v46 offset:29952
    s_waitcnt lgkmcnt(9)
    v_mfma_f32_16x16x32_bf16 v[16:19], v[88:91], v[84:87], v[16:19]
    v_mfma_f32_16x16x32_bf16 v[20:23], v[92:95], v[84:87], v[20:23]
    ds_read_b128 v[132:135], v47 offset:62720
    ds_read_b128 v[136:139], v47 offset:21760
    ds_read_b128 v[140:143], v47 offset:29952
    s_waitcnt lgkmcnt(9)
    v_mfma_f32_16x16x32_bf16 v[16:19], v[100:103], v[96:99], v[16:19]
    v_mfma_f32_16x16x32_bf16 v[20:23], v[104:107], v[96:99], v[20:23]
    s_waitcnt lgkmcnt(6)
    v_mfma_f32_16x16x32_bf16 v[16:19], v[112:115], v[108:111], v[16:19]
    v_mfma_f32_16x16x32_bf16 v[20:23], v[116:119], v[108:111], v[20:23]
    s_waitcnt lgkmcnt(3)
    v_mfma_f32_16x16x32_bf16 v[16:19], v[124:127], v[120:123], v[16:19]
    v_mfma_f32_16x16x32_bf16 v[20:23], v[128:131], v[120:123], v[20:23]
    s_waitcnt lgkmcnt(0)
    v_mfma_f32_16x16x32_bf16 v[16:19], v[136:139], v[132:135], v[16:19]
    v_mfma_f32_16x16x32_bf16 v[20:23], v[140:143], v[132:135], v[20:23]
    s_lshl_b32 s64, s27, 10
    s_add_u32 s64, s64, 65536
    v_lshl_add_u32 v40, v2, 4, s64
    s_lshl_b32 s64, s27, 2
    s_add_u32 s64, s64, 4096
    v_lshl_add_u32 v41, v2, 9, s64
    v_mov_b32 v42, s30
    s_nop 1
    v_cvt_pk_bf16_f32 v44, v16, v17
    v_cvt_pk_bf16_f32 v45, v18, v19
    v_cvt_pk_bf16_f32 v46, v20, v21
    v_cvt_pk_bf16_f32 v47, v22, v23
    global_store_dwordx4 v40, v[44:47], s[28:29] sc1
    s_barrier
    s_mov_b32 s26, 2
    s_waitcnt vmcnt(0)
    s_mov_b64 exec, 0xff
    global_store_dword v41, v42, s[28:29] sc1
    s_mov_b64 exec, -1
    s_branch L_worked_5
L_worked_5_w:
    s_barrier
    s_waitcnt vmcnt(0)
    s_branch L_worked_5
L_gemm:
    v_lshlrev_b32 v8, 4, v0
    v_lshlrev_b32 v10, 2, v0
    v_mov_b32 v12, 1966080
    v_mov_b32 v13, 1966080
    v_mov_b64 v[14:15], v[12:13]
    v_subrev_u32 v9, 32, v0
    v_cmp_gt_u32 vcc, 20, v9
    ds_write_b128 v8, v[12:15] offset:41984
    ds_write_b128 v8, v[12:15] offset:46080
    ds_write_b128 v8, v[12:15] offset:50176
    ds_write_b128 v8, v[12:15] offset:54272
    v_mul_u32_u24 v9, 264, v9
    v_add_u32 v9, 148480, v9
    v_cndmask_b32 v9, 0, v9, vcc
    ds_write_b32 v10, v9
    v_mov_b32 v16, 1310740000
    v_mov_b32 v17, 1310740000
    v_mov_b64 v[18:19], v[16:17]
    v_add_u32 v9, 148480, v8
    ds_write_b128 v9, v[16:19]
    ds_write_b128 v9, v[16:19] offset:4096
    v_and_b32 v3, 15, v2
    v_lshrrev_b32 v4, 4, v2
    v_mov_b32 v5, 0
    v_mov_b32 v6, 1
    s_mov_b32 s100, 67108864
    s_bfe_u32 s65, s2, 0x10003
    s_lshl1_add_u32 s64, s67, s65
    s_and_b32 s65, s2, 0xf0
    s_or_b32 s64, s64, s65
    s_cmp_lt_u32 s2, 240
    s_cselect_b32 s1, s64, s2
    v_lshrrev_b32 v0, 5, v2
    s_lshl_b32 s64, s31, 1
    v_add_u32 v0, s64, v0
    v_and_b32 v1, 31, v2
    v_xor_b32 v1, v1, v0
    v_lshlrev_b32 v1, 4, v1
    v_lshl_add_u32 v30, v0, 9, v1
    v_xor_b32 v31, 0x80, v30
    v_lshrrev_b32 v13, 3, v2
    v_lshrrev_b32 v15, 2, v2
    v_and_b32 v15, 4, v15
    v_and_b32 v14, 7, v2
    v_xor_b32 v15, v15, v14
    v_lshlrev_b32 v15, 4, v15
    v_lshl_add_u32 v13, v13, 9, v15
    s_lshr_b32 s67, s2, 3
    s_and_b32 s67, s67, 7
    s_lshl_b32 s64, s31, 7
    s_lshl_b32 s65, s67, 14
    s_or_b32 s64, s64, s65
    v_add_u32 v13, s64, v13
    s_mul_i32 s63, s1, 20480
    s_lshl_b32 s66, s31, 10
    s_lshl_b32 s70, s31, 14
    s_add_u32 s70, s70, 82944
    s_mov_b32 s71, 3072
    s_mov_b32 s72, 6144
    s_mov_b32 s73, 9216
    s_waitcnt lgkmcnt(0)
    s_mov_b32 s32, s4
    s_and_b32 s33, s5, 0xffff
    s_mov_b32 s34, 5120000
    s_mov_b32 s35, 0x20000
    s_mov_b32 s36, s22
    s_and_b32 s37, s23, 0xffff
    s_mov_b32 s38, 131072
    s_mov_b32 s39, 0x20000
    s_and_b32 s64, s2, 8
    s_or_b32 s64, s64, s31
    s_cbranch_scc1 L_touched_30
    s_lshr_b32 s64, s2, 4
    s_lshl_b32 s64, s64, 3
    s_and_b32 s68, s2, 7
    s_or_b32 s64, s64, s68
    s_lshl_b32 s64, s64, 10
    v_lshl_add_u32 v16, v2, 4, s64
    global_load_dwordx4 v[20:23], v16, s[16:17]
L_touched_30:
    s_cmp_ge_u32 s2, 250
    s_cbranch_scc1 L_end
    s_mul_i32 s64, s1, 20480
    s_mov_b32 s76, 0
    s_cmp_eq_u32 s31, 0
    s_cselect_b64 s[68:69], s[24:25], s[16:17]
    s_cselect_b32 s64, s64, 0
    s_cmp_eq_u32 s31, 2
    s_cselect_b64 s[68:69], s[28:29], s[68:69]
    s_cselect_b32 s64, 0x800, s64
    s_cselect_b32 s76, 0x2f8000, s76
    s_cmp_eq_u32 s31, 3
    s_cselect_b64 s[68:69], s[4:5], s[68:69]
    s_cselect_b32 s76, 0x200000, s76
    s_cselect_b32 s77, 2, 1
    v_min_u32 v17, s77, v2
    v_mul_lo_u32 v17, v17, s76
    v_add_u32 v17, s64, v17
    global_load_dword v24, v17, s[68:69]
    s_barrier
    s_setprio 2
    s_add_u32 m0, s66, 1024
    s_nop 0
    buffer_load_dwordx4 v30, s[32:35], s63 offen lds
    s_add_u32 m0, s66, 5120
    s_add_u32 s63, s63, 4096
    buffer_load_dwordx4 v31, s[32:35], s63 offen lds
    s_add_u32 m0, s70, 0
    s_nop 0
    buffer_load_dwordx4 v13, s[36:39], 0 offen offset:0 lds
    buffer_load_dwordx4 v13, s[36:39], s71 offen offset:1024 lds
    buffer_load_dwordx4 v13, s[36:39], s72 offen offset:2048 lds
    buffer_load_dwordx4 v13, s[36:39], s73 offen offset:3072 lds
    v_xor_b32 v13, 16384, v13
    s_mov_b32 s40, s16
    s_and_b32 s41, s17, 0xffff
    s_mov_b32 s42, 131072
    s_mov_b32 s43, 0x20000
    s_mov_b32 s44, s28
    s_and_b32 s45, s29, 0xffff
    s_mov_b32 s46, 1048576
    s_mov_b32 s47, 0x20000
    s_mov_b32 s48, s24
    s_and_b32 s49, s25, 0xffff
    s_mov_b32 s50, 5120000
    s_mov_b32 s51, 0x20000
    v_xor_b32 v15, v4, v3
    v_lshlrev_b32 v15, 4, v15
    v_lshl_add_u32 v7, v3, 9, v15
    s_lshl_b32 s64, s67, 6
    v_xor_b32 v7, s64, v7
    v_xor_b32 v8, 64, v7
    v_xor_b32 v9, 0x80, v7
    v_xor_b32 v10, 0xc0, v7
    v_lshrrev_b32 v15, 2, v3
    v_lshl_add_u32 v15, v4, 3, v15
    v_lshlrev_b32 v15, 7, v15
    v_lshrrev_b32 v14, 1, v3
    v_and_b32 v14, 4, v14
    v_and_b32 v0, 3, v3
    v_xor_b32 v14, v14, v0
    v_lshl_add_u32 v15, v14, 4, v15
    v_add_u32 v11, s70, v15
    v_xor_b32 v12, 64, v11
    v_and_b32 v0, 31, v2
    v_lshlrev_b32 v0, 2, v0
    s_and_b32 s64, s2, 7
    s_lshl_b32 s64, s64, 9
    s_lshl_b32 s65, s31, 7
    s_add_u32 s64, s64, s65
    s_add_u32 s74, s64, 4096
    v_lshlrev_b32 v14, 4, v2
    s_lshl_b32 s75, s31, 15
    s_lshl_b32 s64, s67, 12
    s_or_b32 s75, s75, s64
    s_add_u32 s75, s75, 65536
    s_add_u32 m0, s66, 9216
    s_add_u32 s63, s63, 4096
    buffer_load_dwordx4 v30, s[32:35], s63 offen lds
    s_add_u32 m0, s66, 13312
    s_add_u32 s63, s63, 4096
    buffer_load_dwordx4 v31, s[32:35], s63 offen lds
    s_add_u32 m0, s66, 17408
    s_add_u32 s63, s63, 4096
    buffer_load_dwordx4 v30, s[32:35], s63 offen lds
    s_barrier
    s_cmp_eq_u32 s31, 0
    s_cbranch_scc0 L_nw_32
    s_call_b64 s[68:69], L_pad0
    s_call_b64 s[68:69], L_pad1
    s_call_b64 s[68:69], L_pad8
    s_branch L_warmed_31
L_nw_32:
    s_cmp_eq_u32 s31, 1
    s_cbranch_scc0 L_nw_33
    s_call_b64 s[68:69], L_pad2
    s_call_b64 s[68:69], L_pad3
    s_call_b64 s[68:69], L_pad9
    s_branch L_warmed_31
L_nw_33:
    s_cmp_eq_u32 s31, 2
    s_cbranch_scc0 L_nw_34
    s_call_b64 s[68:69], L_pad4
    s_call_b64 s[68:69], L_pad5
    s_branch L_warmed_31
L_nw_34:
    s_call_b64 s[68:69], L_pad6
    s_call_b64 s[68:69], L_pad7
L_warmed_31:
    s_add_u32 m0, s70, 4096
    s_waitcnt vmcnt(9)
    buffer_load_dwordx4 v13, s[36:39], 0 offen offset:0 lds
    s_waitcnt vmcnt(9)
    buffer_load_dwordx4 v13, s[36:39], s71 offen offset:1024 lds
    s_waitcnt vmcnt(9)
    buffer_load_dwordx4 v13, s[36:39], s72 offen offset:2048 lds
    s_waitcnt vmcnt(9)
    buffer_load_dwordx4 v13, s[36:39], s73 offen offset:3072 lds
    v_xor_b32 v13, 49152, v13
    s_bitcmp1_b32 s2, 3
    s_cbranch_scc1 L_nobar_36
    s_barrier
L_nobar_36:
    s_add_u32 m0, s70, 8192
    s_waitcnt vmcnt(4)
    buffer_load_dwordx4 v13, s[36:39], 0 offen offset:0 lds
    s_waitcnt vmcnt(4)
    buffer_load_dwordx4 v13, s[36:39], s71 offen offset:1024 lds
    s_waitcnt vmcnt(4)
    buffer_load_dwordx4 v13, s[36:39], s72 offen offset:2048 lds
    s_waitcnt vmcnt(4)
    buffer_load_dwordx4 v13, s[36:39], s73 offen offset:3072 lds
    v_xor_b32 v13, 16384, v13
    s_add_u32 m0, s70, 12288
    s_waitcnt vmcnt(4)
    buffer_load_dwordx4 v13, s[36:39], 0 offen offset:0 lds
    s_waitcnt vmcnt(4)
    buffer_load_dwordx4 v13, s[36:39], s71 offen offset:1024 lds
    s_waitcnt vmcnt(4)
    buffer_load_dwordx4 v13, s[36:39], s72 offen offset:2048 lds
    s_waitcnt vmcnt(4)
    buffer_load_dwordx4 v13, s[36:39], s73 offen offset:3072 lds
    v_xor_b32 v13, 114688, v13
    s_waitcnt vmcnt(12)
    ds_read_b64_tr_b16 v[128:129], v11 offset:0
    ds_read_b64_tr_b16 v[130:131], v11 offset:512
    ds_read_b64_tr_b16 v[132:133], v11 offset:8
    ds_read_b64_tr_b16 v[134:135], v11 offset:520
    ds_read_b64_tr_b16 v[136:137], v12 offset:0
    ds_read_b64_tr_b16 v[138:139], v12 offset:512
    ds_read_b64_tr_b16 v[140:141], v12 offset:8
    ds_read_b64_tr_b16 v[142:143], v12 offset:520
    s_waitcnt lgkmcnt(0)
    s_add_u32 m0, s70, 0
    s_waitcnt vmcnt(4)
    buffer_load_dwordx4 v13, s[36:39], 0 offen offset:0 lds
    s_waitcnt vmcnt(4)
    buffer_load_dwordx4 v13, s[36:39], s71 offen offset:1024 lds
    s_waitcnt vmcnt(4)
    buffer_load_dwordx4 v13, s[36:39], s72 offen offset:2048 lds
    s_waitcnt vmcnt(4)
    buffer_load_dwordx4 v13, s[36:39], s73 offen offset:3072 lds
    v_xor_b32 v13, 16384, v13
    s_waitcnt vmcnt(12)
    s_waitcnt lgkmcnt(0)
    s_mov_b64 exec, 1
    ds_add_u32 v5, v6 offset:4
    s_mov_b64 exec, -1
    ds_read_b64_tr_b16 v[144:145], v11 offset:4096
    ds_read_b64_tr_b16 v[146:147], v11 offset:4608
    ds_read_b64_tr_b16 v[148:149], v11 offset:4104
    ds_read_b64_tr_b16 v[150:151], v11 offset:4616
    ds_read_b64_tr_b16 v[152:153], v12 offset:4096
    ds_read_b64_tr_b16 v[154:155], v12 offset:4608
    ds_read_b64_tr_b16 v[156:157], v12 offset:4104
    ds_read_b64_tr_b16 v[158:159], v12 offset:4616
    s_waitcnt lgkmcnt(0)
    s_add_u32 m0, s70, 4096
    s_waitcnt vmcnt(4)
    buffer_load_dwordx4 v13, s[36:39], 0 offen offset:0 lds
    s_waitcnt vmcnt(4)
    buffer_load_dwordx4 v13, s[36:39], s71 offen offset:1024 lds
    s_waitcnt vmcnt(4)
    buffer_load_dwordx4 v13, s[36:39], s72 offen offset:2048 lds
    s_waitcnt vmcnt(4)
    buffer_load_dwordx4 v13, s[36:39], s73 offen offset:3072 lds
    v_xor_b32 v13, 49152, v13
    s_waitcnt vmcnt(12)
    ds_read_b64_tr_b16 v[160:161], v11 offset:8192
    ds_read_b64_tr_b16 v[162:163], v11 offset:8704
    ds_read_b64_tr_b16 v[164:165], v11 offset:8200
    ds_read_b64_tr_b16 v[166:167], v11 offset:8712
    ds_read_b64_tr_b16 v[168:169], v12 offset:8192
    ds_read_b64_tr_b16 v[170:171], v12 offset:8704
    ds_read_b64_tr_b16 v[172:173], v12 offset:8200
    ds_read_b64_tr_b16 v[174:175], v12 offset:8712
    s_waitcnt lgkmcnt(0)
    s_add_u32 m0, s70, 8192
    s_waitcnt vmcnt(4)
    buffer_load_dwordx4 v13, s[36:39], 0 offen offset:0 lds
    s_waitcnt vmcnt(4)
    buffer_load_dwordx4 v13, s[36:39], s71 offen offset:1024 lds
    s_waitcnt vmcnt(4)
    buffer_load_dwordx4 v13, s[36:39], s72 offen offset:2048 lds
    s_waitcnt vmcnt(4)
    buffer_load_dwordx4 v13, s[36:39], s73 offen offset:3072 lds
    v_xor_b32 v13, 16384, v13
    buffer_load_dword v1, v0, s[44:47], s74 offen sc1
    s_waitcnt vmcnt(13)
    ds_read_b64_tr_b16 v[176:177], v11 offset:12288
    ds_read_b64_tr_b16 v[178:179], v11 offset:12800
    ds_read_b64_tr_b16 v[180:181], v11 offset:12296
    ds_read_b64_tr_b16 v[182:183], v11 offset:12808
    ds_read_b64_tr_b16 v[184:185], v12 offset:12288
    ds_read_b64_tr_b16 v[186:187], v12 offset:12800
    ds_read_b64_tr_b16 v[188:189], v12 offset:12296
    ds_read_b64_tr_b16 v[190:191], v12 offset:12808
    s_waitcnt lgkmcnt(0)
    s_add_u32 m0, s70, 12288
    s_nop 0
    buffer_load_dwordx4 v13, s[36:39], 0 offen offset:0 lds
    buffer_load_dwordx4 v13, s[36:39], s71 offen offset:1024 lds
    buffer_load_dwordx4 v13, s[36:39], s72 offen offset:2048 lds
    buffer_load_dwordx4 v13, s[36:39], s73 offen offset:3072 lds
    v_xor_b32 v13, 114688, v13
    s_waitcnt vmcnt(13)
    ds_read_b64_tr_b16 v[192:193], v11 offset:0
    ds_read_b64_tr_b16 v[194:195], v11 offset:512
    ds_read_b64_tr_b16 v[196:197], v11 offset:8
    ds_read_b64_tr_b16 v[198:199], v11 offset:520
    ds_read_b64_tr_b16 v[200:201], v12 offset:0
    ds_read_b64_tr_b16 v[202:203], v12 offset:512
    ds_read_b64_tr_b16 v[204:205], v12 offset:8
    ds_read_b64_tr_b16 v[206:207], v12 offset:520
    s_waitcnt vmcnt(9)
    ds_read_b64_tr_b16 v[208:209], v11 offset:4096
    ds_read_b64_tr_b16 v[210:211], v11 offset:4608
    ds_read_b64_tr_b16 v[212:213], v11 offset:4104
    ds_read_b64_tr_b16 v[214:215], v11 offset:4616
    ds_read_b64_tr_b16 v[216:217], v12 offset:4096
    ds_read_b64_tr_b16 v[218:219], v12 offset:4608
    ds_read_b64_tr_b16 v[220:221], v12 offset:4104
    ds_read_b64_tr_b16 v[222:223], v12 offset:4616
    s_waitcnt vmcnt(5)
    ds_read_b64_tr_b16 v[224:225], v11 offset:8192
    ds_read_b64_tr_b16 v[226:227], v11 offset:8704
    ds_read_b64_tr_b16 v[228:229], v11 offset:8200
    ds_read_b64_tr_b16 v[230:231], v11 offset:8712
    ds_read_b64_tr_b16 v[232:233], v12 offset:8192
    ds_read_b64_tr_b16 v[234:235], v12 offset:8704
    ds_read_b64_tr_b16 v[236:237], v12 offset:8200
    ds_read_b64_tr_b16 v[238:239], v12 offset:8712
    s_waitcnt vmcnt(4)
L_spin_38:
    ds_read_b128 v[16:19], v5
    s_waitcnt lgkmcnt(0)
    v_readfirstlane_b32 s101, v18
    v_readfirstlane_b32 s30, v19
    s_cmp_ge_u32 s101, 1
    s_cbranch_scc0 L_retry_39
L_mchk_37:
    v_cmp_ne_u32 vcc, s30, v1
    s_cbranch_vccnz L_mre_40
    buffer_load_dwordx4 v[40:43], v14, s[44:47], s75 offen offset:0 sc1
    buffer_load_dwordx4 v[44:47], v14, s[44:47], s75 offen offset:1024 sc1
    buffer_load_dwordx4 v[48:51], v14, s[44:47], s75 offen offset:2048 sc1
    buffer_load_dwordx4 v[52:55], v14, s[44:47], s75 offen offset:3072 sc1
    s_xor_b32 s75, s75, 4096
    buffer_load_dwordx4 v[56:59], v14, s[44:47], s75 offen offset:0 sc1
    buffer_load_dwordx4 v[60:63], v14, s[44:47], s75 offen offset:1024 sc1
    buffer_load_dwordx4 v[64:67], v14, s[44:47], s75 offen offset:2048 sc1
    buffer_load_dwordx4 v[68:71], v14, s[44:47], s75 offen offset:3072 sc1
    s_xor_b32 s75, s75, 12288
    buffer_load_dwordx4 v[72:75], v14, s[44:47], s75 offen offset:0 sc1
    buffer_load_dwordx4 v[76:79], v14, s[44:47], s75 offen offset:1024 sc1
    s_waitcnt vmcnt(10)
    ds_read_b64_tr_b16 v[240:241], v11 offset:12288
    ds_read_b64_tr_b16 v[242:243], v11 offset:12800
    ds_read_b64_tr_b16 v[244:245], v11 offset:12296
    ds_read_b64_tr_b16 v[246:247], v11 offset:12808
    ds_read_b64_tr_b16 v[248:249], v12 offset:12288
    ds_read_b64_tr_b16 v[250:251], v12 offset:12800
    ds_read_b64_tr_b16 v[252:253], v12 offset:12296
    ds_read_b64_tr_b16 v[254:255], v12 offset:12808
L_spin_41:
    ds_read_b32 v15, v5 offset:4
    s_waitcnt lgkmcnt(0)
    v_readfirstlane_b32 s101, v15
    s_cmp_ge_u32 s101, 4
    s_cbranch_scc0 L_retry_42
    ds_read_b128 v[16:19], v7 offset:1024
    ds_read_b128 v[20:23], v7 offset:9216
    ds_read_b128 v[24:27], v7 offset:17408
    v_xor_b32 v7, 0x100, v7
    ds_read_b128 v[28:31], v8 offset:1024
    ds_read_b128 v[32:35], v8 offset:9216
    ds_read_b128 v[36:39], v8 offset:17408
    v_xor_b32 v8, 0x100, v8
    s_waitcnt lgkmcnt(3)
    s_waitcnt vmcnt(9)
    v_mfma_f32_16x16x32_bf16 v[80:83], v[40:43], v[16:19], 0
    v_mfma_f32_16x16x32_bf16 v[96:99], v[40:43], v[20:23], 0
    v_mfma_f32_16x16x32_bf16 v[112:115], v[40:43], v[24:27], 0
    buffer_load_dwordx4 v[40:43], v14, s[44:47], s75 offen offset:2048 sc1
    s_waitcnt vmcnt(9)
    v_mfma_f32_16x16x32_bf16 v[84:87], v[44:47], v[16:19], 0
    v_mfma_f32_16x16x32_bf16 v[100:103], v[44:47], v[20:23], 0
    v_mfma_f32_16x16x32_bf16 v[116:119], v[44:47], v[24:27], 0
    buffer_load_dwordx4 v[44:47], v14, s[44:47], s75 offen offset:3072 sc1
    s_xor_b32 s75, s75, 4096
    s_waitcnt vmcnt(9)
    v_mfma_f32_16x16x32_bf16 v[88:91], v[48:51], v[16:19], 0
    v_mfma_f32_16x16x32_bf16 v[104:107], v[48:51], v[20:23], 0
    v_mfma_f32_16x16x32_bf16 v[120:123], v[48:51], v[24:27], 0
    buffer_load_dwordx4 v[48:51], v14, s[44:47], s75 offen offset:0 sc1
    s_waitcnt vmcnt(9)
    v_mfma_f32_16x16x32_bf16 v[92:95], v[52:55], v[16:19], 0
    v_mfma_f32_16x16x32_bf16 v[108:111], v[52:55], v[20:23], 0
    v_mfma_f32_16x16x32_bf16 v[124:127], v[52:55], v[24:27], 0
    buffer_load_dwordx4 v[52:55], v14, s[44:47], s75 offen offset:1024 sc1
    ds_read_b128 v[16:19], v9 offset:1024
    ds_read_b128 v[20:23], v9 offset:9216
    ds_read_b128 v[24:27], v9 offset:17408
    v_xor_b32 v9, 0x100, v9
    s_waitcnt lgkmcnt(3)
    s_waitcnt vmcnt(9)
    v_mfma_f32_16x16x32_bf16 v[80:83], v[56:59], v[28:31], v[80:83]
    v_mfma_f32_16x16x32_bf16 v[96:99], v[56:59], v[32:35], v[96:99]
    v_mfma_f32_16x16x32_bf16 v[112:115], v[56:59], v[36:39], v[112:115]
    buffer_load_dwordx4 v[56:59], v14, s[44:47], s75 offen offset:2048 sc1
    s_waitcnt vmcnt(9)
    v_mfma_f32_16x16x32_bf16 v[84:87], v[60:63], v[28:31], v[84:87]
    v_mfma_f32_16x16x32_bf16 v[100:103], v[60:63], v[32:35], v[100:103]
    v_mfma_f32_16x16x32_bf16 v[116:119], v[60:63], v[36:39], v[116:119]
    buffer_load_dwordx4 v[60:63], v14, s[44:47], s75 offen offset:3072 sc1
    s_xor_b32 s75, s75, 28672
    s_waitcnt vmcnt(9)
    v_mfma_f32_16x16x32_bf16 v[88:91], v[64:67], v[28:31], v[88:91]
    v_mfma_f32_16x16x32_bf16 v[104:107], v[64:67], v[32:35], v[104:107]
    v_mfma_f32_16x16x32_bf16 v[120:123], v[64:67], v[36:39], v[120:123]
    buffer_load_dwordx4 v[64:67], v14, s[44:47], s75 offen offset:0 sc1
    s_waitcnt vmcnt(9)
    v_mfma_f32_16x16x32_bf16 v[92:95], v[68:71], v[28:31], v[92:95]
    v_mfma_f32_16x16x32_bf16 v[108:111], v[68:71], v[32:35], v[108:111]
    v_mfma_f32_16x16x32_bf16 v[124:127], v[68:71], v[36:39], v[124:127]
    buffer_load_dwordx4 v[68:71], v14, s[44:47], s75 offen offset:1024 sc1
    ds_read_b128 v[28:31], v10 offset:1024
    ds_read_b128 v[32:35], v10 offset:9216
    ds_read_b128 v[36:39], v10 offset:17408
    v_xor_b32 v10, 0x100, v10
    s_waitcnt lgkmcnt(3)
    s_waitcnt vmcnt(9)
    v_mfma_f32_16x16x32_bf16 v[80:83], v[72:75], v[16:19], v[80:83]
    v_mfma_f32_16x16x32_bf16 v[96:99], v[72:75], v[20:23], v[96:99]
    v_mfma_f32_16x16x32_bf16 v[112:115], v[72:75], v[24:27], v[112:115]
    buffer_load_dwordx4 v[72:75], v14, s[44:47], s75 offen offset:2048 sc1
    s_waitcnt vmcnt(9)
    v_mfma_f32_16x16x32_bf16 v[84:87], v[76:79], v[16:19], v[84:87]
    v_mfma_f32_16x16x32_bf16 v[100:103], v[76:79], v[20:23], v[100:103]
    v_mfma_f32_16x16x32_bf16 v[116:119], v[76:79], v[24:27], v[116:119]
    buffer_load_dwordx4 v[76:79], v14, s[44:47], s75 offen offset:3072 sc1
    s_xor_b32 s75, s75, 4096
    s_waitcnt vmcnt(9)
    v_mfma_f32_16x16x32_bf16 v[88:91], v[40:43], v[16:19], v[88:91]
    v_mfma_f32_16x16x32_bf16 v[104:107], v[40:43], v[20:23], v[104:107]
    v_mfma_f32_16x16x32_bf16 v[120:123], v[40:43], v[24:27], v[120:123]
    buffer_load_dwordx4 v[40:43], v14, s[44:47], s75 offen offset:0 sc1
    s_waitcnt vmcnt(9)
    v_mfma_f32_16x16x32_bf16 v[92:95], v[44:47], v[16:19], v[92:95]
    v_mfma_f32_16x16x32_bf16 v[108:111], v[44:47], v[20:23], v[108:111]
    v_mfma_f32_16x16x32_bf16 v[124:127], v[44:47], v[24:27], v[124:127]
    buffer_load_dwordx4 v[44:47], v14, s[44:47], s75 offen offset:1024 sc1
    ds_read_b128 v[16:19], v7 offset:1024
    ds_read_b128 v[20:23], v7 offset:9216
    ds_read_b128 v[24:27], v7 offset:17408
    v_xor_b32 v7, 0x100, v7
    s_waitcnt lgkmcnt(3)
    s_waitcnt vmcnt(9)
    v_mfma_f32_16x16x32_bf16 v[80:83], v[48:51], v[28:31], v[80:83]
    v_mfma_f32_16x16x32_bf16 v[96:99], v[48:51], v[32:35], v[96:99]
    v_mfma_f32_16x16x32_bf16 v[112:115], v[48:51], v[36:39], v[112:115]
    buffer_load_dwordx4 v[48:51], v14, s[44:47], s75 offen offset:2048 sc1
    s_waitcnt vmcnt(9)
    v_mfma_f32_16x16x32_bf16 v[84:87], v[52:55], v[28:31], v[84:87]
    v_mfma_f32_16x16x32_bf16 v[100:103], v[52:55], v[32:35], v[100:103]
    v_mfma_f32_16x16x32_bf16 v[116:119], v[52:55], v[36:39], v[116:119]
    buffer_load_dwordx4 v[52:55], v14, s[44:47], s75 offen offset:3072 sc1
    s_xor_b32 s75, s75, 12288
    s_waitcnt vmcnt(9)
    v_mfma_f32_16x16x32_bf16 v[88:91], v[56:59], v[28:31], v[88:91]
    v_mfma_f32_16x16x32_bf16 v[104:107], v[56:59], v[32:35], v[104:107]
    v_mfma_f32_16x16x32_bf16 v[120:123], v[56:59], v[36:39], v[120:123]
    buffer_load_dwordx4 v[56:59], v14, s[44:47], s75 offen offset:0 sc1
    s_waitcnt vmcnt(9)
    v_mfma_f32_16x16x32_bf16 v[92:95], v[60:63], v[28:31], v[92:95]
    v_mfma_f32_16x16x32_bf16 v[108:111], v[60:63], v[32:35], v[108:111]
    v_mfma_f32_16x16x32_bf16 v[124:127], v[60:63], v[36:39], v[124:127]
    buffer_load_dwordx4 v[60:63], v14, s[44:47], s75 offen offset:1024 sc1
    ds_read_b128 v[28:31], v8 offset:1024
    ds_read_b128 v[32:35], v8 offset:9216
    ds_read_b128 v[36:39], v8 offset:17408
    v_xor_b32 v8, 0x100, v8
    s_waitcnt lgkmcnt(3)
    s_waitcnt vmcnt(9)
    v_mfma_f32_16x16x32_bf16 v[80:83], v[64:67], v[16:19], v[80:83]
    v_mfma_f32_16x16x32_bf16 v[96:99], v[64:67], v[20:23], v[96:99]
    v_mfma_f32_16x16x32_bf16 v[112:115], v[64:67], v[24:27], v[112:115]
    buffer_load_dwordx4 v[64:67], v14, s[44:47], s75 offen offset:2048 sc1
    s_waitcnt vmcnt(9)
    v_mfma_f32_16x16x32_bf16 v[84:87], v[68:71], v[16:19], v[84:87]
    v_mfma_f32_16x16x32_bf16 v[100:103], v[68:71], v[20:23], v[100:103]
    v_mfma_f32_16x16x32_bf16 v[116:119], v[68:71], v[24:27], v[116:119]
    buffer_load_dwordx4 v[68:71], v14, s[44:47], s75 offen offset:3072 sc1
    s_xor_b32 s75, s75, 4096
    s_waitcnt vmcnt(9)
    v_mfma_f32_16x16x32_bf16 v[88:91], v[72:75], v[16:19], v[88:91]
    v_mfma_f32_16x16x32_bf16 v[104:107], v[72:75], v[20:23], v[104:107]
    v_mfma_f32_16x16x32_bf16 v[120:123], v[72:75], v[24:27], v[120:123]
    buffer_load_dwordx4 v[72:75], v14, s[44:47], s75 offen offset:0 sc1
    s_waitcnt vmcnt(9)
    v_mfma_f32_16x16x32_bf16 v[92:95], v[76:79], v[16:19], v[92:95]
    v_mfma_f32_16x16x32_bf16 v[108:111], v[76:79], v[20:23], v[108:111]
    v_mfma_f32_16x16x32_bf16 v[124:127], v[76:79], v[24:27], v[124:127]
    buffer_load_dwordx4 v[76:79], v14, s[44:47], s75 offen offset:1024 sc1
    ds_read_b128 v[16:19], v9 offset:1024
    ds_read_b128 v[20:23], v9 offset:9216
    ds_read_b128 v[24:27], v9 offset:17408
    v_xor_b32 v9, 0x100, v9
    s_waitcnt lgkmcnt(3)
    s_waitcnt vmcnt(9)
    v_mfma_f32_16x16x32_bf16 v[80:83], v[40:43], v[28:31], v[80:83]
    v_mfma_f32_16x16x32_bf16 v[96:99], v[40:43], v[32:35], v[96:99]
    v_mfma_f32_16x16x32_bf16 v[112:115], v[40:43], v[36:39], v[112:115]
    buffer_load_dwordx4 v[40:43], v14, s[44:47], s75 offen offset:2048 sc1
    s_waitcnt vmcnt(9)
    v_mfma_f32_16x16x32_bf16 v[84:87], v[44:47], v[28:31], v[84:87]
    v_mfma_f32_16x16x32_bf16 v[100:103], v[44:47], v[32:35], v[100:103]
    v_mfma_f32_16x16x32_bf16 v[116:119], v[44:47], v[36:39], v[116:119]
    buffer_load_dwordx4 v[44:47], v14, s[44:47], s75 offen offset:3072 sc1
    s_xor_b32 s75, s75, 28672
    s_waitcnt vmcnt(9)
    v_mfma_f32_16x16x32_bf16 v[88:91], v[48:51], v[28:31], v[88:91]
    v_mfma_f32_16x16x32_bf16 v[104:107], v[48:51], v[32:35], v[104:107]
    v_mfma_f32_16x16x32_bf16 v[120:123], v[48:51], v[36:39], v[120:123]
    s_add_u32 m0, s70, 0
    s_nop 0
    buffer_load_dwordx4 v13, s[40:43], 0 offen offset:0 lds
    s_waitcnt vmcnt(9)
    v_mfma_f32_16x16x32_bf16 v[92:95], v[52:55], v[28:31], v[92:95]
    v_mfma_f32_16x16x32_bf16 v[108:111], v[52:55], v[32:35], v[108:111]
    v_mfma_f32_16x16x32_bf16 v[124:127], v[52:55], v[36:39], v[124:127]
    buffer_load_dwordx4 v13, s[40:43], s71 offen offset:1024 lds
    ds_read_b128 v[28:31], v10 offset:1024
    ds_read_b128 v[32:35], v10 offset:9216
    ds_read_b128 v[36:39], v10 offset:17408
    v_xor_b32 v10, 0x100, v10
    s_waitcnt lgkmcnt(3)
    s_waitcnt vmcnt(9)
    v_mfma_f32_16x16x32_bf16 v[80:83], v[56:59], v[16:19], v[80:83]
    v_mfma_f32_16x16x32_bf16 v[96:99], v[56:59], v[20:23], v[96:99]
    v_mfma_f32_16x16x32_bf16 v[112:115], v[56:59], v[24:27], v[112:115]
    buffer_load_dwordx4 v13, s[40:43], s72 offen offset:2048 lds
    s_waitcnt vmcnt(9)
    v_mfma_f32_16x16x32_bf16 v[84:87], v[60:63], v[16:19], v[84:87]
    v_mfma_f32_16x16x32_bf16 v[100:103], v[60:63], v[20:23], v[100:103]
    v_mfma_f32_16x16x32_bf16 v[116:119], v[60:63], v[24:27], v[116:119]
    buffer_load_dwordx4 v13, s[40:43], s73 offen offset:3072 lds
    v_xor_b32 v13, 16384, v13
    s_waitcnt vmcnt(9)
    v_mfma_f32_16x16x32_bf16 v[88:91], v[64:67], v[16:19], v[88:91]
    v_mfma_f32_16x16x32_bf16 v[104:107], v[64:67], v[20:23], v[104:107]
    v_mfma_f32_16x16x32_bf16 v[120:123], v[64:67], v[24:27], v[120:123]
    s_add_u32 m0, s70, 4096
    s_nop 0
    buffer_load_dwordx4 v13, s[40:43], 0 offen offset:0 lds
    s_waitcnt vmcnt(9)
    v_mfma_f32_16x16x32_bf16 v[92:95], v[68:71], v[16:19], v[92:95]
    v_mfma_f32_16x16x32_bf16 v[108:111], v[68:71], v[20:23], v[108:111]
    v_mfma_f32_16x16x32_bf16 v[124:127], v[68:71], v[24:27], v[124:127]
    buffer_load_dwordx4 v13, s[40:43], s71 offen offset:1024 lds
    s_waitcnt lgkmcnt(0)
    s_waitcnt vmcnt(9)
    v_mfma_f32_16x16x32_bf16 v[80:83], v[72:75], v[28:31], v[80:83]
    v_mfma_f32_16x16x32_bf16 v[96:99], v[72:75], v[32:35], v[96:99]
    v_mfma_f32_16x16x32_bf16 v[112:115], v[72:75], v[36:39], v[112:115]
    buffer_load_dwordx4 v13, s[40:43], s72 offen offset:2048 lds
    s_waitcnt vmcnt(9)
    v_mfma_f32_16x16x32_bf16 v[84:87], v[76:79], v[28:31], v[84:87]
    v_mfma_f32_16x16x32_bf16 v[100:103], v[76:79], v[32:35], v[100:103]
    v_mfma_f32_16x16x32_bf16 v[116:119], v[76:79], v[36:39], v[116:119]
    buffer_load_dwordx4 v13, s[40:43], s73 offen offset:3072 lds
    v_xor_b32 v13, 49152, v13
    s_waitcnt vmcnt(9)
    v_mfma_f32_16x16x32_bf16 v[88:91], v[40:43], v[28:31], v[88:91]
    v_mfma_f32_16x16x32_bf16 v[104:107], v[40:43], v[32:35], v[104:107]
    v_mfma_f32_16x16x32_bf16 v[120:123], v[40:43], v[36:39], v[120:123]
    s_add_u32 m0, s70, 8192
    s_nop 0
    buffer_load_dwordx4 v13, s[40:43], 0 offen offset:0 lds
    s_waitcnt vmcnt(9)
    v_mfma_f32_16x16x32_bf16 v[92:95], v[44:47], v[28:31], v[92:95]
    v_mfma_f32_16x16x32_bf16 v[108:111], v[44:47], v[32:35], v[108:111]
    v_mfma_f32_16x16x32_bf16 v[124:127], v[44:47], v[36:39], v[124:127]
    buffer_load_dwordx4 v13, s[40:43], s71 offen offset:1024 lds
    s_lshl_b32 s64, s31, 3
    v_add_u32 v0, s64, v4
    v_xor_b32 v0, v0, v3
    v_lshlrev_b32 v0, 4, v0
    v_lshl_add_u32 v0, v3, 9, v0
    v_xor_b32 v1, 64, v0
    s_mov_b32 s76, 0x00ff00ff
    s_mov_b32 s77, 0x00ff00ff
    v_cvt_pk_bf16_f32 v16, v80, v81
    v_cvt_pk_bf16_f32 v17, v82, v83
    v_cvt_pk_bf16_f32 v18, v84, v85
    v_cvt_pk_bf16_f32 v19, v86, v87
    ds_write_b128 v0, v[16:19] offset:21504
    v_cvt_pk_bf16_f32 v20, v88, v89
    v_cvt_pk_bf16_f32 v21, v90, v91
    v_cvt_pk_bf16_f32 v22, v92, v93
    v_cvt_pk_bf16_f32 v23, v94, v95
    ds_write_b128 v1, v[20:23] offset:21504
    v_cvt_pk_bf16_f32 v24, v96, v97
    v_cvt_pk_bf16_f32 v25, v98, v99
    v_cvt_pk_bf16_f32 v26, v100, v101
    v_cvt_pk_bf16_f32 v27, v102, v103
    ds_write_b128 v0, v[24:27] offset:29696
    v_cvt_pk_bf16_f32 v28, v104, v105
    v_cvt_pk_bf16_f32 v29, v106, v107
    v_cvt_pk_bf16_f32 v30, v108, v109
    v_cvt_pk_bf16_f32 v31, v110, v111
    ds_write_b128 v1, v[28:31] offset:29696
    s_mov_b64 exec, s[76:77]
    v_cvt_pk_bf16_f32 v32, v112, v113
    v_cvt_pk_bf16_f32 v33, v114, v115
    v_cvt_pk_bf16_f32 v34, v116, v117
    v_cvt_pk_bf16_f32 v35, v118, v119
    ds_write_b128 v0, v[32:35] offset:37888
    v_cvt_pk_bf16_f32 v36, v120, v121
    v_cvt_pk_bf16_f32 v37, v122, v123
    v_cvt_pk_bf16_f32 v38, v124, v125
    v_cvt_pk_bf16_f32 v39, v126, v127
    ds_write_b128 v1, v[36:39] offset:37888
    s_mov_b64 exec, -1
    s_waitcnt lgkmcnt(0)
    s_barrier
    buffer_load_dwordx4 v13, s[40:43], s72 offen offset:2048 lds
    buffer_load_dwordx4 v13, s[40:43], s73 offen offset:3072 lds
    v_xor_b32 v13, 16384, v13
    s_add_u32 m0, s70, 12288
    s_nop 0
    buffer_load_dwordx4 v13, s[40:43], 0 offen offset:0 lds
    buffer_load_dwordx4 v13, s[40:43], s71 offen offset:1024 lds
    buffer_load_dwordx4 v13, s[40:43], s72 offen offset:2048 lds
    buffer_load_dwordx4 v13, s[40:43], s73 offen offset:3072 lds
    v_xor_b32 v13, 114688, v13
    v_lshlrev_b32 v0, 4, v4
    v_and_b32 v1, 7, v3
    v_lshl_add_u32 v0, v1, 9, v0
    v_and_b32 v1, 8, v3
    v_lshl_add_u32 v0, v1, 3, v0
    s_mul_i32 s74, s1, 20480
    s_lshl_b32 s64, s31, 7
    s_add_u32 s74, s74, s64
    s_waitcnt vmcnt(8)
    ds_read_b64_tr_b16 v[48:49], v11 offset:0
    ds_read_b64_tr_b16 v[50:51], v11 offset:512
    ds_read_b64_tr_b16 v[52:53], v11 offset:8
    ds_read_b64_tr_b16 v[54:55], v11 offset:520
    ds_read_b64_tr_b16 v[56:57], v12 offset:0
    ds_read_b64_tr_b16 v[58:59], v12 offset:512
    ds_read_b64_tr_b16 v[60:61], v12 offset:8
    ds_read_b64_tr_b16 v[62:63], v12 offset:520
    ds_read_b64_tr_b16 v[64:65], v11 offset:4096
    ds_read_b64_tr_b16 v[66:67], v11 offset:4608
    ds_read_b64_tr_b16 v[68:69], v11 offset:4104
    ds_read_b64_tr_b16 v[70:71], v11 offset:4616
    ds_read_b64_tr_b16 v[72:73], v12 offset:4096
    ds_read_b64_tr_b16 v[74:75], v12 offset:4608
    ds_read_b64_tr_b16 v[76:77], v12 offset:4104
    ds_read_b64_tr_b16 v[78:79], v12 offset:4616
    s_waitcnt lgkmcnt(8)
    s_add_u32 m0, s70, 0
    s_nop 0
    buffer_load_dwordx4 v13, s[40:43], 0 offen offset:0 lds
    buffer_load_dwordx4 v13, s[40:43], s71 offen offset:1024 lds
    buffer_load_dwordx4 v13, s[40:43], s72 offen offset:2048 lds
    buffer_load_dwordx4 v13, s[40:43], s73 offen offset:3072 lds
    v_xor_b32 v13, 16384, v13
    s_waitcnt lgkmcnt(0)
    s_add_u32 m0, s70, 4096
    s_nop 0
    buffer_load_dwordx4 v13, s[40:43], 0 offen offset:0 lds
    buffer_load_dwordx4 v13, s[40:43], s71 offen offset:1024 lds
    buffer_load_dwordx4 v13, s[40:43], s72 offen offset:2048 lds
    buffer_load_dwordx4 v13, s[40:43], s73 offen offset:3072 lds
    v_xor_b32 v13, 49152, v13
    s_lshl_b32 s64, s31, 12
    s_add_u32 s78, s64, 21504
    s_add_u32 s79, s64, 148480
    s_cmp_eq_u32 s31, 3
    s_cselect_b32 s79, 37888, s79
    s_sub_u32 s76, s78, s70
    s_sub_u32 s77, s79, s78
    v_xor_b32 v40, 0x100, v7
    v_xor_b32 v41, 0x100, v8
    v_xor_b32 v42, 0x100, v9
    v_xor_b32 v43, 0x100, v10
    s_barrier
    s_mov_b32 m0, s78
    s_nop 0
    buffer_load_dwordx4 v13, s[40:43], 0 offen offset:0 lds
    buffer_load_dwordx4 v13, s[40:43], s71 offen offset:1024 lds
    buffer_load_dwordx4 v13, s[40:43], s72 offen offset:2048 lds
    buffer_load_dwordx4 v13, s[40:43], s73 offen offset:3072 lds
    v_xor_b32 v13, 16384, v13
    s_mov_b32 m0, s79
    s_nop 0
    buffer_load_dwordx4 v13, s[40:43], 0 offen offset:0 lds
    buffer_load_dwordx4 v13, s[40:43], s71 offen offset:1024 lds
    buffer_load_dwordx4 v13, s[40:43], s72 offen offset:2048 lds
    buffer_load_dwordx4 v13, s[40:43], s73 offen offset:3072 lds
    v_xor_b32 v13, 114688, v13
    s_setprio 0
L_prog_43:
    ds_read_b128 v[16:19], v5 offset:32
    s_waitcnt lgkmcnt(0)
    v_min3_u32 v16, v16, v17, v18
    v_min_u32 v16, v16, v19
    v_cmp_gt_u32 vcc, 1, v16
    s_cbranch_vccnz L_retry_44
    ds_read_b128 v[16:19], v7 offset:1024
    ds_read_b128 v[20:23], v7 offset:9216
    ds_read_b128 v[24:27], v7 offset:17408
    s_waitcnt vmcnt(8)
    s_waitcnt lgkmcnt(0)
    v_mfma_f32_16x16x32_bf16 v[80:83], v[128:131], v[16:19], 0
    ds_read_b128 v[28:31], v8 offset:1024
    v_mfma_f32_16x16x32_bf16 v[96:99], v[128:131], v[20:23], 0
    ds_read_b128 v[32:35], v8 offset:9216
    v_mfma_f32_16x16x32_bf16 v[112:115], v[128:131], v[24:27], 0
    ds_read_b128 v[36:39], v8 offset:17408
    v_mfma_f32_16x16x32_bf16 v[84:87], v[132:135], v[16:19], 0
    v_mfma_f32_16x16x32_bf16 v[100:103], v[132:135], v[20:23], 0
    v_mfma_f32_16x16x32_bf16 v[116:119], v[132:135], v[24:27], 0
    v_mfma_f32_16x16x32_bf16 v[88:91], v[136:139], v[16:19], 0
    v_mfma_f32_16x16x32_bf16 v[104:107], v[136:139], v[20:23], 0
    v_mfma_f32_16x16x32_bf16 v[120:123], v[136:139], v[24:27], 0
    v_mfma_f32_16x16x32_bf16 v[92:95], v[140:143], v[16:19], 0
    v_mfma_f32_16x16x32_bf16 v[108:111], v[140:143], v[20:23], 0
    v_mfma_f32_16x16x32_bf16 v[124:127], v[140:143], v[24:27], 0
    s_waitcnt lgkmcnt(0)
    v_mfma_f32_16x16x32_bf16 v[80:83], v[144:147], v[28:31], v[80:83]
    ds_read_b128 v[16:19], v9 offset:1024
    v_mfma_f32_16x16x32_bf16 v[96:99], v[144:147], v[32:35], v[96:99]
    ds_read_b128 v[20:23], v9 offset:9216
    v_mfma_f32_16x16x32_bf16 v[112:115], v[144:147], v[36:39], v[112:115]
    ds_read_b128 v[24:27], v9 offset:17408
    v_mfma_f32_16x16x32_bf16 v[84:87], v[148:151], v[28:31], v[84:87]
    ds_read_b64_tr_b16 v[128:129], v11 offset:8192
    v_mfma_f32_16x16x32_bf16 v[100:103], v[148:151], v[32:35], v[100:103]
    ds_read_b64_tr_b16 v[130:131], v11 offset:8704
    v_mfma_f32_16x16x32_bf16 v[116:119], v[148:151], v[36:39], v[116:119]
    ds_read_b64_tr_b16 v[132:133], v11 offset:8200
    v_mfma_f32_16x16x32_bf16 v[88:91], v[152:155], v[28:31], v[88:91]
    ds_read_b64_tr_b16 v[134:135], v11 offset:8712
    v_mfma_f32_16x16x32_bf16 v[104:107], v[152:155], v[32:35], v[104:107]
    ds_read_b64_tr_b16 v[136:137], v12 offset:8192
    v_mfma_f32_16x16x32_bf16 v[120:123], v[152:155], v[36:39], v[120:123]
    ds_read_b64_tr_b16 v[138:139], v12 offset:8704
    v_mfma_f32_16x16x32_bf16 v[92:95], v[156:159], v[28:31], v[92:95]
    ds_read_b64_tr_b16 v[140:141], v12 offset:8200
    v_mfma_f32_16x16x32_bf16 v[108:111], v[156:159], v[32:35], v[108:111]
    ds_read_b64_tr_b16 v[142:143], v12 offset:8712
    v_mfma_f32_16x16x32_bf16 v[124:127], v[156:159], v[36:39], v[124:127]
    s_waitcnt lgkmcnt(8)
    v_mfma_f32_16x16x32_bf16 v[80:83], v[160:163], v[16:19], v[80:83]
    ds_read_b128 v[28:31], v10 offset:1024
    v_mfma_f32_16x16x32_bf16 v[96:99], v[160:163], v[20:23], v[96:99]
    ds_read_b128 v[32:35], v10 offset:9216
    v_mfma_f32_16x16x32_bf16 v[112:115], v[160:163], v[24:27], v[112:115]
    ds_read_b128 v[36:39], v10 offset:17408
    v_mfma_f32_16x16x32_bf16 v[84:87], v[164:167], v[16:19], v[84:87]
    ds_read_b64_tr_b16 v[144:145], v11 offset:12288
    v_mfma_f32_16x16x32_bf16 v[100:103], v[164:167], v[20:23], v[100:103]
    ds_read_b64_tr_b16 v[146:147], v11 offset:12800
    v_mfma_f32_16x16x32_bf16 v[116:119], v[164:167], v[24:27], v[116:119]
    ds_read_b64_tr_b16 v[148:149], v11 offset:12296
    v_mfma_f32_16x16x32_bf16 v[88:91], v[168:171], v[16:19], v[88:91]
    ds_read_b64_tr_b16 v[150:151], v11 offset:12808
    v_mfma_f32_16x16x32_bf16 v[104:107], v[168:171], v[20:23], v[104:107]
    ds_read_b64_tr_b16 v[152:153], v12 offset:12288
    v_mfma_f32_16x16x32_bf16 v[120:123], v[168:171], v[24:27], v[120:123]
    ds_read_b64_tr_b16 v[154:155], v12 offset:12800
    v_mfma_f32_16x16x32_bf16 v[92:95], v[172:175], v[16:19], v[92:95]
    ds_read_b64_tr_b16 v[156:157], v12 offset:12296
    v_mfma_f32_16x16x32_bf16 v[108:111], v[172:175], v[20:23], v[108:111]
    ds_read_b64_tr_b16 v[158:159], v12 offset:12808
    v_mfma_f32_16x16x32_bf16 v[124:127], v[172:175], v[24:27], v[124:127]
    s_waitcnt lgkmcnt(8)
    v_mfma_f32_16x16x32_bf16 v[80:83], v[176:179], v[28:31], v[80:83]
    ds_read_b128 v[16:19], v40 offset:1024
    v_mfma_f32_16x16x32_bf16 v[96:99], v[176:179], v[32:35], v[96:99]
    ds_read_b128 v[20:23], v40 offset:9216
    v_mfma_f32_16x16x32_bf16 v[112:115], v[176:179], v[36:39], v[112:115]
    ds_read_b128 v[24:27], v40 offset:17408
    v_mfma_f32_16x16x32_bf16 v[84:87], v[180:183], v[28:31], v[84:87]
    ds_read_b64_tr_b16 v[160:161], v11 offset:0
    v_mfma_f32_16x16x32_bf16 v[100:103], v[180:183], v[32:35], v[100:103]
    ds_read_b64_tr_b16 v[162:163], v11 offset:512
    v_mfma_f32_16x16x32_bf16 v[116:119], v[180:183], v[36:39], v[116:119]
    ds_read_b64_tr_b16 v[164:165], v11 offset:8
    v_mfma_f32_16x16x32_bf16 v[88:91], v[184:187], v[28:31], v[88:91]
    ds_read_b64_tr_b16 v[166:167], v11 offset:520
    v_mfma_f32_16x16x32_bf16 v[104:107], v[184:187], v[32:35], v[104:107]
    ds_read_b64_tr_b16 v[168:169], v12 offset:0
    v_mfma_f32_16x16x32_bf16 v[120:123], v[184:187], v[36:39], v[120:123]
    ds_read_b64_tr_b16 v[170:171], v12 offset:512
    v_mfma_f32_16x16x32_bf16 v[92:95], v[188:191], v[28:31], v[92:95]
    ds_read_b64_tr_b16 v[172:173], v12 offset:8
    v_mfma_f32_16x16x32_bf16 v[108:111], v[188:191], v[32:35], v[108:111]
    ds_read_b64_tr_b16 v[174:175], v12 offset:520
    v_mfma_f32_16x16x32_bf16 v[124:127], v[188:191], v[36:39], v[124:127]
    s_waitcnt lgkmcnt(8)
    v_mfma_f32_16x16x32_bf16 v[80:83], v[192:195], v[16:19], v[80:83]
    ds_read_b128 v[28:31], v41 offset:1024
    v_mfma_f32_16x16x32_bf16 v[96:99], v[192:195], v[20:23], v[96:99]
    ds_read_b128 v[32:35], v41 offset:9216
    v_mfma_f32_16x16x32_bf16 v[112:115], v[192:195], v[24:27], v[112:115]
    ds_read_b128 v[36:39], v41 offset:17408
    v_mfma_f32_16x16x32_bf16 v[84:87], v[196:199], v[16:19], v[84:87]
    ds_read_b64_tr_b16 v[176:177], v11 offset:4096
    v_mfma_f32_16x16x32_bf16 v[100:103], v[196:199], v[20:23], v[100:103]
    ds_read_b64_tr_b16 v[178:179], v11 offset:4608
    v_mfma_f32_16x16x32_bf16 v[116:119], v[196:199], v[24:27], v[116:119]
    ds_read_b64_tr_b16 v[180:181], v11 offset:4104
    v_mfma_f32_16x16x32_bf16 v[88:91], v[200:203], v[16:19], v[88:91]
    ds_read_b64_tr_b16 v[182:183], v11 offset:4616
    v_mfma_f32_16x16x32_bf16 v[104:107], v[200:203], v[20:23], v[104:107]
    ds_read_b64_tr_b16 v[184:185], v12 offset:4096
    v_mfma_f32_16x16x32_bf16 v[120:123], v[200:203], v[24:27], v[120:123]
    ds_read_b64_tr_b16 v[186:187], v12 offset:4608
    v_mfma_f32_16x16x32_bf16 v[92:95], v[204:207], v[16:19], v[92:95]
    ds_read_b64_tr_b16 v[188:189], v12 offset:4104
    v_mfma_f32_16x16x32_bf16 v[108:111], v[204:207], v[20:23], v[108:111]
    ds_read_b64_tr_b16 v[190:191], v12 offset:4616
    v_mfma_f32_16x16x32_bf16 v[124:127], v[204:207], v[24:27], v[124:127]
    s_waitcnt lgkmcnt(8)
    v_mfma_f32_16x16x32_bf16 v[80:83], v[208:211], v[28:31], v[80:83]
    ds_read_b128 v[16:19], v42 offset:1024
    v_mfma_f32_16x16x32_bf16 v[96:99], v[208:211], v[32:35], v[96:99]
    ds_read_b128 v[20:23], v42 offset:9216
    v_mfma_f32_16x16x32_bf16 v[112:115], v[208:211], v[36:39], v[112:115]
    ds_read_b128 v[24:27], v42 offset:17408
    v_mfma_f32_16x16x32_bf16 v[84:87], v[212:215], v[28:31], v[84:87]
    v_mfma_f32_16x16x32_bf16 v[100:103], v[212:215], v[32:35], v[100:103]
    v_mfma_f32_16x16x32_bf16 v[116:119], v[212:215], v[36:39], v[116:119]
    v_mfma_f32_16x16x32_bf16 v[88:91], v[216:219], v[28:31], v[88:91]
    v_mfma_f32_16x16x32_bf16 v[104:107], v[216:219], v[32:35], v[104:107]
    v_mfma_f32_16x16x32_bf16 v[120:123], v[216:219], v[36:39], v[120:123]
    v_mfma_f32_16x16x32_bf16 v[92:95], v[220:223], v[28:31], v[92:95]
    v_mfma_f32_16x16x32_bf16 v[108:111], v[220:223], v[32:35], v[108:111]
    v_mfma_f32_16x16x32_bf16 v[124:127], v[220:223], v[36:39], v[124:127]
    s_waitcnt lgkmcnt(0)
    v_mfma_f32_16x16x32_bf16 v[80:83], v[224:227], v[16:19], v[80:83]
    v_add_u32 v11, s76, v11
    v_add_u32 v12, s76, v12
    v_mfma_f32_16x16x32_bf16 v[96:99], v[224:227], v[20:23], v[96:99]
    ds_read_b128 v[28:31], v43 offset:1024
    v_mfma_f32_16x16x32_bf16 v[112:115], v[224:227], v[24:27], v[112:115]
    ds_read_b128 v[32:35], v43 offset:9216
    v_mfma_f32_16x16x32_bf16 v[84:87], v[228:231], v[16:19], v[84:87]
    ds_read_b128 v[36:39], v43 offset:17408
    v_mfma_f32_16x16x32_bf16 v[100:103], v[228:231], v[20:23], v[100:103]
    s_waitcnt vmcnt(4)
    ds_read_b64_tr_b16 v[192:193], v11 offset:0
    v_mfma_f32_16x16x32_bf16 v[116:119], v[228:231], v[24:27], v[116:119]
    ds_read_b64_tr_b16 v[194:195], v11 offset:512
    v_mfma_f32_16x16x32_bf16 v[88:91], v[232:235], v[16:19], v[88:91]
    ds_read_b64_tr_b16 v[196:197], v11 offset:8
    v_mfma_f32_16x16x32_bf16 v[104:107], v[232:235], v[20:23], v[104:107]
    ds_read_b64_tr_b16 v[198:199], v11 offset:520
    v_mfma_f32_16x16x32_bf16 v[120:123], v[232:235], v[24:27], v[120:123]
    ds_read_b64_tr_b16 v[200:201], v12 offset:0
    v_mfma_f32_16x16x32_bf16 v[92:95], v[236:239], v[16:19], v[92:95]
    ds_read_b64_tr_b16 v[202:203], v12 offset:512
    v_mfma_f32_16x16x32_bf16 v[108:111], v[236:239], v[20:23], v[108:111]
    ds_read_b64_tr_b16 v[204:205], v12 offset:8
    v_mfma_f32_16x16x32_bf16 v[124:127], v[236:239], v[24:27], v[124:127]
    ds_read_b64_tr_b16 v[206:207], v12 offset:520
    s_waitcnt lgkmcnt(8)
    v_mfma_f32_16x16x32_bf16 v[80:83], v[240:243], v[28:31], v[80:83]
    v_add_u32 v11, s77, v11
    v_add_u32 v12, s77, v12
    v_mfma_f32_16x16x32_bf16 v[96:99], v[240:243], v[32:35], v[96:99]
    s_waitcnt vmcnt(0)
    ds_read_b64_tr_b16 v[208:209], v11 offset:0
    v_mfma_f32_16x16x32_bf16 v[112:115], v[240:243], v[36:39], v[112:115]
    ds_read_b64_tr_b16 v[210:211], v11 offset:512
    v_mfma_f32_16x16x32_bf16 v[84:87], v[244:247], v[28:31], v[84:87]
    ds_read_b64_tr_b16 v[212:213], v11 offset:8
    v_mfma_f32_16x16x32_bf16 v[100:103], v[244:247], v[32:35], v[100:103]
    ds_read_b64_tr_b16 v[214:215], v11 offset:520
    v_mfma_f32_16x16x32_bf16 v[116:119], v[244:247], v[36:39], v[116:119]
    ds_read_b64_tr_b16 v[216:217], v12 offset:0
    v_mfma_f32_16x16x32_bf16 v[88:91], v[248:251], v[28:31], v[88:91]
    ds_read_b64_tr_b16 v[218:219], v12 offset:512
    v_mfma_f32_16x16x32_bf16 v[104:107], v[248:251], v[32:35], v[104:107]
    ds_read_b64_tr_b16 v[220:221], v12 offset:8
    v_mfma_f32_16x16x32_bf16 v[120:123], v[248:251], v[36:39], v[120:123]
    ds_read_b64_tr_b16 v[222:223], v12 offset:520
    v_mfma_f32_16x16x32_bf16 v[92:95], v[252:255], v[28:31], v[92:95]
    v_mfma_f32_16x16x32_bf16 v[108:111], v[252:255], v[32:35], v[108:111]
    v_mfma_f32_16x16x32_bf16 v[124:127], v[252:255], v[36:39], v[124:127]
    s_add_u32 s75, s74, 4096
    s_add_u32 s76, s74, 8192
    s_add_u32 s77, s74, 12288
    s_add_u32 s78, s74, 16384
L_prog_45:
    ds_read_b128 v[16:19], v5 offset:32
    s_waitcnt lgkmcnt(0)
    v_min3_u32 v16, v16, v17, v18
    v_min_u32 v16, v16, v19
    v_cmp_gt_u32 vcc, 1, v16
    s_cbranch_vccnz L_retry_46
    ds_read_b128 v[16:19], v7 offset:58368
    ds_read_b128 v[20:23], v8 offset:58368
    ds_read_b128 v[24:27], v9 offset:58368
    ds_read_b128 v[28:31], v10 offset:58368
    ds_read_b128 v[32:35], v40 offset:58368
    ds_read_b128 v[36:39], v41 offset:58368
    ds_read_b128 v[44:47], v42 offset:58368
    ds_read_b128 v[252:255], v43 offset:58368
    s_waitcnt lgkmcnt(7)
    v_mfma_f32_16x16x32_bf16 v[120:123], v[56:59], v[16:19], v[120:123]
    v_mfma_f32_16x16x32_bf16 v[124:127], v[60:63], v[16:19], v[124:127]
    v_mfma_f32_16x16x32_bf16 v[112:115], v[48:51], v[16:19], v[112:115]
    v_mfma_f32_16x16x32_bf16 v[116:119], v[52:55], v[16:19], v[116:119]
    s_waitcnt lgkmcnt(6)
    v_mfma_f32_16x16x32_bf16 v[120:123], v[72:75], v[20:23], v[120:123]
    v_mfma_f32_16x16x32_bf16 v[124:127], v[76:79], v[20:23], v[124:127]
    v_mfma_f32_16x16x32_bf16 v[112:115], v[64:67], v[20:23], v[112:115]
    v_mfma_f32_16x16x32_bf16 v[116:119], v[68:71], v[20:23], v[116:119]
    s_waitcnt lgkmcnt(5)
    v_mfma_f32_16x16x32_bf16 v[120:123], v[136:139], v[24:27], v[120:123]
    v_mfma_f32_16x16x32_bf16 v[124:127], v[140:143], v[24:27], v[124:127]
    v_mfma_f32_16x16x32_bf16 v[112:115], v[128:131], v[24:27], v[112:115]
    v_mfma_f32_16x16x32_bf16 v[116:119], v[132:135], v[24:27], v[116:119]
    s_waitcnt lgkmcnt(4)
    v_mfma_f32_16x16x32_bf16 v[120:123], v[152:155], v[28:31], v[120:123]
    v_mfma_f32_16x16x32_bf16 v[124:127], v[156:159], v[28:31], v[124:127]
    v_mfma_f32_16x16x32_bf16 v[112:115], v[144:147], v[28:31], v[112:115]
    v_mfma_f32_16x16x32_bf16 v[116:119], v[148:151], v[28:31], v[116:119]
    s_waitcnt lgkmcnt(3)
    v_mfma_f32_16x16x32_bf16 v[120:123], v[168:171], v[32:35], v[120:123]
    v_mfma_f32_16x16x32_bf16 v[124:127], v[172:175], v[32:35], v[124:127]
    v_mfma_f32_16x16x32_bf16 v[112:115], v[160:163], v[32:35], v[112:115]
    v_mfma_f32_16x16x32_bf16 v[116:119], v[164:167], v[32:35], v[116:119]
    s_waitcnt lgkmcnt(2)
    v_mfma_f32_16x16x32_bf16 v[120:123], v[184:187], v[36:39], v[120:123]
    v_mfma_f32_16x16x32_bf16 v[124:127], v[188:191], v[36:39], v[124:127]
    v_mfma_f32_16x16x32_bf16 v[112:115], v[176:179], v[36:39], v[112:115]
    v_mfma_f32_16x16x32_bf16 v[116:119], v[180:183], v[36:39], v[116:119]
    s_waitcnt lgkmcnt(1)
    v_mfma_f32_16x16x32_bf16 v[120:123], v[200:203], v[44:47], v[120:123]
    v_mfma_f32_16x16x32_bf16 v[124:127], v[204:207], v[44:47], v[124:127]
    v_mfma_f32_16x16x32_bf16 v[112:115], v[192:195], v[44:47], v[112:115]
    v_mfma_f32_16x16x32_bf16 v[116:119], v[196:199], v[44:47], v[116:119]
    s_waitcnt lgkmcnt(0)
    v_mfma_f32_16x16x32_bf16 v[120:123], v[216:219], v[252:255], v[120:123]
    v_mfma_f32_16x16x32_bf16 v[124:127], v[220:223], v[252:255], v[124:127]
    v_mfma_f32_16x16x32_bf16 v[112:115], v[208:211], v[252:255], v[112:115]
    v_mfma_f32_16x16x32_bf16 v[116:119], v[212:215], v[252:255], v[116:119]
L_prog_47:
    ds_read_b128 v[16:19], v5 offset:32
    s_waitcnt lgkmcnt(0)
    v_min3_u32 v16, v16, v17, v18
    v_min_u32 v16, v16, v19
    v_cmp_gt_u32 vcc, 3, v16
    s_cbranch_vccnz L_retry_48
    ds_read_b128 v[16:19], v7 offset:41984
    ds_read_b128 v[20:23], v8 offset:41984
    ds_read_b128 v[24:27], v9 offset:41984
    ds_read_b128 v[28:31], v10 offset:41984
    ds_read_b128 v[32:35], v40 offset:41984
    ds_read_b128 v[36:39], v41 offset:41984
    ds_read_b128 v[44:47], v42 offset:41984
    ds_read_b128 v[252:255], v43 offset:41984
    s_waitcnt lgkmcnt(7)
    v_mfma_f32_16x16x32_bf16 v[88:91], v[56:59], v[16:19], v[88:91]
    v_cvt_pk_bf16_f32 v248, v120, v121
    v_mfma_f32_16x16x32_bf16 v[92:95], v[60:63], v[16:19], v[92:95]
    v_cvt_pk_bf16_f32 v249, v122, v123
    v_mfma_f32_16x16x32_bf16 v[80:83], v[48:51], v[16:19], v[80:83]
    v_cvt_pk_bf16_f32 v250, v124, v125
    v_mfma_f32_16x16x32_bf16 v[84:87], v[52:55], v[16:19], v[84:87]
    v_cvt_pk_bf16_f32 v251, v126, v127
    s_waitcnt lgkmcnt(6)
    v_mfma_f32_16x16x32_bf16 v[88:91], v[72:75], v[20:23], v[88:91]
    v_cvt_pk_bf16_f32 v244, v112, v113
    v_mfma_f32_16x16x32_bf16 v[92:95], v[76:79], v[20:23], v[92:95]
    v_cvt_pk_bf16_f32 v245, v114, v115
    v_mfma_f32_16x16x32_bf16 v[80:83], v[64:67], v[20:23], v[80:83]
    v_cvt_pk_bf16_f32 v246, v116, v117
    v_mfma_f32_16x16x32_bf16 v[84:87], v[68:71], v[20:23], v[84:87]
    v_cvt_pk_bf16_f32 v247, v118, v119
    s_waitcnt lgkmcnt(5)
    v_mfma_f32_16x16x32_bf16 v[88:91], v[136:139], v[24:27], v[88:91]
    v_mov_b32_dpp v244, v248 row_ror:8 row_mask:0xf bank_mask:0xc
    v_mfma_f32_16x16x32_bf16 v[92:95], v[140:143], v[24:27], v[92:95]
    v_mov_b32_dpp v245, v249 row_ror:8 row_mask:0xf bank_mask:0xc
    v_mfma_f32_16x16x32_bf16 v[80:83], v[128:131], v[24:27], v[80:83]
    v_mov_b32_dpp v246, v250 row_ror:8 row_mask:0xf bank_mask:0xc
    v_mfma_f32_16x16x32_bf16 v[84:87], v[132:135], v[24:27], v[84:87]
    v_mov_b32_dpp v247, v251 row_ror:8 row_mask:0xf bank_mask:0xc
    s_waitcnt lgkmcnt(4)
    v_mfma_f32_16x16x32_bf16 v[88:91], v[152:155], v[28:31], v[88:91]
    v_mfma_f32_16x16x32_bf16 v[92:95], v[156:159], v[28:31], v[92:95]
    v_mfma_f32_16x16x32_bf16 v[80:83], v[144:147], v[28:31], v[80:83]
    v_mfma_f32_16x16x32_bf16 v[84:87], v[148:151], v[28:31], v[84:87]
    s_waitcnt lgkmcnt(3)
    v_mfma_f32_16x16x32_bf16 v[88:91], v[168:171], v[32:35], v[88:91]
    v_mfma_f32_16x16x32_bf16 v[92:95], v[172:175], v[32:35], v[92:95]
    v_mfma_f32_16x16x32_bf16 v[80:83], v[160:163], v[32:35], v[80:83]
    v_mfma_f32_16x16x32_bf16 v[84:87], v[164:167], v[32:35], v[84:87]
    s_waitcnt lgkmcnt(2)
    v_mfma_f32_16x16x32_bf16 v[88:91], v[184:187], v[36:39], v[88:91]
    v_mfma_f32_16x16x32_bf16 v[92:95], v[188:191], v[36:39], v[92:95]
    v_mfma_f32_16x16x32_bf16 v[80:83], v[176:179], v[36:39], v[80:83]
    v_mfma_f32_16x16x32_bf16 v[84:87], v[180:183], v[36:39], v[84:87]
    s_waitcnt lgkmcnt(1)
    v_mfma_f32_16x16x32_bf16 v[88:91], v[200:203], v[44:47], v[88:91]
    v_mfma_f32_16x16x32_bf16 v[92:95], v[204:207], v[44:47], v[92:95]
    v_mfma_f32_16x16x32_bf16 v[80:83], v[192:195], v[44:47], v[80:83]
    v_mfma_f32_16x16x32_bf16 v[84:87], v[196:199], v[44:47], v[84:87]
    s_waitcnt lgkmcnt(0)
    v_mfma_f32_16x16x32_bf16 v[88:91], v[216:219], v[252:255], v[88:91]
    v_mfma_f32_16x16x32_bf16 v[92:95], v[220:223], v[252:255], v[92:95]
    v_mfma_f32_16x16x32_bf16 v[80:83], v[208:211], v[252:255], v[80:83]
    v_mfma_f32_16x16x32_bf16 v[84:87], v[212:215], v[252:255], v[84:87]
    s_nop 4
    v_cvt_pk_bf16_f32 v228, v88, v89
    v_cvt_pk_bf16_f32 v229, v90, v91
    v_cvt_pk_bf16_f32 v230, v92, v93
    v_cvt_pk_bf16_f32 v231, v94, v95
    v_cvt_pk_bf16_f32 v224, v80, v81
    v_cvt_pk_bf16_f32 v225, v82, v83
    v_cvt_pk_bf16_f32 v226, v84, v85
    v_cvt_pk_bf16_f32 v227, v86, v87
    v_cvt_pk_bf16_f32 v240, v80, v81
    v_cvt_pk_bf16_f32 v241, v82, v83
    v_cvt_pk_bf16_f32 v242, v84, v85
    v_cvt_pk_bf16_f32 v243, v86, v87
    v_mov_b32_dpp v224, v228 row_ror:8 row_mask:0xf bank_mask:0xc
    v_mov_b32_dpp v225, v229 row_ror:8 row_mask:0xf bank_mask:0xc
    v_mov_b32_dpp v226, v230 row_ror:8 row_mask:0xf bank_mask:0xc
    v_mov_b32_dpp v227, v231 row_ror:8 row_mask:0xf bank_mask:0xc
    v_mov_b32_dpp v228, v240 row_ror:8 row_mask:0xf bank_mask:0x3
    v_mov_b32_dpp v229, v241 row_ror:8 row_mask:0xf bank_mask:0x3
    v_mov_b32_dpp v230, v242 row_ror:8 row_mask:0xf bank_mask:0x3
    v_mov_b32_dpp v231, v243 row_ror:8 row_mask:0xf bank_mask:0x3
L_prog_49:
    ds_read_b128 v[16:19], v5 offset:48
    s_waitcnt lgkmcnt(0)
    v_min3_u32 v16, v16, v17, v18
    v_min_u32 v16, v16, v19
    v_cmp_gt_u32 vcc, 1, v16
    s_cbranch_vccnz L_retry_50
    s_setprio 2
    buffer_store_dwordx4 v[244:247], v0, s[48:51], s78 offen sc1
    buffer_store_dwordx4 v[224:227], v0, s[48:51], s74 offen sc1
    buffer_store_dwordx4 v[228:231], v0, s[48:51], s75 offen sc1
    s_setprio 0
    v_lshlrev_b32 v1, 4, v4
    v_lshl_add_u32 v1, v3, 9, v1
    s_barrier
    s_setprio 2
    ds_read_b128 v[16:19], v7 offset:50176
    ds_read_b128 v[20:23], v8 offset:50176
    ds_read_b128 v[24:27], v9 offset:50176
    ds_read_b128 v[28:31], v10 offset:50176
    ds_read_b128 v[32:35], v40 offset:50176
    ds_read_b128 v[36:39], v41 offset:50176
    ds_read_b128 v[44:47], v42 offset:50176
    ds_read_b128 v[252:255], v43 offset:50176
    s_waitcnt lgkmcnt(7)
    v_mfma_f32_16x16x32_bf16 v[104:107], v[56:59], v[16:19], v[104:107]
    v_mfma_f32_16x16x32_bf16 v[108:111], v[60:63], v[16:19], v[108:111]
    s_waitcnt lgkmcnt(6)
    v_mfma_f32_16x16x32_bf16 v[104:107], v[72:75], v[20:23], v[104:107]
    v_mfma_f32_16x16x32_bf16 v[108:111], v[76:79], v[20:23], v[108:111]
    s_waitcnt lgkmcnt(5)
    v_mfma_f32_16x16x32_bf16 v[104:107], v[136:139], v[24:27], v[104:107]
    v_mfma_f32_16x16x32_bf16 v[108:111], v[140:143], v[24:27], v[108:111]
    s_waitcnt lgkmcnt(4)
    v_mfma_f32_16x16x32_bf16 v[104:107], v[152:155], v[28:31], v[104:107]
    v_mfma_f32_16x16x32_bf16 v[108:111], v[156:159], v[28:31], v[108:111]
    s_waitcnt lgkmcnt(3)
    v_mfma_f32_16x16x32_bf16 v[104:107], v[168:171], v[32:35], v[104:107]
    v_mfma_f32_16x16x32_bf16 v[108:111], v[172:175], v[32:35], v[108:111]
    s_waitcnt lgkmcnt(2)
    v_mfma_f32_16x16x32_bf16 v[104:107], v[184:187], v[36:39], v[104:107]
    v_mfma_f32_16x16x32_bf16 v[108:111], v[188:191], v[36:39], v[108:111]
    s_waitcnt lgkmcnt(1)
    v_mfma_f32_16x16x32_bf16 v[104:107], v[200:203], v[44:47], v[104:107]
    v_mfma_f32_16x16x32_bf16 v[108:111], v[204:207], v[44:47], v[108:111]
    s_waitcnt lgkmcnt(0)
    v_mfma_f32_16x16x32_bf16 v[104:107], v[216:219], v[252:255], v[104:107]
    v_mfma_f32_16x16x32_bf16 v[108:111], v[220:223], v[252:255], v[108:111]
    v_mfma_f32_16x16x32_bf16 v[96:99], v[48:51], v[16:19], v[96:99]
    v_mfma_f32_16x16x32_bf16 v[100:103], v[52:55], v[16:19], v[100:103]
    v_mfma_f32_16x16x32_bf16 v[96:99], v[64:67], v[20:23], v[96:99]
    v_mfma_f32_16x16x32_bf16 v[100:103], v[68:71], v[20:23], v[100:103]
    v_mfma_f32_16x16x32_bf16 v[96:99], v[128:131], v[24:27], v[96:99]
    v_mfma_f32_16x16x32_bf16 v[100:103], v[132:135], v[24:27], v[100:103]
    v_mfma_f32_16x16x32_bf16 v[96:99], v[144:147], v[28:31], v[96:99]
    v_mfma_f32_16x16x32_bf16 v[100:103], v[148:151], v[28:31], v[100:103]
    v_cvt_pk_bf16_f32 v236, v104, v105
    v_mfma_f32_16x16x32_bf16 v[96:99], v[160:163], v[32:35], v[96:99]
    v_cvt_pk_bf16_f32 v237, v106, v107
    v_mfma_f32_16x16x32_bf16 v[100:103], v[164:167], v[32:35], v[100:103]
    v_cvt_pk_bf16_f32 v238, v108, v109
    v_mfma_f32_16x16x32_bf16 v[96:99], v[176:179], v[36:39], v[96:99]
    v_cvt_pk_bf16_f32 v239, v110, v111
    v_mfma_f32_16x16x32_bf16 v[100:103], v[180:183], v[36:39], v[100:103]
    buffer_store_dwordx4 v[236:239], v1, s[48:51], s76 offen offset:64 sc1
    v_mfma_f32_16x16x32_bf16 v[96:99], v[192:195], v[44:47], v[96:99]
    v_mfma_f32_16x16x32_bf16 v[100:103], v[196:199], v[44:47], v[100:103]
    v_mfma_f32_16x16x32_bf16 v[96:99], v[208:211], v[252:255], v[96:99]
    v_mfma_f32_16x16x32_bf16 v[100:103], v[212:215], v[252:255], v[100:103]
    s_nop 6
    v_cvt_pk_bf16_f32 v232, v96, v97
    v_cvt_pk_bf16_f32 v233, v98, v99
    v_cvt_pk_bf16_f32 v234, v100, v101
    v_cvt_pk_bf16_f32 v235, v102, v103
    buffer_store_dwordx4 v[232:235], v1, s[48:51], s76 offen offset:0 sc1
    s_or_b32 s64, s2, s3
    s_cbranch_scc1 L_noepoch_51
    v_mov_b32 v1, s30
    s_mov_b64 exec, 1
    buffer_store_dword v1, v5, s[44:47], 0 offen sc1
L_noepoch_51:
    s_endpgm
L_retry_39:
    s_sub_u32 s100, s100, 1
    s_cbranch_scc1 L_end
    s_sleep 1
    s_branch L_spin_38
L_mre_40:
    s_sub_u32 s100, s100, 1
    s_cbranch_scc1 L_end
    s_sleep 2
    buffer_load_dword v1, v0, s[44:47], s74 offen sc1
    s_waitcnt vmcnt(0)
    s_branch L_mchk_37
L_retry_42:
    s_sub_u32 s100, s100, 1
    s_cbranch_scc1 L_end
    s_sleep 1
    s_branch L_spin_41
L_retry_44:
    s_sub_u32 s100, s100, 1
    s_cbranch_scc1 L_end
    s_sleep 1
    s_branch L_prog_43
L_retry_46:
    s_sub_u32 s100, s100, 1
    s_cbranch_scc1 L_end
    s_sleep 1
    s_branch L_prog_45
L_retry_48:
    s_sub_u32 s100, s100, 1
    s_cbranch_scc1 L_end
    s_sleep 1
    s_branch L_prog_47
L_retry_50:
    s_sub_u32 s100, s100, 1
    s_cbranch_scc1 L_end
    s_sleep 1
    s_branch L_prog_49
L_end:
    s_endpgm
.section .rodata,"a"
.p2align 6
.amdhsa_kernel standalone__hybrid_graph_tf_exphormer__graph_kernel
  .amdhsa_next_free_vgpr 256
  .amdhsa_next_free_sgpr 102
  .amdhsa_accum_offset 256
  .amdhsa_group_segment_fixed_size 0
  .amdhsa_kernarg_size 104
  .amdhsa_user_sgpr_count 2
  .amdhsa_user_sgpr_kernarg_segment_ptr 1
  .amdhsa_system_sgpr_workgroup_id_x 1
  .amdhsa_float_denorm_mode_32 3
.end_amdhsa_kernel
```

```asm
; @launch grid=(253,1,1) block=(512,1,1) lds=161792
.amdgcn_target "amdgcn-amd-amdhsa--gfx950"
.text
.globl standalone__hybrid_graph_tf_exphormer__graph_kernel
.p2align 8
.type standalone__hybrid_graph_tf_exphormer__graph_kernel,@function
standalone__hybrid_graph_tf_exphormer__graph_kernel:
L_begin:
    s_cmp_ge_u32 s2, 253
    s_cbranch_scc1 L_end
    s_load_dwordx16 s[4:19], s[0:1], 0
    s_load_dwordx8 s[20:27], s[0:1], 64
    s_load_dwordx2 s[28:29], s[0:1], 96
    s_and_b32 s64, s2, 0xf8
    s_cmp_lg_u32 s64, 8
    s_cbranch_scc1 L_nopf
    s_getpc_b64 s[32:33]
L_pc:
    v_lshlrev_b32 v1, 6, v0
    v_min_u32 v1, L_end-L_pc, v1
    global_load_dword v255, v1, s[32:33]
L_nopf:
    v_lshrrev_b32 v1, 6, v0
    v_and_b32 v2, 63, v0
    v_readfirstlane_b32 s3, v1
    s_and_b32 s67, s2, 7
    s_and_b32 s31, s3, 3
    s_cmp_lt_u32 s3, 4
    s_cbranch_scc1 L_gemm
    s_setprio 3
    s_bitcmp1_b32 s2, 3
    s_cbranch_scc0 L_mload_1
    s_lshr_b32 s66, s2, 4
    s_lshl3_add_u32 s68, s66, s67
    s_mul_i32 s64, s68, 5120
    s_sub_u32 s65, s64, 4096
    v_lshl_add_u32 v40, v0, 4, s65
    s_add_u32 s64, s64, 3072
    v_lshl_add_u32 v41, v0, 2, s64
    s_waitcnt lgkmcnt(0)
    global_load_dwordx4 v[48:51], v40, s[8:9] nt
    global_load_dword v52, v41, s[8:9] nt
    global_load_dwordx4 v[56:59], v40, s[6:7] nt
    global_load_dword v60, v41, s[6:7] nt
    s_mov_b32 s27, s68
    s_branch L_roled_2
L_mload_1:
    v_lshrrev_b32 v43, 5, v2
    v_lshl_add_u32 v44, s31, 2, v43
    v_and_b32 v46, 31, v2
    v_xor_b32 v46, v46, v44
    v_lshl_add_u32 v43, s31, 3, v43
    v_lshlrev_b32 v43, 9, v43
    v_lshl_add_u32 v46, v46, 4, v43
    v_lshl_add_u32 v44, s67, 14, v46
    s_and_b32 s65, s2, 0xe0
    s_and_b32 s66, s2, 16
    s_lshl2_add_u32 s65, s65, s66
    v_lshl_add_u32 v46, s65, 7, v46
    s_lshl_b32 s66, s31, 11
    s_add_u32 m0, s66, 62464
    s_waitcnt lgkmcnt(0)
    global_load_lds_dwordx4 v46, s[20:21]
    s_add_u32 m0, s66, 21504
    v_xor_b32 v46, 0x420, v46
    global_load_lds_dwordx4 v44, s[18:19]
    s_add_u32 m0, s66, 27648
    v_xor_b32 v45, 0x420, v44
    global_load_lds_dwordx4 v44, s[18:19] offset:2048
    s_add_u32 m0, s66, 63488
    s_lshr_b32 s64, s2, 6
    global_load_lds_dwordx4 v46, s[20:21]
    s_add_u32 m0, s66, 22528
    s_lshl3_add_u32 s64, s64, s67
    global_load_lds_dwordx4 v45, s[18:19]
    s_add_u32 m0, s66, 28672
    s_bfe_u32 s65, s2, 0x20004
    global_load_lds_dwordx4 v45, s[18:19] offset:2048
    s_lshl2_add_u32 s27, s64, s65
L_roled_2:
    s_cmp_lg_u32 s31, 0
    s_cbranch_scc1 L_roled_2_b
    s_load_dword s30, s[28:29], 0
L_roled_2_b:
    v_and_b32 v3, 15, v2
    v_lshrrev_b32 v4, 4, v2
    v_mov_b32 v5, 0
    v_mov_b32 v6, 1
    s_mov_b32 s100, 67108864
    s_bfe_u32 s65, s2, 0x10003
    s_lshl1_add_u32 s64, s67, s65
    s_and_b32 s65, s2, 0xf0
    s_or_b32 s64, s64, s65
    s_cmp_lt_u32 s2, 240
    s_cselect_b32 s1, s64, s2
    v_lshrrev_b32 v42, 2, v3
    v_and_b32 v43, 3, v3
    v_lshl_add_u32 v42, v42, 4, v43
    s_lshl_b32 s64, s31, 1
    v_mov_b32 v43, s64
    v_lshlrev_b32 v44, 1, v43
    v_cmp_gt_u32 vcc, 8, v3
    s_mul_i32 s65, s1, 640
    v_lshlrev_b32 v7, 4, v3
    v_cndmask_b32 v43, v43, v44, vcc
    v_add_lshl_u32 v42, v42, v43, 4
    v_lshl_add_u32 v42, v4, 2, v42
    v_add_u32 v42, s65, v42
    v_min_u32 v42, 159996, v42
    v_lshlrev_b32 v8, 4, v0
    v_and_b32 v8, 0xfff, v8
    global_load_dword v0, v42, s[10:11] nt
    s_barrier
    s_mov_b32 s32, s4
    s_and_b32 s33, s5, 0xffff
    s_mov_b32 s34, 5120000
    s_mov_b32 s35, 0x20000
    s_mov_b32 s36, s14
    s_and_b32 s37, s15, 0xffff
    s_mov_b32 s38, 20000
    s_mov_b32 s39, 0x20000
    s_add_u32 s40, s28, 1048576
    s_addc_u32 s41, s29, 0
    s_and_b32 s41, s41, 0xffff
    s_mov_b32 s42, 2048000
    s_mov_b32 s43, 0x20000
    v_and_b32 v40, 8, v3
    v_lshlrev_b32 v40, 1, v40
    v_mov_b32 v41, 0xffff
    v_lshlrev_b32 v40, v40, v41
    s_mov_b32 s64, 0x0f0f0f0f
    s_mov_b32 s65, 0x0f0f0f0f
    v_cndmask_b32 v12, 0, v40, s[64:65]
    v_xor_b32 v13, v40, v12
    v_and_b32 v14, 3, v3
    v_mul_u32_u24 v14, 0x5555, v14
    s_cmp_lg_u32 s31, 0
    s_cbranch_scc1 L_tagged_3
    s_waitcnt lgkmcnt(0)
    s_mul_i32 s30, s30, 0x9E3779B1
    s_add_u32 s30, s30, 0x7F4A7C15
    v_mov_b32 v40, 1
    v_mov_b32 v41, s30
    ds_write_b64 v5, v[40:41] offset:8
L_tagged_3:
    s_bitcmp1_b32 s2, 3
    s_cbranch_scc0 L_mwork_4
    v_mov_b32 v43, 4
    v_mov_b32 v44, 2031616
    s_mov_b32 s64, 0x3f0001
    v_lshrrev_b32 v40, 6, v8
    v_and_b32 v41, 0x30, v8
    v_lshl_add_u32 v40, v40, 14, v41
    s_lshl_b32 s68, s27, 6
    s_add_u32 s69, s68, 0x100000
    s_add_u32 s70, s68, 8192
    s_add_u32 s71, s69, 8192
    s_mov_b32 s65, 0x203c
    s_waitcnt vmcnt(3)
    v_mul_u32_u24 v64, 52429, v48
    v_lshrrev_b32 v72, 22, v64
    v_lshlrev_b32 v80, 2, v72
    ds_add_rtn_u32 v80, v80, v43 offset:512
    v_mul_u32_u24 v65, 52429, v49
    v_lshrrev_b32 v73, 22, v65
    v_lshlrev_b32 v81, 2, v73
    ds_add_rtn_u32 v81, v81, v43 offset:512
    v_mul_u32_u24 v66, 52429, v50
    v_lshrrev_b32 v74, 22, v66
    v_lshlrev_b32 v82, 2, v74
    ds_add_rtn_u32 v82, v82, v43 offset:512
    v_mul_u32_u24 v67, 52429, v51
    v_lshrrev_b32 v75, 22, v67
    v_lshlrev_b32 v83, 2, v75
    ds_add_rtn_u32 v83, v83, v43 offset:512
    v_mul_u32_u24 v68, 52429, v52
    v_lshrrev_b32 v76, 22, v68
    v_lshlrev_b32 v84, 2, v76
    ds_add_rtn_u32 v84, v84, v43 offset:512
    v_lshrrev_b32 v64, 21, v64
    v_mad_u32_u24 v64, v64, 24, v48
    v_mul_u32_u24 v64, 0x8001, v64
    v_bfe_u32 v88, v72, 1, 2
    v_lshl_or_b32 v72, v72, 2, v88
    v_lshlrev_b32 v72, 4, v72
    v_lshrrev_b32 v65, 21, v65
    v_mad_u32_u24 v65, v65, 24, v49
    v_mul_u32_u24 v65, 0x8001, v65
    v_bfe_u32 v89, v73, 1, 2
    v_lshl_or_b32 v73, v73, 2, v89
    v_lshlrev_b32 v73, 4, v73
    v_lshrrev_b32 v66, 21, v66
    v_mad_u32_u24 v66, v66, 24, v50
    v_mul_u32_u24 v66, 0x8001, v66
    v_bfe_u32 v90, v74, 1, 2
    v_lshl_or_b32 v74, v74, 2, v90
    v_lshlrev_b32 v74, 4, v74
    v_lshrrev_b32 v67, 21, v67
    v_mad_u32_u24 v67, v67, 24, v51
    v_mul_u32_u24 v67, 0x8001, v67
    v_bfe_u32 v91, v75, 1, 2
    v_lshl_or_b32 v75, v75, 2, v91
    v_lshlrev_b32 v75, 4, v75
    v_lshrrev_b32 v68, 21, v68
    v_mad_u32_u24 v68, v68, 24, v52
    v_mul_u32_u24 v68, 0x8001, v68
    v_bfe_u32 v92, v76, 1, 2
    v_lshl_or_b32 v76, v76, 2, v92
    v_lshlrev_b32 v76, 4, v76
    s_waitcnt vmcnt(1)
    v_lshlrev_b32 v56, 1, v56
    v_and_or_b32 v64, v64, s64, v56
    v_lshlrev_b32 v57, 1, v57
    v_and_or_b32 v65, v65, s64, v57
    v_lshlrev_b32 v58, 1, v58
    v_and_or_b32 v66, v66, s64, v58
    v_lshlrev_b32 v59, 1, v59
    v_and_or_b32 v67, v67, s64, v59
    v_lshlrev_b32 v60, 1, v60
    v_and_or_b32 v68, v68, s64, v60
    s_waitcnt lgkmcnt(0)
    v_cmp_gt_u32 vcc, 124, v80
    v_min_u32 v80, 124, v80
    v_lshl_or_b32 v80, v80, 7, v80
    v_cndmask_b32 v64, v44, v64, vcc
    v_bitop3_b32 v80, v80, s65, v72 bitop3:0x6a
    ds_write_b32 v80, v64 offset:41984
    v_cmp_gt_u32 vcc, 124, v81
    v_min_u32 v81, 124, v81
    v_lshl_or_b32 v81, v81, 7, v81
    v_cndmask_b32 v65, v44, v65, vcc
    v_bitop3_b32 v81, v81, s65, v73 bitop3:0x6a
    ds_write_b32 v81, v65 offset:41984
    v_cmp_gt_u32 vcc, 124, v82
    v_min_u32 v82, 124, v82
    v_lshl_or_b32 v82, v82, 7, v82
    v_cndmask_b32 v66, v44, v66, vcc
    v_bitop3_b32 v82, v82, s65, v74 bitop3:0x6a
    ds_write_b32 v82, v66 offset:41984
    v_cmp_gt_u32 vcc, 124, v83
    v_min_u32 v83, 124, v83
    v_lshl_or_b32 v83, v83, 7, v83
    v_cndmask_b32 v67, v44, v67, vcc
    v_bitop3_b32 v83, v83, s65, v75 bitop3:0x6a
    ds_write_b32 v83, v67 offset:41984
    v_cmp_gt_u32 vcc, 124, v84
    v_min_u32 v84, 124, v84
    v_lshl_or_b32 v84, v84, 7, v84
    v_cndmask_b32 v68, v44, v68, vcc
    v_bitop3_b32 v84, v84, s65, v76 bitop3:0x6a
    ds_write_b32 v84, v68 offset:41984
    s_waitcnt lgkmcnt(0)
    s_barrier
    ds_read_b32 v44, v5 offset:12
    ds_read_b128 v[48:51], v8 offset:41984
    ds_read_b128 v[52:55], v8 offset:46080
    ds_read_b128 v[56:59], v8 offset:50176
    ds_read_b128 v[60:63], v8 offset:54272
    s_waitcnt lgkmcnt(4)
    v_readfirstlane_b32 s30, v44
    s_waitcnt vmcnt(0)
    s_and_b32 s44, s30, 0xffc00000
    s_lshl_b32 s45, s30, 10
    s_and_b32 s45, s45, 0xffc00000
    s_lshl_b32 s46, s30, 20
    s_and_b32 s46, s46, 0xffc00000
    s_lshl_b32 s47, s30, 22
    s_waitcnt lgkmcnt(3)
    v_cmp_eq_u32 vcc, 1966080, v51
    v_or_b32 v48, s44, v48
    v_or_b32 v49, s45, v49
    v_or_b32 v50, s46, v50
    v_or_b32 v51, s47, v51
    buffer_store_dwordx4 v[48:51], v40, s[40:43], s68 offen sc1
    s_wqm_b64 s[72:73], vcc
    s_waitcnt lgkmcnt(2)
    v_cmp_eq_u32 vcc, 1966080, v55
    v_or_b32 v52, s44, v52
    v_or_b32 v53, s45, v53
    v_or_b32 v54, s46, v54
    v_or_b32 v55, s47, v55
    buffer_store_dwordx4 v[52:55], v40, s[40:43], s69 offen sc1
    s_wqm_b64 s[74:75], vcc
    s_waitcnt lgkmcnt(1)
    s_not_b64 exec, s[72:73]
    s_cbranch_scc0 L_nosec_8
    v_or_b32 v56, s44, v56
    v_or_b32 v57, s45, v57
    v_or_b32 v58, s46, v58
    v_or_b32 v59, s47, v59
    buffer_store_dwordx4 v[56:59], v40, s[40:43], s70 offen sc1
L_nosec_8:
    s_waitcnt lgkmcnt(0)
    s_not_b64 exec, s[74:75]
    s_cbranch_scc0 L_nosec_9
    v_or_b32 v60, s44, v60
    v_or_b32 v61, s45, v61
    v_or_b32 v62, s46, v62
    v_or_b32 v63, s47, v63
    buffer_store_dwordx4 v[60:63], v40, s[40:43], s71 offen sc1
L_nosec_9:
    s_mov_b64 exec, -1
    s_cmp_ge_u32 s2, 250
    s_cbranch_scc1 L_end
L_worked_5:
    v_lshlrev_b32 v0, 9, v0
    s_setprio 1
    s_lshl_b32 s64, s31, 10
    s_lshr_b32 s10, s1, 1
    s_lshl_b32 s10, s10, 14
    s_add_u32 s11, s10, 4096
    s_add_u32 s12, s10, 8192
    s_add_u32 s13, s10, 12288
    v_cmp_gt_u32 vcc, 0xf40, v8
    s_mov_b64 s[14:15], vcc
    v_add_u32_dpp v9, v0, v7 row_newbcast:0 row_mask:0xf bank_mask:0xf
    s_waitcnt vmcnt(4)
    buffer_load_dwordx4 v[176:179], v9, s[32:35], 0 offen offset:0
    buffer_load_dwordx4 v[180:183], v9, s[32:35], 0 offen offset:256
    v_add_u32_dpp v9, v0, v7 row_newbcast:1 row_mask:0xf bank_mask:0xf
    s_waitcnt vmcnt(4)
    buffer_load_dwordx4 v[184:187], v9, s[32:35], 0 offen offset:0
    buffer_load_dwordx4 v[188:191], v9, s[32:35], 0 offen offset:256
    s_add_u32 m0, s64, 62464
    s_mov_b32 s65, 0
    buffer_load_dwordx4 v8, s[36:39], s65 offen lds
    v_add_u32_dpp v9, v0, v7 row_newbcast:2 row_mask:0xf bank_mask:0xf
    s_waitcnt vmcnt(4)
    buffer_load_dwordx4 v[192:195], v9, s[32:35], 0 offen offset:0
    buffer_load_dwordx4 v[196:199], v9, s[32:35], 0 offen offset:256
    s_add_u32 m0, s64, 66560
    s_mov_b32 s65, 4096
    buffer_load_dwordx4 v8, s[36:39], s65 offen lds
    v_add_u32_dpp v9, v0, v7 row_newbcast:3 row_mask:0xf bank_mask:0xf
    s_waitcnt vmcnt(4)
    buffer_load_dwordx4 v[200:203], v9, s[32:35], 0 offen offset:0
    buffer_load_dwordx4 v[204:207], v9, s[32:35], 0 offen offset:256
    v_add_u32_dpp v9, v0, v7 row_newbcast:4 row_mask:0xf bank_mask:0xf
    s_waitcnt vmcnt(4)
    buffer_load_dwordx4 v[208:211], v9, s[32:35], 0 offen offset:0
    buffer_load_dwordx4 v[212:215], v9, s[32:35], 0 offen offset:256
    s_add_u32 m0, s64, 70656
    s_mov_b32 s65, 8192
    buffer_load_dwordx4 v8, s[36:39], s65 offen lds
    v_add_u32_dpp v9, v0, v7 row_newbcast:5 row_mask:0xf bank_mask:0xf
    s_waitcnt vmcnt(4)
    buffer_load_dwordx4 v[216:219], v9, s[32:35], 0 offen offset:0
    buffer_load_dwordx4 v[220:223], v9, s[32:35], 0 offen offset:256
    s_add_u32 m0, s64, 74752
    s_mov_b32 s65, 12288
    buffer_load_dwordx4 v8, s[36:39], s65 offen lds
    v_add_u32_dpp v9, v0, v7 row_newbcast:6 row_mask:0xf bank_mask:0xf
    s_waitcnt vmcnt(4)
    buffer_load_dwordx4 v[224:227], v9, s[32:35], 0 offen offset:0
    buffer_load_dwordx4 v[228:231], v9, s[32:35], 0 offen offset:256
    s_add_u32 m0, s64, 78848
    s_mov_b32 s65, 16384
    buffer_load_dwordx4 v8, s[36:39], s65 offen lds
L_ipoll_10:
    buffer_load_dwordx4 v[48:51], v8, s[40:43], s10 offen sc1
    s_mov_b64 exec, s[14:15]
    buffer_load_dwordx4 v[52:55], v8, s[40:43], s11 offen sc1
    s_mov_b64 exec, -1
L_spin_11:
    ds_read_b128 v[44:47], v5
    s_waitcnt lgkmcnt(0)
    v_readfirstlane_b32 s101, v46
    v_readfirstlane_b32 s30, v47
    s_cmp_ge_u32 s101, 1
    s_cbranch_scc0 L_retry_12
    s_and_b32 s44, s30, 0xffc00000
    s_lshl_b32 s45, s30, 10
    s_and_b32 s45, s45, 0xffc00000
    s_lshl_b32 s46, s30, 20
    s_and_b32 s46, s46, 0xffc00000
    s_lshl_b32 s47, s30, 22
    s_and_b32 s64, s1, 1
    s_lshl_b32 s64, s64, 21
    s_xor_b32 s17, s64, 1966080
    s_or_b32 s44, s44, s64
    v_mov_b32 v68, s17
    s_or_b32 s45, s45, s64
    v_mov_b32 v69, s17
    s_or_b32 s46, s46, s64
    v_mov_b32 v70, s17
    s_or_b32 s47, s47, s64
    v_mov_b32 v71, s17
    s_mov_b32 s16, 1310720
    v_mov_b32 v42, 2
    s_waitcnt vmcnt(1)
    v_xor_b32 v64, s44, v48
    v_xor_b32 v65, s45, v49
    v_xor_b32 v66, s46, v50
    v_xor_b32 v67, s47, v51
    v_or3_b32 v40, v64, v65, v66
    v_or_b32 v40, v40, v67
    v_cmp_eq_u32 s[72:73], s17, v67
    v_cmp_gt_u32 s[48:49], s16, v64
    v_lshlrev_b32_sdwa v80, 2, v64 dst_sel:DWORD dst_unused:UNUSED_PAD src0_sel:DWORD src1_sel:WORD_1
    v_cmp_gt_u32 s[50:51], s16, v65
    v_lshlrev_b32_sdwa v81, 2, v65 dst_sel:DWORD dst_unused:UNUSED_PAD src0_sel:DWORD src1_sel:WORD_1
    v_cmp_gt_u32 s[52:53], s16, v66
    v_lshlrev_b32_sdwa v82, 2, v66 dst_sel:DWORD dst_unused:UNUSED_PAD src0_sel:DWORD src1_sel:WORD_1
    v_cmp_gt_u32 s[54:55], s16, v67
    v_lshlrev_b32_sdwa v83, 2, v67 dst_sel:DWORD dst_unused:UNUSED_PAD src0_sel:DWORD src1_sel:WORD_1
    s_waitcnt vmcnt(0)
    s_mov_b64 exec, s[14:15]
    v_xor_b32 v68, s44, v52
    v_xor_b32 v69, s45, v53
    v_xor_b32 v70, s46, v54
    v_xor_b32 v71, s47, v55
    s_mov_b64 exec, -1
    v_or3_b32 v40, v40, v68, v69
    v_or3_b32 v40, v40, v70, v71
    v_cmp_eq_u32 s[74:75], s17, v71
    v_cmp_le_u32 vcc, 0x400000, v40
    s_cbranch_vccnz L_retry_13
    s_wqm_b64 s[72:73], s[72:73]
    s_not_b64 exec, s[72:73]
    s_cbranch_scc0 L_nosec_14
    buffer_load_dwordx4 v[56:59], v8, s[40:43], s12 offen sc1
L_nosec_14:
    s_wqm_b64 s[74:75], s[74:75]
    s_not_b64 exec, s[74:75]
    s_cbranch_scc0 L_nosec_15
    buffer_load_dwordx4 v[60:63], v8, s[40:43], s13 offen sc1
L_nosec_15:
    s_mov_b64 exec, -1
    v_cmp_gt_u32 s[56:57], s16, v68
    v_lshlrev_b32_sdwa v84, 2, v68 dst_sel:DWORD dst_unused:UNUSED_PAD src0_sel:DWORD src1_sel:WORD_1
    v_cmp_gt_u32 s[58:59], s16, v69
    v_lshlrev_b32_sdwa v85, 2, v69 dst_sel:DWORD dst_unused:UNUSED_PAD src0_sel:DWORD src1_sel:WORD_1
    v_cmp_gt_u32 s[60:61], s16, v70
    v_lshlrev_b32_sdwa v86, 2, v70 dst_sel:DWORD dst_unused:UNUSED_PAD src0_sel:DWORD src1_sel:WORD_1
    v_cmp_gt_u32 s[62:63], s16, v71
    v_lshlrev_b32_sdwa v87, 2, v71 dst_sel:DWORD dst_unused:UNUSED_PAD src0_sel:DWORD src1_sel:WORD_1
    s_mov_b64 exec, s[48:49]
    ds_add_rtn_u32 v80, v80, v42 offset:128
    s_mov_b64 exec, s[50:51]
    ds_add_rtn_u32 v81, v81, v42 offset:128
    s_mov_b64 exec, s[52:53]
    ds_add_rtn_u32 v82, v82, v42 offset:128
    s_mov_b64 exec, s[54:55]
    ds_add_rtn_u32 v83, v83, v42 offset:128
    s_mov_b64 exec, s[56:57]
    ds_add_rtn_u32 v84, v84, v42 offset:128
    s_mov_b64 exec, s[58:59]
    ds_add_rtn_u32 v85, v85, v42 offset:128
    s_mov_b64 exec, s[60:61]
    ds_add_rtn_u32 v86, v86, v42 offset:128
    s_mov_b64 exec, s[62:63]
    ds_add_rtn_u32 v87, v87, v42 offset:128
    s_mov_b64 exec, -1
    v_add_u32_dpp v9, v0, v7 row_newbcast:7 row_mask:0xf bank_mask:0xf
    buffer_load_dwordx4 v[232:235], v9, s[32:35], 0 offen offset:0
    buffer_load_dwordx4 v[236:239], v9, s[32:35], 0 offen offset:256
    v_add_u32_dpp v9, v0, v7 row_newbcast:8 row_mask:0xf bank_mask:0xf
    buffer_load_dwordx4 v[240:243], v9, s[32:35], 0 offen offset:0
    buffer_load_dwordx4 v[244:247], v9, s[32:35], 0 offen offset:256
    s_waitcnt lgkmcnt(4)
    s_mov_b64 exec, s[48:49]
    ds_write_b16 v80, v64
    s_mov_b64 exec, s[50:51]
    ds_write_b16 v81, v65
    s_mov_b64 exec, s[52:53]
    ds_write_b16 v82, v66
    s_mov_b64 exec, s[54:55]
    ds_write_b16 v83, v67
    s_waitcnt lgkmcnt(4)
    s_mov_b64 exec, s[56:57]
    ds_write_b16 v84, v68
    s_mov_b64 exec, s[58:59]
    ds_write_b16 v85, v69
    s_mov_b64 exec, s[60:61]
    ds_write_b16 v86, v70
    s_mov_b64 exec, s[62:63]
    ds_write_b16 v87, v71
    s_not_b64 exec, s[72:73]
    s_cbranch_scc0 L_secdone_17
    s_waitcnt vmcnt(4)
L_sec_16:
    v_xor_b32 v72, s44, v56
    v_xor_b32 v73, s45, v57
    v_xor_b32 v74, s46, v58
    v_xor_b32 v75, s47, v59
    v_or3_b32 v40, v72, v73, v74
    v_or_b32 v40, v40, v75
    v_cmp_le_u32 vcc, 0x400000, v40
    s_cbranch_vccnz L_retry_19
    v_and_b32 v40, 2031616, v75
    v_cmp_eq_u32 vcc, 2031616, v40
    v_cmp_gt_u32 s[64:65], s16, v72
    v_lshlrev_b32_sdwa v88, 2, v72 dst_sel:DWORD dst_unused:UNUSED_PAD src0_sel:DWORD src1_sel:WORD_1
    v_cmp_gt_u32 s[66:67], s16, v73
    v_lshlrev_b32_sdwa v89, 2, v73 dst_sel:DWORD dst_unused:UNUSED_PAD src0_sel:DWORD src1_sel:WORD_1
    v_cmp_gt_u32 s[68:69], s16, v74
    v_lshlrev_b32_sdwa v90, 2, v74 dst_sel:DWORD dst_unused:UNUSED_PAD src0_sel:DWORD src1_sel:WORD_1
    v_cmp_gt_u32 s[70:71], s16, v75
    v_lshlrev_b32_sdwa v91, 2, v75 dst_sel:DWORD dst_unused:UNUSED_PAD src0_sel:DWORD src1_sel:WORD_1
    s_mov_b64 exec, s[64:65]
    ds_add_rtn_u32 v88, v88, v42 offset:128
    s_mov_b64 exec, s[66:67]
    ds_add_rtn_u32 v89, v89, v42 offset:128
    s_mov_b64 exec, s[68:69]
    ds_add_rtn_u32 v90, v90, v42 offset:128
    s_mov_b64 exec, s[70:71]
    ds_add_rtn_u32 v91, v91, v42 offset:128
    s_mov_b64 exec, vcc
    ds_write_b32 v5, v6 offset:20
    s_waitcnt lgkmcnt(0)
    s_mov_b64 exec, s[64:65]
    ds_write_b16 v88, v72
    s_mov_b64 exec, s[66:67]
    ds_write_b16 v89, v73
    s_mov_b64 exec, s[68:69]
    ds_write_b16 v90, v74
    s_mov_b64 exec, s[70:71]
    ds_write_b16 v91, v75
L_secdone_17:
    s_not_b64 exec, s[74:75]
    s_cbranch_scc0 L_secdone_21
    s_waitcnt vmcnt(4)
L_sec_20:
    v_xor_b32 v76, s44, v60
    v_xor_b32 v77, s45, v61
    v_xor_b32 v78, s46, v62
    v_xor_b32 v79, s47, v63
    v_or3_b32 v40, v76, v77, v78
    v_or_b32 v40, v40, v79
    v_cmp_le_u32 vcc, 0x400000, v40
    s_cbranch_vccnz L_retry_23
    v_and_b32 v40, 2031616, v79
    v_cmp_eq_u32 vcc, 2031616, v40
    v_cmp_gt_u32 s[64:65], s16, v76
    v_lshlrev_b32_sdwa v92, 2, v76 dst_sel:DWORD dst_unused:UNUSED_PAD src0_sel:DWORD src1_sel:WORD_1
    v_cmp_gt_u32 s[66:67], s16, v77
    v_lshlrev_b32_sdwa v93, 2, v77 dst_sel:DWORD dst_unused:UNUSED_PAD src0_sel:DWORD src1_sel:WORD_1
    v_cmp_gt_u32 s[68:69], s16, v78
    v_lshlrev_b32_sdwa v94, 2, v78 dst_sel:DWORD dst_unused:UNUSED_PAD src0_sel:DWORD src1_sel:WORD_1
    v_cmp_gt_u32 s[70:71], s16, v79
    v_lshlrev_b32_sdwa v95, 2, v79 dst_sel:DWORD dst_unused:UNUSED_PAD src0_sel:DWORD src1_sel:WORD_1
    s_mov_b64 exec, s[64:65]
    ds_add_rtn_u32 v92, v92, v42 offset:128
    s_mov_b64 exec, s[66:67]
    ds_add_rtn_u32 v93, v93, v42 offset:128
    s_mov_b64 exec, s[68:69]
    ds_add_rtn_u32 v94, v94, v42 offset:128
    s_mov_b64 exec, s[70:71]
    ds_add_rtn_u32 v95, v95, v42 offset:128
    s_mov_b64 exec, vcc
    ds_write_b32 v5, v6 offset:20
    s_waitcnt lgkmcnt(0)
    s_mov_b64 exec, s[64:65]
    ds_write_b16 v92, v76
    s_mov_b64 exec, s[66:67]
    ds_write_b16 v93, v77
    s_mov_b64 exec, s[68:69]
    ds_write_b16 v94, v78
    s_mov_b64 exec, s[70:71]
    ds_write_b16 v95, v79
L_secdone_21:
    s_waitcnt lgkmcnt(0)
    s_mov_b64 exec, 1
    ds_add_u32 v5, v6 offset:16
    s_mov_b64 exec, -1
    v_add_u32_dpp v9, v0, v7 row_newbcast:9 row_mask:0xf bank_mask:0xf
    buffer_load_dwordx4 v[248:251], v9, s[32:35], 0 offen offset:0
    buffer_load_dwordx4 v[252:255], v9, s[32:35], 0 offen offset:256
    s_lshl_b32 s20, s31, 1
    s_add_u32 s21, s20, 1
    s_add_u32 s22, s20, 8
    s_add_u32 s23, s20, 9
    s_add_u32 s24, s31, 16
    v_add_u32 v47, -1, v3
    v_bfe_u32 v40, v47, 1, 1
    v_and_b32 v41, 1, v47
    v_lshl_add_u32 v40, v40, 3, v41
    v_add_u32 v40, s20, v40
    v_mov_b32 v41, s24
    v_cmp_ne_u32 vcc, 0, v3
    v_min_u32 v47, 19, v2
    v_mul_u32_u24 v46, 264, v47
    v_cndmask_b32 v40, v41, v40, vcc
    v_mul_u32_u24 v41, 264, v40
    v_add_u32 v41, 148480, v41
    v_lshlrev_b32 v40, 2, v40
    v_add_u32 v46, 148728, v46
    v_lshlrev_b32 v47, 2, v47
    v_lshlrev_b32 v43, 3, v3
    v_lshl_add_u32 v43, v4, 1, v43
L_spin_24:
    ds_read_b32 v44, v5 offset:16
    s_waitcnt lgkmcnt(0)
    v_readfirstlane_b32 s101, v44
    s_cmp_ge_u32 s101, 4
    s_cbranch_scc0 L_retry_25
    ds_read_b32 v44, v40 offset:128
    ds_read_b32 v47, v47 offset:128
    ds_read_b32 v45, v5 offset:20
    s_waitcnt lgkmcnt(2)
    v_sub_u32 v44, v44, v41
    v_max_u32 v44, 18, v44
    s_waitcnt lgkmcnt(0)
    v_cmp_gt_u32 vcc, v47, v46
    v_add_u32_dpp v48, v44, v44 row_shr:1 row_mask:0xf bank_mask:0xf bound_ctrl:1
    v_readfirstlane_b32 s25, v45
    s_or_b32 s64, vcc_lo, vcc_hi
    v_add_u32_dpp v48, v48, v48 row_shr:2 row_mask:0xf bank_mask:0xf bound_ctrl:1
    s_or_b32 s25, s25, s64
    s_mov_b32 s53, 0
    v_add_u32_dpp v48, v48, v48 row_shr:4 row_mask:0xf bank_mask:0xf bound_ctrl:1
    v_sub_u32 v44, v48, v44
    v_sub_u32 v44, v41, v44
    v_readlane_b32 s10, v48, 0
    v_readlane_b32 s11, v48, 1
    v_readlane_b32 s12, v48, 2
    v_readlane_b32 s13, v48, 3
    v_readlane_b32 s14, v48, 4
    v_add_u32_dpp v160, v44, v43 row_newbcast:0 row_mask:0xf bank_mask:0xf
    v_add_u32_dpp v161, v44, v43 row_newbcast:1 row_mask:0xf bank_mask:0xf
    v_add_u32_dpp v162, v44, v43 row_newbcast:2 row_mask:0xf bank_mask:0xf
    v_add_u32_dpp v163, v44, v43 row_newbcast:3 row_mask:0xf bank_mask:0xf
    v_add_u32_dpp v164, v44, v43 row_newbcast:4 row_mask:0xf bank_mask:0xf
    s_add_u32 s50, s14, 14
    s_lshr_b32 s50, s50, 4
    s_cmp_gt_u32 s50, 32
    s_cselect_b32 s25, 1, s25
    s_max_u32 s50, s50, 12
    v_add_u32 v40, 0, v43
    v_cmp_le_u32 s[64:65], s10, v40
    v_cmp_le_u32 s[66:67], s11, v40
    v_cmp_le_u32 s[68:69], s12, v40
    v_cmp_le_u32 s[70:71], s13, v40
    v_cndmask_b32 v40, v160, v161, s[64:65]
    v_cndmask_b32 v40, v40, v162, s[66:67]
    v_cndmask_b32 v40, v40, v163, s[68:69]
    v_cndmask_b32 v40, v40, v164, s[70:71]
    ds_read_u16 v40, v40 offset:0
    v_add_u32 v41, 128, v43
    v_cmp_le_u32 s[64:65], s10, v41
    v_cmp_le_u32 s[66:67], s11, v41
    v_cmp_le_u32 s[68:69], s12, v41
    v_cmp_le_u32 s[70:71], s13, v41
    v_cndmask_b32 v41, v160, v161, s[64:65]
    v_cndmask_b32 v41, v41, v162, s[66:67]
    v_cndmask_b32 v41, v41, v163, s[68:69]
    v_cndmask_b32 v41, v41, v164, s[70:71]
    ds_read_u16 v41, v41 offset:128
    v_add_u32 v42, 256, v43
    v_cmp_le_u32 s[64:65], s10, v42
    v_cmp_le_u32 s[66:67], s11, v42
    v_cmp_le_u32 s[68:69], s12, v42
    v_cmp_le_u32 s[70:71], s13, v42
    v_cndmask_b32 v42, v160, v161, s[64:65]
    v_cndmask_b32 v42, v42, v162, s[66:67]
    v_cndmask_b32 v42, v42, v163, s[68:69]
    v_cndmask_b32 v42, v42, v164, s[70:71]
    ds_read_u16 v42, v42 offset:256
    v_add_u32 v43, 384, v43
    v_cmp_le_u32 s[64:65], s10, v43
    v_cmp_le_u32 s[66:67], s11, v43
    v_cmp_le_u32 s[68:69], s12, v43
    v_cmp_le_u32 s[70:71], s13, v43
    v_cndmask_b32 v43, v160, v161, s[64:65]
    v_cndmask_b32 v43, v43, v162, s[66:67]
    v_cndmask_b32 v43, v43, v163, s[68:69]
    v_cndmask_b32 v43, v43, v164, s[70:71]
    ds_read_u16 v43, v43 offset:384
    s_waitcnt lgkmcnt(3)
    v_and_b32 v32, 0x7ffe, v40
    ds_read_u16 v33, v32 offset:62464
    v_lshlrev_b32 v32, 8, v32
    v_lshlrev_b32 v40, 4, v40
    s_waitcnt lgkmcnt(3)
    v_and_b32 v34, 0x7ffe, v41
    ds_read_u16 v35, v34 offset:62464
    v_lshlrev_b32 v34, 8, v34
    v_lshlrev_b32 v41, 4, v41
    s_waitcnt lgkmcnt(3)
    v_and_b32 v36, 0x7ffe, v42
    ds_read_u16 v37, v36 offset:62464
    v_lshlrev_b32 v36, 8, v36
    v_lshlrev_b32 v42, 4, v42
    s_waitcnt lgkmcnt(3)
    v_and_b32 v38, 0x7ffe, v43
    ds_read_u16 v39, v38 offset:62464
    v_lshlrev_b32 v38, 8, v38
    v_lshlrev_b32 v43, 4, v43
    v_add_u32_dpp v11, v32, v7 row_newbcast:0 row_mask:0xf bank_mask:0xf
    buffer_load_dwordx4 v[48:51], v11, s[32:35], 0 offen offset:0
    buffer_load_dwordx4 v[56:59], v11, s[32:35], 0 offen offset:256
    v_add_u32_dpp v11, v32, v7 row_newbcast:1 row_mask:0xf bank_mask:0xf
    buffer_load_dwordx4 v[52:55], v11, s[32:35], 0 offen offset:0
    buffer_load_dwordx4 v[60:63], v11, s[32:35], 0 offen offset:256
    v_add_u32_dpp v11, v32, v7 row_newbcast:2 row_mask:0xf bank_mask:0xf
    buffer_load_dwordx4 v[64:67], v11, s[32:35], 0 offen offset:0
    buffer_load_dwordx4 v[72:75], v11, s[32:35], 0 offen offset:256
    v_add_u32_dpp v11, v32, v7 row_newbcast:3 row_mask:0xf bank_mask:0xf
    buffer_load_dwordx4 v[68:71], v11, s[32:35], 0 offen offset:0
    buffer_load_dwordx4 v[76:79], v11, s[32:35], 0 offen offset:256
    v_add_u32_dpp v11, v32, v7 row_newbcast:4 row_mask:0xf bank_mask:0xf
    buffer_load_dwordx4 v[80:83], v11, s[32:35], 0 offen offset:0
    buffer_load_dwordx4 v[88:91], v11, s[32:35], 0 offen offset:256
    v_add_u32_dpp v11, v32, v7 row_newbcast:5 row_mask:0xf bank_mask:0xf
    buffer_load_dwordx4 v[84:87], v11, s[32:35], 0 offen offset:0
    buffer_load_dwordx4 v[92:95], v11, s[32:35], 0 offen offset:256
    s_mov_b32 s57, 0
    s_sub_u32 s64, s14, 18
    s_lshr_b32 s65, s64, 4
    s_bitset1_b32 s53, s65
    s_and_b32 s64, s64, 14
    s_lshl4_add_u32 s57, s57, s64
    s_and_b32 s65, s24, 7
    s_lshl_b32 s65, s65, 5
    s_lshl_b32 s19, s24, 10
    s_or_b32 s19, s19, s65
    s_sub_u32 s64, s13, 18
    s_lshr_b32 s65, s64, 4
    s_bitset1_b32 s53, s65
    s_and_b32 s64, s64, 14
    s_lshl4_add_u32 s57, s57, s64
    s_and_b32 s65, s23, 7
    s_lshl_b32 s65, s65, 5
    s_lshl_b32 s18, s23, 10
    s_or_b32 s18, s18, s65
    s_sub_u32 s64, s12, 18
    s_lshr_b32 s65, s64, 4
    s_bitset1_b32 s53, s65
    s_and_b32 s64, s64, 14
    s_lshl4_add_u32 s57, s57, s64
    s_and_b32 s65, s22, 7
    s_lshl_b32 s65, s65, 5
    s_lshl_b32 s17, s22, 10
    s_or_b32 s17, s17, s65
    s_sub_u32 s64, s11, 18
    s_lshr_b32 s65, s64, 4
    s_bitset1_b32 s53, s65
    s_and_b32 s64, s64, 14
    s_lshl4_add_u32 s57, s57, s64
    s_and_b32 s65, s21, 7
    s_lshl_b32 s65, s65, 5
    s_lshl_b32 s16, s21, 10
    s_or_b32 s16, s16, s65
    s_sub_u32 s64, s10, 18
    s_lshr_b32 s65, s64, 4
    s_bitset1_b32 s53, s65
    s_and_b32 s64, s64, 14
    s_lshl4_add_u32 s57, s57, s64
    s_and_b32 s65, s20, 7
    s_lshl_b32 s65, s65, 5
    s_lshl_b32 s15, s20, 10
    s_or_b32 s15, s15, s65
    s_sub_u32 s64, s50, 5
    s_lshl_b32 s56, 1, s64
    s_or_b32 s52, s56, s53
    v_and_b32 v46, 1, v3
    v_lshl_add_u32 v46, v4, 1, v46
    v_and_b32 v46, 3, v46
    v_and_b32 v47, 14, v3
    v_lshl_add_u32 v46, v46, 4, v47
    v_lshrrev_b32 v47, 1, v4
    v_add_lshl_u32 v46, v46, v47, 2
    v_lshrrev_b32 v44, 1, v4
    v_mul_u32_u24 v44, 528, v44
    v_xor_b32 v44, v44, v7
    v_and_b32 v45, 1, v4
    v_lshl_or_b32 v2, v45, 3, v44
    v_xor_b32 v144, s15, v7
    v_xor_b32 v146, s16, v7
    v_xor_b32 v148, s19, v7
    v_xor_b32 v145, 528, v144
    v_xor_b32 v147, 528, v146
    v_xor_b32 v149, 528, v148
    s_mul_i32 s64, s1, 80
    s_add_u32 s64, s64, 62464
    v_and_b32 v45, 2, v4
    v_add_u32 v0, s64, v45
    s_getpc_b64 s[72:73]
L_anc:
    v_lshlrev_b32 v4, 2, v4
    s_mov_b32 s62, L_fp1-L_anc
    s_mov_b32 s63, L_fp1-L_fp0
    s_mov_b32 s70, L_dr1-L_anc
    s_mov_b32 s71, L_dr1-L_dr0
    s_mov_b32 s26, 0
    s_mov_b32 s49, 0
    v_mov_b32 v1, 0
    s_lshl_b32 s64, s31, 2
    v_mov_b32 v10, s64
    v_and_b32 v9, 8, v3
    v_lshlrev_b32 v9, 1, v9
    s_mov_b32 s66, 0x22222222
    s_mov_b32 s67, 0x22222222
    s_mov_b32 s68, 0x44444444
    s_mov_b32 s69, 0x44444444
    v_mov_b64 v[150:151], 0
    v_mov_b64 v[152:153], 0
    v_mov_b64 v[154:155], 0
    v_mov_b64 v[156:157], 0
    v_mov_b64 v[158:159], 0
    v_mov_b64 v[16:17], 0
    v_mov_b64 v[18:19], 0
    v_mov_b64 v[20:21], 0
    v_mov_b64 v[22:23], 0
    s_waitcnt lgkmcnt(0)
    v_lshlrev_b32 v33, v40, v33
    ds_bpermute_b32 v33, v46, v33
    v_lshlrev_b32 v35, v41, v35
    ds_bpermute_b32 v35, v46, v35
    v_lshlrev_b32 v37, v42, v37
    ds_bpermute_b32 v37, v46, v37
    v_lshlrev_b32 v39, v43, v39
    ds_bpermute_b32 v39, v46, v39
    s_waitcnt vmcnt(12) lgkmcnt(0)
    s_barrier
    ds_read_b128 v[160:163], v144 offset:21504
    ds_read_b128 v[164:167], v144 offset:21760
    ds_read_b128 v[168:171], v145 offset:21504
    ds_read_b128 v[172:175], v145 offset:21760
    s_waitcnt lgkmcnt(2)
    v_dot2c_f32_bf16 v150, v176, v160
    v_dot2c_f32_bf16 v150, v177, v161
    v_dot2c_f32_bf16 v150, v178, v162
    v_dot2c_f32_bf16 v150, v179, v163
    v_dot2c_f32_bf16 v150, v180, v164
    v_dot2c_f32_bf16 v150, v181, v165
    v_dot2c_f32_bf16 v150, v182, v166
    v_dot2c_f32_bf16 v150, v183, v167
    ds_read_b128 v[160:163], v146 offset:21504
    ds_read_b128 v[164:167], v146 offset:21760
    s_waitcnt lgkmcnt(2)
    v_dot2c_f32_bf16 v151, v184, v168
    v_dot2c_f32_bf16 v151, v185, v169
    v_dot2c_f32_bf16 v151, v186, v170
    v_dot2c_f32_bf16 v151, v187, v171
    v_dot2c_f32_bf16 v151, v188, v172
    v_dot2c_f32_bf16 v151, v189, v173
    v_dot2c_f32_bf16 v151, v190, v174
    v_dot2c_f32_bf16 v151, v191, v175
    ds_read_b128 v[168:171], v147 offset:21504
    ds_read_b128 v[172:175], v147 offset:21760
    s_waitcnt lgkmcnt(2)
    v_dot2c_f32_bf16 v152, v192, v160
    v_dot2c_f32_bf16 v152, v193, v161
    v_dot2c_f32_bf16 v152, v194, v162
    v_dot2c_f32_bf16 v152, v195, v163
    v_dot2c_f32_bf16 v152, v196, v164
    v_dot2c_f32_bf16 v152, v197, v165
    v_dot2c_f32_bf16 v152, v198, v166
    v_dot2c_f32_bf16 v152, v199, v167
    v_add_f32_dpp v150, v150, v150 row_ror:8 row_mask:0xf bank_mask:0x3
    v_add_f32_dpp v150, v151, v151 row_ror:8 row_mask:0xf bank_mask:0xc
    ds_read_b128 v[160:163], v144 offset:29696
    ds_read_b128 v[164:167], v144 offset:29952
    s_waitcnt lgkmcnt(2)
    v_dot2c_f32_bf16 v153, v200, v168
    v_dot2c_f32_bf16 v153, v201, v169
    v_dot2c_f32_bf16 v153, v202, v170
    v_dot2c_f32_bf16 v153, v203, v171
    v_dot2c_f32_bf16 v153, v204, v172
    v_dot2c_f32_bf16 v153, v205, v173
    v_dot2c_f32_bf16 v153, v206, v174
    v_dot2c_f32_bf16 v153, v207, v175
    ds_read_b128 v[168:171], v145 offset:29696
    ds_read_b128 v[172:175], v145 offset:29952
    s_waitcnt lgkmcnt(2)
    v_dot2c_f32_bf16 v154, v208, v160
    v_dot2c_f32_bf16 v154, v209, v161
    v_dot2c_f32_bf16 v154, v210, v162
    v_dot2c_f32_bf16 v154, v211, v163
    v_dot2c_f32_bf16 v154, v212, v164
    v_dot2c_f32_bf16 v154, v213, v165
    v_dot2c_f32_bf16 v154, v214, v166
    v_dot2c_f32_bf16 v154, v215, v167
    v_add_f32_dpp v152, v152, v152 row_ror:8 row_mask:0xf bank_mask:0x3
    v_add_f32_dpp v152, v153, v153 row_ror:8 row_mask:0xf bank_mask:0xc
    v_add_u32_dpp v11, v32, v7 row_newbcast:6 row_mask:0xf bank_mask:0xf
    buffer_load_dwordx4 v[96:99], v11, s[32:35], 0 offen offset:0
    buffer_load_dwordx4 v[104:107], v11, s[32:35], 0 offen offset:256
    ds_read_b128 v[160:163], v146 offset:29696
    ds_read_b128 v[164:167], v146 offset:29952
    s_waitcnt lgkmcnt(2)
    v_dot2c_f32_bf16 v155, v216, v168
    v_dot2c_f32_bf16 v155, v217, v169
    v_dot2c_f32_bf16 v155, v218, v170
    v_dot2c_f32_bf16 v155, v219, v171
    v_dot2c_f32_bf16 v155, v220, v172
    v_dot2c_f32_bf16 v155, v221, v173
    v_dot2c_f32_bf16 v155, v222, v174
    v_dot2c_f32_bf16 v155, v223, v175
    v_add_f32_dpp v150, v150, v150 row_half_mirror row_mask:0xf bank_mask:0x5
    v_add_f32_dpp v150, v152, v152 row_half_mirror row_mask:0xf bank_mask:0xa
    v_add_u32_dpp v11, v32, v7 row_newbcast:7 row_mask:0xf bank_mask:0xf
    buffer_load_dwordx4 v[100:103], v11, s[32:35], 0 offen offset:0
    buffer_load_dwordx4 v[108:111], v11, s[32:35], 0 offen offset:256
    ds_read_b128 v[168:171], v147 offset:29696
    ds_read_b128 v[172:175], v147 offset:29952
    s_waitcnt lgkmcnt(2)
    v_dot2c_f32_bf16 v156, v224, v160
    v_dot2c_f32_bf16 v156, v225, v161
    v_dot2c_f32_bf16 v156, v226, v162
    v_dot2c_f32_bf16 v156, v227, v163
    v_dot2c_f32_bf16 v156, v228, v164
    v_dot2c_f32_bf16 v156, v229, v165
    v_dot2c_f32_bf16 v156, v230, v166
    v_dot2c_f32_bf16 v156, v231, v167
    v_add_f32_dpp v154, v154, v154 row_ror:8 row_mask:0xf bank_mask:0x3
    v_add_f32_dpp v154, v155, v155 row_ror:8 row_mask:0xf bank_mask:0xc
    v_add_u32_dpp v11, v32, v7 row_newbcast:8 row_mask:0xf bank_mask:0xf
    buffer_load_dwordx4 v[112:115], v11, s[32:35], 0 offen offset:0
    buffer_load_dwordx4 v[120:123], v11, s[32:35], 0 offen offset:256
    ds_read_b128 v[160:163], v148 offset:21504
    ds_read_b128 v[164:167], v148 offset:21760
    s_waitcnt lgkmcnt(2)
    v_dot2c_f32_bf16 v157, v232, v168
    v_dot2c_f32_bf16 v157, v233, v169
    v_dot2c_f32_bf16 v157, v234, v170
    v_dot2c_f32_bf16 v157, v235, v171
    v_dot2c_f32_bf16 v157, v236, v172
    v_dot2c_f32_bf16 v157, v237, v173
    v_dot2c_f32_bf16 v157, v238, v174
    v_dot2c_f32_bf16 v157, v239, v175
    v_add_u32_dpp v11, v32, v7 row_newbcast:9 row_mask:0xf bank_mask:0xf
    buffer_load_dwordx4 v[116:119], v11, s[32:35], 0 offen offset:0
    buffer_load_dwordx4 v[124:127], v11, s[32:35], 0 offen offset:256
    ds_read_b128 v[168:171], v149 offset:21504
    ds_read_b128 v[172:175], v149 offset:21760
    s_waitcnt lgkmcnt(2)
    v_dot2c_f32_bf16 v158, v240, v160
    v_dot2c_f32_bf16 v158, v241, v161
    v_dot2c_f32_bf16 v158, v242, v162
    v_dot2c_f32_bf16 v158, v243, v163
    v_dot2c_f32_bf16 v158, v244, v164
    v_dot2c_f32_bf16 v158, v245, v165
    v_dot2c_f32_bf16 v158, v246, v166
    v_dot2c_f32_bf16 v158, v247, v167
    v_add_f32_dpp v156, v156, v156 row_ror:8 row_mask:0xf bank_mask:0x3
    v_add_f32_dpp v156, v157, v157 row_ror:8 row_mask:0xf bank_mask:0xc
    v_add_u32_dpp v11, v32, v7 row_newbcast:10 row_mask:0xf bank_mask:0xf
    buffer_load_dwordx4 v[128:131], v11, s[32:35], 0 offen offset:0
    buffer_load_dwordx4 v[136:139], v11, s[32:35], 0 offen offset:256
    s_waitcnt lgkmcnt(0)
    v_dot2c_f32_bf16 v159, v248, v168
    v_dot2c_f32_bf16 v159, v249, v169
    v_dot2c_f32_bf16 v159, v250, v170
    v_dot2c_f32_bf16 v159, v251, v171
    v_dot2c_f32_bf16 v159, v252, v172
    v_dot2c_f32_bf16 v159, v253, v173
    v_dot2c_f32_bf16 v159, v254, v174
    v_dot2c_f32_bf16 v159, v255, v175
    v_add_f32_dpp v154, v154, v154 row_half_mirror row_mask:0xf bank_mask:0x5
    v_add_f32_dpp v154, v156, v156 row_half_mirror row_mask:0xf bank_mask:0xa
    v_add_u32_dpp v11, v32, v7 row_newbcast:11 row_mask:0xf bank_mask:0xf
    buffer_load_dwordx4 v[132:135], v11, s[32:35], 0 offen offset:0
    buffer_load_dwordx4 v[140:143], v11, s[32:35], 0 offen offset:256
    v_add_f32_dpp v150, v150, v150 quad_perm:[1,0,3,2] row_mask:0xf bank_mask:0xf
    s_nop 0
    v_add_f32_dpp v158, v158, v158 row_ror:8 row_mask:0xf bank_mask:0x3
    v_add_f32_dpp v158, v159, v159 row_ror:8 row_mask:0xf bank_mask:0xc
    v_add_f32_dpp v154, v154, v154 quad_perm:[1,0,3,2] row_mask:0xf bank_mask:0xf
    v_add_f32_dpp v150, v150, v150 quad_perm:[2,3,0,1] row_mask:0xf bank_mask:0xf
    v_add_f32_dpp v158, v158, v158 row_half_mirror row_mask:0xf bank_mask:0x5
    v_add_f32_dpp v154, v154, v154 quad_perm:[2,3,0,1] row_mask:0xf bank_mask:0xf
    s_nop 0
    v_add_f32_dpp v158, v158, v158 quad_perm:[1,0,3,2] row_mask:0xf bank_mask:0xf
    v_cndmask_b32 v150, v150, v154, s[66:67]
    s_nop 0
    v_add_f32_dpp v158, v158, v158 quad_perm:[2,3,0,1] row_mask:0xf bank_mask:0xf
    v_cndmask_b32 v150, v150, v158, s[68:69]
    v_mul_f32 v150, 0x3db8aa3b, v150
    v_exp_f32 v150, v150
    s_nop 0
    v_mov_b32 v44, v150
    v_mov_b32 v45, v150
    s_nop 1
    v_permlane32_swap_b32 v44, v45
    v_add_f32 v44, v44, v45
    v_mov_b32 v45, v44
    s_nop 1
    v_permlane16_swap_b32 v44, v45
    v_add_f32 v44, v44, v45
    v_add_f32 v44, 0x3089705f, v44
    v_rcp_f32 v44, v44
    s_nop 0
    v_mul_f32 v150, v150, v44
    v_cvt_pk_bf16_f32 v150, v150, 0
    v_lshlrev_b32 v8, v9, v150
    s_nop 1
    v_and_b32_dpp v24, v8, v12 row_newbcast:0 row_mask:0xf bank_mask:0xf
    v_and_b32_dpp v25, v8, v13 row_newbcast:0 row_mask:0xf bank_mask:0xf
    v_mov_b64 v[40:41], 0
    v_mov_b64 v[42:43], 0
    v_mov_b64 v[44:45], 0
    v_mov_b64 v[46:47], 0
    v_smfmac_f32_16x16x32_bf16 v[40:43], v[24:25], v[176:179], v14
    v_and_b32_dpp v28, v8, v12 row_newbcast:8 row_mask:0xf bank_mask:0xf
    v_and_b32_dpp v29, v8, v13 row_newbcast:8 row_mask:0xf bank_mask:0xf
    v_smfmac_f32_16x16x32_bf16 v[44:47], v[24:25], v[180:183], v14
    v_add_u32_dpp v11, v32, v7 row_newbcast:12 row_mask:0xf bank_mask:0xf
    buffer_load_dwordx4 v[144:147], v11, s[32:35], 0 offen offset:0
    buffer_load_dwordx4 v[152:155], v11, s[32:35], 0 offen offset:256
    v_smfmac_f32_16x16x32_bf16 v[40:43], v[28:29], v[184:187], v14
    v_and_b32_dpp v24, v8, v12 row_newbcast:4 row_mask:0xf bank_mask:0xf
    v_and_b32_dpp v25, v8, v13 row_newbcast:4 row_mask:0xf bank_mask:0xf
    v_smfmac_f32_16x16x32_bf16 v[44:47], v[28:29], v[188:191], v14
    s_nop 0
    v_smfmac_f32_16x16x32_bf16 v[16:19], v[24:25], v[192:195], v14
    v_and_b32_dpp v28, v8, v12 row_newbcast:12 row_mask:0xf bank_mask:0xf
    v_and_b32_dpp v29, v8, v13 row_newbcast:12 row_mask:0xf bank_mask:0xf
    v_smfmac_f32_16x16x32_bf16 v[20:23], v[24:25], v[196:199], v14
    v_add_u32_dpp v11, v32, v7 row_newbcast:13 row_mask:0xf bank_mask:0xf
    buffer_load_dwordx4 v[148:151], v11, s[32:35], 0 offen offset:0
    buffer_load_dwordx4 v[156:159], v11, s[32:35], 0 offen offset:256
    v_smfmac_f32_16x16x32_bf16 v[16:19], v[28:29], v[200:203], v14
    v_and_b32_dpp v24, v8, v12 row_newbcast:1 row_mask:0xf bank_mask:0xf
    v_and_b32_dpp v25, v8, v13 row_newbcast:1 row_mask:0xf bank_mask:0xf
    v_smfmac_f32_16x16x32_bf16 v[20:23], v[28:29], v[204:207], v14
    v_xor_b32 v178, s15, v2
    s_lshl_b32 s64, s20, 2
    v_add_u32 v9, s64, v0
    v_mov_b32 v179, 0
    v_cvt_pk_bf16_f32 v30, v40, v41
    v_cvt_pk_bf16_f32 v31, v42, v43
    ds_write_b64 v178, v[30:31] offset:1024
    v_cvt_pk_bf16_f32 v30, v44, v45
    v_cvt_pk_bf16_f32 v31, v46, v47
    ds_write_b64 v178, v[30:31] offset:1280
    ds_read_u16_d16_hi v179, v9
    v_mov_b64 v[40:41], 0
    v_mov_b64 v[42:43], 0
    v_mov_b64 v[44:45], 0
    v_mov_b64 v[46:47], 0
    s_nop 0
    v_smfmac_f32_16x16x32_bf16 v[40:43], v[24:25], v[208:211], v14
    v_and_b32_dpp v28, v8, v12 row_newbcast:9 row_mask:0xf bank_mask:0xf
    v_and_b32_dpp v29, v8, v13 row_newbcast:9 row_mask:0xf bank_mask:0xf
    v_smfmac_f32_16x16x32_bf16 v[44:47], v[24:25], v[212:215], v14
    v_add_u32_dpp v11, v32, v7 row_newbcast:14 row_mask:0xf bank_mask:0xf
    buffer_load_dwordx4 v[160:163], v11, s[32:35], 0 offen offset:0
    buffer_load_dwordx4 v[168:171], v11, s[32:35], 0 offen offset:256
    v_smfmac_f32_16x16x32_bf16 v[40:43], v[28:29], v[216:219], v14
    v_and_b32_dpp v24, v8, v12 row_newbcast:5 row_mask:0xf bank_mask:0xf
    v_and_b32_dpp v25, v8, v13 row_newbcast:5 row_mask:0xf bank_mask:0xf
    v_smfmac_f32_16x16x32_bf16 v[44:47], v[28:29], v[220:223], v14
    v_xor_b32 v180, s16, v2
    s_lshl_b32 s64, s21, 2
    v_add_u32 v9, s64, v0
    v_mov_b32 v181, 0
    v_cvt_pk_bf16_f32 v30, v16, v17
    v_cvt_pk_bf16_f32 v31, v18, v19
    ds_write_b64 v180, v[30:31] offset:1024
    v_cvt_pk_bf16_f32 v30, v20, v21
    v_cvt_pk_bf16_f32 v31, v22, v23
    ds_write_b64 v180, v[30:31] offset:1280
    ds_read_u16_d16_hi v181, v9
    v_mov_b64 v[16:17], 0
    v_mov_b64 v[18:19], 0
    v_mov_b64 v[20:21], 0
    v_mov_b64 v[22:23], 0
    s_nop 0
    v_smfmac_f32_16x16x32_bf16 v[16:19], v[24:25], v[224:227], v14
    v_and_b32_dpp v28, v8, v12 row_newbcast:13 row_mask:0xf bank_mask:0xf
    v_and_b32_dpp v29, v8, v13 row_newbcast:13 row_mask:0xf bank_mask:0xf
    v_smfmac_f32_16x16x32_bf16 v[20:23], v[24:25], v[228:231], v14
    v_add_u32_dpp v11, v32, v7 row_newbcast:15 row_mask:0xf bank_mask:0xf
    buffer_load_dwordx4 v[164:167], v11, s[32:35], 0 offen offset:0
    buffer_load_dwordx4 v[172:175], v11, s[32:35], 0 offen offset:256
    v_smfmac_f32_16x16x32_bf16 v[16:19], v[28:29], v[232:235], v14
    v_and_b32_dpp v24, v8, v12 row_newbcast:2 row_mask:0xf bank_mask:0xf
    v_and_b32_dpp v25, v8, v13 row_newbcast:2 row_mask:0xf bank_mask:0xf
    v_smfmac_f32_16x16x32_bf16 v[20:23], v[28:29], v[236:239], v14
    v_xor_b32 v182, s17, v2
    s_lshl_b32 s64, s22, 2
    v_add_u32 v9, s64, v0
    v_mov_b32 v183, 0
    v_cvt_pk_bf16_f32 v30, v40, v41
    v_cvt_pk_bf16_f32 v31, v42, v43
    ds_write_b64 v182, v[30:31] offset:1024
    v_cvt_pk_bf16_f32 v30, v44, v45
    v_cvt_pk_bf16_f32 v31, v46, v47
    ds_write_b64 v182, v[30:31] offset:1280
    ds_read_u16_d16_hi v183, v9
    v_mov_b64 v[40:41], 0
    v_mov_b64 v[42:43], 0
    v_mov_b64 v[44:45], 0
    v_mov_b64 v[46:47], 0
    s_nop 0
    v_smfmac_f32_16x16x32_bf16 v[40:43], v[24:25], v[240:243], v14
    v_and_b32_dpp v28, v8, v12 row_newbcast:10 row_mask:0xf bank_mask:0xf
    v_and_b32_dpp v29, v8, v13 row_newbcast:10 row_mask:0xf bank_mask:0xf
    v_smfmac_f32_16x16x32_bf16 v[44:47], v[24:25], v[244:247], v14
    s_nop 0
    v_smfmac_f32_16x16x32_bf16 v[40:43], v[28:29], v[248:251], v14
    v_and_b32_dpp v24, v33, v12 row_newbcast:0 row_mask:0xf bank_mask:0xf
    v_and_b32_dpp v25, v33, v13 row_newbcast:0 row_mask:0xf bank_mask:0xf
    v_and_b32_dpp v26, v33, v12 row_newbcast:1 row_mask:0xf bank_mask:0xf
    v_and_b32_dpp v27, v33, v13 row_newbcast:1 row_mask:0xf bank_mask:0xf
    v_smfmac_f32_16x16x32_bf16 v[44:47], v[28:29], v[252:255], v14
    v_xor_b32 v184, s18, v2
    s_lshl_b32 s64, s23, 2
    v_add_u32 v9, s64, v0
    v_mov_b32 v185, 0
    v_cvt_pk_bf16_f32 v30, v16, v17
    v_cvt_pk_bf16_f32 v31, v18, v19
    ds_write_b64 v184, v[30:31] offset:1024
    v_cvt_pk_bf16_f32 v30, v20, v21
    v_cvt_pk_bf16_f32 v31, v22, v23
    ds_write_b64 v184, v[30:31] offset:1280
    ds_read_u16_d16_hi v185, v9
    v_mov_b64 v[16:17], 0
    v_mov_b64 v[18:19], 0
    v_mov_b64 v[20:21], 0
    v_mov_b64 v[22:23], 0
    s_nop 0
    v_xor_b32 v176, s19, v2
    s_lshl_b32 s64, s24, 2
    v_add_u32 v9, s64, v0
    v_mov_b32 v177, 0
    v_cvt_pk_bf16_f32 v30, v40, v41
    v_cvt_pk_bf16_f32 v31, v42, v43
    ds_write_b64 v176, v[30:31] offset:1024
    v_cvt_pk_bf16_f32 v30, v44, v45
    v_cvt_pk_bf16_f32 v31, v46, v47
    ds_write_b64 v176, v[30:31] offset:1280
    ds_read_u16_d16_hi v177, v9
    s_waitcnt lgkmcnt(0)
    s_barrier
    s_cmp_lg_u32 s25, 0
    s_cbranch_scc1 L_slow
L_fp0:
    s_bitcmp1_b32 s52, 0
    s_waitcnt vmcnt(28)
    v_smfmac_f32_16x16x64_bf16 v[16:19], v[24:27], v[48:55], v14
    v_and_b32_dpp v28, v33, v12 row_newbcast:2 row_mask:0xf bank_mask:0xf
    v_and_b32_dpp v29, v33, v13 row_newbcast:2 row_mask:0xf bank_mask:0xf
    v_smfmac_f32_16x16x64_bf16 v[20:23], v[24:27], v[56:63], v14
    v_and_b32_dpp v30, v33, v12 row_newbcast:3 row_mask:0xf bank_mask:0xf
    v_and_b32_dpp v31, v33, v13 row_newbcast:3 row_mask:0xf bank_mask:0xf
    v_add_u32_dpp v11, v34, v7 row_newbcast:0 row_mask:0xf bank_mask:0xf
    buffer_load_dwordx4 v[48:51], v11, s[32:35], 0 offen offset:0
    buffer_load_dwordx4 v[56:59], v11, s[32:35], 0 offen offset:256
    s_cbranch_scc1 L_ev0
L_fp1:
    s_bitcmp1_b32 s52, 1
    s_waitcnt vmcnt(26)
    v_smfmac_f32_16x16x64_bf16 v[16:19], v[28:31], v[64:71], v14
    v_and_b32_dpp v24, v33, v12 row_newbcast:4 row_mask:0xf bank_mask:0xf
    v_and_b32_dpp v25, v33, v13 row_newbcast:4 row_mask:0xf bank_mask:0xf
    v_smfmac_f32_16x16x64_bf16 v[20:23], v[28:31], v[72:79], v14
    v_and_b32_dpp v26, v33, v12 row_newbcast:5 row_mask:0xf bank_mask:0xf
    v_and_b32_dpp v27, v33, v13 row_newbcast:5 row_mask:0xf bank_mask:0xf
    v_add_u32_dpp v11, v34, v7 row_newbcast:1 row_mask:0xf bank_mask:0xf
    buffer_load_dwordx4 v[52:55], v11, s[32:35], 0 offen offset:0
    buffer_load_dwordx4 v[60:63], v11, s[32:35], 0 offen offset:256
    s_cbranch_scc1 L_ev1
L_fp2:
    s_bitcmp1_b32 s52, 2
    s_waitcnt vmcnt(24)
    v_smfmac_f32_16x16x64_bf16 v[16:19], v[24:27], v[80:87], v14
    v_and_b32_dpp v28, v33, v12 row_newbcast:6 row_mask:0xf bank_mask:0xf
    v_and_b32_dpp v29, v33, v13 row_newbcast:6 row_mask:0xf bank_mask:0xf
    v_smfmac_f32_16x16x64_bf16 v[20:23], v[24:27], v[88:95], v14
    v_and_b32_dpp v30, v33, v12 row_newbcast:7 row_mask:0xf bank_mask:0xf
    v_and_b32_dpp v31, v33, v13 row_newbcast:7 row_mask:0xf bank_mask:0xf
    v_add_u32_dpp v11, v34, v7 row_newbcast:2 row_mask:0xf bank_mask:0xf
    buffer_load_dwordx4 v[64:67], v11, s[32:35], 0 offen offset:0
    buffer_load_dwordx4 v[72:75], v11, s[32:35], 0 offen offset:256
    s_cbranch_scc1 L_ev2
L_fp3:
    s_bitcmp1_b32 s52, 3
    s_waitcnt vmcnt(22)
    v_smfmac_f32_16x16x64_bf16 v[16:19], v[28:31], v[96:103], v14
    v_and_b32_dpp v24, v33, v12 row_newbcast:8 row_mask:0xf bank_mask:0xf
    v_and_b32_dpp v25, v33, v13 row_newbcast:8 row_mask:0xf bank_mask:0xf
    v_smfmac_f32_16x16x64_bf16 v[20:23], v[28:31], v[104:111], v14
    v_and_b32_dpp v26, v33, v12 row_newbcast:9 row_mask:0xf bank_mask:0xf
    v_and_b32_dpp v27, v33, v13 row_newbcast:9 row_mask:0xf bank_mask:0xf
    v_add_u32_dpp v11, v34, v7 row_newbcast:3 row_mask:0xf bank_mask:0xf
    buffer_load_dwordx4 v[68:71], v11, s[32:35], 0 offen offset:0
    buffer_load_dwordx4 v[76:79], v11, s[32:35], 0 offen offset:256
    s_cbranch_scc1 L_ev3
L_fp4:
    s_bitcmp1_b32 s52, 4
    s_waitcnt vmcnt(20)
    v_smfmac_f32_16x16x64_bf16 v[16:19], v[24:27], v[112:119], v14
    v_and_b32_dpp v28, v33, v12 row_newbcast:10 row_mask:0xf bank_mask:0xf
    v_and_b32_dpp v29, v33, v13 row_newbcast:10 row_mask:0xf bank_mask:0xf
    v_smfmac_f32_16x16x64_bf16 v[20:23], v[24:27], v[120:127], v14
    v_and_b32_dpp v30, v33, v12 row_newbcast:11 row_mask:0xf bank_mask:0xf
    v_and_b32_dpp v31, v33, v13 row_newbcast:11 row_mask:0xf bank_mask:0xf
    v_add_u32_dpp v11, v34, v7 row_newbcast:4 row_mask:0xf bank_mask:0xf
    buffer_load_dwordx4 v[80:83], v11, s[32:35], 0 offen offset:0
    buffer_load_dwordx4 v[88:91], v11, s[32:35], 0 offen offset:256
    s_cbranch_scc1 L_ev4
L_fp5:
    s_bitcmp1_b32 s52, 5
    s_waitcnt vmcnt(18)
    v_smfmac_f32_16x16x64_bf16 v[16:19], v[28:31], v[128:135], v14
    v_and_b32_dpp v24, v33, v12 row_newbcast:12 row_mask:0xf bank_mask:0xf
    v_and_b32_dpp v25, v33, v13 row_newbcast:12 row_mask:0xf bank_mask:0xf
    v_smfmac_f32_16x16x64_bf16 v[20:23], v[28:31], v[136:143], v14
    v_and_b32_dpp v26, v33, v12 row_newbcast:13 row_mask:0xf bank_mask:0xf
    v_and_b32_dpp v27, v33, v13 row_newbcast:13 row_mask:0xf bank_mask:0xf
    v_add_u32_dpp v11, v34, v7 row_newbcast:5 row_mask:0xf bank_mask:0xf
    buffer_load_dwordx4 v[84:87], v11, s[32:35], 0 offen offset:0
    buffer_load_dwordx4 v[92:95], v11, s[32:35], 0 offen offset:256
    s_cbranch_scc1 L_ev5
L_fp6:
    s_bitcmp1_b32 s52, 6
    s_waitcnt vmcnt(16)
    v_smfmac_f32_16x16x64_bf16 v[16:19], v[24:27], v[144:151], v14
    v_and_b32_dpp v28, v33, v12 row_newbcast:14 row_mask:0xf bank_mask:0xf
    v_and_b32_dpp v29, v33, v13 row_newbcast:14 row_mask:0xf bank_mask:0xf
    v_smfmac_f32_16x16x64_bf16 v[20:23], v[24:27], v[152:159], v14
    v_and_b32_dpp v30, v33, v12 row_newbcast:15 row_mask:0xf bank_mask:0xf
    v_and_b32_dpp v31, v33, v13 row_newbcast:15 row_mask:0xf bank_mask:0xf
    v_add_u32_dpp v11, v34, v7 row_newbcast:6 row_mask:0xf bank_mask:0xf
    buffer_load_dwordx4 v[96:99], v11, s[32:35], 0 offen offset:0
    buffer_load_dwordx4 v[104:107], v11, s[32:35], 0 offen offset:256
    s_cbranch_scc1 L_ev6
L_fp7:
    s_bitcmp1_b32 s52, 7
    s_waitcnt vmcnt(14)
    v_smfmac_f32_16x16x64_bf16 v[16:19], v[28:31], v[160:167], v14
    v_and_b32_dpp v24, v35, v12 row_newbcast:0 row_mask:0xf bank_mask:0xf
    v_and_b32_dpp v25, v35, v13 row_newbcast:0 row_mask:0xf bank_mask:0xf
    v_smfmac_f32_16x16x64_bf16 v[20:23], v[28:31], v[168:175], v14
    v_and_b32_dpp v26, v35, v12 row_newbcast:1 row_mask:0xf bank_mask:0xf
    v_and_b32_dpp v27, v35, v13 row_newbcast:1 row_mask:0xf bank_mask:0xf
    v_add_u32_dpp v11, v34, v7 row_newbcast:7 row_mask:0xf bank_mask:0xf
    buffer_load_dwordx4 v[100:103], v11, s[32:35], 0 offen offset:0
    buffer_load_dwordx4 v[108:111], v11, s[32:35], 0 offen offset:256
    s_cbranch_scc1 L_ev7
L_fp8:
    v_mov_b64 v[32:33], v[34:35]
    v_mov_b64 v[34:35], v[36:37]
    v_mov_b64 v[36:37], v[38:39]
    s_lshr_b32 s52, s52, 8
    s_lshr_b32 s53, s53, 8
    s_lshr_b32 s56, s56, 8
    s_mov_b32 s62, L_st1-L_anc
    s_mov_b32 s63, L_st1-L_st0
L_st0:
    s_bitcmp1_b32 s52, 0
    s_waitcnt vmcnt(12)
    v_smfmac_f32_16x16x64_bf16 v[16:19], v[24:27], v[48:55], v14
    v_and_b32_dpp v28, v33, v12 row_newbcast:2 row_mask:0xf bank_mask:0xf
    v_and_b32_dpp v29, v33, v13 row_newbcast:2 row_mask:0xf bank_mask:0xf
    v_smfmac_f32_16x16x64_bf16 v[20:23], v[24:27], v[56:63], v14
    v_and_b32_dpp v30, v33, v12 row_newbcast:3 row_mask:0xf bank_mask:0xf
    v_and_b32_dpp v31, v33, v13 row_newbcast:3 row_mask:0xf bank_mask:0xf
    v_add_u32_dpp v11, v32, v7 row_newbcast:8 row_mask:0xf bank_mask:0xf
    buffer_load_dwordx4 v[112:115], v11, s[32:35], 0 offen offset:0
    buffer_load_dwordx4 v[120:123], v11, s[32:35], 0 offen offset:256
    v_add_u32_dpp v11, v32, v7 row_newbcast:9 row_mask:0xf bank_mask:0xf
    buffer_load_dwordx4 v[116:119], v11, s[32:35], 0 offen offset:0
    buffer_load_dwordx4 v[124:127], v11, s[32:35], 0 offen offset:256
    s_cbranch_scc1 L_ev0
L_st1:
    s_bitcmp1_b32 s52, 1
    s_waitcnt vmcnt(12)
    v_smfmac_f32_16x16x64_bf16 v[16:19], v[28:31], v[64:71], v14
    v_and_b32_dpp v24, v33, v12 row_newbcast:4 row_mask:0xf bank_mask:0xf
    v_and_b32_dpp v25, v33, v13 row_newbcast:4 row_mask:0xf bank_mask:0xf
    v_smfmac_f32_16x16x64_bf16 v[20:23], v[28:31], v[72:79], v14
    v_and_b32_dpp v26, v33, v12 row_newbcast:5 row_mask:0xf bank_mask:0xf
    v_and_b32_dpp v27, v33, v13 row_newbcast:5 row_mask:0xf bank_mask:0xf
    v_add_u32_dpp v11, v32, v7 row_newbcast:10 row_mask:0xf bank_mask:0xf
    buffer_load_dwordx4 v[128:131], v11, s[32:35], 0 offen offset:0
    buffer_load_dwordx4 v[136:139], v11, s[32:35], 0 offen offset:256
    v_add_u32_dpp v11, v32, v7 row_newbcast:11 row_mask:0xf bank_mask:0xf
    buffer_load_dwordx4 v[132:135], v11, s[32:35], 0 offen offset:0
    buffer_load_dwordx4 v[140:143], v11, s[32:35], 0 offen offset:256
    s_cbranch_scc1 L_ev1
L_st2:
    s_bitcmp1_b32 s52, 2
    s_waitcnt vmcnt(12)
    v_smfmac_f32_16x16x64_bf16 v[16:19], v[24:27], v[80:87], v14
    v_and_b32_dpp v28, v33, v12 row_newbcast:6 row_mask:0xf bank_mask:0xf
    v_and_b32_dpp v29, v33, v13 row_newbcast:6 row_mask:0xf bank_mask:0xf
    v_smfmac_f32_16x16x64_bf16 v[20:23], v[24:27], v[88:95], v14
    v_and_b32_dpp v30, v33, v12 row_newbcast:7 row_mask:0xf bank_mask:0xf
    v_and_b32_dpp v31, v33, v13 row_newbcast:7 row_mask:0xf bank_mask:0xf
    v_add_u32_dpp v11, v32, v7 row_newbcast:12 row_mask:0xf bank_mask:0xf
    buffer_load_dwordx4 v[144:147], v11, s[32:35], 0 offen offset:0
    buffer_load_dwordx4 v[152:155], v11, s[32:35], 0 offen offset:256
    v_add_u32_dpp v11, v32, v7 row_newbcast:13 row_mask:0xf bank_mask:0xf
    buffer_load_dwordx4 v[148:151], v11, s[32:35], 0 offen offset:0
    buffer_load_dwordx4 v[156:159], v11, s[32:35], 0 offen offset:256
    s_cbranch_scc1 L_ev2
L_st3:
    s_bitcmp1_b32 s52, 3
    s_waitcnt vmcnt(12)
    v_smfmac_f32_16x16x64_bf16 v[16:19], v[28:31], v[96:103], v14
    v_and_b32_dpp v24, v33, v12 row_newbcast:8 row_mask:0xf bank_mask:0xf
    v_and_b32_dpp v25, v33, v13 row_newbcast:8 row_mask:0xf bank_mask:0xf
    v_smfmac_f32_16x16x64_bf16 v[20:23], v[28:31], v[104:111], v14
    v_and_b32_dpp v26, v33, v12 row_newbcast:9 row_mask:0xf bank_mask:0xf
    v_and_b32_dpp v27, v33, v13 row_newbcast:9 row_mask:0xf bank_mask:0xf
    v_add_u32_dpp v11, v32, v7 row_newbcast:14 row_mask:0xf bank_mask:0xf
    buffer_load_dwordx4 v[160:163], v11, s[32:35], 0 offen offset:0
    buffer_load_dwordx4 v[168:171], v11, s[32:35], 0 offen offset:256
    v_add_u32_dpp v11, v32, v7 row_newbcast:15 row_mask:0xf bank_mask:0xf
    buffer_load_dwordx4 v[164:167], v11, s[32:35], 0 offen offset:0
    buffer_load_dwordx4 v[172:175], v11, s[32:35], 0 offen offset:256
    s_cbranch_scc1 L_ev3
L_st4:
    s_bitcmp1_b32 s52, 4
    s_waitcnt vmcnt(12)
    v_smfmac_f32_16x16x64_bf16 v[16:19], v[24:27], v[112:119], v14
    v_and_b32_dpp v28, v33, v12 row_newbcast:10 row_mask:0xf bank_mask:0xf
    v_and_b32_dpp v29, v33, v13 row_newbcast:10 row_mask:0xf bank_mask:0xf
    v_smfmac_f32_16x16x64_bf16 v[20:23], v[24:27], v[120:127], v14
    v_and_b32_dpp v30, v33, v12 row_newbcast:11 row_mask:0xf bank_mask:0xf
    v_and_b32_dpp v31, v33, v13 row_newbcast:11 row_mask:0xf bank_mask:0xf
    v_add_u32_dpp v11, v34, v7 row_newbcast:0 row_mask:0xf bank_mask:0xf
    buffer_load_dwordx4 v[48:51], v11, s[32:35], 0 offen offset:0
    buffer_load_dwordx4 v[56:59], v11, s[32:35], 0 offen offset:256
    v_add_u32_dpp v11, v34, v7 row_newbcast:1 row_mask:0xf bank_mask:0xf
    buffer_load_dwordx4 v[52:55], v11, s[32:35], 0 offen offset:0
    buffer_load_dwordx4 v[60:63], v11, s[32:35], 0 offen offset:256
    s_cbranch_scc1 L_ev4
L_st5:
    s_bitcmp1_b32 s52, 5
    s_waitcnt vmcnt(12)
    v_smfmac_f32_16x16x64_bf16 v[16:19], v[28:31], v[128:135], v14
    v_and_b32_dpp v24, v33, v12 row_newbcast:12 row_mask:0xf bank_mask:0xf
    v_and_b32_dpp v25, v33, v13 row_newbcast:12 row_mask:0xf bank_mask:0xf
    v_smfmac_f32_16x16x64_bf16 v[20:23], v[28:31], v[136:143], v14
    v_and_b32_dpp v26, v33, v12 row_newbcast:13 row_mask:0xf bank_mask:0xf
    v_and_b32_dpp v27, v33, v13 row_newbcast:13 row_mask:0xf bank_mask:0xf
    v_add_u32_dpp v11, v34, v7 row_newbcast:2 row_mask:0xf bank_mask:0xf
    buffer_load_dwordx4 v[64:67], v11, s[32:35], 0 offen offset:0
    buffer_load_dwordx4 v[72:75], v11, s[32:35], 0 offen offset:256
    v_add_u32_dpp v11, v34, v7 row_newbcast:3 row_mask:0xf bank_mask:0xf
    buffer_load_dwordx4 v[68:71], v11, s[32:35], 0 offen offset:0
    buffer_load_dwordx4 v[76:79], v11, s[32:35], 0 offen offset:256
    s_cbranch_scc1 L_ev5
L_st6:
    s_bitcmp1_b32 s52, 6
    s_waitcnt vmcnt(12)
    v_smfmac_f32_16x16x64_bf16 v[16:19], v[24:27], v[144:151], v14
    v_and_b32_dpp v28, v33, v12 row_newbcast:14 row_mask:0xf bank_mask:0xf
    v_and_b32_dpp v29, v33, v13 row_newbcast:14 row_mask:0xf bank_mask:0xf
    v_smfmac_f32_16x16x64_bf16 v[20:23], v[24:27], v[152:159], v14
    v_and_b32_dpp v30, v33, v12 row_newbcast:15 row_mask:0xf bank_mask:0xf
    v_and_b32_dpp v31, v33, v13 row_newbcast:15 row_mask:0xf bank_mask:0xf
    v_add_u32_dpp v11, v34, v7 row_newbcast:4 row_mask:0xf bank_mask:0xf
    buffer_load_dwordx4 v[80:83], v11, s[32:35], 0 offen offset:0
    buffer_load_dwordx4 v[88:91], v11, s[32:35], 0 offen offset:256
    v_add_u32_dpp v11, v34, v7 row_newbcast:5 row_mask:0xf bank_mask:0xf
    buffer_load_dwordx4 v[84:87], v11, s[32:35], 0 offen offset:0
    buffer_load_dwordx4 v[92:95], v11, s[32:35], 0 offen offset:256
    s_cbranch_scc1 L_ev6
L_st7:
    s_bitcmp1_b32 s52, 7
    s_waitcnt vmcnt(12)
    v_smfmac_f32_16x16x64_bf16 v[16:19], v[28:31], v[160:167], v14
    v_and_b32_dpp v24, v35, v12 row_newbcast:0 row_mask:0xf bank_mask:0xf
    v_and_b32_dpp v25, v35, v13 row_newbcast:0 row_mask:0xf bank_mask:0xf
    v_smfmac_f32_16x16x64_bf16 v[20:23], v[28:31], v[168:175], v14
    v_and_b32_dpp v26, v35, v12 row_newbcast:1 row_mask:0xf bank_mask:0xf
    v_and_b32_dpp v27, v35, v13 row_newbcast:1 row_mask:0xf bank_mask:0xf
    v_add_u32_dpp v11, v34, v7 row_newbcast:6 row_mask:0xf bank_mask:0xf
    buffer_load_dwordx4 v[96:99], v11, s[32:35], 0 offen offset:0
    buffer_load_dwordx4 v[104:107], v11, s[32:35], 0 offen offset:256
    v_add_u32_dpp v11, v34, v7 row_newbcast:7 row_mask:0xf bank_mask:0xf
    buffer_load_dwordx4 v[100:103], v11, s[32:35], 0 offen offset:0
    buffer_load_dwordx4 v[108:111], v11, s[32:35], 0 offen offset:256
    s_cbranch_scc1 L_ev7
L_st8:
    v_mov_b64 v[32:33], v[34:35]
    v_mov_b64 v[34:35], v[36:37]
    v_mov_b64 v[36:37], v[38:39]
    s_lshr_b32 s52, s52, 8
    s_lshr_b32 s53, s53, 8
    s_lshr_b32 s56, s56, 8
    s_branch L_st0
L_pad8:
    s_setpc_b64 s[68:69]
L_dr0:
    s_add_u32 s49, s49, 1
    ds_write_b32 v10, v6 offset:48
    s_waitcnt vmcnt(12)
    v_smfmac_f32_16x16x64_bf16 v[16:19], v[24:27], v[48:55], v14
    v_and_b32_dpp v28, v33, v12 row_newbcast:2 row_mask:0xf bank_mask:0xf
    v_and_b32_dpp v29, v33, v13 row_newbcast:2 row_mask:0xf bank_mask:0xf
    v_smfmac_f32_16x16x64_bf16 v[20:23], v[24:27], v[56:63], v14
    v_and_b32_dpp v30, v33, v12 row_newbcast:3 row_mask:0xf bank_mask:0xf
    v_and_b32_dpp v31, v33, v13 row_newbcast:3 row_mask:0xf bank_mask:0xf
    s_cmp_eq_u32 s49, 1
    s_cbranch_scc1 L_dw0_1
    s_cmp_eq_u32 s49, 2
    s_cbranch_scc1 L_dw0_2
L_dw0_3:
    s_waitcnt vmcnt(0)
L_dw0_2:
    s_waitcnt vmcnt(4)
L_dw0_1:
    s_waitcnt vmcnt(8)
    s_bitcmp1_b32 s52, 0
    s_cbranch_scc1 L_ev0
L_dr1:
    s_add_u32 s49, s49, 1
    ds_write_b32 v10, v6 offset:48
    s_waitcnt vmcnt(12)
    v_smfmac_f32_16x16x64_bf16 v[16:19], v[28:31], v[64:71], v14
    v_and_b32_dpp v24, v33, v12 row_newbcast:4 row_mask:0xf bank_mask:0xf
    v_and_b32_dpp v25, v33, v13 row_newbcast:4 row_mask:0xf bank_mask:0xf
    v_smfmac_f32_16x16x64_bf16 v[20:23], v[28:31], v[72:79], v14
    v_and_b32_dpp v26, v33, v12 row_newbcast:5 row_mask:0xf bank_mask:0xf
    v_and_b32_dpp v27, v33, v13 row_newbcast:5 row_mask:0xf bank_mask:0xf
    s_cmp_eq_u32 s49, 1
    s_cbranch_scc1 L_dw1_1
    s_cmp_eq_u32 s49, 2
    s_cbranch_scc1 L_dw1_2
L_dw1_3:
    s_waitcnt vmcnt(0)
L_dw1_2:
    s_waitcnt vmcnt(4)
L_dw1_1:
    s_waitcnt vmcnt(8)
    s_bitcmp1_b32 s52, 1
    s_cbranch_scc1 L_ev1
L_dr2:
    s_add_u32 s49, s49, 1
    ds_write_b32 v10, v6 offset:48
    s_waitcnt vmcnt(12)
    v_smfmac_f32_16x16x64_bf16 v[16:19], v[24:27], v[80:87], v14
    v_and_b32_dpp v28, v33, v12 row_newbcast:6 row_mask:0xf bank_mask:0xf
    v_and_b32_dpp v29, v33, v13 row_newbcast:6 row_mask:0xf bank_mask:0xf
    v_smfmac_f32_16x16x64_bf16 v[20:23], v[24:27], v[88:95], v14
    v_and_b32_dpp v30, v33, v12 row_newbcast:7 row_mask:0xf bank_mask:0xf
    v_and_b32_dpp v31, v33, v13 row_newbcast:7 row_mask:0xf bank_mask:0xf
    s_cmp_eq_u32 s49, 1
    s_cbranch_scc1 L_dw2_1
    s_cmp_eq_u32 s49, 2
    s_cbranch_scc1 L_dw2_2
L_dw2_3:
    s_waitcnt vmcnt(0)
L_dw2_2:
    s_waitcnt vmcnt(4)
L_dw2_1:
    s_waitcnt vmcnt(8)
    s_bitcmp1_b32 s52, 2
    s_cbranch_scc1 L_ev2
L_dr3:
    s_add_u32 s49, s49, 1
    ds_write_b32 v10, v6 offset:48
    s_waitcnt vmcnt(12)
    v_smfmac_f32_16x16x64_bf16 v[16:19], v[28:31], v[96:103], v14
    v_and_b32_dpp v24, v33, v12 row_newbcast:8 row_mask:0xf bank_mask:0xf
    v_and_b32_dpp v25, v33, v13 row_newbcast:8 row_mask:0xf bank_mask:0xf
    v_smfmac_f32_16x16x64_bf16 v[20:23], v[28:31], v[104:111], v14
    v_and_b32_dpp v26, v33, v12 row_newbcast:9 row_mask:0xf bank_mask:0xf
    v_and_b32_dpp v27, v33, v13 row_newbcast:9 row_mask:0xf bank_mask:0xf
    s_cmp_eq_u32 s49, 1
    s_cbranch_scc1 L_dw3_1
    s_cmp_eq_u32 s49, 2
    s_cbranch_scc1 L_dw3_2
L_dw3_3:
    s_waitcnt vmcnt(0)
L_dw3_2:
    s_waitcnt vmcnt(4)
L_dw3_1:
    s_waitcnt vmcnt(8)
    s_bitcmp1_b32 s52, 3
    s_cbranch_scc1 L_ev3
L_dr4:
    s_add_u32 s49, s49, 1
    ds_write_b32 v10, v6 offset:48
    s_waitcnt vmcnt(12)
    v_smfmac_f32_16x16x64_bf16 v[16:19], v[24:27], v[112:119], v14
    v_and_b32_dpp v28, v33, v12 row_newbcast:10 row_mask:0xf bank_mask:0xf
    v_and_b32_dpp v29, v33, v13 row_newbcast:10 row_mask:0xf bank_mask:0xf
    v_smfmac_f32_16x16x64_bf16 v[20:23], v[24:27], v[120:127], v14
    v_and_b32_dpp v30, v33, v12 row_newbcast:11 row_mask:0xf bank_mask:0xf
    v_and_b32_dpp v31, v33, v13 row_newbcast:11 row_mask:0xf bank_mask:0xf
    s_cmp_eq_u32 s49, 1
    s_cbranch_scc1 L_dw4_1
    s_cmp_eq_u32 s49, 2
    s_cbranch_scc1 L_dw4_2
L_dw4_3:
    s_waitcnt vmcnt(0)
L_dw4_2:
    s_waitcnt vmcnt(4)
L_dw4_1:
    s_waitcnt vmcnt(8)
    s_bitcmp1_b32 s52, 4
    s_cbranch_scc1 L_ev4
L_dr5:
    s_add_u32 s49, s49, 1
    ds_write_b32 v10, v6 offset:48
    s_waitcnt vmcnt(12)
    v_smfmac_f32_16x16x64_bf16 v[16:19], v[28:31], v[128:135], v14
    v_and_b32_dpp v24, v33, v12 row_newbcast:12 row_mask:0xf bank_mask:0xf
    v_and_b32_dpp v25, v33, v13 row_newbcast:12 row_mask:0xf bank_mask:0xf
    v_smfmac_f32_16x16x64_bf16 v[20:23], v[28:31], v[136:143], v14
    v_and_b32_dpp v26, v33, v12 row_newbcast:13 row_mask:0xf bank_mask:0xf
    v_and_b32_dpp v27, v33, v13 row_newbcast:13 row_mask:0xf bank_mask:0xf
    s_cmp_eq_u32 s49, 1
    s_cbranch_scc1 L_dw5_1
    s_cmp_eq_u32 s49, 2
    s_cbranch_scc1 L_dw5_2
L_dw5_3:
    s_waitcnt vmcnt(0)
L_dw5_2:
    s_waitcnt vmcnt(4)
L_dw5_1:
    s_waitcnt vmcnt(8)
    s_bitcmp1_b32 s52, 5
    s_cbranch_scc1 L_ev5
L_dr6:
    s_add_u32 s49, s49, 1
    ds_write_b32 v10, v6 offset:48
    s_waitcnt vmcnt(12)
    v_smfmac_f32_16x16x64_bf16 v[16:19], v[24:27], v[144:151], v14
    v_and_b32_dpp v28, v33, v12 row_newbcast:14 row_mask:0xf bank_mask:0xf
    v_and_b32_dpp v29, v33, v13 row_newbcast:14 row_mask:0xf bank_mask:0xf
    v_smfmac_f32_16x16x64_bf16 v[20:23], v[24:27], v[152:159], v14
    v_and_b32_dpp v30, v33, v12 row_newbcast:15 row_mask:0xf bank_mask:0xf
    v_and_b32_dpp v31, v33, v13 row_newbcast:15 row_mask:0xf bank_mask:0xf
    s_cmp_eq_u32 s49, 1
    s_cbranch_scc1 L_dw6_1
    s_cmp_eq_u32 s49, 2
    s_cbranch_scc1 L_dw6_2
L_dw6_3:
    s_waitcnt vmcnt(0)
L_dw6_2:
    s_waitcnt vmcnt(4)
L_dw6_1:
    s_waitcnt vmcnt(8)
    s_bitcmp1_b32 s52, 6
    s_cbranch_scc1 L_ev6
L_dr7:
    s_add_u32 s49, s49, 1
    ds_write_b32 v10, v6 offset:48
    s_waitcnt vmcnt(12)
    v_smfmac_f32_16x16x64_bf16 v[16:19], v[28:31], v[160:167], v14
    v_and_b32_dpp v24, v35, v12 row_newbcast:0 row_mask:0xf bank_mask:0xf
    v_and_b32_dpp v25, v35, v13 row_newbcast:0 row_mask:0xf bank_mask:0xf
    v_smfmac_f32_16x16x64_bf16 v[20:23], v[28:31], v[168:175], v14
    v_and_b32_dpp v26, v35, v12 row_newbcast:1 row_mask:0xf bank_mask:0xf
    v_and_b32_dpp v27, v35, v13 row_newbcast:1 row_mask:0xf bank_mask:0xf
    s_cmp_eq_u32 s49, 1
    s_cbranch_scc1 L_dw7_1
    s_cmp_eq_u32 s49, 2
    s_cbranch_scc1 L_dw7_2
L_dw7_3:
    s_waitcnt vmcnt(0)
L_dw7_2:
    s_waitcnt vmcnt(4)
L_dw7_1:
    s_waitcnt vmcnt(8)
    s_bitcmp1_b32 s52, 7
    s_cbranch_scc1 L_ev7
L_dr8:
    v_mov_b64 v[32:33], v[34:35]
    v_mov_b64 v[34:35], v[36:37]
    v_mov_b64 v[36:37], v[38:39]
    s_lshr_b32 s52, s52, 8
    s_lshr_b32 s53, s53, 8
    s_lshr_b32 s56, s56, 8
    s_branch L_dr0
L_pad0:
    s_setpc_b64 s[68:69]
L_ev0:
    s_and_b32 s65, s57, 15
    v_cmp_ge_u32 s[66:67], s65, v4
    v_cmp_gt_u32 s[68:69], s65, v4
    s_bitcmp1_b32 s56, 0
    s_cselect_b64 s[62:63], s[70:71], s[62:63]
    v_cndmask_b32 v40, 0, v28, s[66:67]
    v_cndmask_b32 v41, 0, v29, s[66:67]
    v_cndmask_b32 v42, 0, v30, s[68:69]
    v_cndmask_b32 v43, 0, v31, s[68:69]
    s_mul_i32 s64, s63, 0
    s_bitcmp1_b32 s53, 0
    s_cbranch_scc0 L_evret
    s_waitcnt vmcnt(12)
    v_smfmac_f32_16x16x64_bf16 v[16:19], v[40:43], v[64:71], v14
    v_xor_b32 v28, v28, v40
    v_xor_b32 v29, v29, v41
    v_smfmac_f32_16x16x64_bf16 v[20:23], v[40:43], v[72:79], v14
    v_xor_b32 v30, v30, v42
    v_xor_b32 v31, v31, v43
    s_branch L_flush
L_pad1:
    s_setpc_b64 s[68:69]
L_ev1:
    s_and_b32 s65, s57, 15
    v_cmp_ge_u32 s[66:67], s65, v4
    v_cmp_gt_u32 s[68:69], s65, v4
    s_bitcmp1_b32 s56, 1
    s_cselect_b64 s[62:63], s[70:71], s[62:63]
    v_cndmask_b32 v40, 0, v24, s[66:67]
    v_cndmask_b32 v41, 0, v25, s[66:67]
    v_cndmask_b32 v42, 0, v26, s[68:69]
    v_cndmask_b32 v43, 0, v27, s[68:69]
    s_mul_i32 s64, s63, 1
    s_bitcmp1_b32 s53, 1
    s_cbranch_scc0 L_evret
    s_waitcnt vmcnt(12)
    v_smfmac_f32_16x16x64_bf16 v[16:19], v[40:43], v[80:87], v14
    v_xor_b32 v24, v24, v40
    v_xor_b32 v25, v25, v41
    v_smfmac_f32_16x16x64_bf16 v[20:23], v[40:43], v[88:95], v14
    v_xor_b32 v26, v26, v42
    v_xor_b32 v27, v27, v43
    s_branch L_flush
L_pad2:
    s_setpc_b64 s[68:69]
L_ev2:
    s_and_b32 s65, s57, 15
    v_cmp_ge_u32 s[66:67], s65, v4
    v_cmp_gt_u32 s[68:69], s65, v4
    s_bitcmp1_b32 s56, 2
    s_cselect_b64 s[62:63], s[70:71], s[62:63]
    v_cndmask_b32 v40, 0, v28, s[66:67]
    v_cndmask_b32 v41, 0, v29, s[66:67]
    v_cndmask_b32 v42, 0, v30, s[68:69]
    v_cndmask_b32 v43, 0, v31, s[68:69]
    s_mul_i32 s64, s63, 2
    s_bitcmp1_b32 s53, 2
    s_cbranch_scc0 L_evret
    s_waitcnt vmcnt(12)
    v_smfmac_f32_16x16x64_bf16 v[16:19], v[40:43], v[96:103], v14
    v_xor_b32 v28, v28, v40
    v_xor_b32 v29, v29, v41
    v_smfmac_f32_16x16x64_bf16 v[20:23], v[40:43], v[104:111], v14
    v_xor_b32 v30, v30, v42
    v_xor_b32 v31, v31, v43
    s_branch L_flush
L_pad3:
    s_setpc_b64 s[68:69]
L_ev3:
    s_and_b32 s65, s57, 15
    v_cmp_ge_u32 s[66:67], s65, v4
    v_cmp_gt_u32 s[68:69], s65, v4
    s_bitcmp1_b32 s56, 3
    s_cselect_b64 s[62:63], s[70:71], s[62:63]
    v_cndmask_b32 v40, 0, v24, s[66:67]
    v_cndmask_b32 v41, 0, v25, s[66:67]
    v_cndmask_b32 v42, 0, v26, s[68:69]
    v_cndmask_b32 v43, 0, v27, s[68:69]
    s_mul_i32 s64, s63, 3
    s_bitcmp1_b32 s53, 3
    s_cbranch_scc0 L_evret
    s_waitcnt vmcnt(12)
    v_smfmac_f32_16x16x64_bf16 v[16:19], v[40:43], v[112:119], v14
    v_xor_b32 v24, v24, v40
    v_xor_b32 v25, v25, v41
    v_smfmac_f32_16x16x64_bf16 v[20:23], v[40:43], v[120:127], v14
    v_xor_b32 v26, v26, v42
    v_xor_b32 v27, v27, v43
    s_branch L_flush
L_pad4:
    s_setpc_b64 s[68:69]
L_ev4:
    s_and_b32 s65, s57, 15
    v_cmp_ge_u32 s[66:67], s65, v4
    v_cmp_gt_u32 s[68:69], s65, v4
    s_bitcmp1_b32 s56, 4
    s_cselect_b64 s[62:63], s[70:71], s[62:63]
    v_cndmask_b32 v40, 0, v28, s[66:67]
    v_cndmask_b32 v41, 0, v29, s[66:67]
    v_cndmask_b32 v42, 0, v30, s[68:69]
    v_cndmask_b32 v43, 0, v31, s[68:69]
    s_mul_i32 s64, s63, 4
    s_bitcmp1_b32 s53, 4
    s_cbranch_scc0 L_evret
    s_waitcnt vmcnt(12)
    v_smfmac_f32_16x16x64_bf16 v[16:19], v[40:43], v[128:135], v14
    v_xor_b32 v28, v28, v40
    v_xor_b32 v29, v29, v41
    v_smfmac_f32_16x16x64_bf16 v[20:23], v[40:43], v[136:143], v14
    v_xor_b32 v30, v30, v42
    v_xor_b32 v31, v31, v43
    s_branch L_flush
L_pad5:
    s_setpc_b64 s[68:69]
L_ev5:
    s_and_b32 s65, s57, 15
    v_cmp_ge_u32 s[66:67], s65, v4
    v_cmp_gt_u32 s[68:69], s65, v4
    s_bitcmp1_b32 s56, 5
    s_cselect_b64 s[62:63], s[70:71], s[62:63]
    v_cndmask_b32 v40, 0, v24, s[66:67]
    v_cndmask_b32 v41, 0, v25, s[66:67]
    v_cndmask_b32 v42, 0, v26, s[68:69]
    v_cndmask_b32 v43, 0, v27, s[68:69]
    s_mul_i32 s64, s63, 5
    s_bitcmp1_b32 s53, 5
    s_cbranch_scc0 L_evret
    s_waitcnt vmcnt(12)
    v_smfmac_f32_16x16x64_bf16 v[16:19], v[40:43], v[144:151], v14
    v_xor_b32 v24, v24, v40
    v_xor_b32 v25, v25, v41
    v_smfmac_f32_16x16x64_bf16 v[20:23], v[40:43], v[152:159], v14
    v_xor_b32 v26, v26, v42
    v_xor_b32 v27, v27, v43
    s_branch L_flush
L_pad6:
    s_setpc_b64 s[68:69]
L_ev6:
    s_and_b32 s65, s57, 15
    v_cmp_ge_u32 s[66:67], s65, v4
    v_cmp_gt_u32 s[68:69], s65, v4
    s_bitcmp1_b32 s56, 6
    s_cselect_b64 s[62:63], s[70:71], s[62:63]
    v_cndmask_b32 v40, 0, v28, s[66:67]
    v_cndmask_b32 v41, 0, v29, s[66:67]
    v_cndmask_b32 v42, 0, v30, s[68:69]
    v_cndmask_b32 v43, 0, v31, s[68:69]
    s_mul_i32 s64, s63, 6
    s_bitcmp1_b32 s53, 6
    s_cbranch_scc0 L_evret
    s_waitcnt vmcnt(12)
    v_smfmac_f32_16x16x64_bf16 v[16:19], v[40:43], v[160:167], v14
    v_xor_b32 v28, v28, v40
    v_xor_b32 v29, v29, v41
    v_smfmac_f32_16x16x64_bf16 v[20:23], v[40:43], v[168:175], v14
    v_xor_b32 v30, v30, v42
    v_xor_b32 v31, v31, v43
    s_branch L_flush
L_pad7:
    s_setpc_b64 s[68:69]
L_ev7:
    s_and_b32 s65, s57, 15
    v_cmp_ge_u32 s[66:67], s65, v4
    v_cmp_gt_u32 s[68:69], s65, v4
    s_bitcmp1_b32 s56, 7
    s_cselect_b64 s[62:63], s[70:71], s[62:63]
    v_cndmask_b32 v40, 0, v24, s[66:67]
    v_cndmask_b32 v41, 0, v25, s[66:67]
    v_cndmask_b32 v42, 0, v26, s[68:69]
    v_cndmask_b32 v43, 0, v27, s[68:69]
    s_mul_i32 s64, s63, 7
    s_bitcmp1_b32 s53, 7
    s_cbranch_scc0 L_evret
    s_waitcnt vmcnt(12)
    v_smfmac_f32_16x16x64_bf16 v[16:19], v[40:43], v[48:55], v14
    v_xor_b32 v24, v24, v40
    v_xor_b32 v25, v25, v41
    v_smfmac_f32_16x16x64_bf16 v[20:23], v[40:43], v[56:63], v14
    v_xor_b32 v26, v26, v42
    v_xor_b32 v27, v27, v43
    s_nop 0
L_flush:
    s_lshr_b32 s57, s57, 4
    s_cmp_eq_u32 s26, 4
    v_add_u32 v1, 1, v1
    v_mul_f32 v40, v177, v16
    v_mul_f32 v41, v177, v17
    v_mul_f32 v42, v177, v18
    v_mul_f32 v43, v177, v19
    v_cvt_pk_bf16_f32 v40, v40, v41
    v_cvt_pk_bf16_f32 v41, v42, v43
    ds_write_b64 v176, v[40:41] offset:41984
    v_mul_f32 v44, v177, v20
    v_mul_f32 v45, v177, v21
    v_mul_f32 v46, v177, v22
    v_mul_f32 v47, v177, v23
    v_cvt_pk_bf16_f32 v44, v44, v45
    v_cvt_pk_bf16_f32 v45, v46, v47
    ds_write_b64 v176, v[44:45] offset:42240
    ds_write_b32 v10, v1 offset:32
    s_cbranch_scc1 L_sdone
    v_mov_b64 v[16:17], 0
    v_mov_b64 v[18:19], 0
    v_mov_b64 v[20:21], 0
    v_mov_b64 v[22:23], 0
    s_add_u32 s26, s26, 1
    v_mov_b64 v[176:177], v[178:179]
    v_mov_b64 v[178:179], v[180:181]
    v_mov_b64 v[180:181], v[182:183]
    v_mov_b64 v[182:183], v[184:185]
L_evret:
    s_add_u32 s64, s64, s62
    s_add_u32 s54, s72, s64
    s_addc_u32 s55, s73, 0
    s_setpc_b64 s[54:55]
L_pad9:
    s_setpc_b64 s[68:69]
L_slow:
    s_mov_b32 s62, L_slow_pair-L_anc
    v_mbcnt_lo_u32_b32 v200, -1, 0
    v_mbcnt_hi_u32_b32 v200, -1, v200
L_slow_pair:
    v_lshlrev_b32 v201, 2, v200
    s_mul_i32 s70, s1, 40
    s_lshl1_add_u32 s70, s24, s70
    s_mov_b32 s71, 0
    s_mov_b32 s24, s20
    s_mov_b32 s20, s21
    s_mov_b32 s21, s22
    s_mov_b32 s22, s23
L_slow_chunk:
    global_load_dword v202, v201, s[8:9]
    global_load_dword v203, v201, s[6:7]
    v_add_u32 v201, 0x100, v201
    s_waitcnt vmcnt(0)
    v_subrev_u32 v202, s70, v202
    v_cmp_gt_u32 vcc, 2, v202
    v_lshlrev_b32 v204, 1, v203
    ds_read_u16 v204, v204 offset:62464
    s_mov_b64 s[76:77], vcc
    v_lshlrev_b32 v202, 4, v202
    v_lshlrev_b32 v203, 9, v203
    s_waitcnt lgkmcnt(0)
    v_lshlrev_b32 v204, v202, v204
L_slow_edge:
    s_cmp_eq_u64 s[76:77], 0
    s_cbranch_scc1 L_slow_next
    s_ff1_i32_b64 s74, s[76:77]
    s_bitset0_b64 s[76:77], s74
    v_readlane_b32 s64, v203, s74
    v_readlane_b32 s65, v204, s74
    v_mov_b32 v205, 0
    v_mov_b32 v11, 2147483648
    s_mov_b64 exec, 0xffff
    v_mov_b32 v205, s65
    v_add_u32 v11, s64, v7
    s_mov_b64 exec, -1
    buffer_load_dwordx4 v[208:211], v11, s[32:35], 0 offen
    buffer_load_dwordx4 v[212:215], v11, s[32:35], 0 offen offset:256
    v_and_b32 v24, v205, v12
    v_and_b32 v25, v205, v13
    s_nop 0
    s_waitcnt vmcnt(0)
    v_smfmac_f32_16x16x32_bf16 v[16:19], v[24:25], v[208:211], v14
    v_smfmac_f32_16x16x32_bf16 v[20:23], v[24:25], v[212:215], v14
    s_branch L_slow_edge
L_slow_next:
    s_add_u32 s71, s71, 1
    s_cmp_lt_u32 s71, 2500
    s_cbranch_scc1 L_slow_chunk
    s_mov_b32 s64, 0
    s_nop 3
    s_branch L_flush
L_sdone:
    ds_write_b32 v10, v6 offset:48
    s_waitcnt lgkmcnt(0)
    s_barrier
    s_endpgm
L_retry_12:
    s_sub_u32 s100, s100, 1
    s_cbranch_scc1 L_end
    s_sleep 1
    s_branch L_spin_11
L_retry_13:
    s_sub_u32 s100, s100, 1
    s_cbranch_scc1 L_end
    s_sleep 4
    s_branch L_ipoll_10
L_retry_19:
    s_sub_u32 s100, s100, 1
    s_cbranch_scc1 L_end
    s_sleep 2
    s_branch L_secload_18
L_secload_18:
    buffer_load_dwordx4 v[56:59], v8, s[40:43], s12 offen sc1
    s_waitcnt vmcnt(0)
    s_branch L_sec_16
L_retry_23:
    s_sub_u32 s100, s100, 1
    s_cbranch_scc1 L_end
    s_sleep 2
    s_branch L_secload_22
L_secload_22:
    buffer_load_dwordx4 v[60:63], v8, s[40:43], s13 offen sc1
    s_waitcnt vmcnt(0)
    s_branch L_sec_20
L_retry_25:
    s_sub_u32 s100, s100, 1
    s_cbranch_scc1 L_end
    s_sleep 1
    s_branch L_spin_24
L_mwork_4:
    v_xor_b32 v44, v4, v3
    v_lshlrev_b32 v44, 4, v44
    v_lshl_add_u32 v44, v3, 9, v44
    v_xor_b32 v45, 64, v44
    v_xor_b32 v46, 0x80, v44
    v_xor_b32 v47, 0xc0, v44
    s_cmp_lg_u32 s31, 0
    s_waitcnt vmcnt(1)
    s_barrier
    s_cbranch_scc1 L_worked_5_w
    ds_read_b128 v[48:51], v44 offset:62464
    ds_read_b128 v[52:55], v44 offset:21504
    ds_read_b128 v[56:59], v44 offset:29696
    ds_read_b128 v[60:63], v45 offset:62464
    ds_read_b128 v[64:67], v45 offset:21504
    ds_read_b128 v[68:71], v45 offset:29696
    ds_read_b128 v[72:75], v46 offset:62464
    ds_read_b128 v[76:79], v46 offset:21504
    ds_read_b128 v[80:83], v46 offset:29696
    ds_read_b128 v[84:87], v47 offset:62464
    ds_read_b128 v[88:91], v47 offset:21504
    ds_read_b128 v[92:95], v47 offset:29696
    s_waitcnt lgkmcnt(9)
    v_mfma_f32_16x16x32_bf16 v[16:19], v[52:55], v[48:51], 0
    v_mfma_f32_16x16x32_bf16 v[20:23], v[56:59], v[48:51], 0
    ds_read_b128 v[96:99], v44 offset:62720
    ds_read_b128 v[100:103], v44 offset:21760
    ds_read_b128 v[104:107], v44 offset:29952
    s_waitcnt lgkmcnt(9)
    v_mfma_f32_16x16x32_bf16 v[16:19], v[64:67], v[60:63], v[16:19]
    v_mfma_f32_16x16x32_bf16 v[20:23], v[68:71], v[60:63], v[20:23]
    ds_read_b128 v[108:111], v45 offset:62720
    ds_read_b128 v[112:115], v45 offset:21760
    ds_read_b128 v[116:119], v45 offset:29952
    s_waitcnt lgkmcnt(9)
    v_mfma_f32_16x16x32_bf16 v[16:19], v[76:79], v[72:75], v[16:19]
    v_mfma_f32_16x16x32_bf16 v[20:23], v[80:83], v[72:75], v[20:23]
    ds_read_b128 v[120:123], v46 offset:62720
    ds_read_b128 v[124:127], v46 offset:21760
    ds_read_b128 v[128:131], v46 offset:29952
    s_waitcnt lgkmcnt(9)
    v_mfma_f32_16x16x32_bf16 v[16:19], v[88:91], v[84:87], v[16:19]
    v_mfma_f32_16x16x32_bf16 v[20:23], v[92:95], v[84:87], v[20:23]
    ds_read_b128 v[132:135], v47 offset:62720
    ds_read_b128 v[136:139], v47 offset:21760
    ds_read_b128 v[140:143], v47 offset:29952
    s_waitcnt lgkmcnt(9)
    v_mfma_f32_16x16x32_bf16 v[16:19], v[100:103], v[96:99], v[16:19]
    v_mfma_f32_16x16x32_bf16 v[20:23], v[104:107], v[96:99], v[20:23]
    s_waitcnt lgkmcnt(6)
    v_mfma_f32_16x16x32_bf16 v[16:19], v[112:115], v[108:111], v[16:19]
    v_mfma_f32_16x16x32_bf16 v[20:23], v[116:119], v[108:111], v[20:23]
    s_waitcnt lgkmcnt(3)
    v_mfma_f32_16x16x32_bf16 v[16:19], v[124:127], v[120:123], v[16:19]
    v_mfma_f32_16x16x32_bf16 v[20:23], v[128:131], v[120:123], v[20:23]
    s_waitcnt lgkmcnt(0)
    v_mfma_f32_16x16x32_bf16 v[16:19], v[136:139], v[132:135], v[16:19]
    v_mfma_f32_16x16x32_bf16 v[20:23], v[140:143], v[132:135], v[20:23]
    s_lshl_b32 s64, s27, 10
    s_add_u32 s64, s64, 65536
    v_lshl_add_u32 v40, v2, 4, s64
    s_lshl_b32 s64, s27, 2
    s_add_u32 s64, s64, 4096
    v_lshl_add_u32 v41, v2, 9, s64
    v_mov_b32 v42, s30
    s_nop 1
    v_cvt_pk_bf16_f32 v44, v16, v17
    v_cvt_pk_bf16_f32 v45, v18, v19
    v_cvt_pk_bf16_f32 v46, v20, v21
    v_cvt_pk_bf16_f32 v47, v22, v23
    global_store_dwordx4 v40, v[44:47], s[28:29] sc1
    s_barrier
    s_waitcnt vmcnt(0)
    s_mov_b64 exec, 0xff
    global_store_dword v41, v42, s[28:29] sc1
    s_mov_b64 exec, -1
    s_branch L_worked_5
L_worked_5_w:
    s_barrier
    s_waitcnt vmcnt(0)
    s_branch L_worked_5
L_gemm:
    v_lshlrev_b32 v8, 4, v0
    v_lshlrev_b32 v10, 2, v0
    v_mov_b32 v32, 1966080
    v_mov_b32 v33, 1966080
    v_mov_b64 v[34:35], v[32:33]
    v_subrev_u32 v9, 32, v0
    v_cmp_gt_u32 vcc, 20, v9
    ds_write_b128 v8, v[32:35] offset:41984
    ds_write_b128 v8, v[32:35] offset:46080
    ds_write_b128 v8, v[32:35] offset:50176
    ds_write_b128 v8, v[32:35] offset:54272
    v_mul_u32_u24 v9, 264, v9
    v_add_u32 v9, 148480, v9
    v_cndmask_b32 v9, 0, v9, vcc
    ds_write_b32 v10, v9
    v_mov_b32 v16, 1310740000
    v_mov_b32 v17, 1310740000
    v_mov_b64 v[18:19], v[16:17]
    v_add_u32 v9, 148480, v8
    ds_write_b128 v9, v[16:19]
    ds_write_b128 v9, v[16:19] offset:4096
    v_and_b32 v3, 15, v2
    v_lshrrev_b32 v4, 4, v2
    v_mov_b32 v5, 0
    v_mov_b32 v6, 1
    s_mov_b32 s100, 67108864
    s_bfe_u32 s65, s2, 0x10003
    s_lshl1_add_u32 s64, s67, s65
    s_and_b32 s65, s2, 0xf0
    s_or_b32 s64, s64, s65
    s_cmp_lt_u32 s2, 240
    s_cselect_b32 s1, s64, s2
    v_lshrrev_b32 v28, 5, v0
    v_and_b32 v1, 31, v2
    v_xor_b32 v1, v1, v28
    v_lshlrev_b32 v1, 4, v1
    v_lshl_add_u32 v30, v28, 9, v1
    v_xor_b32 v31, 0x80, v30
    s_mul_i32 s63, s1, 20480
    s_lshl_b32 s66, s31, 10
    s_waitcnt lgkmcnt(0)
    s_mov_b32 s32, s4
    s_and_b32 s33, s5, 0xffff
    s_mov_b32 s34, 5120000
    s_mov_b32 s35, 0x20000
    s_add_u32 m0, s66, 1024
    s_nop 0
    buffer_load_dwordx4 v30, s[32:35], s63 offen lds
    s_add_u32 m0, s66, 5120
    s_add_u32 s63, s63, 4096
    buffer_load_dwordx4 v31, s[32:35], s63 offen lds
    s_waitcnt lgkmcnt(0)
    s_cmp_ge_u32 s2, 250
    s_cbranch_scc1 L_end
    s_barrier
    s_setprio 2
    s_min_u32 s64, s1, 249
    s_mul_i32 s64, s64, 20480
    s_cmp_eq_u32 s31, 0
    s_cselect_b64 s[68:69], s[24:25], s[16:17]
    s_cselect_b32 s64, s64, 0
    s_cmp_eq_u32 s31, 2
    s_cselect_b64 s[68:69], s[28:29], s[68:69]
    s_cselect_b32 s64, 0x800, s64
    s_cselect_b32 s76, 0x2f8000, 0
    s_cmp_eq_u32 s31, 3
    s_cselect_b64 s[68:69], s[4:5], s[68:69]
    s_cselect_b32 s76, 0x200000, s76
    s_cselect_b32 s77, 2, 1
    v_min_u32 v27, s77, v2
    v_mul_lo_u32 v27, v27, s76
    v_add_u32 v27, s64, v27
    global_load_dword v24, v27, s[68:69]
    v_lshrrev_b32 v13, 3, v2
    v_lshrrev_b32 v15, 2, v2
    v_and_b32 v15, 4, v15
    v_and_b32 v14, 7, v2
    v_xor_b32 v15, v15, v14
    v_lshlrev_b32 v15, 4, v15
    v_lshl_add_u32 v13, v13, 9, v15
    s_bfe_u32 s67, s2, 0x30003
    s_lshl_b32 s64, s31, 7
    s_lshl_b32 s65, s67, 14
    s_or_b32 s64, s64, s65
    v_add_u32 v13, s64, v13
    s_lshl_b32 s70, s31, 14
    s_add_u32 s70, s70, 82944
    s_mov_b32 s71, 3072
    s_mov_b32 s72, 6144
    s_mov_b32 s73, 9216
    s_mov_b32 s36, s22
    s_and_b32 s37, s23, 0xffff
    s_mov_b32 s38, 131072
    s_mov_b32 s39, 0x20000
    s_and_b32 s64, s2, 8
    s_or_b32 s64, s64, s31
    s_cbranch_scc1 L_touched_26
    s_lshr_b32 s64, s2, 4
    s_and_b32 s68, s2, 7
    s_lshl3_add_u32 s64, s64, s68
    s_lshl_b32 s64, s64, 10
    v_lshl_add_u32 v26, v2, 4, s64
    global_load_dwordx4 v[20:23], v26, s[16:17]
L_touched_26:
    s_add_u32 m0, s70, 0
    s_nop 0
    buffer_load_dwordx4 v13, s[36:39], 0 offen offset:0 lds
    buffer_load_dwordx4 v13, s[36:39], s71 offen offset:1024 lds
    buffer_load_dwordx4 v13, s[36:39], s72 offen offset:2048 lds
    buffer_load_dwordx4 v13, s[36:39], s73 offen offset:3072 lds
    v_xor_b32 v13, 16384, v13
    s_mov_b32 s40, s16
    s_and_b32 s41, s17, 0xffff
    s_mov_b32 s42, 131072
    s_mov_b32 s43, 0x20000
    s_mov_b32 s44, s28
    s_and_b32 s45, s29, 0xffff
    s_mov_b32 s46, 1048576
    s_mov_b32 s47, 0x20000
    s_mov_b32 s48, s24
    s_and_b32 s49, s25, 0xffff
    s_mov_b32 s50, 5120000
    s_mov_b32 s51, 0x20000
    v_xor_b32 v15, v4, v3
    v_lshlrev_b32 v15, 4, v15
    v_lshl_add_u32 v7, v3, 9, v15
    s_lshl_b32 s64, s67, 6
    v_xor_b32 v7, s64, v7
    v_xor_b32 v8, 64, v7
    v_xor_b32 v9, 0x80, v7
    v_xor_b32 v10, 0xc0, v7
    v_lshrrev_b32 v15, 2, v3
    v_lshl_add_u32 v15, v4, 3, v15
    v_lshlrev_b32 v15, 7, v15
    v_lshrrev_b32 v14, 1, v3
    v_and_b32 v14, 4, v14
    v_and_b32 v0, 3, v3
    v_xor_b32 v14, v14, v0
    v_lshl_add_u32 v15, v14, 4, v15
    v_add_u32 v11, s70, v15
    v_xor_b32 v12, 64, v11
    v_and_b32 v0, 31, v2
    v_lshlrev_b32 v0, 2, v0
    s_and_b32 s64, s2, 7
    s_lshl_b32 s64, s64, 9
    s_lshl_b32 s65, s31, 7
    s_add_u32 s64, s64, s65
    s_add_u32 s74, s64, 4096
    v_lshlrev_b32 v14, 4, v2
    s_lshl_b32 s75, s31, 15
    s_lshl_b32 s64, s67, 12
    s_or_b32 s75, s75, s64
    s_add_u32 s75, s75, 65536
    s_add_u32 m0, s66, 9216
    s_add_u32 s63, s63, 4096
    buffer_load_dwordx4 v30, s[32:35], s63 offen lds
    s_add_u32 m0, s66, 13312
    s_add_u32 s63, s63, 4096
    buffer_load_dwordx4 v31, s[32:35], s63 offen lds
    s_add_u32 m0, s66, 17408
    s_add_u32 s63, s63, 4096
    buffer_load_dwordx4 v30, s[32:35], s63 offen lds
    s_barrier
    s_cmp_eq_u32 s31, 0
    s_cbranch_scc0 L_nw_28
    s_call_b64 s[68:69], L_pad0
    s_call_b64 s[68:69], L_pad1
    s_call_b64 s[68:69], L_pad8
    s_branch L_warmed_27
L_nw_28:
    s_cmp_eq_u32 s31, 1
    s_cbranch_scc0 L_nw_29
    s_call_b64 s[68:69], L_pad2
    s_call_b64 s[68:69], L_pad3
    s_call_b64 s[68:69], L_pad9
    s_branch L_warmed_27
L_nw_29:
    s_cmp_eq_u32 s31, 2
    s_cbranch_scc0 L_nw_30
    s_call_b64 s[68:69], L_pad4
    s_call_b64 s[68:69], L_pad5
    s_branch L_warmed_27
L_nw_30:
    s_call_b64 s[68:69], L_pad6
    s_call_b64 s[68:69], L_pad7
L_warmed_27:
    s_add_u32 m0, s70, 4096
    s_waitcnt vmcnt(9)
    buffer_load_dwordx4 v13, s[36:39], 0 offen offset:0 lds
    s_waitcnt vmcnt(9)
    buffer_load_dwordx4 v13, s[36:39], s71 offen offset:1024 lds
    s_waitcnt vmcnt(9)
    buffer_load_dwordx4 v13, s[36:39], s72 offen offset:2048 lds
    s_waitcnt vmcnt(9)
    buffer_load_dwordx4 v13, s[36:39], s73 offen offset:3072 lds
    v_xor_b32 v13, 49152, v13
    s_bitcmp1_b32 s2, 3
    s_cbranch_scc1 L_nobar_32
    s_barrier
L_nobar_32:
    s_add_u32 m0, s70, 8192
    s_waitcnt vmcnt(9)
    buffer_load_dwordx4 v13, s[36:39], 0 offen offset:0 lds
    s_waitcnt vmcnt(9)
    buffer_load_dwordx4 v13, s[36:39], s71 offen offset:1024 lds
    s_waitcnt vmcnt(9)
    buffer_load_dwordx4 v13, s[36:39], s72 offen offset:2048 lds
    s_waitcnt vmcnt(9)
    buffer_load_dwordx4 v13, s[36:39], s73 offen offset:3072 lds
    v_xor_b32 v13, 16384, v13
    s_add_u32 m0, s70, 12288
    s_waitcnt vmcnt(6)
    buffer_load_dwordx4 v13, s[36:39], 0 offen offset:0 lds
    s_waitcnt vmcnt(6)
    buffer_load_dwordx4 v13, s[36:39], s71 offen offset:1024 lds
    s_waitcnt vmcnt(6)
    buffer_load_dwordx4 v13, s[36:39], s72 offen offset:2048 lds
    s_waitcnt vmcnt(6)
    buffer_load_dwordx4 v13, s[36:39], s73 offen offset:3072 lds
    v_xor_b32 v13, 114688, v13
    s_waitcnt vmcnt(12)
    ds_read_b64_tr_b16 v[128:129], v11 offset:0
    ds_read_b64_tr_b16 v[130:131], v11 offset:512
    ds_read_b64_tr_b16 v[132:133], v11 offset:8
    ds_read_b64_tr_b16 v[134:135], v11 offset:520
    ds_read_b64_tr_b16 v[136:137], v12 offset:0
    ds_read_b64_tr_b16 v[138:139], v12 offset:512
    ds_read_b64_tr_b16 v[140:141], v12 offset:8
    ds_read_b64_tr_b16 v[142:143], v12 offset:520
    s_waitcnt lgkmcnt(0)
    s_add_u32 m0, s70, 0
    s_waitcnt vmcnt(6)
    buffer_load_dwordx4 v13, s[36:39], 0 offen offset:0 lds
    s_waitcnt vmcnt(6)
    buffer_load_dwordx4 v13, s[36:39], s71 offen offset:1024 lds
    s_waitcnt vmcnt(6)
    buffer_load_dwordx4 v13, s[36:39], s72 offen offset:2048 lds
    s_waitcnt vmcnt(6)
    buffer_load_dwordx4 v13, s[36:39], s73 offen offset:3072 lds
    v_xor_b32 v13, 16384, v13
    s_waitcnt vmcnt(12)
    s_waitcnt lgkmcnt(0)
    s_mov_b64 exec, 1
    ds_add_u32 v5, v6 offset:4
    s_mov_b64 exec, -1
    ds_read_b64_tr_b16 v[144:145], v11 offset:4096
    ds_read_b64_tr_b16 v[146:147], v11 offset:4608
    ds_read_b64_tr_b16 v[148:149], v11 offset:4104
    ds_read_b64_tr_b16 v[150:151], v11 offset:4616
    ds_read_b64_tr_b16 v[152:153], v12 offset:4096
    ds_read_b64_tr_b16 v[154:155], v12 offset:4608
    ds_read_b64_tr_b16 v[156:157], v12 offset:4104
    ds_read_b64_tr_b16 v[158:159], v12 offset:4616
    s_waitcnt lgkmcnt(0)
    s_add_u32 m0, s70, 4096
    s_waitcnt vmcnt(6)
    buffer_load_dwordx4 v13, s[36:39], 0 offen offset:0 lds
    s_waitcnt vmcnt(6)
    buffer_load_dwordx4 v13, s[36:39], s71 offen offset:1024 lds
    s_waitcnt vmcnt(6)
    buffer_load_dwordx4 v13, s[36:39], s72 offen offset:2048 lds
    s_waitcnt vmcnt(6)
    buffer_load_dwordx4 v13, s[36:39], s73 offen offset:3072 lds
    v_xor_b32 v13, 49152, v13
    s_waitcnt vmcnt(12)
    ds_read_b64_tr_b16 v[160:161], v11 offset:8192
    ds_read_b64_tr_b16 v[162:163], v11 offset:8704
    ds_read_b64_tr_b16 v[164:165], v11 offset:8200
    ds_read_b64_tr_b16 v[166:167], v11 offset:8712
    ds_read_b64_tr_b16 v[168:169], v12 offset:8192
    ds_read_b64_tr_b16 v[170:171], v12 offset:8704
    ds_read_b64_tr_b16 v[172:173], v12 offset:8200
    ds_read_b64_tr_b16 v[174:175], v12 offset:8712
    s_waitcnt lgkmcnt(0)
    s_add_u32 m0, s70, 8192
    s_waitcnt vmcnt(6)
    buffer_load_dwordx4 v13, s[36:39], 0 offen offset:0 lds
    s_waitcnt vmcnt(6)
    buffer_load_dwordx4 v13, s[36:39], s71 offen offset:1024 lds
    s_waitcnt vmcnt(6)
    buffer_load_dwordx4 v13, s[36:39], s72 offen offset:2048 lds
    s_waitcnt vmcnt(6)
    buffer_load_dwordx4 v13, s[36:39], s73 offen offset:3072 lds
    v_xor_b32 v13, 16384, v13
    buffer_load_dword v1, v0, s[44:47], s74 offen sc1
    s_waitcnt vmcnt(13)
    ds_read_b64_tr_b16 v[176:177], v11 offset:12288
    ds_read_b64_tr_b16 v[178:179], v11 offset:12800
    ds_read_b64_tr_b16 v[180:181], v11 offset:12296
    ds_read_b64_tr_b16 v[182:183], v11 offset:12808
    ds_read_b64_tr_b16 v[184:185], v12 offset:12288
    ds_read_b64_tr_b16 v[186:187], v12 offset:12800
    ds_read_b64_tr_b16 v[188:189], v12 offset:12296
    ds_read_b64_tr_b16 v[190:191], v12 offset:12808
    s_waitcnt lgkmcnt(0)
    s_add_u32 m0, s70, 12288
    s_nop 0
    buffer_load_dwordx4 v13, s[36:39], 0 offen offset:0 lds
    buffer_load_dwordx4 v13, s[36:39], s71 offen offset:1024 lds
    buffer_load_dwordx4 v13, s[36:39], s72 offen offset:2048 lds
    buffer_load_dwordx4 v13, s[36:39], s73 offen offset:3072 lds
    v_xor_b32 v13, 114688, v13
    s_waitcnt vmcnt(13)
    ds_read_b64_tr_b16 v[192:193], v11 offset:0
    ds_read_b64_tr_b16 v[194:195], v11 offset:512
    ds_read_b64_tr_b16 v[196:197], v11 offset:8
    ds_read_b64_tr_b16 v[198:199], v11 offset:520
    ds_read_b64_tr_b16 v[200:201], v12 offset:0
    ds_read_b64_tr_b16 v[202:203], v12 offset:512
    ds_read_b64_tr_b16 v[204:205], v12 offset:8
    ds_read_b64_tr_b16 v[206:207], v12 offset:520
    s_waitcnt vmcnt(9)
    ds_read_b64_tr_b16 v[208:209], v11 offset:4096
    ds_read_b64_tr_b16 v[210:211], v11 offset:4608
    ds_read_b64_tr_b16 v[212:213], v11 offset:4104
    ds_read_b64_tr_b16 v[214:215], v11 offset:4616
    ds_read_b64_tr_b16 v[216:217], v12 offset:4096
    ds_read_b64_tr_b16 v[218:219], v12 offset:4608
    ds_read_b64_tr_b16 v[220:221], v12 offset:4104
    ds_read_b64_tr_b16 v[222:223], v12 offset:4616
    s_waitcnt vmcnt(5)
    ds_read_b64_tr_b16 v[224:225], v11 offset:8192
    ds_read_b64_tr_b16 v[226:227], v11 offset:8704
    ds_read_b64_tr_b16 v[228:229], v11 offset:8200
    ds_read_b64_tr_b16 v[230:231], v11 offset:8712
    ds_read_b64_tr_b16 v[232:233], v12 offset:8192
    ds_read_b64_tr_b16 v[234:235], v12 offset:8704
    ds_read_b64_tr_b16 v[236:237], v12 offset:8200
    ds_read_b64_tr_b16 v[238:239], v12 offset:8712
    s_waitcnt vmcnt(4)
L_spin_34:
    ds_read_b128 v[16:19], v5
    s_waitcnt lgkmcnt(0)
    v_readfirstlane_b32 s101, v18
    v_readfirstlane_b32 s30, v19
    s_cmp_ge_u32 s101, 1
    s_cbranch_scc0 L_retry_35
L_mchk_33:
    v_cmp_ne_u32 vcc, s30, v1
    s_cbranch_vccnz L_mre_36
    buffer_load_dwordx4 v[40:43], v14, s[44:47], s75 offen offset:0 sc1
    buffer_load_dwordx4 v[44:47], v14, s[44:47], s75 offen offset:1024 sc1
    buffer_load_dwordx4 v[48:51], v14, s[44:47], s75 offen offset:2048 sc1
    buffer_load_dwordx4 v[52:55], v14, s[44:47], s75 offen offset:3072 sc1
    s_xor_b32 s75, s75, 4096
    buffer_load_dwordx4 v[56:59], v14, s[44:47], s75 offen offset:0 sc1
    buffer_load_dwordx4 v[60:63], v14, s[44:47], s75 offen offset:1024 sc1
    buffer_load_dwordx4 v[64:67], v14, s[44:47], s75 offen offset:2048 sc1
    buffer_load_dwordx4 v[68:71], v14, s[44:47], s75 offen offset:3072 sc1
    s_xor_b32 s75, s75, 12288
    buffer_load_dwordx4 v[72:75], v14, s[44:47], s75 offen offset:0 sc1
    buffer_load_dwordx4 v[76:79], v14, s[44:47], s75 offen offset:1024 sc1
    s_waitcnt vmcnt(10)
    ds_read_b64_tr_b16 v[240:241], v11 offset:12288
    ds_read_b64_tr_b16 v[242:243], v11 offset:12800
    ds_read_b64_tr_b16 v[244:245], v11 offset:12296
    ds_read_b64_tr_b16 v[246:247], v11 offset:12808
    ds_read_b64_tr_b16 v[248:249], v12 offset:12288
    ds_read_b64_tr_b16 v[250:251], v12 offset:12800
    ds_read_b64_tr_b16 v[252:253], v12 offset:12296
    ds_read_b64_tr_b16 v[254:255], v12 offset:12808
L_spin_37:
    ds_read_b32 v15, v5 offset:4
    s_waitcnt lgkmcnt(0)
    v_readfirstlane_b32 s101, v15
    s_cmp_ge_u32 s101, 4
    s_cbranch_scc0 L_retry_38
    ds_read_b128 v[16:19], v7 offset:1024
    ds_read_b128 v[20:23], v7 offset:9216
    ds_read_b128 v[24:27], v7 offset:17408
    v_xor_b32 v7, 0x100, v7
    ds_read_b128 v[28:31], v8 offset:1024
    ds_read_b128 v[32:35], v8 offset:9216
    ds_read_b128 v[36:39], v8 offset:17408
    v_xor_b32 v8, 0x100, v8
    s_waitcnt lgkmcnt(3)
    s_waitcnt vmcnt(9)
    v_mfma_f32_16x16x32_bf16 v[80:83], v[40:43], v[16:19], 0
    v_mfma_f32_16x16x32_bf16 v[96:99], v[40:43], v[20:23], 0
    v_mfma_f32_16x16x32_bf16 v[112:115], v[40:43], v[24:27], 0
    buffer_load_dwordx4 v[40:43], v14, s[44:47], s75 offen offset:2048 sc1
    s_waitcnt vmcnt(9)
    v_mfma_f32_16x16x32_bf16 v[84:87], v[44:47], v[16:19], 0
    v_mfma_f32_16x16x32_bf16 v[100:103], v[44:47], v[20:23], 0
    v_mfma_f32_16x16x32_bf16 v[116:119], v[44:47], v[24:27], 0
    buffer_load_dwordx4 v[44:47], v14, s[44:47], s75 offen offset:3072 sc1
    s_xor_b32 s75, s75, 4096
    s_waitcnt vmcnt(9)
    v_mfma_f32_16x16x32_bf16 v[88:91], v[48:51], v[16:19], 0
    v_mfma_f32_16x16x32_bf16 v[104:107], v[48:51], v[20:23], 0
    v_mfma_f32_16x16x32_bf16 v[120:123], v[48:51], v[24:27], 0
    buffer_load_dwordx4 v[48:51], v14, s[44:47], s75 offen offset:0 sc1
    s_waitcnt vmcnt(9)
    v_mfma_f32_16x16x32_bf16 v[92:95], v[52:55], v[16:19], 0
    v_mfma_f32_16x16x32_bf16 v[108:111], v[52:55], v[20:23], 0
    v_mfma_f32_16x16x32_bf16 v[124:127], v[52:55], v[24:27], 0
    buffer_load_dwordx4 v[52:55], v14, s[44:47], s75 offen offset:1024 sc1
    ds_read_b128 v[16:19], v9 offset:1024
    ds_read_b128 v[20:23], v9 offset:9216
    ds_read_b128 v[24:27], v9 offset:17408
    v_xor_b32 v9, 0x100, v9
    s_waitcnt lgkmcnt(3)
    s_waitcnt vmcnt(9)
    v_mfma_f32_16x16x32_bf16 v[80:83], v[56:59], v[28:31], v[80:83]
    v_mfma_f32_16x16x32_bf16 v[96:99], v[56:59], v[32:35], v[96:99]
    v_mfma_f32_16x16x32_bf16 v[112:115], v[56:59], v[36:39], v[112:115]
    buffer_load_dwordx4 v[56:59], v14, s[44:47], s75 offen offset:2048 sc1
    s_waitcnt vmcnt(9)
    v_mfma_f32_16x16x32_bf16 v[84:87], v[60:63], v[28:31], v[84:87]
    v_mfma_f32_16x16x32_bf16 v[100:103], v[60:63], v[32:35], v[100:103]
    v_mfma_f32_16x16x32_bf16 v[116:119], v[60:63], v[36:39], v[116:119]
    buffer_load_dwordx4 v[60:63], v14, s[44:47], s75 offen offset:3072 sc1
    s_xor_b32 s75, s75, 28672
    s_waitcnt vmcnt(9)
    v_mfma_f32_16x16x32_bf16 v[88:91], v[64:67], v[28:31], v[88:91]
    v_mfma_f32_16x16x32_bf16 v[104:107], v[64:67], v[32:35], v[104:107]
    v_mfma_f32_16x16x32_bf16 v[120:123], v[64:67], v[36:39], v[120:123]
    buffer_load_dwordx4 v[64:67], v14, s[44:47], s75 offen offset:0 sc1
    s_waitcnt vmcnt(9)
    v_mfma_f32_16x16x32_bf16 v[92:95], v[68:71], v[28:31], v[92:95]
    v_mfma_f32_16x16x32_bf16 v[108:111], v[68:71], v[32:35], v[108:111]
    v_mfma_f32_16x16x32_bf16 v[124:127], v[68:71], v[36:39], v[124:127]
    buffer_load_dwordx4 v[68:71], v14, s[44:47], s75 offen offset:1024 sc1
    ds_read_b128 v[28:31], v10 offset:1024
    ds_read_b128 v[32:35], v10 offset:9216
    ds_read_b128 v[36:39], v10 offset:17408
    v_xor_b32 v10, 0x100, v10
    s_waitcnt lgkmcnt(3)
    s_waitcnt vmcnt(9)
    v_mfma_f32_16x16x32_bf16 v[80:83], v[72:75], v[16:19], v[80:83]
    v_mfma_f32_16x16x32_bf16 v[96:99], v[72:75], v[20:23], v[96:99]
    v_mfma_f32_16x16x32_bf16 v[112:115], v[72:75], v[24:27], v[112:115]
    buffer_load_dwordx4 v[72:75], v14, s[44:47], s75 offen offset:2048 sc1
    s_waitcnt vmcnt(9)
    v_mfma_f32_16x16x32_bf16 v[84:87], v[76:79], v[16:19], v[84:87]
    v_mfma_f32_16x16x32_bf16 v[100:103], v[76:79], v[20:23], v[100:103]
    v_mfma_f32_16x16x32_bf16 v[116:119], v[76:79], v[24:27], v[116:119]
    buffer_load_dwordx4 v[76:79], v14, s[44:47], s75 offen offset:3072 sc1
    s_xor_b32 s75, s75, 4096
    s_waitcnt vmcnt(9)
    v_mfma_f32_16x16x32_bf16 v[88:91], v[40:43], v[16:19], v[88:91]
    v_mfma_f32_16x16x32_bf16 v[104:107], v[40:43], v[20:23], v[104:107]
    v_mfma_f32_16x16x32_bf16 v[120:123], v[40:43], v[24:27], v[120:123]
    buffer_load_dwordx4 v[40:43], v14, s[44:47], s75 offen offset:0 sc1
    s_waitcnt vmcnt(9)
    v_mfma_f32_16x16x32_bf16 v[92:95], v[44:47], v[16:19], v[92:95]
    v_mfma_f32_16x16x32_bf16 v[108:111], v[44:47], v[20:23], v[108:111]
    v_mfma_f32_16x16x32_bf16 v[124:127], v[44:47], v[24:27], v[124:127]
    buffer_load_dwordx4 v[44:47], v14, s[44:47], s75 offen offset:1024 sc1
    ds_read_b128 v[16:19], v7 offset:1024
    ds_read_b128 v[20:23], v7 offset:9216
    ds_read_b128 v[24:27], v7 offset:17408
    v_xor_b32 v7, 0x100, v7
    s_waitcnt lgkmcnt(3)
    s_waitcnt vmcnt(9)
    v_mfma_f32_16x16x32_bf16 v[80:83], v[48:51], v[28:31], v[80:83]
    v_mfma_f32_16x16x32_bf16 v[96:99], v[48:51], v[32:35], v[96:99]
    v_mfma_f32_16x16x32_bf16 v[112:115], v[48:51], v[36:39], v[112:115]
    buffer_load_dwordx4 v[48:51], v14, s[44:47], s75 offen offset:2048 sc1
    s_waitcnt vmcnt(9)
    v_mfma_f32_16x16x32_bf16 v[84:87], v[52:55], v[28:31], v[84:87]
    v_mfma_f32_16x16x32_bf16 v[100:103], v[52:55], v[32:35], v[100:103]
    v_mfma_f32_16x16x32_bf16 v[116:119], v[52:55], v[36:39], v[116:119]
    buffer_load_dwordx4 v[52:55], v14, s[44:47], s75 offen offset:3072 sc1
    s_xor_b32 s75, s75, 12288
    s_waitcnt vmcnt(9)
    v_mfma_f32_16x16x32_bf16 v[88:91], v[56:59], v[28:31], v[88:91]
    v_mfma_f32_16x16x32_bf16 v[104:107], v[56:59], v[32:35], v[104:107]
    v_mfma_f32_16x16x32_bf16 v[120:123], v[56:59], v[36:39], v[120:123]
    buffer_load_dwordx4 v[56:59], v14, s[44:47], s75 offen offset:0 sc1
    s_waitcnt vmcnt(9)
    v_mfma_f32_16x16x32_bf16 v[92:95], v[60:63], v[28:31], v[92:95]
    v_mfma_f32_16x16x32_bf16 v[108:111], v[60:63], v[32:35], v[108:111]
    v_mfma_f32_16x16x32_bf16 v[124:127], v[60:63], v[36:39], v[124:127]
    buffer_load_dwordx4 v[60:63], v14, s[44:47], s75 offen offset:1024 sc1
    ds_read_b128 v[28:31], v8 offset:1024
    ds_read_b128 v[32:35], v8 offset:9216
    ds_read_b128 v[36:39], v8 offset:17408
    v_xor_b32 v8, 0x100, v8
    s_waitcnt lgkmcnt(3)
    s_waitcnt vmcnt(9)
    v_mfma_f32_16x16x32_bf16 v[80:83], v[64:67], v[16:19], v[80:83]
    v_mfma_f32_16x16x32_bf16 v[96:99], v[64:67], v[20:23], v[96:99]
    v_mfma_f32_16x16x32_bf16 v[112:115], v[64:67], v[24:27], v[112:115]
    buffer_load_dwordx4 v[64:67], v14, s[44:47], s75 offen offset:2048 sc1
    s_waitcnt vmcnt(9)
    v_mfma_f32_16x16x32_bf16 v[84:87], v[68:71], v[16:19], v[84:87]
    v_mfma_f32_16x16x32_bf16 v[100:103], v[68:71], v[20:23], v[100:103]
    v_mfma_f32_16x16x32_bf16 v[116:119], v[68:71], v[24:27], v[116:119]
    buffer_load_dwordx4 v[68:71], v14, s[44:47], s75 offen offset:3072 sc1
    s_xor_b32 s75, s75, 4096
    s_waitcnt vmcnt(9)
    v_mfma_f32_16x16x32_bf16 v[88:91], v[72:75], v[16:19], v[88:91]
    v_mfma_f32_16x16x32_bf16 v[104:107], v[72:75], v[20:23], v[104:107]
    v_mfma_f32_16x16x32_bf16 v[120:123], v[72:75], v[24:27], v[120:123]
    buffer_load_dwordx4 v[72:75], v14, s[44:47], s75 offen offset:0 sc1
    s_waitcnt vmcnt(9)
    v_mfma_f32_16x16x32_bf16 v[92:95], v[76:79], v[16:19], v[92:95]
    v_mfma_f32_16x16x32_bf16 v[108:111], v[76:79], v[20:23], v[108:111]
    v_mfma_f32_16x16x32_bf16 v[124:127], v[76:79], v[24:27], v[124:127]
    buffer_load_dwordx4 v[76:79], v14, s[44:47], s75 offen offset:1024 sc1
    ds_read_b128 v[16:19], v9 offset:1024
    ds_read_b128 v[20:23], v9 offset:9216
    ds_read_b128 v[24:27], v9 offset:17408
    v_xor_b32 v9, 0x100, v9
    s_waitcnt lgkmcnt(3)
    s_waitcnt vmcnt(9)
    v_mfma_f32_16x16x32_bf16 v[80:83], v[40:43], v[28:31], v[80:83]
    v_mfma_f32_16x16x32_bf16 v[96:99], v[40:43], v[32:35], v[96:99]
    v_mfma_f32_16x16x32_bf16 v[112:115], v[40:43], v[36:39], v[112:115]
    buffer_load_dwordx4 v[40:43], v14, s[44:47], s75 offen offset:2048 sc1
    s_waitcnt vmcnt(9)
    v_mfma_f32_16x16x32_bf16 v[84:87], v[44:47], v[28:31], v[84:87]
    v_mfma_f32_16x16x32_bf16 v[100:103], v[44:47], v[32:35], v[100:103]
    v_mfma_f32_16x16x32_bf16 v[116:119], v[44:47], v[36:39], v[116:119]
    buffer_load_dwordx4 v[44:47], v14, s[44:47], s75 offen offset:3072 sc1
    s_xor_b32 s75, s75, 28672
    s_waitcnt vmcnt(9)
    v_mfma_f32_16x16x32_bf16 v[88:91], v[48:51], v[28:31], v[88:91]
    v_mfma_f32_16x16x32_bf16 v[104:107], v[48:51], v[32:35], v[104:107]
    v_mfma_f32_16x16x32_bf16 v[120:123], v[48:51], v[36:39], v[120:123]
    s_add_u32 m0, s70, 0
    s_nop 0
    buffer_load_dwordx4 v13, s[40:43], 0 offen offset:0 lds
    s_waitcnt vmcnt(9)
    v_mfma_f32_16x16x32_bf16 v[92:95], v[52:55], v[28:31], v[92:95]
    v_mfma_f32_16x16x32_bf16 v[108:111], v[52:55], v[32:35], v[108:111]
    v_mfma_f32_16x16x32_bf16 v[124:127], v[52:55], v[36:39], v[124:127]
    buffer_load_dwordx4 v13, s[40:43], s71 offen offset:1024 lds
    ds_read_b128 v[28:31], v10 offset:1024
    ds_read_b128 v[32:35], v10 offset:9216
    ds_read_b128 v[36:39], v10 offset:17408
    v_xor_b32 v10, 0x100, v10
    s_waitcnt lgkmcnt(3)
    s_waitcnt vmcnt(9)
    v_mfma_f32_16x16x32_bf16 v[80:83], v[56:59], v[16:19], v[80:83]
    v_mfma_f32_16x16x32_bf16 v[96:99], v[56:59], v[20:23], v[96:99]
    v_mfma_f32_16x16x32_bf16 v[112:115], v[56:59], v[24:27], v[112:115]
    buffer_load_dwordx4 v13, s[40:43], s72 offen offset:2048 lds
    s_waitcnt vmcnt(9)
    v_mfma_f32_16x16x32_bf16 v[84:87], v[60:63], v[16:19], v[84:87]
    v_mfma_f32_16x16x32_bf16 v[100:103], v[60:63], v[20:23], v[100:103]
    v_mfma_f32_16x16x32_bf16 v[116:119], v[60:63], v[24:27], v[116:119]
    buffer_load_dwordx4 v13, s[40:43], s73 offen offset:3072 lds
    v_xor_b32 v13, 16384, v13
    s_waitcnt vmcnt(9)
    v_mfma_f32_16x16x32_bf16 v[88:91], v[64:67], v[16:19], v[88:91]
    v_mfma_f32_16x16x32_bf16 v[104:107], v[64:67], v[20:23], v[104:107]
    v_mfma_f32_16x16x32_bf16 v[120:123], v[64:67], v[24:27], v[120:123]
    s_add_u32 m0, s70, 4096
    s_nop 0
    buffer_load_dwordx4 v13, s[40:43], 0 offen offset:0 lds
    s_waitcnt vmcnt(9)
    v_mfma_f32_16x16x32_bf16 v[92:95], v[68:71], v[16:19], v[92:95]
    v_mfma_f32_16x16x32_bf16 v[108:111], v[68:71], v[20:23], v[108:111]
    v_mfma_f32_16x16x32_bf16 v[124:127], v[68:71], v[24:27], v[124:127]
    buffer_load_dwordx4 v13, s[40:43], s71 offen offset:1024 lds
    s_waitcnt lgkmcnt(0)
    s_waitcnt vmcnt(9)
    v_mfma_f32_16x16x32_bf16 v[80:83], v[72:75], v[28:31], v[80:83]
    v_mfma_f32_16x16x32_bf16 v[96:99], v[72:75], v[32:35], v[96:99]
    v_mfma_f32_16x16x32_bf16 v[112:115], v[72:75], v[36:39], v[112:115]
    buffer_load_dwordx4 v13, s[40:43], s72 offen offset:2048 lds
    s_waitcnt vmcnt(9)
    v_mfma_f32_16x16x32_bf16 v[84:87], v[76:79], v[28:31], v[84:87]
    v_mfma_f32_16x16x32_bf16 v[100:103], v[76:79], v[32:35], v[100:103]
    v_mfma_f32_16x16x32_bf16 v[116:119], v[76:79], v[36:39], v[116:119]
    buffer_load_dwordx4 v13, s[40:43], s73 offen offset:3072 lds
    v_xor_b32 v13, 49152, v13
    s_waitcnt vmcnt(9)
    v_mfma_f32_16x16x32_bf16 v[88:91], v[40:43], v[28:31], v[88:91]
    v_mfma_f32_16x16x32_bf16 v[104:107], v[40:43], v[32:35], v[104:107]
    v_mfma_f32_16x16x32_bf16 v[120:123], v[40:43], v[36:39], v[120:123]
    s_add_u32 m0, s70, 8192
    s_nop 0
    buffer_load_dwordx4 v13, s[40:43], 0 offen offset:0 lds
    s_waitcnt vmcnt(9)
    v_mfma_f32_16x16x32_bf16 v[92:95], v[44:47], v[28:31], v[92:95]
    v_mfma_f32_16x16x32_bf16 v[108:111], v[44:47], v[32:35], v[108:111]
    v_mfma_f32_16x16x32_bf16 v[124:127], v[44:47], v[36:39], v[124:127]
    buffer_load_dwordx4 v13, s[40:43], s71 offen offset:1024 lds
    s_lshl_b32 s64, s31, 3
    v_add_u32 v0, s64, v4
    v_xor_b32 v0, v0, v3
    v_lshlrev_b32 v0, 4, v0
    v_lshl_add_u32 v0, v3, 9, v0
    v_xor_b32 v1, 64, v0
    s_mov_b32 s76, 0x00ff00ff
    s_mov_b32 s77, 0x00ff00ff
    v_cvt_pk_bf16_f32 v16, v80, v81
    v_cvt_pk_bf16_f32 v17, v82, v83
    v_cvt_pk_bf16_f32 v18, v84, v85
    v_cvt_pk_bf16_f32 v19, v86, v87
    ds_write_b128 v0, v[16:19] offset:21504
    v_cvt_pk_bf16_f32 v20, v88, v89
    v_cvt_pk_bf16_f32 v21, v90, v91
    v_cvt_pk_bf16_f32 v22, v92, v93
    v_cvt_pk_bf16_f32 v23, v94, v95
    ds_write_b128 v1, v[20:23] offset:21504
    v_cvt_pk_bf16_f32 v24, v96, v97
    v_cvt_pk_bf16_f32 v25, v98, v99
    v_cvt_pk_bf16_f32 v26, v100, v101
    v_cvt_pk_bf16_f32 v27, v102, v103
    ds_write_b128 v0, v[24:27] offset:29696
    v_cvt_pk_bf16_f32 v28, v104, v105
    v_cvt_pk_bf16_f32 v29, v106, v107
    v_cvt_pk_bf16_f32 v30, v108, v109
    v_cvt_pk_bf16_f32 v31, v110, v111
    ds_write_b128 v1, v[28:31] offset:29696
    s_mov_b64 exec, s[76:77]
    v_cvt_pk_bf16_f32 v32, v112, v113
    v_cvt_pk_bf16_f32 v33, v114, v115
    v_cvt_pk_bf16_f32 v34, v116, v117
    v_cvt_pk_bf16_f32 v35, v118, v119
    ds_write_b128 v0, v[32:35] offset:37888
    v_cvt_pk_bf16_f32 v36, v120, v121
    v_cvt_pk_bf16_f32 v37, v122, v123
    v_cvt_pk_bf16_f32 v38, v124, v125
    v_cvt_pk_bf16_f32 v39, v126, v127
    ds_write_b128 v1, v[36:39] offset:37888
    s_mov_b64 exec, -1
    s_waitcnt lgkmcnt(0)
    s_barrier
    buffer_load_dwordx4 v13, s[40:43], s72 offen offset:2048 lds
    buffer_load_dwordx4 v13, s[40:43], s73 offen offset:3072 lds
    v_xor_b32 v13, 16384, v13
    s_add_u32 m0, s70, 12288
    s_nop 0
    buffer_load_dwordx4 v13, s[40:43], 0 offen offset:0 lds
    buffer_load_dwordx4 v13, s[40:43], s71 offen offset:1024 lds
    buffer_load_dwordx4 v13, s[40:43], s72 offen offset:2048 lds
    buffer_load_dwordx4 v13, s[40:43], s73 offen offset:3072 lds
    v_xor_b32 v13, 114688, v13
    v_lshlrev_b32 v0, 4, v4
    v_and_b32 v1, 7, v3
    v_lshl_add_u32 v0, v1, 9, v0
    v_and_b32 v1, 8, v3
    v_lshl_add_u32 v0, v1, 3, v0
    s_mul_i32 s74, s1, 20480
    s_lshl_b32 s64, s31, 7
    s_add_u32 s74, s74, s64
    s_waitcnt vmcnt(8)
    ds_read_b64_tr_b16 v[48:49], v11 offset:0
    ds_read_b64_tr_b16 v[50:51], v11 offset:512
    ds_read_b64_tr_b16 v[52:53], v11 offset:8
    ds_read_b64_tr_b16 v[54:55], v11 offset:520
    ds_read_b64_tr_b16 v[56:57], v12 offset:0
    ds_read_b64_tr_b16 v[58:59], v12 offset:512
    ds_read_b64_tr_b16 v[60:61], v12 offset:8
    ds_read_b64_tr_b16 v[62:63], v12 offset:520
    ds_read_b64_tr_b16 v[64:65], v11 offset:4096
    ds_read_b64_tr_b16 v[66:67], v11 offset:4608
    ds_read_b64_tr_b16 v[68:69], v11 offset:4104
    ds_read_b64_tr_b16 v[70:71], v11 offset:4616
    ds_read_b64_tr_b16 v[72:73], v12 offset:4096
    ds_read_b64_tr_b16 v[74:75], v12 offset:4608
    ds_read_b64_tr_b16 v[76:77], v12 offset:4104
    ds_read_b64_tr_b16 v[78:79], v12 offset:4616
    s_waitcnt lgkmcnt(8)
    s_add_u32 m0, s70, 0
    s_nop 0
    buffer_load_dwordx4 v13, s[40:43], 0 offen offset:0 lds
    buffer_load_dwordx4 v13, s[40:43], s71 offen offset:1024 lds
    buffer_load_dwordx4 v13, s[40:43], s72 offen offset:2048 lds
    buffer_load_dwordx4 v13, s[40:43], s73 offen offset:3072 lds
    v_xor_b32 v13, 16384, v13
    s_waitcnt lgkmcnt(0)
    s_add_u32 m0, s70, 4096
    s_nop 0
    buffer_load_dwordx4 v13, s[40:43], 0 offen offset:0 lds
    buffer_load_dwordx4 v13, s[40:43], s71 offen offset:1024 lds
    buffer_load_dwordx4 v13, s[40:43], s72 offen offset:2048 lds
    buffer_load_dwordx4 v13, s[40:43], s73 offen offset:3072 lds
    v_xor_b32 v13, 49152, v13
    s_lshl_b32 s64, s31, 12
    s_add_u32 s78, s64, 21504
    s_add_u32 s79, s64, 148480
    s_cmp_eq_u32 s31, 3
    s_cselect_b32 s79, 37888, s79
    s_sub_u32 s76, s78, s70
    s_sub_u32 s77, s79, s78
    v_xor_b32 v40, 0x100, v7
    v_xor_b32 v41, 0x100, v8
    v_xor_b32 v42, 0x100, v9
    v_xor_b32 v43, 0x100, v10
    s_barrier
    s_mov_b32 m0, s78
    s_nop 0
    buffer_load_dwordx4 v13, s[40:43], 0 offen offset:0 lds
    buffer_load_dwordx4 v13, s[40:43], s71 offen offset:1024 lds
    buffer_load_dwordx4 v13, s[40:43], s72 offen offset:2048 lds
    buffer_load_dwordx4 v13, s[40:43], s73 offen offset:3072 lds
    v_xor_b32 v13, 16384, v13
    s_mov_b32 m0, s79
    s_nop 0
    buffer_load_dwordx4 v13, s[40:43], 0 offen offset:0 lds
    buffer_load_dwordx4 v13, s[40:43], s71 offen offset:1024 lds
    buffer_load_dwordx4 v13, s[40:43], s72 offen offset:2048 lds
    buffer_load_dwordx4 v13, s[40:43], s73 offen offset:3072 lds
    v_xor_b32 v13, 114688, v13
    s_setprio 0
L_prog_39:
    ds_read_b128 v[16:19], v5 offset:32
    s_waitcnt lgkmcnt(0)
    v_min3_u32 v16, v16, v17, v18
    v_min_u32 v16, v16, v19
    v_cmp_gt_u32 vcc, 1, v16
    s_cbranch_vccnz L_retry_40
    ds_read_b128 v[16:19], v7 offset:1024
    ds_read_b128 v[20:23], v7 offset:9216
    ds_read_b128 v[24:27], v7 offset:17408
    s_waitcnt vmcnt(8)
    s_waitcnt lgkmcnt(0)
    v_mfma_f32_16x16x32_bf16 v[80:83], v[128:131], v[16:19], 0
    ds_read_b128 v[28:31], v8 offset:1024
    v_mfma_f32_16x16x32_bf16 v[96:99], v[128:131], v[20:23], 0
    ds_read_b128 v[32:35], v8 offset:9216
    v_mfma_f32_16x16x32_bf16 v[112:115], v[128:131], v[24:27], 0
    ds_read_b128 v[36:39], v8 offset:17408
    v_mfma_f32_16x16x32_bf16 v[84:87], v[132:135], v[16:19], 0
    v_mfma_f32_16x16x32_bf16 v[100:103], v[132:135], v[20:23], 0
    v_mfma_f32_16x16x32_bf16 v[116:119], v[132:135], v[24:27], 0
    v_mfma_f32_16x16x32_bf16 v[88:91], v[136:139], v[16:19], 0
    v_mfma_f32_16x16x32_bf16 v[104:107], v[136:139], v[20:23], 0
    v_mfma_f32_16x16x32_bf16 v[120:123], v[136:139], v[24:27], 0
    v_mfma_f32_16x16x32_bf16 v[92:95], v[140:143], v[16:19], 0
    v_mfma_f32_16x16x32_bf16 v[108:111], v[140:143], v[20:23], 0
    v_mfma_f32_16x16x32_bf16 v[124:127], v[140:143], v[24:27], 0
    s_waitcnt lgkmcnt(0)
    v_mfma_f32_16x16x32_bf16 v[80:83], v[144:147], v[28:31], v[80:83]
    ds_read_b128 v[16:19], v9 offset:1024
    v_mfma_f32_16x16x32_bf16 v[96:99], v[144:147], v[32:35], v[96:99]
    ds_read_b128 v[20:23], v9 offset:9216
    v_mfma_f32_16x16x32_bf16 v[112:115], v[144:147], v[36:39], v[112:115]
    ds_read_b128 v[24:27], v9 offset:17408
    v_mfma_f32_16x16x32_bf16 v[84:87], v[148:151], v[28:31], v[84:87]
    ds_read_b64_tr_b16 v[128:129], v11 offset:8192
    v_mfma_f32_16x16x32_bf16 v[100:103], v[148:151], v[32:35], v[100:103]
    ds_read_b64_tr_b16 v[130:131], v11 offset:8704
    v_mfma_f32_16x16x32_bf16 v[116:119], v[148:151], v[36:39], v[116:119]
    ds_read_b64_tr_b16 v[132:133], v11 offset:8200
    v_mfma_f32_16x16x32_bf16 v[88:91], v[152:155], v[28:31], v[88:91]
    ds_read_b64_tr_b16 v[134:135], v11 offset:8712
    v_mfma_f32_16x16x32_bf16 v[104:107], v[152:155], v[32:35], v[104:107]
    ds_read_b64_tr_b16 v[136:137], v12 offset:8192
    v_mfma_f32_16x16x32_bf16 v[120:123], v[152:155], v[36:39], v[120:123]
    ds_read_b64_tr_b16 v[138:139], v12 offset:8704
    v_mfma_f32_16x16x32_bf16 v[92:95], v[156:159], v[28:31], v[92:95]
    ds_read_b64_tr_b16 v[140:141], v12 offset:8200
    v_mfma_f32_16x16x32_bf16 v[108:111], v[156:159], v[32:35], v[108:111]
    ds_read_b64_tr_b16 v[142:143], v12 offset:8712
    v_mfma_f32_16x16x32_bf16 v[124:127], v[156:159], v[36:39], v[124:127]
    s_waitcnt lgkmcnt(8)
    v_mfma_f32_16x16x32_bf16 v[80:83], v[160:163], v[16:19], v[80:83]
    ds_read_b128 v[28:31], v10 offset:1024
    v_mfma_f32_16x16x32_bf16 v[96:99], v[160:163], v[20:23], v[96:99]
    ds_read_b128 v[32:35], v10 offset:9216
    v_mfma_f32_16x16x32_bf16 v[112:115], v[160:163], v[24:27], v[112:115]
    ds_read_b128 v[36:39], v10 offset:17408
    v_mfma_f32_16x16x32_bf16 v[84:87], v[164:167], v[16:19], v[84:87]
    ds_read_b64_tr_b16 v[144:145], v11 offset:12288
    v_mfma_f32_16x16x32_bf16 v[100:103], v[164:167], v[20:23], v[100:103]
    ds_read_b64_tr_b16 v[146:147], v11 offset:12800
    v_mfma_f32_16x16x32_bf16 v[116:119], v[164:167], v[24:27], v[116:119]
    ds_read_b64_tr_b16 v[148:149], v11 offset:12296
    v_mfma_f32_16x16x32_bf16 v[88:91], v[168:171], v[16:19], v[88:91]
    ds_read_b64_tr_b16 v[150:151], v11 offset:12808
    v_mfma_f32_16x16x32_bf16 v[104:107], v[168:171], v[20:23], v[104:107]
    ds_read_b64_tr_b16 v[152:153], v12 offset:12288
    v_mfma_f32_16x16x32_bf16 v[120:123], v[168:171], v[24:27], v[120:123]
    ds_read_b64_tr_b16 v[154:155], v12 offset:12800
    v_mfma_f32_16x16x32_bf16 v[92:95], v[172:175], v[16:19], v[92:95]
    ds_read_b64_tr_b16 v[156:157], v12 offset:12296
    v_mfma_f32_16x16x32_bf16 v[108:111], v[172:175], v[20:23], v[108:111]
    ds_read_b64_tr_b16 v[158:159], v12 offset:12808
    v_mfma_f32_16x16x32_bf16 v[124:127], v[172:175], v[24:27], v[124:127]
    s_waitcnt lgkmcnt(8)
    v_mfma_f32_16x16x32_bf16 v[80:83], v[176:179], v[28:31], v[80:83]
    ds_read_b128 v[16:19], v40 offset:1024
    v_mfma_f32_16x16x32_bf16 v[96:99], v[176:179], v[32:35], v[96:99]
    ds_read_b128 v[20:23], v40 offset:9216
    v_mfma_f32_16x16x32_bf16 v[112:115], v[176:179], v[36:39], v[112:115]
    ds_read_b128 v[24:27], v40 offset:17408
    v_mfma_f32_16x16x32_bf16 v[84:87], v[180:183], v[28:31], v[84:87]
    ds_read_b64_tr_b16 v[160:161], v11 offset:0
    v_mfma_f32_16x16x32_bf16 v[100:103], v[180:183], v[32:35], v[100:103]
    ds_read_b64_tr_b16 v[162:163], v11 offset:512
    v_mfma_f32_16x16x32_bf16 v[116:119], v[180:183], v[36:39], v[116:119]
    ds_read_b64_tr_b16 v[164:165], v11 offset:8
    v_mfma_f32_16x16x32_bf16 v[88:91], v[184:187], v[28:31], v[88:91]
    ds_read_b64_tr_b16 v[166:167], v11 offset:520
    v_mfma_f32_16x16x32_bf16 v[104:107], v[184:187], v[32:35], v[104:107]
    ds_read_b64_tr_b16 v[168:169], v12 offset:0
    v_mfma_f32_16x16x32_bf16 v[120:123], v[184:187], v[36:39], v[120:123]
    ds_read_b64_tr_b16 v[170:171], v12 offset:512
    v_mfma_f32_16x16x32_bf16 v[92:95], v[188:191], v[28:31], v[92:95]
    ds_read_b64_tr_b16 v[172:173], v12 offset:8
    v_mfma_f32_16x16x32_bf16 v[108:111], v[188:191], v[32:35], v[108:111]
    ds_read_b64_tr_b16 v[174:175], v12 offset:520
    v_mfma_f32_16x16x32_bf16 v[124:127], v[188:191], v[36:39], v[124:127]
    s_waitcnt lgkmcnt(8)
    v_mfma_f32_16x16x32_bf16 v[80:83], v[192:195], v[16:19], v[80:83]
    ds_read_b128 v[28:31], v41 offset:1024
    v_mfma_f32_16x16x32_bf16 v[96:99], v[192:195], v[20:23], v[96:99]
    ds_read_b128 v[32:35], v41 offset:9216
    v_mfma_f32_16x16x32_bf16 v[112:115], v[192:195], v[24:27], v[112:115]
    ds_read_b128 v[36:39], v41 offset:17408
    v_mfma_f32_16x16x32_bf16 v[84:87], v[196:199], v[16:19], v[84:87]
    ds_read_b64_tr_b16 v[176:177], v11 offset:4096
    v_mfma_f32_16x16x32_bf16 v[100:103], v[196:199], v[20:23], v[100:103]
    ds_read_b64_tr_b16 v[178:179], v11 offset:4608
    v_mfma_f32_16x16x32_bf16 v[116:119], v[196:199], v[24:27], v[116:119]
    ds_read_b64_tr_b16 v[180:181], v11 offset:4104
    v_mfma_f32_16x16x32_bf16 v[88:91], v[200:203], v[16:19], v[88:91]
    ds_read_b64_tr_b16 v[182:183], v11 offset:4616
    v_mfma_f32_16x16x32_bf16 v[104:107], v[200:203], v[20:23], v[104:107]
    ds_read_b64_tr_b16 v[184:185], v12 offset:4096
    v_mfma_f32_16x16x32_bf16 v[120:123], v[200:203], v[24:27], v[120:123]
    ds_read_b64_tr_b16 v[186:187], v12 offset:4608
    v_mfma_f32_16x16x32_bf16 v[92:95], v[204:207], v[16:19], v[92:95]
    ds_read_b64_tr_b16 v[188:189], v12 offset:4104
    v_mfma_f32_16x16x32_bf16 v[108:111], v[204:207], v[20:23], v[108:111]
    ds_read_b64_tr_b16 v[190:191], v12 offset:4616
    v_mfma_f32_16x16x32_bf16 v[124:127], v[204:207], v[24:27], v[124:127]
    s_waitcnt lgkmcnt(8)
    v_mfma_f32_16x16x32_bf16 v[80:83], v[208:211], v[28:31], v[80:83]
    ds_read_b128 v[16:19], v42 offset:1024
    v_mfma_f32_16x16x32_bf16 v[96:99], v[208:211], v[32:35], v[96:99]
    ds_read_b128 v[20:23], v42 offset:9216
    v_mfma_f32_16x16x32_bf16 v[112:115], v[208:211], v[36:39], v[112:115]
    ds_read_b128 v[24:27], v42 offset:17408
    v_mfma_f32_16x16x32_bf16 v[84:87], v[212:215], v[28:31], v[84:87]
    v_mfma_f32_16x16x32_bf16 v[100:103], v[212:215], v[32:35], v[100:103]
    v_mfma_f32_16x16x32_bf16 v[116:119], v[212:215], v[36:39], v[116:119]
    v_mfma_f32_16x16x32_bf16 v[88:91], v[216:219], v[28:31], v[88:91]
    v_mfma_f32_16x16x32_bf16 v[104:107], v[216:219], v[32:35], v[104:107]
    v_mfma_f32_16x16x32_bf16 v[120:123], v[216:219], v[36:39], v[120:123]
    v_mfma_f32_16x16x32_bf16 v[92:95], v[220:223], v[28:31], v[92:95]
    v_mfma_f32_16x16x32_bf16 v[108:111], v[220:223], v[32:35], v[108:111]
    v_mfma_f32_16x16x32_bf16 v[124:127], v[220:223], v[36:39], v[124:127]
    s_waitcnt lgkmcnt(0)
    v_mfma_f32_16x16x32_bf16 v[80:83], v[224:227], v[16:19], v[80:83]
    v_add_u32 v11, s76, v11
    v_add_u32 v12, s76, v12
    v_mfma_f32_16x16x32_bf16 v[96:99], v[224:227], v[20:23], v[96:99]
    ds_read_b128 v[28:31], v43 offset:1024
    v_mfma_f32_16x16x32_bf16 v[112:115], v[224:227], v[24:27], v[112:115]
    ds_read_b128 v[32:35], v43 offset:9216
    v_mfma_f32_16x16x32_bf16 v[84:87], v[228:231], v[16:19], v[84:87]
    ds_read_b128 v[36:39], v43 offset:17408
    v_mfma_f32_16x16x32_bf16 v[100:103], v[228:231], v[20:23], v[100:103]
    s_waitcnt vmcnt(4)
    ds_read_b64_tr_b16 v[192:193], v11 offset:0
    v_mfma_f32_16x16x32_bf16 v[116:119], v[228:231], v[24:27], v[116:119]
    ds_read_b64_tr_b16 v[194:195], v11 offset:512
    v_mfma_f32_16x16x32_bf16 v[88:91], v[232:235], v[16:19], v[88:91]
    ds_read_b64_tr_b16 v[196:197], v11 offset:8
    v_mfma_f32_16x16x32_bf16 v[104:107], v[232:235], v[20:23], v[104:107]
    ds_read_b64_tr_b16 v[198:199], v11 offset:520
    v_mfma_f32_16x16x32_bf16 v[120:123], v[232:235], v[24:27], v[120:123]
    ds_read_b64_tr_b16 v[200:201], v12 offset:0
    v_mfma_f32_16x16x32_bf16 v[92:95], v[236:239], v[16:19], v[92:95]
    ds_read_b64_tr_b16 v[202:203], v12 offset:512
    v_mfma_f32_16x16x32_bf16 v[108:111], v[236:239], v[20:23], v[108:111]
    ds_read_b64_tr_b16 v[204:205], v12 offset:8
    v_mfma_f32_16x16x32_bf16 v[124:127], v[236:239], v[24:27], v[124:127]
    ds_read_b64_tr_b16 v[206:207], v12 offset:520
    s_waitcnt lgkmcnt(8)
    v_mfma_f32_16x16x32_bf16 v[80:83], v[240:243], v[28:31], v[80:83]
    v_add_u32 v11, s77, v11
    v_add_u32 v12, s77, v12
    v_mfma_f32_16x16x32_bf16 v[96:99], v[240:243], v[32:35], v[96:99]
    s_waitcnt vmcnt(0)
    ds_read_b64_tr_b16 v[208:209], v11 offset:0
    v_mfma_f32_16x16x32_bf16 v[112:115], v[240:243], v[36:39], v[112:115]
    ds_read_b64_tr_b16 v[210:211], v11 offset:512
    v_mfma_f32_16x16x32_bf16 v[84:87], v[244:247], v[28:31], v[84:87]
    ds_read_b64_tr_b16 v[212:213], v11 offset:8
    v_mfma_f32_16x16x32_bf16 v[100:103], v[244:247], v[32:35], v[100:103]
    ds_read_b64_tr_b16 v[214:215], v11 offset:520
    v_mfma_f32_16x16x32_bf16 v[116:119], v[244:247], v[36:39], v[116:119]
    ds_read_b64_tr_b16 v[216:217], v12 offset:0
    v_mfma_f32_16x16x32_bf16 v[88:91], v[248:251], v[28:31], v[88:91]
    ds_read_b64_tr_b16 v[218:219], v12 offset:512
    v_mfma_f32_16x16x32_bf16 v[104:107], v[248:251], v[32:35], v[104:107]
    ds_read_b64_tr_b16 v[220:221], v12 offset:8
    v_mfma_f32_16x16x32_bf16 v[120:123], v[248:251], v[36:39], v[120:123]
    ds_read_b64_tr_b16 v[222:223], v12 offset:520
    v_mfma_f32_16x16x32_bf16 v[92:95], v[252:255], v[28:31], v[92:95]
    v_mfma_f32_16x16x32_bf16 v[108:111], v[252:255], v[32:35], v[108:111]
    v_mfma_f32_16x16x32_bf16 v[124:127], v[252:255], v[36:39], v[124:127]
    s_add_u32 s75, s74, 4096
    s_add_u32 s76, s74, 8192
    s_add_u32 s77, s74, 12288
    s_add_u32 s78, s74, 16384
L_prog_41:
    ds_read_b128 v[16:19], v5 offset:32
    s_waitcnt lgkmcnt(0)
    v_min3_u32 v16, v16, v17, v18
    v_min_u32 v16, v16, v19
    v_cmp_gt_u32 vcc, 1, v16
    s_cbranch_vccnz L_retry_42
    ds_read_b128 v[16:19], v7 offset:58368
    ds_read_b128 v[20:23], v8 offset:58368
    ds_read_b128 v[24:27], v9 offset:58368
    ds_read_b128 v[28:31], v10 offset:58368
    ds_read_b128 v[32:35], v40 offset:58368
    ds_read_b128 v[36:39], v41 offset:58368
    ds_read_b128 v[44:47], v42 offset:58368
    ds_read_b128 v[252:255], v43 offset:58368
    s_waitcnt lgkmcnt(7)
    v_mfma_f32_16x16x32_bf16 v[120:123], v[56:59], v[16:19], v[120:123]
    v_mfma_f32_16x16x32_bf16 v[124:127], v[60:63], v[16:19], v[124:127]
    v_mfma_f32_16x16x32_bf16 v[112:115], v[48:51], v[16:19], v[112:115]
    v_mfma_f32_16x16x32_bf16 v[116:119], v[52:55], v[16:19], v[116:119]
    s_waitcnt lgkmcnt(6)
    v_mfma_f32_16x16x32_bf16 v[120:123], v[72:75], v[20:23], v[120:123]
    v_mfma_f32_16x16x32_bf16 v[124:127], v[76:79], v[20:23], v[124:127]
    v_mfma_f32_16x16x32_bf16 v[112:115], v[64:67], v[20:23], v[112:115]
    v_mfma_f32_16x16x32_bf16 v[116:119], v[68:71], v[20:23], v[116:119]
    s_waitcnt lgkmcnt(5)
    v_mfma_f32_16x16x32_bf16 v[120:123], v[136:139], v[24:27], v[120:123]
    v_mfma_f32_16x16x32_bf16 v[124:127], v[140:143], v[24:27], v[124:127]
    v_mfma_f32_16x16x32_bf16 v[112:115], v[128:131], v[24:27], v[112:115]
    v_mfma_f32_16x16x32_bf16 v[116:119], v[132:135], v[24:27], v[116:119]
    s_waitcnt lgkmcnt(4)
    v_mfma_f32_16x16x32_bf16 v[120:123], v[152:155], v[28:31], v[120:123]
    v_mfma_f32_16x16x32_bf16 v[124:127], v[156:159], v[28:31], v[124:127]
    v_mfma_f32_16x16x32_bf16 v[112:115], v[144:147], v[28:31], v[112:115]
    v_mfma_f32_16x16x32_bf16 v[116:119], v[148:151], v[28:31], v[116:119]
    s_waitcnt lgkmcnt(3)
    v_mfma_f32_16x16x32_bf16 v[120:123], v[168:171], v[32:35], v[120:123]
    v_mfma_f32_16x16x32_bf16 v[124:127], v[172:175], v[32:35], v[124:127]
    v_mfma_f32_16x16x32_bf16 v[112:115], v[160:163], v[32:35], v[112:115]
    v_mfma_f32_16x16x32_bf16 v[116:119], v[164:167], v[32:35], v[116:119]
    s_waitcnt lgkmcnt(2)
    v_mfma_f32_16x16x32_bf16 v[120:123], v[184:187], v[36:39], v[120:123]
    v_mfma_f32_16x16x32_bf16 v[124:127], v[188:191], v[36:39], v[124:127]
    v_mfma_f32_16x16x32_bf16 v[112:115], v[176:179], v[36:39], v[112:115]
    v_mfma_f32_16x16x32_bf16 v[116:119], v[180:183], v[36:39], v[116:119]
    s_waitcnt lgkmcnt(1)
    v_mfma_f32_16x16x32_bf16 v[120:123], v[200:203], v[44:47], v[120:123]
    v_mfma_f32_16x16x32_bf16 v[124:127], v[204:207], v[44:47], v[124:127]
    v_mfma_f32_16x16x32_bf16 v[112:115], v[192:195], v[44:47], v[112:115]
    v_mfma_f32_16x16x32_bf16 v[116:119], v[196:199], v[44:47], v[116:119]
    s_waitcnt lgkmcnt(0)
    v_mfma_f32_16x16x32_bf16 v[120:123], v[216:219], v[252:255], v[120:123]
    v_mfma_f32_16x16x32_bf16 v[124:127], v[220:223], v[252:255], v[124:127]
    v_mfma_f32_16x16x32_bf16 v[112:115], v[208:211], v[252:255], v[112:115]
    v_mfma_f32_16x16x32_bf16 v[116:119], v[212:215], v[252:255], v[116:119]
L_prog_43:
    ds_read_b128 v[16:19], v5 offset:32
    s_waitcnt lgkmcnt(0)
    v_min3_u32 v16, v16, v17, v18
    v_min_u32 v16, v16, v19
    v_cmp_gt_u32 vcc, 3, v16
    s_cbranch_vccnz L_retry_44
    ds_read_b128 v[16:19], v7 offset:41984
    ds_read_b128 v[20:23], v8 offset:41984
    ds_read_b128 v[24:27], v9 offset:41984
    ds_read_b128 v[28:31], v10 offset:41984
    ds_read_b128 v[32:35], v40 offset:41984
    ds_read_b128 v[36:39], v41 offset:41984
    ds_read_b128 v[44:47], v42 offset:41984
    ds_read_b128 v[252:255], v43 offset:41984
    s_waitcnt lgkmcnt(7)
    v_mfma_f32_16x16x32_bf16 v[88:91], v[56:59], v[16:19], v[88:91]
    v_cvt_pk_bf16_f32 v248, v120, v121
    v_mfma_f32_16x16x32_bf16 v[92:95], v[60:63], v[16:19], v[92:95]
    v_cvt_pk_bf16_f32 v249, v122, v123
    v_mfma_f32_16x16x32_bf16 v[80:83], v[48:51], v[16:19], v[80:83]
    v_cvt_pk_bf16_f32 v250, v124, v125
    v_mfma_f32_16x16x32_bf16 v[84:87], v[52:55], v[16:19], v[84:87]
    v_cvt_pk_bf16_f32 v251, v126, v127
    s_waitcnt lgkmcnt(6)
    v_mfma_f32_16x16x32_bf16 v[88:91], v[72:75], v[20:23], v[88:91]
    v_cvt_pk_bf16_f32 v244, v112, v113
    v_mfma_f32_16x16x32_bf16 v[92:95], v[76:79], v[20:23], v[92:95]
    v_cvt_pk_bf16_f32 v245, v114, v115
    v_mfma_f32_16x16x32_bf16 v[80:83], v[64:67], v[20:23], v[80:83]
    v_cvt_pk_bf16_f32 v246, v116, v117
    v_mfma_f32_16x16x32_bf16 v[84:87], v[68:71], v[20:23], v[84:87]
    v_cvt_pk_bf16_f32 v247, v118, v119
    s_waitcnt lgkmcnt(5)
    v_mfma_f32_16x16x32_bf16 v[88:91], v[136:139], v[24:27], v[88:91]
    v_mov_b32_dpp v244, v248 row_ror:8 row_mask:0xf bank_mask:0xc
    v_mfma_f32_16x16x32_bf16 v[92:95], v[140:143], v[24:27], v[92:95]
    v_mov_b32_dpp v245, v249 row_ror:8 row_mask:0xf bank_mask:0xc
    v_mfma_f32_16x16x32_bf16 v[80:83], v[128:131], v[24:27], v[80:83]
    v_mov_b32_dpp v246, v250 row_ror:8 row_mask:0xf bank_mask:0xc
    v_mfma_f32_16x16x32_bf16 v[84:87], v[132:135], v[24:27], v[84:87]
    v_mov_b32_dpp v247, v251 row_ror:8 row_mask:0xf bank_mask:0xc
    s_waitcnt lgkmcnt(4)
    v_mfma_f32_16x16x32_bf16 v[88:91], v[152:155], v[28:31], v[88:91]
    v_mfma_f32_16x16x32_bf16 v[92:95], v[156:159], v[28:31], v[92:95]
    v_mfma_f32_16x16x32_bf16 v[80:83], v[144:147], v[28:31], v[80:83]
    v_mfma_f32_16x16x32_bf16 v[84:87], v[148:151], v[28:31], v[84:87]
    s_waitcnt lgkmcnt(3)
    v_mfma_f32_16x16x32_bf16 v[88:91], v[168:171], v[32:35], v[88:91]
    v_mfma_f32_16x16x32_bf16 v[92:95], v[172:175], v[32:35], v[92:95]
    v_mfma_f32_16x16x32_bf16 v[80:83], v[160:163], v[32:35], v[80:83]
    v_mfma_f32_16x16x32_bf16 v[84:87], v[164:167], v[32:35], v[84:87]
    s_waitcnt lgkmcnt(2)
    v_mfma_f32_16x16x32_bf16 v[88:91], v[184:187], v[36:39], v[88:91]
    v_mfma_f32_16x16x32_bf16 v[92:95], v[188:191], v[36:39], v[92:95]
    v_mfma_f32_16x16x32_bf16 v[80:83], v[176:179], v[36:39], v[80:83]
    v_mfma_f32_16x16x32_bf16 v[84:87], v[180:183], v[36:39], v[84:87]
    s_waitcnt lgkmcnt(1)
    v_mfma_f32_16x16x32_bf16 v[88:91], v[200:203], v[44:47], v[88:91]
    v_mfma_f32_16x16x32_bf16 v[92:95], v[204:207], v[44:47], v[92:95]
    v_mfma_f32_16x16x32_bf16 v[80:83], v[192:195], v[44:47], v[80:83]
    v_mfma_f32_16x16x32_bf16 v[84:87], v[196:199], v[44:47], v[84:87]
    s_waitcnt lgkmcnt(0)
    v_mfma_f32_16x16x32_bf16 v[88:91], v[216:219], v[252:255], v[88:91]
    v_mfma_f32_16x16x32_bf16 v[92:95], v[220:223], v[252:255], v[92:95]
    v_mfma_f32_16x16x32_bf16 v[80:83], v[208:211], v[252:255], v[80:83]
    v_mfma_f32_16x16x32_bf16 v[84:87], v[212:215], v[252:255], v[84:87]
    s_nop 4
    v_cvt_pk_bf16_f32 v228, v88, v89
    v_cvt_pk_bf16_f32 v229, v90, v91
    v_cvt_pk_bf16_f32 v230, v92, v93
    v_cvt_pk_bf16_f32 v231, v94, v95
    v_cvt_pk_bf16_f32 v224, v80, v81
    v_cvt_pk_bf16_f32 v225, v82, v83
    v_cvt_pk_bf16_f32 v226, v84, v85
    v_cvt_pk_bf16_f32 v227, v86, v87
    v_cvt_pk_bf16_f32 v240, v80, v81
    v_cvt_pk_bf16_f32 v241, v82, v83
    v_cvt_pk_bf16_f32 v242, v84, v85
    v_cvt_pk_bf16_f32 v243, v86, v87
    v_mov_b32_dpp v224, v228 row_ror:8 row_mask:0xf bank_mask:0xc
    v_mov_b32_dpp v225, v229 row_ror:8 row_mask:0xf bank_mask:0xc
    v_mov_b32_dpp v226, v230 row_ror:8 row_mask:0xf bank_mask:0xc
    v_mov_b32_dpp v227, v231 row_ror:8 row_mask:0xf bank_mask:0xc
    v_mov_b32_dpp v228, v240 row_ror:8 row_mask:0xf bank_mask:0x3
    v_mov_b32_dpp v229, v241 row_ror:8 row_mask:0xf bank_mask:0x3
    v_mov_b32_dpp v230, v242 row_ror:8 row_mask:0xf bank_mask:0x3
    v_mov_b32_dpp v231, v243 row_ror:8 row_mask:0xf bank_mask:0x3
L_prog_45:
    ds_read_b128 v[16:19], v5 offset:48
    s_waitcnt lgkmcnt(0)
    v_min3_u32 v16, v16, v17, v18
    v_min_u32 v16, v16, v19
    v_cmp_gt_u32 vcc, 1, v16
    s_cbranch_vccnz L_retry_46
    s_setprio 2
    buffer_store_dwordx4 v[244:247], v0, s[48:51], s78 offen sc1
    buffer_store_dwordx4 v[224:227], v0, s[48:51], s74 offen sc1
    buffer_store_dwordx4 v[228:231], v0, s[48:51], s75 offen sc1
    s_setprio 0
    v_lshlrev_b32 v1, 4, v4
    v_lshl_add_u32 v1, v3, 9, v1
    s_barrier
    s_setprio 2
    ds_read_b128 v[16:19], v7 offset:50176
    ds_read_b128 v[20:23], v8 offset:50176
    ds_read_b128 v[24:27], v9 offset:50176
    ds_read_b128 v[28:31], v10 offset:50176
    ds_read_b128 v[32:35], v40 offset:50176
    ds_read_b128 v[36:39], v41 offset:50176
    ds_read_b128 v[44:47], v42 offset:50176
    ds_read_b128 v[252:255], v43 offset:50176
    s_waitcnt lgkmcnt(7)
    v_mfma_f32_16x16x32_bf16 v[104:107], v[56:59], v[16:19], v[104:107]
    v_mfma_f32_16x16x32_bf16 v[108:111], v[60:63], v[16:19], v[108:111]
    s_waitcnt lgkmcnt(6)
    v_mfma_f32_16x16x32_bf16 v[104:107], v[72:75], v[20:23], v[104:107]
    v_mfma_f32_16x16x32_bf16 v[108:111], v[76:79], v[20:23], v[108:111]
    s_waitcnt lgkmcnt(5)
    v_mfma_f32_16x16x32_bf16 v[104:107], v[136:139], v[24:27], v[104:107]
    v_mfma_f32_16x16x32_bf16 v[108:111], v[140:143], v[24:27], v[108:111]
    s_waitcnt lgkmcnt(4)
    v_mfma_f32_16x16x32_bf16 v[104:107], v[152:155], v[28:31], v[104:107]
    v_mfma_f32_16x16x32_bf16 v[108:111], v[156:159], v[28:31], v[108:111]
    s_waitcnt lgkmcnt(3)
    v_mfma_f32_16x16x32_bf16 v[104:107], v[168:171], v[32:35], v[104:107]
    v_mfma_f32_16x16x32_bf16 v[108:111], v[172:175], v[32:35], v[108:111]
    s_waitcnt lgkmcnt(2)
    v_mfma_f32_16x16x32_bf16 v[104:107], v[184:187], v[36:39], v[104:107]
    v_mfma_f32_16x16x32_bf16 v[108:111], v[188:191], v[36:39], v[108:111]
    s_waitcnt lgkmcnt(1)
    v_mfma_f32_16x16x32_bf16 v[104:107], v[200:203], v[44:47], v[104:107]
    v_mfma_f32_16x16x32_bf16 v[108:111], v[204:207], v[44:47], v[108:111]
    s_waitcnt lgkmcnt(0)
    v_mfma_f32_16x16x32_bf16 v[104:107], v[216:219], v[252:255], v[104:107]
    v_mfma_f32_16x16x32_bf16 v[108:111], v[220:223], v[252:255], v[108:111]
    v_mfma_f32_16x16x32_bf16 v[96:99], v[48:51], v[16:19], v[96:99]
    v_mfma_f32_16x16x32_bf16 v[100:103], v[52:55], v[16:19], v[100:103]
    v_mfma_f32_16x16x32_bf16 v[96:99], v[64:67], v[20:23], v[96:99]
    v_mfma_f32_16x16x32_bf16 v[100:103], v[68:71], v[20:23], v[100:103]
    v_mfma_f32_16x16x32_bf16 v[96:99], v[128:131], v[24:27], v[96:99]
    v_mfma_f32_16x16x32_bf16 v[100:103], v[132:135], v[24:27], v[100:103]
    v_mfma_f32_16x16x32_bf16 v[96:99], v[144:147], v[28:31], v[96:99]
    v_mfma_f32_16x16x32_bf16 v[100:103], v[148:151], v[28:31], v[100:103]
    v_cvt_pk_bf16_f32 v236, v104, v105
    v_mfma_f32_16x16x32_bf16 v[96:99], v[160:163], v[32:35], v[96:99]
    v_cvt_pk_bf16_f32 v237, v106, v107
    v_mfma_f32_16x16x32_bf16 v[100:103], v[164:167], v[32:35], v[100:103]
    v_cvt_pk_bf16_f32 v238, v108, v109
    v_mfma_f32_16x16x32_bf16 v[96:99], v[176:179], v[36:39], v[96:99]
    v_cvt_pk_bf16_f32 v239, v110, v111
    v_mfma_f32_16x16x32_bf16 v[100:103], v[180:183], v[36:39], v[100:103]
    buffer_store_dwordx4 v[236:239], v1, s[48:51], s76 offen offset:64 sc1
    v_mfma_f32_16x16x32_bf16 v[96:99], v[192:195], v[44:47], v[96:99]
    v_mfma_f32_16x16x32_bf16 v[100:103], v[196:199], v[44:47], v[100:103]
    v_mfma_f32_16x16x32_bf16 v[96:99], v[208:211], v[252:255], v[96:99]
    v_mfma_f32_16x16x32_bf16 v[100:103], v[212:215], v[252:255], v[100:103]
    s_nop 6
    v_cvt_pk_bf16_f32 v232, v96, v97
    v_cvt_pk_bf16_f32 v233, v98, v99
    v_cvt_pk_bf16_f32 v234, v100, v101
    v_cvt_pk_bf16_f32 v235, v102, v103
    buffer_store_dwordx4 v[232:235], v1, s[48:51], s76 offen offset:0 sc1
    s_or_b32 s64, s2, s3
    s_cbranch_scc1 L_noepoch_47
    v_mov_b32 v1, s30
    s_mov_b64 exec, 1
    buffer_store_dword v1, v5, s[44:47], 0 offen sc1
L_noepoch_47:
    s_endpgm
L_retry_35:
    s_sub_u32 s100, s100, 1
    s_cbranch_scc1 L_end
    s_sleep 1
    s_branch L_spin_34
L_mre_36:
    s_sub_u32 s100, s100, 1
    s_cbranch_scc1 L_end
    s_sleep 2
    buffer_load_dword v1, v0, s[44:47], s74 offen sc1
    s_waitcnt vmcnt(0)
    s_branch L_mchk_33
L_retry_38:
    s_sub_u32 s100, s100, 1
    s_cbranch_scc1 L_end
    s_sleep 1
    s_branch L_spin_37
L_retry_40:
    s_sub_u32 s100, s100, 1
    s_cbranch_scc1 L_end
    s_sleep 1
    s_branch L_prog_39
L_retry_42:
    s_sub_u32 s100, s100, 1
    s_cbranch_scc1 L_end
    s_sleep 1
    s_branch L_prog_41
L_retry_44:
    s_sub_u32 s100, s100, 1
    s_cbranch_scc1 L_end
    s_sleep 1
    s_branch L_prog_43
L_retry_46:
    s_sub_u32 s100, s100, 1
    s_cbranch_scc1 L_end
    s_sleep 1
    s_branch L_prog_45
L_end:
    s_endpgm
.section .rodata,"a"
.p2align 6
.amdhsa_kernel standalone__hybrid_graph_tf_exphormer__graph_kernel
  .amdhsa_next_free_vgpr 256
  .amdhsa_next_free_sgpr 102
  .amdhsa_accum_offset 256
  .amdhsa_group_segment_fixed_size 0
  .amdhsa_kernarg_size 104
  .amdhsa_user_sgpr_count 2
  .amdhsa_user_sgpr_kernarg_segment_ptr 1
  .amdhsa_system_sgpr_workgroup_id_x 1
  .amdhsa_float_denorm_mode_32 3
.end_amdhsa_kernel
```

```asm
; @launch grid=(253,1,1) block=(512,1,1) lds=161792
.amdgcn_target "amdgcn-amd-amdhsa--gfx950"
.text
.globl standalone__hybrid_graph_tf_exphormer__graph_kernel
.p2align 8
.type standalone__hybrid_graph_tf_exphormer__graph_kernel,@function
standalone__hybrid_graph_tf_exphormer__graph_kernel:
L_begin:
    s_cmp_ge_u32 s2, 253
    s_cbranch_scc1 L_end
    s_load_dwordx16 s[4:19], s[0:1], 0
    s_load_dwordx8 s[20:27], s[0:1], 64
    s_load_dwordx2 s[28:29], s[0:1], 96
    s_and_b32 s64, s2, 0xf8
    s_cmp_lg_u32 s64, 8
    s_cbranch_scc1 L_nopf
    s_getpc_b64 s[32:33]
L_pc:
    v_lshlrev_b32 v1, 6, v0
    v_min_u32 v1, L_end-L_pc, v1
    global_load_dword v255, v1, s[32:33]
L_nopf:
    v_lshrrev_b32 v1, 6, v0
    v_and_b32 v2, 63, v0
    v_readfirstlane_b32 s3, v1
    s_and_b32 s67, s2, 7
    s_and_b32 s31, s3, 3
    s_cmp_lt_u32 s3, 4
    s_cbranch_scc1 L_gemm
    s_setprio 3
    s_bitcmp1_b32 s2, 3
    s_cbranch_scc0 L_mload_1
    s_lshr_b32 s66, s2, 4
    s_lshl3_add_u32 s68, s66, s67
    s_mul_i32 s64, s68, 5120
    s_sub_u32 s65, s64, 4096
    v_lshl_add_u32 v40, v0, 4, s65
    s_add_u32 s64, s64, 3072
    v_lshl_add_u32 v41, v0, 2, s64
    s_waitcnt lgkmcnt(0)
    global_load_dwordx4 v[48:51], v40, s[8:9] nt
    global_load_dword v52, v41, s[8:9] nt
    global_load_dwordx4 v[56:59], v40, s[6:7] nt
    global_load_dword v60, v41, s[6:7] nt
    s_mov_b32 s27, s68
    s_branch L_roled_2
L_mload_1:
    v_lshrrev_b32 v43, 5, v2
    v_lshl_add_u32 v44, s31, 2, v43
    v_and_b32 v46, 31, v2
    v_xor_b32 v46, v46, v44
    v_lshl_add_u32 v43, s31, 3, v43
    v_lshlrev_b32 v43, 9, v43
    v_lshl_add_u32 v46, v46, 4, v43
    v_lshl_add_u32 v44, s67, 14, v46
    s_and_b32 s65, s2, 0xe0
    s_and_b32 s66, s2, 16
    s_lshl2_add_u32 s65, s65, s66
    v_lshl_add_u32 v46, s65, 7, v46
    s_lshl_b32 s66, s31, 11
    s_add_u32 m0, s66, 62464
    s_waitcnt lgkmcnt(0)
    global_load_lds_dwordx4 v46, s[20:21]
    s_add_u32 m0, s66, 21504
    v_xor_b32 v46, 0x420, v46
    global_load_lds_dwordx4 v44, s[18:19]
    s_add_u32 m0, s66, 27648
    v_xor_b32 v45, 0x420, v44
    global_load_lds_dwordx4 v44, s[18:19] offset:2048
    s_add_u32 m0, s66, 63488
    s_lshr_b32 s64, s2, 6
    global_load_lds_dwordx4 v46, s[20:21]
    s_add_u32 m0, s66, 22528
    s_lshl3_add_u32 s64, s64, s67
    global_load_lds_dwordx4 v45, s[18:19]
    s_add_u32 m0, s66, 28672
    s_bfe_u32 s65, s2, 0x20004
    global_load_lds_dwordx4 v45, s[18:19] offset:2048
    s_lshl2_add_u32 s27, s64, s65
L_roled_2:
    s_cmp_lg_u32 s31, 0
    s_cbranch_scc1 L_roled_2_b
    s_load_dword s30, s[28:29], 0
L_roled_2_b:
    v_and_b32 v3, 15, v2
    v_lshrrev_b32 v4, 4, v2
    v_mov_b32 v5, 0
    v_mov_b32 v6, 1
    s_mov_b32 s100, 67108864
    s_bfe_u32 s65, s2, 0x10003
    s_lshl1_add_u32 s64, s67, s65
    s_and_b32 s65, s2, 0xf0
    s_or_b32 s64, s64, s65
    s_cmp_lt_u32 s2, 240
    s_cselect_b32 s1, s64, s2
    v_lshrrev_b32 v42, 2, v3
    v_and_b32 v43, 3, v3
    v_lshl_add_u32 v42, v42, 4, v43
    s_lshl_b32 s64, s31, 1
    v_mov_b32 v43, s64
    v_lshlrev_b32 v44, 1, v43
    v_cmp_gt_u32 vcc, 8, v3
    s_mul_i32 s65, s1, 640
    v_lshlrev_b32 v7, 4, v3
    v_cndmask_b32 v43, v43, v44, vcc
    v_add_lshl_u32 v42, v42, v43, 4
    v_lshl_add_u32 v42, v4, 2, v42
    v_add_u32 v42, s65, v42
    v_min_u32 v42, 159996, v42
    v_lshlrev_b32 v8, 4, v0
    v_and_b32 v8, 0xfff, v8
    global_load_dword v0, v42, s[10:11] nt
    s_barrier
    s_mov_b32 s32, s4
    s_and_b32 s33, s5, 0xffff
    s_mov_b32 s34, 5120000
    s_mov_b32 s35, 0x20000
    s_mov_b32 s36, s14
    s_and_b32 s37, s15, 0xffff
    s_mov_b32 s38, 20000
    s_mov_b32 s39, 0x20000
    s_add_u32 s40, s28, 1048576
    s_addc_u32 s41, s29, 0
    s_and_b32 s41, s41, 0xffff
    s_mov_b32 s42, 2048000
    s_mov_b32 s43, 0x20000
    v_and_b32 v40, 8, v3
    v_lshlrev_b32 v40, 1, v40
    v_mov_b32 v41, 0xffff
    v_lshlrev_b32 v40, v40, v41
    s_mov_b32 s64, 0x0f0f0f0f
    s_mov_b32 s65, 0x0f0f0f0f
    v_cndmask_b32 v12, 0, v40, s[64:65]
    v_xor_b32 v13, v40, v12
    v_and_b32 v14, 3, v3
    v_mul_u32_u24 v14, 0x5555, v14
    s_cmp_lg_u32 s31, 0
    s_cbranch_scc1 L_tagged_3
    s_waitcnt lgkmcnt(0)
    s_mul_i32 s30, s30, 0x9E3779B1
    s_add_u32 s30, s30, 0x7F4A7C15
    v_mov_b32 v40, 1
    v_mov_b32 v41, s30
    ds_write_b64 v5, v[40:41] offset:8
L_tagged_3:
    s_bitcmp1_b32 s2, 3
    s_cbranch_scc0 L_mwork_4
    v_mov_b32 v43, 4
    v_mov_b32 v44, 2031616
    s_mov_b32 s64, 0x3f0001
    v_lshrrev_b32 v40, 6, v8
    v_and_b32 v41, 0x30, v8
    v_lshl_add_u32 v40, v40, 14, v41
    s_lshl_b32 s68, s27, 6
    s_add_u32 s69, s68, 0x100000
    s_add_u32 s70, s68, 8192
    s_add_u32 s71, s69, 8192
    s_mov_b32 s65, 0x203c
    s_waitcnt vmcnt(3)
    v_mul_u32_u24 v64, 52429, v48
    v_lshrrev_b32 v72, 22, v64
    v_lshlrev_b32 v80, 2, v72
    ds_add_rtn_u32 v80, v80, v43 offset:512
    v_mul_u32_u24 v65, 52429, v49
    v_lshrrev_b32 v73, 22, v65
    v_lshlrev_b32 v81, 2, v73
    ds_add_rtn_u32 v81, v81, v43 offset:512
    v_mul_u32_u24 v66, 52429, v50
    v_lshrrev_b32 v74, 22, v66
    v_lshlrev_b32 v82, 2, v74
    ds_add_rtn_u32 v82, v82, v43 offset:512
    v_mul_u32_u24 v67, 52429, v51
    v_lshrrev_b32 v75, 22, v67
    v_lshlrev_b32 v83, 2, v75
    ds_add_rtn_u32 v83, v83, v43 offset:512
    v_mul_u32_u24 v68, 52429, v52
    v_lshrrev_b32 v76, 22, v68
    v_lshlrev_b32 v84, 2, v76
    ds_add_rtn_u32 v84, v84, v43 offset:512
    v_lshrrev_b32 v64, 21, v64
    v_mad_u32_u24 v64, v64, 24, v48
    v_mul_u32_u24 v64, 0x8001, v64
    v_bfe_u32 v88, v72, 1, 2
    v_lshl_or_b32 v72, v72, 2, v88
    v_lshlrev_b32 v72, 4, v72
    v_lshrrev_b32 v65, 21, v65
    v_mad_u32_u24 v65, v65, 24, v49
    v_mul_u32_u24 v65, 0x8001, v65
    v_bfe_u32 v89, v73, 1, 2
    v_lshl_or_b32 v73, v73, 2, v89
    v_lshlrev_b32 v73, 4, v73
    v_lshrrev_b32 v66, 21, v66
    v_mad_u32_u24 v66, v66, 24, v50
    v_mul_u32_u24 v66, 0x8001, v66
    v_bfe_u32 v90, v74, 1, 2
    v_lshl_or_b32 v74, v74, 2, v90
    v_lshlrev_b32 v74, 4, v74
    v_lshrrev_b32 v67, 21, v67
    v_mad_u32_u24 v67, v67, 24, v51
    v_mul_u32_u24 v67, 0x8001, v67
    v_bfe_u32 v91, v75, 1, 2
    v_lshl_or_b32 v75, v75, 2, v91
    v_lshlrev_b32 v75, 4, v75
    v_lshrrev_b32 v68, 21, v68
    v_mad_u32_u24 v68, v68, 24, v52
    v_mul_u32_u24 v68, 0x8001, v68
    v_bfe_u32 v92, v76, 1, 2
    v_lshl_or_b32 v76, v76, 2, v92
    v_lshlrev_b32 v76, 4, v76
    s_waitcnt vmcnt(1)
    v_lshlrev_b32 v56, 1, v56
    v_and_or_b32 v64, v64, s64, v56
    v_lshlrev_b32 v57, 1, v57
    v_and_or_b32 v65, v65, s64, v57
    v_lshlrev_b32 v58, 1, v58
    v_and_or_b32 v66, v66, s64, v58
    v_lshlrev_b32 v59, 1, v59
    v_and_or_b32 v67, v67, s64, v59
    v_lshlrev_b32 v60, 1, v60
    v_and_or_b32 v68, v68, s64, v60
    s_waitcnt lgkmcnt(0)
    v_cmp_gt_u32 vcc, 124, v80
    v_min_u32 v80, 124, v80
    v_lshl_or_b32 v80, v80, 7, v80
    v_cndmask_b32 v64, v44, v64, vcc
    v_bitop3_b32 v80, v80, s65, v72 bitop3:0x6a
    ds_write_b32 v80, v64 offset:41984
    v_cmp_gt_u32 vcc, 124, v81
    v_min_u32 v81, 124, v81
    v_lshl_or_b32 v81, v81, 7, v81
    v_cndmask_b32 v65, v44, v65, vcc
    v_bitop3_b32 v81, v81, s65, v73 bitop3:0x6a
    ds_write_b32 v81, v65 offset:41984
    v_cmp_gt_u32 vcc, 124, v82
    v_min_u32 v82, 124, v82
    v_lshl_or_b32 v82, v82, 7, v82
    v_cndmask_b32 v66, v44, v66, vcc
    v_bitop3_b32 v82, v82, s65, v74 bitop3:0x6a
    ds_write_b32 v82, v66 offset:41984
    v_cmp_gt_u32 vcc, 124, v83
    v_min_u32 v83, 124, v83
    v_lshl_or_b32 v83, v83, 7, v83
    v_cndmask_b32 v67, v44, v67, vcc
    v_bitop3_b32 v83, v83, s65, v75 bitop3:0x6a
    ds_write_b32 v83, v67 offset:41984
    v_cmp_gt_u32 vcc, 124, v84
    v_min_u32 v84, 124, v84
    v_lshl_or_b32 v84, v84, 7, v84
    v_cndmask_b32 v68, v44, v68, vcc
    v_bitop3_b32 v84, v84, s65, v76 bitop3:0x6a
    ds_write_b32 v84, v68 offset:41984
    s_waitcnt lgkmcnt(0)
    s_barrier
    ds_read_b32 v44, v5 offset:12
    ds_read_b128 v[48:51], v8 offset:41984
    ds_read_b128 v[52:55], v8 offset:46080
    ds_read_b128 v[56:59], v8 offset:50176
    ds_read_b128 v[60:63], v8 offset:54272
    s_waitcnt lgkmcnt(4)
    v_readfirstlane_b32 s30, v44
    s_waitcnt vmcnt(0)
    s_and_b32 s44, s30, 0xffc00000
    s_lshl_b32 s45, s30, 10
    s_and_b32 s45, s45, 0xffc00000
    s_lshl_b32 s46, s30, 20
    s_and_b32 s46, s46, 0xffc00000
    s_lshl_b32 s47, s30, 22
    s_waitcnt lgkmcnt(3)
    v_cmp_eq_u32 vcc, 1966080, v51
    v_or_b32 v48, s44, v48
    v_or_b32 v49, s45, v49
    v_or_b32 v50, s46, v50
    v_or_b32 v51, s47, v51
    buffer_store_dwordx4 v[48:51], v40, s[40:43], s68 offen sc1
    s_wqm_b64 s[72:73], vcc
    s_waitcnt lgkmcnt(2)
    v_cmp_eq_u32 vcc, 1966080, v55
    v_or_b32 v52, s44, v52
    v_or_b32 v53, s45, v53
    v_or_b32 v54, s46, v54
    v_or_b32 v55, s47, v55
    buffer_store_dwordx4 v[52:55], v40, s[40:43], s69 offen sc1
    s_wqm_b64 s[74:75], vcc
    s_waitcnt lgkmcnt(1)
    s_not_b64 exec, s[72:73]
    s_cbranch_scc0 L_nosec_8
    v_or_b32 v56, s44, v56
    v_or_b32 v57, s45, v57
    v_or_b32 v58, s46, v58
    v_or_b32 v59, s47, v59
    buffer_store_dwordx4 v[56:59], v40, s[40:43], s70 offen sc1
L_nosec_8:
    s_waitcnt lgkmcnt(0)
    s_not_b64 exec, s[74:75]
    s_cbranch_scc0 L_nosec_9
    v_or_b32 v60, s44, v60
    v_or_b32 v61, s45, v61
    v_or_b32 v62, s46, v62
    v_or_b32 v63, s47, v63
    buffer_store_dwordx4 v[60:63], v40, s[40:43], s71 offen sc1
L_nosec_9:
    s_mov_b64 exec, -1
    s_cmp_ge_u32 s2, 250
    s_cbranch_scc1 L_end
L_worked_5:
    v_lshlrev_b32 v0, 9, v0
    s_setprio 1
    s_lshl_b32 s64, s31, 10
    s_lshr_b32 s10, s1, 1
    s_lshl_b32 s10, s10, 14
    s_add_u32 s11, s10, 4096
    s_add_u32 s12, s10, 8192
    s_add_u32 s13, s10, 12288
    v_cmp_gt_u32 vcc, 0xf40, v8
    s_mov_b64 s[14:15], vcc
    v_add_u32_dpp v9, v0, v7 row_newbcast:0 row_mask:0xf bank_mask:0xf
    s_waitcnt vmcnt(4)
    buffer_load_dwordx4 v[176:179], v9, s[32:35], 0 offen offset:0
    buffer_load_dwordx4 v[180:183], v9, s[32:35], 0 offen offset:256
    v_add_u32_dpp v9, v0, v7 row_newbcast:1 row_mask:0xf bank_mask:0xf
    s_waitcnt vmcnt(4)
    buffer_load_dwordx4 v[184:187], v9, s[32:35], 0 offen offset:0
    buffer_load_dwordx4 v[188:191], v9, s[32:35], 0 offen offset:256
    s_bfe_u32 s65, s2, 0x30003
    s_min_u32 s65, s65, 4
    s_lshl_b32 s65, s65, 12
    s_add_u32 s64, s64, 62464
    s_add_u32 m0, s64, s65
    s_nop 0
    buffer_load_dwordx4 v8, s[36:39], s65 offen lds
    v_add_u32_dpp v9, v0, v7 row_newbcast:2 row_mask:0xf bank_mask:0xf
    s_waitcnt vmcnt(4)
    buffer_load_dwordx4 v[192:195], v9, s[32:35], 0 offen offset:0
    buffer_load_dwordx4 v[196:199], v9, s[32:35], 0 offen offset:256
    s_add_u32 s65, s65, 4096
    s_cmp_eq_u32 s65, 20480
    s_cselect_b32 s65, 0, s65
    s_add_u32 m0, s64, s65
    s_nop 0
    buffer_load_dwordx4 v8, s[36:39], s65 offen lds
    v_add_u32_dpp v9, v0, v7 row_newbcast:3 row_mask:0xf bank_mask:0xf
    s_waitcnt vmcnt(4)
    buffer_load_dwordx4 v[200:203], v9, s[32:35], 0 offen offset:0
    buffer_load_dwordx4 v[204:207], v9, s[32:35], 0 offen offset:256
    v_add_u32_dpp v9, v0, v7 row_newbcast:4 row_mask:0xf bank_mask:0xf
    s_waitcnt vmcnt(4)
    buffer_load_dwordx4 v[208:211], v9, s[32:35], 0 offen offset:0
    buffer_load_dwordx4 v[212:215], v9, s[32:35], 0 offen offset:256
    s_add_u32 s65, s65, 4096
    s_cmp_eq_u32 s65, 20480
    s_cselect_b32 s65, 0, s65
    s_add_u32 m0, s64, s65
    s_nop 0
    buffer_load_dwordx4 v8, s[36:39], s65 offen lds
    v_add_u32_dpp v9, v0, v7 row_newbcast:5 row_mask:0xf bank_mask:0xf
    s_waitcnt vmcnt(4)
    buffer_load_dwordx4 v[216:219], v9, s[32:35], 0 offen offset:0
    buffer_load_dwordx4 v[220:223], v9, s[32:35], 0 offen offset:256
    s_add_u32 s65, s65, 4096
    s_cmp_eq_u32 s65, 20480
    s_cselect_b32 s65, 0, s65
    s_add_u32 m0, s64, s65
    s_nop 0
    buffer_load_dwordx4 v8, s[36:39], s65 offen lds
    v_add_u32_dpp v9, v0, v7 row_newbcast:6 row_mask:0xf bank_mask:0xf
    s_waitcnt vmcnt(4)
    buffer_load_dwordx4 v[224:227], v9, s[32:35], 0 offen offset:0
    buffer_load_dwordx4 v[228:231], v9, s[32:35], 0 offen offset:256
    s_add_u32 s65, s65, 4096
    s_cmp_eq_u32 s65, 20480
    s_cselect_b32 s65, 0, s65
    s_add_u32 m0, s64, s65
    s_nop 0
    buffer_load_dwordx4 v8, s[36:39], s65 offen lds
L_ipoll_10:
    buffer_load_dwordx4 v[48:51], v8, s[40:43], s10 offen sc1
    s_mov_b64 exec, s[14:15]
    buffer_load_dwordx4 v[52:55], v8, s[40:43], s11 offen sc1
    s_mov_b64 exec, -1
L_spin_11:
    ds_read_b128 v[44:47], v5
    s_waitcnt lgkmcnt(0)
    v_readfirstlane_b32 s101, v46
    v_readfirstlane_b32 s30, v47
    s_cmp_ge_u32 s101, 1
    s_cbranch_scc0 L_retry_12
    s_and_b32 s44, s30, 0xffc00000
    s_lshl_b32 s45, s30, 10
    s_and_b32 s45, s45, 0xffc00000
    s_lshl_b32 s46, s30, 20
    s_and_b32 s46, s46, 0xffc00000
    s_lshl_b32 s47, s30, 22
    s_and_b32 s64, s1, 1
    s_lshl_b32 s64, s64, 21
    s_xor_b32 s17, s64, 1966080
    s_or_b32 s44, s44, s64
    v_mov_b32 v68, s17
    s_or_b32 s45, s45, s64
    v_mov_b32 v69, s17
    s_or_b32 s46, s46, s64
    v_mov_b32 v70, s17
    s_or_b32 s47, s47, s64
    v_mov_b32 v71, s17
    s_mov_b32 s16, 1310720
    v_mov_b32 v42, 2
    s_waitcnt vmcnt(1)
    v_xor_b32 v64, s44, v48
    v_xor_b32 v65, s45, v49
    v_xor_b32 v66, s46, v50
    v_xor_b32 v67, s47, v51
    v_or3_b32 v40, v64, v65, v66
    v_or_b32 v40, v40, v67
    v_cmp_eq_u32 s[72:73], s17, v67
    v_cmp_gt_u32 s[48:49], s16, v64
    v_lshlrev_b32_sdwa v80, 2, v64 dst_sel:DWORD dst_unused:UNUSED_PAD src0_sel:DWORD src1_sel:WORD_1
    v_cmp_gt_u32 s[50:51], s16, v65
    v_lshlrev_b32_sdwa v81, 2, v65 dst_sel:DWORD dst_unused:UNUSED_PAD src0_sel:DWORD src1_sel:WORD_1
    v_cmp_gt_u32 s[52:53], s16, v66
    v_lshlrev_b32_sdwa v82, 2, v66 dst_sel:DWORD dst_unused:UNUSED_PAD src0_sel:DWORD src1_sel:WORD_1
    v_cmp_gt_u32 s[54:55], s16, v67
    v_lshlrev_b32_sdwa v83, 2, v67 dst_sel:DWORD dst_unused:UNUSED_PAD src0_sel:DWORD src1_sel:WORD_1
    s_waitcnt vmcnt(0)
    s_mov_b64 exec, s[14:15]
    v_xor_b32 v68, s44, v52
    v_xor_b32 v69, s45, v53
    v_xor_b32 v70, s46, v54
    v_xor_b32 v71, s47, v55
    s_mov_b64 exec, -1
    v_or3_b32 v40, v40, v68, v69
    v_or3_b32 v40, v40, v70, v71
    v_cmp_eq_u32 s[74:75], s17, v71
    v_cmp_le_u32 vcc, 0x400000, v40
    s_cbranch_vccnz L_retry_13
    s_wqm_b64 s[72:73], s[72:73]
    s_not_b64 exec, s[72:73]
    s_cbranch_scc0 L_nosec_14
    buffer_load_dwordx4 v[56:59], v8, s[40:43], s12 offen sc1
L_nosec_14:
    s_wqm_b64 s[74:75], s[74:75]
    s_not_b64 exec, s[74:75]
    s_cbranch_scc0 L_nosec_15
    buffer_load_dwordx4 v[60:63], v8, s[40:43], s13 offen sc1
L_nosec_15:
    s_mov_b64 exec, -1
    v_cmp_gt_u32 s[56:57], s16, v68
    v_lshlrev_b32_sdwa v84, 2, v68 dst_sel:DWORD dst_unused:UNUSED_PAD src0_sel:DWORD src1_sel:WORD_1
    v_cmp_gt_u32 s[58:59], s16, v69
    v_lshlrev_b32_sdwa v85, 2, v69 dst_sel:DWORD dst_unused:UNUSED_PAD src0_sel:DWORD src1_sel:WORD_1
    v_cmp_gt_u32 s[60:61], s16, v70
    v_lshlrev_b32_sdwa v86, 2, v70 dst_sel:DWORD dst_unused:UNUSED_PAD src0_sel:DWORD src1_sel:WORD_1
    v_cmp_gt_u32 s[62:63], s16, v71
    v_lshlrev_b32_sdwa v87, 2, v71 dst_sel:DWORD dst_unused:UNUSED_PAD src0_sel:DWORD src1_sel:WORD_1
    s_mov_b64 exec, s[48:49]
    ds_add_rtn_u32 v80, v80, v42 offset:128
    s_mov_b64 exec, s[50:51]
    ds_add_rtn_u32 v81, v81, v42 offset:128
    s_mov_b64 exec, s[52:53]
    ds_add_rtn_u32 v82, v82, v42 offset:128
    s_mov_b64 exec, s[54:55]
    ds_add_rtn_u32 v83, v83, v42 offset:128
    s_mov_b64 exec, s[56:57]
    ds_add_rtn_u32 v84, v84, v42 offset:128
    s_mov_b64 exec, s[58:59]
    ds_add_rtn_u32 v85, v85, v42 offset:128
    s_mov_b64 exec, s[60:61]
    ds_add_rtn_u32 v86, v86, v42 offset:128
    s_mov_b64 exec, s[62:63]
    ds_add_rtn_u32 v87, v87, v42 offset:128
    s_mov_b64 exec, -1
    v_add_u32_dpp v9, v0, v7 row_newbcast:7 row_mask:0xf bank_mask:0xf
    buffer_load_dwordx4 v[232:235], v9, s[32:35], 0 offen offset:0
    buffer_load_dwordx4 v[236:239], v9, s[32:35], 0 offen offset:256
    v_add_u32_dpp v9, v0, v7 row_newbcast:8 row_mask:0xf bank_mask:0xf
    buffer_load_dwordx4 v[240:243], v9, s[32:35], 0 offen offset:0
    buffer_load_dwordx4 v[244:247], v9, s[32:35], 0 offen offset:256
    s_waitcnt lgkmcnt(4)
    s_mov_b64 exec, s[48:49]
    ds_write_b16 v80, v64
    s_mov_b64 exec, s[50:51]
    ds_write_b16 v81, v65
    s_mov_b64 exec, s[52:53]
    ds_write_b16 v82, v66
    s_mov_b64 exec, s[54:55]
    ds_write_b16 v83, v67
    s_waitcnt lgkmcnt(4)
    s_mov_b64 exec, s[56:57]
    ds_write_b16 v84, v68
    s_mov_b64 exec, s[58:59]
    ds_write_b16 v85, v69
    s_mov_b64 exec, s[60:61]
    ds_write_b16 v86, v70
    s_mov_b64 exec, s[62:63]
    ds_write_b16 v87, v71
    s_not_b64 exec, s[72:73]
    s_cbranch_scc0 L_secdone_17
    s_waitcnt vmcnt(4)
L_sec_16:
    v_xor_b32 v72, s44, v56
    v_xor_b32 v73, s45, v57
    v_xor_b32 v74, s46, v58
    v_xor_b32 v75, s47, v59
    v_or3_b32 v40, v72, v73, v74
    v_or_b32 v40, v40, v75
    v_cmp_le_u32 vcc, 0x400000, v40
    s_cbranch_vccnz L_retry_19
    v_and_b32 v40, 2031616, v75
    v_cmp_eq_u32 vcc, 2031616, v40
    v_cmp_gt_u32 s[64:65], s16, v72
    v_lshlrev_b32_sdwa v88, 2, v72 dst_sel:DWORD dst_unused:UNUSED_PAD src0_sel:DWORD src1_sel:WORD_1
    v_cmp_gt_u32 s[66:67], s16, v73
    v_lshlrev_b32_sdwa v89, 2, v73 dst_sel:DWORD dst_unused:UNUSED_PAD src0_sel:DWORD src1_sel:WORD_1
    v_cmp_gt_u32 s[68:69], s16, v74
    v_lshlrev_b32_sdwa v90, 2, v74 dst_sel:DWORD dst_unused:UNUSED_PAD src0_sel:DWORD src1_sel:WORD_1
    v_cmp_gt_u32 s[70:71], s16, v75
    v_lshlrev_b32_sdwa v91, 2, v75 dst_sel:DWORD dst_unused:UNUSED_PAD src0_sel:DWORD src1_sel:WORD_1
    s_mov_b64 exec, s[64:65]
    ds_add_rtn_u32 v88, v88, v42 offset:128
    s_mov_b64 exec, s[66:67]
    ds_add_rtn_u32 v89, v89, v42 offset:128
    s_mov_b64 exec, s[68:69]
    ds_add_rtn_u32 v90, v90, v42 offset:128
    s_mov_b64 exec, s[70:71]
    ds_add_rtn_u32 v91, v91, v42 offset:128
    s_mov_b64 exec, vcc
    ds_write_b32 v5, v6 offset:20
    s_waitcnt lgkmcnt(0)
    s_mov_b64 exec, s[64:65]
    ds_write_b16 v88, v72
    s_mov_b64 exec, s[66:67]
    ds_write_b16 v89, v73
    s_mov_b64 exec, s[68:69]
    ds_write_b16 v90, v74
    s_mov_b64 exec, s[70:71]
    ds_write_b16 v91, v75
L_secdone_17:
    s_not_b64 exec, s[74:75]
    s_cbranch_scc0 L_secdone_21
    s_waitcnt vmcnt(4)
L_sec_20:
    v_xor_b32 v76, s44, v60
    v_xor_b32 v77, s45, v61
    v_xor_b32 v78, s46, v62
    v_xor_b32 v79, s47, v63
    v_or3_b32 v40, v76, v77, v78
    v_or_b32 v40, v40, v79
    v_cmp_le_u32 vcc, 0x400000, v40
    s_cbranch_vccnz L_retry_23
    v_and_b32 v40, 2031616, v79
    v_cmp_eq_u32 vcc, 2031616, v40
    v_cmp_gt_u32 s[64:65], s16, v76
    v_lshlrev_b32_sdwa v92, 2, v76 dst_sel:DWORD dst_unused:UNUSED_PAD src0_sel:DWORD src1_sel:WORD_1
    v_cmp_gt_u32 s[66:67], s16, v77
    v_lshlrev_b32_sdwa v93, 2, v77 dst_sel:DWORD dst_unused:UNUSED_PAD src0_sel:DWORD src1_sel:WORD_1
    v_cmp_gt_u32 s[68:69], s16, v78
    v_lshlrev_b32_sdwa v94, 2, v78 dst_sel:DWORD dst_unused:UNUSED_PAD src0_sel:DWORD src1_sel:WORD_1
    v_cmp_gt_u32 s[70:71], s16, v79
    v_lshlrev_b32_sdwa v95, 2, v79 dst_sel:DWORD dst_unused:UNUSED_PAD src0_sel:DWORD src1_sel:WORD_1
    s_mov_b64 exec, s[64:65]
    ds_add_rtn_u32 v92, v92, v42 offset:128
    s_mov_b64 exec, s[66:67]
    ds_add_rtn_u32 v93, v93, v42 offset:128
    s_mov_b64 exec, s[68:69]
    ds_add_rtn_u32 v94, v94, v42 offset:128
    s_mov_b64 exec, s[70:71]
    ds_add_rtn_u32 v95, v95, v42 offset:128
    s_mov_b64 exec, vcc
    ds_write_b32 v5, v6 offset:20
    s_waitcnt lgkmcnt(0)
    s_mov_b64 exec, s[64:65]
    ds_write_b16 v92, v76
    s_mov_b64 exec, s[66:67]
    ds_write_b16 v93, v77
    s_mov_b64 exec, s[68:69]
    ds_write_b16 v94, v78
    s_mov_b64 exec, s[70:71]
    ds_write_b16 v95, v79
L_secdone_21:
    s_waitcnt lgkmcnt(0)
    s_mov_b64 exec, 1
    ds_add_u32 v5, v6 offset:16
    s_mov_b64 exec, -1
    v_add_u32_dpp v9, v0, v7 row_newbcast:9 row_mask:0xf bank_mask:0xf
    buffer_load_dwordx4 v[248:251], v9, s[32:35], 0 offen offset:0
    buffer_load_dwordx4 v[252:255], v9, s[32:35], 0 offen offset:256
    s_lshl_b32 s20, s31, 1
    s_add_u32 s21, s20, 1
    s_add_u32 s22, s20, 8
    s_add_u32 s23, s20, 9
    s_add_u32 s24, s31, 16
    v_add_u32 v47, -1, v3
    v_bfe_u32 v40, v47, 1, 1
    v_and_b32 v41, 1, v47
    v_lshl_add_u32 v40, v40, 3, v41
    v_add_u32 v40, s20, v40
    v_mov_b32 v41, s24
    v_cmp_ne_u32 vcc, 0, v3
    v_min_u32 v47, 19, v2
    v_mul_u32_u24 v46, 264, v47
    v_cndmask_b32 v40, v41, v40, vcc
    v_mul_u32_u24 v41, 264, v40
    v_add_u32 v41, 148480, v41
    v_lshlrev_b32 v40, 2, v40
    v_add_u32 v46, 148728, v46
    v_lshlrev_b32 v47, 2, v47
    v_lshlrev_b32 v43, 3, v3
    v_lshl_add_u32 v43, v4, 1, v43
L_spin_24:
    ds_read_b32 v44, v5 offset:16
    s_waitcnt lgkmcnt(0)
    v_readfirstlane_b32 s101, v44
    s_cmp_ge_u32 s101, 4
    s_cbranch_scc0 L_retry_25
    ds_read_b32 v44, v40 offset:128
    ds_read_b32 v47, v47 offset:128
    ds_read_b32 v45, v5 offset:20
    s_waitcnt lgkmcnt(2)
    v_sub_u32 v44, v44, v41
    v_max_u32 v44, 18, v44
    s_waitcnt lgkmcnt(0)
    v_cmp_gt_u32 vcc, v47, v46
    v_add_u32_dpp v48, v44, v44 row_shr:1 row_mask:0xf bank_mask:0xf bound_ctrl:1
    v_readfirstlane_b32 s25, v45
    s_or_b32 s64, vcc_lo, vcc_hi
    v_add_u32_dpp v48, v48, v48 row_shr:2 row_mask:0xf bank_mask:0xf bound_ctrl:1
    s_or_b32 s25, s25, s64
    s_mov_b32 s53, 0
    v_add_u32_dpp v48, v48, v48 row_shr:4 row_mask:0xf bank_mask:0xf bound_ctrl:1
    v_sub_u32 v44, v48, v44
    v_sub_u32 v44, v41, v44
    v_readlane_b32 s10, v48, 0
    v_readlane_b32 s11, v48, 1
    v_readlane_b32 s12, v48, 2
    v_readlane_b32 s13, v48, 3
    v_readlane_b32 s14, v48, 4
    v_add_u32_dpp v160, v44, v43 row_newbcast:0 row_mask:0xf bank_mask:0xf
    v_add_u32_dpp v161, v44, v43 row_newbcast:1 row_mask:0xf bank_mask:0xf
    v_add_u32_dpp v162, v44, v43 row_newbcast:2 row_mask:0xf bank_mask:0xf
    v_add_u32_dpp v163, v44, v43 row_newbcast:3 row_mask:0xf bank_mask:0xf
    v_add_u32_dpp v164, v44, v43 row_newbcast:4 row_mask:0xf bank_mask:0xf
    s_add_u32 s50, s14, 14
    s_lshr_b32 s50, s50, 4
    s_cmp_gt_u32 s50, 32
    s_cselect_b32 s25, 1, s25
    s_max_u32 s50, s50, 12
    v_add_u32 v40, 0, v43
    v_cmp_le_u32 s[64:65], s10, v40
    v_cmp_le_u32 s[66:67], s11, v40
    v_cmp_le_u32 s[68:69], s12, v40
    v_cmp_le_u32 s[70:71], s13, v40
    v_cndmask_b32 v40, v160, v161, s[64:65]
    v_cndmask_b32 v40, v40, v162, s[66:67]
    v_cndmask_b32 v40, v40, v163, s[68:69]
    v_cndmask_b32 v40, v40, v164, s[70:71]
    ds_read_u16 v40, v40 offset:0
    v_add_u32 v41, 128, v43
    v_cmp_le_u32 s[64:65], s10, v41
    v_cmp_le_u32 s[66:67], s11, v41
    v_cmp_le_u32 s[68:69], s12, v41
    v_cmp_le_u32 s[70:71], s13, v41
    v_cndmask_b32 v41, v160, v161, s[64:65]
    v_cndmask_b32 v41, v41, v162, s[66:67]
    v_cndmask_b32 v41, v41, v163, s[68:69]
    v_cndmask_b32 v41, v41, v164, s[70:71]
    ds_read_u16 v41, v41 offset:128
    v_add_u32 v42, 256, v43
    v_cmp_le_u32 s[64:65], s10, v42
    v_cmp_le_u32 s[66:67], s11, v42
    v_cmp_le_u32 s[68:69], s12, v42
    v_cmp_le_u32 s[70:71], s13, v42
    v_cndmask_b32 v42, v160, v161, s[64:65]
    v_cndmask_b32 v42, v42, v162, s[66:67]
    v_cndmask_b32 v42, v42, v163, s[68:69]
    v_cndmask_b32 v42, v42, v164, s[70:71]
    ds_read_u16 v42, v42 offset:256
    v_add_u32 v43, 384, v43
    v_cmp_le_u32 s[64:65], s10, v43
    v_cmp_le_u32 s[66:67], s11, v43
    v_cmp_le_u32 s[68:69], s12, v43
    v_cmp_le_u32 s[70:71], s13, v43
    v_cndmask_b32 v43, v160, v161, s[64:65]
    v_cndmask_b32 v43, v43, v162, s[66:67]
    v_cndmask_b32 v43, v43, v163, s[68:69]
    v_cndmask_b32 v43, v43, v164, s[70:71]
    ds_read_u16 v43, v43 offset:384
    s_waitcnt lgkmcnt(3)
    v_and_b32 v32, 0x7ffe, v40
    ds_read_u16 v33, v32 offset:62464
    v_lshlrev_b32 v32, 8, v32
    v_lshlrev_b32 v40, 4, v40
    s_waitcnt lgkmcnt(3)
    v_and_b32 v34, 0x7ffe, v41
    ds_read_u16 v35, v34 offset:62464
    v_lshlrev_b32 v34, 8, v34
    v_lshlrev_b32 v41, 4, v41
    s_waitcnt lgkmcnt(3)
    v_and_b32 v36, 0x7ffe, v42
    ds_read_u16 v37, v36 offset:62464
    v_lshlrev_b32 v36, 8, v36
    v_lshlrev_b32 v42, 4, v42
    s_waitcnt lgkmcnt(3)
    v_and_b32 v38, 0x7ffe, v43
    ds_read_u16 v39, v38 offset:62464
    v_lshlrev_b32 v38, 8, v38
    v_lshlrev_b32 v43, 4, v43
    v_add_u32_dpp v11, v32, v7 row_newbcast:0 row_mask:0xf bank_mask:0xf
    buffer_load_dwordx4 v[48:51], v11, s[32:35], 0 offen offset:0
    buffer_load_dwordx4 v[56:59], v11, s[32:35], 0 offen offset:256
    v_add_u32_dpp v11, v32, v7 row_newbcast:1 row_mask:0xf bank_mask:0xf
    buffer_load_dwordx4 v[52:55], v11, s[32:35], 0 offen offset:0
    buffer_load_dwordx4 v[60:63], v11, s[32:35], 0 offen offset:256
    v_add_u32_dpp v11, v32, v7 row_newbcast:2 row_mask:0xf bank_mask:0xf
    buffer_load_dwordx4 v[64:67], v11, s[32:35], 0 offen offset:0
    buffer_load_dwordx4 v[72:75], v11, s[32:35], 0 offen offset:256
    v_add_u32_dpp v11, v32, v7 row_newbcast:3 row_mask:0xf bank_mask:0xf
    buffer_load_dwordx4 v[68:71], v11, s[32:35], 0 offen offset:0
    buffer_load_dwordx4 v[76:79], v11, s[32:35], 0 offen offset:256
    v_add_u32_dpp v11, v32, v7 row_newbcast:4 row_mask:0xf bank_mask:0xf
    buffer_load_dwordx4 v[80:83], v11, s[32:35], 0 offen offset:0
    buffer_load_dwordx4 v[88:91], v11, s[32:35], 0 offen offset:256
    v_add_u32_dpp v11, v32, v7 row_newbcast:5 row_mask:0xf bank_mask:0xf
    buffer_load_dwordx4 v[84:87], v11, s[32:35], 0 offen offset:0
    buffer_load_dwordx4 v[92:95], v11, s[32:35], 0 offen offset:256
    s_mov_b32 s57, 0
    s_sub_u32 s64, s14, 18
    s_lshr_b32 s65, s64, 4
    s_bitset1_b32 s53, s65
    s_and_b32 s64, s64, 14
    s_lshl4_add_u32 s57, s57, s64
    s_and_b32 s65, s24, 7
    s_lshl_b32 s65, s65, 5
    s_lshl_b32 s19, s24, 10
    s_or_b32 s19, s19, s65
    s_sub_u32 s64, s13, 18
    s_lshr_b32 s65, s64, 4
    s_bitset1_b32 s53, s65
    s_and_b32 s64, s64, 14
    s_lshl4_add_u32 s57, s57, s64
    s_and_b32 s65, s23, 7
    s_lshl_b32 s65, s65, 5
    s_lshl_b32 s18, s23, 10
    s_or_b32 s18, s18, s65
    s_sub_u32 s64, s12, 18
    s_lshr_b32 s65, s64, 4
    s_bitset1_b32 s53, s65
    s_and_b32 s64, s64, 14
    s_lshl4_add_u32 s57, s57, s64
    s_and_b32 s65, s22, 7
    s_lshl_b32 s65, s65, 5
    s_lshl_b32 s17, s22, 10
    s_or_b32 s17, s17, s65
    s_sub_u32 s64, s11, 18
    s_lshr_b32 s65, s64, 4
    s_bitset1_b32 s53, s65
    s_and_b32 s64, s64, 14
    s_lshl4_add_u32 s57, s57, s64
    s_and_b32 s65, s21, 7
    s_lshl_b32 s65, s65, 5
    s_lshl_b32 s16, s21, 10
    s_or_b32 s16, s16, s65
    s_sub_u32 s64, s10, 18
    s_lshr_b32 s65, s64, 4
    s_bitset1_b32 s53, s65
    s_and_b32 s64, s64, 14
    s_lshl4_add_u32 s57, s57, s64
    s_and_b32 s65, s20, 7
    s_lshl_b32 s65, s65, 5
    s_lshl_b32 s15, s20, 10
    s_or_b32 s15, s15, s65
    s_sub_u32 s64, s50, 5
    s_lshl_b32 s56, 1, s64
    s_or_b32 s52, s56, s53
    v_and_b32 v46, 1, v3
    v_lshl_add_u32 v46, v4, 1, v46
    v_and_b32 v46, 3, v46
    v_and_b32 v47, 14, v3
    v_lshl_add_u32 v46, v46, 4, v47
    v_lshrrev_b32 v47, 1, v4
    v_add_lshl_u32 v46, v46, v47, 2
    v_lshrrev_b32 v44, 1, v4
    v_mul_u32_u24 v44, 528, v44
    v_xor_b32 v44, v44, v7
    v_and_b32 v45, 1, v4
    v_lshl_or_b32 v2, v45, 3, v44
    v_xor_b32 v144, s15, v7
    v_xor_b32 v146, s16, v7
    v_xor_b32 v148, s19, v7
    v_xor_b32 v145, 528, v144
    v_xor_b32 v147, 528, v146
    v_xor_b32 v149, 528, v148
    s_mul_i32 s64, s1, 80
    s_add_u32 s64, s64, 62464
    v_and_b32 v45, 2, v4
    v_add_u32 v0, s64, v45
    s_getpc_b64 s[72:73]
L_anc:
    v_lshlrev_b32 v4, 2, v4
    s_mov_b32 s62, L_fp1-L_anc
    s_mov_b32 s63, L_fp1-L_fp0
    s_mov_b32 s70, L_dr1-L_anc
    s_mov_b32 s71, L_dr1-L_dr0
    s_mov_b32 s26, 0
    s_mov_b32 s49, 0
    v_mov_b32 v1, 0
    s_lshl_b32 s64, s31, 2
    v_mov_b32 v10, s64
    v_and_b32 v9, 8, v3
    v_lshlrev_b32 v9, 1, v9
    s_mov_b32 s66, 0x22222222
    s_mov_b32 s67, 0x22222222
    s_mov_b32 s68, 0x44444444
    s_mov_b32 s69, 0x44444444
    v_mov_b64 v[150:151], 0
    v_mov_b64 v[152:153], 0
    v_mov_b64 v[154:155], 0
    v_mov_b64 v[156:157], 0
    v_mov_b64 v[158:159], 0
    v_mov_b64 v[16:17], 0
    v_mov_b64 v[18:19], 0
    v_mov_b64 v[20:21], 0
    v_mov_b64 v[22:23], 0
    s_waitcnt lgkmcnt(0)
    v_lshlrev_b32 v33, v40, v33
    ds_bpermute_b32 v33, v46, v33
    v_lshlrev_b32 v35, v41, v35
    ds_bpermute_b32 v35, v46, v35
    v_lshlrev_b32 v37, v42, v37
    ds_bpermute_b32 v37, v46, v37
    v_lshlrev_b32 v39, v43, v39
    ds_bpermute_b32 v39, v46, v39
    s_waitcnt vmcnt(12) lgkmcnt(0)
    s_barrier
    ds_read_b128 v[160:163], v144 offset:21504
    ds_read_b128 v[164:167], v144 offset:21760
    ds_read_b128 v[168:171], v145 offset:21504
    ds_read_b128 v[172:175], v145 offset:21760
    s_waitcnt lgkmcnt(2)
    v_dot2c_f32_bf16 v150, v176, v160
    v_dot2c_f32_bf16 v150, v177, v161
    v_dot2c_f32_bf16 v150, v178, v162
    v_dot2c_f32_bf16 v150, v179, v163
    v_dot2c_f32_bf16 v150, v180, v164
    v_dot2c_f32_bf16 v150, v181, v165
    v_dot2c_f32_bf16 v150, v182, v166
    v_dot2c_f32_bf16 v150, v183, v167
    ds_read_b128 v[160:163], v146 offset:21504
    ds_read_b128 v[164:167], v146 offset:21760
    s_waitcnt lgkmcnt(2)
    v_dot2c_f32_bf16 v151, v184, v168
    v_dot2c_f32_bf16 v151, v185, v169
    v_dot2c_f32_bf16 v151, v186, v170
    v_dot2c_f32_bf16 v151, v187, v171
    v_dot2c_f32_bf16 v151, v188, v172
    v_dot2c_f32_bf16 v151, v189, v173
    v_dot2c_f32_bf16 v151, v190, v174
    v_dot2c_f32_bf16 v151, v191, v175
    ds_read_b128 v[168:171], v147 offset:21504
    ds_read_b128 v[172:175], v147 offset:21760
    s_waitcnt lgkmcnt(2)
    v_dot2c_f32_bf16 v152, v192, v160
    v_dot2c_f32_bf16 v152, v193, v161
    v_dot2c_f32_bf16 v152, v194, v162
    v_dot2c_f32_bf16 v152, v195, v163
    v_dot2c_f32_bf16 v152, v196, v164
    v_dot2c_f32_bf16 v152, v197, v165
    v_dot2c_f32_bf16 v152, v198, v166
    v_dot2c_f32_bf16 v152, v199, v167
    v_add_f32_dpp v150, v150, v150 row_ror:8 row_mask:0xf bank_mask:0x3
    v_add_f32_dpp v150, v151, v151 row_ror:8 row_mask:0xf bank_mask:0xc
    ds_read_b128 v[160:163], v144 offset:29696
    ds_read_b128 v[164:167], v144 offset:29952
    s_waitcnt lgkmcnt(2)
    v_dot2c_f32_bf16 v153, v200, v168
    v_dot2c_f32_bf16 v153, v201, v169
    v_dot2c_f32_bf16 v153, v202, v170
    v_dot2c_f32_bf16 v153, v203, v171
    v_dot2c_f32_bf16 v153, v204, v172
    v_dot2c_f32_bf16 v153, v205, v173
    v_dot2c_f32_bf16 v153, v206, v174
    v_dot2c_f32_bf16 v153, v207, v175
    ds_read_b128 v[168:171], v145 offset:29696
    ds_read_b128 v[172:175], v145 offset:29952
    s_waitcnt lgkmcnt(2)
    v_dot2c_f32_bf16 v154, v208, v160
    v_dot2c_f32_bf16 v154, v209, v161
    v_dot2c_f32_bf16 v154, v210, v162
    v_dot2c_f32_bf16 v154, v211, v163
    v_dot2c_f32_bf16 v154, v212, v164
    v_dot2c_f32_bf16 v154, v213, v165
    v_dot2c_f32_bf16 v154, v214, v166
    v_dot2c_f32_bf16 v154, v215, v167
    v_add_f32_dpp v152, v152, v152 row_ror:8 row_mask:0xf bank_mask:0x3
    v_add_f32_dpp v152, v153, v153 row_ror:8 row_mask:0xf bank_mask:0xc
    v_add_u32_dpp v11, v32, v7 row_newbcast:6 row_mask:0xf bank_mask:0xf
    buffer_load_dwordx4 v[96:99], v11, s[32:35], 0 offen offset:0
    buffer_load_dwordx4 v[104:107], v11, s[32:35], 0 offen offset:256
    ds_read_b128 v[160:163], v146 offset:29696
    ds_read_b128 v[164:167], v146 offset:29952
    s_waitcnt lgkmcnt(2)
    v_dot2c_f32_bf16 v155, v216, v168
    v_dot2c_f32_bf16 v155, v217, v169
    v_dot2c_f32_bf16 v155, v218, v170
    v_dot2c_f32_bf16 v155, v219, v171
    v_dot2c_f32_bf16 v155, v220, v172
    v_dot2c_f32_bf16 v155, v221, v173
    v_dot2c_f32_bf16 v155, v222, v174
    v_dot2c_f32_bf16 v155, v223, v175
    v_add_f32_dpp v150, v150, v150 row_half_mirror row_mask:0xf bank_mask:0x5
    v_add_f32_dpp v150, v152, v152 row_half_mirror row_mask:0xf bank_mask:0xa
    v_add_u32_dpp v11, v32, v7 row_newbcast:7 row_mask:0xf bank_mask:0xf
    buffer_load_dwordx4 v[100:103], v11, s[32:35], 0 offen offset:0
    buffer_load_dwordx4 v[108:111], v11, s[32:35], 0 offen offset:256
    ds_read_b128 v[168:171], v147 offset:29696
    ds_read_b128 v[172:175], v147 offset:29952
    s_waitcnt lgkmcnt(2)
    v_dot2c_f32_bf16 v156, v224, v160
    v_dot2c_f32_bf16 v156, v225, v161
    v_dot2c_f32_bf16 v156, v226, v162
    v_dot2c_f32_bf16 v156, v227, v163
    v_dot2c_f32_bf16 v156, v228, v164
    v_dot2c_f32_bf16 v156, v229, v165
    v_dot2c_f32_bf16 v156, v230, v166
    v_dot2c_f32_bf16 v156, v231, v167
    v_add_f32_dpp v154, v154, v154 row_ror:8 row_mask:0xf bank_mask:0x3
    v_add_f32_dpp v154, v155, v155 row_ror:8 row_mask:0xf bank_mask:0xc
    v_add_u32_dpp v11, v32, v7 row_newbcast:8 row_mask:0xf bank_mask:0xf
    buffer_load_dwordx4 v[112:115], v11, s[32:35], 0 offen offset:0
    buffer_load_dwordx4 v[120:123], v11, s[32:35], 0 offen offset:256
    ds_read_b128 v[160:163], v148 offset:21504
    ds_read_b128 v[164:167], v148 offset:21760
    s_waitcnt lgkmcnt(2)
    v_dot2c_f32_bf16 v157, v232, v168
    v_dot2c_f32_bf16 v157, v233, v169
    v_dot2c_f32_bf16 v157, v234, v170
    v_dot2c_f32_bf16 v157, v235, v171
    v_dot2c_f32_bf16 v157, v236, v172
    v_dot2c_f32_bf16 v157, v237, v173
    v_dot2c_f32_bf16 v157, v238, v174
    v_dot2c_f32_bf16 v157, v239, v175
    v_add_u32_dpp v11, v32, v7 row_newbcast:9 row_mask:0xf bank_mask:0xf
    buffer_load_dwordx4 v[116:119], v11, s[32:35], 0 offen offset:0
    buffer_load_dwordx4 v[124:127], v11, s[32:35], 0 offen offset:256
    ds_read_b128 v[168:171], v149 offset:21504
    ds_read_b128 v[172:175], v149 offset:21760
    s_waitcnt lgkmcnt(2)
    v_dot2c_f32_bf16 v158, v240, v160
    v_dot2c_f32_bf16 v158, v241, v161
    v_dot2c_f32_bf16 v158, v242, v162
    v_dot2c_f32_bf16 v158, v243, v163
    v_dot2c_f32_bf16 v158, v244, v164
    v_dot2c_f32_bf16 v158, v245, v165
    v_dot2c_f32_bf16 v158, v246, v166
    v_dot2c_f32_bf16 v158, v247, v167
    v_add_f32_dpp v156, v156, v156 row_ror:8 row_mask:0xf bank_mask:0x3
    v_add_f32_dpp v156, v157, v157 row_ror:8 row_mask:0xf bank_mask:0xc
    v_add_u32_dpp v11, v32, v7 row_newbcast:10 row_mask:0xf bank_mask:0xf
    buffer_load_dwordx4 v[128:131], v11, s[32:35], 0 offen offset:0
    buffer_load_dwordx4 v[136:139], v11, s[32:35], 0 offen offset:256
    s_waitcnt lgkmcnt(0)
    v_dot2c_f32_bf16 v159, v248, v168
    v_dot2c_f32_bf16 v159, v249, v169
    v_dot2c_f32_bf16 v159, v250, v170
    v_dot2c_f32_bf16 v159, v251, v171
    v_dot2c_f32_bf16 v159, v252, v172
    v_dot2c_f32_bf16 v159, v253, v173
    v_dot2c_f32_bf16 v159, v254, v174
    v_dot2c_f32_bf16 v159, v255, v175
    v_add_f32_dpp v154, v154, v154 row_half_mirror row_mask:0xf bank_mask:0x5
    v_add_f32_dpp v154, v156, v156 row_half_mirror row_mask:0xf bank_mask:0xa
    v_add_u32_dpp v11, v32, v7 row_newbcast:11 row_mask:0xf bank_mask:0xf
    buffer_load_dwordx4 v[132:135], v11, s[32:35], 0 offen offset:0
    buffer_load_dwordx4 v[140:143], v11, s[32:35], 0 offen offset:256
    v_add_f32_dpp v150, v150, v150 quad_perm:[1,0,3,2] row_mask:0xf bank_mask:0xf
    s_nop 0
    v_add_f32_dpp v158, v158, v158 row_ror:8 row_mask:0xf bank_mask:0x3
    v_add_f32_dpp v158, v159, v159 row_ror:8 row_mask:0xf bank_mask:0xc
    v_add_f32_dpp v154, v154, v154 quad_perm:[1,0,3,2] row_mask:0xf bank_mask:0xf
    v_add_f32_dpp v150, v150, v150 quad_perm:[2,3,0,1] row_mask:0xf bank_mask:0xf
    v_add_f32_dpp v158, v158, v158 row_half_mirror row_mask:0xf bank_mask:0x5
    v_add_f32_dpp v154, v154, v154 quad_perm:[2,3,0,1] row_mask:0xf bank_mask:0xf
    s_nop 0
    v_add_f32_dpp v158, v158, v158 quad_perm:[1,0,3,2] row_mask:0xf bank_mask:0xf
    v_cndmask_b32 v150, v150, v154, s[66:67]
    s_nop 0
    v_add_f32_dpp v158, v158, v158 quad_perm:[2,3,0,1] row_mask:0xf bank_mask:0xf
    v_cndmask_b32 v150, v150, v158, s[68:69]
    v_mul_f32 v150, 0x3db8aa3b, v150
    v_exp_f32 v150, v150
    s_nop 0
    v_mov_b32 v44, v150
    v_mov_b32 v45, v150
    s_nop 1
    v_permlane32_swap_b32 v44, v45
    v_add_f32 v44, v44, v45
    v_mov_b32 v45, v44
    s_nop 1
    v_permlane16_swap_b32 v44, v45
    v_add_f32 v44, v44, v45
    v_add_f32 v44, 0x3089705f, v44
    v_rcp_f32 v44, v44
    s_nop 0
    v_mul_f32 v150, v150, v44
    v_cvt_pk_bf16_f32 v150, v150, 0
    v_lshlrev_b32 v8, v9, v150
    s_nop 1
    v_and_b32_dpp v24, v8, v12 row_newbcast:0 row_mask:0xf bank_mask:0xf
    v_and_b32_dpp v25, v8, v13 row_newbcast:0 row_mask:0xf bank_mask:0xf
    v_mov_b64 v[40:41], 0
    v_mov_b64 v[42:43], 0
    v_mov_b64 v[44:45], 0
    v_mov_b64 v[46:47], 0
    v_smfmac_f32_16x16x32_bf16 v[40:43], v[24:25], v[176:179], v14
    v_and_b32_dpp v28, v8, v12 row_newbcast:8 row_mask:0xf bank_mask:0xf
    v_and_b32_dpp v29, v8, v13 row_newbcast:8 row_mask:0xf bank_mask:0xf
    v_smfmac_f32_16x16x32_bf16 v[44:47], v[24:25], v[180:183], v14
    v_add_u32_dpp v11, v32, v7 row_newbcast:12 row_mask:0xf bank_mask:0xf
    buffer_load_dwordx4 v[144:147], v11, s[32:35], 0 offen offset:0
    buffer_load_dwordx4 v[152:155], v11, s[32:35], 0 offen offset:256
    v_smfmac_f32_16x16x32_bf16 v[40:43], v[28:29], v[184:187], v14
    v_and_b32_dpp v24, v8, v12 row_newbcast:4 row_mask:0xf bank_mask:0xf
    v_and_b32_dpp v25, v8, v13 row_newbcast:4 row_mask:0xf bank_mask:0xf
    v_smfmac_f32_16x16x32_bf16 v[44:47], v[28:29], v[188:191], v14
    s_nop 0
    v_smfmac_f32_16x16x32_bf16 v[16:19], v[24:25], v[192:195], v14
    v_and_b32_dpp v28, v8, v12 row_newbcast:12 row_mask:0xf bank_mask:0xf
    v_and_b32_dpp v29, v8, v13 row_newbcast:12 row_mask:0xf bank_mask:0xf
    v_smfmac_f32_16x16x32_bf16 v[20:23], v[24:25], v[196:199], v14
    v_add_u32_dpp v11, v32, v7 row_newbcast:13 row_mask:0xf bank_mask:0xf
    buffer_load_dwordx4 v[148:151], v11, s[32:35], 0 offen offset:0
    buffer_load_dwordx4 v[156:159], v11, s[32:35], 0 offen offset:256
    v_smfmac_f32_16x16x32_bf16 v[16:19], v[28:29], v[200:203], v14
    v_and_b32_dpp v24, v8, v12 row_newbcast:1 row_mask:0xf bank_mask:0xf
    v_and_b32_dpp v25, v8, v13 row_newbcast:1 row_mask:0xf bank_mask:0xf
    v_smfmac_f32_16x16x32_bf16 v[20:23], v[28:29], v[204:207], v14
    v_xor_b32 v178, s15, v2
    s_lshl_b32 s64, s20, 2
    v_add_u32 v9, s64, v0
    v_mov_b32 v179, 0
    v_cvt_pk_bf16_f32 v30, v40, v41
    v_cvt_pk_bf16_f32 v31, v42, v43
    ds_write_b64 v178, v[30:31] offset:1024
    v_cvt_pk_bf16_f32 v30, v44, v45
    v_cvt_pk_bf16_f32 v31, v46, v47
    ds_write_b64 v178, v[30:31] offset:1280
    ds_read_u16_d16_hi v179, v9
    v_mov_b64 v[40:41], 0
    v_mov_b64 v[42:43], 0
    v_mov_b64 v[44:45], 0
    v_mov_b64 v[46:47], 0
    s_nop 0
    v_smfmac_f32_16x16x32_bf16 v[40:43], v[24:25], v[208:211], v14
    v_and_b32_dpp v28, v8, v12 row_newbcast:9 row_mask:0xf bank_mask:0xf
    v_and_b32_dpp v29, v8, v13 row_newbcast:9 row_mask:0xf bank_mask:0xf
    v_smfmac_f32_16x16x32_bf16 v[44:47], v[24:25], v[212:215], v14
    v_add_u32_dpp v11, v32, v7 row_newbcast:14 row_mask:0xf bank_mask:0xf
    buffer_load_dwordx4 v[160:163], v11, s[32:35], 0 offen offset:0
    buffer_load_dwordx4 v[168:171], v11, s[32:35], 0 offen offset:256
    v_smfmac_f32_16x16x32_bf16 v[40:43], v[28:29], v[216:219], v14
    v_and_b32_dpp v24, v8, v12 row_newbcast:5 row_mask:0xf bank_mask:0xf
    v_and_b32_dpp v25, v8, v13 row_newbcast:5 row_mask:0xf bank_mask:0xf
    v_smfmac_f32_16x16x32_bf16 v[44:47], v[28:29], v[220:223], v14
    v_xor_b32 v180, s16, v2
    s_lshl_b32 s64, s21, 2
    v_add_u32 v9, s64, v0
    v_mov_b32 v181, 0
    v_cvt_pk_bf16_f32 v30, v16, v17
    v_cvt_pk_bf16_f32 v31, v18, v19
    ds_write_b64 v180, v[30:31] offset:1024
    v_cvt_pk_bf16_f32 v30, v20, v21
    v_cvt_pk_bf16_f32 v31, v22, v23
    ds_write_b64 v180, v[30:31] offset:1280
    ds_read_u16_d16_hi v181, v9
    v_mov_b64 v[16:17], 0
    v_mov_b64 v[18:19], 0
    v_mov_b64 v[20:21], 0
    v_mov_b64 v[22:23], 0
    s_nop 0
    v_smfmac_f32_16x16x32_bf16 v[16:19], v[24:25], v[224:227], v14
    v_and_b32_dpp v28, v8, v12 row_newbcast:13 row_mask:0xf bank_mask:0xf
    v_and_b32_dpp v29, v8, v13 row_newbcast:13 row_mask:0xf bank_mask:0xf
    v_smfmac_f32_16x16x32_bf16 v[20:23], v[24:25], v[228:231], v14
    v_add_u32_dpp v11, v32, v7 row_newbcast:15 row_mask:0xf bank_mask:0xf
    buffer_load_dwordx4 v[164:167], v11, s[32:35], 0 offen offset:0
    buffer_load_dwordx4 v[172:175], v11, s[32:35], 0 offen offset:256
    v_smfmac_f32_16x16x32_bf16 v[16:19], v[28:29], v[232:235], v14
    v_and_b32_dpp v24, v8, v12 row_newbcast:2 row_mask:0xf bank_mask:0xf
    v_and_b32_dpp v25, v8, v13 row_newbcast:2 row_mask:0xf bank_mask:0xf
    v_smfmac_f32_16x16x32_bf16 v[20:23], v[28:29], v[236:239], v14
    v_xor_b32 v182, s17, v2
    s_lshl_b32 s64, s22, 2
    v_add_u32 v9, s64, v0
    v_mov_b32 v183, 0
    v_cvt_pk_bf16_f32 v30, v40, v41
    v_cvt_pk_bf16_f32 v31, v42, v43
    ds_write_b64 v182, v[30:31] offset:1024
    v_cvt_pk_bf16_f32 v30, v44, v45
    v_cvt_pk_bf16_f32 v31, v46, v47
    ds_write_b64 v182, v[30:31] offset:1280
    ds_read_u16_d16_hi v183, v9
    v_mov_b64 v[40:41], 0
    v_mov_b64 v[42:43], 0
    v_mov_b64 v[44:45], 0
    v_mov_b64 v[46:47], 0
    s_nop 0
    v_smfmac_f32_16x16x32_bf16 v[40:43], v[24:25], v[240:243], v14
    v_and_b32_dpp v28, v8, v12 row_newbcast:10 row_mask:0xf bank_mask:0xf
    v_and_b32_dpp v29, v8, v13 row_newbcast:10 row_mask:0xf bank_mask:0xf
    v_smfmac_f32_16x16x32_bf16 v[44:47], v[24:25], v[244:247], v14
    s_nop 0
    v_smfmac_f32_16x16x32_bf16 v[40:43], v[28:29], v[248:251], v14
    v_and_b32_dpp v24, v33, v12 row_newbcast:0 row_mask:0xf bank_mask:0xf
    v_and_b32_dpp v25, v33, v13 row_newbcast:0 row_mask:0xf bank_mask:0xf
    v_and_b32_dpp v26, v33, v12 row_newbcast:1 row_mask:0xf bank_mask:0xf
    v_and_b32_dpp v27, v33, v13 row_newbcast:1 row_mask:0xf bank_mask:0xf
    v_smfmac_f32_16x16x32_bf16 v[44:47], v[28:29], v[252:255], v14
    v_xor_b32 v184, s18, v2
    s_lshl_b32 s64, s23, 2
    v_add_u32 v9, s64, v0
    v_mov_b32 v185, 0
    v_cvt_pk_bf16_f32 v30, v16, v17
    v_cvt_pk_bf16_f32 v31, v18, v19
    ds_write_b64 v184, v[30:31] offset:1024
    v_cvt_pk_bf16_f32 v30, v20, v21
    v_cvt_pk_bf16_f32 v31, v22, v23
    ds_write_b64 v184, v[30:31] offset:1280
    ds_read_u16_d16_hi v185, v9
    v_mov_b64 v[16:17], 0
    v_mov_b64 v[18:19], 0
    v_mov_b64 v[20:21], 0
    v_mov_b64 v[22:23], 0
    s_nop 0
    v_xor_b32 v176, s19, v2
    s_lshl_b32 s64, s24, 2
    v_add_u32 v9, s64, v0
    v_mov_b32 v177, 0
    v_cvt_pk_bf16_f32 v30, v40, v41
    v_cvt_pk_bf16_f32 v31, v42, v43
    ds_write_b64 v176, v[30:31] offset:1024
    v_cvt_pk_bf16_f32 v30, v44, v45
    v_cvt_pk_bf16_f32 v31, v46, v47
    ds_write_b64 v176, v[30:31] offset:1280
    ds_read_u16_d16_hi v177, v9
    s_waitcnt lgkmcnt(0)
    s_barrier
    s_cmp_lg_u32 s25, 0
    s_cbranch_scc1 L_slow
L_fp0:
    s_bitcmp1_b32 s52, 0
    s_waitcnt vmcnt(28)
    v_smfmac_f32_16x16x64_bf16 v[16:19], v[24:27], v[48:55], v14
    v_and_b32_dpp v28, v33, v12 row_newbcast:2 row_mask:0xf bank_mask:0xf
    v_and_b32_dpp v29, v33, v13 row_newbcast:2 row_mask:0xf bank_mask:0xf
    v_smfmac_f32_16x16x64_bf16 v[20:23], v[24:27], v[56:63], v14
    v_and_b32_dpp v30, v33, v12 row_newbcast:3 row_mask:0xf bank_mask:0xf
    v_and_b32_dpp v31, v33, v13 row_newbcast:3 row_mask:0xf bank_mask:0xf
    v_add_u32_dpp v11, v34, v7 row_newbcast:0 row_mask:0xf bank_mask:0xf
    buffer_load_dwordx4 v[48:51], v11, s[32:35], 0 offen offset:0
    buffer_load_dwordx4 v[56:59], v11, s[32:35], 0 offen offset:256
    s_cbranch_scc1 L_ev0
L_fp1:
    s_bitcmp1_b32 s52, 1
    s_waitcnt vmcnt(26)
    v_smfmac_f32_16x16x64_bf16 v[16:19], v[28:31], v[64:71], v14
    v_and_b32_dpp v24, v33, v12 row_newbcast:4 row_mask:0xf bank_mask:0xf
    v_and_b32_dpp v25, v33, v13 row_newbcast:4 row_mask:0xf bank_mask:0xf
    v_smfmac_f32_16x16x64_bf16 v[20:23], v[28:31], v[72:79], v14
    v_and_b32_dpp v26, v33, v12 row_newbcast:5 row_mask:0xf bank_mask:0xf
    v_and_b32_dpp v27, v33, v13 row_newbcast:5 row_mask:0xf bank_mask:0xf
    v_add_u32_dpp v11, v34, v7 row_newbcast:1 row_mask:0xf bank_mask:0xf
    buffer_load_dwordx4 v[52:55], v11, s[32:35], 0 offen offset:0
    buffer_load_dwordx4 v[60:63], v11, s[32:35], 0 offen offset:256
    s_cbranch_scc1 L_ev1
L_fp2:
    s_bitcmp1_b32 s52, 2
    s_waitcnt vmcnt(24)
    v_smfmac_f32_16x16x64_bf16 v[16:19], v[24:27], v[80:87], v14
    v_and_b32_dpp v28, v33, v12 row_newbcast:6 row_mask:0xf bank_mask:0xf
    v_and_b32_dpp v29, v33, v13 row_newbcast:6 row_mask:0xf bank_mask:0xf
    v_smfmac_f32_16x16x64_bf16 v[20:23], v[24:27], v[88:95], v14
    v_and_b32_dpp v30, v33, v12 row_newbcast:7 row_mask:0xf bank_mask:0xf
    v_and_b32_dpp v31, v33, v13 row_newbcast:7 row_mask:0xf bank_mask:0xf
    v_add_u32_dpp v11, v34, v7 row_newbcast:2 row_mask:0xf bank_mask:0xf
    buffer_load_dwordx4 v[64:67], v11, s[32:35], 0 offen offset:0
    buffer_load_dwordx4 v[72:75], v11, s[32:35], 0 offen offset:256
    s_cbranch_scc1 L_ev2
L_fp3:
    s_bitcmp1_b32 s52, 3
    s_waitcnt vmcnt(22)
    v_smfmac_f32_16x16x64_bf16 v[16:19], v[28:31], v[96:103], v14
    v_and_b32_dpp v24, v33, v12 row_newbcast:8 row_mask:0xf bank_mask:0xf
    v_and_b32_dpp v25, v33, v13 row_newbcast:8 row_mask:0xf bank_mask:0xf
    v_smfmac_f32_16x16x64_bf16 v[20:23], v[28:31], v[104:111], v14
    v_and_b32_dpp v26, v33, v12 row_newbcast:9 row_mask:0xf bank_mask:0xf
    v_and_b32_dpp v27, v33, v13 row_newbcast:9 row_mask:0xf bank_mask:0xf
    v_add_u32_dpp v11, v34, v7 row_newbcast:3 row_mask:0xf bank_mask:0xf
    buffer_load_dwordx4 v[68:71], v11, s[32:35], 0 offen offset:0
    buffer_load_dwordx4 v[76:79], v11, s[32:35], 0 offen offset:256
    s_cbranch_scc1 L_ev3
L_fp4:
    s_bitcmp1_b32 s52, 4
    s_waitcnt vmcnt(20)
    v_smfmac_f32_16x16x64_bf16 v[16:19], v[24:27], v[112:119], v14
    v_and_b32_dpp v28, v33, v12 row_newbcast:10 row_mask:0xf bank_mask:0xf
    v_and_b32_dpp v29, v33, v13 row_newbcast:10 row_mask:0xf bank_mask:0xf
    v_smfmac_f32_16x16x64_bf16 v[20:23], v[24:27], v[120:127], v14
    v_and_b32_dpp v30, v33, v12 row_newbcast:11 row_mask:0xf bank_mask:0xf
    v_and_b32_dpp v31, v33, v13 row_newbcast:11 row_mask:0xf bank_mask:0xf
    v_add_u32_dpp v11, v34, v7 row_newbcast:4 row_mask:0xf bank_mask:0xf
    buffer_load_dwordx4 v[80:83], v11, s[32:35], 0 offen offset:0
    buffer_load_dwordx4 v[88:91], v11, s[32:35], 0 offen offset:256
    s_cbranch_scc1 L_ev4
L_fp5:
    s_bitcmp1_b32 s52, 5
    s_waitcnt vmcnt(18)
    v_smfmac_f32_16x16x64_bf16 v[16:19], v[28:31], v[128:135], v14
    v_and_b32_dpp v24, v33, v12 row_newbcast:12 row_mask:0xf bank_mask:0xf
    v_and_b32_dpp v25, v33, v13 row_newbcast:12 row_mask:0xf bank_mask:0xf
    v_smfmac_f32_16x16x64_bf16 v[20:23], v[28:31], v[136:143], v14
    v_and_b32_dpp v26, v33, v12 row_newbcast:13 row_mask:0xf bank_mask:0xf
    v_and_b32_dpp v27, v33, v13 row_newbcast:13 row_mask:0xf bank_mask:0xf
    v_add_u32_dpp v11, v34, v7 row_newbcast:5 row_mask:0xf bank_mask:0xf
    buffer_load_dwordx4 v[84:87], v11, s[32:35], 0 offen offset:0
    buffer_load_dwordx4 v[92:95], v11, s[32:35], 0 offen offset:256
    s_cbranch_scc1 L_ev5
L_fp6:
    s_bitcmp1_b32 s52, 6
    s_waitcnt vmcnt(16)
    v_smfmac_f32_16x16x64_bf16 v[16:19], v[24:27], v[144:151], v14
    v_and_b32_dpp v28, v33, v12 row_newbcast:14 row_mask:0xf bank_mask:0xf
    v_and_b32_dpp v29, v33, v13 row_newbcast:14 row_mask:0xf bank_mask:0xf
    v_smfmac_f32_16x16x64_bf16 v[20:23], v[24:27], v[152:159], v14
    v_and_b32_dpp v30, v33, v12 row_newbcast:15 row_mask:0xf bank_mask:0xf
    v_and_b32_dpp v31, v33, v13 row_newbcast:15 row_mask:0xf bank_mask:0xf
    v_add_u32_dpp v11, v34, v7 row_newbcast:6 row_mask:0xf bank_mask:0xf
    buffer_load_dwordx4 v[96:99], v11, s[32:35], 0 offen offset:0
    buffer_load_dwordx4 v[104:107], v11, s[32:35], 0 offen offset:256
    s_cbranch_scc1 L_ev6
L_fp7:
    s_bitcmp1_b32 s52, 7
    s_waitcnt vmcnt(14)
    v_smfmac_f32_16x16x64_bf16 v[16:19], v[28:31], v[160:167], v14
    v_and_b32_dpp v24, v35, v12 row_newbcast:0 row_mask:0xf bank_mask:0xf
    v_and_b32_dpp v25, v35, v13 row_newbcast:0 row_mask:0xf bank_mask:0xf
    v_smfmac_f32_16x16x64_bf16 v[20:23], v[28:31], v[168:175], v14
    v_and_b32_dpp v26, v35, v12 row_newbcast:1 row_mask:0xf bank_mask:0xf
    v_and_b32_dpp v27, v35, v13 row_newbcast:1 row_mask:0xf bank_mask:0xf
    v_add_u32_dpp v11, v34, v7 row_newbcast:7 row_mask:0xf bank_mask:0xf
    buffer_load_dwordx4 v[100:103], v11, s[32:35], 0 offen offset:0
    buffer_load_dwordx4 v[108:111], v11, s[32:35], 0 offen offset:256
    s_cbranch_scc1 L_ev7
L_fp8:
    v_mov_b64 v[32:33], v[34:35]
    v_mov_b64 v[34:35], v[36:37]
    v_mov_b64 v[36:37], v[38:39]
    s_lshr_b32 s52, s52, 8
    s_lshr_b32 s53, s53, 8
    s_lshr_b32 s56, s56, 8
    s_mov_b32 s62, L_st1-L_anc
    s_mov_b32 s63, L_st1-L_st0
L_st0:
    s_bitcmp1_b32 s52, 0
    s_waitcnt vmcnt(12)
    v_smfmac_f32_16x16x64_bf16 v[16:19], v[24:27], v[48:55], v14
    v_and_b32_dpp v28, v33, v12 row_newbcast:2 row_mask:0xf bank_mask:0xf
    v_and_b32_dpp v29, v33, v13 row_newbcast:2 row_mask:0xf bank_mask:0xf
    v_smfmac_f32_16x16x64_bf16 v[20:23], v[24:27], v[56:63], v14
    v_and_b32_dpp v30, v33, v12 row_newbcast:3 row_mask:0xf bank_mask:0xf
    v_and_b32_dpp v31, v33, v13 row_newbcast:3 row_mask:0xf bank_mask:0xf
    v_add_u32_dpp v11, v32, v7 row_newbcast:8 row_mask:0xf bank_mask:0xf
    buffer_load_dwordx4 v[112:115], v11, s[32:35], 0 offen offset:0
    buffer_load_dwordx4 v[120:123], v11, s[32:35], 0 offen offset:256
    v_add_u32_dpp v11, v32, v7 row_newbcast:9 row_mask:0xf bank_mask:0xf
    buffer_load_dwordx4 v[116:119], v11, s[32:35], 0 offen offset:0
    buffer_load_dwordx4 v[124:127], v11, s[32:35], 0 offen offset:256
    s_cbranch_scc1 L_ev0
L_st1:
    s_bitcmp1_b32 s52, 1
    s_waitcnt vmcnt(12)
    v_smfmac_f32_16x16x64_bf16 v[16:19], v[28:31], v[64:71], v14
    v_and_b32_dpp v24, v33, v12 row_newbcast:4 row_mask:0xf bank_mask:0xf
    v_and_b32_dpp v25, v33, v13 row_newbcast:4 row_mask:0xf bank_mask:0xf
    v_smfmac_f32_16x16x64_bf16 v[20:23], v[28:31], v[72:79], v14
    v_and_b32_dpp v26, v33, v12 row_newbcast:5 row_mask:0xf bank_mask:0xf
    v_and_b32_dpp v27, v33, v13 row_newbcast:5 row_mask:0xf bank_mask:0xf
    v_add_u32_dpp v11, v32, v7 row_newbcast:10 row_mask:0xf bank_mask:0xf
    buffer_load_dwordx4 v[128:131], v11, s[32:35], 0 offen offset:0
    buffer_load_dwordx4 v[136:139], v11, s[32:35], 0 offen offset:256
    v_add_u32_dpp v11, v32, v7 row_newbcast:11 row_mask:0xf bank_mask:0xf
    buffer_load_dwordx4 v[132:135], v11, s[32:35], 0 offen offset:0
    buffer_load_dwordx4 v[140:143], v11, s[32:35], 0 offen offset:256
    s_cbranch_scc1 L_ev1
L_st2:
    s_bitcmp1_b32 s52, 2
    s_waitcnt vmcnt(12)
    v_smfmac_f32_16x16x64_bf16 v[16:19], v[24:27], v[80:87], v14
    v_and_b32_dpp v28, v33, v12 row_newbcast:6 row_mask:0xf bank_mask:0xf
    v_and_b32_dpp v29, v33, v13 row_newbcast:6 row_mask:0xf bank_mask:0xf
    v_smfmac_f32_16x16x64_bf16 v[20:23], v[24:27], v[88:95], v14
    v_and_b32_dpp v30, v33, v12 row_newbcast:7 row_mask:0xf bank_mask:0xf
    v_and_b32_dpp v31, v33, v13 row_newbcast:7 row_mask:0xf bank_mask:0xf
    v_add_u32_dpp v11, v32, v7 row_newbcast:12 row_mask:0xf bank_mask:0xf
    buffer_load_dwordx4 v[144:147], v11, s[32:35], 0 offen offset:0
    buffer_load_dwordx4 v[152:155], v11, s[32:35], 0 offen offset:256
    v_add_u32_dpp v11, v32, v7 row_newbcast:13 row_mask:0xf bank_mask:0xf
    buffer_load_dwordx4 v[148:151], v11, s[32:35], 0 offen offset:0
    buffer_load_dwordx4 v[156:159], v11, s[32:35], 0 offen offset:256
    s_cbranch_scc1 L_ev2
L_st3:
    s_bitcmp1_b32 s52, 3
    s_waitcnt vmcnt(12)
    v_smfmac_f32_16x16x64_bf16 v[16:19], v[28:31], v[96:103], v14
    v_and_b32_dpp v24, v33, v12 row_newbcast:8 row_mask:0xf bank_mask:0xf
    v_and_b32_dpp v25, v33, v13 row_newbcast:8 row_mask:0xf bank_mask:0xf
    v_smfmac_f32_16x16x64_bf16 v[20:23], v[28:31], v[104:111], v14
    v_and_b32_dpp v26, v33, v12 row_newbcast:9 row_mask:0xf bank_mask:0xf
    v_and_b32_dpp v27, v33, v13 row_newbcast:9 row_mask:0xf bank_mask:0xf
    v_add_u32_dpp v11, v32, v7 row_newbcast:14 row_mask:0xf bank_mask:0xf
    buffer_load_dwordx4 v[160:163], v11, s[32:35], 0 offen offset:0
    buffer_load_dwordx4 v[168:171], v11, s[32:35], 0 offen offset:256
    v_add_u32_dpp v11, v32, v7 row_newbcast:15 row_mask:0xf bank_mask:0xf
    buffer_load_dwordx4 v[164:167], v11, s[32:35], 0 offen offset:0
    buffer_load_dwordx4 v[172:175], v11, s[32:35], 0 offen offset:256
    s_cbranch_scc1 L_ev3
L_st4:
    s_bitcmp1_b32 s52, 4
    s_waitcnt vmcnt(12)
    v_smfmac_f32_16x16x64_bf16 v[16:19], v[24:27], v[112:119], v14
    v_and_b32_dpp v28, v33, v12 row_newbcast:10 row_mask:0xf bank_mask:0xf
    v_and_b32_dpp v29, v33, v13 row_newbcast:10 row_mask:0xf bank_mask:0xf
    v_smfmac_f32_16x16x64_bf16 v[20:23], v[24:27], v[120:127], v14
    v_and_b32_dpp v30, v33, v12 row_newbcast:11 row_mask:0xf bank_mask:0xf
    v_and_b32_dpp v31, v33, v13 row_newbcast:11 row_mask:0xf bank_mask:0xf
    v_add_u32_dpp v11, v34, v7 row_newbcast:0 row_mask:0xf bank_mask:0xf
    buffer_load_dwordx4 v[48:51], v11, s[32:35], 0 offen offset:0
    buffer_load_dwordx4 v[56:59], v11, s[32:35], 0 offen offset:256
    v_add_u32_dpp v11, v34, v7 row_newbcast:1 row_mask:0xf bank_mask:0xf
    buffer_load_dwordx4 v[52:55], v11, s[32:35], 0 offen offset:0
    buffer_load_dwordx4 v[60:63], v11, s[32:35], 0 offen offset:256
    s_cbranch_scc1 L_ev4
L_st5:
    s_bitcmp1_b32 s52, 5
    s_waitcnt vmcnt(12)
    v_smfmac_f32_16x16x64_bf16 v[16:19], v[28:31], v[128:135], v14
    v_and_b32_dpp v24, v33, v12 row_newbcast:12 row_mask:0xf bank_mask:0xf
    v_and_b32_dpp v25, v33, v13 row_newbcast:12 row_mask:0xf bank_mask:0xf
    v_smfmac_f32_16x16x64_bf16 v[20:23], v[28:31], v[136:143], v14
    v_and_b32_dpp v26, v33, v12 row_newbcast:13 row_mask:0xf bank_mask:0xf
    v_and_b32_dpp v27, v33, v13 row_newbcast:13 row_mask:0xf bank_mask:0xf
    v_add_u32_dpp v11, v34, v7 row_newbcast:2 row_mask:0xf bank_mask:0xf
    buffer_load_dwordx4 v[64:67], v11, s[32:35], 0 offen offset:0
    buffer_load_dwordx4 v[72:75], v11, s[32:35], 0 offen offset:256
    v_add_u32_dpp v11, v34, v7 row_newbcast:3 row_mask:0xf bank_mask:0xf
    buffer_load_dwordx4 v[68:71], v11, s[32:35], 0 offen offset:0
    buffer_load_dwordx4 v[76:79], v11, s[32:35], 0 offen offset:256
    s_cbranch_scc1 L_ev5
L_st6:
    s_bitcmp1_b32 s52, 6
    s_waitcnt vmcnt(12)
    v_smfmac_f32_16x16x64_bf16 v[16:19], v[24:27], v[144:151], v14
    v_and_b32_dpp v28, v33, v12 row_newbcast:14 row_mask:0xf bank_mask:0xf
    v_and_b32_dpp v29, v33, v13 row_newbcast:14 row_mask:0xf bank_mask:0xf
    v_smfmac_f32_16x16x64_bf16 v[20:23], v[24:27], v[152:159], v14
    v_and_b32_dpp v30, v33, v12 row_newbcast:15 row_mask:0xf bank_mask:0xf
    v_and_b32_dpp v31, v33, v13 row_newbcast:15 row_mask:0xf bank_mask:0xf
    v_add_u32_dpp v11, v34, v7 row_newbcast:4 row_mask:0xf bank_mask:0xf
    buffer_load_dwordx4 v[80:83], v11, s[32:35], 0 offen offset:0
    buffer_load_dwordx4 v[88:91], v11, s[32:35], 0 offen offset:256
    v_add_u32_dpp v11, v34, v7 row_newbcast:5 row_mask:0xf bank_mask:0xf
    buffer_load_dwordx4 v[84:87], v11, s[32:35], 0 offen offset:0
    buffer_load_dwordx4 v[92:95], v11, s[32:35], 0 offen offset:256
    s_cbranch_scc1 L_ev6
L_st7:
    s_bitcmp1_b32 s52, 7
    s_waitcnt vmcnt(12)
    v_smfmac_f32_16x16x64_bf16 v[16:19], v[28:31], v[160:167], v14
    v_and_b32_dpp v24, v35, v12 row_newbcast:0 row_mask:0xf bank_mask:0xf
    v_and_b32_dpp v25, v35, v13 row_newbcast:0 row_mask:0xf bank_mask:0xf
    v_smfmac_f32_16x16x64_bf16 v[20:23], v[28:31], v[168:175], v14
    v_and_b32_dpp v26, v35, v12 row_newbcast:1 row_mask:0xf bank_mask:0xf
    v_and_b32_dpp v27, v35, v13 row_newbcast:1 row_mask:0xf bank_mask:0xf
    v_add_u32_dpp v11, v34, v7 row_newbcast:6 row_mask:0xf bank_mask:0xf
    buffer_load_dwordx4 v[96:99], v11, s[32:35], 0 offen offset:0
    buffer_load_dwordx4 v[104:107], v11, s[32:35], 0 offen offset:256
    v_add_u32_dpp v11, v34, v7 row_newbcast:7 row_mask:0xf bank_mask:0xf
    buffer_load_dwordx4 v[100:103], v11, s[32:35], 0 offen offset:0
    buffer_load_dwordx4 v[108:111], v11, s[32:35], 0 offen offset:256
    s_cbranch_scc1 L_ev7
L_st8:
    v_mov_b64 v[32:33], v[34:35]
    v_mov_b64 v[34:35], v[36:37]
    v_mov_b64 v[36:37], v[38:39]
    s_lshr_b32 s52, s52, 8
    s_lshr_b32 s53, s53, 8
    s_lshr_b32 s56, s56, 8
    s_branch L_st0
L_pad8:
    s_setpc_b64 s[68:69]
L_dr0:
    s_add_u32 s49, s49, 1
    ds_write_b32 v10, v6 offset:48
    s_waitcnt vmcnt(12)
    v_smfmac_f32_16x16x64_bf16 v[16:19], v[24:27], v[48:55], v14
    v_and_b32_dpp v28, v33, v12 row_newbcast:2 row_mask:0xf bank_mask:0xf
    v_and_b32_dpp v29, v33, v13 row_newbcast:2 row_mask:0xf bank_mask:0xf
    v_smfmac_f32_16x16x64_bf16 v[20:23], v[24:27], v[56:63], v14
    v_and_b32_dpp v30, v33, v12 row_newbcast:3 row_mask:0xf bank_mask:0xf
    v_and_b32_dpp v31, v33, v13 row_newbcast:3 row_mask:0xf bank_mask:0xf
    s_cmp_eq_u32 s49, 1
    s_cbranch_scc1 L_dw0_1
    s_cmp_eq_u32 s49, 2
    s_cbranch_scc1 L_dw0_2
L_dw0_3:
    s_waitcnt vmcnt(0)
L_dw0_2:
    s_waitcnt vmcnt(4)
L_dw0_1:
    s_waitcnt vmcnt(8)
    s_bitcmp1_b32 s52, 0
    s_cbranch_scc1 L_ev0
L_dr1:
    s_add_u32 s49, s49, 1
    ds_write_b32 v10, v6 offset:48
    s_waitcnt vmcnt(12)
    v_smfmac_f32_16x16x64_bf16 v[16:19], v[28:31], v[64:71], v14
    v_and_b32_dpp v24, v33, v12 row_newbcast:4 row_mask:0xf bank_mask:0xf
    v_and_b32_dpp v25, v33, v13 row_newbcast:4 row_mask:0xf bank_mask:0xf
    v_smfmac_f32_16x16x64_bf16 v[20:23], v[28:31], v[72:79], v14
    v_and_b32_dpp v26, v33, v12 row_newbcast:5 row_mask:0xf bank_mask:0xf
    v_and_b32_dpp v27, v33, v13 row_newbcast:5 row_mask:0xf bank_mask:0xf
    s_cmp_eq_u32 s49, 1
    s_cbranch_scc1 L_dw1_1
    s_cmp_eq_u32 s49, 2
    s_cbranch_scc1 L_dw1_2
L_dw1_3:
    s_waitcnt vmcnt(0)
L_dw1_2:
    s_waitcnt vmcnt(4)
L_dw1_1:
    s_waitcnt vmcnt(8)
    s_bitcmp1_b32 s52, 1
    s_cbranch_scc1 L_ev1
L_dr2:
    s_add_u32 s49, s49, 1
    ds_write_b32 v10, v6 offset:48
    s_waitcnt vmcnt(12)
    v_smfmac_f32_16x16x64_bf16 v[16:19], v[24:27], v[80:87], v14
    v_and_b32_dpp v28, v33, v12 row_newbcast:6 row_mask:0xf bank_mask:0xf
    v_and_b32_dpp v29, v33, v13 row_newbcast:6 row_mask:0xf bank_mask:0xf
    v_smfmac_f32_16x16x64_bf16 v[20:23], v[24:27], v[88:95], v14
    v_and_b32_dpp v30, v33, v12 row_newbcast:7 row_mask:0xf bank_mask:0xf
    v_and_b32_dpp v31, v33, v13 row_newbcast:7 row_mask:0xf bank_mask:0xf
    s_cmp_eq_u32 s49, 1
    s_cbranch_scc1 L_dw2_1
    s_cmp_eq_u32 s49, 2
    s_cbranch_scc1 L_dw2_2
L_dw2_3:
    s_waitcnt vmcnt(0)
L_dw2_2:
    s_waitcnt vmcnt(4)
L_dw2_1:
    s_waitcnt vmcnt(8)
    s_bitcmp1_b32 s52, 2
    s_cbranch_scc1 L_ev2
L_dr3:
    s_add_u32 s49, s49, 1
    ds_write_b32 v10, v6 offset:48
    s_waitcnt vmcnt(12)
    v_smfmac_f32_16x16x64_bf16 v[16:19], v[28:31], v[96:103], v14
    v_and_b32_dpp v24, v33, v12 row_newbcast:8 row_mask:0xf bank_mask:0xf
    v_and_b32_dpp v25, v33, v13 row_newbcast:8 row_mask:0xf bank_mask:0xf
    v_smfmac_f32_16x16x64_bf16 v[20:23], v[28:31], v[104:111], v14
    v_and_b32_dpp v26, v33, v12 row_newbcast:9 row_mask:0xf bank_mask:0xf
    v_and_b32_dpp v27, v33, v13 row_newbcast:9 row_mask:0xf bank_mask:0xf
    s_cmp_eq_u32 s49, 1
    s_cbranch_scc1 L_dw3_1
    s_cmp_eq_u32 s49, 2
    s_cbranch_scc1 L_dw3_2
L_dw3_3:
    s_waitcnt vmcnt(0)
L_dw3_2:
    s_waitcnt vmcnt(4)
L_dw3_1:
    s_waitcnt vmcnt(8)
    s_bitcmp1_b32 s52, 3
    s_cbranch_scc1 L_ev3
L_dr4:
    s_add_u32 s49, s49, 1
    ds_write_b32 v10, v6 offset:48
    s_waitcnt vmcnt(12)
    v_smfmac_f32_16x16x64_bf16 v[16:19], v[24:27], v[112:119], v14
    v_and_b32_dpp v28, v33, v12 row_newbcast:10 row_mask:0xf bank_mask:0xf
    v_and_b32_dpp v29, v33, v13 row_newbcast:10 row_mask:0xf bank_mask:0xf
    v_smfmac_f32_16x16x64_bf16 v[20:23], v[24:27], v[120:127], v14
    v_and_b32_dpp v30, v33, v12 row_newbcast:11 row_mask:0xf bank_mask:0xf
    v_and_b32_dpp v31, v33, v13 row_newbcast:11 row_mask:0xf bank_mask:0xf
    s_cmp_eq_u32 s49, 1
    s_cbranch_scc1 L_dw4_1
    s_cmp_eq_u32 s49, 2
    s_cbranch_scc1 L_dw4_2
L_dw4_3:
    s_waitcnt vmcnt(0)
L_dw4_2:
    s_waitcnt vmcnt(4)
L_dw4_1:
    s_waitcnt vmcnt(8)
    s_bitcmp1_b32 s52, 4
    s_cbranch_scc1 L_ev4
L_dr5:
    s_add_u32 s49, s49, 1
    ds_write_b32 v10, v6 offset:48
    s_waitcnt vmcnt(12)
    v_smfmac_f32_16x16x64_bf16 v[16:19], v[28:31], v[128:135], v14
    v_and_b32_dpp v24, v33, v12 row_newbcast:12 row_mask:0xf bank_mask:0xf
    v_and_b32_dpp v25, v33, v13 row_newbcast:12 row_mask:0xf bank_mask:0xf
    v_smfmac_f32_16x16x64_bf16 v[20:23], v[28:31], v[136:143], v14
    v_and_b32_dpp v26, v33, v12 row_newbcast:13 row_mask:0xf bank_mask:0xf
    v_and_b32_dpp v27, v33, v13 row_newbcast:13 row_mask:0xf bank_mask:0xf
    s_cmp_eq_u32 s49, 1
    s_cbranch_scc1 L_dw5_1
    s_cmp_eq_u32 s49, 2
    s_cbranch_scc1 L_dw5_2
L_dw5_3:
    s_waitcnt vmcnt(0)
L_dw5_2:
    s_waitcnt vmcnt(4)
L_dw5_1:
    s_waitcnt vmcnt(8)
    s_bitcmp1_b32 s52, 5
    s_cbranch_scc1 L_ev5
L_dr6:
    s_add_u32 s49, s49, 1
    ds_write_b32 v10, v6 offset:48
    s_waitcnt vmcnt(12)
    v_smfmac_f32_16x16x64_bf16 v[16:19], v[24:27], v[144:151], v14
    v_and_b32_dpp v28, v33, v12 row_newbcast:14 row_mask:0xf bank_mask:0xf
    v_and_b32_dpp v29, v33, v13 row_newbcast:14 row_mask:0xf bank_mask:0xf
    v_smfmac_f32_16x16x64_bf16 v[20:23], v[24:27], v[152:159], v14
    v_and_b32_dpp v30, v33, v12 row_newbcast:15 row_mask:0xf bank_mask:0xf
    v_and_b32_dpp v31, v33, v13 row_newbcast:15 row_mask:0xf bank_mask:0xf
    s_cmp_eq_u32 s49, 1
    s_cbranch_scc1 L_dw6_1
    s_cmp_eq_u32 s49, 2
    s_cbranch_scc1 L_dw6_2
L_dw6_3:
    s_waitcnt vmcnt(0)
L_dw6_2:
    s_waitcnt vmcnt(4)
L_dw6_1:
    s_waitcnt vmcnt(8)
    s_bitcmp1_b32 s52, 6
    s_cbranch_scc1 L_ev6
L_dr7:
    s_add_u32 s49, s49, 1
    ds_write_b32 v10, v6 offset:48
    s_waitcnt vmcnt(12)
    v_smfmac_f32_16x16x64_bf16 v[16:19], v[28:31], v[160:167], v14
    v_and_b32_dpp v24, v35, v12 row_newbcast:0 row_mask:0xf bank_mask:0xf
    v_and_b32_dpp v25, v35, v13 row_newbcast:0 row_mask:0xf bank_mask:0xf
    v_smfmac_f32_16x16x64_bf16 v[20:23], v[28:31], v[168:175], v14
    v_and_b32_dpp v26, v35, v12 row_newbcast:1 row_mask:0xf bank_mask:0xf
    v_and_b32_dpp v27, v35, v13 row_newbcast:1 row_mask:0xf bank_mask:0xf
    s_cmp_eq_u32 s49, 1
    s_cbranch_scc1 L_dw7_1
    s_cmp_eq_u32 s49, 2
    s_cbranch_scc1 L_dw7_2
L_dw7_3:
    s_waitcnt vmcnt(0)
L_dw7_2:
    s_waitcnt vmcnt(4)
L_dw7_1:
    s_waitcnt vmcnt(8)
    s_bitcmp1_b32 s52, 7
    s_cbranch_scc1 L_ev7
L_dr8:
    v_mov_b64 v[32:33], v[34:35]
    v_mov_b64 v[34:35], v[36:37]
    v_mov_b64 v[36:37], v[38:39]
    s_lshr_b32 s52, s52, 8
    s_lshr_b32 s53, s53, 8
    s_lshr_b32 s56, s56, 8
    s_branch L_dr0
L_pad0:
    s_setpc_b64 s[68:69]
L_ev0:
    s_and_b32 s65, s57, 15
    v_cmp_ge_u32 s[66:67], s65, v4
    v_cmp_gt_u32 s[68:69], s65, v4
    s_bitcmp1_b32 s56, 0
    s_cselect_b64 s[62:63], s[70:71], s[62:63]
    v_cndmask_b32 v40, 0, v28, s[66:67]
    v_cndmask_b32 v41, 0, v29, s[66:67]
    v_cndmask_b32 v42, 0, v30, s[68:69]
    v_cndmask_b32 v43, 0, v31, s[68:69]
    s_mul_i32 s64, s63, 0
    s_bitcmp1_b32 s53, 0
    s_cbranch_scc0 L_evret
    s_waitcnt vmcnt(12)
    v_smfmac_f32_16x16x64_bf16 v[16:19], v[40:43], v[64:71], v14
    v_xor_b32 v28, v28, v40
    v_xor_b32 v29, v29, v41
    v_smfmac_f32_16x16x64_bf16 v[20:23], v[40:43], v[72:79], v14
    v_xor_b32 v30, v30, v42
    v_xor_b32 v31, v31, v43
    s_branch L_flush
L_pad1:
    s_setpc_b64 s[68:69]
L_ev1:
    s_and_b32 s65, s57, 15
    v_cmp_ge_u32 s[66:67], s65, v4
    v_cmp_gt_u32 s[68:69], s65, v4
    s_bitcmp1_b32 s56, 1
    s_cselect_b64 s[62:63], s[70:71], s[62:63]
    v_cndmask_b32 v40, 0, v24, s[66:67]
    v_cndmask_b32 v41, 0, v25, s[66:67]
    v_cndmask_b32 v42, 0, v26, s[68:69]
    v_cndmask_b32 v43, 0, v27, s[68:69]
    s_mul_i32 s64, s63, 1
    s_bitcmp1_b32 s53, 1
    s_cbranch_scc0 L_evret
    s_waitcnt vmcnt(12)
    v_smfmac_f32_16x16x64_bf16 v[16:19], v[40:43], v[80:87], v14
    v_xor_b32 v24, v24, v40
    v_xor_b32 v25, v25, v41
    v_smfmac_f32_16x16x64_bf16 v[20:23], v[40:43], v[88:95], v14
    v_xor_b32 v26, v26, v42
    v_xor_b32 v27, v27, v43
    s_branch L_flush
L_pad2:
    s_setpc_b64 s[68:69]
L_ev2:
    s_and_b32 s65, s57, 15
    v_cmp_ge_u32 s[66:67], s65, v4
    v_cmp_gt_u32 s[68:69], s65, v4
    s_bitcmp1_b32 s56, 2
    s_cselect_b64 s[62:63], s[70:71], s[62:63]
    v_cndmask_b32 v40, 0, v28, s[66:67]
    v_cndmask_b32 v41, 0, v29, s[66:67]
    v_cndmask_b32 v42, 0, v30, s[68:69]
    v_cndmask_b32 v43, 0, v31, s[68:69]
    s_mul_i32 s64, s63, 2
    s_bitcmp1_b32 s53, 2
    s_cbranch_scc0 L_evret
    s_waitcnt vmcnt(12)
    v_smfmac_f32_16x16x64_bf16 v[16:19], v[40:43], v[96:103], v14
    v_xor_b32 v28, v28, v40
    v_xor_b32 v29, v29, v41
    v_smfmac_f32_16x16x64_bf16 v[20:23], v[40:43], v[104:111], v14
    v_xor_b32 v30, v30, v42
    v_xor_b32 v31, v31, v43
    s_branch L_flush
L_pad3:
    s_setpc_b64 s[68:69]
L_ev3:
    s_and_b32 s65, s57, 15
    v_cmp_ge_u32 s[66:67], s65, v4
    v_cmp_gt_u32 s[68:69], s65, v4
    s_bitcmp1_b32 s56, 3
    s_cselect_b64 s[62:63], s[70:71], s[62:63]
    v_cndmask_b32 v40, 0, v24, s[66:67]
    v_cndmask_b32 v41, 0, v25, s[66:67]
    v_cndmask_b32 v42, 0, v26, s[68:69]
    v_cndmask_b32 v43, 0, v27, s[68:69]
    s_mul_i32 s64, s63, 3
    s_bitcmp1_b32 s53, 3
    s_cbranch_scc0 L_evret
    s_waitcnt vmcnt(12)
    v_smfmac_f32_16x16x64_bf16 v[16:19], v[40:43], v[112:119], v14
    v_xor_b32 v24, v24, v40
    v_xor_b32 v25, v25, v41
    v_smfmac_f32_16x16x64_bf16 v[20:23], v[40:43], v[120:127], v14
    v_xor_b32 v26, v26, v42
    v_xor_b32 v27, v27, v43
    s_branch L_flush
L_pad4:
    s_setpc_b64 s[68:69]
L_ev4:
    s_and_b32 s65, s57, 15
    v_cmp_ge_u32 s[66:67], s65, v4
    v_cmp_gt_u32 s[68:69], s65, v4
    s_bitcmp1_b32 s56, 4
    s_cselect_b64 s[62:63], s[70:71], s[62:63]
    v_cndmask_b32 v40, 0, v28, s[66:67]
    v_cndmask_b32 v41, 0, v29, s[66:67]
    v_cndmask_b32 v42, 0, v30, s[68:69]
    v_cndmask_b32 v43, 0, v31, s[68:69]
    s_mul_i32 s64, s63, 4
    s_bitcmp1_b32 s53, 4
    s_cbranch_scc0 L_evret
    s_waitcnt vmcnt(12)
    v_smfmac_f32_16x16x64_bf16 v[16:19], v[40:43], v[128:135], v14
    v_xor_b32 v28, v28, v40
    v_xor_b32 v29, v29, v41
    v_smfmac_f32_16x16x64_bf16 v[20:23], v[40:43], v[136:143], v14
    v_xor_b32 v30, v30, v42
    v_xor_b32 v31, v31, v43
    s_branch L_flush
L_pad5:
    s_setpc_b64 s[68:69]
L_ev5:
    s_and_b32 s65, s57, 15
    v_cmp_ge_u32 s[66:67], s65, v4
    v_cmp_gt_u32 s[68:69], s65, v4
    s_bitcmp1_b32 s56, 5
    s_cselect_b64 s[62:63], s[70:71], s[62:63]
    v_cndmask_b32 v40, 0, v24, s[66:67]
    v_cndmask_b32 v41, 0, v25, s[66:67]
    v_cndmask_b32 v42, 0, v26, s[68:69]
    v_cndmask_b32 v43, 0, v27, s[68:69]
    s_mul_i32 s64, s63, 5
    s_bitcmp1_b32 s53, 5
    s_cbranch_scc0 L_evret
    s_waitcnt vmcnt(12)
    v_smfmac_f32_16x16x64_bf16 v[16:19], v[40:43], v[144:151], v14
    v_xor_b32 v24, v24, v40
    v_xor_b32 v25, v25, v41
    v_smfmac_f32_16x16x64_bf16 v[20:23], v[40:43], v[152:159], v14
    v_xor_b32 v26, v26, v42
    v_xor_b32 v27, v27, v43
    s_branch L_flush
L_pad6:
    s_setpc_b64 s[68:69]
L_ev6:
    s_and_b32 s65, s57, 15
    v_cmp_ge_u32 s[66:67], s65, v4
    v_cmp_gt_u32 s[68:69], s65, v4
    s_bitcmp1_b32 s56, 6
    s_cselect_b64 s[62:63], s[70:71], s[62:63]
    v_cndmask_b32 v40, 0, v28, s[66:67]
    v_cndmask_b32 v41, 0, v29, s[66:67]
    v_cndmask_b32 v42, 0, v30, s[68:69]
    v_cndmask_b32 v43, 0, v31, s[68:69]
    s_mul_i32 s64, s63, 6
    s_bitcmp1_b32 s53, 6
    s_cbranch_scc0 L_evret
    s_waitcnt vmcnt(12)
    v_smfmac_f32_16x16x64_bf16 v[16:19], v[40:43], v[160:167], v14
    v_xor_b32 v28, v28, v40
    v_xor_b32 v29, v29, v41
    v_smfmac_f32_16x16x64_bf16 v[20:23], v[40:43], v[168:175], v14
    v_xor_b32 v30, v30, v42
    v_xor_b32 v31, v31, v43
    s_branch L_flush
L_pad7:
    s_setpc_b64 s[68:69]
L_ev7:
    s_and_b32 s65, s57, 15
    v_cmp_ge_u32 s[66:67], s65, v4
    v_cmp_gt_u32 s[68:69], s65, v4
    s_bitcmp1_b32 s56, 7
    s_cselect_b64 s[62:63], s[70:71], s[62:63]
    v_cndmask_b32 v40, 0, v24, s[66:67]
    v_cndmask_b32 v41, 0, v25, s[66:67]
    v_cndmask_b32 v42, 0, v26, s[68:69]
    v_cndmask_b32 v43, 0, v27, s[68:69]
    s_mul_i32 s64, s63, 7
    s_bitcmp1_b32 s53, 7
    s_cbranch_scc0 L_evret
    s_waitcnt vmcnt(12)
    v_smfmac_f32_16x16x64_bf16 v[16:19], v[40:43], v[48:55], v14
    v_xor_b32 v24, v24, v40
    v_xor_b32 v25, v25, v41
    v_smfmac_f32_16x16x64_bf16 v[20:23], v[40:43], v[56:63], v14
    v_xor_b32 v26, v26, v42
    v_xor_b32 v27, v27, v43
    s_nop 0
L_flush:
    s_lshr_b32 s57, s57, 4
    s_cmp_eq_u32 s26, 4
    v_add_u32 v1, 1, v1
    v_mul_f32 v40, v177, v16
    v_mul_f32 v41, v177, v17
    v_mul_f32 v42, v177, v18
    v_mul_f32 v43, v177, v19
    v_cvt_pk_bf16_f32 v40, v40, v41
    v_cvt_pk_bf16_f32 v41, v42, v43
    ds_write_b64 v176, v[40:41] offset:41984
    v_mul_f32 v44, v177, v20
    v_mul_f32 v45, v177, v21
    v_mul_f32 v46, v177, v22
    v_mul_f32 v47, v177, v23
    v_cvt_pk_bf16_f32 v44, v44, v45
    v_cvt_pk_bf16_f32 v45, v46, v47
    ds_write_b64 v176, v[44:45] offset:42240
    ds_write_b32 v10, v1 offset:32
    s_cbranch_scc1 L_sdone
    v_mov_b64 v[16:17], 0
    v_mov_b64 v[18:19], 0
    v_mov_b64 v[20:21], 0
    v_mov_b64 v[22:23], 0
    s_add_u32 s26, s26, 1
    v_mov_b64 v[176:177], v[178:179]
    v_mov_b64 v[178:179], v[180:181]
    v_mov_b64 v[180:181], v[182:183]
    v_mov_b64 v[182:183], v[184:185]
L_evret:
    s_add_u32 s64, s64, s62
    s_add_u32 s54, s72, s64
    s_addc_u32 s55, s73, 0
    s_setpc_b64 s[54:55]
L_pad9:
    s_setpc_b64 s[68:69]
L_slow:
    s_mov_b32 s62, L_slow_pair-L_anc
    v_mbcnt_lo_u32_b32 v200, -1, 0
    v_mbcnt_hi_u32_b32 v200, -1, v200
L_slow_pair:
    v_lshlrev_b32 v201, 2, v200
    s_mul_i32 s70, s1, 40
    s_lshl1_add_u32 s70, s24, s70
    s_mov_b32 s71, 0
    s_mov_b32 s24, s20
    s_mov_b32 s20, s21
    s_mov_b32 s21, s22
    s_mov_b32 s22, s23
L_slow_chunk:
    global_load_dword v202, v201, s[8:9]
    global_load_dword v203, v201, s[6:7]
    v_add_u32 v201, 0x100, v201
    s_waitcnt vmcnt(0)
    v_subrev_u32 v202, s70, v202
    v_cmp_gt_u32 vcc, 2, v202
    v_lshlrev_b32 v204, 1, v203
    ds_read_u16 v204, v204 offset:62464
    s_mov_b64 s[76:77], vcc
    v_lshlrev_b32 v202, 4, v202
    v_lshlrev_b32 v203, 9, v203
    s_waitcnt lgkmcnt(0)
    v_lshlrev_b32 v204, v202, v204
L_slow_edge:
    s_cmp_eq_u64 s[76:77], 0
    s_cbranch_scc1 L_slow_next
    s_ff1_i32_b64 s74, s[76:77]
    s_bitset0_b64 s[76:77], s74
    v_readlane_b32 s64, v203, s74
    v_readlane_b32 s65, v204, s74
    v_mov_b32 v205, 0
    v_mov_b32 v11, 2147483648
    s_mov_b64 exec, 0xffff
    v_mov_b32 v205, s65
    v_add_u32 v11, s64, v7
    s_mov_b64 exec, -1
    buffer_load_dwordx4 v[208:211], v11, s[32:35], 0 offen
    buffer_load_dwordx4 v[212:215], v11, s[32:35], 0 offen offset:256
    v_and_b32 v24, v205, v12
    v_and_b32 v25, v205, v13
    s_nop 0
    s_waitcnt vmcnt(0)
    v_smfmac_f32_16x16x32_bf16 v[16:19], v[24:25], v[208:211], v14
    v_smfmac_f32_16x16x32_bf16 v[20:23], v[24:25], v[212:215], v14
    s_branch L_slow_edge
L_slow_next:
    s_add_u32 s71, s71, 1
    s_cmp_lt_u32 s71, 2500
    s_cbranch_scc1 L_slow_chunk
    s_mov_b32 s64, 0
    s_nop 3
    s_branch L_flush
L_sdone:
    ds_write_b32 v10, v6 offset:48
    s_waitcnt lgkmcnt(0)
    s_barrier
    s_endpgm
L_retry_12:
    s_sub_u32 s100, s100, 1
    s_cbranch_scc1 L_end
    s_sleep 1
    s_branch L_spin_11
L_retry_13:
    s_sub_u32 s100, s100, 1
    s_cbranch_scc1 L_end
    s_sleep 4
    s_branch L_ipoll_10
L_retry_19:
    s_sub_u32 s100, s100, 1
    s_cbranch_scc1 L_end
    s_sleep 2
    s_branch L_secload_18
L_secload_18:
    buffer_load_dwordx4 v[56:59], v8, s[40:43], s12 offen sc1
    s_waitcnt vmcnt(0)
    s_branch L_sec_16
L_retry_23:
    s_sub_u32 s100, s100, 1
    s_cbranch_scc1 L_end
    s_sleep 2
    s_branch L_secload_22
L_secload_22:
    buffer_load_dwordx4 v[60:63], v8, s[40:43], s13 offen sc1
    s_waitcnt vmcnt(0)
    s_branch L_sec_20
L_retry_25:
    s_sub_u32 s100, s100, 1
    s_cbranch_scc1 L_end
    s_sleep 1
    s_branch L_spin_24
L_mwork_4:
    v_xor_b32 v44, v4, v3
    v_lshlrev_b32 v44, 4, v44
    v_lshl_add_u32 v44, v3, 9, v44
    v_xor_b32 v45, 64, v44
    v_xor_b32 v46, 0x80, v44
    v_xor_b32 v47, 0xc0, v44
    s_cmp_lg_u32 s31, 0
    s_waitcnt vmcnt(1)
    s_barrier
    s_cbranch_scc1 L_worked_5_w
    ds_read_b128 v[48:51], v44 offset:62464
    ds_read_b128 v[52:55], v44 offset:21504
    ds_read_b128 v[56:59], v44 offset:29696
    ds_read_b128 v[60:63], v45 offset:62464
    ds_read_b128 v[64:67], v45 offset:21504
    ds_read_b128 v[68:71], v45 offset:29696
    ds_read_b128 v[72:75], v46 offset:62464
    ds_read_b128 v[76:79], v46 offset:21504
    ds_read_b128 v[80:83], v46 offset:29696
    ds_read_b128 v[84:87], v47 offset:62464
    ds_read_b128 v[88:91], v47 offset:21504
    ds_read_b128 v[92:95], v47 offset:29696
    s_waitcnt lgkmcnt(9)
    v_mfma_f32_16x16x32_bf16 v[16:19], v[52:55], v[48:51], 0
    v_mfma_f32_16x16x32_bf16 v[20:23], v[56:59], v[48:51], 0
    ds_read_b128 v[96:99], v44 offset:62720
    ds_read_b128 v[100:103], v44 offset:21760
    ds_read_b128 v[104:107], v44 offset:29952
    s_waitcnt lgkmcnt(9)
    v_mfma_f32_16x16x32_bf16 v[16:19], v[64:67], v[60:63], v[16:19]
    v_mfma_f32_16x16x32_bf16 v[20:23], v[68:71], v[60:63], v[20:23]
    ds_read_b128 v[108:111], v45 offset:62720
    ds_read_b128 v[112:115], v45 offset:21760
    ds_read_b128 v[116:119], v45 offset:29952
    s_waitcnt lgkmcnt(9)
    v_mfma_f32_16x16x32_bf16 v[16:19], v[76:79], v[72:75], v[16:19]
    v_mfma_f32_16x16x32_bf16 v[20:23], v[80:83], v[72:75], v[20:23]
    ds_read_b128 v[120:123], v46 offset:62720
    ds_read_b128 v[124:127], v46 offset:21760
    ds_read_b128 v[128:131], v46 offset:29952
    s_waitcnt lgkmcnt(9)
    v_mfma_f32_16x16x32_bf16 v[16:19], v[88:91], v[84:87], v[16:19]
    v_mfma_f32_16x16x32_bf16 v[20:23], v[92:95], v[84:87], v[20:23]
    ds_read_b128 v[132:135], v47 offset:62720
    ds_read_b128 v[136:139], v47 offset:21760
    ds_read_b128 v[140:143], v47 offset:29952
    s_waitcnt lgkmcnt(9)
    v_mfma_f32_16x16x32_bf16 v[16:19], v[100:103], v[96:99], v[16:19]
    v_mfma_f32_16x16x32_bf16 v[20:23], v[104:107], v[96:99], v[20:23]
    s_waitcnt lgkmcnt(6)
    v_mfma_f32_16x16x32_bf16 v[16:19], v[112:115], v[108:111], v[16:19]
    v_mfma_f32_16x16x32_bf16 v[20:23], v[116:119], v[108:111], v[20:23]
    s_waitcnt lgkmcnt(3)
    v_mfma_f32_16x16x32_bf16 v[16:19], v[124:127], v[120:123], v[16:19]
    v_mfma_f32_16x16x32_bf16 v[20:23], v[128:131], v[120:123], v[20:23]
    s_waitcnt lgkmcnt(0)
    v_mfma_f32_16x16x32_bf16 v[16:19], v[136:139], v[132:135], v[16:19]
    v_mfma_f32_16x16x32_bf16 v[20:23], v[140:143], v[132:135], v[20:23]
    s_lshl_b32 s64, s27, 10
    s_add_u32 s64, s64, 65536
    v_lshl_add_u32 v40, v2, 4, s64
    s_lshl_b32 s64, s27, 2
    s_add_u32 s64, s64, 4096
    v_lshl_add_u32 v41, v2, 9, s64
    v_mov_b32 v42, s30
    s_nop 1
    v_cvt_pk_bf16_f32 v44, v16, v17
    v_cvt_pk_bf16_f32 v45, v18, v19
    v_cvt_pk_bf16_f32 v46, v20, v21
    v_cvt_pk_bf16_f32 v47, v22, v23
    global_store_dwordx4 v40, v[44:47], s[28:29] sc1
    s_barrier
    s_waitcnt vmcnt(0)
    s_mov_b64 exec, 0xff
    global_store_dword v41, v42, s[28:29] sc1
    s_mov_b64 exec, -1
    s_branch L_worked_5
L_worked_5_w:
    s_barrier
    s_waitcnt vmcnt(0)
    s_branch L_worked_5
L_gemm:
    v_lshlrev_b32 v8, 4, v0
    v_lshlrev_b32 v10, 2, v0
    v_mov_b32 v32, 1966080
    v_mov_b32 v33, 1966080
    v_mov_b64 v[34:35], v[32:33]
    v_subrev_u32 v9, 32, v0
    v_cmp_gt_u32 vcc, 20, v9
    ds_write_b128 v8, v[32:35] offset:41984
    ds_write_b128 v8, v[32:35] offset:46080
    ds_write_b128 v8, v[32:35] offset:50176
    ds_write_b128 v8, v[32:35] offset:54272
    v_mul_u32_u24 v9, 264, v9
    v_add_u32 v9, 148480, v9
    v_cndmask_b32 v9, 0, v9, vcc
    ds_write_b32 v10, v9
    v_mov_b32 v16, 1310740000
    v_mov_b32 v17, 1310740000
    v_mov_b64 v[18:19], v[16:17]
    v_add_u32 v9, 148480, v8
    ds_write_b128 v9, v[16:19]
    ds_write_b128 v9, v[16:19] offset:4096
    v_and_b32 v3, 15, v2
    v_lshrrev_b32 v4, 4, v2
    v_mov_b32 v5, 0
    v_mov_b32 v6, 1
    s_mov_b32 s100, 67108864
    s_bfe_u32 s65, s2, 0x10003
    s_lshl1_add_u32 s64, s67, s65
    s_and_b32 s65, s2, 0xf0
    s_or_b32 s64, s64, s65
    s_cmp_lt_u32 s2, 240
    s_cselect_b32 s1, s64, s2
    v_lshrrev_b32 v28, 5, v0
    v_and_b32 v1, 31, v2
    v_xor_b32 v1, v1, v28
    v_lshlrev_b32 v1, 4, v1
    v_lshl_add_u32 v30, v28, 9, v1
    v_xor_b32 v31, 0x80, v30
    s_mul_i32 s63, s1, 20480
    s_lshl_b32 s66, s31, 10
    s_waitcnt lgkmcnt(0)
    s_mov_b32 s32, s4
    s_and_b32 s33, s5, 0xffff
    s_mov_b32 s34, 5120000
    s_mov_b32 s35, 0x20000
    s_add_u32 m0, s66, 1024
    s_nop 0
    buffer_load_dwordx4 v30, s[32:35], s63 offen lds
    s_add_u32 m0, s66, 5120
    s_add_u32 s63, s63, 4096
    buffer_load_dwordx4 v31, s[32:35], s63 offen lds
    s_waitcnt lgkmcnt(0)
    s_cmp_ge_u32 s2, 250
    s_cbranch_scc1 L_end
    s_barrier
    s_setprio 2
    s_min_u32 s64, s1, 249
    s_mul_i32 s64, s64, 20480
    s_cmp_eq_u32 s31, 0
    s_cselect_b64 s[68:69], s[24:25], s[16:17]
    s_cselect_b32 s64, s64, 0
    s_cmp_eq_u32 s31, 2
    s_cselect_b64 s[68:69], s[28:29], s[68:69]
    s_cselect_b32 s64, 0x800, s64
    s_cselect_b32 s76, 0x2f8000, 0
    s_cmp_eq_u32 s31, 3
    s_cselect_b64 s[68:69], s[4:5], s[68:69]
    s_cselect_b32 s76, 0x200000, s76
    s_cselect_b32 s77, 2, 1
    v_min_u32 v27, s77, v2
    v_mul_lo_u32 v27, v27, s76
    v_add_u32 v27, s64, v27
    global_load_dword v24, v27, s[68:69]
    v_lshrrev_b32 v13, 3, v2
    v_lshrrev_b32 v15, 2, v2
    v_and_b32 v15, 4, v15
    v_and_b32 v14, 7, v2
    v_xor_b32 v15, v15, v14
    v_lshlrev_b32 v15, 4, v15
    v_lshl_add_u32 v13, v13, 9, v15
    s_bfe_u32 s67, s2, 0x30003
    s_lshl_b32 s64, s31, 7
    s_lshl_b32 s65, s67, 14
    s_or_b32 s64, s64, s65
    v_add_u32 v13, s64, v13
    s_lshl_b32 s70, s31, 14
    s_add_u32 s70, s70, 82944
    s_mov_b32 s71, 3072
    s_mov_b32 s72, 6144
    s_mov_b32 s73, 9216
    s_mov_b32 s36, s22
    s_and_b32 s37, s23, 0xffff
    s_mov_b32 s38, 131072
    s_mov_b32 s39, 0x20000
    s_and_b32 s64, s2, 8
    s_or_b32 s64, s64, s31
    s_cbranch_scc1 L_touched_26
    s_lshr_b32 s64, s2, 4
    s_and_b32 s68, s2, 7
    s_lshl3_add_u32 s64, s64, s68
    s_lshl_b32 s64, s64, 10
    v_lshl_add_u32 v26, v2, 4, s64
    global_load_dwordx4 v[20:23], v26, s[16:17]
L_touched_26:
    s_add_u32 m0, s70, 0
    s_nop 0
    buffer_load_dwordx4 v13, s[36:39], 0 offen offset:0 lds
    buffer_load_dwordx4 v13, s[36:39], s71 offen offset:1024 lds
    buffer_load_dwordx4 v13, s[36:39], s72 offen offset:2048 lds
    buffer_load_dwordx4 v13, s[36:39], s73 offen offset:3072 lds
    v_xor_b32 v13, 16384, v13
    s_mov_b32 s40, s16
    s_and_b32 s41, s17, 0xffff
    s_mov_b32 s42, 131072
    s_mov_b32 s43, 0x20000
    s_mov_b32 s44, s28
    s_and_b32 s45, s29, 0xffff
    s_mov_b32 s46, 1048576
    s_mov_b32 s47, 0x20000
    s_mov_b32 s48, s24
    s_and_b32 s49, s25, 0xffff
    s_mov_b32 s50, 5120000
    s_mov_b32 s51, 0x20000
    v_xor_b32 v15, v4, v3
    v_lshlrev_b32 v15, 4, v15
    v_lshl_add_u32 v7, v3, 9, v15
    s_lshl_b32 s64, s67, 6
    v_xor_b32 v7, s64, v7
    v_xor_b32 v8, 64, v7
    v_xor_b32 v9, 0x80, v7
    v_xor_b32 v10, 0xc0, v7
    v_lshrrev_b32 v15, 2, v3
    v_lshl_add_u32 v15, v4, 3, v15
    v_lshlrev_b32 v15, 7, v15
    v_lshrrev_b32 v14, 1, v3
    v_and_b32 v14, 4, v14
    v_and_b32 v0, 3, v3
    v_xor_b32 v14, v14, v0
    v_lshl_add_u32 v15, v14, 4, v15
    v_add_u32 v11, s70, v15
    v_xor_b32 v12, 64, v11
    v_and_b32 v0, 31, v2
    v_lshlrev_b32 v0, 2, v0
    s_and_b32 s64, s2, 7
    s_lshl_b32 s64, s64, 9
    s_lshl_b32 s65, s31, 7
    s_add_u32 s64, s64, s65
    s_add_u32 s74, s64, 4096
    v_lshlrev_b32 v14, 4, v2
    s_lshl_b32 s75, s31, 15
    s_lshl_b32 s64, s67, 12
    s_or_b32 s75, s75, s64
    s_add_u32 s75, s75, 65536
    s_add_u32 m0, s66, 9216
    s_add_u32 s63, s63, 4096
    buffer_load_dwordx4 v30, s[32:35], s63 offen lds
    s_add_u32 m0, s66, 13312
    s_add_u32 s63, s63, 4096
    buffer_load_dwordx4 v31, s[32:35], s63 offen lds
    s_add_u32 m0, s66, 17408
    s_add_u32 s63, s63, 4096
    buffer_load_dwordx4 v30, s[32:35], s63 offen lds
    s_barrier
    s_cmp_eq_u32 s31, 0
    s_cbranch_scc0 L_nw_28
    s_call_b64 s[68:69], L_pad0
    s_call_b64 s[68:69], L_pad1
    s_call_b64 s[68:69], L_pad8
    s_branch L_warmed_27
L_nw_28:
    s_cmp_eq_u32 s31, 1
    s_cbranch_scc0 L_nw_29
    s_call_b64 s[68:69], L_pad2
    s_call_b64 s[68:69], L_pad3
    s_call_b64 s[68:69], L_pad9
    s_branch L_warmed_27
L_nw_29:
    s_cmp_eq_u32 s31, 2
    s_cbranch_scc0 L_nw_30
    s_call_b64 s[68:69], L_pad4
    s_call_b64 s[68:69], L_pad5
    s_branch L_warmed_27
L_nw_30:
    s_call_b64 s[68:69], L_pad6
    s_call_b64 s[68:69], L_pad7
L_warmed_27:
    s_add_u32 m0, s70, 4096
    s_waitcnt vmcnt(9)
    buffer_load_dwordx4 v13, s[36:39], 0 offen offset:0 lds
    s_waitcnt vmcnt(9)
    buffer_load_dwordx4 v13, s[36:39], s71 offen offset:1024 lds
    s_waitcnt vmcnt(9)
    buffer_load_dwordx4 v13, s[36:39], s72 offen offset:2048 lds
    s_waitcnt vmcnt(9)
    buffer_load_dwordx4 v13, s[36:39], s73 offen offset:3072 lds
    v_xor_b32 v13, 49152, v13
    s_bitcmp1_b32 s2, 3
    s_cbranch_scc1 L_nobar_32
    s_barrier
L_nobar_32:
    s_add_u32 m0, s70, 8192
    s_waitcnt vmcnt(9)
    buffer_load_dwordx4 v13, s[36:39], 0 offen offset:0 lds
    s_waitcnt vmcnt(9)
    buffer_load_dwordx4 v13, s[36:39], s71 offen offset:1024 lds
    s_waitcnt vmcnt(9)
    buffer_load_dwordx4 v13, s[36:39], s72 offen offset:2048 lds
    s_waitcnt vmcnt(9)
    buffer_load_dwordx4 v13, s[36:39], s73 offen offset:3072 lds
    v_xor_b32 v13, 16384, v13
    s_add_u32 m0, s70, 12288
    s_waitcnt vmcnt(6)
    buffer_load_dwordx4 v13, s[36:39], 0 offen offset:0 lds
    s_waitcnt vmcnt(6)
    buffer_load_dwordx4 v13, s[36:39], s71 offen offset:1024 lds
    s_waitcnt vmcnt(6)
    buffer_load_dwordx4 v13, s[36:39], s72 offen offset:2048 lds
    s_waitcnt vmcnt(6)
    buffer_load_dwordx4 v13, s[36:39], s73 offen offset:3072 lds
    v_xor_b32 v13, 114688, v13
    s_waitcnt vmcnt(12)
    ds_read_b64_tr_b16 v[128:129], v11 offset:0
    ds_read_b64_tr_b16 v[130:131], v11 offset:512
    ds_read_b64_tr_b16 v[132:133], v11 offset:8
    ds_read_b64_tr_b16 v[134:135], v11 offset:520
    ds_read_b64_tr_b16 v[136:137], v12 offset:0
    ds_read_b64_tr_b16 v[138:139], v12 offset:512
    ds_read_b64_tr_b16 v[140:141], v12 offset:8
    ds_read_b64_tr_b16 v[142:143], v12 offset:520
    s_waitcnt lgkmcnt(0)
    s_add_u32 m0, s70, 0
    s_waitcnt vmcnt(6)
    buffer_load_dwordx4 v13, s[36:39], 0 offen offset:0 lds
    s_waitcnt vmcnt(6)
    buffer_load_dwordx4 v13, s[36:39], s71 offen offset:1024 lds
    s_waitcnt vmcnt(6)
    buffer_load_dwordx4 v13, s[36:39], s72 offen offset:2048 lds
    s_waitcnt vmcnt(6)
    buffer_load_dwordx4 v13, s[36:39], s73 offen offset:3072 lds
    v_xor_b32 v13, 16384, v13
    s_waitcnt vmcnt(12)
    s_waitcnt lgkmcnt(0)
    s_mov_b64 exec, 1
    ds_add_u32 v5, v6 offset:4
    s_mov_b64 exec, -1
    ds_read_b64_tr_b16 v[144:145], v11 offset:4096
    ds_read_b64_tr_b16 v[146:147], v11 offset:4608
    ds_read_b64_tr_b16 v[148:149], v11 offset:4104
    ds_read_b64_tr_b16 v[150:151], v11 offset:4616
    ds_read_b64_tr_b16 v[152:153], v12 offset:4096
    ds_read_b64_tr_b16 v[154:155], v12 offset:4608
    ds_read_b64_tr_b16 v[156:157], v12 offset:4104
    ds_read_b64_tr_b16 v[158:159], v12 offset:4616
    s_waitcnt lgkmcnt(0)
    s_add_u32 m0, s70, 4096
    s_waitcnt vmcnt(6)
    buffer_load_dwordx4 v13, s[36:39], 0 offen offset:0 lds
    s_waitcnt vmcnt(6)
    buffer_load_dwordx4 v13, s[36:39], s71 offen offset:1024 lds
    s_waitcnt vmcnt(6)
    buffer_load_dwordx4 v13, s[36:39], s72 offen offset:2048 lds
    s_waitcnt vmcnt(6)
    buffer_load_dwordx4 v13, s[36:39], s73 offen offset:3072 lds
    v_xor_b32 v13, 49152, v13
    s_waitcnt vmcnt(12)
    ds_read_b64_tr_b16 v[160:161], v11 offset:8192
    ds_read_b64_tr_b16 v[162:163], v11 offset:8704
    ds_read_b64_tr_b16 v[164:165], v11 offset:8200
    ds_read_b64_tr_b16 v[166:167], v11 offset:8712
    ds_read_b64_tr_b16 v[168:169], v12 offset:8192
    ds_read_b64_tr_b16 v[170:171], v12 offset:8704
    ds_read_b64_tr_b16 v[172:173], v12 offset:8200
    ds_read_b64_tr_b16 v[174:175], v12 offset:8712
    s_waitcnt lgkmcnt(0)
    s_add_u32 m0, s70, 8192
    s_waitcnt vmcnt(6)
    buffer_load_dwordx4 v13, s[36:39], 0 offen offset:0 lds
    s_waitcnt vmcnt(6)
    buffer_load_dwordx4 v13, s[36:39], s71 offen offset:1024 lds
    s_waitcnt vmcnt(6)
    buffer_load_dwordx4 v13, s[36:39], s72 offen offset:2048 lds
    s_waitcnt vmcnt(6)
    buffer_load_dwordx4 v13, s[36:39], s73 offen offset:3072 lds
    v_xor_b32 v13, 16384, v13
    buffer_load_dword v1, v0, s[44:47], s74 offen sc1
    s_waitcnt vmcnt(13)
    ds_read_b64_tr_b16 v[176:177], v11 offset:12288
    ds_read_b64_tr_b16 v[178:179], v11 offset:12800
    ds_read_b64_tr_b16 v[180:181], v11 offset:12296
    ds_read_b64_tr_b16 v[182:183], v11 offset:12808
    ds_read_b64_tr_b16 v[184:185], v12 offset:12288
    ds_read_b64_tr_b16 v[186:187], v12 offset:12800
    ds_read_b64_tr_b16 v[188:189], v12 offset:12296
    ds_read_b64_tr_b16 v[190:191], v12 offset:12808
    s_waitcnt lgkmcnt(0)
    s_add_u32 m0, s70, 12288
    s_nop 0
    buffer_load_dwordx4 v13, s[36:39], 0 offen offset:0 lds
    buffer_load_dwordx4 v13, s[36:39], s71 offen offset:1024 lds
    buffer_load_dwordx4 v13, s[36:39], s72 offen offset:2048 lds
    buffer_load_dwordx4 v13, s[36:39], s73 offen offset:3072 lds
    v_xor_b32 v13, 114688, v13
    s_waitcnt vmcnt(13)
    ds_read_b64_tr_b16 v[192:193], v11 offset:0
    ds_read_b64_tr_b16 v[194:195], v11 offset:512
    ds_read_b64_tr_b16 v[196:197], v11 offset:8
    ds_read_b64_tr_b16 v[198:199], v11 offset:520
    ds_read_b64_tr_b16 v[200:201], v12 offset:0
    ds_read_b64_tr_b16 v[202:203], v12 offset:512
    ds_read_b64_tr_b16 v[204:205], v12 offset:8
    ds_read_b64_tr_b16 v[206:207], v12 offset:520
    s_waitcnt vmcnt(9)
    ds_read_b64_tr_b16 v[208:209], v11 offset:4096
    ds_read_b64_tr_b16 v[210:211], v11 offset:4608
    ds_read_b64_tr_b16 v[212:213], v11 offset:4104
    ds_read_b64_tr_b16 v[214:215], v11 offset:4616
    ds_read_b64_tr_b16 v[216:217], v12 offset:4096
    ds_read_b64_tr_b16 v[218:219], v12 offset:4608
    ds_read_b64_tr_b16 v[220:221], v12 offset:4104
    ds_read_b64_tr_b16 v[222:223], v12 offset:4616
    s_waitcnt vmcnt(5)
    ds_read_b64_tr_b16 v[224:225], v11 offset:8192
    ds_read_b64_tr_b16 v[226:227], v11 offset:8704
    ds_read_b64_tr_b16 v[228:229], v11 offset:8200
    ds_read_b64_tr_b16 v[230:231], v11 offset:8712
    ds_read_b64_tr_b16 v[232:233], v12 offset:8192
    ds_read_b64_tr_b16 v[234:235], v12 offset:8704
    ds_read_b64_tr_b16 v[236:237], v12 offset:8200
    ds_read_b64_tr_b16 v[238:239], v12 offset:8712
    s_waitcnt vmcnt(4)
L_spin_34:
    ds_read_b128 v[16:19], v5
    s_waitcnt lgkmcnt(0)
    v_readfirstlane_b32 s101, v18
    v_readfirstlane_b32 s30, v19
    s_cmp_ge_u32 s101, 1
    s_cbranch_scc0 L_retry_35
L_mchk_33:
    v_cmp_ne_u32 vcc, s30, v1
    s_cbranch_vccnz L_mre_36
    buffer_load_dwordx4 v[40:43], v14, s[44:47], s75 offen offset:0 sc1
    buffer_load_dwordx4 v[44:47], v14, s[44:47], s75 offen offset:1024 sc1
    buffer_load_dwordx4 v[48:51], v14, s[44:47], s75 offen offset:2048 sc1
    buffer_load_dwordx4 v[52:55], v14, s[44:47], s75 offen offset:3072 sc1
    s_xor_b32 s75, s75, 4096
    buffer_load_dwordx4 v[56:59], v14, s[44:47], s75 offen offset:0 sc1
    buffer_load_dwordx4 v[60:63], v14, s[44:47], s75 offen offset:1024 sc1
    buffer_load_dwordx4 v[64:67], v14, s[44:47], s75 offen offset:2048 sc1
    buffer_load_dwordx4 v[68:71], v14, s[44:47], s75 offen offset:3072 sc1
    s_xor_b32 s75, s75, 12288
    buffer_load_dwordx4 v[72:75], v14, s[44:47], s75 offen offset:0 sc1
    buffer_load_dwordx4 v[76:79], v14, s[44:47], s75 offen offset:1024 sc1
    s_waitcnt vmcnt(10)
    ds_read_b64_tr_b16 v[240:241], v11 offset:12288
    ds_read_b64_tr_b16 v[242:243], v11 offset:12800
    ds_read_b64_tr_b16 v[244:245], v11 offset:12296
    ds_read_b64_tr_b16 v[246:247], v11 offset:12808
    ds_read_b64_tr_b16 v[248:249], v12 offset:12288
    ds_read_b64_tr_b16 v[250:251], v12 offset:12800
    ds_read_b64_tr_b16 v[252:253], v12 offset:12296
    ds_read_b64_tr_b16 v[254:255], v12 offset:12808
L_spin_37:
    ds_read_b32 v15, v5 offset:4
    s_waitcnt lgkmcnt(0)
    v_readfirstlane_b32 s101, v15
    s_cmp_ge_u32 s101, 4
    s_cbranch_scc0 L_retry_38
    ds_read_b128 v[16:19], v7 offset:1024
    ds_read_b128 v[20:23], v7 offset:9216
    ds_read_b128 v[24:27], v7 offset:17408
    v_xor_b32 v7, 0x100, v7
    ds_read_b128 v[28:31], v8 offset:1024
    ds_read_b128 v[32:35], v8 offset:9216
    ds_read_b128 v[36:39], v8 offset:17408
    v_xor_b32 v8, 0x100, v8
    s_waitcnt lgkmcnt(3)
    s_waitcnt vmcnt(9)
    v_mfma_f32_16x16x32_bf16 v[80:83], v[40:43], v[16:19], 0
    v_mfma_f32_16x16x32_bf16 v[96:99], v[40:43], v[20:23], 0
    v_mfma_f32_16x16x32_bf16 v[112:115], v[40:43], v[24:27], 0
    buffer_load_dwordx4 v[40:43], v14, s[44:47], s75 offen offset:2048 sc1
    s_waitcnt vmcnt(9)
    v_mfma_f32_16x16x32_bf16 v[84:87], v[44:47], v[16:19], 0
    v_mfma_f32_16x16x32_bf16 v[100:103], v[44:47], v[20:23], 0
    v_mfma_f32_16x16x32_bf16 v[116:119], v[44:47], v[24:27], 0
    buffer_load_dwordx4 v[44:47], v14, s[44:47], s75 offen offset:3072 sc1
    s_xor_b32 s75, s75, 4096
    s_waitcnt vmcnt(9)
    v_mfma_f32_16x16x32_bf16 v[88:91], v[48:51], v[16:19], 0
    v_mfma_f32_16x16x32_bf16 v[104:107], v[48:51], v[20:23], 0
    v_mfma_f32_16x16x32_bf16 v[120:123], v[48:51], v[24:27], 0
    buffer_load_dwordx4 v[48:51], v14, s[44:47], s75 offen offset:0 sc1
    s_waitcnt vmcnt(9)
    v_mfma_f32_16x16x32_bf16 v[92:95], v[52:55], v[16:19], 0
    v_mfma_f32_16x16x32_bf16 v[108:111], v[52:55], v[20:23], 0
    v_mfma_f32_16x16x32_bf16 v[124:127], v[52:55], v[24:27], 0
    buffer_load_dwordx4 v[52:55], v14, s[44:47], s75 offen offset:1024 sc1
    ds_read_b128 v[16:19], v9 offset:1024
    ds_read_b128 v[20:23], v9 offset:9216
    ds_read_b128 v[24:27], v9 offset:17408
    v_xor_b32 v9, 0x100, v9
    s_waitcnt lgkmcnt(3)
    s_waitcnt vmcnt(9)
    v_mfma_f32_16x16x32_bf16 v[80:83], v[56:59], v[28:31], v[80:83]
    v_mfma_f32_16x16x32_bf16 v[96:99], v[56:59], v[32:35], v[96:99]
    v_mfma_f32_16x16x32_bf16 v[112:115], v[56:59], v[36:39], v[112:115]
    buffer_load_dwordx4 v[56:59], v14, s[44:47], s75 offen offset:2048 sc1
    s_waitcnt vmcnt(9)
    v_mfma_f32_16x16x32_bf16 v[84:87], v[60:63], v[28:31], v[84:87]
    v_mfma_f32_16x16x32_bf16 v[100:103], v[60:63], v[32:35], v[100:103]
    v_mfma_f32_16x16x32_bf16 v[116:119], v[60:63], v[36:39], v[116:119]
    buffer_load_dwordx4 v[60:63], v14, s[44:47], s75 offen offset:3072 sc1
    s_xor_b32 s75, s75, 28672
    s_waitcnt vmcnt(9)
    v_mfma_f32_16x16x32_bf16 v[88:91], v[64:67], v[28:31], v[88:91]
    v_mfma_f32_16x16x32_bf16 v[104:107], v[64:67], v[32:35], v[104:107]
    v_mfma_f32_16x16x32_bf16 v[120:123], v[64:67], v[36:39], v[120:123]
    buffer_load_dwordx4 v[64:67], v14, s[44:47], s75 offen offset:0 sc1
    s_waitcnt vmcnt(9)
    v_mfma_f32_16x16x32_bf16 v[92:95], v[68:71], v[28:31], v[92:95]
    v_mfma_f32_16x16x32_bf16 v[108:111], v[68:71], v[32:35], v[108:111]
    v_mfma_f32_16x16x32_bf16 v[124:127], v[68:71], v[36:39], v[124:127]
    buffer_load_dwordx4 v[68:71], v14, s[44:47], s75 offen offset:1024 sc1
    ds_read_b128 v[28:31], v10 offset:1024
    ds_read_b128 v[32:35], v10 offset:9216
    ds_read_b128 v[36:39], v10 offset:17408
    v_xor_b32 v10, 0x100, v10
    s_waitcnt lgkmcnt(3)
    s_waitcnt vmcnt(9)
    v_mfma_f32_16x16x32_bf16 v[80:83], v[72:75], v[16:19], v[80:83]
    v_mfma_f32_16x16x32_bf16 v[96:99], v[72:75], v[20:23], v[96:99]
    v_mfma_f32_16x16x32_bf16 v[112:115], v[72:75], v[24:27], v[112:115]
    buffer_load_dwordx4 v[72:75], v14, s[44:47], s75 offen offset:2048 sc1
    s_waitcnt vmcnt(9)
    v_mfma_f32_16x16x32_bf16 v[84:87], v[76:79], v[16:19], v[84:87]
    v_mfma_f32_16x16x32_bf16 v[100:103], v[76:79], v[20:23], v[100:103]
    v_mfma_f32_16x16x32_bf16 v[116:119], v[76:79], v[24:27], v[116:119]
    buffer_load_dwordx4 v[76:79], v14, s[44:47], s75 offen offset:3072 sc1
    s_xor_b32 s75, s75, 4096
    s_waitcnt vmcnt(9)
    v_mfma_f32_16x16x32_bf16 v[88:91], v[40:43], v[16:19], v[88:91]
    v_mfma_f32_16x16x32_bf16 v[104:107], v[40:43], v[20:23], v[104:107]
    v_mfma_f32_16x16x32_bf16 v[120:123], v[40:43], v[24:27], v[120:123]
    buffer_load_dwordx4 v[40:43], v14, s[44:47], s75 offen offset:0 sc1
    s_waitcnt vmcnt(9)
    v_mfma_f32_16x16x32_bf16 v[92:95], v[44:47], v[16:19], v[92:95]
    v_mfma_f32_16x16x32_bf16 v[108:111], v[44:47], v[20:23], v[108:111]
    v_mfma_f32_16x16x32_bf16 v[124:127], v[44:47], v[24:27], v[124:127]
    buffer_load_dwordx4 v[44:47], v14, s[44:47], s75 offen offset:1024 sc1
    ds_read_b128 v[16:19], v7 offset:1024
    ds_read_b128 v[20:23], v7 offset:9216
    ds_read_b128 v[24:27], v7 offset:17408
    v_xor_b32 v7, 0x100, v7
    s_waitcnt lgkmcnt(3)
    s_waitcnt vmcnt(9)
    v_mfma_f32_16x16x32_bf16 v[80:83], v[48:51], v[28:31], v[80:83]
    v_mfma_f32_16x16x32_bf16 v[96:99], v[48:51], v[32:35], v[96:99]
    v_mfma_f32_16x16x32_bf16 v[112:115], v[48:51], v[36:39], v[112:115]
    buffer_load_dwordx4 v[48:51], v14, s[44:47], s75 offen offset:2048 sc1
    s_waitcnt vmcnt(9)
    v_mfma_f32_16x16x32_bf16 v[84:87], v[52:55], v[28:31], v[84:87]
    v_mfma_f32_16x16x32_bf16 v[100:103], v[52:55], v[32:35], v[100:103]
    v_mfma_f32_16x16x32_bf16 v[116:119], v[52:55], v[36:39], v[116:119]
    buffer_load_dwordx4 v[52:55], v14, s[44:47], s75 offen offset:3072 sc1
    s_xor_b32 s75, s75, 12288
    s_waitcnt vmcnt(9)
    v_mfma_f32_16x16x32_bf16 v[88:91], v[56:59], v[28:31], v[88:91]
    v_mfma_f32_16x16x32_bf16 v[104:107], v[56:59], v[32:35], v[104:107]
    v_mfma_f32_16x16x32_bf16 v[120:123], v[56:59], v[36:39], v[120:123]
    buffer_load_dwordx4 v[56:59], v14, s[44:47], s75 offen offset:0 sc1
    s_waitcnt vmcnt(9)
    v_mfma_f32_16x16x32_bf16 v[92:95], v[60:63], v[28:31], v[92:95]
    v_mfma_f32_16x16x32_bf16 v[108:111], v[60:63], v[32:35], v[108:111]
    v_mfma_f32_16x16x32_bf16 v[124:127], v[60:63], v[36:39], v[124:127]
    buffer_load_dwordx4 v[60:63], v14, s[44:47], s75 offen offset:1024 sc1
    ds_read_b128 v[28:31], v8 offset:1024
    ds_read_b128 v[32:35], v8 offset:9216
    ds_read_b128 v[36:39], v8 offset:17408
    v_xor_b32 v8, 0x100, v8
    s_waitcnt lgkmcnt(3)
    s_waitcnt vmcnt(9)
    v_mfma_f32_16x16x32_bf16 v[80:83], v[64:67], v[16:19], v[80:83]
    v_mfma_f32_16x16x32_bf16 v[96:99], v[64:67], v[20:23], v[96:99]
    v_mfma_f32_16x16x32_bf16 v[112:115], v[64:67], v[24:27], v[112:115]
    buffer_load_dwordx4 v[64:67], v14, s[44:47], s75 offen offset:2048 sc1
    s_waitcnt vmcnt(9)
    v_mfma_f32_16x16x32_bf16 v[84:87], v[68:71], v[16:19], v[84:87]
    v_mfma_f32_16x16x32_bf16 v[100:103], v[68:71], v[20:23], v[100:103]
    v_mfma_f32_16x16x32_bf16 v[116:119], v[68:71], v[24:27], v[116:119]
    buffer_load_dwordx4 v[68:71], v14, s[44:47], s75 offen offset:3072 sc1
    s_xor_b32 s75, s75, 4096
    s_waitcnt vmcnt(9)
    v_mfma_f32_16x16x32_bf16 v[88:91], v[72:75], v[16:19], v[88:91]
    v_mfma_f32_16x16x32_bf16 v[104:107], v[72:75], v[20:23], v[104:107]
    v_mfma_f32_16x16x32_bf16 v[120:123], v[72:75], v[24:27], v[120:123]
    buffer_load_dwordx4 v[72:75], v14, s[44:47], s75 offen offset:0 sc1
    s_waitcnt vmcnt(9)
    v_mfma_f32_16x16x32_bf16 v[92:95], v[76:79], v[16:19], v[92:95]
    v_mfma_f32_16x16x32_bf16 v[108:111], v[76:79], v[20:23], v[108:111]
    v_mfma_f32_16x16x32_bf16 v[124:127], v[76:79], v[24:27], v[124:127]
    buffer_load_dwordx4 v[76:79], v14, s[44:47], s75 offen offset:1024 sc1
    ds_read_b128 v[16:19], v9 offset:1024
    ds_read_b128 v[20:23], v9 offset:9216
    ds_read_b128 v[24:27], v9 offset:17408
    v_xor_b32 v9, 0x100, v9
    s_waitcnt lgkmcnt(3)
    s_waitcnt vmcnt(9)
    v_mfma_f32_16x16x32_bf16 v[80:83], v[40:43], v[28:31], v[80:83]
    v_mfma_f32_16x16x32_bf16 v[96:99], v[40:43], v[32:35], v[96:99]
    v_mfma_f32_16x16x32_bf16 v[112:115], v[40:43], v[36:39], v[112:115]
    buffer_load_dwordx4 v[40:43], v14, s[44:47], s75 offen offset:2048 sc1
    s_waitcnt vmcnt(9)
    v_mfma_f32_16x16x32_bf16 v[84:87], v[44:47], v[28:31], v[84:87]
    v_mfma_f32_16x16x32_bf16 v[100:103], v[44:47], v[32:35], v[100:103]
    v_mfma_f32_16x16x32_bf16 v[116:119], v[44:47], v[36:39], v[116:119]
    buffer_load_dwordx4 v[44:47], v14, s[44:47], s75 offen offset:3072 sc1
    s_xor_b32 s75, s75, 28672
    s_waitcnt vmcnt(9)
    v_mfma_f32_16x16x32_bf16 v[88:91], v[48:51], v[28:31], v[88:91]
    v_mfma_f32_16x16x32_bf16 v[104:107], v[48:51], v[32:35], v[104:107]
    v_mfma_f32_16x16x32_bf16 v[120:123], v[48:51], v[36:39], v[120:123]
    s_add_u32 m0, s70, 0
    s_nop 0
    buffer_load_dwordx4 v13, s[40:43], 0 offen offset:0 lds
    s_waitcnt vmcnt(9)
    v_mfma_f32_16x16x32_bf16 v[92:95], v[52:55], v[28:31], v[92:95]
    v_mfma_f32_16x16x32_bf16 v[108:111], v[52:55], v[32:35], v[108:111]
    v_mfma_f32_16x16x32_bf16 v[124:127], v[52:55], v[36:39], v[124:127]
    buffer_load_dwordx4 v13, s[40:43], s71 offen offset:1024 lds
    ds_read_b128 v[28:31], v10 offset:1024
    ds_read_b128 v[32:35], v10 offset:9216
    ds_read_b128 v[36:39], v10 offset:17408
    v_xor_b32 v10, 0x100, v10
    s_waitcnt lgkmcnt(3)
    s_waitcnt vmcnt(9)
    v_mfma_f32_16x16x32_bf16 v[80:83], v[56:59], v[16:19], v[80:83]
    v_mfma_f32_16x16x32_bf16 v[96:99], v[56:59], v[20:23], v[96:99]
    v_mfma_f32_16x16x32_bf16 v[112:115], v[56:59], v[24:27], v[112:115]
    buffer_load_dwordx4 v13, s[40:43], s72 offen offset:2048 lds
    s_waitcnt vmcnt(9)
    v_mfma_f32_16x16x32_bf16 v[84:87], v[60:63], v[16:19], v[84:87]
    v_mfma_f32_16x16x32_bf16 v[100:103], v[60:63], v[20:23], v[100:103]
    v_mfma_f32_16x16x32_bf16 v[116:119], v[60:63], v[24:27], v[116:119]
    buffer_load_dwordx4 v13, s[40:43], s73 offen offset:3072 lds
    v_xor_b32 v13, 16384, v13
    s_waitcnt vmcnt(9)
    v_mfma_f32_16x16x32_bf16 v[88:91], v[64:67], v[16:19], v[88:91]
    v_mfma_f32_16x16x32_bf16 v[104:107], v[64:67], v[20:23], v[104:107]
    v_mfma_f32_16x16x32_bf16 v[120:123], v[64:67], v[24:27], v[120:123]
    s_add_u32 m0, s70, 4096
    s_nop 0
    buffer_load_dwordx4 v13, s[40:43], 0 offen offset:0 lds
    s_waitcnt vmcnt(9)
    v_mfma_f32_16x16x32_bf16 v[92:95], v[68:71], v[16:19], v[92:95]
    v_mfma_f32_16x16x32_bf16 v[108:111], v[68:71], v[20:23], v[108:111]
    v_mfma_f32_16x16x32_bf16 v[124:127], v[68:71], v[24:27], v[124:127]
    buffer_load_dwordx4 v13, s[40:43], s71 offen offset:1024 lds
    s_waitcnt lgkmcnt(0)
    s_waitcnt vmcnt(9)
    v_mfma_f32_16x16x32_bf16 v[80:83], v[72:75], v[28:31], v[80:83]
    v_mfma_f32_16x16x32_bf16 v[96:99], v[72:75], v[32:35], v[96:99]
    v_mfma_f32_16x16x32_bf16 v[112:115], v[72:75], v[36:39], v[112:115]
    buffer_load_dwordx4 v13, s[40:43], s72 offen offset:2048 lds
    s_waitcnt vmcnt(9)
    v_mfma_f32_16x16x32_bf16 v[84:87], v[76:79], v[28:31], v[84:87]
    v_mfma_f32_16x16x32_bf16 v[100:103], v[76:79], v[32:35], v[100:103]
    v_mfma_f32_16x16x32_bf16 v[116:119], v[76:79], v[36:39], v[116:119]
    buffer_load_dwordx4 v13, s[40:43], s73 offen offset:3072 lds
    v_xor_b32 v13, 49152, v13
    s_waitcnt vmcnt(9)
    v_mfma_f32_16x16x32_bf16 v[88:91], v[40:43], v[28:31], v[88:91]
    v_mfma_f32_16x16x32_bf16 v[104:107], v[40:43], v[32:35], v[104:107]
    v_mfma_f32_16x16x32_bf16 v[120:123], v[40:43], v[36:39], v[120:123]
    s_add_u32 m0, s70, 8192
    s_nop 0
    buffer_load_dwordx4 v13, s[40:43], 0 offen offset:0 lds
    s_waitcnt vmcnt(9)
    v_mfma_f32_16x16x32_bf16 v[92:95], v[44:47], v[28:31], v[92:95]
    v_mfma_f32_16x16x32_bf16 v[108:111], v[44:47], v[32:35], v[108:111]
    v_mfma_f32_16x16x32_bf16 v[124:127], v[44:47], v[36:39], v[124:127]
    buffer_load_dwordx4 v13, s[40:43], s71 offen offset:1024 lds
    s_lshl_b32 s64, s31, 3
    v_add_u32 v0, s64, v4
    v_xor_b32 v0, v0, v3
    v_lshlrev_b32 v0, 4, v0
    v_lshl_add_u32 v0, v3, 9, v0
    v_xor_b32 v1, 64, v0
    s_mov_b32 s76, 0x00ff00ff
    s_mov_b32 s77, 0x00ff00ff
    v_cvt_pk_bf16_f32 v16, v80, v81
    v_cvt_pk_bf16_f32 v17, v82, v83
    v_cvt_pk_bf16_f32 v18, v84, v85
    v_cvt_pk_bf16_f32 v19, v86, v87
    ds_write_b128 v0, v[16:19] offset:21504
    v_cvt_pk_bf16_f32 v20, v88, v89
    v_cvt_pk_bf16_f32 v21, v90, v91
    v_cvt_pk_bf16_f32 v22, v92, v93
    v_cvt_pk_bf16_f32 v23, v94, v95
    ds_write_b128 v1, v[20:23] offset:21504
    v_cvt_pk_bf16_f32 v24, v96, v97
    v_cvt_pk_bf16_f32 v25, v98, v99
    v_cvt_pk_bf16_f32 v26, v100, v101
    v_cvt_pk_bf16_f32 v27, v102, v103
    ds_write_b128 v0, v[24:27] offset:29696
    v_cvt_pk_bf16_f32 v28, v104, v105
    v_cvt_pk_bf16_f32 v29, v106, v107
    v_cvt_pk_bf16_f32 v30, v108, v109
    v_cvt_pk_bf16_f32 v31, v110, v111
    ds_write_b128 v1, v[28:31] offset:29696
    s_mov_b64 exec, s[76:77]
    v_cvt_pk_bf16_f32 v32, v112, v113
    v_cvt_pk_bf16_f32 v33, v114, v115
    v_cvt_pk_bf16_f32 v34, v116, v117
    v_cvt_pk_bf16_f32 v35, v118, v119
    ds_write_b128 v0, v[32:35] offset:37888
    v_cvt_pk_bf16_f32 v36, v120, v121
    v_cvt_pk_bf16_f32 v37, v122, v123
    v_cvt_pk_bf16_f32 v38, v124, v125
    v_cvt_pk_bf16_f32 v39, v126, v127
    ds_write_b128 v1, v[36:39] offset:37888
    s_mov_b64 exec, -1
    s_waitcnt lgkmcnt(0)
    s_barrier
    buffer_load_dwordx4 v13, s[40:43], s72 offen offset:2048 lds
    buffer_load_dwordx4 v13, s[40:43], s73 offen offset:3072 lds
    v_xor_b32 v13, 16384, v13
    s_add_u32 m0, s70, 12288
    s_nop 0
    buffer_load_dwordx4 v13, s[40:43], 0 offen offset:0 lds
    buffer_load_dwordx4 v13, s[40:43], s71 offen offset:1024 lds
    buffer_load_dwordx4 v13, s[40:43], s72 offen offset:2048 lds
    buffer_load_dwordx4 v13, s[40:43], s73 offen offset:3072 lds
    v_xor_b32 v13, 114688, v13
    v_lshlrev_b32 v0, 4, v4
    v_and_b32 v1, 7, v3
    v_lshl_add_u32 v0, v1, 9, v0
    v_and_b32 v1, 8, v3
    v_lshl_add_u32 v0, v1, 3, v0
    s_mul_i32 s74, s1, 20480
    s_lshl_b32 s64, s31, 7
    s_add_u32 s74, s74, s64
    s_waitcnt vmcnt(8)
    ds_read_b64_tr_b16 v[48:49], v11 offset:0
    ds_read_b64_tr_b16 v[50:51], v11 offset:512
    ds_read_b64_tr_b16 v[52:53], v11 offset:8
    ds_read_b64_tr_b16 v[54:55], v11 offset:520
    ds_read_b64_tr_b16 v[56:57], v12 offset:0
    ds_read_b64_tr_b16 v[58:59], v12 offset:512
    ds_read_b64_tr_b16 v[60:61], v12 offset:8
    ds_read_b64_tr_b16 v[62:63], v12 offset:520
    ds_read_b64_tr_b16 v[64:65], v11 offset:4096
    ds_read_b64_tr_b16 v[66:67], v11 offset:4608
    ds_read_b64_tr_b16 v[68:69], v11 offset:4104
    ds_read_b64_tr_b16 v[70:71], v11 offset:4616
    ds_read_b64_tr_b16 v[72:73], v12 offset:4096
    ds_read_b64_tr_b16 v[74:75], v12 offset:4608
    ds_read_b64_tr_b16 v[76:77], v12 offset:4104
    ds_read_b64_tr_b16 v[78:79], v12 offset:4616
    s_waitcnt lgkmcnt(8)
    s_add_u32 m0, s70, 0
    s_nop 0
    buffer_load_dwordx4 v13, s[40:43], 0 offen offset:0 lds
    buffer_load_dwordx4 v13, s[40:43], s71 offen offset:1024 lds
    buffer_load_dwordx4 v13, s[40:43], s72 offen offset:2048 lds
    buffer_load_dwordx4 v13, s[40:43], s73 offen offset:3072 lds
    v_xor_b32 v13, 16384, v13
    s_waitcnt lgkmcnt(0)
    s_add_u32 m0, s70, 4096
    s_nop 0
    buffer_load_dwordx4 v13, s[40:43], 0 offen offset:0 lds
    buffer_load_dwordx4 v13, s[40:43], s71 offen offset:1024 lds
    buffer_load_dwordx4 v13, s[40:43], s72 offen offset:2048 lds
    buffer_load_dwordx4 v13, s[40:43], s73 offen offset:3072 lds
    v_xor_b32 v13, 49152, v13
    s_lshl_b32 s64, s31, 12
    s_add_u32 s78, s64, 21504
    s_add_u32 s79, s64, 148480
    s_cmp_eq_u32 s31, 3
    s_cselect_b32 s79, 37888, s79
    s_sub_u32 s76, s78, s70
    s_sub_u32 s77, s79, s78
    v_xor_b32 v40, 0x100, v7
    v_xor_b32 v41, 0x100, v8
    v_xor_b32 v42, 0x100, v9
    v_xor_b32 v43, 0x100, v10
    s_barrier
    s_mov_b32 m0, s78
    s_nop 0
    buffer_load_dwordx4 v13, s[40:43], 0 offen offset:0 lds
    buffer_load_dwordx4 v13, s[40:43], s71 offen offset:1024 lds
    buffer_load_dwordx4 v13, s[40:43], s72 offen offset:2048 lds
    buffer_load_dwordx4 v13, s[40:43], s73 offen offset:3072 lds
    v_xor_b32 v13, 16384, v13
    s_mov_b32 m0, s79
    s_nop 0
    buffer_load_dwordx4 v13, s[40:43], 0 offen offset:0 lds
    buffer_load_dwordx4 v13, s[40:43], s71 offen offset:1024 lds
    buffer_load_dwordx4 v13, s[40:43], s72 offen offset:2048 lds
    buffer_load_dwordx4 v13, s[40:43], s73 offen offset:3072 lds
    v_xor_b32 v13, 114688, v13
    s_setprio 0
L_prog_39:
    ds_read_b128 v[16:19], v5 offset:32
    s_waitcnt lgkmcnt(0)
    v_min3_u32 v16, v16, v17, v18
    v_min_u32 v16, v16, v19
    v_cmp_gt_u32 vcc, 1, v16
    s_cbranch_vccnz L_retry_40
    ds_read_b128 v[16:19], v7 offset:1024
    ds_read_b128 v[20:23], v7 offset:9216
    ds_read_b128 v[24:27], v7 offset:17408
    s_waitcnt vmcnt(8)
    s_waitcnt lgkmcnt(0)
    v_mfma_f32_16x16x32_bf16 v[80:83], v[128:131], v[16:19], 0
    ds_read_b128 v[28:31], v8 offset:1024
    v_mfma_f32_16x16x32_bf16 v[96:99], v[128:131], v[20:23], 0
    ds_read_b128 v[32:35], v8 offset:9216
    v_mfma_f32_16x16x32_bf16 v[112:115], v[128:131], v[24:27], 0
    ds_read_b128 v[36:39], v8 offset:17408
    v_mfma_f32_16x16x32_bf16 v[84:87], v[132:135], v[16:19], 0
    v_mfma_f32_16x16x32_bf16 v[100:103], v[132:135], v[20:23], 0
    v_mfma_f32_16x16x32_bf16 v[116:119], v[132:135], v[24:27], 0
    v_mfma_f32_16x16x32_bf16 v[88:91], v[136:139], v[16:19], 0
    v_mfma_f32_16x16x32_bf16 v[104:107], v[136:139], v[20:23], 0
    v_mfma_f32_16x16x32_bf16 v[120:123], v[136:139], v[24:27], 0
    v_mfma_f32_16x16x32_bf16 v[92:95], v[140:143], v[16:19], 0
    v_mfma_f32_16x16x32_bf16 v[108:111], v[140:143], v[20:23], 0
    v_mfma_f32_16x16x32_bf16 v[124:127], v[140:143], v[24:27], 0
    s_waitcnt lgkmcnt(0)
    v_mfma_f32_16x16x32_bf16 v[80:83], v[144:147], v[28:31], v[80:83]
    ds_read_b128 v[16:19], v9 offset:1024
    v_mfma_f32_16x16x32_bf16 v[96:99], v[144:147], v[32:35], v[96:99]
    ds_read_b128 v[20:23], v9 offset:9216
    v_mfma_f32_16x16x32_bf16 v[112:115], v[144:147], v[36:39], v[112:115]
    ds_read_b128 v[24:27], v9 offset:17408
    v_mfma_f32_16x16x32_bf16 v[84:87], v[148:151], v[28:31], v[84:87]
    ds_read_b64_tr_b16 v[128:129], v11 offset:8192
    v_mfma_f32_16x16x32_bf16 v[100:103], v[148:151], v[32:35], v[100:103]
    ds_read_b64_tr_b16 v[130:131], v11 offset:8704
    v_mfma_f32_16x16x32_bf16 v[116:119], v[148:151], v[36:39], v[116:119]
    ds_read_b64_tr_b16 v[132:133], v11 offset:8200
    v_mfma_f32_16x16x32_bf16 v[88:91], v[152:155], v[28:31], v[88:91]
    ds_read_b64_tr_b16 v[134:135], v11 offset:8712
    v_mfma_f32_16x16x32_bf16 v[104:107], v[152:155], v[32:35], v[104:107]
    ds_read_b64_tr_b16 v[136:137], v12 offset:8192
    v_mfma_f32_16x16x32_bf16 v[120:123], v[152:155], v[36:39], v[120:123]
    ds_read_b64_tr_b16 v[138:139], v12 offset:8704
    v_mfma_f32_16x16x32_bf16 v[92:95], v[156:159], v[28:31], v[92:95]
    ds_read_b64_tr_b16 v[140:141], v12 offset:8200
    v_mfma_f32_16x16x32_bf16 v[108:111], v[156:159], v[32:35], v[108:111]
    ds_read_b64_tr_b16 v[142:143], v12 offset:8712
    v_mfma_f32_16x16x32_bf16 v[124:127], v[156:159], v[36:39], v[124:127]
    s_waitcnt lgkmcnt(8)
    v_mfma_f32_16x16x32_bf16 v[80:83], v[160:163], v[16:19], v[80:83]
    ds_read_b128 v[28:31], v10 offset:1024
    v_mfma_f32_16x16x32_bf16 v[96:99], v[160:163], v[20:23], v[96:99]
    ds_read_b128 v[32:35], v10 offset:9216
    v_mfma_f32_16x16x32_bf16 v[112:115], v[160:163], v[24:27], v[112:115]
    ds_read_b128 v[36:39], v10 offset:17408
    v_mfma_f32_16x16x32_bf16 v[84:87], v[164:167], v[16:19], v[84:87]
    ds_read_b64_tr_b16 v[144:145], v11 offset:12288
    v_mfma_f32_16x16x32_bf16 v[100:103], v[164:167], v[20:23], v[100:103]
    ds_read_b64_tr_b16 v[146:147], v11 offset:12800
    v_mfma_f32_16x16x32_bf16 v[116:119], v[164:167], v[24:27], v[116:119]
    ds_read_b64_tr_b16 v[148:149], v11 offset:12296
    v_mfma_f32_16x16x32_bf16 v[88:91], v[168:171], v[16:19], v[88:91]
    ds_read_b64_tr_b16 v[150:151], v11 offset:12808
    v_mfma_f32_16x16x32_bf16 v[104:107], v[168:171], v[20:23], v[104:107]
    ds_read_b64_tr_b16 v[152:153], v12 offset:12288
    v_mfma_f32_16x16x32_bf16 v[120:123], v[168:171], v[24:27], v[120:123]
    ds_read_b64_tr_b16 v[154:155], v12 offset:12800
    v_mfma_f32_16x16x32_bf16 v[92:95], v[172:175], v[16:19], v[92:95]
    ds_read_b64_tr_b16 v[156:157], v12 offset:12296
    v_mfma_f32_16x16x32_bf16 v[108:111], v[172:175], v[20:23], v[108:111]
    ds_read_b64_tr_b16 v[158:159], v12 offset:12808
    v_mfma_f32_16x16x32_bf16 v[124:127], v[172:175], v[24:27], v[124:127]
    s_waitcnt lgkmcnt(8)
    v_mfma_f32_16x16x32_bf16 v[80:83], v[176:179], v[28:31], v[80:83]
    ds_read_b128 v[16:19], v40 offset:1024
    v_mfma_f32_16x16x32_bf16 v[96:99], v[176:179], v[32:35], v[96:99]
    ds_read_b128 v[20:23], v40 offset:9216
    v_mfma_f32_16x16x32_bf16 v[112:115], v[176:179], v[36:39], v[112:115]
    ds_read_b128 v[24:27], v40 offset:17408
    v_mfma_f32_16x16x32_bf16 v[84:87], v[180:183], v[28:31], v[84:87]
    ds_read_b64_tr_b16 v[160:161], v11 offset:0
    v_mfma_f32_16x16x32_bf16 v[100:103], v[180:183], v[32:35], v[100:103]
    ds_read_b64_tr_b16 v[162:163], v11 offset:512
    v_mfma_f32_16x16x32_bf16 v[116:119], v[180:183], v[36:39], v[116:119]
    ds_read_b64_tr_b16 v[164:165], v11 offset:8
    v_mfma_f32_16x16x32_bf16 v[88:91], v[184:187], v[28:31], v[88:91]
    ds_read_b64_tr_b16 v[166:167], v11 offset:520
    v_mfma_f32_16x16x32_bf16 v[104:107], v[184:187], v[32:35], v[104:107]
    ds_read_b64_tr_b16 v[168:169], v12 offset:0
    v_mfma_f32_16x16x32_bf16 v[120:123], v[184:187], v[36:39], v[120:123]
    ds_read_b64_tr_b16 v[170:171], v12 offset:512
    v_mfma_f32_16x16x32_bf16 v[92:95], v[188:191], v[28:31], v[92:95]
    ds_read_b64_tr_b16 v[172:173], v12 offset:8
    v_mfma_f32_16x16x32_bf16 v[108:111], v[188:191], v[32:35], v[108:111]
    ds_read_b64_tr_b16 v[174:175], v12 offset:520
    v_mfma_f32_16x16x32_bf16 v[124:127], v[188:191], v[36:39], v[124:127]
    s_waitcnt lgkmcnt(8)
    v_mfma_f32_16x16x32_bf16 v[80:83], v[192:195], v[16:19], v[80:83]
    ds_read_b128 v[28:31], v41 offset:1024
    v_mfma_f32_16x16x32_bf16 v[96:99], v[192:195], v[20:23], v[96:99]
    ds_read_b128 v[32:35], v41 offset:9216
    v_mfma_f32_16x16x32_bf16 v[112:115], v[192:195], v[24:27], v[112:115]
    ds_read_b128 v[36:39], v41 offset:17408
    v_mfma_f32_16x16x32_bf16 v[84:87], v[196:199], v[16:19], v[84:87]
    ds_read_b64_tr_b16 v[176:177], v11 offset:4096
    v_mfma_f32_16x16x32_bf16 v[100:103], v[196:199], v[20:23], v[100:103]
    ds_read_b64_tr_b16 v[178:179], v11 offset:4608
    v_mfma_f32_16x16x32_bf16 v[116:119], v[196:199], v[24:27], v[116:119]
    ds_read_b64_tr_b16 v[180:181], v11 offset:4104
    v_mfma_f32_16x16x32_bf16 v[88:91], v[200:203], v[16:19], v[88:91]
    ds_read_b64_tr_b16 v[182:183], v11 offset:4616
    v_mfma_f32_16x16x32_bf16 v[104:107], v[200:203], v[20:23], v[104:107]
    ds_read_b64_tr_b16 v[184:185], v12 offset:4096
    v_mfma_f32_16x16x32_bf16 v[120:123], v[200:203], v[24:27], v[120:123]
    ds_read_b64_tr_b16 v[186:187], v12 offset:4608
    v_mfma_f32_16x16x32_bf16 v[92:95], v[204:207], v[16:19], v[92:95]
    ds_read_b64_tr_b16 v[188:189], v12 offset:4104
    v_mfma_f32_16x16x32_bf16 v[108:111], v[204:207], v[20:23], v[108:111]
    ds_read_b64_tr_b16 v[190:191], v12 offset:4616
    v_mfma_f32_16x16x32_bf16 v[124:127], v[204:207], v[24:27], v[124:127]
    s_waitcnt lgkmcnt(8)
    v_mfma_f32_16x16x32_bf16 v[80:83], v[208:211], v[28:31], v[80:83]
    ds_read_b128 v[16:19], v42 offset:1024
    v_mfma_f32_16x16x32_bf16 v[96:99], v[208:211], v[32:35], v[96:99]
    ds_read_b128 v[20:23], v42 offset:9216
    v_mfma_f32_16x16x32_bf16 v[112:115], v[208:211], v[36:39], v[112:115]
    ds_read_b128 v[24:27], v42 offset:17408
    v_mfma_f32_16x16x32_bf16 v[84:87], v[212:215], v[28:31], v[84:87]
    v_mfma_f32_16x16x32_bf16 v[100:103], v[212:215], v[32:35], v[100:103]
    v_mfma_f32_16x16x32_bf16 v[116:119], v[212:215], v[36:39], v[116:119]
    v_mfma_f32_16x16x32_bf16 v[88:91], v[216:219], v[28:31], v[88:91]
    v_mfma_f32_16x16x32_bf16 v[104:107], v[216:219], v[32:35], v[104:107]
    v_mfma_f32_16x16x32_bf16 v[120:123], v[216:219], v[36:39], v[120:123]
    v_mfma_f32_16x16x32_bf16 v[92:95], v[220:223], v[28:31], v[92:95]
    v_mfma_f32_16x16x32_bf16 v[108:111], v[220:223], v[32:35], v[108:111]
    v_mfma_f32_16x16x32_bf16 v[124:127], v[220:223], v[36:39], v[124:127]
    s_waitcnt lgkmcnt(0)
    v_mfma_f32_16x16x32_bf16 v[80:83], v[224:227], v[16:19], v[80:83]
    v_add_u32 v11, s76, v11
    v_add_u32 v12, s76, v12
    v_mfma_f32_16x16x32_bf16 v[96:99], v[224:227], v[20:23], v[96:99]
    ds_read_b128 v[28:31], v43 offset:1024
    v_mfma_f32_16x16x32_bf16 v[112:115], v[224:227], v[24:27], v[112:115]
    ds_read_b128 v[32:35], v43 offset:9216
    v_mfma_f32_16x16x32_bf16 v[84:87], v[228:231], v[16:19], v[84:87]
    ds_read_b128 v[36:39], v43 offset:17408
    v_mfma_f32_16x16x32_bf16 v[100:103], v[228:231], v[20:23], v[100:103]
    s_waitcnt vmcnt(4)
    ds_read_b64_tr_b16 v[192:193], v11 offset:0
    v_mfma_f32_16x16x32_bf16 v[116:119], v[228:231], v[24:27], v[116:119]
    ds_read_b64_tr_b16 v[194:195], v11 offset:512
    v_mfma_f32_16x16x32_bf16 v[88:91], v[232:235], v[16:19], v[88:91]
    ds_read_b64_tr_b16 v[196:197], v11 offset:8
    v_mfma_f32_16x16x32_bf16 v[104:107], v[232:235], v[20:23], v[104:107]
    ds_read_b64_tr_b16 v[198:199], v11 offset:520
    v_mfma_f32_16x16x32_bf16 v[120:123], v[232:235], v[24:27], v[120:123]
    ds_read_b64_tr_b16 v[200:201], v12 offset:0
    v_mfma_f32_16x16x32_bf16 v[92:95], v[236:239], v[16:19], v[92:95]
    ds_read_b64_tr_b16 v[202:203], v12 offset:512
    v_mfma_f32_16x16x32_bf16 v[108:111], v[236:239], v[20:23], v[108:111]
    ds_read_b64_tr_b16 v[204:205], v12 offset:8
    v_mfma_f32_16x16x32_bf16 v[124:127], v[236:239], v[24:27], v[124:127]
    ds_read_b64_tr_b16 v[206:207], v12 offset:520
    s_waitcnt lgkmcnt(8)
    v_mfma_f32_16x16x32_bf16 v[80:83], v[240:243], v[28:31], v[80:83]
    v_add_u32 v11, s77, v11
    v_add_u32 v12, s77, v12
    v_mfma_f32_16x16x32_bf16 v[96:99], v[240:243], v[32:35], v[96:99]
    s_waitcnt vmcnt(0)
    ds_read_b64_tr_b16 v[208:209], v11 offset:0
    v_mfma_f32_16x16x32_bf16 v[112:115], v[240:243], v[36:39], v[112:115]
    ds_read_b64_tr_b16 v[210:211], v11 offset:512
    v_mfma_f32_16x16x32_bf16 v[84:87], v[244:247], v[28:31], v[84:87]
    ds_read_b64_tr_b16 v[212:213], v11 offset:8
    v_mfma_f32_16x16x32_bf16 v[100:103], v[244:247], v[32:35], v[100:103]
    ds_read_b64_tr_b16 v[214:215], v11 offset:520
    v_mfma_f32_16x16x32_bf16 v[116:119], v[244:247], v[36:39], v[116:119]
    ds_read_b64_tr_b16 v[216:217], v12 offset:0
    v_mfma_f32_16x16x32_bf16 v[88:91], v[248:251], v[28:31], v[88:91]
    ds_read_b64_tr_b16 v[218:219], v12 offset:512
    v_mfma_f32_16x16x32_bf16 v[104:107], v[248:251], v[32:35], v[104:107]
    ds_read_b64_tr_b16 v[220:221], v12 offset:8
    v_mfma_f32_16x16x32_bf16 v[120:123], v[248:251], v[36:39], v[120:123]
    ds_read_b64_tr_b16 v[222:223], v12 offset:520
    v_mfma_f32_16x16x32_bf16 v[92:95], v[252:255], v[28:31], v[92:95]
    v_mfma_f32_16x16x32_bf16 v[108:111], v[252:255], v[32:35], v[108:111]
    v_mfma_f32_16x16x32_bf16 v[124:127], v[252:255], v[36:39], v[124:127]
    s_add_u32 s75, s74, 4096
    s_add_u32 s76, s74, 8192
    s_add_u32 s77, s74, 12288
    s_add_u32 s78, s74, 16384
L_prog_41:
    ds_read_b128 v[16:19], v5 offset:32
    s_waitcnt lgkmcnt(0)
    v_min3_u32 v16, v16, v17, v18
    v_min_u32 v16, v16, v19
    v_cmp_gt_u32 vcc, 1, v16
    s_cbranch_vccnz L_retry_42
    ds_read_b128 v[16:19], v7 offset:58368
    ds_read_b128 v[20:23], v8 offset:58368
    ds_read_b128 v[24:27], v9 offset:58368
    ds_read_b128 v[28:31], v10 offset:58368
    ds_read_b128 v[32:35], v40 offset:58368
    ds_read_b128 v[36:39], v41 offset:58368
    ds_read_b128 v[44:47], v42 offset:58368
    ds_read_b128 v[252:255], v43 offset:58368
    s_waitcnt lgkmcnt(7)
    v_mfma_f32_16x16x32_bf16 v[120:123], v[56:59], v[16:19], v[120:123]
    v_mfma_f32_16x16x32_bf16 v[124:127], v[60:63], v[16:19], v[124:127]
    v_mfma_f32_16x16x32_bf16 v[112:115], v[48:51], v[16:19], v[112:115]
    v_mfma_f32_16x16x32_bf16 v[116:119], v[52:55], v[16:19], v[116:119]
    s_waitcnt lgkmcnt(6)
    v_mfma_f32_16x16x32_bf16 v[120:123], v[72:75], v[20:23], v[120:123]
    v_mfma_f32_16x16x32_bf16 v[124:127], v[76:79], v[20:23], v[124:127]
    v_mfma_f32_16x16x32_bf16 v[112:115], v[64:67], v[20:23], v[112:115]
    v_mfma_f32_16x16x32_bf16 v[116:119], v[68:71], v[20:23], v[116:119]
    s_waitcnt lgkmcnt(5)
    v_mfma_f32_16x16x32_bf16 v[120:123], v[136:139], v[24:27], v[120:123]
    v_mfma_f32_16x16x32_bf16 v[124:127], v[140:143], v[24:27], v[124:127]
    v_mfma_f32_16x16x32_bf16 v[112:115], v[128:131], v[24:27], v[112:115]
    v_mfma_f32_16x16x32_bf16 v[116:119], v[132:135], v[24:27], v[116:119]
    s_waitcnt lgkmcnt(4)
    v_mfma_f32_16x16x32_bf16 v[120:123], v[152:155], v[28:31], v[120:123]
    v_mfma_f32_16x16x32_bf16 v[124:127], v[156:159], v[28:31], v[124:127]
    v_mfma_f32_16x16x32_bf16 v[112:115], v[144:147], v[28:31], v[112:115]
    v_mfma_f32_16x16x32_bf16 v[116:119], v[148:151], v[28:31], v[116:119]
    s_waitcnt lgkmcnt(3)
    v_mfma_f32_16x16x32_bf16 v[120:123], v[168:171], v[32:35], v[120:123]
    v_mfma_f32_16x16x32_bf16 v[124:127], v[172:175], v[32:35], v[124:127]
    v_mfma_f32_16x16x32_bf16 v[112:115], v[160:163], v[32:35], v[112:115]
    v_mfma_f32_16x16x32_bf16 v[116:119], v[164:167], v[32:35], v[116:119]
    s_waitcnt lgkmcnt(2)
    v_mfma_f32_16x16x32_bf16 v[120:123], v[184:187], v[36:39], v[120:123]
    v_mfma_f32_16x16x32_bf16 v[124:127], v[188:191], v[36:39], v[124:127]
    v_mfma_f32_16x16x32_bf16 v[112:115], v[176:179], v[36:39], v[112:115]
    v_mfma_f32_16x16x32_bf16 v[116:119], v[180:183], v[36:39], v[116:119]
    s_waitcnt lgkmcnt(1)
    v_mfma_f32_16x16x32_bf16 v[120:123], v[200:203], v[44:47], v[120:123]
    v_mfma_f32_16x16x32_bf16 v[124:127], v[204:207], v[44:47], v[124:127]
    v_mfma_f32_16x16x32_bf16 v[112:115], v[192:195], v[44:47], v[112:115]
    v_mfma_f32_16x16x32_bf16 v[116:119], v[196:199], v[44:47], v[116:119]
    s_waitcnt lgkmcnt(0)
    v_mfma_f32_16x16x32_bf16 v[120:123], v[216:219], v[252:255], v[120:123]
    v_mfma_f32_16x16x32_bf16 v[124:127], v[220:223], v[252:255], v[124:127]
    v_mfma_f32_16x16x32_bf16 v[112:115], v[208:211], v[252:255], v[112:115]
    v_mfma_f32_16x16x32_bf16 v[116:119], v[212:215], v[252:255], v[116:119]
L_prog_43:
    ds_read_b128 v[16:19], v5 offset:32
    s_waitcnt lgkmcnt(0)
    v_min3_u32 v16, v16, v17, v18
    v_min_u32 v16, v16, v19
    v_cmp_gt_u32 vcc, 3, v16
    s_cbranch_vccnz L_retry_44
    ds_read_b128 v[16:19], v7 offset:41984
    ds_read_b128 v[20:23], v8 offset:41984
    ds_read_b128 v[24:27], v9 offset:41984
    ds_read_b128 v[28:31], v10 offset:41984
    ds_read_b128 v[32:35], v40 offset:41984
    ds_read_b128 v[36:39], v41 offset:41984
    ds_read_b128 v[44:47], v42 offset:41984
    ds_read_b128 v[252:255], v43 offset:41984
    s_waitcnt lgkmcnt(7)
    v_mfma_f32_16x16x32_bf16 v[88:91], v[56:59], v[16:19], v[88:91]
    v_cvt_pk_bf16_f32 v248, v120, v121
    v_mfma_f32_16x16x32_bf16 v[92:95], v[60:63], v[16:19], v[92:95]
    v_cvt_pk_bf16_f32 v249, v122, v123
    v_mfma_f32_16x16x32_bf16 v[80:83], v[48:51], v[16:19], v[80:83]
    v_cvt_pk_bf16_f32 v250, v124, v125
    v_mfma_f32_16x16x32_bf16 v[84:87], v[52:55], v[16:19], v[84:87]
    v_cvt_pk_bf16_f32 v251, v126, v127
    s_waitcnt lgkmcnt(6)
    v_mfma_f32_16x16x32_bf16 v[88:91], v[72:75], v[20:23], v[88:91]
    v_cvt_pk_bf16_f32 v244, v112, v113
    v_mfma_f32_16x16x32_bf16 v[92:95], v[76:79], v[20:23], v[92:95]
    v_cvt_pk_bf16_f32 v245, v114, v115
    v_mfma_f32_16x16x32_bf16 v[80:83], v[64:67], v[20:23], v[80:83]
    v_cvt_pk_bf16_f32 v246, v116, v117
    v_mfma_f32_16x16x32_bf16 v[84:87], v[68:71], v[20:23], v[84:87]
    v_cvt_pk_bf16_f32 v247, v118, v119
    s_waitcnt lgkmcnt(5)
    v_mfma_f32_16x16x32_bf16 v[88:91], v[136:139], v[24:27], v[88:91]
    v_mov_b32_dpp v244, v248 row_ror:8 row_mask:0xf bank_mask:0xc
    v_mfma_f32_16x16x32_bf16 v[92:95], v[140:143], v[24:27], v[92:95]
    v_mov_b32_dpp v245, v249 row_ror:8 row_mask:0xf bank_mask:0xc
    v_mfma_f32_16x16x32_bf16 v[80:83], v[128:131], v[24:27], v[80:83]
    v_mov_b32_dpp v246, v250 row_ror:8 row_mask:0xf bank_mask:0xc
    v_mfma_f32_16x16x32_bf16 v[84:87], v[132:135], v[24:27], v[84:87]
    v_mov_b32_dpp v247, v251 row_ror:8 row_mask:0xf bank_mask:0xc
    s_waitcnt lgkmcnt(4)
    v_mfma_f32_16x16x32_bf16 v[88:91], v[152:155], v[28:31], v[88:91]
    v_mfma_f32_16x16x32_bf16 v[92:95], v[156:159], v[28:31], v[92:95]
    v_mfma_f32_16x16x32_bf16 v[80:83], v[144:147], v[28:31], v[80:83]
    v_mfma_f32_16x16x32_bf16 v[84:87], v[148:151], v[28:31], v[84:87]
    s_waitcnt lgkmcnt(3)
    v_mfma_f32_16x16x32_bf16 v[88:91], v[168:171], v[32:35], v[88:91]
    v_mfma_f32_16x16x32_bf16 v[92:95], v[172:175], v[32:35], v[92:95]
    v_mfma_f32_16x16x32_bf16 v[80:83], v[160:163], v[32:35], v[80:83]
    v_mfma_f32_16x16x32_bf16 v[84:87], v[164:167], v[32:35], v[84:87]
    s_waitcnt lgkmcnt(2)
    v_mfma_f32_16x16x32_bf16 v[88:91], v[184:187], v[36:39], v[88:91]
    v_mfma_f32_16x16x32_bf16 v[92:95], v[188:191], v[36:39], v[92:95]
    v_mfma_f32_16x16x32_bf16 v[80:83], v[176:179], v[36:39], v[80:83]
    v_mfma_f32_16x16x32_bf16 v[84:87], v[180:183], v[36:39], v[84:87]
    s_waitcnt lgkmcnt(1)
    v_mfma_f32_16x16x32_bf16 v[88:91], v[200:203], v[44:47], v[88:91]
    v_mfma_f32_16x16x32_bf16 v[92:95], v[204:207], v[44:47], v[92:95]
    v_mfma_f32_16x16x32_bf16 v[80:83], v[192:195], v[44:47], v[80:83]
    v_mfma_f32_16x16x32_bf16 v[84:87], v[196:199], v[44:47], v[84:87]
    s_waitcnt lgkmcnt(0)
    v_mfma_f32_16x16x32_bf16 v[88:91], v[216:219], v[252:255], v[88:91]
    v_mfma_f32_16x16x32_bf16 v[92:95], v[220:223], v[252:255], v[92:95]
    v_mfma_f32_16x16x32_bf16 v[80:83], v[208:211], v[252:255], v[80:83]
    v_mfma_f32_16x16x32_bf16 v[84:87], v[212:215], v[252:255], v[84:87]
    s_nop 4
    v_cvt_pk_bf16_f32 v228, v88, v89
    v_cvt_pk_bf16_f32 v229, v90, v91
    v_cvt_pk_bf16_f32 v230, v92, v93
    v_cvt_pk_bf16_f32 v231, v94, v95
    v_cvt_pk_bf16_f32 v224, v80, v81
    v_cvt_pk_bf16_f32 v225, v82, v83
    v_cvt_pk_bf16_f32 v226, v84, v85
    v_cvt_pk_bf16_f32 v227, v86, v87
    v_cvt_pk_bf16_f32 v240, v80, v81
    v_cvt_pk_bf16_f32 v241, v82, v83
    v_cvt_pk_bf16_f32 v242, v84, v85
    v_cvt_pk_bf16_f32 v243, v86, v87
    v_mov_b32_dpp v224, v228 row_ror:8 row_mask:0xf bank_mask:0xc
    v_mov_b32_dpp v225, v229 row_ror:8 row_mask:0xf bank_mask:0xc
    v_mov_b32_dpp v226, v230 row_ror:8 row_mask:0xf bank_mask:0xc
    v_mov_b32_dpp v227, v231 row_ror:8 row_mask:0xf bank_mask:0xc
    v_mov_b32_dpp v228, v240 row_ror:8 row_mask:0xf bank_mask:0x3
    v_mov_b32_dpp v229, v241 row_ror:8 row_mask:0xf bank_mask:0x3
    v_mov_b32_dpp v230, v242 row_ror:8 row_mask:0xf bank_mask:0x3
    v_mov_b32_dpp v231, v243 row_ror:8 row_mask:0xf bank_mask:0x3
L_prog_45:
    ds_read_b128 v[16:19], v5 offset:48
    s_waitcnt lgkmcnt(0)
    v_min3_u32 v16, v16, v17, v18
    v_min_u32 v16, v16, v19
    v_cmp_gt_u32 vcc, 1, v16
    s_cbranch_vccnz L_retry_46
    s_setprio 2
    buffer_store_dwordx4 v[244:247], v0, s[48:51], s78 offen sc1
    buffer_store_dwordx4 v[224:227], v0, s[48:51], s74 offen sc1
    buffer_store_dwordx4 v[228:231], v0, s[48:51], s75 offen sc1
    s_setprio 0
    v_lshlrev_b32 v1, 4, v4
    v_lshl_add_u32 v1, v3, 9, v1
    s_barrier
    s_setprio 2
    ds_read_b128 v[16:19], v7 offset:50176
    ds_read_b128 v[20:23], v8 offset:50176
    ds_read_b128 v[24:27], v9 offset:50176
    ds_read_b128 v[28:31], v10 offset:50176
    ds_read_b128 v[32:35], v40 offset:50176
    ds_read_b128 v[36:39], v41 offset:50176
    ds_read_b128 v[44:47], v42 offset:50176
    ds_read_b128 v[252:255], v43 offset:50176
    s_waitcnt lgkmcnt(7)
    v_mfma_f32_16x16x32_bf16 v[104:107], v[56:59], v[16:19], v[104:107]
    v_mfma_f32_16x16x32_bf16 v[108:111], v[60:63], v[16:19], v[108:111]
    s_waitcnt lgkmcnt(6)
    v_mfma_f32_16x16x32_bf16 v[104:107], v[72:75], v[20:23], v[104:107]
    v_mfma_f32_16x16x32_bf16 v[108:111], v[76:79], v[20:23], v[108:111]
    s_waitcnt lgkmcnt(5)
    v_mfma_f32_16x16x32_bf16 v[104:107], v[136:139], v[24:27], v[104:107]
    v_mfma_f32_16x16x32_bf16 v[108:111], v[140:143], v[24:27], v[108:111]
    s_waitcnt lgkmcnt(4)
    v_mfma_f32_16x16x32_bf16 v[104:107], v[152:155], v[28:31], v[104:107]
    v_mfma_f32_16x16x32_bf16 v[108:111], v[156:159], v[28:31], v[108:111]
    s_waitcnt lgkmcnt(3)
    v_mfma_f32_16x16x32_bf16 v[104:107], v[168:171], v[32:35], v[104:107]
    v_mfma_f32_16x16x32_bf16 v[108:111], v[172:175], v[32:35], v[108:111]
    s_waitcnt lgkmcnt(2)
    v_mfma_f32_16x16x32_bf16 v[104:107], v[184:187], v[36:39], v[104:107]
    v_mfma_f32_16x16x32_bf16 v[108:111], v[188:191], v[36:39], v[108:111]
    s_waitcnt lgkmcnt(1)
    v_mfma_f32_16x16x32_bf16 v[104:107], v[200:203], v[44:47], v[104:107]
    v_mfma_f32_16x16x32_bf16 v[108:111], v[204:207], v[44:47], v[108:111]
    s_waitcnt lgkmcnt(0)
    v_mfma_f32_16x16x32_bf16 v[104:107], v[216:219], v[252:255], v[104:107]
    v_mfma_f32_16x16x32_bf16 v[108:111], v[220:223], v[252:255], v[108:111]
    v_mfma_f32_16x16x32_bf16 v[96:99], v[48:51], v[16:19], v[96:99]
    v_mfma_f32_16x16x32_bf16 v[100:103], v[52:55], v[16:19], v[100:103]
    v_mfma_f32_16x16x32_bf16 v[96:99], v[64:67], v[20:23], v[96:99]
    v_mfma_f32_16x16x32_bf16 v[100:103], v[68:71], v[20:23], v[100:103]
    v_mfma_f32_16x16x32_bf16 v[96:99], v[128:131], v[24:27], v[96:99]
    v_mfma_f32_16x16x32_bf16 v[100:103], v[132:135], v[24:27], v[100:103]
    v_mfma_f32_16x16x32_bf16 v[96:99], v[144:147], v[28:31], v[96:99]
    v_mfma_f32_16x16x32_bf16 v[100:103], v[148:151], v[28:31], v[100:103]
    v_cvt_pk_bf16_f32 v236, v104, v105
    v_mfma_f32_16x16x32_bf16 v[96:99], v[160:163], v[32:35], v[96:99]
    v_cvt_pk_bf16_f32 v237, v106, v107
    v_mfma_f32_16x16x32_bf16 v[100:103], v[164:167], v[32:35], v[100:103]
    v_cvt_pk_bf16_f32 v238, v108, v109
    v_mfma_f32_16x16x32_bf16 v[96:99], v[176:179], v[36:39], v[96:99]
    v_cvt_pk_bf16_f32 v239, v110, v111
    v_mfma_f32_16x16x32_bf16 v[100:103], v[180:183], v[36:39], v[100:103]
    buffer_store_dwordx4 v[236:239], v1, s[48:51], s76 offen offset:64 sc1
    v_mfma_f32_16x16x32_bf16 v[96:99], v[192:195], v[44:47], v[96:99]
    v_mfma_f32_16x16x32_bf16 v[100:103], v[196:199], v[44:47], v[100:103]
    v_mfma_f32_16x16x32_bf16 v[96:99], v[208:211], v[252:255], v[96:99]
    v_mfma_f32_16x16x32_bf16 v[100:103], v[212:215], v[252:255], v[100:103]
    s_nop 6
    v_cvt_pk_bf16_f32 v232, v96, v97
    v_cvt_pk_bf16_f32 v233, v98, v99
    v_cvt_pk_bf16_f32 v234, v100, v101
    v_cvt_pk_bf16_f32 v235, v102, v103
    buffer_store_dwordx4 v[232:235], v1, s[48:51], s76 offen offset:0 sc1
    s_or_b32 s64, s2, s3
    s_cbranch_scc1 L_noepoch_47
    v_mov_b32 v1, s30
    s_mov_b64 exec, 1
    buffer_store_dword v1, v5, s[44:47], 0 offen sc1
L_noepoch_47:
    s_endpgm
L_retry_35:
    s_sub_u32 s100, s100, 1
    s_cbranch_scc1 L_end
    s_sleep 1
    s_branch L_spin_34
L_mre_36:
    s_sub_u32 s100, s100, 1
    s_cbranch_scc1 L_end
    s_sleep 2
    buffer_load_dword v1, v0, s[44:47], s74 offen sc1
    s_waitcnt vmcnt(0)
    s_branch L_mchk_33
L_retry_38:
    s_sub_u32 s100, s100, 1
    s_cbranch_scc1 L_end
    s_sleep 1
    s_branch L_spin_37
L_retry_40:
    s_sub_u32 s100, s100, 1
    s_cbranch_scc1 L_end
    s_sleep 1
    s_branch L_prog_39
L_retry_42:
    s_sub_u32 s100, s100, 1
    s_cbranch_scc1 L_end
    s_sleep 1
    s_branch L_prog_41
L_retry_44:
    s_sub_u32 s100, s100, 1
    s_cbranch_scc1 L_end
    s_sleep 1
    s_branch L_prog_43
L_retry_46:
    s_sub_u32 s100, s100, 1
    s_cbranch_scc1 L_end
    s_sleep 1
    s_branch L_prog_45
L_end:
    s_endpgm
.section .rodata,"a"
.p2align 6
.amdhsa_kernel standalone__hybrid_graph_tf_exphormer__graph_kernel
  .amdhsa_next_free_vgpr 256
  .amdhsa_next_free_sgpr 102
  .amdhsa_accum_offset 256
  .amdhsa_group_segment_fixed_size 0
  .amdhsa_kernarg_size 104
  .amdhsa_user_sgpr_count 2
  .amdhsa_user_sgpr_kernarg_segment_ptr 1
  .amdhsa_system_sgpr_workgroup_id_x 1
  .amdhsa_float_denorm_mode_32 3
.end_amdhsa_kernel
```

```asm
; @launch grid=(253,1,1) block=(512,1,1) lds=161792
.amdgcn_target "amdgcn-amd-amdhsa--gfx950"
.text
.globl standalone__hybrid_graph_tf_exphormer__graph_kernel
.p2align 8
.type standalone__hybrid_graph_tf_exphormer__graph_kernel,@function
standalone__hybrid_graph_tf_exphormer__graph_kernel:
L_begin:
    s_cmp_ge_u32 s2, 253
    s_cbranch_scc1 L_end
    s_load_dwordx16 s[4:19], s[0:1], 0
    s_load_dwordx8 s[20:27], s[0:1], 64
    s_load_dwordx2 s[28:29], s[0:1], 96
    s_and_b32 s64, s2, 0xf8
    s_cmp_lg_u32 s64, 8
    s_cbranch_scc1 L_nopf
    s_getpc_b64 s[32:33]
L_pc:
    v_lshlrev_b32 v1, 6, v0
    v_min_u32 v1, L_end-L_pc, v1
    global_load_dword v255, v1, s[32:33]
L_nopf:
    v_lshrrev_b32 v1, 6, v0
    v_and_b32 v2, 63, v0
    v_readfirstlane_b32 s3, v1
    s_and_b32 s67, s2, 7
    s_and_b32 s31, s3, 3
    s_cmp_lt_u32 s3, 4
    s_cbranch_scc1 L_gemm
    s_setprio 3
    s_bitcmp1_b32 s2, 3
    s_cbranch_scc0 L_mload_1
    s_lshr_b32 s66, s2, 4
    s_lshl3_add_u32 s68, s66, s67
    s_mul_i32 s64, s68, 5120
    s_sub_u32 s65, s64, 4096
    v_lshl_add_u32 v40, v0, 4, s65
    s_add_u32 s64, s64, 3072
    v_lshl_add_u32 v41, v0, 2, s64
    s_waitcnt lgkmcnt(0)
    global_load_dwordx4 v[48:51], v40, s[8:9] nt
    global_load_dword v52, v41, s[8:9] nt
    global_load_dwordx4 v[56:59], v40, s[6:7] nt
    global_load_dword v60, v41, s[6:7] nt
    s_mov_b32 s27, s68
    s_branch L_roled_2
L_mload_1:
    v_lshrrev_b32 v43, 5, v2
    v_lshl_add_u32 v44, s31, 2, v43
    v_and_b32 v46, 31, v2
    v_xor_b32 v46, v46, v44
    v_lshl_add_u32 v43, s31, 3, v43
    v_lshlrev_b32 v43, 9, v43
    v_lshl_add_u32 v46, v46, 4, v43
    v_lshl_add_u32 v44, s67, 14, v46
    s_and_b32 s65, s2, 0xe0
    s_and_b32 s66, s2, 16
    s_lshl2_add_u32 s65, s65, s66
    v_lshl_add_u32 v46, s65, 7, v46
    s_lshl_b32 s66, s31, 11
    s_add_u32 m0, s66, 62464
    s_waitcnt lgkmcnt(0)
    global_load_lds_dwordx4 v46, s[20:21]
    s_add_u32 m0, s66, 21504
    v_xor_b32 v46, 0x420, v46
    global_load_lds_dwordx4 v44, s[18:19]
    s_add_u32 m0, s66, 27648
    v_xor_b32 v45, 0x420, v44
    global_load_lds_dwordx4 v44, s[18:19] offset:2048
    s_add_u32 m0, s66, 63488
    s_lshr_b32 s64, s2, 6
    global_load_lds_dwordx4 v46, s[20:21]
    s_add_u32 m0, s66, 22528
    s_lshl3_add_u32 s64, s64, s67
    global_load_lds_dwordx4 v45, s[18:19]
    s_add_u32 m0, s66, 28672
    s_bfe_u32 s65, s2, 0x20004
    global_load_lds_dwordx4 v45, s[18:19] offset:2048
    s_lshl2_add_u32 s27, s64, s65
L_roled_2:
    s_cmp_lg_u32 s31, 0
    s_cbranch_scc1 L_roled_2_b
    s_load_dword s30, s[28:29], 0
L_roled_2_b:
    v_and_b32 v3, 15, v2
    v_lshrrev_b32 v4, 4, v2
    v_mov_b32 v5, 0
    v_mov_b32 v6, 1
    s_mov_b32 s100, 67108864
    s_bfe_u32 s65, s2, 0x10003
    s_lshl1_add_u32 s64, s67, s65
    s_and_b32 s65, s2, 0xf0
    s_or_b32 s64, s64, s65
    s_cmp_lt_u32 s2, 240
    s_cselect_b32 s1, s64, s2
    v_lshrrev_b32 v42, 2, v3
    v_and_b32 v43, 3, v3
    v_lshl_add_u32 v42, v42, 4, v43
    s_lshl_b32 s64, s31, 1
    v_mov_b32 v43, s64
    v_lshlrev_b32 v44, 1, v43
    v_cmp_gt_u32 vcc, 8, v3
    s_mul_i32 s65, s1, 640
    v_lshlrev_b32 v7, 4, v3
    v_cndmask_b32 v43, v43, v44, vcc
    v_add_lshl_u32 v42, v42, v43, 4
    v_lshl_add_u32 v42, v4, 2, v42
    v_add_u32 v42, s65, v42
    v_min_u32 v42, 159996, v42
    v_lshlrev_b32 v8, 4, v0
    v_and_b32 v8, 0xfff, v8
    global_load_dword v0, v42, s[10:11] nt
    s_barrier
    s_mov_b32 s32, s4
    s_and_b32 s33, s5, 0xffff
    s_mov_b32 s34, 5120000
    s_mov_b32 s35, 0x20000
    s_mov_b32 s36, s14
    s_and_b32 s37, s15, 0xffff
    s_mov_b32 s38, 20000
    s_mov_b32 s39, 0x20000
    s_add_u32 s40, s28, 1048576
    s_addc_u32 s41, s29, 0
    s_and_b32 s41, s41, 0xffff
    s_mov_b32 s42, 2048000
    s_mov_b32 s43, 0x20000
    v_and_b32 v40, 8, v3
    v_lshlrev_b32 v40, 1, v40
    v_mov_b32 v41, 0xffff
    v_lshlrev_b32 v40, v40, v41
    s_mov_b32 s64, 0x0f0f0f0f
    s_mov_b32 s65, 0x0f0f0f0f
    v_cndmask_b32 v12, 0, v40, s[64:65]
    v_xor_b32 v13, v40, v12
    v_and_b32 v14, 3, v3
    v_mul_u32_u24 v14, 0x5555, v14
    s_cmp_lg_u32 s31, 0
    s_cbranch_scc1 L_tagged_3
    s_waitcnt lgkmcnt(0)
    s_mul_i32 s30, s30, 0x9E3779B1
    s_add_u32 s30, s30, 0x7F4A7C15
    v_mov_b32 v40, 1
    v_mov_b32 v41, s30
    ds_write_b64 v5, v[40:41] offset:8
L_tagged_3:
    s_bitcmp1_b32 s2, 3
    s_cbranch_scc0 L_mwork_4
    v_mov_b32 v43, 4
    v_mov_b32 v44, 2031616
    s_mov_b32 s64, 0x3f0001
    v_lshrrev_b32 v40, 6, v8
    v_and_b32 v41, 0x30, v8
    v_lshl_add_u32 v40, v40, 14, v41
    s_lshl_b32 s68, s27, 6
    s_add_u32 s69, s68, 0x100000
    s_add_u32 s70, s68, 8192
    s_add_u32 s71, s69, 8192
    s_mov_b32 s65, 0x203c
    s_waitcnt vmcnt(3)
    v_mul_u32_u24 v64, 52429, v48
    v_lshrrev_b32 v72, 22, v64
    v_lshlrev_b32 v80, 2, v72
    ds_add_rtn_u32 v80, v80, v43 offset:512
    v_mul_u32_u24 v65, 52429, v49
    v_lshrrev_b32 v73, 22, v65
    v_lshlrev_b32 v81, 2, v73
    ds_add_rtn_u32 v81, v81, v43 offset:512
    v_mul_u32_u24 v66, 52429, v50
    v_lshrrev_b32 v74, 22, v66
    v_lshlrev_b32 v82, 2, v74
    ds_add_rtn_u32 v82, v82, v43 offset:512
    v_mul_u32_u24 v67, 52429, v51
    v_lshrrev_b32 v75, 22, v67
    v_lshlrev_b32 v83, 2, v75
    ds_add_rtn_u32 v83, v83, v43 offset:512
    v_mul_u32_u24 v68, 52429, v52
    v_lshrrev_b32 v76, 22, v68
    v_lshlrev_b32 v84, 2, v76
    ds_add_rtn_u32 v84, v84, v43 offset:512
    v_lshrrev_b32 v64, 21, v64
    v_mad_u32_u24 v64, v64, 24, v48
    v_mul_u32_u24 v64, 0x8001, v64
    v_bfe_u32 v88, v72, 1, 2
    v_lshl_or_b32 v72, v72, 2, v88
    v_lshlrev_b32 v72, 4, v72
    v_lshrrev_b32 v65, 21, v65
    v_mad_u32_u24 v65, v65, 24, v49
    v_mul_u32_u24 v65, 0x8001, v65
    v_bfe_u32 v89, v73, 1, 2
    v_lshl_or_b32 v73, v73, 2, v89
    v_lshlrev_b32 v73, 4, v73
    v_lshrrev_b32 v66, 21, v66
    v_mad_u32_u24 v66, v66, 24, v50
    v_mul_u32_u24 v66, 0x8001, v66
    v_bfe_u32 v90, v74, 1, 2
    v_lshl_or_b32 v74, v74, 2, v90
    v_lshlrev_b32 v74, 4, v74
    v_lshrrev_b32 v67, 21, v67
    v_mad_u32_u24 v67, v67, 24, v51
    v_mul_u32_u24 v67, 0x8001, v67
    v_bfe_u32 v91, v75, 1, 2
    v_lshl_or_b32 v75, v75, 2, v91
    v_lshlrev_b32 v75, 4, v75
    v_lshrrev_b32 v68, 21, v68
    v_mad_u32_u24 v68, v68, 24, v52
    v_mul_u32_u24 v68, 0x8001, v68
    v_bfe_u32 v92, v76, 1, 2
    v_lshl_or_b32 v76, v76, 2, v92
    v_lshlrev_b32 v76, 4, v76
    s_waitcnt vmcnt(1)
    v_lshlrev_b32 v56, 1, v56
    v_and_or_b32 v64, v64, s64, v56
    v_lshlrev_b32 v57, 1, v57
    v_and_or_b32 v65, v65, s64, v57
    v_lshlrev_b32 v58, 1, v58
    v_and_or_b32 v66, v66, s64, v58
    v_lshlrev_b32 v59, 1, v59
    v_and_or_b32 v67, v67, s64, v59
    v_lshlrev_b32 v60, 1, v60
    v_and_or_b32 v68, v68, s64, v60
    s_waitcnt lgkmcnt(0)
    v_cmp_gt_u32 vcc, 124, v80
    v_min_u32 v80, 124, v80
    v_lshl_or_b32 v80, v80, 7, v80
    v_cndmask_b32 v64, v44, v64, vcc
    v_bitop3_b32 v80, v80, s65, v72 bitop3:0x6a
    ds_write_b32 v80, v64 offset:41984
    v_cmp_gt_u32 vcc, 124, v81
    v_min_u32 v81, 124, v81
    v_lshl_or_b32 v81, v81, 7, v81
    v_cndmask_b32 v65, v44, v65, vcc
    v_bitop3_b32 v81, v81, s65, v73 bitop3:0x6a
    ds_write_b32 v81, v65 offset:41984
    v_cmp_gt_u32 vcc, 124, v82
    v_min_u32 v82, 124, v82
    v_lshl_or_b32 v82, v82, 7, v82
    v_cndmask_b32 v66, v44, v66, vcc
    v_bitop3_b32 v82, v82, s65, v74 bitop3:0x6a
    ds_write_b32 v82, v66 offset:41984
    v_cmp_gt_u32 vcc, 124, v83
    v_min_u32 v83, 124, v83
    v_lshl_or_b32 v83, v83, 7, v83
    v_cndmask_b32 v67, v44, v67, vcc
    v_bitop3_b32 v83, v83, s65, v75 bitop3:0x6a
    ds_write_b32 v83, v67 offset:41984
    v_cmp_gt_u32 vcc, 124, v84
    v_min_u32 v84, 124, v84
    v_lshl_or_b32 v84, v84, 7, v84
    v_cndmask_b32 v68, v44, v68, vcc
    v_bitop3_b32 v84, v84, s65, v76 bitop3:0x6a
    ds_write_b32 v84, v68 offset:41984
    s_waitcnt lgkmcnt(0)
    s_barrier
    ds_read_b32 v44, v5 offset:12
    ds_read_b128 v[48:51], v8 offset:41984
    ds_read_b128 v[52:55], v8 offset:46080
    ds_read_b128 v[56:59], v8 offset:50176
    ds_read_b128 v[60:63], v8 offset:54272
    s_waitcnt lgkmcnt(4)
    v_readfirstlane_b32 s30, v44
    s_waitcnt vmcnt(0)
    s_and_b32 s44, s30, 0xffc00000
    s_lshl_b32 s45, s30, 10
    s_and_b32 s45, s45, 0xffc00000
    s_lshl_b32 s46, s30, 20
    s_and_b32 s46, s46, 0xffc00000
    s_lshl_b32 s47, s30, 22
    s_waitcnt lgkmcnt(3)
    v_cmp_eq_u32 vcc, 1966080, v51
    v_or_b32 v48, s44, v48
    v_or_b32 v49, s45, v49
    v_or_b32 v50, s46, v50
    v_or_b32 v51, s47, v51
    buffer_store_dwordx4 v[48:51], v40, s[40:43], s68 offen sc1
    s_wqm_b64 s[72:73], vcc
    s_waitcnt lgkmcnt(2)
    v_cmp_eq_u32 vcc, 1966080, v55
    v_or_b32 v52, s44, v52
    v_or_b32 v53, s45, v53
    v_or_b32 v54, s46, v54
    v_or_b32 v55, s47, v55
    buffer_store_dwordx4 v[52:55], v40, s[40:43], s69 offen sc1
    s_wqm_b64 s[74:75], vcc
    s_waitcnt lgkmcnt(1)
    s_not_b64 exec, s[72:73]
    s_cbranch_scc0 L_nosec_8
    v_or_b32 v56, s44, v56
    v_or_b32 v57, s45, v57
    v_or_b32 v58, s46, v58
    v_or_b32 v59, s47, v59
    buffer_store_dwordx4 v[56:59], v40, s[40:43], s70 offen sc1
L_nosec_8:
    s_waitcnt lgkmcnt(0)
    s_not_b64 exec, s[74:75]
    s_cbranch_scc0 L_nosec_9
    v_or_b32 v60, s44, v60
    v_or_b32 v61, s45, v61
    v_or_b32 v62, s46, v62
    v_or_b32 v63, s47, v63
    buffer_store_dwordx4 v[60:63], v40, s[40:43], s71 offen sc1
L_nosec_9:
    s_mov_b64 exec, -1
    s_cmp_ge_u32 s2, 250
    s_cbranch_scc1 L_end
L_worked_5:
    v_lshlrev_b32 v0, 9, v0
    s_setprio 1
    s_lshl_b32 s64, s31, 10
    s_lshr_b32 s10, s1, 1
    s_lshl_b32 s10, s10, 14
    s_add_u32 s11, s10, 4096
    s_add_u32 s12, s10, 8192
    s_add_u32 s13, s10, 12288
    v_cmp_gt_u32 vcc, 0xf40, v8
    s_mov_b64 s[14:15], vcc
    v_add_u32_dpp v9, v0, v7 row_newbcast:0 row_mask:0xf bank_mask:0xf
    s_waitcnt vmcnt(4)
    buffer_load_dwordx4 v[176:179], v9, s[32:35], 0 offen offset:0
    buffer_load_dwordx4 v[180:183], v9, s[32:35], 0 offen offset:256
    v_add_u32_dpp v9, v0, v7 row_newbcast:1 row_mask:0xf bank_mask:0xf
    s_waitcnt vmcnt(4)
    buffer_load_dwordx4 v[184:187], v9, s[32:35], 0 offen offset:0
    buffer_load_dwordx4 v[188:191], v9, s[32:35], 0 offen offset:256
    s_bfe_u32 s65, s2, 0x30003
    s_min_u32 s65, s65, 4
    s_lshl_b32 s65, s65, 12
    s_add_u32 s64, s64, 62464
    s_add_u32 m0, s64, s65
    s_nop 0
    buffer_load_dwordx4 v8, s[36:39], s65 offen lds
    v_add_u32_dpp v9, v0, v7 row_newbcast:2 row_mask:0xf bank_mask:0xf
    s_waitcnt vmcnt(4)
    buffer_load_dwordx4 v[192:195], v9, s[32:35], 0 offen offset:0
    buffer_load_dwordx4 v[196:199], v9, s[32:35], 0 offen offset:256
    s_add_u32 s65, s65, 4096
    s_cmp_eq_u32 s65, 20480
    s_cselect_b32 s65, 0, s65
    s_add_u32 m0, s64, s65
    s_nop 0
    buffer_load_dwordx4 v8, s[36:39], s65 offen lds
    v_add_u32_dpp v9, v0, v7 row_newbcast:3 row_mask:0xf bank_mask:0xf
    s_waitcnt vmcnt(4)
    buffer_load_dwordx4 v[200:203], v9, s[32:35], 0 offen offset:0
    buffer_load_dwordx4 v[204:207], v9, s[32:35], 0 offen offset:256
    v_add_u32_dpp v9, v0, v7 row_newbcast:4 row_mask:0xf bank_mask:0xf
    s_waitcnt vmcnt(4)
    buffer_load_dwordx4 v[208:211], v9, s[32:35], 0 offen offset:0
    buffer_load_dwordx4 v[212:215], v9, s[32:35], 0 offen offset:256
    s_add_u32 s65, s65, 4096
    s_cmp_eq_u32 s65, 20480
    s_cselect_b32 s65, 0, s65
    s_add_u32 m0, s64, s65
    s_nop 0
    buffer_load_dwordx4 v8, s[36:39], s65 offen lds
    v_add_u32_dpp v9, v0, v7 row_newbcast:5 row_mask:0xf bank_mask:0xf
    s_waitcnt vmcnt(4)
    buffer_load_dwordx4 v[216:219], v9, s[32:35], 0 offen offset:0
    buffer_load_dwordx4 v[220:223], v9, s[32:35], 0 offen offset:256
    s_add_u32 s65, s65, 4096
    s_cmp_eq_u32 s65, 20480
    s_cselect_b32 s65, 0, s65
    s_add_u32 m0, s64, s65
    s_nop 0
    buffer_load_dwordx4 v8, s[36:39], s65 offen lds
    v_add_u32_dpp v9, v0, v7 row_newbcast:6 row_mask:0xf bank_mask:0xf
    s_waitcnt vmcnt(4)
    buffer_load_dwordx4 v[224:227], v9, s[32:35], 0 offen offset:0
    buffer_load_dwordx4 v[228:231], v9, s[32:35], 0 offen offset:256
    s_add_u32 s65, s65, 4096
    s_cmp_eq_u32 s65, 20480
    s_cselect_b32 s65, 0, s65
    s_add_u32 m0, s64, s65
    s_nop 0
    buffer_load_dwordx4 v8, s[36:39], s65 offen lds
L_ipoll_10:
    buffer_load_dwordx4 v[48:51], v8, s[40:43], s10 offen sc1
    s_mov_b64 exec, s[14:15]
    buffer_load_dwordx4 v[52:55], v8, s[40:43], s11 offen sc1
    s_mov_b64 exec, -1
L_spin_11:
    ds_read_b128 v[44:47], v5
    s_waitcnt lgkmcnt(0)
    v_readfirstlane_b32 s101, v46
    v_readfirstlane_b32 s30, v47
    s_cmp_ge_u32 s101, 1
    s_cbranch_scc0 L_retry_12
    s_and_b32 s44, s30, 0xffc00000
    s_lshl_b32 s45, s30, 10
    s_and_b32 s45, s45, 0xffc00000
    s_lshl_b32 s46, s30, 20
    s_and_b32 s46, s46, 0xffc00000
    s_lshl_b32 s47, s30, 22
    s_and_b32 s64, s1, 1
    s_lshl_b32 s64, s64, 21
    s_xor_b32 s17, s64, 1966080
    s_or_b32 s44, s44, s64
    v_mov_b32 v68, s17
    s_or_b32 s45, s45, s64
    v_mov_b32 v69, s17
    s_or_b32 s46, s46, s64
    v_mov_b32 v70, s17
    s_or_b32 s47, s47, s64
    v_mov_b32 v71, s17
    s_mov_b32 s16, 1310720
    v_mov_b32 v42, 2
    s_waitcnt vmcnt(1)
    v_xor_b32 v64, s44, v48
    v_xor_b32 v65, s45, v49
    v_xor_b32 v66, s46, v50
    v_xor_b32 v67, s47, v51
    v_or3_b32 v40, v64, v65, v66
    v_or_b32 v40, v40, v67
    v_cmp_eq_u32 s[72:73], s17, v67
    v_cmp_gt_u32 s[48:49], s16, v64
    v_lshlrev_b32_sdwa v80, 2, v64 dst_sel:DWORD dst_unused:UNUSED_PAD src0_sel:DWORD src1_sel:WORD_1
    v_cmp_gt_u32 s[50:51], s16, v65
    v_lshlrev_b32_sdwa v81, 2, v65 dst_sel:DWORD dst_unused:UNUSED_PAD src0_sel:DWORD src1_sel:WORD_1
    v_cmp_gt_u32 s[52:53], s16, v66
    v_lshlrev_b32_sdwa v82, 2, v66 dst_sel:DWORD dst_unused:UNUSED_PAD src0_sel:DWORD src1_sel:WORD_1
    v_cmp_gt_u32 s[54:55], s16, v67
    v_lshlrev_b32_sdwa v83, 2, v67 dst_sel:DWORD dst_unused:UNUSED_PAD src0_sel:DWORD src1_sel:WORD_1
    s_waitcnt vmcnt(0)
    s_mov_b64 exec, s[14:15]
    v_xor_b32 v68, s44, v52
    v_xor_b32 v69, s45, v53
    v_xor_b32 v70, s46, v54
    v_xor_b32 v71, s47, v55
    s_mov_b64 exec, -1
    v_or3_b32 v40, v40, v68, v69
    v_or3_b32 v40, v40, v70, v71
    v_cmp_eq_u32 s[74:75], s17, v71
    v_cmp_le_u32 vcc, 0x400000, v40
    s_cbranch_vccnz L_retry_13
    s_wqm_b64 s[72:73], s[72:73]
    s_not_b64 exec, s[72:73]
    s_cbranch_scc0 L_nosec_14
    buffer_load_dwordx4 v[56:59], v8, s[40:43], s12 offen sc1
L_nosec_14:
    s_wqm_b64 s[74:75], s[74:75]
    s_not_b64 exec, s[74:75]
    s_cbranch_scc0 L_nosec_15
    buffer_load_dwordx4 v[60:63], v8, s[40:43], s13 offen sc1
L_nosec_15:
    s_mov_b64 exec, -1
    v_cmp_gt_u32 s[56:57], s16, v68
    v_lshlrev_b32_sdwa v84, 2, v68 dst_sel:DWORD dst_unused:UNUSED_PAD src0_sel:DWORD src1_sel:WORD_1
    v_cmp_gt_u32 s[58:59], s16, v69
    v_lshlrev_b32_sdwa v85, 2, v69 dst_sel:DWORD dst_unused:UNUSED_PAD src0_sel:DWORD src1_sel:WORD_1
    v_cmp_gt_u32 s[60:61], s16, v70
    v_lshlrev_b32_sdwa v86, 2, v70 dst_sel:DWORD dst_unused:UNUSED_PAD src0_sel:DWORD src1_sel:WORD_1
    v_cmp_gt_u32 s[62:63], s16, v71
    v_lshlrev_b32_sdwa v87, 2, v71 dst_sel:DWORD dst_unused:UNUSED_PAD src0_sel:DWORD src1_sel:WORD_1
    s_mov_b64 exec, s[48:49]
    ds_add_rtn_u32 v80, v80, v42 offset:128
    s_mov_b64 exec, s[50:51]
    ds_add_rtn_u32 v81, v81, v42 offset:128
    s_mov_b64 exec, s[52:53]
    ds_add_rtn_u32 v82, v82, v42 offset:128
    s_mov_b64 exec, s[54:55]
    ds_add_rtn_u32 v83, v83, v42 offset:128
    s_mov_b64 exec, s[56:57]
    ds_add_rtn_u32 v84, v84, v42 offset:128
    s_mov_b64 exec, s[58:59]
    ds_add_rtn_u32 v85, v85, v42 offset:128
    s_mov_b64 exec, s[60:61]
    ds_add_rtn_u32 v86, v86, v42 offset:128
    s_mov_b64 exec, s[62:63]
    ds_add_rtn_u32 v87, v87, v42 offset:128
    s_mov_b64 exec, -1
    v_add_u32_dpp v9, v0, v7 row_newbcast:7 row_mask:0xf bank_mask:0xf
    buffer_load_dwordx4 v[232:235], v9, s[32:35], 0 offen offset:0
    buffer_load_dwordx4 v[236:239], v9, s[32:35], 0 offen offset:256
    v_add_u32_dpp v9, v0, v7 row_newbcast:8 row_mask:0xf bank_mask:0xf
    buffer_load_dwordx4 v[240:243], v9, s[32:35], 0 offen offset:0
    buffer_load_dwordx4 v[244:247], v9, s[32:35], 0 offen offset:256
    s_waitcnt lgkmcnt(4)
    s_mov_b64 exec, s[48:49]
    ds_write_b16 v80, v64
    s_mov_b64 exec, s[50:51]
    ds_write_b16 v81, v65
    s_mov_b64 exec, s[52:53]
    ds_write_b16 v82, v66
    s_mov_b64 exec, s[54:55]
    ds_write_b16 v83, v67
    s_waitcnt lgkmcnt(4)
    s_mov_b64 exec, s[56:57]
    ds_write_b16 v84, v68
    s_mov_b64 exec, s[58:59]
    ds_write_b16 v85, v69
    s_mov_b64 exec, s[60:61]
    ds_write_b16 v86, v70
    s_mov_b64 exec, s[62:63]
    ds_write_b16 v87, v71
    s_not_b64 exec, s[72:73]
    s_cbranch_scc0 L_secdone_17
    s_waitcnt vmcnt(4)
L_sec_16:
    v_xor_b32 v72, s44, v56
    v_xor_b32 v73, s45, v57
    v_xor_b32 v74, s46, v58
    v_xor_b32 v75, s47, v59
    v_or3_b32 v40, v72, v73, v74
    v_or_b32 v40, v40, v75
    v_cmp_le_u32 vcc, 0x400000, v40
    s_cbranch_vccnz L_retry_19
    v_and_b32 v40, 2031616, v75
    v_cmp_eq_u32 vcc, 2031616, v40
    v_cmp_gt_u32 s[64:65], s16, v72
    v_lshlrev_b32_sdwa v88, 2, v72 dst_sel:DWORD dst_unused:UNUSED_PAD src0_sel:DWORD src1_sel:WORD_1
    v_cmp_gt_u32 s[66:67], s16, v73
    v_lshlrev_b32_sdwa v89, 2, v73 dst_sel:DWORD dst_unused:UNUSED_PAD src0_sel:DWORD src1_sel:WORD_1
    v_cmp_gt_u32 s[68:69], s16, v74
    v_lshlrev_b32_sdwa v90, 2, v74 dst_sel:DWORD dst_unused:UNUSED_PAD src0_sel:DWORD src1_sel:WORD_1
    v_cmp_gt_u32 s[70:71], s16, v75
    v_lshlrev_b32_sdwa v91, 2, v75 dst_sel:DWORD dst_unused:UNUSED_PAD src0_sel:DWORD src1_sel:WORD_1
    s_mov_b64 exec, s[64:65]
    ds_add_rtn_u32 v88, v88, v42 offset:128
    s_mov_b64 exec, s[66:67]
    ds_add_rtn_u32 v89, v89, v42 offset:128
    s_mov_b64 exec, s[68:69]
    ds_add_rtn_u32 v90, v90, v42 offset:128
    s_mov_b64 exec, s[70:71]
    ds_add_rtn_u32 v91, v91, v42 offset:128
    s_mov_b64 exec, vcc
    ds_write_b32 v5, v6 offset:20
    s_waitcnt lgkmcnt(0)
    s_mov_b64 exec, s[64:65]
    ds_write_b16 v88, v72
    s_mov_b64 exec, s[66:67]
    ds_write_b16 v89, v73
    s_mov_b64 exec, s[68:69]
    ds_write_b16 v90, v74
    s_mov_b64 exec, s[70:71]
    ds_write_b16 v91, v75
L_secdone_17:
    s_not_b64 exec, s[74:75]
    s_cbranch_scc0 L_secdone_21
    s_waitcnt vmcnt(4)
L_sec_20:
    v_xor_b32 v76, s44, v60
    v_xor_b32 v77, s45, v61
    v_xor_b32 v78, s46, v62
    v_xor_b32 v79, s47, v63
    v_or3_b32 v40, v76, v77, v78
    v_or_b32 v40, v40, v79
    v_cmp_le_u32 vcc, 0x400000, v40
    s_cbranch_vccnz L_retry_23
    v_and_b32 v40, 2031616, v79
    v_cmp_eq_u32 vcc, 2031616, v40
    v_cmp_gt_u32 s[64:65], s16, v76
    v_lshlrev_b32_sdwa v92, 2, v76 dst_sel:DWORD dst_unused:UNUSED_PAD src0_sel:DWORD src1_sel:WORD_1
    v_cmp_gt_u32 s[66:67], s16, v77
    v_lshlrev_b32_sdwa v93, 2, v77 dst_sel:DWORD dst_unused:UNUSED_PAD src0_sel:DWORD src1_sel:WORD_1
    v_cmp_gt_u32 s[68:69], s16, v78
    v_lshlrev_b32_sdwa v94, 2, v78 dst_sel:DWORD dst_unused:UNUSED_PAD src0_sel:DWORD src1_sel:WORD_1
    v_cmp_gt_u32 s[70:71], s16, v79
    v_lshlrev_b32_sdwa v95, 2, v79 dst_sel:DWORD dst_unused:UNUSED_PAD src0_sel:DWORD src1_sel:WORD_1
    s_mov_b64 exec, s[64:65]
    ds_add_rtn_u32 v92, v92, v42 offset:128
    s_mov_b64 exec, s[66:67]
    ds_add_rtn_u32 v93, v93, v42 offset:128
    s_mov_b64 exec, s[68:69]
    ds_add_rtn_u32 v94, v94, v42 offset:128
    s_mov_b64 exec, s[70:71]
    ds_add_rtn_u32 v95, v95, v42 offset:128
    s_mov_b64 exec, vcc
    ds_write_b32 v5, v6 offset:20
    s_waitcnt lgkmcnt(0)
    s_mov_b64 exec, s[64:65]
    ds_write_b16 v92, v76
    s_mov_b64 exec, s[66:67]
    ds_write_b16 v93, v77
    s_mov_b64 exec, s[68:69]
    ds_write_b16 v94, v78
    s_mov_b64 exec, s[70:71]
    ds_write_b16 v95, v79
L_secdone_21:
    s_waitcnt lgkmcnt(0)
    s_mov_b64 exec, 1
    ds_add_u32 v5, v6 offset:16
    s_mov_b64 exec, -1
    v_add_u32_dpp v9, v0, v7 row_newbcast:9 row_mask:0xf bank_mask:0xf
    buffer_load_dwordx4 v[248:251], v9, s[32:35], 0 offen offset:0
    buffer_load_dwordx4 v[252:255], v9, s[32:35], 0 offen offset:256
    s_lshl_b32 s20, s31, 1
    s_add_u32 s21, s20, 1
    s_add_u32 s22, s20, 8
    s_add_u32 s23, s20, 9
    s_add_u32 s24, s31, 16
    v_add_u32 v47, -1, v3
    v_bfe_u32 v40, v47, 1, 1
    v_and_b32 v41, 1, v47
    v_lshl_add_u32 v40, v40, 3, v41
    v_add_u32 v40, s20, v40
    v_mov_b32 v41, s24
    v_cmp_ne_u32 vcc, 0, v3
    v_min_u32 v47, 19, v2
    v_mul_u32_u24 v46, 264, v47
    v_cndmask_b32 v40, v41, v40, vcc
    v_mul_u32_u24 v41, 264, v40
    v_add_u32 v41, 148480, v41
    v_lshlrev_b32 v40, 2, v40
    v_add_u32 v46, 148728, v46
    v_lshlrev_b32 v47, 2, v47
    v_lshlrev_b32 v43, 3, v3
    v_lshl_add_u32 v43, v4, 1, v43
L_spin_24:
    ds_read_b32 v44, v5 offset:16
    s_waitcnt lgkmcnt(0)
    v_readfirstlane_b32 s101, v44
    s_cmp_ge_u32 s101, 4
    s_cbranch_scc0 L_retry_25
    ds_read_b32 v44, v40 offset:128
    ds_read_b32 v47, v47 offset:128
    ds_read_b32 v45, v5 offset:20
    s_waitcnt lgkmcnt(2)
    v_sub_u32 v44, v44, v41
    v_max_u32 v44, 18, v44
    s_waitcnt lgkmcnt(0)
    v_cmp_gt_u32 vcc, v47, v46
    v_add_u32_dpp v48, v44, v44 row_shr:1 row_mask:0xf bank_mask:0xf bound_ctrl:1
    v_readfirstlane_b32 s25, v45
    s_or_b32 s64, vcc_lo, vcc_hi
    v_add_u32_dpp v48, v48, v48 row_shr:2 row_mask:0xf bank_mask:0xf bound_ctrl:1
    s_or_b32 s25, s25, s64
    s_mov_b32 s53, 0
    v_add_u32_dpp v48, v48, v48 row_shr:4 row_mask:0xf bank_mask:0xf bound_ctrl:1
    v_sub_u32 v44, v48, v44
    v_sub_u32 v44, v41, v44
    v_readlane_b32 s10, v48, 0
    v_readlane_b32 s11, v48, 1
    v_readlane_b32 s12, v48, 2
    v_readlane_b32 s13, v48, 3
    v_readlane_b32 s14, v48, 4
    v_add_u32_dpp v160, v44, v43 row_newbcast:0 row_mask:0xf bank_mask:0xf
    v_add_u32_dpp v161, v44, v43 row_newbcast:1 row_mask:0xf bank_mask:0xf
    v_add_u32_dpp v162, v44, v43 row_newbcast:2 row_mask:0xf bank_mask:0xf
    v_add_u32_dpp v163, v44, v43 row_newbcast:3 row_mask:0xf bank_mask:0xf
    v_add_u32_dpp v164, v44, v43 row_newbcast:4 row_mask:0xf bank_mask:0xf
    s_add_u32 s50, s14, 14
    s_lshr_b32 s50, s50, 4
    s_cmp_gt_u32 s50, 32
    s_cselect_b32 s25, 1, s25
    s_max_u32 s50, s50, 12
    v_add_u32 v40, 0, v43
    v_cmp_le_u32 s[64:65], s10, v40
    v_cmp_le_u32 s[66:67], s11, v40
    v_cmp_le_u32 s[68:69], s12, v40
    v_cmp_le_u32 s[70:71], s13, v40
    v_cndmask_b32 v40, v160, v161, s[64:65]
    v_cndmask_b32 v40, v40, v162, s[66:67]
    v_cndmask_b32 v40, v40, v163, s[68:69]
    v_cndmask_b32 v40, v40, v164, s[70:71]
    ds_read_u16 v40, v40 offset:0
    v_add_u32 v41, 128, v43
    v_cmp_le_u32 s[64:65], s10, v41
    v_cmp_le_u32 s[66:67], s11, v41
    v_cmp_le_u32 s[68:69], s12, v41
    v_cmp_le_u32 s[70:71], s13, v41
    v_cndmask_b32 v41, v160, v161, s[64:65]
    v_cndmask_b32 v41, v41, v162, s[66:67]
    v_cndmask_b32 v41, v41, v163, s[68:69]
    v_cndmask_b32 v41, v41, v164, s[70:71]
    ds_read_u16 v41, v41 offset:128
    v_add_u32 v42, 256, v43
    v_cmp_le_u32 s[64:65], s10, v42
    v_cmp_le_u32 s[66:67], s11, v42
    v_cmp_le_u32 s[68:69], s12, v42
    v_cmp_le_u32 s[70:71], s13, v42
    v_cndmask_b32 v42, v160, v161, s[64:65]
    v_cndmask_b32 v42, v42, v162, s[66:67]
    v_cndmask_b32 v42, v42, v163, s[68:69]
    v_cndmask_b32 v42, v42, v164, s[70:71]
    ds_read_u16 v42, v42 offset:256
    v_add_u32 v43, 384, v43
    v_cmp_le_u32 s[64:65], s10, v43
    v_cmp_le_u32 s[66:67], s11, v43
    v_cmp_le_u32 s[68:69], s12, v43
    v_cmp_le_u32 s[70:71], s13, v43
    v_cndmask_b32 v43, v160, v161, s[64:65]
    v_cndmask_b32 v43, v43, v162, s[66:67]
    v_cndmask_b32 v43, v43, v163, s[68:69]
    v_cndmask_b32 v43, v43, v164, s[70:71]
    ds_read_u16 v43, v43 offset:384
    s_waitcnt lgkmcnt(3)
    v_and_b32 v32, 0x7ffe, v40
    ds_read_u16 v33, v32 offset:62464
    v_lshlrev_b32 v32, 8, v32
    v_lshlrev_b32 v40, 4, v40
    s_waitcnt lgkmcnt(3)
    v_and_b32 v34, 0x7ffe, v41
    ds_read_u16 v35, v34 offset:62464
    v_lshlrev_b32 v34, 8, v34
    v_lshlrev_b32 v41, 4, v41
    s_waitcnt lgkmcnt(3)
    v_and_b32 v36, 0x7ffe, v42
    ds_read_u16 v37, v36 offset:62464
    v_lshlrev_b32 v36, 8, v36
    v_lshlrev_b32 v42, 4, v42
    s_waitcnt lgkmcnt(3)
    v_and_b32 v38, 0x7ffe, v43
    ds_read_u16 v39, v38 offset:62464
    v_lshlrev_b32 v38, 8, v38
    v_lshlrev_b32 v43, 4, v43
    v_add_u32_dpp v11, v32, v7 row_newbcast:0 row_mask:0xf bank_mask:0xf
    buffer_load_dwordx4 v[48:51], v11, s[32:35], 0 offen offset:0
    buffer_load_dwordx4 v[56:59], v11, s[32:35], 0 offen offset:256
    v_add_u32_dpp v11, v32, v7 row_newbcast:1 row_mask:0xf bank_mask:0xf
    buffer_load_dwordx4 v[52:55], v11, s[32:35], 0 offen offset:0
    buffer_load_dwordx4 v[60:63], v11, s[32:35], 0 offen offset:256
    v_add_u32_dpp v11, v32, v7 row_newbcast:2 row_mask:0xf bank_mask:0xf
    buffer_load_dwordx4 v[64:67], v11, s[32:35], 0 offen offset:0
    buffer_load_dwordx4 v[72:75], v11, s[32:35], 0 offen offset:256
    v_add_u32_dpp v11, v32, v7 row_newbcast:3 row_mask:0xf bank_mask:0xf
    buffer_load_dwordx4 v[68:71], v11, s[32:35], 0 offen offset:0
    buffer_load_dwordx4 v[76:79], v11, s[32:35], 0 offen offset:256
    v_add_u32_dpp v11, v32, v7 row_newbcast:4 row_mask:0xf bank_mask:0xf
    buffer_load_dwordx4 v[80:83], v11, s[32:35], 0 offen offset:0
    buffer_load_dwordx4 v[88:91], v11, s[32:35], 0 offen offset:256
    v_add_u32_dpp v11, v32, v7 row_newbcast:5 row_mask:0xf bank_mask:0xf
    buffer_load_dwordx4 v[84:87], v11, s[32:35], 0 offen offset:0
    buffer_load_dwordx4 v[92:95], v11, s[32:35], 0 offen offset:256
    s_mov_b32 s57, 0
    s_sub_u32 s64, s14, 18
    s_lshr_b32 s65, s64, 4
    s_bitset1_b32 s53, s65
    s_and_b32 s64, s64, 14
    s_lshl4_add_u32 s57, s57, s64
    s_and_b32 s65, s24, 7
    s_lshl_b32 s65, s65, 5
    s_lshl_b32 s19, s24, 10
    s_or_b32 s19, s19, s65
    s_sub_u32 s64, s13, 18
    s_lshr_b32 s65, s64, 4
    s_bitset1_b32 s53, s65
    s_and_b32 s64, s64, 14
    s_lshl4_add_u32 s57, s57, s64
    s_and_b32 s65, s23, 7
    s_lshl_b32 s65, s65, 5
    s_lshl_b32 s18, s23, 10
    s_or_b32 s18, s18, s65
    s_sub_u32 s64, s12, 18
    s_lshr_b32 s65, s64, 4
    s_bitset1_b32 s53, s65
    s_and_b32 s64, s64, 14
    s_lshl4_add_u32 s57, s57, s64
    s_and_b32 s65, s22, 7
    s_lshl_b32 s65, s65, 5
    s_lshl_b32 s17, s22, 10
    s_or_b32 s17, s17, s65
    s_sub_u32 s64, s11, 18
    s_lshr_b32 s65, s64, 4
    s_bitset1_b32 s53, s65
    s_and_b32 s64, s64, 14
    s_lshl4_add_u32 s57, s57, s64
    s_and_b32 s65, s21, 7
    s_lshl_b32 s65, s65, 5
    s_lshl_b32 s16, s21, 10
    s_or_b32 s16, s16, s65
    s_sub_u32 s64, s10, 18
    s_lshr_b32 s65, s64, 4
    s_bitset1_b32 s53, s65
    s_and_b32 s64, s64, 14
    s_lshl4_add_u32 s57, s57, s64
    s_and_b32 s65, s20, 7
    s_lshl_b32 s65, s65, 5
    s_lshl_b32 s15, s20, 10
    s_or_b32 s15, s15, s65
    s_sub_u32 s64, s50, 5
    s_lshl_b32 s56, 1, s64
    s_or_b32 s52, s56, s53
    v_and_b32 v46, 1, v3
    v_lshl_add_u32 v46, v4, 1, v46
    v_and_b32 v46, 3, v46
    v_and_b32 v47, 14, v3
    v_lshl_add_u32 v46, v46, 4, v47
    v_lshrrev_b32 v47, 1, v4
    v_add_lshl_u32 v46, v46, v47, 2
    v_lshrrev_b32 v44, 1, v4
    v_mul_u32_u24 v44, 528, v44
    v_xor_b32 v44, v44, v7
    v_and_b32 v45, 1, v4
    v_lshl_or_b32 v2, v45, 3, v44
    v_xor_b32 v144, s15, v7
    v_xor_b32 v146, s16, v7
    v_xor_b32 v148, s19, v7
    v_xor_b32 v145, 528, v144
    v_xor_b32 v147, 528, v146
    v_xor_b32 v149, 528, v148
    s_mul_i32 s64, s1, 80
    s_add_u32 s64, s64, 62464
    v_and_b32 v45, 2, v4
    v_add_u32 v0, s64, v45
    s_getpc_b64 s[72:73]
L_anc:
    v_lshlrev_b32 v4, 2, v4
    s_mov_b32 s62, L_fp1-L_anc
    s_mov_b32 s63, L_fp1-L_fp0
    s_mov_b32 s70, L_dr1-L_anc
    s_mov_b32 s71, L_dr1-L_dr0
    s_mov_b32 s26, 0
    s_mov_b32 s49, 0
    v_mov_b32 v1, 0
    s_lshl_b32 s64, s31, 2
    v_mov_b32 v10, s64
    v_and_b32 v9, 8, v3
    v_lshlrev_b32 v9, 1, v9
    s_mov_b32 s66, 0x22222222
    s_mov_b32 s67, 0x22222222
    s_mov_b32 s68, 0x44444444
    s_mov_b32 s69, 0x44444444
    v_mov_b64 v[150:151], 0
    v_mov_b64 v[152:153], 0
    v_mov_b64 v[154:155], 0
    v_mov_b64 v[156:157], 0
    v_mov_b64 v[158:159], 0
    v_mov_b64 v[16:17], 0
    v_mov_b64 v[18:19], 0
    v_mov_b64 v[20:21], 0
    v_mov_b64 v[22:23], 0
    s_waitcnt lgkmcnt(0)
    v_lshlrev_b32 v33, v40, v33
    ds_bpermute_b32 v33, v46, v33
    v_lshlrev_b32 v35, v41, v35
    ds_bpermute_b32 v35, v46, v35
    v_lshlrev_b32 v37, v42, v37
    ds_bpermute_b32 v37, v46, v37
    v_lshlrev_b32 v39, v43, v39
    ds_bpermute_b32 v39, v46, v39
    s_waitcnt vmcnt(12) lgkmcnt(0)
    s_barrier
    ds_read_b128 v[160:163], v144 offset:21504
    ds_read_b128 v[164:167], v144 offset:21760
    ds_read_b128 v[168:171], v145 offset:21504
    ds_read_b128 v[172:175], v145 offset:21760
    s_waitcnt lgkmcnt(2)
    v_dot2c_f32_bf16 v150, v176, v160
    v_dot2c_f32_bf16 v150, v177, v161
    v_dot2c_f32_bf16 v150, v178, v162
    v_dot2c_f32_bf16 v150, v179, v163
    v_dot2c_f32_bf16 v150, v180, v164
    v_dot2c_f32_bf16 v150, v181, v165
    v_dot2c_f32_bf16 v150, v182, v166
    v_dot2c_f32_bf16 v150, v183, v167
    ds_read_b128 v[160:163], v146 offset:21504
    ds_read_b128 v[164:167], v146 offset:21760
    s_waitcnt lgkmcnt(2)
    v_dot2c_f32_bf16 v151, v184, v168
    v_dot2c_f32_bf16 v151, v185, v169
    v_dot2c_f32_bf16 v151, v186, v170
    v_dot2c_f32_bf16 v151, v187, v171
    v_dot2c_f32_bf16 v151, v188, v172
    v_dot2c_f32_bf16 v151, v189, v173
    v_dot2c_f32_bf16 v151, v190, v174
    v_dot2c_f32_bf16 v151, v191, v175
    ds_read_b128 v[168:171], v147 offset:21504
    ds_read_b128 v[172:175], v147 offset:21760
    s_waitcnt lgkmcnt(2)
    v_dot2c_f32_bf16 v152, v192, v160
    v_dot2c_f32_bf16 v152, v193, v161
    v_dot2c_f32_bf16 v152, v194, v162
    v_dot2c_f32_bf16 v152, v195, v163
    v_dot2c_f32_bf16 v152, v196, v164
    v_dot2c_f32_bf16 v152, v197, v165
    v_dot2c_f32_bf16 v152, v198, v166
    v_dot2c_f32_bf16 v152, v199, v167
    v_add_f32_dpp v150, v150, v150 row_ror:8 row_mask:0xf bank_mask:0x3
    v_add_f32_dpp v150, v151, v151 row_ror:8 row_mask:0xf bank_mask:0xc
    ds_read_b128 v[160:163], v144 offset:29696
    ds_read_b128 v[164:167], v144 offset:29952
    s_waitcnt lgkmcnt(2)
    v_dot2c_f32_bf16 v153, v200, v168
    v_dot2c_f32_bf16 v153, v201, v169
    v_dot2c_f32_bf16 v153, v202, v170
    v_dot2c_f32_bf16 v153, v203, v171
    v_dot2c_f32_bf16 v153, v204, v172
    v_dot2c_f32_bf16 v153, v205, v173
    v_dot2c_f32_bf16 v153, v206, v174
    v_dot2c_f32_bf16 v153, v207, v175
    ds_read_b128 v[168:171], v145 offset:29696
    ds_read_b128 v[172:175], v145 offset:29952
    s_waitcnt lgkmcnt(2)
    v_dot2c_f32_bf16 v154, v208, v160
    v_dot2c_f32_bf16 v154, v209, v161
    v_dot2c_f32_bf16 v154, v210, v162
    v_dot2c_f32_bf16 v154, v211, v163
    v_dot2c_f32_bf16 v154, v212, v164
    v_dot2c_f32_bf16 v154, v213, v165
    v_dot2c_f32_bf16 v154, v214, v166
    v_dot2c_f32_bf16 v154, v215, v167
    v_add_f32_dpp v152, v152, v152 row_ror:8 row_mask:0xf bank_mask:0x3
    v_add_f32_dpp v152, v153, v153 row_ror:8 row_mask:0xf bank_mask:0xc
    v_add_u32_dpp v11, v32, v7 row_newbcast:6 row_mask:0xf bank_mask:0xf
    buffer_load_dwordx4 v[96:99], v11, s[32:35], 0 offen offset:0
    buffer_load_dwordx4 v[104:107], v11, s[32:35], 0 offen offset:256
    ds_read_b128 v[160:163], v146 offset:29696
    ds_read_b128 v[164:167], v146 offset:29952
    s_waitcnt lgkmcnt(2)
    v_dot2c_f32_bf16 v155, v216, v168
    v_dot2c_f32_bf16 v155, v217, v169
    v_dot2c_f32_bf16 v155, v218, v170
    v_dot2c_f32_bf16 v155, v219, v171
    v_dot2c_f32_bf16 v155, v220, v172
    v_dot2c_f32_bf16 v155, v221, v173
    v_dot2c_f32_bf16 v155, v222, v174
    v_dot2c_f32_bf16 v155, v223, v175
    v_add_f32_dpp v150, v150, v150 row_half_mirror row_mask:0xf bank_mask:0x5
    v_add_f32_dpp v150, v152, v152 row_half_mirror row_mask:0xf bank_mask:0xa
    v_add_u32_dpp v11, v32, v7 row_newbcast:7 row_mask:0xf bank_mask:0xf
    buffer_load_dwordx4 v[100:103], v11, s[32:35], 0 offen offset:0
    buffer_load_dwordx4 v[108:111], v11, s[32:35], 0 offen offset:256
    ds_read_b128 v[168:171], v147 offset:29696
    ds_read_b128 v[172:175], v147 offset:29952
    s_waitcnt lgkmcnt(2)
    v_dot2c_f32_bf16 v156, v224, v160
    v_dot2c_f32_bf16 v156, v225, v161
    v_dot2c_f32_bf16 v156, v226, v162
    v_dot2c_f32_bf16 v156, v227, v163
    v_dot2c_f32_bf16 v156, v228, v164
    v_dot2c_f32_bf16 v156, v229, v165
    v_dot2c_f32_bf16 v156, v230, v166
    v_dot2c_f32_bf16 v156, v231, v167
    v_add_f32_dpp v154, v154, v154 row_ror:8 row_mask:0xf bank_mask:0x3
    v_add_f32_dpp v154, v155, v155 row_ror:8 row_mask:0xf bank_mask:0xc
    v_add_u32_dpp v11, v32, v7 row_newbcast:8 row_mask:0xf bank_mask:0xf
    buffer_load_dwordx4 v[112:115], v11, s[32:35], 0 offen offset:0
    buffer_load_dwordx4 v[120:123], v11, s[32:35], 0 offen offset:256
    ds_read_b128 v[160:163], v148 offset:21504
    ds_read_b128 v[164:167], v148 offset:21760
    s_waitcnt lgkmcnt(2)
    v_dot2c_f32_bf16 v157, v232, v168
    v_dot2c_f32_bf16 v157, v233, v169
    v_dot2c_f32_bf16 v157, v234, v170
    v_dot2c_f32_bf16 v157, v235, v171
    v_dot2c_f32_bf16 v157, v236, v172
    v_dot2c_f32_bf16 v157, v237, v173
    v_dot2c_f32_bf16 v157, v238, v174
    v_dot2c_f32_bf16 v157, v239, v175
    v_add_u32_dpp v11, v32, v7 row_newbcast:9 row_mask:0xf bank_mask:0xf
    buffer_load_dwordx4 v[116:119], v11, s[32:35], 0 offen offset:0
    buffer_load_dwordx4 v[124:127], v11, s[32:35], 0 offen offset:256
    ds_read_b128 v[168:171], v149 offset:21504
    ds_read_b128 v[172:175], v149 offset:21760
    s_waitcnt lgkmcnt(2)
    v_dot2c_f32_bf16 v158, v240, v160
    v_dot2c_f32_bf16 v158, v241, v161
    v_dot2c_f32_bf16 v158, v242, v162
    v_dot2c_f32_bf16 v158, v243, v163
    v_dot2c_f32_bf16 v158, v244, v164
    v_dot2c_f32_bf16 v158, v245, v165
    v_dot2c_f32_bf16 v158, v246, v166
    v_dot2c_f32_bf16 v158, v247, v167
    v_add_f32_dpp v156, v156, v156 row_ror:8 row_mask:0xf bank_mask:0x3
    v_add_f32_dpp v156, v157, v157 row_ror:8 row_mask:0xf bank_mask:0xc
    v_add_u32_dpp v11, v32, v7 row_newbcast:10 row_mask:0xf bank_mask:0xf
    buffer_load_dwordx4 v[128:131], v11, s[32:35], 0 offen offset:0
    buffer_load_dwordx4 v[136:139], v11, s[32:35], 0 offen offset:256
    s_waitcnt lgkmcnt(0)
    v_dot2c_f32_bf16 v159, v248, v168
    v_dot2c_f32_bf16 v159, v249, v169
    v_dot2c_f32_bf16 v159, v250, v170
    v_dot2c_f32_bf16 v159, v251, v171
    v_dot2c_f32_bf16 v159, v252, v172
    v_dot2c_f32_bf16 v159, v253, v173
    v_dot2c_f32_bf16 v159, v254, v174
    v_dot2c_f32_bf16 v159, v255, v175
    v_add_f32_dpp v154, v154, v154 row_half_mirror row_mask:0xf bank_mask:0x5
    v_add_f32_dpp v154, v156, v156 row_half_mirror row_mask:0xf bank_mask:0xa
    v_add_u32_dpp v11, v32, v7 row_newbcast:11 row_mask:0xf bank_mask:0xf
    buffer_load_dwordx4 v[132:135], v11, s[32:35], 0 offen offset:0
    buffer_load_dwordx4 v[140:143], v11, s[32:35], 0 offen offset:256
    v_add_f32_dpp v150, v150, v150 quad_perm:[1,0,3,2] row_mask:0xf bank_mask:0xf
    s_nop 0
    v_add_f32_dpp v158, v158, v158 row_ror:8 row_mask:0xf bank_mask:0x3
    v_add_f32_dpp v158, v159, v159 row_ror:8 row_mask:0xf bank_mask:0xc
    v_add_f32_dpp v154, v154, v154 quad_perm:[1,0,3,2] row_mask:0xf bank_mask:0xf
    v_add_f32_dpp v150, v150, v150 quad_perm:[2,3,0,1] row_mask:0xf bank_mask:0xf
    v_add_f32_dpp v158, v158, v158 row_half_mirror row_mask:0xf bank_mask:0x5
    v_add_f32_dpp v154, v154, v154 quad_perm:[2,3,0,1] row_mask:0xf bank_mask:0xf
    s_nop 0
    v_add_f32_dpp v158, v158, v158 quad_perm:[1,0,3,2] row_mask:0xf bank_mask:0xf
    v_cndmask_b32 v150, v150, v154, s[66:67]
    s_nop 0
    v_add_f32_dpp v158, v158, v158 quad_perm:[2,3,0,1] row_mask:0xf bank_mask:0xf
    v_cndmask_b32 v150, v150, v158, s[68:69]
    v_mul_f32 v150, 0x3db8aa3b, v150
    v_exp_f32 v150, v150
    s_nop 0
    v_mov_b32 v44, v150
    v_mov_b32 v45, v150
    s_nop 1
    v_permlane32_swap_b32 v44, v45
    v_add_f32 v44, v44, v45
    v_mov_b32 v45, v44
    s_nop 1
    v_permlane16_swap_b32 v44, v45
    v_add_f32 v44, v44, v45
    v_add_f32 v44, 0x3089705f, v44
    v_rcp_f32 v44, v44
    s_nop 0
    v_mul_f32 v150, v150, v44
    v_cvt_pk_bf16_f32 v150, v150, 0
    v_lshlrev_b32 v8, v9, v150
    s_nop 1
    v_and_b32_dpp v24, v8, v12 row_newbcast:0 row_mask:0xf bank_mask:0xf
    v_and_b32_dpp v25, v8, v13 row_newbcast:0 row_mask:0xf bank_mask:0xf
    v_mov_b64 v[40:41], 0
    v_mov_b64 v[42:43], 0
    v_mov_b64 v[44:45], 0
    v_mov_b64 v[46:47], 0
    v_smfmac_f32_16x16x32_bf16 v[40:43], v[24:25], v[176:179], v14
    v_and_b32_dpp v28, v8, v12 row_newbcast:8 row_mask:0xf bank_mask:0xf
    v_and_b32_dpp v29, v8, v13 row_newbcast:8 row_mask:0xf bank_mask:0xf
    v_smfmac_f32_16x16x32_bf16 v[44:47], v[24:25], v[180:183], v14
    v_add_u32_dpp v11, v32, v7 row_newbcast:12 row_mask:0xf bank_mask:0xf
    buffer_load_dwordx4 v[144:147], v11, s[32:35], 0 offen offset:0
    buffer_load_dwordx4 v[152:155], v11, s[32:35], 0 offen offset:256
    v_smfmac_f32_16x16x32_bf16 v[40:43], v[28:29], v[184:187], v14
    v_and_b32_dpp v24, v8, v12 row_newbcast:4 row_mask:0xf bank_mask:0xf
    v_and_b32_dpp v25, v8, v13 row_newbcast:4 row_mask:0xf bank_mask:0xf
    v_smfmac_f32_16x16x32_bf16 v[44:47], v[28:29], v[188:191], v14
    s_nop 0
    v_smfmac_f32_16x16x32_bf16 v[16:19], v[24:25], v[192:195], v14
    v_and_b32_dpp v28, v8, v12 row_newbcast:12 row_mask:0xf bank_mask:0xf
    v_and_b32_dpp v29, v8, v13 row_newbcast:12 row_mask:0xf bank_mask:0xf
    v_smfmac_f32_16x16x32_bf16 v[20:23], v[24:25], v[196:199], v14
    v_add_u32_dpp v11, v32, v7 row_newbcast:13 row_mask:0xf bank_mask:0xf
    buffer_load_dwordx4 v[148:151], v11, s[32:35], 0 offen offset:0
    buffer_load_dwordx4 v[156:159], v11, s[32:35], 0 offen offset:256
    v_smfmac_f32_16x16x32_bf16 v[16:19], v[28:29], v[200:203], v14
    v_and_b32_dpp v24, v8, v12 row_newbcast:1 row_mask:0xf bank_mask:0xf
    v_and_b32_dpp v25, v8, v13 row_newbcast:1 row_mask:0xf bank_mask:0xf
    v_smfmac_f32_16x16x32_bf16 v[20:23], v[28:29], v[204:207], v14
    v_xor_b32 v178, s15, v2
    s_lshl_b32 s64, s20, 2
    v_add_u32 v9, s64, v0
    v_mov_b32 v179, 0
    v_cvt_pk_bf16_f32 v30, v40, v41
    v_cvt_pk_bf16_f32 v31, v42, v43
    ds_write_b64 v178, v[30:31] offset:1024
    v_cvt_pk_bf16_f32 v30, v44, v45
    v_cvt_pk_bf16_f32 v31, v46, v47
    ds_write_b64 v178, v[30:31] offset:1280
    ds_read_u16_d16_hi v179, v9
    v_mov_b64 v[40:41], 0
    v_mov_b64 v[42:43], 0
    v_mov_b64 v[44:45], 0
    v_mov_b64 v[46:47], 0
    s_nop 0
    v_smfmac_f32_16x16x32_bf16 v[40:43], v[24:25], v[208:211], v14
    v_and_b32_dpp v28, v8, v12 row_newbcast:9 row_mask:0xf bank_mask:0xf
    v_and_b32_dpp v29, v8, v13 row_newbcast:9 row_mask:0xf bank_mask:0xf
    v_smfmac_f32_16x16x32_bf16 v[44:47], v[24:25], v[212:215], v14
    v_add_u32_dpp v11, v32, v7 row_newbcast:14 row_mask:0xf bank_mask:0xf
    buffer_load_dwordx4 v[160:163], v11, s[32:35], 0 offen offset:0
    buffer_load_dwordx4 v[168:171], v11, s[32:35], 0 offen offset:256
    v_smfmac_f32_16x16x32_bf16 v[40:43], v[28:29], v[216:219], v14
    v_and_b32_dpp v24, v8, v12 row_newbcast:5 row_mask:0xf bank_mask:0xf
    v_and_b32_dpp v25, v8, v13 row_newbcast:5 row_mask:0xf bank_mask:0xf
    v_smfmac_f32_16x16x32_bf16 v[44:47], v[28:29], v[220:223], v14
    v_xor_b32 v180, s16, v2
    s_lshl_b32 s64, s21, 2
    v_add_u32 v9, s64, v0
    v_mov_b32 v181, 0
    v_cvt_pk_bf16_f32 v30, v16, v17
    v_cvt_pk_bf16_f32 v31, v18, v19
    ds_write_b64 v180, v[30:31] offset:1024
    v_cvt_pk_bf16_f32 v30, v20, v21
    v_cvt_pk_bf16_f32 v31, v22, v23
    ds_write_b64 v180, v[30:31] offset:1280
    ds_read_u16_d16_hi v181, v9
    v_mov_b64 v[16:17], 0
    v_mov_b64 v[18:19], 0
    v_mov_b64 v[20:21], 0
    v_mov_b64 v[22:23], 0
    s_nop 0
    v_smfmac_f32_16x16x32_bf16 v[16:19], v[24:25], v[224:227], v14
    v_and_b32_dpp v28, v8, v12 row_newbcast:13 row_mask:0xf bank_mask:0xf
    v_and_b32_dpp v29, v8, v13 row_newbcast:13 row_mask:0xf bank_mask:0xf
    v_smfmac_f32_16x16x32_bf16 v[20:23], v[24:25], v[228:231], v14
    v_add_u32_dpp v11, v32, v7 row_newbcast:15 row_mask:0xf bank_mask:0xf
    buffer_load_dwordx4 v[164:167], v11, s[32:35], 0 offen offset:0
    buffer_load_dwordx4 v[172:175], v11, s[32:35], 0 offen offset:256
    v_smfmac_f32_16x16x32_bf16 v[16:19], v[28:29], v[232:235], v14
    v_and_b32_dpp v24, v8, v12 row_newbcast:2 row_mask:0xf bank_mask:0xf
    v_and_b32_dpp v25, v8, v13 row_newbcast:2 row_mask:0xf bank_mask:0xf
    v_smfmac_f32_16x16x32_bf16 v[20:23], v[28:29], v[236:239], v14
    v_xor_b32 v182, s17, v2
    s_lshl_b32 s64, s22, 2
    v_add_u32 v9, s64, v0
    v_mov_b32 v183, 0
    v_cvt_pk_bf16_f32 v30, v40, v41
    v_cvt_pk_bf16_f32 v31, v42, v43
    ds_write_b64 v182, v[30:31] offset:1024
    v_cvt_pk_bf16_f32 v30, v44, v45
    v_cvt_pk_bf16_f32 v31, v46, v47
    ds_write_b64 v182, v[30:31] offset:1280
    ds_read_u16_d16_hi v183, v9
    v_mov_b64 v[40:41], 0
    v_mov_b64 v[42:43], 0
    v_mov_b64 v[44:45], 0
    v_mov_b64 v[46:47], 0
    s_nop 0
    v_smfmac_f32_16x16x32_bf16 v[40:43], v[24:25], v[240:243], v14
    v_and_b32_dpp v28, v8, v12 row_newbcast:10 row_mask:0xf bank_mask:0xf
    v_and_b32_dpp v29, v8, v13 row_newbcast:10 row_mask:0xf bank_mask:0xf
    v_smfmac_f32_16x16x32_bf16 v[44:47], v[24:25], v[244:247], v14
    s_nop 0
    v_smfmac_f32_16x16x32_bf16 v[40:43], v[28:29], v[248:251], v14
    v_and_b32_dpp v24, v33, v12 row_newbcast:0 row_mask:0xf bank_mask:0xf
    v_and_b32_dpp v25, v33, v13 row_newbcast:0 row_mask:0xf bank_mask:0xf
    v_and_b32_dpp v26, v33, v12 row_newbcast:1 row_mask:0xf bank_mask:0xf
    v_and_b32_dpp v27, v33, v13 row_newbcast:1 row_mask:0xf bank_mask:0xf
    v_smfmac_f32_16x16x32_bf16 v[44:47], v[28:29], v[252:255], v14
    v_xor_b32 v184, s18, v2
    s_lshl_b32 s64, s23, 2
    v_add_u32 v9, s64, v0
    v_mov_b32 v185, 0
    v_cvt_pk_bf16_f32 v30, v16, v17
    v_cvt_pk_bf16_f32 v31, v18, v19
    ds_write_b64 v184, v[30:31] offset:1024
    v_cvt_pk_bf16_f32 v30, v20, v21
    v_cvt_pk_bf16_f32 v31, v22, v23
    ds_write_b64 v184, v[30:31] offset:1280
    ds_read_u16_d16_hi v185, v9
    v_mov_b64 v[16:17], 0
    v_mov_b64 v[18:19], 0
    v_mov_b64 v[20:21], 0
    v_mov_b64 v[22:23], 0
    s_nop 0
    v_xor_b32 v176, s19, v2
    s_lshl_b32 s64, s24, 2
    v_add_u32 v9, s64, v0
    v_mov_b32 v177, 0
    v_cvt_pk_bf16_f32 v30, v40, v41
    v_cvt_pk_bf16_f32 v31, v42, v43
    ds_write_b64 v176, v[30:31] offset:1024
    v_cvt_pk_bf16_f32 v30, v44, v45
    v_cvt_pk_bf16_f32 v31, v46, v47
    ds_write_b64 v176, v[30:31] offset:1280
    ds_read_u16_d16_hi v177, v9
    s_waitcnt lgkmcnt(0)
    s_barrier
    s_cmp_lg_u32 s25, 0
    s_cbranch_scc1 L_slow
L_fp0:
    s_bitcmp1_b32 s52, 0
    s_waitcnt vmcnt(28)
    v_smfmac_f32_16x16x64_bf16 v[16:19], v[24:27], v[48:55], v14
    v_and_b32_dpp v28, v33, v12 row_newbcast:2 row_mask:0xf bank_mask:0xf
    v_and_b32_dpp v29, v33, v13 row_newbcast:2 row_mask:0xf bank_mask:0xf
    v_smfmac_f32_16x16x64_bf16 v[20:23], v[24:27], v[56:63], v14
    v_and_b32_dpp v30, v33, v12 row_newbcast:3 row_mask:0xf bank_mask:0xf
    v_and_b32_dpp v31, v33, v13 row_newbcast:3 row_mask:0xf bank_mask:0xf
    v_add_u32_dpp v11, v34, v7 row_newbcast:0 row_mask:0xf bank_mask:0xf
    buffer_load_dwordx4 v[48:51], v11, s[32:35], 0 offen offset:0
    buffer_load_dwordx4 v[56:59], v11, s[32:35], 0 offen offset:256
    s_cbranch_scc1 L_ev0
L_fp1:
    s_bitcmp1_b32 s52, 1
    s_waitcnt vmcnt(26)
    v_smfmac_f32_16x16x64_bf16 v[16:19], v[28:31], v[64:71], v14
    v_and_b32_dpp v24, v33, v12 row_newbcast:4 row_mask:0xf bank_mask:0xf
    v_and_b32_dpp v25, v33, v13 row_newbcast:4 row_mask:0xf bank_mask:0xf
    v_smfmac_f32_16x16x64_bf16 v[20:23], v[28:31], v[72:79], v14
    v_and_b32_dpp v26, v33, v12 row_newbcast:5 row_mask:0xf bank_mask:0xf
    v_and_b32_dpp v27, v33, v13 row_newbcast:5 row_mask:0xf bank_mask:0xf
    v_add_u32_dpp v11, v34, v7 row_newbcast:1 row_mask:0xf bank_mask:0xf
    buffer_load_dwordx4 v[52:55], v11, s[32:35], 0 offen offset:0
    buffer_load_dwordx4 v[60:63], v11, s[32:35], 0 offen offset:256
    s_cbranch_scc1 L_ev1
L_fp2:
    s_bitcmp1_b32 s52, 2
    s_waitcnt vmcnt(24)
    v_smfmac_f32_16x16x64_bf16 v[16:19], v[24:27], v[80:87], v14
    v_and_b32_dpp v28, v33, v12 row_newbcast:6 row_mask:0xf bank_mask:0xf
    v_and_b32_dpp v29, v33, v13 row_newbcast:6 row_mask:0xf bank_mask:0xf
    v_smfmac_f32_16x16x64_bf16 v[20:23], v[24:27], v[88:95], v14
    v_and_b32_dpp v30, v33, v12 row_newbcast:7 row_mask:0xf bank_mask:0xf
    v_and_b32_dpp v31, v33, v13 row_newbcast:7 row_mask:0xf bank_mask:0xf
    v_add_u32_dpp v11, v34, v7 row_newbcast:2 row_mask:0xf bank_mask:0xf
    buffer_load_dwordx4 v[64:67], v11, s[32:35], 0 offen offset:0
    buffer_load_dwordx4 v[72:75], v11, s[32:35], 0 offen offset:256
    s_cbranch_scc1 L_ev2
L_fp3:
    s_bitcmp1_b32 s52, 3
    s_waitcnt vmcnt(22)
    v_smfmac_f32_16x16x64_bf16 v[16:19], v[28:31], v[96:103], v14
    v_and_b32_dpp v24, v33, v12 row_newbcast:8 row_mask:0xf bank_mask:0xf
    v_and_b32_dpp v25, v33, v13 row_newbcast:8 row_mask:0xf bank_mask:0xf
    v_smfmac_f32_16x16x64_bf16 v[20:23], v[28:31], v[104:111], v14
    v_and_b32_dpp v26, v33, v12 row_newbcast:9 row_mask:0xf bank_mask:0xf
    v_and_b32_dpp v27, v33, v13 row_newbcast:9 row_mask:0xf bank_mask:0xf
    v_add_u32_dpp v11, v34, v7 row_newbcast:3 row_mask:0xf bank_mask:0xf
    buffer_load_dwordx4 v[68:71], v11, s[32:35], 0 offen offset:0
    buffer_load_dwordx4 v[76:79], v11, s[32:35], 0 offen offset:256
    s_cbranch_scc1 L_ev3
L_fp4:
    s_bitcmp1_b32 s52, 4
    s_waitcnt vmcnt(20)
    v_smfmac_f32_16x16x64_bf16 v[16:19], v[24:27], v[112:119], v14
    v_and_b32_dpp v28, v33, v12 row_newbcast:10 row_mask:0xf bank_mask:0xf
    v_and_b32_dpp v29, v33, v13 row_newbcast:10 row_mask:0xf bank_mask:0xf
    v_smfmac_f32_16x16x64_bf16 v[20:23], v[24:27], v[120:127], v14
    v_and_b32_dpp v30, v33, v12 row_newbcast:11 row_mask:0xf bank_mask:0xf
    v_and_b32_dpp v31, v33, v13 row_newbcast:11 row_mask:0xf bank_mask:0xf
    v_add_u32_dpp v11, v34, v7 row_newbcast:4 row_mask:0xf bank_mask:0xf
    buffer_load_dwordx4 v[80:83], v11, s[32:35], 0 offen offset:0
    buffer_load_dwordx4 v[88:91], v11, s[32:35], 0 offen offset:256
    s_cbranch_scc1 L_ev4
L_fp5:
    s_bitcmp1_b32 s52, 5
    s_waitcnt vmcnt(18)
    v_smfmac_f32_16x16x64_bf16 v[16:19], v[28:31], v[128:135], v14
    v_and_b32_dpp v24, v33, v12 row_newbcast:12 row_mask:0xf bank_mask:0xf
    v_and_b32_dpp v25, v33, v13 row_newbcast:12 row_mask:0xf bank_mask:0xf
    v_smfmac_f32_16x16x64_bf16 v[20:23], v[28:31], v[136:143], v14
    v_and_b32_dpp v26, v33, v12 row_newbcast:13 row_mask:0xf bank_mask:0xf
    v_and_b32_dpp v27, v33, v13 row_newbcast:13 row_mask:0xf bank_mask:0xf
    v_add_u32_dpp v11, v34, v7 row_newbcast:5 row_mask:0xf bank_mask:0xf
    buffer_load_dwordx4 v[84:87], v11, s[32:35], 0 offen offset:0
    buffer_load_dwordx4 v[92:95], v11, s[32:35], 0 offen offset:256
    s_cbranch_scc1 L_ev5
L_fp6:
    s_bitcmp1_b32 s52, 6
    s_waitcnt vmcnt(16)
    v_smfmac_f32_16x16x64_bf16 v[16:19], v[24:27], v[144:151], v14
    v_and_b32_dpp v28, v33, v12 row_newbcast:14 row_mask:0xf bank_mask:0xf
    v_and_b32_dpp v29, v33, v13 row_newbcast:14 row_mask:0xf bank_mask:0xf
    v_smfmac_f32_16x16x64_bf16 v[20:23], v[24:27], v[152:159], v14
    v_and_b32_dpp v30, v33, v12 row_newbcast:15 row_mask:0xf bank_mask:0xf
    v_and_b32_dpp v31, v33, v13 row_newbcast:15 row_mask:0xf bank_mask:0xf
    v_add_u32_dpp v11, v34, v7 row_newbcast:6 row_mask:0xf bank_mask:0xf
    buffer_load_dwordx4 v[96:99], v11, s[32:35], 0 offen offset:0
    buffer_load_dwordx4 v[104:107], v11, s[32:35], 0 offen offset:256
    s_cbranch_scc1 L_ev6
L_fp7:
    s_bitcmp1_b32 s52, 7
    s_waitcnt vmcnt(14)
    v_smfmac_f32_16x16x64_bf16 v[16:19], v[28:31], v[160:167], v14
    v_and_b32_dpp v24, v35, v12 row_newbcast:0 row_mask:0xf bank_mask:0xf
    v_and_b32_dpp v25, v35, v13 row_newbcast:0 row_mask:0xf bank_mask:0xf
    v_smfmac_f32_16x16x64_bf16 v[20:23], v[28:31], v[168:175], v14
    v_and_b32_dpp v26, v35, v12 row_newbcast:1 row_mask:0xf bank_mask:0xf
    v_and_b32_dpp v27, v35, v13 row_newbcast:1 row_mask:0xf bank_mask:0xf
    v_add_u32_dpp v11, v34, v7 row_newbcast:7 row_mask:0xf bank_mask:0xf
    buffer_load_dwordx4 v[100:103], v11, s[32:35], 0 offen offset:0
    buffer_load_dwordx4 v[108:111], v11, s[32:35], 0 offen offset:256
    s_cbranch_scc1 L_ev7
L_fp8:
    v_mov_b64 v[32:33], v[34:35]
    v_mov_b64 v[34:35], v[36:37]
    v_mov_b64 v[36:37], v[38:39]
    s_lshr_b32 s52, s52, 8
    s_lshr_b32 s53, s53, 8
    s_lshr_b32 s56, s56, 8
    s_mov_b32 s62, L_st1-L_anc
    s_mov_b32 s63, L_st1-L_st0
L_st0:
    s_bitcmp1_b32 s52, 0
    s_waitcnt vmcnt(12)
    v_smfmac_f32_16x16x64_bf16 v[16:19], v[24:27], v[48:55], v14
    v_and_b32_dpp v28, v33, v12 row_newbcast:2 row_mask:0xf bank_mask:0xf
    v_and_b32_dpp v29, v33, v13 row_newbcast:2 row_mask:0xf bank_mask:0xf
    v_smfmac_f32_16x16x64_bf16 v[20:23], v[24:27], v[56:63], v14
    v_and_b32_dpp v30, v33, v12 row_newbcast:3 row_mask:0xf bank_mask:0xf
    v_and_b32_dpp v31, v33, v13 row_newbcast:3 row_mask:0xf bank_mask:0xf
    v_add_u32_dpp v11, v32, v7 row_newbcast:8 row_mask:0xf bank_mask:0xf
    buffer_load_dwordx4 v[112:115], v11, s[32:35], 0 offen offset:0
    buffer_load_dwordx4 v[120:123], v11, s[32:35], 0 offen offset:256
    v_add_u32_dpp v11, v32, v7 row_newbcast:9 row_mask:0xf bank_mask:0xf
    buffer_load_dwordx4 v[116:119], v11, s[32:35], 0 offen offset:0
    buffer_load_dwordx4 v[124:127], v11, s[32:35], 0 offen offset:256
    s_cbranch_scc1 L_ev0
L_st1:
    s_bitcmp1_b32 s52, 1
    s_waitcnt vmcnt(12)
    v_smfmac_f32_16x16x64_bf16 v[16:19], v[28:31], v[64:71], v14
    v_and_b32_dpp v24, v33, v12 row_newbcast:4 row_mask:0xf bank_mask:0xf
    v_and_b32_dpp v25, v33, v13 row_newbcast:4 row_mask:0xf bank_mask:0xf
    v_smfmac_f32_16x16x64_bf16 v[20:23], v[28:31], v[72:79], v14
    v_and_b32_dpp v26, v33, v12 row_newbcast:5 row_mask:0xf bank_mask:0xf
    v_and_b32_dpp v27, v33, v13 row_newbcast:5 row_mask:0xf bank_mask:0xf
    v_add_u32_dpp v11, v32, v7 row_newbcast:10 row_mask:0xf bank_mask:0xf
    buffer_load_dwordx4 v[128:131], v11, s[32:35], 0 offen offset:0
    buffer_load_dwordx4 v[136:139], v11, s[32:35], 0 offen offset:256
    v_add_u32_dpp v11, v32, v7 row_newbcast:11 row_mask:0xf bank_mask:0xf
    buffer_load_dwordx4 v[132:135], v11, s[32:35], 0 offen offset:0
    buffer_load_dwordx4 v[140:143], v11, s[32:35], 0 offen offset:256
    s_cbranch_scc1 L_ev1
L_st2:
    s_bitcmp1_b32 s52, 2
    s_waitcnt vmcnt(12)
    v_smfmac_f32_16x16x64_bf16 v[16:19], v[24:27], v[80:87], v14
    v_and_b32_dpp v28, v33, v12 row_newbcast:6 row_mask:0xf bank_mask:0xf
    v_and_b32_dpp v29, v33, v13 row_newbcast:6 row_mask:0xf bank_mask:0xf
    v_smfmac_f32_16x16x64_bf16 v[20:23], v[24:27], v[88:95], v14
    v_and_b32_dpp v30, v33, v12 row_newbcast:7 row_mask:0xf bank_mask:0xf
    v_and_b32_dpp v31, v33, v13 row_newbcast:7 row_mask:0xf bank_mask:0xf
    v_add_u32_dpp v11, v32, v7 row_newbcast:12 row_mask:0xf bank_mask:0xf
    buffer_load_dwordx4 v[144:147], v11, s[32:35], 0 offen offset:0
    buffer_load_dwordx4 v[152:155], v11, s[32:35], 0 offen offset:256
    v_add_u32_dpp v11, v32, v7 row_newbcast:13 row_mask:0xf bank_mask:0xf
    buffer_load_dwordx4 v[148:151], v11, s[32:35], 0 offen offset:0
    buffer_load_dwordx4 v[156:159], v11, s[32:35], 0 offen offset:256
    s_cbranch_scc1 L_ev2
L_st3:
    s_bitcmp1_b32 s52, 3
    s_waitcnt vmcnt(12)
    v_smfmac_f32_16x16x64_bf16 v[16:19], v[28:31], v[96:103], v14
    v_and_b32_dpp v24, v33, v12 row_newbcast:8 row_mask:0xf bank_mask:0xf
    v_and_b32_dpp v25, v33, v13 row_newbcast:8 row_mask:0xf bank_mask:0xf
    v_smfmac_f32_16x16x64_bf16 v[20:23], v[28:31], v[104:111], v14
    v_and_b32_dpp v26, v33, v12 row_newbcast:9 row_mask:0xf bank_mask:0xf
    v_and_b32_dpp v27, v33, v13 row_newbcast:9 row_mask:0xf bank_mask:0xf
    v_add_u32_dpp v11, v32, v7 row_newbcast:14 row_mask:0xf bank_mask:0xf
    buffer_load_dwordx4 v[160:163], v11, s[32:35], 0 offen offset:0
    buffer_load_dwordx4 v[168:171], v11, s[32:35], 0 offen offset:256
    v_add_u32_dpp v11, v32, v7 row_newbcast:15 row_mask:0xf bank_mask:0xf
    buffer_load_dwordx4 v[164:167], v11, s[32:35], 0 offen offset:0
    buffer_load_dwordx4 v[172:175], v11, s[32:35], 0 offen offset:256
    s_cbranch_scc1 L_ev3
L_st4:
    s_bitcmp1_b32 s52, 4
    s_waitcnt vmcnt(12)
    v_smfmac_f32_16x16x64_bf16 v[16:19], v[24:27], v[112:119], v14
    v_and_b32_dpp v28, v33, v12 row_newbcast:10 row_mask:0xf bank_mask:0xf
    v_and_b32_dpp v29, v33, v13 row_newbcast:10 row_mask:0xf bank_mask:0xf
    v_smfmac_f32_16x16x64_bf16 v[20:23], v[24:27], v[120:127], v14
    v_and_b32_dpp v30, v33, v12 row_newbcast:11 row_mask:0xf bank_mask:0xf
    v_and_b32_dpp v31, v33, v13 row_newbcast:11 row_mask:0xf bank_mask:0xf
    v_add_u32_dpp v11, v34, v7 row_newbcast:0 row_mask:0xf bank_mask:0xf
    buffer_load_dwordx4 v[48:51], v11, s[32:35], 0 offen offset:0
    buffer_load_dwordx4 v[56:59], v11, s[32:35], 0 offen offset:256
    v_add_u32_dpp v11, v34, v7 row_newbcast:1 row_mask:0xf bank_mask:0xf
    buffer_load_dwordx4 v[52:55], v11, s[32:35], 0 offen offset:0
    buffer_load_dwordx4 v[60:63], v11, s[32:35], 0 offen offset:256
    s_cbranch_scc1 L_ev4
L_st5:
    s_bitcmp1_b32 s52, 5
    s_waitcnt vmcnt(12)
    v_smfmac_f32_16x16x64_bf16 v[16:19], v[28:31], v[128:135], v14
    v_and_b32_dpp v24, v33, v12 row_newbcast:12 row_mask:0xf bank_mask:0xf
    v_and_b32_dpp v25, v33, v13 row_newbcast:12 row_mask:0xf bank_mask:0xf
    v_smfmac_f32_16x16x64_bf16 v[20:23], v[28:31], v[136:143], v14
    v_and_b32_dpp v26, v33, v12 row_newbcast:13 row_mask:0xf bank_mask:0xf
    v_and_b32_dpp v27, v33, v13 row_newbcast:13 row_mask:0xf bank_mask:0xf
    v_add_u32_dpp v11, v34, v7 row_newbcast:2 row_mask:0xf bank_mask:0xf
    buffer_load_dwordx4 v[64:67], v11, s[32:35], 0 offen offset:0
    buffer_load_dwordx4 v[72:75], v11, s[32:35], 0 offen offset:256
    v_add_u32_dpp v11, v34, v7 row_newbcast:3 row_mask:0xf bank_mask:0xf
    buffer_load_dwordx4 v[68:71], v11, s[32:35], 0 offen offset:0
    buffer_load_dwordx4 v[76:79], v11, s[32:35], 0 offen offset:256
    s_cbranch_scc1 L_ev5
L_st6:
    s_bitcmp1_b32 s52, 6
    s_waitcnt vmcnt(12)
    v_smfmac_f32_16x16x64_bf16 v[16:19], v[24:27], v[144:151], v14
    v_and_b32_dpp v28, v33, v12 row_newbcast:14 row_mask:0xf bank_mask:0xf
    v_and_b32_dpp v29, v33, v13 row_newbcast:14 row_mask:0xf bank_mask:0xf
    v_smfmac_f32_16x16x64_bf16 v[20:23], v[24:27], v[152:159], v14
    v_and_b32_dpp v30, v33, v12 row_newbcast:15 row_mask:0xf bank_mask:0xf
    v_and_b32_dpp v31, v33, v13 row_newbcast:15 row_mask:0xf bank_mask:0xf
    v_add_u32_dpp v11, v34, v7 row_newbcast:4 row_mask:0xf bank_mask:0xf
    buffer_load_dwordx4 v[80:83], v11, s[32:35], 0 offen offset:0
    buffer_load_dwordx4 v[88:91], v11, s[32:35], 0 offen offset:256
    v_add_u32_dpp v11, v34, v7 row_newbcast:5 row_mask:0xf bank_mask:0xf
    buffer_load_dwordx4 v[84:87], v11, s[32:35], 0 offen offset:0
    buffer_load_dwordx4 v[92:95], v11, s[32:35], 0 offen offset:256
    s_cbranch_scc1 L_ev6
L_st7:
    s_bitcmp1_b32 s52, 7
    s_waitcnt vmcnt(12)
    v_smfmac_f32_16x16x64_bf16 v[16:19], v[28:31], v[160:167], v14
    v_and_b32_dpp v24, v35, v12 row_newbcast:0 row_mask:0xf bank_mask:0xf
    v_and_b32_dpp v25, v35, v13 row_newbcast:0 row_mask:0xf bank_mask:0xf
    v_smfmac_f32_16x16x64_bf16 v[20:23], v[28:31], v[168:175], v14
    v_and_b32_dpp v26, v35, v12 row_newbcast:1 row_mask:0xf bank_mask:0xf
    v_and_b32_dpp v27, v35, v13 row_newbcast:1 row_mask:0xf bank_mask:0xf
    v_add_u32_dpp v11, v34, v7 row_newbcast:6 row_mask:0xf bank_mask:0xf
    buffer_load_dwordx4 v[96:99], v11, s[32:35], 0 offen offset:0
    buffer_load_dwordx4 v[104:107], v11, s[32:35], 0 offen offset:256
    v_add_u32_dpp v11, v34, v7 row_newbcast:7 row_mask:0xf bank_mask:0xf
    buffer_load_dwordx4 v[100:103], v11, s[32:35], 0 offen offset:0
    buffer_load_dwordx4 v[108:111], v11, s[32:35], 0 offen offset:256
    s_cbranch_scc1 L_ev7
L_st8:
    v_mov_b64 v[32:33], v[34:35]
    v_mov_b64 v[34:35], v[36:37]
    v_mov_b64 v[36:37], v[38:39]
    s_lshr_b32 s52, s52, 8
    s_lshr_b32 s53, s53, 8
    s_lshr_b32 s56, s56, 8
    s_branch L_st0
L_pad8:
    s_setpc_b64 s[68:69]
L_dr0:
    s_add_u32 s49, s49, 1
    ds_write_b32 v10, v6 offset:48
    s_waitcnt vmcnt(12)
    v_smfmac_f32_16x16x64_bf16 v[16:19], v[24:27], v[48:55], v14
    v_and_b32_dpp v28, v33, v12 row_newbcast:2 row_mask:0xf bank_mask:0xf
    v_and_b32_dpp v29, v33, v13 row_newbcast:2 row_mask:0xf bank_mask:0xf
    v_smfmac_f32_16x16x64_bf16 v[20:23], v[24:27], v[56:63], v14
    v_and_b32_dpp v30, v33, v12 row_newbcast:3 row_mask:0xf bank_mask:0xf
    v_and_b32_dpp v31, v33, v13 row_newbcast:3 row_mask:0xf bank_mask:0xf
    s_cmp_eq_u32 s49, 1
    s_cbranch_scc1 L_dw0_1
    s_cmp_eq_u32 s49, 2
    s_cbranch_scc1 L_dw0_2
L_dw0_3:
    s_waitcnt vmcnt(0)
L_dw0_2:
    s_waitcnt vmcnt(4)
L_dw0_1:
    s_waitcnt vmcnt(8)
    s_bitcmp1_b32 s52, 0
    s_cbranch_scc1 L_ev0
L_dr1:
    s_add_u32 s49, s49, 1
    ds_write_b32 v10, v6 offset:48
    s_waitcnt vmcnt(12)
    v_smfmac_f32_16x16x64_bf16 v[16:19], v[28:31], v[64:71], v14
    v_and_b32_dpp v24, v33, v12 row_newbcast:4 row_mask:0xf bank_mask:0xf
    v_and_b32_dpp v25, v33, v13 row_newbcast:4 row_mask:0xf bank_mask:0xf
    v_smfmac_f32_16x16x64_bf16 v[20:23], v[28:31], v[72:79], v14
    v_and_b32_dpp v26, v33, v12 row_newbcast:5 row_mask:0xf bank_mask:0xf
    v_and_b32_dpp v27, v33, v13 row_newbcast:5 row_mask:0xf bank_mask:0xf
    s_cmp_eq_u32 s49, 1
    s_cbranch_scc1 L_dw1_1
    s_cmp_eq_u32 s49, 2
    s_cbranch_scc1 L_dw1_2
L_dw1_3:
    s_waitcnt vmcnt(0)
L_dw1_2:
    s_waitcnt vmcnt(4)
L_dw1_1:
    s_waitcnt vmcnt(8)
    s_bitcmp1_b32 s52, 1
    s_cbranch_scc1 L_ev1
L_dr2:
    s_add_u32 s49, s49, 1
    ds_write_b32 v10, v6 offset:48
    s_waitcnt vmcnt(12)
    v_smfmac_f32_16x16x64_bf16 v[16:19], v[24:27], v[80:87], v14
    v_and_b32_dpp v28, v33, v12 row_newbcast:6 row_mask:0xf bank_mask:0xf
    v_and_b32_dpp v29, v33, v13 row_newbcast:6 row_mask:0xf bank_mask:0xf
    v_smfmac_f32_16x16x64_bf16 v[20:23], v[24:27], v[88:95], v14
    v_and_b32_dpp v30, v33, v12 row_newbcast:7 row_mask:0xf bank_mask:0xf
    v_and_b32_dpp v31, v33, v13 row_newbcast:7 row_mask:0xf bank_mask:0xf
    s_cmp_eq_u32 s49, 1
    s_cbranch_scc1 L_dw2_1
    s_cmp_eq_u32 s49, 2
    s_cbranch_scc1 L_dw2_2
L_dw2_3:
    s_waitcnt vmcnt(0)
L_dw2_2:
    s_waitcnt vmcnt(4)
L_dw2_1:
    s_waitcnt vmcnt(8)
    s_bitcmp1_b32 s52, 2
    s_cbranch_scc1 L_ev2
L_dr3:
    s_add_u32 s49, s49, 1
    ds_write_b32 v10, v6 offset:48
    s_waitcnt vmcnt(12)
    v_smfmac_f32_16x16x64_bf16 v[16:19], v[28:31], v[96:103], v14
    v_and_b32_dpp v24, v33, v12 row_newbcast:8 row_mask:0xf bank_mask:0xf
    v_and_b32_dpp v25, v33, v13 row_newbcast:8 row_mask:0xf bank_mask:0xf
    v_smfmac_f32_16x16x64_bf16 v[20:23], v[28:31], v[104:111], v14
    v_and_b32_dpp v26, v33, v12 row_newbcast:9 row_mask:0xf bank_mask:0xf
    v_and_b32_dpp v27, v33, v13 row_newbcast:9 row_mask:0xf bank_mask:0xf
    s_cmp_eq_u32 s49, 1
    s_cbranch_scc1 L_dw3_1
    s_cmp_eq_u32 s49, 2
    s_cbranch_scc1 L_dw3_2
L_dw3_3:
    s_waitcnt vmcnt(0)
L_dw3_2:
    s_waitcnt vmcnt(4)
L_dw3_1:
    s_waitcnt vmcnt(8)
    s_bitcmp1_b32 s52, 3
    s_cbranch_scc1 L_ev3
L_dr4:
    s_add_u32 s49, s49, 1
    ds_write_b32 v10, v6 offset:48
    s_waitcnt vmcnt(12)
    v_smfmac_f32_16x16x64_bf16 v[16:19], v[24:27], v[112:119], v14
    v_and_b32_dpp v28, v33, v12 row_newbcast:10 row_mask:0xf bank_mask:0xf
    v_and_b32_dpp v29, v33, v13 row_newbcast:10 row_mask:0xf bank_mask:0xf
    v_smfmac_f32_16x16x64_bf16 v[20:23], v[24:27], v[120:127], v14
    v_and_b32_dpp v30, v33, v12 row_newbcast:11 row_mask:0xf bank_mask:0xf
    v_and_b32_dpp v31, v33, v13 row_newbcast:11 row_mask:0xf bank_mask:0xf
    s_cmp_eq_u32 s49, 1
    s_cbranch_scc1 L_dw4_1
    s_cmp_eq_u32 s49, 2
    s_cbranch_scc1 L_dw4_2
L_dw4_3:
    s_waitcnt vmcnt(0)
L_dw4_2:
    s_waitcnt vmcnt(4)
L_dw4_1:
    s_waitcnt vmcnt(8)
    s_bitcmp1_b32 s52, 4
    s_cbranch_scc1 L_ev4
L_dr5:
    s_add_u32 s49, s49, 1
    ds_write_b32 v10, v6 offset:48
    s_waitcnt vmcnt(12)
    v_smfmac_f32_16x16x64_bf16 v[16:19], v[28:31], v[128:135], v14
    v_and_b32_dpp v24, v33, v12 row_newbcast:12 row_mask:0xf bank_mask:0xf
    v_and_b32_dpp v25, v33, v13 row_newbcast:12 row_mask:0xf bank_mask:0xf
    v_smfmac_f32_16x16x64_bf16 v[20:23], v[28:31], v[136:143], v14
    v_and_b32_dpp v26, v33, v12 row_newbcast:13 row_mask:0xf bank_mask:0xf
    v_and_b32_dpp v27, v33, v13 row_newbcast:13 row_mask:0xf bank_mask:0xf
    s_cmp_eq_u32 s49, 1
    s_cbranch_scc1 L_dw5_1
    s_cmp_eq_u32 s49, 2
    s_cbranch_scc1 L_dw5_2
L_dw5_3:
    s_waitcnt vmcnt(0)
L_dw5_2:
    s_waitcnt vmcnt(4)
L_dw5_1:
    s_waitcnt vmcnt(8)
    s_bitcmp1_b32 s52, 5
    s_cbranch_scc1 L_ev5
L_dr6:
    s_add_u32 s49, s49, 1
    ds_write_b32 v10, v6 offset:48
    s_waitcnt vmcnt(12)
    v_smfmac_f32_16x16x64_bf16 v[16:19], v[24:27], v[144:151], v14
    v_and_b32_dpp v28, v33, v12 row_newbcast:14 row_mask:0xf bank_mask:0xf
    v_and_b32_dpp v29, v33, v13 row_newbcast:14 row_mask:0xf bank_mask:0xf
    v_smfmac_f32_16x16x64_bf16 v[20:23], v[24:27], v[152:159], v14
    v_and_b32_dpp v30, v33, v12 row_newbcast:15 row_mask:0xf bank_mask:0xf
    v_and_b32_dpp v31, v33, v13 row_newbcast:15 row_mask:0xf bank_mask:0xf
    s_cmp_eq_u32 s49, 1
    s_cbranch_scc1 L_dw6_1
    s_cmp_eq_u32 s49, 2
    s_cbranch_scc1 L_dw6_2
L_dw6_3:
    s_waitcnt vmcnt(0)
L_dw6_2:
    s_waitcnt vmcnt(4)
L_dw6_1:
    s_waitcnt vmcnt(8)
    s_bitcmp1_b32 s52, 6
    s_cbranch_scc1 L_ev6
L_dr7:
    s_add_u32 s49, s49, 1
    ds_write_b32 v10, v6 offset:48
    s_waitcnt vmcnt(12)
    v_smfmac_f32_16x16x64_bf16 v[16:19], v[28:31], v[160:167], v14
    v_and_b32_dpp v24, v35, v12 row_newbcast:0 row_mask:0xf bank_mask:0xf
    v_and_b32_dpp v25, v35, v13 row_newbcast:0 row_mask:0xf bank_mask:0xf
    v_smfmac_f32_16x16x64_bf16 v[20:23], v[28:31], v[168:175], v14
    v_and_b32_dpp v26, v35, v12 row_newbcast:1 row_mask:0xf bank_mask:0xf
    v_and_b32_dpp v27, v35, v13 row_newbcast:1 row_mask:0xf bank_mask:0xf
    s_cmp_eq_u32 s49, 1
    s_cbranch_scc1 L_dw7_1
    s_cmp_eq_u32 s49, 2
    s_cbranch_scc1 L_dw7_2
L_dw7_3:
    s_waitcnt vmcnt(0)
L_dw7_2:
    s_waitcnt vmcnt(4)
L_dw7_1:
    s_waitcnt vmcnt(8)
    s_bitcmp1_b32 s52, 7
    s_cbranch_scc1 L_ev7
L_dr8:
    v_mov_b64 v[32:33], v[34:35]
    v_mov_b64 v[34:35], v[36:37]
    v_mov_b64 v[36:37], v[38:39]
    s_lshr_b32 s52, s52, 8
    s_lshr_b32 s53, s53, 8
    s_lshr_b32 s56, s56, 8
    s_branch L_dr0
L_pad0:
    s_setpc_b64 s[68:69]
L_ev0:
    s_and_b32 s65, s57, 15
    v_cmp_ge_u32 s[66:67], s65, v4
    v_cmp_gt_u32 s[68:69], s65, v4
    s_bitcmp1_b32 s56, 0
    s_cselect_b64 s[62:63], s[70:71], s[62:63]
    v_cndmask_b32 v40, 0, v28, s[66:67]
    v_cndmask_b32 v41, 0, v29, s[66:67]
    v_cndmask_b32 v42, 0, v30, s[68:69]
    v_cndmask_b32 v43, 0, v31, s[68:69]
    s_mul_i32 s64, s63, 0
    s_bitcmp1_b32 s53, 0
    s_cbranch_scc0 L_evret
    s_waitcnt vmcnt(12)
    v_smfmac_f32_16x16x64_bf16 v[16:19], v[40:43], v[64:71], v14
    v_xor_b32 v28, v28, v40
    v_xor_b32 v29, v29, v41
    v_smfmac_f32_16x16x64_bf16 v[20:23], v[40:43], v[72:79], v14
    v_xor_b32 v30, v30, v42
    v_xor_b32 v31, v31, v43
    s_branch L_flush
L_pad1:
    s_setpc_b64 s[68:69]
L_ev1:
    s_and_b32 s65, s57, 15
    v_cmp_ge_u32 s[66:67], s65, v4
    v_cmp_gt_u32 s[68:69], s65, v4
    s_bitcmp1_b32 s56, 1
    s_cselect_b64 s[62:63], s[70:71], s[62:63]
    v_cndmask_b32 v40, 0, v24, s[66:67]
    v_cndmask_b32 v41, 0, v25, s[66:67]
    v_cndmask_b32 v42, 0, v26, s[68:69]
    v_cndmask_b32 v43, 0, v27, s[68:69]
    s_mul_i32 s64, s63, 1
    s_bitcmp1_b32 s53, 1
    s_cbranch_scc0 L_evret
    s_waitcnt vmcnt(12)
    v_smfmac_f32_16x16x64_bf16 v[16:19], v[40:43], v[80:87], v14
    v_xor_b32 v24, v24, v40
    v_xor_b32 v25, v25, v41
    v_smfmac_f32_16x16x64_bf16 v[20:23], v[40:43], v[88:95], v14
    v_xor_b32 v26, v26, v42
    v_xor_b32 v27, v27, v43
    s_branch L_flush
L_pad2:
    s_setpc_b64 s[68:69]
L_ev2:
    s_and_b32 s65, s57, 15
    v_cmp_ge_u32 s[66:67], s65, v4
    v_cmp_gt_u32 s[68:69], s65, v4
    s_bitcmp1_b32 s56, 2
    s_cselect_b64 s[62:63], s[70:71], s[62:63]
    v_cndmask_b32 v40, 0, v28, s[66:67]
    v_cndmask_b32 v41, 0, v29, s[66:67]
    v_cndmask_b32 v42, 0, v30, s[68:69]
    v_cndmask_b32 v43, 0, v31, s[68:69]
    s_mul_i32 s64, s63, 2
    s_bitcmp1_b32 s53, 2
    s_cbranch_scc0 L_evret
    s_waitcnt vmcnt(12)
    v_smfmac_f32_16x16x64_bf16 v[16:19], v[40:43], v[96:103], v14
    v_xor_b32 v28, v28, v40
    v_xor_b32 v29, v29, v41
    v_smfmac_f32_16x16x64_bf16 v[20:23], v[40:43], v[104:111], v14
    v_xor_b32 v30, v30, v42
    v_xor_b32 v31, v31, v43
    s_branch L_flush
L_pad3:
    s_setpc_b64 s[68:69]
L_ev3:
    s_and_b32 s65, s57, 15
    v_cmp_ge_u32 s[66:67], s65, v4
    v_cmp_gt_u32 s[68:69], s65, v4
    s_bitcmp1_b32 s56, 3
    s_cselect_b64 s[62:63], s[70:71], s[62:63]
    v_cndmask_b32 v40, 0, v24, s[66:67]
    v_cndmask_b32 v41, 0, v25, s[66:67]
    v_cndmask_b32 v42, 0, v26, s[68:69]
    v_cndmask_b32 v43, 0, v27, s[68:69]
    s_mul_i32 s64, s63, 3
    s_bitcmp1_b32 s53, 3
    s_cbranch_scc0 L_evret
    s_waitcnt vmcnt(12)
    v_smfmac_f32_16x16x64_bf16 v[16:19], v[40:43], v[112:119], v14
    v_xor_b32 v24, v24, v40
    v_xor_b32 v25, v25, v41
    v_smfmac_f32_16x16x64_bf16 v[20:23], v[40:43], v[120:127], v14
    v_xor_b32 v26, v26, v42
    v_xor_b32 v27, v27, v43
    s_branch L_flush
L_pad4:
    s_setpc_b64 s[68:69]
L_ev4:
    s_and_b32 s65, s57, 15
    v_cmp_ge_u32 s[66:67], s65, v4
    v_cmp_gt_u32 s[68:69], s65, v4
    s_bitcmp1_b32 s56, 4
    s_cselect_b64 s[62:63], s[70:71], s[62:63]
    v_cndmask_b32 v40, 0, v28, s[66:67]
    v_cndmask_b32 v41, 0, v29, s[66:67]
    v_cndmask_b32 v42, 0, v30, s[68:69]
    v_cndmask_b32 v43, 0, v31, s[68:69]
    s_mul_i32 s64, s63, 4
    s_bitcmp1_b32 s53, 4
    s_cbranch_scc0 L_evret
    s_waitcnt vmcnt(12)
    v_smfmac_f32_16x16x64_bf16 v[16:19], v[40:43], v[128:135], v14
    v_xor_b32 v28, v28, v40
    v_xor_b32 v29, v29, v41
    v_smfmac_f32_16x16x64_bf16 v[20:23], v[40:43], v[136:143], v14
    v_xor_b32 v30, v30, v42
    v_xor_b32 v31, v31, v43
    s_branch L_flush
L_pad5:
    s_setpc_b64 s[68:69]
L_ev5:
    s_and_b32 s65, s57, 15
    v_cmp_ge_u32 s[66:67], s65, v4
    v_cmp_gt_u32 s[68:69], s65, v4
    s_bitcmp1_b32 s56, 5
    s_cselect_b64 s[62:63], s[70:71], s[62:63]
    v_cndmask_b32 v40, 0, v24, s[66:67]
    v_cndmask_b32 v41, 0, v25, s[66:67]
    v_cndmask_b32 v42, 0, v26, s[68:69]
    v_cndmask_b32 v43, 0, v27, s[68:69]
    s_mul_i32 s64, s63, 5
    s_bitcmp1_b32 s53, 5
    s_cbranch_scc0 L_evret
    s_waitcnt vmcnt(12)
    v_smfmac_f32_16x16x64_bf16 v[16:19], v[40:43], v[144:151], v14
    v_xor_b32 v24, v24, v40
    v_xor_b32 v25, v25, v41
    v_smfmac_f32_16x16x64_bf16 v[20:23], v[40:43], v[152:159], v14
    v_xor_b32 v26, v26, v42
    v_xor_b32 v27, v27, v43
    s_branch L_flush
L_pad6:
    s_setpc_b64 s[68:69]
L_ev6:
    s_and_b32 s65, s57, 15
    v_cmp_ge_u32 s[66:67], s65, v4
    v_cmp_gt_u32 s[68:69], s65, v4
    s_bitcmp1_b32 s56, 6
    s_cselect_b64 s[62:63], s[70:71], s[62:63]
    v_cndmask_b32 v40, 0, v28, s[66:67]
    v_cndmask_b32 v41, 0, v29, s[66:67]
    v_cndmask_b32 v42, 0, v30, s[68:69]
    v_cndmask_b32 v43, 0, v31, s[68:69]
    s_mul_i32 s64, s63, 6
    s_bitcmp1_b32 s53, 6
    s_cbranch_scc0 L_evret
    s_waitcnt vmcnt(12)
    v_smfmac_f32_16x16x64_bf16 v[16:19], v[40:43], v[160:167], v14
    v_xor_b32 v28, v28, v40
    v_xor_b32 v29, v29, v41
    v_smfmac_f32_16x16x64_bf16 v[20:23], v[40:43], v[168:175], v14
    v_xor_b32 v30, v30, v42
    v_xor_b32 v31, v31, v43
    s_branch L_flush
L_pad7:
    s_setpc_b64 s[68:69]
L_ev7:
    s_and_b32 s65, s57, 15
    v_cmp_ge_u32 s[66:67], s65, v4
    v_cmp_gt_u32 s[68:69], s65, v4
    s_bitcmp1_b32 s56, 7
    s_cselect_b64 s[62:63], s[70:71], s[62:63]
    v_cndmask_b32 v40, 0, v24, s[66:67]
    v_cndmask_b32 v41, 0, v25, s[66:67]
    v_cndmask_b32 v42, 0, v26, s[68:69]
    v_cndmask_b32 v43, 0, v27, s[68:69]
    s_mul_i32 s64, s63, 7
    s_bitcmp1_b32 s53, 7
    s_cbranch_scc0 L_evret
    s_waitcnt vmcnt(12)
    v_smfmac_f32_16x16x64_bf16 v[16:19], v[40:43], v[48:55], v14
    v_xor_b32 v24, v24, v40
    v_xor_b32 v25, v25, v41
    v_smfmac_f32_16x16x64_bf16 v[20:23], v[40:43], v[56:63], v14
    v_xor_b32 v26, v26, v42
    v_xor_b32 v27, v27, v43
    s_nop 0
L_flush:
    s_lshr_b32 s57, s57, 4
    s_cmp_eq_u32 s26, 4
    v_add_u32 v1, 1, v1
    v_mul_f32 v40, v177, v16
    v_mul_f32 v41, v177, v17
    v_mul_f32 v42, v177, v18
    v_mul_f32 v43, v177, v19
    v_cvt_pk_bf16_f32 v40, v40, v41
    v_cvt_pk_bf16_f32 v41, v42, v43
    ds_write_b64 v176, v[40:41] offset:41984
    v_mul_f32 v44, v177, v20
    v_mul_f32 v45, v177, v21
    v_mul_f32 v46, v177, v22
    v_mul_f32 v47, v177, v23
    v_cvt_pk_bf16_f32 v44, v44, v45
    v_cvt_pk_bf16_f32 v45, v46, v47
    ds_write_b64 v176, v[44:45] offset:42240
    ds_write_b32 v10, v1 offset:32
    s_cbranch_scc1 L_sdone
    v_mov_b64 v[16:17], 0
    v_mov_b64 v[18:19], 0
    v_mov_b64 v[20:21], 0
    v_mov_b64 v[22:23], 0
    s_add_u32 s26, s26, 1
    v_mov_b64 v[176:177], v[178:179]
    v_mov_b64 v[178:179], v[180:181]
    v_mov_b64 v[180:181], v[182:183]
    v_mov_b64 v[182:183], v[184:185]
L_evret:
    s_add_u32 s64, s64, s62
    s_add_u32 s54, s72, s64
    s_addc_u32 s55, s73, 0
    s_setpc_b64 s[54:55]
L_pad9:
    s_setpc_b64 s[68:69]
L_slow:
    s_mov_b32 s62, L_slow_pair-L_anc
    v_mbcnt_lo_u32_b32 v200, -1, 0
    v_mbcnt_hi_u32_b32 v200, -1, v200
L_slow_pair:
    v_lshlrev_b32 v201, 2, v200
    s_mul_i32 s70, s1, 40
    s_lshl1_add_u32 s70, s24, s70
    s_mov_b32 s71, 0
    s_mov_b32 s24, s20
    s_mov_b32 s20, s21
    s_mov_b32 s21, s22
    s_mov_b32 s22, s23
L_slow_chunk:
    global_load_dword v202, v201, s[8:9]
    global_load_dword v203, v201, s[6:7]
    v_add_u32 v201, 0x100, v201
    s_waitcnt vmcnt(0)
    v_subrev_u32 v202, s70, v202
    v_cmp_gt_u32 vcc, 2, v202
    v_lshlrev_b32 v204, 1, v203
    ds_read_u16 v204, v204 offset:62464
    s_mov_b64 s[76:77], vcc
    v_lshlrev_b32 v202, 4, v202
    v_lshlrev_b32 v203, 9, v203
    s_waitcnt lgkmcnt(0)
    v_lshlrev_b32 v204, v202, v204
L_slow_edge:
    s_cmp_eq_u64 s[76:77], 0
    s_cbranch_scc1 L_slow_next
    s_ff1_i32_b64 s74, s[76:77]
    s_bitset0_b64 s[76:77], s74
    v_readlane_b32 s64, v203, s74
    v_readlane_b32 s65, v204, s74
    v_mov_b32 v205, 0
    v_mov_b32 v11, 2147483648
    s_mov_b64 exec, 0xffff
    v_mov_b32 v205, s65
    v_add_u32 v11, s64, v7
    s_mov_b64 exec, -1
    buffer_load_dwordx4 v[208:211], v11, s[32:35], 0 offen
    buffer_load_dwordx4 v[212:215], v11, s[32:35], 0 offen offset:256
    v_and_b32 v24, v205, v12
    v_and_b32 v25, v205, v13
    s_nop 0
    s_waitcnt vmcnt(0)
    v_smfmac_f32_16x16x32_bf16 v[16:19], v[24:25], v[208:211], v14
    v_smfmac_f32_16x16x32_bf16 v[20:23], v[24:25], v[212:215], v14
    s_branch L_slow_edge
L_slow_next:
    s_add_u32 s71, s71, 1
    s_cmp_lt_u32 s71, 2500
    s_cbranch_scc1 L_slow_chunk
    s_mov_b32 s64, 0
    s_nop 3
    s_branch L_flush
L_sdone:
    ds_write_b32 v10, v6 offset:48
    s_waitcnt lgkmcnt(0)
    s_barrier
    s_endpgm
L_retry_12:
    s_sub_u32 s100, s100, 1
    s_cbranch_scc1 L_end
    s_sleep 1
    s_branch L_spin_11
L_retry_13:
    s_sub_u32 s100, s100, 1
    s_cbranch_scc1 L_end
    s_sleep 4
    s_branch L_ipoll_10
L_retry_19:
    s_sub_u32 s100, s100, 1
    s_cbranch_scc1 L_end
    s_sleep 2
    s_branch L_secload_18
L_secload_18:
    buffer_load_dwordx4 v[56:59], v8, s[40:43], s12 offen sc1
    s_waitcnt vmcnt(0)
    s_branch L_sec_16
L_retry_23:
    s_sub_u32 s100, s100, 1
    s_cbranch_scc1 L_end
    s_sleep 2
    s_branch L_secload_22
L_secload_22:
    buffer_load_dwordx4 v[60:63], v8, s[40:43], s13 offen sc1
    s_waitcnt vmcnt(0)
    s_branch L_sec_20
L_retry_25:
    s_sub_u32 s100, s100, 1
    s_cbranch_scc1 L_end
    s_sleep 1
    s_branch L_spin_24
L_mwork_4:
    v_xor_b32 v44, v4, v3
    v_lshlrev_b32 v44, 4, v44
    v_lshl_add_u32 v44, v3, 9, v44
    v_xor_b32 v45, 64, v44
    v_xor_b32 v46, 0x80, v44
    v_xor_b32 v47, 0xc0, v44
    s_cmp_lg_u32 s31, 0
    s_waitcnt vmcnt(1)
    s_barrier
    s_cbranch_scc1 L_worked_5_w
    ds_read_b128 v[48:51], v44 offset:62464
    ds_read_b128 v[52:55], v44 offset:21504
    ds_read_b128 v[56:59], v44 offset:29696
    ds_read_b128 v[60:63], v45 offset:62464
    ds_read_b128 v[64:67], v45 offset:21504
    ds_read_b128 v[68:71], v45 offset:29696
    ds_read_b128 v[72:75], v46 offset:62464
    ds_read_b128 v[76:79], v46 offset:21504
    ds_read_b128 v[80:83], v46 offset:29696
    ds_read_b128 v[84:87], v47 offset:62464
    ds_read_b128 v[88:91], v47 offset:21504
    ds_read_b128 v[92:95], v47 offset:29696
    s_waitcnt lgkmcnt(9)
    v_mfma_f32_16x16x32_bf16 v[16:19], v[52:55], v[48:51], 0
    v_mfma_f32_16x16x32_bf16 v[20:23], v[56:59], v[48:51], 0
    ds_read_b128 v[96:99], v44 offset:62720
    ds_read_b128 v[100:103], v44 offset:21760
    ds_read_b128 v[104:107], v44 offset:29952
    s_waitcnt lgkmcnt(9)
    v_mfma_f32_16x16x32_bf16 v[16:19], v[64:67], v[60:63], v[16:19]
    v_mfma_f32_16x16x32_bf16 v[20:23], v[68:71], v[60:63], v[20:23]
    ds_read_b128 v[108:111], v45 offset:62720
    ds_read_b128 v[112:115], v45 offset:21760
    ds_read_b128 v[116:119], v45 offset:29952
    s_waitcnt lgkmcnt(9)
    v_mfma_f32_16x16x32_bf16 v[16:19], v[76:79], v[72:75], v[16:19]
    v_mfma_f32_16x16x32_bf16 v[20:23], v[80:83], v[72:75], v[20:23]
    ds_read_b128 v[120:123], v46 offset:62720
    ds_read_b128 v[124:127], v46 offset:21760
    ds_read_b128 v[128:131], v46 offset:29952
    s_waitcnt lgkmcnt(9)
    v_mfma_f32_16x16x32_bf16 v[16:19], v[88:91], v[84:87], v[16:19]
    v_mfma_f32_16x16x32_bf16 v[20:23], v[92:95], v[84:87], v[20:23]
    ds_read_b128 v[132:135], v47 offset:62720
    ds_read_b128 v[136:139], v47 offset:21760
    ds_read_b128 v[140:143], v47 offset:29952
    s_waitcnt lgkmcnt(9)
    v_mfma_f32_16x16x32_bf16 v[16:19], v[100:103], v[96:99], v[16:19]
    v_mfma_f32_16x16x32_bf16 v[20:23], v[104:107], v[96:99], v[20:23]
    s_waitcnt lgkmcnt(6)
    v_mfma_f32_16x16x32_bf16 v[16:19], v[112:115], v[108:111], v[16:19]
    v_mfma_f32_16x16x32_bf16 v[20:23], v[116:119], v[108:111], v[20:23]
    s_waitcnt lgkmcnt(3)
    v_mfma_f32_16x16x32_bf16 v[16:19], v[124:127], v[120:123], v[16:19]
    v_mfma_f32_16x16x32_bf16 v[20:23], v[128:131], v[120:123], v[20:23]
    s_waitcnt lgkmcnt(0)
    v_mfma_f32_16x16x32_bf16 v[16:19], v[136:139], v[132:135], v[16:19]
    v_mfma_f32_16x16x32_bf16 v[20:23], v[140:143], v[132:135], v[20:23]
    s_lshl_b32 s64, s27, 10
    s_add_u32 s64, s64, 65536
    v_lshl_add_u32 v40, v2, 4, s64
    s_lshl_b32 s64, s27, 2
    s_add_u32 s64, s64, 4096
    v_lshl_add_u32 v41, v2, 9, s64
    v_mov_b32 v42, s30
    s_nop 1
    v_cvt_pk_bf16_f32 v44, v16, v17
    v_cvt_pk_bf16_f32 v45, v18, v19
    v_cvt_pk_bf16_f32 v46, v20, v21
    v_cvt_pk_bf16_f32 v47, v22, v23
    global_store_dwordx4 v40, v[44:47], s[28:29] sc1
    s_barrier
    s_waitcnt vmcnt(0)
    s_mov_b64 exec, 0xff
    global_store_dword v41, v42, s[28:29] sc1
    s_mov_b64 exec, -1
    s_branch L_worked_5
L_worked_5_w:
    s_barrier
    s_waitcnt vmcnt(0)
    s_branch L_worked_5
L_gemm:
    v_lshlrev_b32 v8, 4, v0
    v_lshlrev_b32 v10, 2, v0
    v_mov_b32 v32, 1966080
    v_mov_b32 v33, 1966080
    v_mov_b64 v[34:35], v[32:33]
    v_subrev_u32 v9, 32, v0
    v_cmp_gt_u32 vcc, 20, v9
    ds_write_b128 v8, v[32:35] offset:41984
    ds_write_b128 v8, v[32:35] offset:46080
    ds_write_b128 v8, v[32:35] offset:50176
    ds_write_b128 v8, v[32:35] offset:54272
    v_mul_u32_u24 v9, 264, v9
    v_add_u32 v9, 148480, v9
    v_cndmask_b32 v9, 0, v9, vcc
    ds_write_b32 v10, v9
    v_mov_b32 v16, 1310740000
    v_mov_b32 v17, 1310740000
    v_mov_b64 v[18:19], v[16:17]
    v_add_u32 v9, 148480, v8
    ds_write_b128 v9, v[16:19]
    ds_write_b128 v9, v[16:19] offset:4096
    v_and_b32 v3, 15, v2
    v_lshrrev_b32 v4, 4, v2
    v_mov_b32 v5, 0
    v_mov_b32 v6, 1
    s_mov_b32 s100, 67108864
    s_bfe_u32 s65, s2, 0x10003
    s_lshl1_add_u32 s64, s67, s65
    s_and_b32 s65, s2, 0xf0
    s_or_b32 s64, s64, s65
    s_cmp_lt_u32 s2, 240
    s_cselect_b32 s1, s64, s2
    v_lshrrev_b32 v28, 5, v0
    v_and_b32 v1, 31, v2
    v_xor_b32 v1, v1, v28
    v_lshlrev_b32 v1, 4, v1
    v_lshl_add_u32 v30, v28, 9, v1
    v_xor_b32 v31, 0x80, v30
    s_mul_i32 s63, s1, 20480
    s_lshl_b32 s66, s31, 10
    s_waitcnt lgkmcnt(0)
    s_mov_b32 s32, s4
    s_and_b32 s33, s5, 0xffff
    s_mov_b32 s34, 5120000
    s_mov_b32 s35, 0x20000
    s_min_u32 s64, s1, 249
    s_mul_i32 s64, s64, 20480
    s_cmp_eq_u32 s31, 0
    s_cselect_b64 s[68:69], s[24:25], s[16:17]
    s_cselect_b32 s64, s64, 0
    s_cmp_eq_u32 s31, 2
    s_cselect_b64 s[68:69], s[28:29], s[68:69]
    s_cselect_b32 s64, 0x800, s64
    s_cselect_b32 s76, 0x2f8000, 0
    s_cmp_eq_u32 s31, 3
    s_cselect_b64 s[68:69], s[4:5], s[68:69]
    s_cselect_b32 s76, 0x200000, s76
    s_cselect_b32 s77, 2, 1
    v_min_u32 v27, s77, v2
    v_mul_lo_u32 v27, v27, s76
    v_add_u32 v27, s64, v27
    global_load_dword v24, v27, s[68:69]
    s_waitcnt lgkmcnt(0)
    s_cmp_ge_u32 s2, 250
    s_cbranch_scc1 L_end
    s_barrier
    s_setprio 2
    s_add_u32 m0, s66, 1024
    s_nop 0
    buffer_load_dwordx4 v30, s[32:35], s63 offen lds
    s_add_u32 m0, s66, 5120
    s_add_u32 s63, s63, 4096
    buffer_load_dwordx4 v31, s[32:35], s63 offen lds
    v_lshrrev_b32 v13, 3, v2
    v_lshrrev_b32 v15, 2, v2
    v_and_b32 v15, 4, v15
    v_and_b32 v14, 7, v2
    v_xor_b32 v15, v15, v14
    v_lshlrev_b32 v15, 4, v15
    v_lshl_add_u32 v13, v13, 9, v15
    s_bfe_u32 s67, s2, 0x30003
    s_lshl_b32 s64, s31, 7
    s_lshl_b32 s65, s67, 14
    s_or_b32 s64, s64, s65
    v_add_u32 v13, s64, v13
    s_lshl_b32 s70, s31, 14
    s_add_u32 s70, s70, 82944
    s_mov_b32 s71, 3072
    s_mov_b32 s72, 6144
    s_mov_b32 s73, 9216
    s_mov_b32 s36, s22
    s_and_b32 s37, s23, 0xffff
    s_mov_b32 s38, 131072
    s_mov_b32 s39, 0x20000
    s_and_b32 s64, s2, 8
    s_or_b32 s64, s64, s31
    s_cbranch_scc1 L_touched_26
    s_lshr_b32 s64, s2, 4
    s_and_b32 s68, s2, 7
    s_lshl3_add_u32 s64, s64, s68
    s_lshl_b32 s64, s64, 10
    v_lshl_add_u32 v26, v2, 4, s64
    global_load_dwordx4 v[20:23], v26, s[16:17]
L_touched_26:
    s_add_u32 m0, s70, 0
    s_nop 0
    buffer_load_dwordx4 v13, s[36:39], 0 offen offset:0 lds
    buffer_load_dwordx4 v13, s[36:39], s71 offen offset:1024 lds
    buffer_load_dwordx4 v13, s[36:39], s72 offen offset:2048 lds
    buffer_load_dwordx4 v13, s[36:39], s73 offen offset:3072 lds
    v_xor_b32 v13, 16384, v13
    s_mov_b32 s40, s16
    s_and_b32 s41, s17, 0xffff
    s_mov_b32 s42, 131072
    s_mov_b32 s43, 0x20000
    s_mov_b32 s44, s28
    s_and_b32 s45, s29, 0xffff
    s_mov_b32 s46, 1048576
    s_mov_b32 s47, 0x20000
    s_mov_b32 s48, s24
    s_and_b32 s49, s25, 0xffff
    s_mov_b32 s50, 5120000
    s_mov_b32 s51, 0x20000
    v_xor_b32 v15, v4, v3
    v_lshlrev_b32 v15, 4, v15
    v_lshl_add_u32 v7, v3, 9, v15
    s_lshl_b32 s64, s67, 6
    v_xor_b32 v7, s64, v7
    v_xor_b32 v8, 64, v7
    v_xor_b32 v9, 0x80, v7
    v_xor_b32 v10, 0xc0, v7
    v_lshrrev_b32 v15, 2, v3
    v_lshl_add_u32 v15, v4, 3, v15
    v_lshlrev_b32 v15, 7, v15
    v_lshrrev_b32 v14, 1, v3
    v_and_b32 v14, 4, v14
    v_and_b32 v0, 3, v3
    v_xor_b32 v14, v14, v0
    v_lshl_add_u32 v15, v14, 4, v15
    v_add_u32 v11, s70, v15
    v_xor_b32 v12, 64, v11
    v_and_b32 v0, 31, v2
    v_lshlrev_b32 v0, 2, v0
    s_and_b32 s64, s2, 7
    s_lshl_b32 s64, s64, 9
    s_lshl_b32 s65, s31, 7
    s_add_u32 s64, s64, s65
    s_add_u32 s74, s64, 4096
    v_lshlrev_b32 v14, 4, v2
    s_lshl_b32 s75, s31, 15
    s_lshl_b32 s64, s67, 12
    s_or_b32 s75, s75, s64
    s_add_u32 s75, s75, 65536
    s_add_u32 m0, s66, 9216
    s_add_u32 s63, s63, 4096
    buffer_load_dwordx4 v30, s[32:35], s63 offen lds
    s_add_u32 m0, s66, 13312
    s_add_u32 s63, s63, 4096
    buffer_load_dwordx4 v31, s[32:35], s63 offen lds
    s_add_u32 m0, s66, 17408
    s_add_u32 s63, s63, 4096
    buffer_load_dwordx4 v30, s[32:35], s63 offen lds
    s_barrier
    s_cmp_eq_u32 s31, 0
    s_cbranch_scc0 L_nw_28
    s_call_b64 s[68:69], L_pad0
    s_call_b64 s[68:69], L_pad1
    s_call_b64 s[68:69], L_pad8
    s_branch L_warmed_27
L_nw_28:
    s_cmp_eq_u32 s31, 1
    s_cbranch_scc0 L_nw_29
    s_call_b64 s[68:69], L_pad2
    s_call_b64 s[68:69], L_pad3
    s_call_b64 s[68:69], L_pad9
    s_branch L_warmed_27
L_nw_29:
    s_cmp_eq_u32 s31, 2
    s_cbranch_scc0 L_nw_30
    s_call_b64 s[68:69], L_pad4
    s_call_b64 s[68:69], L_pad5
    s_branch L_warmed_27
L_nw_30:
    s_call_b64 s[68:69], L_pad6
    s_call_b64 s[68:69], L_pad7
L_warmed_27:
    s_add_u32 m0, s70, 4096
    s_waitcnt vmcnt(9)
    buffer_load_dwordx4 v13, s[36:39], 0 offen offset:0 lds
    s_waitcnt vmcnt(9)
    buffer_load_dwordx4 v13, s[36:39], s71 offen offset:1024 lds
    s_waitcnt vmcnt(9)
    buffer_load_dwordx4 v13, s[36:39], s72 offen offset:2048 lds
    s_waitcnt vmcnt(9)
    buffer_load_dwordx4 v13, s[36:39], s73 offen offset:3072 lds
    v_xor_b32 v13, 49152, v13
    s_bitcmp1_b32 s2, 3
    s_cbranch_scc1 L_nobar_32
    s_barrier
L_nobar_32:
    s_add_u32 m0, s70, 8192
    s_waitcnt vmcnt(9)
    buffer_load_dwordx4 v13, s[36:39], 0 offen offset:0 lds
    s_waitcnt vmcnt(9)
    buffer_load_dwordx4 v13, s[36:39], s71 offen offset:1024 lds
    s_waitcnt vmcnt(9)
    buffer_load_dwordx4 v13, s[36:39], s72 offen offset:2048 lds
    s_waitcnt vmcnt(9)
    buffer_load_dwordx4 v13, s[36:39], s73 offen offset:3072 lds
    v_xor_b32 v13, 16384, v13
    s_add_u32 m0, s70, 12288
    s_waitcnt vmcnt(6)
    buffer_load_dwordx4 v13, s[36:39], 0 offen offset:0 lds
    s_waitcnt vmcnt(6)
    buffer_load_dwordx4 v13, s[36:39], s71 offen offset:1024 lds
    s_waitcnt vmcnt(6)
    buffer_load_dwordx4 v13, s[36:39], s72 offen offset:2048 lds
    s_waitcnt vmcnt(6)
    buffer_load_dwordx4 v13, s[36:39], s73 offen offset:3072 lds
    v_xor_b32 v13, 114688, v13
    s_waitcnt vmcnt(12)
    ds_read_b64_tr_b16 v[128:129], v11 offset:0
    ds_read_b64_tr_b16 v[130:131], v11 offset:512
    ds_read_b64_tr_b16 v[132:133], v11 offset:8
    ds_read_b64_tr_b16 v[134:135], v11 offset:520
    ds_read_b64_tr_b16 v[136:137], v12 offset:0
    ds_read_b64_tr_b16 v[138:139], v12 offset:512
    ds_read_b64_tr_b16 v[140:141], v12 offset:8
    ds_read_b64_tr_b16 v[142:143], v12 offset:520
    s_waitcnt lgkmcnt(0)
    s_add_u32 m0, s70, 0
    s_waitcnt vmcnt(6)
    buffer_load_dwordx4 v13, s[36:39], 0 offen offset:0 lds
    s_waitcnt vmcnt(6)
    buffer_load_dwordx4 v13, s[36:39], s71 offen offset:1024 lds
    s_waitcnt vmcnt(6)
    buffer_load_dwordx4 v13, s[36:39], s72 offen offset:2048 lds
    s_waitcnt vmcnt(6)
    buffer_load_dwordx4 v13, s[36:39], s73 offen offset:3072 lds
    v_xor_b32 v13, 16384, v13
    s_waitcnt vmcnt(12)
    s_waitcnt lgkmcnt(0)
    s_mov_b64 exec, 1
    ds_add_u32 v5, v6 offset:4
    s_mov_b64 exec, -1
    ds_read_b64_tr_b16 v[144:145], v11 offset:4096
    ds_read_b64_tr_b16 v[146:147], v11 offset:4608
    ds_read_b64_tr_b16 v[148:149], v11 offset:4104
    ds_read_b64_tr_b16 v[150:151], v11 offset:4616
    ds_read_b64_tr_b16 v[152:153], v12 offset:4096
    ds_read_b64_tr_b16 v[154:155], v12 offset:4608
    ds_read_b64_tr_b16 v[156:157], v12 offset:4104
    ds_read_b64_tr_b16 v[158:159], v12 offset:4616
    s_waitcnt lgkmcnt(0)
    s_add_u32 m0, s70, 4096
    s_waitcnt vmcnt(6)
    buffer_load_dwordx4 v13, s[36:39], 0 offen offset:0 lds
    s_waitcnt vmcnt(6)
    buffer_load_dwordx4 v13, s[36:39], s71 offen offset:1024 lds
    s_waitcnt vmcnt(6)
    buffer_load_dwordx4 v13, s[36:39], s72 offen offset:2048 lds
    s_waitcnt vmcnt(6)
    buffer_load_dwordx4 v13, s[36:39], s73 offen offset:3072 lds
    v_xor_b32 v13, 49152, v13
    s_waitcnt vmcnt(12)
    ds_read_b64_tr_b16 v[160:161], v11 offset:8192
    ds_read_b64_tr_b16 v[162:163], v11 offset:8704
    ds_read_b64_tr_b16 v[164:165], v11 offset:8200
    ds_read_b64_tr_b16 v[166:167], v11 offset:8712
    ds_read_b64_tr_b16 v[168:169], v12 offset:8192
    ds_read_b64_tr_b16 v[170:171], v12 offset:8704
    ds_read_b64_tr_b16 v[172:173], v12 offset:8200
    ds_read_b64_tr_b16 v[174:175], v12 offset:8712
    s_waitcnt lgkmcnt(0)
    s_add_u32 m0, s70, 8192
    s_waitcnt vmcnt(6)
    buffer_load_dwordx4 v13, s[36:39], 0 offen offset:0 lds
    s_waitcnt vmcnt(6)
    buffer_load_dwordx4 v13, s[36:39], s71 offen offset:1024 lds
    s_waitcnt vmcnt(6)
    buffer_load_dwordx4 v13, s[36:39], s72 offen offset:2048 lds
    s_waitcnt vmcnt(6)
    buffer_load_dwordx4 v13, s[36:39], s73 offen offset:3072 lds
    v_xor_b32 v13, 16384, v13
    buffer_load_dword v1, v0, s[44:47], s74 offen sc1
    s_waitcnt vmcnt(13)
    ds_read_b64_tr_b16 v[176:177], v11 offset:12288
    ds_read_b64_tr_b16 v[178:179], v11 offset:12800
    ds_read_b64_tr_b16 v[180:181], v11 offset:12296
    ds_read_b64_tr_b16 v[182:183], v11 offset:12808
    ds_read_b64_tr_b16 v[184:185], v12 offset:12288
    ds_read_b64_tr_b16 v[186:187], v12 offset:12800
    ds_read_b64_tr_b16 v[188:189], v12 offset:12296
    ds_read_b64_tr_b16 v[190:191], v12 offset:12808
    s_waitcnt lgkmcnt(0)
    s_add_u32 m0, s70, 12288
    s_nop 0
    buffer_load_dwordx4 v13, s[36:39], 0 offen offset:0 lds
    buffer_load_dwordx4 v13, s[36:39], s71 offen offset:1024 lds
    buffer_load_dwordx4 v13, s[36:39], s72 offen offset:2048 lds
    buffer_load_dwordx4 v13, s[36:39], s73 offen offset:3072 lds
    v_xor_b32 v13, 114688, v13
    s_waitcnt vmcnt(13)
    ds_read_b64_tr_b16 v[192:193], v11 offset:0
    ds_read_b64_tr_b16 v[194:195], v11 offset:512
    ds_read_b64_tr_b16 v[196:197], v11 offset:8
    ds_read_b64_tr_b16 v[198:199], v11 offset:520
    ds_read_b64_tr_b16 v[200:201], v12 offset:0
    ds_read_b64_tr_b16 v[202:203], v12 offset:512
    ds_read_b64_tr_b16 v[204:205], v12 offset:8
    ds_read_b64_tr_b16 v[206:207], v12 offset:520
    s_waitcnt vmcnt(9)
    ds_read_b64_tr_b16 v[208:209], v11 offset:4096
    ds_read_b64_tr_b16 v[210:211], v11 offset:4608
    ds_read_b64_tr_b16 v[212:213], v11 offset:4104
    ds_read_b64_tr_b16 v[214:215], v11 offset:4616
    ds_read_b64_tr_b16 v[216:217], v12 offset:4096
    ds_read_b64_tr_b16 v[218:219], v12 offset:4608
    ds_read_b64_tr_b16 v[220:221], v12 offset:4104
    ds_read_b64_tr_b16 v[222:223], v12 offset:4616
    s_waitcnt vmcnt(5)
    ds_read_b64_tr_b16 v[224:225], v11 offset:8192
    ds_read_b64_tr_b16 v[226:227], v11 offset:8704
    ds_read_b64_tr_b16 v[228:229], v11 offset:8200
    ds_read_b64_tr_b16 v[230:231], v11 offset:8712
    ds_read_b64_tr_b16 v[232:233], v12 offset:8192
    ds_read_b64_tr_b16 v[234:235], v12 offset:8704
    ds_read_b64_tr_b16 v[236:237], v12 offset:8200
    ds_read_b64_tr_b16 v[238:239], v12 offset:8712
    s_waitcnt vmcnt(4)
L_spin_34:
    ds_read_b128 v[16:19], v5
    s_waitcnt lgkmcnt(0)
    v_readfirstlane_b32 s101, v18
    v_readfirstlane_b32 s30, v19
    s_cmp_ge_u32 s101, 1
    s_cbranch_scc0 L_retry_35
L_mchk_33:
    v_cmp_ne_u32 vcc, s30, v1
    s_cbranch_vccnz L_mre_36
    buffer_load_dwordx4 v[40:43], v14, s[44:47], s75 offen offset:0 sc1
    buffer_load_dwordx4 v[44:47], v14, s[44:47], s75 offen offset:1024 sc1
    buffer_load_dwordx4 v[48:51], v14, s[44:47], s75 offen offset:2048 sc1
    buffer_load_dwordx4 v[52:55], v14, s[44:47], s75 offen offset:3072 sc1
    s_xor_b32 s75, s75, 4096
    buffer_load_dwordx4 v[56:59], v14, s[44:47], s75 offen offset:0 sc1
    buffer_load_dwordx4 v[60:63], v14, s[44:47], s75 offen offset:1024 sc1
    buffer_load_dwordx4 v[64:67], v14, s[44:47], s75 offen offset:2048 sc1
    buffer_load_dwordx4 v[68:71], v14, s[44:47], s75 offen offset:3072 sc1
    s_xor_b32 s75, s75, 12288
    buffer_load_dwordx4 v[72:75], v14, s[44:47], s75 offen offset:0 sc1
    buffer_load_dwordx4 v[76:79], v14, s[44:47], s75 offen offset:1024 sc1
    s_waitcnt vmcnt(10)
    ds_read_b64_tr_b16 v[240:241], v11 offset:12288
    ds_read_b64_tr_b16 v[242:243], v11 offset:12800
    ds_read_b64_tr_b16 v[244:245], v11 offset:12296
    ds_read_b64_tr_b16 v[246:247], v11 offset:12808
    ds_read_b64_tr_b16 v[248:249], v12 offset:12288
    ds_read_b64_tr_b16 v[250:251], v12 offset:12800
    ds_read_b64_tr_b16 v[252:253], v12 offset:12296
    ds_read_b64_tr_b16 v[254:255], v12 offset:12808
L_spin_37:
    ds_read_b32 v15, v5 offset:4
    s_waitcnt lgkmcnt(0)
    v_readfirstlane_b32 s101, v15
    s_cmp_ge_u32 s101, 4
    s_cbranch_scc0 L_retry_38
    ds_read_b128 v[16:19], v7 offset:1024
    ds_read_b128 v[20:23], v7 offset:9216
    ds_read_b128 v[24:27], v7 offset:17408
    v_xor_b32 v7, 0x100, v7
    ds_read_b128 v[28:31], v8 offset:1024
    ds_read_b128 v[32:35], v8 offset:9216
    ds_read_b128 v[36:39], v8 offset:17408
    v_xor_b32 v8, 0x100, v8
    s_waitcnt lgkmcnt(3)
    s_waitcnt vmcnt(9)
    v_mfma_f32_16x16x32_bf16 v[80:83], v[40:43], v[16:19], 0
    v_mfma_f32_16x16x32_bf16 v[96:99], v[40:43], v[20:23], 0
    v_mfma_f32_16x16x32_bf16 v[112:115], v[40:43], v[24:27], 0
    buffer_load_dwordx4 v[40:43], v14, s[44:47], s75 offen offset:2048 sc1
    s_waitcnt vmcnt(9)
    v_mfma_f32_16x16x32_bf16 v[84:87], v[44:47], v[16:19], 0
    v_mfma_f32_16x16x32_bf16 v[100:103], v[44:47], v[20:23], 0
    v_mfma_f32_16x16x32_bf16 v[116:119], v[44:47], v[24:27], 0
    buffer_load_dwordx4 v[44:47], v14, s[44:47], s75 offen offset:3072 sc1
    s_xor_b32 s75, s75, 4096
    s_waitcnt vmcnt(9)
    v_mfma_f32_16x16x32_bf16 v[88:91], v[48:51], v[16:19], 0
    v_mfma_f32_16x16x32_bf16 v[104:107], v[48:51], v[20:23], 0
    v_mfma_f32_16x16x32_bf16 v[120:123], v[48:51], v[24:27], 0
    buffer_load_dwordx4 v[48:51], v14, s[44:47], s75 offen offset:0 sc1
    s_waitcnt vmcnt(9)
    v_mfma_f32_16x16x32_bf16 v[92:95], v[52:55], v[16:19], 0
    v_mfma_f32_16x16x32_bf16 v[108:111], v[52:55], v[20:23], 0
    v_mfma_f32_16x16x32_bf16 v[124:127], v[52:55], v[24:27], 0
    buffer_load_dwordx4 v[52:55], v14, s[44:47], s75 offen offset:1024 sc1
    ds_read_b128 v[16:19], v9 offset:1024
    ds_read_b128 v[20:23], v9 offset:9216
    ds_read_b128 v[24:27], v9 offset:17408
    v_xor_b32 v9, 0x100, v9
    s_waitcnt lgkmcnt(3)
    s_waitcnt vmcnt(9)
    v_mfma_f32_16x16x32_bf16 v[80:83], v[56:59], v[28:31], v[80:83]
    v_mfma_f32_16x16x32_bf16 v[96:99], v[56:59], v[32:35], v[96:99]
    v_mfma_f32_16x16x32_bf16 v[112:115], v[56:59], v[36:39], v[112:115]
    buffer_load_dwordx4 v[56:59], v14, s[44:47], s75 offen offset:2048 sc1
    s_waitcnt vmcnt(9)
    v_mfma_f32_16x16x32_bf16 v[84:87], v[60:63], v[28:31], v[84:87]
    v_mfma_f32_16x16x32_bf16 v[100:103], v[60:63], v[32:35], v[100:103]
    v_mfma_f32_16x16x32_bf16 v[116:119], v[60:63], v[36:39], v[116:119]
    buffer_load_dwordx4 v[60:63], v14, s[44:47], s75 offen offset:3072 sc1
    s_xor_b32 s75, s75, 28672
    s_waitcnt vmcnt(9)
    v_mfma_f32_16x16x32_bf16 v[88:91], v[64:67], v[28:31], v[88:91]
    v_mfma_f32_16x16x32_bf16 v[104:107], v[64:67], v[32:35], v[104:107]
    v_mfma_f32_16x16x32_bf16 v[120:123], v[64:67], v[36:39], v[120:123]
    buffer_load_dwordx4 v[64:67], v14, s[44:47], s75 offen offset:0 sc1
    s_waitcnt vmcnt(9)
    v_mfma_f32_16x16x32_bf16 v[92:95], v[68:71], v[28:31], v[92:95]
    v_mfma_f32_16x16x32_bf16 v[108:111], v[68:71], v[32:35], v[108:111]
    v_mfma_f32_16x16x32_bf16 v[124:127], v[68:71], v[36:39], v[124:127]
    buffer_load_dwordx4 v[68:71], v14, s[44:47], s75 offen offset:1024 sc1
    ds_read_b128 v[28:31], v10 offset:1024
    ds_read_b128 v[32:35], v10 offset:9216
    ds_read_b128 v[36:39], v10 offset:17408
    v_xor_b32 v10, 0x100, v10
    s_waitcnt lgkmcnt(3)
    s_waitcnt vmcnt(9)
    v_mfma_f32_16x16x32_bf16 v[80:83], v[72:75], v[16:19], v[80:83]
    v_mfma_f32_16x16x32_bf16 v[96:99], v[72:75], v[20:23], v[96:99]
    v_mfma_f32_16x16x32_bf16 v[112:115], v[72:75], v[24:27], v[112:115]
    buffer_load_dwordx4 v[72:75], v14, s[44:47], s75 offen offset:2048 sc1
    s_waitcnt vmcnt(9)
    v_mfma_f32_16x16x32_bf16 v[84:87], v[76:79], v[16:19], v[84:87]
    v_mfma_f32_16x16x32_bf16 v[100:103], v[76:79], v[20:23], v[100:103]
    v_mfma_f32_16x16x32_bf16 v[116:119], v[76:79], v[24:27], v[116:119]
    buffer_load_dwordx4 v[76:79], v14, s[44:47], s75 offen offset:3072 sc1
    s_xor_b32 s75, s75, 4096
    s_waitcnt vmcnt(9)
    v_mfma_f32_16x16x32_bf16 v[88:91], v[40:43], v[16:19], v[88:91]
    v_mfma_f32_16x16x32_bf16 v[104:107], v[40:43], v[20:23], v[104:107]
    v_mfma_f32_16x16x32_bf16 v[120:123], v[40:43], v[24:27], v[120:123]
    buffer_load_dwordx4 v[40:43], v14, s[44:47], s75 offen offset:0 sc1
    s_waitcnt vmcnt(9)
    v_mfma_f32_16x16x32_bf16 v[92:95], v[44:47], v[16:19], v[92:95]
    v_mfma_f32_16x16x32_bf16 v[108:111], v[44:47], v[20:23], v[108:111]
    v_mfma_f32_16x16x32_bf16 v[124:127], v[44:47], v[24:27], v[124:127]
    buffer_load_dwordx4 v[44:47], v14, s[44:47], s75 offen offset:1024 sc1
    ds_read_b128 v[16:19], v7 offset:1024
    ds_read_b128 v[20:23], v7 offset:9216
    ds_read_b128 v[24:27], v7 offset:17408
    v_xor_b32 v7, 0x100, v7
    s_waitcnt lgkmcnt(3)
    s_waitcnt vmcnt(9)
    v_mfma_f32_16x16x32_bf16 v[80:83], v[48:51], v[28:31], v[80:83]
    v_mfma_f32_16x16x32_bf16 v[96:99], v[48:51], v[32:35], v[96:99]
    v_mfma_f32_16x16x32_bf16 v[112:115], v[48:51], v[36:39], v[112:115]
    buffer_load_dwordx4 v[48:51], v14, s[44:47], s75 offen offset:2048 sc1
    s_waitcnt vmcnt(9)
    v_mfma_f32_16x16x32_bf16 v[84:87], v[52:55], v[28:31], v[84:87]
    v_mfma_f32_16x16x32_bf16 v[100:103], v[52:55], v[32:35], v[100:103]
    v_mfma_f32_16x16x32_bf16 v[116:119], v[52:55], v[36:39], v[116:119]
    buffer_load_dwordx4 v[52:55], v14, s[44:47], s75 offen offset:3072 sc1
    s_xor_b32 s75, s75, 12288
    s_waitcnt vmcnt(9)
    v_mfma_f32_16x16x32_bf16 v[88:91], v[56:59], v[28:31], v[88:91]
    v_mfma_f32_16x16x32_bf16 v[104:107], v[56:59], v[32:35], v[104:107]
    v_mfma_f32_16x16x32_bf16 v[120:123], v[56:59], v[36:39], v[120:123]
    buffer_load_dwordx4 v[56:59], v14, s[44:47], s75 offen offset:0 sc1
    s_waitcnt vmcnt(9)
    v_mfma_f32_16x16x32_bf16 v[92:95], v[60:63], v[28:31], v[92:95]
    v_mfma_f32_16x16x32_bf16 v[108:111], v[60:63], v[32:35], v[108:111]
    v_mfma_f32_16x16x32_bf16 v[124:127], v[60:63], v[36:39], v[124:127]
    buffer_load_dwordx4 v[60:63], v14, s[44:47], s75 offen offset:1024 sc1
    ds_read_b128 v[28:31], v8 offset:1024
    ds_read_b128 v[32:35], v8 offset:9216
    ds_read_b128 v[36:39], v8 offset:17408
    v_xor_b32 v8, 0x100, v8
    s_waitcnt lgkmcnt(3)
    s_waitcnt vmcnt(9)
    v_mfma_f32_16x16x32_bf16 v[80:83], v[64:67], v[16:19], v[80:83]
    v_mfma_f32_16x16x32_bf16 v[96:99], v[64:67], v[20:23], v[96:99]
    v_mfma_f32_16x16x32_bf16 v[112:115], v[64:67], v[24:27], v[112:115]
    buffer_load_dwordx4 v[64:67], v14, s[44:47], s75 offen offset:2048 sc1
    s_waitcnt vmcnt(9)
    v_mfma_f32_16x16x32_bf16 v[84:87], v[68:71], v[16:19], v[84:87]
    v_mfma_f32_16x16x32_bf16 v[100:103], v[68:71], v[20:23], v[100:103]
    v_mfma_f32_16x16x32_bf16 v[116:119], v[68:71], v[24:27], v[116:119]
    buffer_load_dwordx4 v[68:71], v14, s[44:47], s75 offen offset:3072 sc1
    s_xor_b32 s75, s75, 4096
    s_waitcnt vmcnt(9)
    v_mfma_f32_16x16x32_bf16 v[88:91], v[72:75], v[16:19], v[88:91]
    v_mfma_f32_16x16x32_bf16 v[104:107], v[72:75], v[20:23], v[104:107]
    v_mfma_f32_16x16x32_bf16 v[120:123], v[72:75], v[24:27], v[120:123]
    buffer_load_dwordx4 v[72:75], v14, s[44:47], s75 offen offset:0 sc1
    s_waitcnt vmcnt(9)
    v_mfma_f32_16x16x32_bf16 v[92:95], v[76:79], v[16:19], v[92:95]
    v_mfma_f32_16x16x32_bf16 v[108:111], v[76:79], v[20:23], v[108:111]
    v_mfma_f32_16x16x32_bf16 v[124:127], v[76:79], v[24:27], v[124:127]
    buffer_load_dwordx4 v[76:79], v14, s[44:47], s75 offen offset:1024 sc1
    ds_read_b128 v[16:19], v9 offset:1024
    ds_read_b128 v[20:23], v9 offset:9216
    ds_read_b128 v[24:27], v9 offset:17408
    v_xor_b32 v9, 0x100, v9
    s_waitcnt lgkmcnt(3)
    s_waitcnt vmcnt(9)
    v_mfma_f32_16x16x32_bf16 v[80:83], v[40:43], v[28:31], v[80:83]
    v_mfma_f32_16x16x32_bf16 v[96:99], v[40:43], v[32:35], v[96:99]
    v_mfma_f32_16x16x32_bf16 v[112:115], v[40:43], v[36:39], v[112:115]
    buffer_load_dwordx4 v[40:43], v14, s[44:47], s75 offen offset:2048 sc1
    s_waitcnt vmcnt(9)
    v_mfma_f32_16x16x32_bf16 v[84:87], v[44:47], v[28:31], v[84:87]
    v_mfma_f32_16x16x32_bf16 v[100:103], v[44:47], v[32:35], v[100:103]
    v_mfma_f32_16x16x32_bf16 v[116:119], v[44:47], v[36:39], v[116:119]
    buffer_load_dwordx4 v[44:47], v14, s[44:47], s75 offen offset:3072 sc1
    s_xor_b32 s75, s75, 28672
    s_waitcnt vmcnt(9)
    v_mfma_f32_16x16x32_bf16 v[88:91], v[48:51], v[28:31], v[88:91]
    v_mfma_f32_16x16x32_bf16 v[104:107], v[48:51], v[32:35], v[104:107]
    v_mfma_f32_16x16x32_bf16 v[120:123], v[48:51], v[36:39], v[120:123]
    s_add_u32 m0, s70, 0
    s_nop 0
    buffer_load_dwordx4 v13, s[40:43], 0 offen offset:0 lds
    s_waitcnt vmcnt(9)
    v_mfma_f32_16x16x32_bf16 v[92:95], v[52:55], v[28:31], v[92:95]
    v_mfma_f32_16x16x32_bf16 v[108:111], v[52:55], v[32:35], v[108:111]
    v_mfma_f32_16x16x32_bf16 v[124:127], v[52:55], v[36:39], v[124:127]
    buffer_load_dwordx4 v13, s[40:43], s71 offen offset:1024 lds
    ds_read_b128 v[28:31], v10 offset:1024
    ds_read_b128 v[32:35], v10 offset:9216
    ds_read_b128 v[36:39], v10 offset:17408
    v_xor_b32 v10, 0x100, v10
    s_waitcnt lgkmcnt(3)
    s_waitcnt vmcnt(9)
    v_mfma_f32_16x16x32_bf16 v[80:83], v[56:59], v[16:19], v[80:83]
    v_mfma_f32_16x16x32_bf16 v[96:99], v[56:59], v[20:23], v[96:99]
    v_mfma_f32_16x16x32_bf16 v[112:115], v[56:59], v[24:27], v[112:115]
    buffer_load_dwordx4 v13, s[40:43], s72 offen offset:2048 lds
    s_waitcnt vmcnt(9)
    v_mfma_f32_16x16x32_bf16 v[84:87], v[60:63], v[16:19], v[84:87]
    v_mfma_f32_16x16x32_bf16 v[100:103], v[60:63], v[20:23], v[100:103]
    v_mfma_f32_16x16x32_bf16 v[116:119], v[60:63], v[24:27], v[116:119]
    buffer_load_dwordx4 v13, s[40:43], s73 offen offset:3072 lds
    v_xor_b32 v13, 16384, v13
    s_waitcnt vmcnt(9)
    v_mfma_f32_16x16x32_bf16 v[88:91], v[64:67], v[16:19], v[88:91]
    v_mfma_f32_16x16x32_bf16 v[104:107], v[64:67], v[20:23], v[104:107]
    v_mfma_f32_16x16x32_bf16 v[120:123], v[64:67], v[24:27], v[120:123]
    s_add_u32 m0, s70, 4096
    s_nop 0
    buffer_load_dwordx4 v13, s[40:43], 0 offen offset:0 lds
    s_waitcnt vmcnt(9)
    v_mfma_f32_16x16x32_bf16 v[92:95], v[68:71], v[16:19], v[92:95]
    v_mfma_f32_16x16x32_bf16 v[108:111], v[68:71], v[20:23], v[108:111]
    v_mfma_f32_16x16x32_bf16 v[124:127], v[68:71], v[24:27], v[124:127]
    buffer_load_dwordx4 v13, s[40:43], s71 offen offset:1024 lds
    s_waitcnt lgkmcnt(0)
    s_waitcnt vmcnt(9)
    v_mfma_f32_16x16x32_bf16 v[80:83], v[72:75], v[28:31], v[80:83]
    v_mfma_f32_16x16x32_bf16 v[96:99], v[72:75], v[32:35], v[96:99]
    v_mfma_f32_16x16x32_bf16 v[112:115], v[72:75], v[36:39], v[112:115]
    buffer_load_dwordx4 v13, s[40:43], s72 offen offset:2048 lds
    s_waitcnt vmcnt(9)
    v_mfma_f32_16x16x32_bf16 v[84:87], v[76:79], v[28:31], v[84:87]
    v_mfma_f32_16x16x32_bf16 v[100:103], v[76:79], v[32:35], v[100:103]
    v_mfma_f32_16x16x32_bf16 v[116:119], v[76:79], v[36:39], v[116:119]
    buffer_load_dwordx4 v13, s[40:43], s73 offen offset:3072 lds
    v_xor_b32 v13, 49152, v13
    s_waitcnt vmcnt(9)
    v_mfma_f32_16x16x32_bf16 v[88:91], v[40:43], v[28:31], v[88:91]
    v_mfma_f32_16x16x32_bf16 v[104:107], v[40:43], v[32:35], v[104:107]
    v_mfma_f32_16x16x32_bf16 v[120:123], v[40:43], v[36:39], v[120:123]
    s_add_u32 m0, s70, 8192
    s_nop 0
    buffer_load_dwordx4 v13, s[40:43], 0 offen offset:0 lds
    s_waitcnt vmcnt(9)
    v_mfma_f32_16x16x32_bf16 v[92:95], v[44:47], v[28:31], v[92:95]
    v_mfma_f32_16x16x32_bf16 v[108:111], v[44:47], v[32:35], v[108:111]
    v_mfma_f32_16x16x32_bf16 v[124:127], v[44:47], v[36:39], v[124:127]
    buffer_load_dwordx4 v13, s[40:43], s71 offen offset:1024 lds
    s_lshl_b32 s64, s31, 3
    v_add_u32 v0, s64, v4
    v_xor_b32 v0, v0, v3
    v_lshlrev_b32 v0, 4, v0
    v_lshl_add_u32 v0, v3, 9, v0
    v_xor_b32 v1, 64, v0
    s_mov_b32 s76, 0x00ff00ff
    s_mov_b32 s77, 0x00ff00ff
    v_cvt_pk_bf16_f32 v16, v80, v81
    v_cvt_pk_bf16_f32 v17, v82, v83
    v_cvt_pk_bf16_f32 v18, v84, v85
    v_cvt_pk_bf16_f32 v19, v86, v87
    ds_write_b128 v0, v[16:19] offset:21504
    v_cvt_pk_bf16_f32 v20, v88, v89
    v_cvt_pk_bf16_f32 v21, v90, v91
    v_cvt_pk_bf16_f32 v22, v92, v93
    v_cvt_pk_bf16_f32 v23, v94, v95
    ds_write_b128 v1, v[20:23] offset:21504
    v_cvt_pk_bf16_f32 v24, v96, v97
    v_cvt_pk_bf16_f32 v25, v98, v99
    v_cvt_pk_bf16_f32 v26, v100, v101
    v_cvt_pk_bf16_f32 v27, v102, v103
    ds_write_b128 v0, v[24:27] offset:29696
    v_cvt_pk_bf16_f32 v28, v104, v105
    v_cvt_pk_bf16_f32 v29, v106, v107
    v_cvt_pk_bf16_f32 v30, v108, v109
    v_cvt_pk_bf16_f32 v31, v110, v111
    ds_write_b128 v1, v[28:31] offset:29696
    s_mov_b64 exec, s[76:77]
    v_cvt_pk_bf16_f32 v32, v112, v113
    v_cvt_pk_bf16_f32 v33, v114, v115
    v_cvt_pk_bf16_f32 v34, v116, v117
    v_cvt_pk_bf16_f32 v35, v118, v119
    ds_write_b128 v0, v[32:35] offset:37888
    v_cvt_pk_bf16_f32 v36, v120, v121
    v_cvt_pk_bf16_f32 v37, v122, v123
    v_cvt_pk_bf16_f32 v38, v124, v125
    v_cvt_pk_bf16_f32 v39, v126, v127
    ds_write_b128 v1, v[36:39] offset:37888
    s_mov_b64 exec, -1
    s_waitcnt lgkmcnt(0)
    s_barrier
    buffer_load_dwordx4 v13, s[40:43], s72 offen offset:2048 lds
    buffer_load_dwordx4 v13, s[40:43], s73 offen offset:3072 lds
    v_xor_b32 v13, 16384, v13
    s_add_u32 m0, s70, 12288
    s_nop 0
    buffer_load_dwordx4 v13, s[40:43], 0 offen offset:0 lds
    buffer_load_dwordx4 v13, s[40:43], s71 offen offset:1024 lds
    buffer_load_dwordx4 v13, s[40:43], s72 offen offset:2048 lds
    buffer_load_dwordx4 v13, s[40:43], s73 offen offset:3072 lds
    v_xor_b32 v13, 114688, v13
    v_lshlrev_b32 v0, 4, v4
    v_and_b32 v1, 7, v3
    v_lshl_add_u32 v0, v1, 9, v0
    v_and_b32 v1, 8, v3
    v_lshl_add_u32 v0, v1, 3, v0
    s_mul_i32 s74, s1, 20480
    s_lshl_b32 s64, s31, 7
    s_add_u32 s74, s74, s64
    s_waitcnt vmcnt(8)
    ds_read_b64_tr_b16 v[48:49], v11 offset:0
    ds_read_b64_tr_b16 v[50:51], v11 offset:512
    ds_read_b64_tr_b16 v[52:53], v11 offset:8
    ds_read_b64_tr_b16 v[54:55], v11 offset:520
    ds_read_b64_tr_b16 v[56:57], v12 offset:0
    ds_read_b64_tr_b16 v[58:59], v12 offset:512
    ds_read_b64_tr_b16 v[60:61], v12 offset:8
    ds_read_b64_tr_b16 v[62:63], v12 offset:520
    ds_read_b64_tr_b16 v[64:65], v11 offset:4096
    ds_read_b64_tr_b16 v[66:67], v11 offset:4608
    ds_read_b64_tr_b16 v[68:69], v11 offset:4104
    ds_read_b64_tr_b16 v[70:71], v11 offset:4616
    ds_read_b64_tr_b16 v[72:73], v12 offset:4096
    ds_read_b64_tr_b16 v[74:75], v12 offset:4608
    ds_read_b64_tr_b16 v[76:77], v12 offset:4104
    ds_read_b64_tr_b16 v[78:79], v12 offset:4616
    s_waitcnt lgkmcnt(8)
    s_add_u32 m0, s70, 0
    s_nop 0
    buffer_load_dwordx4 v13, s[40:43], 0 offen offset:0 lds
    buffer_load_dwordx4 v13, s[40:43], s71 offen offset:1024 lds
    buffer_load_dwordx4 v13, s[40:43], s72 offen offset:2048 lds
    buffer_load_dwordx4 v13, s[40:43], s73 offen offset:3072 lds
    v_xor_b32 v13, 16384, v13
    s_waitcnt lgkmcnt(0)
    s_add_u32 m0, s70, 4096
    s_nop 0
    buffer_load_dwordx4 v13, s[40:43], 0 offen offset:0 lds
    buffer_load_dwordx4 v13, s[40:43], s71 offen offset:1024 lds
    buffer_load_dwordx4 v13, s[40:43], s72 offen offset:2048 lds
    buffer_load_dwordx4 v13, s[40:43], s73 offen offset:3072 lds
    v_xor_b32 v13, 49152, v13
    s_lshl_b32 s64, s31, 12
    s_add_u32 s78, s64, 21504
    s_add_u32 s79, s64, 148480
    s_cmp_eq_u32 s31, 3
    s_cselect_b32 s79, 37888, s79
    s_sub_u32 s76, s78, s70
    s_sub_u32 s77, s79, s78
    v_xor_b32 v40, 0x100, v7
    v_xor_b32 v41, 0x100, v8
    v_xor_b32 v42, 0x100, v9
    v_xor_b32 v43, 0x100, v10
    s_barrier
    s_mov_b32 m0, s78
    s_nop 0
    buffer_load_dwordx4 v13, s[40:43], 0 offen offset:0 lds
    buffer_load_dwordx4 v13, s[40:43], s71 offen offset:1024 lds
    buffer_load_dwordx4 v13, s[40:43], s72 offen offset:2048 lds
    buffer_load_dwordx4 v13, s[40:43], s73 offen offset:3072 lds
    v_xor_b32 v13, 16384, v13
    s_mov_b32 m0, s79
    s_nop 0
    buffer_load_dwordx4 v13, s[40:43], 0 offen offset:0 lds
    buffer_load_dwordx4 v13, s[40:43], s71 offen offset:1024 lds
    buffer_load_dwordx4 v13, s[40:43], s72 offen offset:2048 lds
    buffer_load_dwordx4 v13, s[40:43], s73 offen offset:3072 lds
    v_xor_b32 v13, 114688, v13
    s_setprio 0
L_prog_39:
    ds_read_b128 v[16:19], v5 offset:32
    s_waitcnt lgkmcnt(0)
    v_min3_u32 v16, v16, v17, v18
    v_min_u32 v16, v16, v19
    v_cmp_gt_u32 vcc, 1, v16
    s_cbranch_vccnz L_retry_40
    ds_read_b128 v[16:19], v7 offset:1024
    ds_read_b128 v[20:23], v7 offset:9216
    ds_read_b128 v[24:27], v7 offset:17408
    s_waitcnt vmcnt(8)
    s_waitcnt lgkmcnt(0)
    v_mfma_f32_16x16x32_bf16 v[80:83], v[128:131], v[16:19], 0
    ds_read_b128 v[28:31], v8 offset:1024
    v_mfma_f32_16x16x32_bf16 v[96:99], v[128:131], v[20:23], 0
    ds_read_b128 v[32:35], v8 offset:9216
    v_mfma_f32_16x16x32_bf16 v[112:115], v[128:131], v[24:27], 0
    ds_read_b128 v[36:39], v8 offset:17408
    v_mfma_f32_16x16x32_bf16 v[84:87], v[132:135], v[16:19], 0
    v_mfma_f32_16x16x32_bf16 v[100:103], v[132:135], v[20:23], 0
    v_mfma_f32_16x16x32_bf16 v[116:119], v[132:135], v[24:27], 0
    v_mfma_f32_16x16x32_bf16 v[88:91], v[136:139], v[16:19], 0
    v_mfma_f32_16x16x32_bf16 v[104:107], v[136:139], v[20:23], 0
    v_mfma_f32_16x16x32_bf16 v[120:123], v[136:139], v[24:27], 0
    v_mfma_f32_16x16x32_bf16 v[92:95], v[140:143], v[16:19], 0
    v_mfma_f32_16x16x32_bf16 v[108:111], v[140:143], v[20:23], 0
    v_mfma_f32_16x16x32_bf16 v[124:127], v[140:143], v[24:27], 0
    s_waitcnt lgkmcnt(0)
    v_mfma_f32_16x16x32_bf16 v[80:83], v[144:147], v[28:31], v[80:83]
    ds_read_b128 v[16:19], v9 offset:1024
    v_mfma_f32_16x16x32_bf16 v[96:99], v[144:147], v[32:35], v[96:99]
    ds_read_b128 v[20:23], v9 offset:9216
    v_mfma_f32_16x16x32_bf16 v[112:115], v[144:147], v[36:39], v[112:115]
    ds_read_b128 v[24:27], v9 offset:17408
    v_mfma_f32_16x16x32_bf16 v[84:87], v[148:151], v[28:31], v[84:87]
    ds_read_b64_tr_b16 v[128:129], v11 offset:8192
    v_mfma_f32_16x16x32_bf16 v[100:103], v[148:151], v[32:35], v[100:103]
    ds_read_b64_tr_b16 v[130:131], v11 offset:8704
    v_mfma_f32_16x16x32_bf16 v[116:119], v[148:151], v[36:39], v[116:119]
    ds_read_b64_tr_b16 v[132:133], v11 offset:8200
    v_mfma_f32_16x16x32_bf16 v[88:91], v[152:155], v[28:31], v[88:91]
    ds_read_b64_tr_b16 v[134:135], v11 offset:8712
    v_mfma_f32_16x16x32_bf16 v[104:107], v[152:155], v[32:35], v[104:107]
    ds_read_b64_tr_b16 v[136:137], v12 offset:8192
    v_mfma_f32_16x16x32_bf16 v[120:123], v[152:155], v[36:39], v[120:123]
    ds_read_b64_tr_b16 v[138:139], v12 offset:8704
    v_mfma_f32_16x16x32_bf16 v[92:95], v[156:159], v[28:31], v[92:95]
    ds_read_b64_tr_b16 v[140:141], v12 offset:8200
    v_mfma_f32_16x16x32_bf16 v[108:111], v[156:159], v[32:35], v[108:111]
    ds_read_b64_tr_b16 v[142:143], v12 offset:8712
    v_mfma_f32_16x16x32_bf16 v[124:127], v[156:159], v[36:39], v[124:127]
    s_waitcnt lgkmcnt(8)
    v_mfma_f32_16x16x32_bf16 v[80:83], v[160:163], v[16:19], v[80:83]
    ds_read_b128 v[28:31], v10 offset:1024
    v_mfma_f32_16x16x32_bf16 v[96:99], v[160:163], v[20:23], v[96:99]
    ds_read_b128 v[32:35], v10 offset:9216
    v_mfma_f32_16x16x32_bf16 v[112:115], v[160:163], v[24:27], v[112:115]
    ds_read_b128 v[36:39], v10 offset:17408
    v_mfma_f32_16x16x32_bf16 v[84:87], v[164:167], v[16:19], v[84:87]
    ds_read_b64_tr_b16 v[144:145], v11 offset:12288
    v_mfma_f32_16x16x32_bf16 v[100:103], v[164:167], v[20:23], v[100:103]
    ds_read_b64_tr_b16 v[146:147], v11 offset:12800
    v_mfma_f32_16x16x32_bf16 v[116:119], v[164:167], v[24:27], v[116:119]
    ds_read_b64_tr_b16 v[148:149], v11 offset:12296
    v_mfma_f32_16x16x32_bf16 v[88:91], v[168:171], v[16:19], v[88:91]
    ds_read_b64_tr_b16 v[150:151], v11 offset:12808
    v_mfma_f32_16x16x32_bf16 v[104:107], v[168:171], v[20:23], v[104:107]
    ds_read_b64_tr_b16 v[152:153], v12 offset:12288
    v_mfma_f32_16x16x32_bf16 v[120:123], v[168:171], v[24:27], v[120:123]
    ds_read_b64_tr_b16 v[154:155], v12 offset:12800
    v_mfma_f32_16x16x32_bf16 v[92:95], v[172:175], v[16:19], v[92:95]
    ds_read_b64_tr_b16 v[156:157], v12 offset:12296
    v_mfma_f32_16x16x32_bf16 v[108:111], v[172:175], v[20:23], v[108:111]
    ds_read_b64_tr_b16 v[158:159], v12 offset:12808
    v_mfma_f32_16x16x32_bf16 v[124:127], v[172:175], v[24:27], v[124:127]
    s_waitcnt lgkmcnt(8)
    v_mfma_f32_16x16x32_bf16 v[80:83], v[176:179], v[28:31], v[80:83]
    ds_read_b128 v[16:19], v40 offset:1024
    v_mfma_f32_16x16x32_bf16 v[96:99], v[176:179], v[32:35], v[96:99]
    ds_read_b128 v[20:23], v40 offset:9216
    v_mfma_f32_16x16x32_bf16 v[112:115], v[176:179], v[36:39], v[112:115]
    ds_read_b128 v[24:27], v40 offset:17408
    v_mfma_f32_16x16x32_bf16 v[84:87], v[180:183], v[28:31], v[84:87]
    ds_read_b64_tr_b16 v[160:161], v11 offset:0
    v_mfma_f32_16x16x32_bf16 v[100:103], v[180:183], v[32:35], v[100:103]
    ds_read_b64_tr_b16 v[162:163], v11 offset:512
    v_mfma_f32_16x16x32_bf16 v[116:119], v[180:183], v[36:39], v[116:119]
    ds_read_b64_tr_b16 v[164:165], v11 offset:8
    v_mfma_f32_16x16x32_bf16 v[88:91], v[184:187], v[28:31], v[88:91]
    ds_read_b64_tr_b16 v[166:167], v11 offset:520
    v_mfma_f32_16x16x32_bf16 v[104:107], v[184:187], v[32:35], v[104:107]
    ds_read_b64_tr_b16 v[168:169], v12 offset:0
    v_mfma_f32_16x16x32_bf16 v[120:123], v[184:187], v[36:39], v[120:123]
    ds_read_b64_tr_b16 v[170:171], v12 offset:512
    v_mfma_f32_16x16x32_bf16 v[92:95], v[188:191], v[28:31], v[92:95]
    ds_read_b64_tr_b16 v[172:173], v12 offset:8
    v_mfma_f32_16x16x32_bf16 v[108:111], v[188:191], v[32:35], v[108:111]
    ds_read_b64_tr_b16 v[174:175], v12 offset:520
    v_mfma_f32_16x16x32_bf16 v[124:127], v[188:191], v[36:39], v[124:127]
    s_waitcnt lgkmcnt(8)
    v_mfma_f32_16x16x32_bf16 v[80:83], v[192:195], v[16:19], v[80:83]
    ds_read_b128 v[28:31], v41 offset:1024
    v_mfma_f32_16x16x32_bf16 v[96:99], v[192:195], v[20:23], v[96:99]
    ds_read_b128 v[32:35], v41 offset:9216
    v_mfma_f32_16x16x32_bf16 v[112:115], v[192:195], v[24:27], v[112:115]
    ds_read_b128 v[36:39], v41 offset:17408
    v_mfma_f32_16x16x32_bf16 v[84:87], v[196:199], v[16:19], v[84:87]
    ds_read_b64_tr_b16 v[176:177], v11 offset:4096
    v_mfma_f32_16x16x32_bf16 v[100:103], v[196:199], v[20:23], v[100:103]
    ds_read_b64_tr_b16 v[178:179], v11 offset:4608
    v_mfma_f32_16x16x32_bf16 v[116:119], v[196:199], v[24:27], v[116:119]
    ds_read_b64_tr_b16 v[180:181], v11 offset:4104
    v_mfma_f32_16x16x32_bf16 v[88:91], v[200:203], v[16:19], v[88:91]
    ds_read_b64_tr_b16 v[182:183], v11 offset:4616
    v_mfma_f32_16x16x32_bf16 v[104:107], v[200:203], v[20:23], v[104:107]
    ds_read_b64_tr_b16 v[184:185], v12 offset:4096
    v_mfma_f32_16x16x32_bf16 v[120:123], v[200:203], v[24:27], v[120:123]
    ds_read_b64_tr_b16 v[186:187], v12 offset:4608
    v_mfma_f32_16x16x32_bf16 v[92:95], v[204:207], v[16:19], v[92:95]
    ds_read_b64_tr_b16 v[188:189], v12 offset:4104
    v_mfma_f32_16x16x32_bf16 v[108:111], v[204:207], v[20:23], v[108:111]
    ds_read_b64_tr_b16 v[190:191], v12 offset:4616
    v_mfma_f32_16x16x32_bf16 v[124:127], v[204:207], v[24:27], v[124:127]
    s_waitcnt lgkmcnt(8)
    v_mfma_f32_16x16x32_bf16 v[80:83], v[208:211], v[28:31], v[80:83]
    ds_read_b128 v[16:19], v42 offset:1024
    v_mfma_f32_16x16x32_bf16 v[96:99], v[208:211], v[32:35], v[96:99]
    ds_read_b128 v[20:23], v42 offset:9216
    v_mfma_f32_16x16x32_bf16 v[112:115], v[208:211], v[36:39], v[112:115]
    ds_read_b128 v[24:27], v42 offset:17408
    v_mfma_f32_16x16x32_bf16 v[84:87], v[212:215], v[28:31], v[84:87]
    v_mfma_f32_16x16x32_bf16 v[100:103], v[212:215], v[32:35], v[100:103]
    v_mfma_f32_16x16x32_bf16 v[116:119], v[212:215], v[36:39], v[116:119]
    v_mfma_f32_16x16x32_bf16 v[88:91], v[216:219], v[28:31], v[88:91]
    v_mfma_f32_16x16x32_bf16 v[104:107], v[216:219], v[32:35], v[104:107]
    v_mfma_f32_16x16x32_bf16 v[120:123], v[216:219], v[36:39], v[120:123]
    v_mfma_f32_16x16x32_bf16 v[92:95], v[220:223], v[28:31], v[92:95]
    v_mfma_f32_16x16x32_bf16 v[108:111], v[220:223], v[32:35], v[108:111]
    v_mfma_f32_16x16x32_bf16 v[124:127], v[220:223], v[36:39], v[124:127]
    s_waitcnt lgkmcnt(0)
    v_mfma_f32_16x16x32_bf16 v[80:83], v[224:227], v[16:19], v[80:83]
    v_add_u32 v11, s76, v11
    v_add_u32 v12, s76, v12
    v_mfma_f32_16x16x32_bf16 v[96:99], v[224:227], v[20:23], v[96:99]
    ds_read_b128 v[28:31], v43 offset:1024
    v_mfma_f32_16x16x32_bf16 v[112:115], v[224:227], v[24:27], v[112:115]
    ds_read_b128 v[32:35], v43 offset:9216
    v_mfma_f32_16x16x32_bf16 v[84:87], v[228:231], v[16:19], v[84:87]
    ds_read_b128 v[36:39], v43 offset:17408
    v_mfma_f32_16x16x32_bf16 v[100:103], v[228:231], v[20:23], v[100:103]
    s_waitcnt vmcnt(4)
    ds_read_b64_tr_b16 v[192:193], v11 offset:0
    v_mfma_f32_16x16x32_bf16 v[116:119], v[228:231], v[24:27], v[116:119]
    ds_read_b64_tr_b16 v[194:195], v11 offset:512
    v_mfma_f32_16x16x32_bf16 v[88:91], v[232:235], v[16:19], v[88:91]
    ds_read_b64_tr_b16 v[196:197], v11 offset:8
    v_mfma_f32_16x16x32_bf16 v[104:107], v[232:235], v[20:23], v[104:107]
    ds_read_b64_tr_b16 v[198:199], v11 offset:520
    v_mfma_f32_16x16x32_bf16 v[120:123], v[232:235], v[24:27], v[120:123]
    ds_read_b64_tr_b16 v[200:201], v12 offset:0
    v_mfma_f32_16x16x32_bf16 v[92:95], v[236:239], v[16:19], v[92:95]
    ds_read_b64_tr_b16 v[202:203], v12 offset:512
    v_mfma_f32_16x16x32_bf16 v[108:111], v[236:239], v[20:23], v[108:111]
    ds_read_b64_tr_b16 v[204:205], v12 offset:8
    v_mfma_f32_16x16x32_bf16 v[124:127], v[236:239], v[24:27], v[124:127]
    ds_read_b64_tr_b16 v[206:207], v12 offset:520
    s_waitcnt lgkmcnt(8)
    v_mfma_f32_16x16x32_bf16 v[80:83], v[240:243], v[28:31], v[80:83]
    v_add_u32 v11, s77, v11
    v_add_u32 v12, s77, v12
    v_mfma_f32_16x16x32_bf16 v[96:99], v[240:243], v[32:35], v[96:99]
    s_waitcnt vmcnt(0)
    ds_read_b64_tr_b16 v[208:209], v11 offset:0
    v_mfma_f32_16x16x32_bf16 v[112:115], v[240:243], v[36:39], v[112:115]
    ds_read_b64_tr_b16 v[210:211], v11 offset:512
    v_mfma_f32_16x16x32_bf16 v[84:87], v[244:247], v[28:31], v[84:87]
    ds_read_b64_tr_b16 v[212:213], v11 offset:8
    v_mfma_f32_16x16x32_bf16 v[100:103], v[244:247], v[32:35], v[100:103]
    ds_read_b64_tr_b16 v[214:215], v11 offset:520
    v_mfma_f32_16x16x32_bf16 v[116:119], v[244:247], v[36:39], v[116:119]
    ds_read_b64_tr_b16 v[216:217], v12 offset:0
    v_mfma_f32_16x16x32_bf16 v[88:91], v[248:251], v[28:31], v[88:91]
    ds_read_b64_tr_b16 v[218:219], v12 offset:512
    v_mfma_f32_16x16x32_bf16 v[104:107], v[248:251], v[32:35], v[104:107]
    ds_read_b64_tr_b16 v[220:221], v12 offset:8
    v_mfma_f32_16x16x32_bf16 v[120:123], v[248:251], v[36:39], v[120:123]
    ds_read_b64_tr_b16 v[222:223], v12 offset:520
    v_mfma_f32_16x16x32_bf16 v[92:95], v[252:255], v[28:31], v[92:95]
    v_mfma_f32_16x16x32_bf16 v[108:111], v[252:255], v[32:35], v[108:111]
    v_mfma_f32_16x16x32_bf16 v[124:127], v[252:255], v[36:39], v[124:127]
    s_add_u32 s75, s74, 4096
    s_add_u32 s76, s74, 8192
    s_add_u32 s77, s74, 12288
    s_add_u32 s78, s74, 16384
L_prog_41:
    ds_read_b128 v[16:19], v5 offset:32
    s_waitcnt lgkmcnt(0)
    v_min3_u32 v16, v16, v17, v18
    v_min_u32 v16, v16, v19
    v_cmp_gt_u32 vcc, 1, v16
    s_cbranch_vccnz L_retry_42
    ds_read_b128 v[16:19], v7 offset:58368
    ds_read_b128 v[20:23], v8 offset:58368
    ds_read_b128 v[24:27], v9 offset:58368
    ds_read_b128 v[28:31], v10 offset:58368
    ds_read_b128 v[32:35], v40 offset:58368
    ds_read_b128 v[36:39], v41 offset:58368
    ds_read_b128 v[44:47], v42 offset:58368
    ds_read_b128 v[252:255], v43 offset:58368
    s_waitcnt lgkmcnt(7)
    v_mfma_f32_16x16x32_bf16 v[120:123], v[56:59], v[16:19], v[120:123]
    v_mfma_f32_16x16x32_bf16 v[124:127], v[60:63], v[16:19], v[124:127]
    v_mfma_f32_16x16x32_bf16 v[112:115], v[48:51], v[16:19], v[112:115]
    v_mfma_f32_16x16x32_bf16 v[116:119], v[52:55], v[16:19], v[116:119]
    s_waitcnt lgkmcnt(6)
    v_mfma_f32_16x16x32_bf16 v[120:123], v[72:75], v[20:23], v[120:123]
    v_mfma_f32_16x16x32_bf16 v[124:127], v[76:79], v[20:23], v[124:127]
    v_mfma_f32_16x16x32_bf16 v[112:115], v[64:67], v[20:23], v[112:115]
    v_mfma_f32_16x16x32_bf16 v[116:119], v[68:71], v[20:23], v[116:119]
    s_waitcnt lgkmcnt(5)
    v_mfma_f32_16x16x32_bf16 v[120:123], v[136:139], v[24:27], v[120:123]
    v_mfma_f32_16x16x32_bf16 v[124:127], v[140:143], v[24:27], v[124:127]
    v_mfma_f32_16x16x32_bf16 v[112:115], v[128:131], v[24:27], v[112:115]
    v_mfma_f32_16x16x32_bf16 v[116:119], v[132:135], v[24:27], v[116:119]
    s_waitcnt lgkmcnt(4)
    v_mfma_f32_16x16x32_bf16 v[120:123], v[152:155], v[28:31], v[120:123]
    v_mfma_f32_16x16x32_bf16 v[124:127], v[156:159], v[28:31], v[124:127]
    v_mfma_f32_16x16x32_bf16 v[112:115], v[144:147], v[28:31], v[112:115]
    v_mfma_f32_16x16x32_bf16 v[116:119], v[148:151], v[28:31], v[116:119]
    s_waitcnt lgkmcnt(3)
    v_mfma_f32_16x16x32_bf16 v[120:123], v[168:171], v[32:35], v[120:123]
    v_mfma_f32_16x16x32_bf16 v[124:127], v[172:175], v[32:35], v[124:127]
    v_mfma_f32_16x16x32_bf16 v[112:115], v[160:163], v[32:35], v[112:115]
    v_mfma_f32_16x16x32_bf16 v[116:119], v[164:167], v[32:35], v[116:119]
    s_waitcnt lgkmcnt(2)
    v_mfma_f32_16x16x32_bf16 v[120:123], v[184:187], v[36:39], v[120:123]
    v_mfma_f32_16x16x32_bf16 v[124:127], v[188:191], v[36:39], v[124:127]
    v_mfma_f32_16x16x32_bf16 v[112:115], v[176:179], v[36:39], v[112:115]
    v_mfma_f32_16x16x32_bf16 v[116:119], v[180:183], v[36:39], v[116:119]
    s_waitcnt lgkmcnt(1)
    v_mfma_f32_16x16x32_bf16 v[120:123], v[200:203], v[44:47], v[120:123]
    v_mfma_f32_16x16x32_bf16 v[124:127], v[204:207], v[44:47], v[124:127]
    v_mfma_f32_16x16x32_bf16 v[112:115], v[192:195], v[44:47], v[112:115]
    v_mfma_f32_16x16x32_bf16 v[116:119], v[196:199], v[44:47], v[116:119]
    s_waitcnt lgkmcnt(0)
    v_mfma_f32_16x16x32_bf16 v[120:123], v[216:219], v[252:255], v[120:123]
    v_mfma_f32_16x16x32_bf16 v[124:127], v[220:223], v[252:255], v[124:127]
    v_mfma_f32_16x16x32_bf16 v[112:115], v[208:211], v[252:255], v[112:115]
    v_mfma_f32_16x16x32_bf16 v[116:119], v[212:215], v[252:255], v[116:119]
L_prog_43:
    ds_read_b128 v[16:19], v5 offset:32
    s_waitcnt lgkmcnt(0)
    v_min3_u32 v16, v16, v17, v18
    v_min_u32 v16, v16, v19
    v_cmp_gt_u32 vcc, 3, v16
    s_cbranch_vccnz L_retry_44
    ds_read_b128 v[16:19], v7 offset:41984
    ds_read_b128 v[20:23], v8 offset:41984
    ds_read_b128 v[24:27], v9 offset:41984
    ds_read_b128 v[28:31], v10 offset:41984
    ds_read_b128 v[32:35], v40 offset:41984
    ds_read_b128 v[36:39], v41 offset:41984
    ds_read_b128 v[44:47], v42 offset:41984
    ds_read_b128 v[252:255], v43 offset:41984
    s_waitcnt lgkmcnt(7)
    v_mfma_f32_16x16x32_bf16 v[88:91], v[56:59], v[16:19], v[88:91]
    v_cvt_pk_bf16_f32 v248, v120, v121
    v_mfma_f32_16x16x32_bf16 v[92:95], v[60:63], v[16:19], v[92:95]
    v_cvt_pk_bf16_f32 v249, v122, v123
    v_mfma_f32_16x16x32_bf16 v[80:83], v[48:51], v[16:19], v[80:83]
    v_cvt_pk_bf16_f32 v250, v124, v125
    v_mfma_f32_16x16x32_bf16 v[84:87], v[52:55], v[16:19], v[84:87]
    v_cvt_pk_bf16_f32 v251, v126, v127
    s_waitcnt lgkmcnt(6)
    v_mfma_f32_16x16x32_bf16 v[88:91], v[72:75], v[20:23], v[88:91]
    v_cvt_pk_bf16_f32 v244, v112, v113
    v_mfma_f32_16x16x32_bf16 v[92:95], v[76:79], v[20:23], v[92:95]
    v_cvt_pk_bf16_f32 v245, v114, v115
    v_mfma_f32_16x16x32_bf16 v[80:83], v[64:67], v[20:23], v[80:83]
    v_cvt_pk_bf16_f32 v246, v116, v117
    v_mfma_f32_16x16x32_bf16 v[84:87], v[68:71], v[20:23], v[84:87]
    v_cvt_pk_bf16_f32 v247, v118, v119
    s_waitcnt lgkmcnt(5)
    v_mfma_f32_16x16x32_bf16 v[88:91], v[136:139], v[24:27], v[88:91]
    v_mov_b32_dpp v244, v248 row_ror:8 row_mask:0xf bank_mask:0xc
    v_mfma_f32_16x16x32_bf16 v[92:95], v[140:143], v[24:27], v[92:95]
    v_mov_b32_dpp v245, v249 row_ror:8 row_mask:0xf bank_mask:0xc
    v_mfma_f32_16x16x32_bf16 v[80:83], v[128:131], v[24:27], v[80:83]
    v_mov_b32_dpp v246, v250 row_ror:8 row_mask:0xf bank_mask:0xc
    v_mfma_f32_16x16x32_bf16 v[84:87], v[132:135], v[24:27], v[84:87]
    v_mov_b32_dpp v247, v251 row_ror:8 row_mask:0xf bank_mask:0xc
    s_waitcnt lgkmcnt(4)
    v_mfma_f32_16x16x32_bf16 v[88:91], v[152:155], v[28:31], v[88:91]
    v_mfma_f32_16x16x32_bf16 v[92:95], v[156:159], v[28:31], v[92:95]
    v_mfma_f32_16x16x32_bf16 v[80:83], v[144:147], v[28:31], v[80:83]
    v_mfma_f32_16x16x32_bf16 v[84:87], v[148:151], v[28:31], v[84:87]
    s_waitcnt lgkmcnt(3)
    v_mfma_f32_16x16x32_bf16 v[88:91], v[168:171], v[32:35], v[88:91]
    v_mfma_f32_16x16x32_bf16 v[92:95], v[172:175], v[32:35], v[92:95]
    v_mfma_f32_16x16x32_bf16 v[80:83], v[160:163], v[32:35], v[80:83]
    v_mfma_f32_16x16x32_bf16 v[84:87], v[164:167], v[32:35], v[84:87]
    s_waitcnt lgkmcnt(2)
    v_mfma_f32_16x16x32_bf16 v[88:91], v[184:187], v[36:39], v[88:91]
    v_mfma_f32_16x16x32_bf16 v[92:95], v[188:191], v[36:39], v[92:95]
    v_mfma_f32_16x16x32_bf16 v[80:83], v[176:179], v[36:39], v[80:83]
    v_mfma_f32_16x16x32_bf16 v[84:87], v[180:183], v[36:39], v[84:87]
    s_waitcnt lgkmcnt(1)
    v_mfma_f32_16x16x32_bf16 v[88:91], v[200:203], v[44:47], v[88:91]
    v_mfma_f32_16x16x32_bf16 v[92:95], v[204:207], v[44:47], v[92:95]
    v_mfma_f32_16x16x32_bf16 v[80:83], v[192:195], v[44:47], v[80:83]
    v_mfma_f32_16x16x32_bf16 v[84:87], v[196:199], v[44:47], v[84:87]
    s_waitcnt lgkmcnt(0)
    v_mfma_f32_16x16x32_bf16 v[88:91], v[216:219], v[252:255], v[88:91]
    v_mfma_f32_16x16x32_bf16 v[92:95], v[220:223], v[252:255], v[92:95]
    v_mfma_f32_16x16x32_bf16 v[80:83], v[208:211], v[252:255], v[80:83]
    v_mfma_f32_16x16x32_bf16 v[84:87], v[212:215], v[252:255], v[84:87]
    s_nop 4
    v_cvt_pk_bf16_f32 v228, v88, v89
    v_cvt_pk_bf16_f32 v229, v90, v91
    v_cvt_pk_bf16_f32 v230, v92, v93
    v_cvt_pk_bf16_f32 v231, v94, v95
    v_cvt_pk_bf16_f32 v224, v80, v81
    v_cvt_pk_bf16_f32 v225, v82, v83
    v_cvt_pk_bf16_f32 v226, v84, v85
    v_cvt_pk_bf16_f32 v227, v86, v87
    v_cvt_pk_bf16_f32 v240, v80, v81
    v_cvt_pk_bf16_f32 v241, v82, v83
    v_cvt_pk_bf16_f32 v242, v84, v85
    v_cvt_pk_bf16_f32 v243, v86, v87
    v_mov_b32_dpp v224, v228 row_ror:8 row_mask:0xf bank_mask:0xc
    v_mov_b32_dpp v225, v229 row_ror:8 row_mask:0xf bank_mask:0xc
    v_mov_b32_dpp v226, v230 row_ror:8 row_mask:0xf bank_mask:0xc
    v_mov_b32_dpp v227, v231 row_ror:8 row_mask:0xf bank_mask:0xc
    v_mov_b32_dpp v228, v240 row_ror:8 row_mask:0xf bank_mask:0x3
    v_mov_b32_dpp v229, v241 row_ror:8 row_mask:0xf bank_mask:0x3
    v_mov_b32_dpp v230, v242 row_ror:8 row_mask:0xf bank_mask:0x3
    v_mov_b32_dpp v231, v243 row_ror:8 row_mask:0xf bank_mask:0x3
L_prog_45:
    ds_read_b128 v[16:19], v5 offset:48
    s_waitcnt lgkmcnt(0)
    v_min3_u32 v16, v16, v17, v18
    v_min_u32 v16, v16, v19
    v_cmp_gt_u32 vcc, 1, v16
    s_cbranch_vccnz L_retry_46
    s_setprio 2
    buffer_store_dwordx4 v[244:247], v0, s[48:51], s78 offen sc1
    buffer_store_dwordx4 v[224:227], v0, s[48:51], s74 offen sc1
    buffer_store_dwordx4 v[228:231], v0, s[48:51], s75 offen sc1
    s_setprio 0
    v_lshlrev_b32 v1, 4, v4
    v_lshl_add_u32 v1, v3, 9, v1
    s_barrier
    s_setprio 2
    ds_read_b128 v[16:19], v7 offset:50176
    ds_read_b128 v[20:23], v8 offset:50176
    ds_read_b128 v[24:27], v9 offset:50176
    ds_read_b128 v[28:31], v10 offset:50176
    ds_read_b128 v[32:35], v40 offset:50176
    ds_read_b128 v[36:39], v41 offset:50176
    ds_read_b128 v[44:47], v42 offset:50176
    ds_read_b128 v[252:255], v43 offset:50176
    s_waitcnt lgkmcnt(7)
    v_mfma_f32_16x16x32_bf16 v[104:107], v[56:59], v[16:19], v[104:107]
    v_mfma_f32_16x16x32_bf16 v[108:111], v[60:63], v[16:19], v[108:111]
    s_waitcnt lgkmcnt(6)
    v_mfma_f32_16x16x32_bf16 v[104:107], v[72:75], v[20:23], v[104:107]
    v_mfma_f32_16x16x32_bf16 v[108:111], v[76:79], v[20:23], v[108:111]
    s_waitcnt lgkmcnt(5)
    v_mfma_f32_16x16x32_bf16 v[104:107], v[136:139], v[24:27], v[104:107]
    v_mfma_f32_16x16x32_bf16 v[108:111], v[140:143], v[24:27], v[108:111]
    s_waitcnt lgkmcnt(4)
    v_mfma_f32_16x16x32_bf16 v[104:107], v[152:155], v[28:31], v[104:107]
    v_mfma_f32_16x16x32_bf16 v[108:111], v[156:159], v[28:31], v[108:111]
    s_waitcnt lgkmcnt(3)
    v_mfma_f32_16x16x32_bf16 v[104:107], v[168:171], v[32:35], v[104:107]
    v_mfma_f32_16x16x32_bf16 v[108:111], v[172:175], v[32:35], v[108:111]
    s_waitcnt lgkmcnt(2)
    v_mfma_f32_16x16x32_bf16 v[104:107], v[184:187], v[36:39], v[104:107]
    v_mfma_f32_16x16x32_bf16 v[108:111], v[188:191], v[36:39], v[108:111]
    s_waitcnt lgkmcnt(1)
    v_mfma_f32_16x16x32_bf16 v[104:107], v[200:203], v[44:47], v[104:107]
    v_mfma_f32_16x16x32_bf16 v[108:111], v[204:207], v[44:47], v[108:111]
    s_waitcnt lgkmcnt(0)
    v_mfma_f32_16x16x32_bf16 v[104:107], v[216:219], v[252:255], v[104:107]
    v_mfma_f32_16x16x32_bf16 v[108:111], v[220:223], v[252:255], v[108:111]
    v_mfma_f32_16x16x32_bf16 v[96:99], v[48:51], v[16:19], v[96:99]
    v_mfma_f32_16x16x32_bf16 v[100:103], v[52:55], v[16:19], v[100:103]
    v_mfma_f32_16x16x32_bf16 v[96:99], v[64:67], v[20:23], v[96:99]
    v_mfma_f32_16x16x32_bf16 v[100:103], v[68:71], v[20:23], v[100:103]
    v_mfma_f32_16x16x32_bf16 v[96:99], v[128:131], v[24:27], v[96:99]
    v_mfma_f32_16x16x32_bf16 v[100:103], v[132:135], v[24:27], v[100:103]
    v_mfma_f32_16x16x32_bf16 v[96:99], v[144:147], v[28:31], v[96:99]
    v_mfma_f32_16x16x32_bf16 v[100:103], v[148:151], v[28:31], v[100:103]
    v_cvt_pk_bf16_f32 v236, v104, v105
    v_mfma_f32_16x16x32_bf16 v[96:99], v[160:163], v[32:35], v[96:99]
    v_cvt_pk_bf16_f32 v237, v106, v107
    v_mfma_f32_16x16x32_bf16 v[100:103], v[164:167], v[32:35], v[100:103]
    v_cvt_pk_bf16_f32 v238, v108, v109
    v_mfma_f32_16x16x32_bf16 v[96:99], v[176:179], v[36:39], v[96:99]
    v_cvt_pk_bf16_f32 v239, v110, v111
    v_mfma_f32_16x16x32_bf16 v[100:103], v[180:183], v[36:39], v[100:103]
    buffer_store_dwordx4 v[236:239], v1, s[48:51], s76 offen offset:64 sc1
    v_mfma_f32_16x16x32_bf16 v[96:99], v[192:195], v[44:47], v[96:99]
    v_mfma_f32_16x16x32_bf16 v[100:103], v[196:199], v[44:47], v[100:103]
    v_mfma_f32_16x16x32_bf16 v[96:99], v[208:211], v[252:255], v[96:99]
    v_mfma_f32_16x16x32_bf16 v[100:103], v[212:215], v[252:255], v[100:103]
    s_nop 6
    v_cvt_pk_bf16_f32 v232, v96, v97
    v_cvt_pk_bf16_f32 v233, v98, v99
    v_cvt_pk_bf16_f32 v234, v100, v101
    v_cvt_pk_bf16_f32 v235, v102, v103
    buffer_store_dwordx4 v[232:235], v1, s[48:51], s76 offen offset:0 sc1
    s_or_b32 s64, s2, s3
    s_cbranch_scc1 L_noepoch_47
    v_mov_b32 v1, s30
    s_mov_b64 exec, 1
    buffer_store_dword v1, v5, s[44:47], 0 offen sc1
L_noepoch_47:
    s_endpgm
L_retry_35:
    s_sub_u32 s100, s100, 1
    s_cbranch_scc1 L_end
    s_sleep 1
    s_branch L_spin_34
L_mre_36:
    s_sub_u32 s100, s100, 1
    s_cbranch_scc1 L_end
    s_sleep 2
    buffer_load_dword v1, v0, s[44:47], s74 offen sc1
    s_waitcnt vmcnt(0)
    s_branch L_mchk_33
L_retry_38:
    s_sub_u32 s100, s100, 1
    s_cbranch_scc1 L_end
    s_sleep 1
    s_branch L_spin_37
L_retry_40:
    s_sub_u32 s100, s100, 1
    s_cbranch_scc1 L_end
    s_sleep 1
    s_branch L_prog_39
L_retry_42:
    s_sub_u32 s100, s100, 1
    s_cbranch_scc1 L_end
    s_sleep 1
    s_branch L_prog_41
L_retry_44:
    s_sub_u32 s100, s100, 1
    s_cbranch_scc1 L_end
    s_sleep 1
    s_branch L_prog_43
L_retry_46:
    s_sub_u32 s100, s100, 1
    s_cbranch_scc1 L_end
    s_sleep 1
    s_branch L_prog_45
L_end:
    s_endpgm
.section .rodata,"a"
.p2align 6
.amdhsa_kernel standalone__hybrid_graph_tf_exphormer__graph_kernel
  .amdhsa_next_free_vgpr 256
  .amdhsa_next_free_sgpr 102
  .amdhsa_accum_offset 256
  .amdhsa_group_segment_fixed_size 0
  .amdhsa_kernarg_size 104
  .amdhsa_user_sgpr_count 2
  .amdhsa_user_sgpr_kernarg_segment_ptr 1
  .amdhsa_system_sgpr_workgroup_id_x 1
  .amdhsa_float_denorm_mode_32 3
.end_amdhsa_kernel
```
